```python
import torch

def _softmax(x, axis=-1):
    return torch.softmax(x, dim=axis)

def _gelu(x):
    return torch.nn.functional.gelu(x, approximate='tanh')

def _silu(x):
    return torch.nn.functional.silu(x)

def _sigmoid(x):
    return torch.sigmoid(x)

def _layernorm(x, axis=-1, eps=1e-05):
    m = x.mean(dim=axis, keepdim=True)
    v = x.var(dim=axis, keepdim=True, unbiased=False)
    return (x - m) / torch.sqrt(v + eps)

def _scatter_add(tgt, idx, src, axis=0):
    return tgt.clone().index_add_(axis, idx, src)

def _segment_sum(src, seg, n):
    out = torch.zeros((n,) + src.shape[1:], dtype=src.dtype)
    return out.index_add_(0, seg, src)

def _pad(x, pw):
    flat = tuple((v for pair in reversed(pw) for v in pair))
    return torch.nn.functional.pad(x, flat)
kernel_name = 'concat_heads__memory_aug_recurrent_mem_tr__mha_block__prompt'

def setup_inputs():

    _w = lambda a: (lambda t: t.to(torch.bfloat16) if t.is_floating_point() else t)(torch.as_tensor(a))

    def _A_setup():
        B, S, Dm = (1, 2048, 640)
        H, Dh = (32, 192)
        M, seg = (8, 32)
        seg = min(seg, S)
        S = S // seg * seg
        return {'x': _w((lambda *s: torch.randn(*s, dtype=torch.bfloat16) * 0.05)(B, S, Dm)), 'mem0': _w((lambda *s: torch.randn(*s, dtype=torch.bfloat16) * 0.8)(B, M, Dm)), 'Wq': _w((lambda *s: torch.randn(*s, dtype=torch.bfloat16) * 1.6)(Dm, H, Dh) * Dm ** (-0.5)), 'Wk': _w((lambda *s: torch.randn(*s, dtype=torch.bfloat16) * 1.6)(Dm, H, Dh) * Dm ** (-0.5)), 'Wv': _w((lambda *s: torch.randn(*s, dtype=torch.bfloat16) * 0.8)(Dm, H, Dh) * Dm ** (-0.5)), 'Wo': _w((lambda *s: torch.randn(*s, dtype=torch.bfloat16) * 0.8)(H, Dh, Dm) * (H * Dh) ** (-0.5)), 'seg_len': seg}
    _A_in = _A_setup()

    def _B_setup():
        B, S, D, H = (1, 2048, 640, 32)
        return {'x': _w((lambda *s: torch.randn(*s, dtype=torch.bfloat16) * 0.2)(B, S, D)), 'wqkv': _w((lambda *s: torch.randn(*s, dtype=torch.bfloat16) * 0.2)(D, 3 * D)), 'wo': _w((lambda *s: torch.randn(*s, dtype=torch.bfloat16) * 0.05)(D, D))}
    _B_in = _B_setup()
    return {'A_x': _A_in['x'], 'A_mem0': _A_in['mem0'], 'A_Wq': _A_in['Wq'], 'A_Wk': _A_in['Wk'], 'A_Wv': _A_in['Wv'], 'A_Wo': _A_in['Wo'], 'A_seg_len': _A_in['seg_len'], 'B_x': _B_in['x'], 'B_wqkv': _B_in['wqkv'], 'B_wo': _B_in['wo']}

def reference(A_x, A_mem0, A_Wq, A_Wk, A_Wv, A_Wo, A_seg_len, B_x, B_wqkv, B_wo):

    def _A_ref(x, mem0, Wq, Wk, Wv, Wo, seg_len):
        B, S, Dm = x.shape
        H, Dh = (Wq.shape[1], Wq.shape[2])
        M = mem0.shape[1]
        scale = Dh ** (-0.5)
        n_seg = S // seg_len
        L = M + seg_len
        idx = torch.arange(L)
        mask = (idx[:, None] < M) | (idx[:, None] >= idx[None, :])
        mem = mem0
        outs = []
        for s in range(n_seg):
            xs = x[:, s * seg_len:(s + 1) * seg_len, :].clone()
            h = torch.concatenate([mem, xs], axis=1)
            q = torch.einsum('btd,dhe->bhte', h, Wq)
            k = torch.einsum('btd,dhe->bhte', h, Wk)
            v = torch.einsum('btd,dhe->bhte', h, Wv)
            scores = torch.einsum('bhqe,bhke->bhqk', q, k) * scale
            scores = torch.where(mask[None, None], scores, -1000000000.0)
            p = _softmax(scores, axis=-1)
            o = torch.einsum('bhqk,bhke->bhqe', p, v)
            o = torch.einsum('bhte,hed->btd', o, Wo)
            mem = o[:, :M, :].clone()
            outs.append(o[:, M:, :])
        return torch.concatenate(outs, axis=1)

    def _B_ref(x, wqkv, wo):
        B, S, D = x.shape
        H = 32
        Dh = D // H
        qkv = (lambda x, *d: x.permute(*d))((x @ wqkv).reshape(B, S, 3, H, Dh), 2, 0, 3, 1, 4)
        q, k, v = (qkv[0], qkv[1], qkv[2])
        scores = torch.einsum('bhqd,bhkd->bhqk', q, k) * Dh ** (-0.5)
        p = _softmax(scores, axis=-1)
        o = torch.einsum('bhqk,bhkd->bhqd', p, v)
        return (lambda x, *d: x.permute(*d))(o, 0, 2, 1, 3).reshape(B, S, D) @ wo
    a = _A_ref(A_x, A_mem0, A_Wq, A_Wk, A_Wv, A_Wo, A_seg_len)
    b = _B_ref(B_x, B_wqkv, B_wo)
    return torch.concatenate([a, b], axis=-1)
```

```asm
; @launch grid=(256,1,1) block=(256,1,1) lds=163840
.amdgcn_target "amdgcn-amd-amdhsa--gfx950"
.text
.globl concat_heads__memory_aug_recurrent_mem_tr__mha_block__prompt_kernel
.p2align 8
.type concat_heads__memory_aug_recurrent_mem_tr__mha_block__prompt_kernel,@function
concat_heads__memory_aug_recurrent_mem_tr__mha_block__prompt_kernel:
  s_cmp_ge_u32 s2, 256
  s_cbranch_scc0 L_start
  s_endpgm
L_start:
  s_load_dwordx2 s[4:5], s[0:1], 0
  s_load_dwordx2 s[8:9], s[0:1], 8
  s_load_dwordx2 s[12:13], s[0:1], 16
  s_load_dwordx2 s[16:17], s[0:1], 24
  s_load_dwordx2 s[20:21], s[0:1], 32
  s_load_dwordx2 s[24:25], s[0:1], 40
  s_load_dwordx2 s[28:29], s[0:1], 56
  s_load_dwordx2 s[32:33], s[0:1], 64
  s_load_dwordx2 s[36:37], s[0:1], 72
  s_load_dwordx2 s[40:41], s[0:1], 80
  s_load_dwordx2 s[44:45], s[0:1], 88
  s_load_dwordx2 s[48:49], s[0:1], 96
  s_mov_b32 s6, 0x280000
  s_mov_b32 s7, 0x20000
  s_mov_b32 s10, 0x2800
  s_mov_b32 s11, 0x20000
  s_mov_b32 s14, 0x780000
  s_mov_b32 s15, 0x20000
  s_mov_b32 s18, 0x780000
  s_mov_b32 s19, 0x20000
  s_mov_b32 s22, 0x780000
  s_mov_b32 s23, 0x20000
  s_mov_b32 s26, 0x780000
  s_mov_b32 s27, 0x20000
  s_mov_b32 s30, 0x280000
  s_mov_b32 s31, 0x20000
  s_mov_b32 s34, 0x258000
  s_mov_b32 s35, 0x20000
  s_mov_b32 s38, 0xc8000
  s_mov_b32 s39, 0x20000
  s_mov_b32 s42, 0x500000
  s_mov_b32 s43, 0x20000
  s_mov_b32 s46, 0x100
  s_mov_b32 s47, 0x20000
  s_mov_b32 s50, 0x10000000
  s_mov_b32 s51, 0x20000
  s_getreg_b32 s57, hwreg(HW_REG_XCC_ID, 0, 4)
  s_and_b32 s57, s57, 7
  s_mov_b32 s55, 0
  v_lshrrev_b32 v1, 6, v0
  s_nop 0
  v_readfirstlane_b32 s52, v1
  s_waitcnt lgkmcnt(0)
  s_cmp_lg_u32 s52, 0
  s_cbranch_scc1 noticket_1
  s_lshl_b32 s58, s57, 2
  v_mov_b32 v3, s58
  v_mov_b32 v2, 1
  s_mov_b64 exec, 1
  buffer_atomic_add v2, v3, s[44:47], 0 offen sc0
  s_mov_b64 exec, -1
noticket_1:
  s_lshl_b32 s58, s2, 13
  v_lshlrev_b32 v1, 4, v0
  v_add_u32 v1, s58, v1
  v_add_u32 v8, 0x1000, v1
  v_mov_b32 v4, 0
  v_mov_b32 v5, 0
  v_mov_b32 v6, 0
  v_mov_b32 v7, 0
  buffer_store_dwordx4 v[4:7], v1, s[48:51], 0 offen sc1
  buffer_store_dwordx4 v[4:7], v8, s[48:51], 0 offen sc1
  s_cmp_lg_u32 s52, 0
  s_cbranch_scc1 notick2_2
  s_waitcnt vmcnt(2)
  v_mov_b32 v3, 0
  s_mov_b64 exec, 1
  ds_write_b32 v3, v2
  s_mov_b64 exec, -1
  s_waitcnt lgkmcnt(0)
notick2_2:
  s_waitcnt vmcnt(0)
  s_barrier
  v_mov_b32 v3, 0
  ds_read_b32 v2, v3
  s_waitcnt lgkmcnt(0)
  v_readfirstlane_b32 s54, v2
  s_barrier
  s_mov_b32 s53, s57
  s_cmp_lt_u32 s54, 32
  s_cbranch_scc1 tick_ok_3
  s_cmp_lg_u32 s52, 0
  s_cbranch_scc1 noover_4
  v_mov_b32 v3, 132
  v_mov_b32 v2, 1
  s_mov_b64 exec, 1
  buffer_atomic_add v2, v3, s[44:47], 0 offen sc1
  s_mov_b64 exec, -1
noover_4:
  s_branch L_irregular
tick_ok_3:
L_dispatch_r:
  s_cmp_lg_u32 s52, 0
  s_cbranch_scc1 arre_5
  v_mov_b32 v21, 128
  v_mov_b32 v20, 1
  s_mov_b64 exec, 1
  buffer_atomic_add v20, v21, s[44:47], 0 offen sc1
  s_mov_b64 exec, -1
arre_5:
  s_cmp_lt_u32 s53, 4
  s_cbranch_scc0 L_bulk_r
  s_lshl_b32 s99, s53, 3
  s_lshr_b32 s58, s54, 2
  s_add_u32 s99, s99, s58
  s_and_b32 s3, s54, 3
  v_mov_b32 v30, v0
  v_mul_u32_u24 v31, 10923, v30
  v_lshrrev_b32 v31, 16, v31
  v_mul_u32_u24 v32, 6, v31
  v_sub_u32 v30, v30, v32
  v_mul_u32_u24 v31, 12288, v31
  v_lshlrev_b32 v30, 4, v30
  v_add_u32 v2, v30, v31
  v_add_u32 v30, 256, v0
  v_mul_u32_u24 v31, 10923, v30
  v_lshrrev_b32 v31, 16, v31
  v_mul_u32_u24 v32, 6, v31
  v_sub_u32 v30, v30, v32
  v_mul_u32_u24 v31, 12288, v31
  v_lshlrev_b32 v30, 4, v30
  v_add_u32 v3, v30, v31
  v_add_u32 v30, 512, v0
  v_mul_u32_u24 v31, 10923, v30
  v_lshrrev_b32 v31, 16, v31
  v_mul_u32_u24 v32, 6, v31
  v_sub_u32 v30, v30, v32
  v_mul_u32_u24 v31, 12288, v31
  v_lshlrev_b32 v30, 4, v30
  v_add_u32 v4, v30, v31
  v_add_u32 v30, 768, v0
  v_mul_u32_u24 v31, 10923, v30
  v_lshrrev_b32 v31, 16, v31
  v_mul_u32_u24 v32, 6, v31
  v_sub_u32 v30, v30, v32
  v_mul_u32_u24 v31, 12288, v31
  v_lshlrev_b32 v30, 4, v30
  v_add_u32 v5, v30, v31
  v_add_u32 v30, 1024, v0
  v_mul_u32_u24 v31, 10923, v30
  v_lshrrev_b32 v31, 16, v31
  v_mul_u32_u24 v32, 6, v31
  v_sub_u32 v30, v30, v32
  v_mul_u32_u24 v31, 12288, v31
  v_lshlrev_b32 v30, 4, v30
  v_add_u32 v6, v30, v31
  v_add_u32 v30, 1280, v0
  v_mul_u32_u24 v31, 10923, v30
  v_lshrrev_b32 v31, 16, v31
  v_mul_u32_u24 v32, 6, v31
  v_sub_u32 v30, v30, v32
  v_mul_u32_u24 v31, 12288, v31
  v_lshlrev_b32 v30, 4, v30
  v_add_u32 v7, v30, v31
  v_add_u32 v30, 1536, v0
  v_mul_u32_u24 v31, 10923, v30
  v_lshrrev_b32 v31, 16, v31
  v_mul_u32_u24 v32, 6, v31
  v_sub_u32 v30, v30, v32
  v_mul_u32_u24 v31, 12288, v31
  v_lshlrev_b32 v30, 4, v30
  v_add_u32 v8, v30, v31
  v_add_u32 v30, 1792, v0
  v_mul_u32_u24 v31, 10923, v30
  v_lshrrev_b32 v31, 16, v31
  v_mul_u32_u24 v32, 6, v31
  v_sub_u32 v30, v30, v32
  v_mul_u32_u24 v31, 12288, v31
  v_lshlrev_b32 v30, 4, v30
  v_add_u32 v9, v30, v31
  v_add_u32 v30, 2048, v0
  v_mul_u32_u24 v31, 10923, v30
  v_lshrrev_b32 v31, 16, v31
  v_mul_u32_u24 v32, 6, v31
  v_sub_u32 v30, v30, v32
  v_mul_u32_u24 v31, 12288, v31
  v_lshlrev_b32 v30, 4, v30
  v_add_u32 v10, v30, v31
  v_add_u32 v30, 2304, v0
  v_mul_u32_u24 v31, 10923, v30
  v_lshrrev_b32 v31, 16, v31
  v_mul_u32_u24 v32, 6, v31
  v_sub_u32 v30, v30, v32
  v_mul_u32_u24 v31, 12288, v31
  v_lshlrev_b32 v30, 4, v30
  v_add_u32 v11, v30, v31
  v_add_u32 v30, 2560, v0
  v_mul_u32_u24 v31, 10923, v30
  v_lshrrev_b32 v31, 16, v31
  v_mul_u32_u24 v32, 6, v31
  v_sub_u32 v30, v30, v32
  v_mul_u32_u24 v31, 12288, v31
  v_lshlrev_b32 v30, 4, v30
  v_add_u32 v12, v30, v31
  v_add_u32 v30, 2816, v0
  v_mul_u32_u24 v31, 10923, v30
  v_lshrrev_b32 v31, 16, v31
  v_mul_u32_u24 v32, 6, v31
  v_sub_u32 v30, v30, v32
  v_mul_u32_u24 v31, 12288, v31
  v_lshlrev_b32 v30, 4, v30
  v_add_u32 v13, v30, v31
  v_add_u32 v30, 3072, v0
  v_mul_u32_u24 v31, 10923, v30
  v_lshrrev_b32 v31, 16, v31
  v_mul_u32_u24 v32, 6, v31
  v_sub_u32 v30, v30, v32
  v_mul_u32_u24 v31, 12288, v31
  v_lshlrev_b32 v30, 4, v30
  v_add_u32 v14, v30, v31
  v_add_u32 v30, 3328, v0
  v_mul_u32_u24 v31, 10923, v30
  v_lshrrev_b32 v31, 16, v31
  v_mul_u32_u24 v32, 6, v31
  v_sub_u32 v30, v30, v32
  v_mul_u32_u24 v31, 12288, v31
  v_lshlrev_b32 v30, 4, v30
  v_add_u32 v15, v30, v31
  v_add_u32 v30, 3584, v0
  v_mul_u32_u24 v31, 10923, v30
  v_lshrrev_b32 v31, 16, v31
  v_mul_u32_u24 v32, 6, v31
  v_sub_u32 v30, v30, v32
  v_mul_u32_u24 v31, 12288, v31
  v_lshlrev_b32 v30, 4, v30
  v_add_u32 v16, v30, v31
  s_mul_i32 s2, s99, 384
  s_mul_i32 s58, s3, 96
  s_add_u32 s2, s2, s58
  s_lshl_b32 s60, s52, 10
  s_add_u32 s60, s60, 0x0
  s_add_u32 m0, s60, 0
  s_nop 0
  buffer_load_dwordx4 v2, s[12:15], s2 offen lds
  s_add_u32 m0, s60, 4096
  s_nop 0
  buffer_load_dwordx4 v3, s[12:15], s2 offen lds
  s_add_u32 m0, s60, 8192
  s_nop 0
  buffer_load_dwordx4 v4, s[12:15], s2 offen lds
  s_add_u32 m0, s60, 12288
  s_nop 0
  buffer_load_dwordx4 v5, s[12:15], s2 offen lds
  s_add_u32 m0, s60, 16384
  s_nop 0
  buffer_load_dwordx4 v6, s[12:15], s2 offen lds
  s_add_u32 m0, s60, 20480
  s_nop 0
  buffer_load_dwordx4 v7, s[12:15], s2 offen lds
  s_add_u32 m0, s60, 24576
  s_nop 0
  buffer_load_dwordx4 v8, s[12:15], s2 offen lds
  s_add_u32 m0, s60, 28672
  s_nop 0
  buffer_load_dwordx4 v9, s[12:15], s2 offen lds
  s_add_u32 m0, s60, 32768
  s_nop 0
  buffer_load_dwordx4 v10, s[12:15], s2 offen lds
  s_add_u32 m0, s60, 36864
  s_nop 0
  buffer_load_dwordx4 v11, s[12:15], s2 offen lds
  s_add_u32 m0, s60, 40960
  s_nop 0
  buffer_load_dwordx4 v12, s[12:15], s2 offen lds
  s_add_u32 m0, s60, 45056
  s_nop 0
  buffer_load_dwordx4 v13, s[12:15], s2 offen lds
  s_add_u32 m0, s60, 49152
  s_nop 0
  buffer_load_dwordx4 v14, s[12:15], s2 offen lds
  s_add_u32 m0, s60, 53248
  s_nop 0
  buffer_load_dwordx4 v15, s[12:15], s2 offen lds
  s_add_u32 m0, s60, 57344
  s_nop 0
  buffer_load_dwordx4 v16, s[12:15], s2 offen lds
  s_lshl_b32 s60, s52, 10
  s_add_u32 s60, s60, 0xf000
  s_add_u32 m0, s60, 0
  s_nop 0
  buffer_load_dwordx4 v2, s[16:19], s2 offen lds
  s_add_u32 m0, s60, 4096
  s_nop 0
  buffer_load_dwordx4 v3, s[16:19], s2 offen lds
  s_add_u32 m0, s60, 8192
  s_nop 0
  buffer_load_dwordx4 v4, s[16:19], s2 offen lds
  s_add_u32 m0, s60, 12288
  s_nop 0
  buffer_load_dwordx4 v5, s[16:19], s2 offen lds
  s_add_u32 m0, s60, 16384
  s_nop 0
  buffer_load_dwordx4 v6, s[16:19], s2 offen lds
  s_add_u32 m0, s60, 20480
  s_nop 0
  buffer_load_dwordx4 v7, s[16:19], s2 offen lds
  s_add_u32 m0, s60, 24576
  s_nop 0
  buffer_load_dwordx4 v8, s[16:19], s2 offen lds
  s_add_u32 m0, s60, 28672
  s_nop 0
  buffer_load_dwordx4 v9, s[16:19], s2 offen lds
  s_add_u32 m0, s60, 32768
  s_nop 0
  buffer_load_dwordx4 v10, s[16:19], s2 offen lds
  s_add_u32 m0, s60, 36864
  s_nop 0
  buffer_load_dwordx4 v11, s[16:19], s2 offen lds
  s_add_u32 m0, s60, 40960
  s_nop 0
  buffer_load_dwordx4 v12, s[16:19], s2 offen lds
  s_add_u32 m0, s60, 45056
  s_nop 0
  buffer_load_dwordx4 v13, s[16:19], s2 offen lds
  s_add_u32 m0, s60, 49152
  s_nop 0
  buffer_load_dwordx4 v14, s[16:19], s2 offen lds
  s_add_u32 m0, s60, 53248
  s_nop 0
  buffer_load_dwordx4 v15, s[16:19], s2 offen lds
  s_add_u32 m0, s60, 57344
  s_nop 0
  buffer_load_dwordx4 v16, s[16:19], s2 offen lds
  v_lshlrev_b32 v34, 1, v0
  s_mov_b32 s58, 0
  buffer_load_ushort v48, v34, s[8:11], s58 offen
  s_mov_b32 s58, 1280
  buffer_load_ushort v49, v34, s[8:11], s58 offen
  s_mov_b32 s58, 2560
  buffer_load_ushort v50, v34, s[8:11], s58 offen
  s_mov_b32 s58, 3840
  buffer_load_ushort v51, v34, s[8:11], s58 offen
  s_mov_b32 s58, 5120
  buffer_load_ushort v52, v34, s[8:11], s58 offen
  s_mov_b32 s58, 6400
  buffer_load_ushort v53, v34, s[8:11], s58 offen
  s_mov_b32 s58, 7680
  buffer_load_ushort v54, v34, s[8:11], s58 offen
  s_mov_b32 s58, 8960
  buffer_load_ushort v55, v34, s[8:11], s58 offen
m0_6:
  s_mov_b32 s58, 512
  buffer_load_ushort v56, v34, s[8:11], s58 offen
  s_mov_b32 s58, 1792
  buffer_load_ushort v57, v34, s[8:11], s58 offen
  s_mov_b32 s58, 3072
  buffer_load_ushort v58, v34, s[8:11], s58 offen
  s_mov_b32 s58, 4352
  buffer_load_ushort v59, v34, s[8:11], s58 offen
  s_mov_b32 s58, 5632
  buffer_load_ushort v60, v34, s[8:11], s58 offen
  s_mov_b32 s58, 6912
  buffer_load_ushort v61, v34, s[8:11], s58 offen
  s_mov_b32 s58, 8192
  buffer_load_ushort v62, v34, s[8:11], s58 offen
  s_mov_b32 s58, 9472
  buffer_load_ushort v63, v34, s[8:11], s58 offen
m0_7:
  s_cmp_ge_u32 s52, 2
  s_cbranch_scc1 m0_8
  s_mov_b32 s58, 1024
  buffer_load_ushort v64, v34, s[8:11], s58 offen
  s_mov_b32 s58, 2304
  buffer_load_ushort v65, v34, s[8:11], s58 offen
  s_mov_b32 s58, 3584
  buffer_load_ushort v66, v34, s[8:11], s58 offen
  s_mov_b32 s58, 4864
  buffer_load_ushort v67, v34, s[8:11], s58 offen
  s_mov_b32 s58, 6144
  buffer_load_ushort v68, v34, s[8:11], s58 offen
  s_mov_b32 s58, 7424
  buffer_load_ushort v69, v34, s[8:11], s58 offen
  s_mov_b32 s58, 8704
  buffer_load_ushort v70, v34, s[8:11], s58 offen
  s_mov_b32 s58, 9984
  buffer_load_ushort v71, v34, s[8:11], s58 offen
m0_8:
  v_and_b32 v31, 63, v0
  v_lshrrev_b32 v32, 2, v31
  v_and_b32 v33, 3, v31
  v_lshlrev_b32 v33, 3, v33
  v_mul_u32_u24 v17, 96, v32
  v_add_u32 v17, v17, v33
  v_mul_u32_u24 v18, 320, v32
  v_add_u32 v18, v18, v33
  s_mul_i32 s58, s52, 96
  s_add_u32 s58, s58, 61440
  v_add_u32 v18, s58, v18
  s_lshl_b32 s58, s52, 5
  v_add_u32 v19, s58, v17
  v_add_u32 v20, 61440, v19
  s_waitcnt vmcnt(31)
  s_barrier
  s_cmp_eq_u32 s52, 3
  s_cbranch_scc1 w3a_9
  ds_read_b64_tr_b16 a[0:1], v19 offset:0
  ds_read_b64_tr_b16 a[2:3], v19 offset:1536
  ds_read_b64_tr_b16 a[4:5], v19 offset:3072
  ds_read_b64_tr_b16 a[6:7], v19 offset:4608
  ds_read_b64_tr_b16 a[8:9], v19 offset:6144
  ds_read_b64_tr_b16 a[10:11], v19 offset:7680
  ds_read_b64_tr_b16 a[12:13], v19 offset:9216
  ds_read_b64_tr_b16 a[14:15], v19 offset:10752
  s_waitcnt lgkmcnt(6)
  ds_read_b64_tr_b16 a[16:17], v19 offset:12288
  ds_read_b64_tr_b16 a[18:19], v19 offset:13824
  ds_read_b64_tr_b16 a[20:21], v19 offset:15360
  ds_read_b64_tr_b16 a[22:23], v19 offset:16896
  ds_read_b64_tr_b16 a[24:25], v19 offset:18432
  ds_read_b64_tr_b16 a[26:27], v19 offset:19968
  ds_read_b64_tr_b16 a[28:29], v19 offset:21504
  ds_read_b64_tr_b16 a[30:31], v19 offset:23040
  s_waitcnt lgkmcnt(6)
  ds_read_b64_tr_b16 a[32:33], v19 offset:24576
  ds_read_b64_tr_b16 a[34:35], v19 offset:26112
  ds_read_b64_tr_b16 a[36:37], v19 offset:27648
  ds_read_b64_tr_b16 a[38:39], v19 offset:29184
  ds_read_b64_tr_b16 a[40:41], v19 offset:30720
  ds_read_b64_tr_b16 a[42:43], v19 offset:32256
  ds_read_b64_tr_b16 a[44:45], v19 offset:33792
  ds_read_b64_tr_b16 a[46:47], v19 offset:35328
  s_waitcnt lgkmcnt(6)
  ds_read_b64_tr_b16 a[48:49], v19 offset:36864
  ds_read_b64_tr_b16 a[50:51], v19 offset:38400
  ds_read_b64_tr_b16 a[52:53], v19 offset:39936
  ds_read_b64_tr_b16 a[54:55], v19 offset:41472
  ds_read_b64_tr_b16 a[56:57], v19 offset:43008
  ds_read_b64_tr_b16 a[58:59], v19 offset:44544
  ds_read_b64_tr_b16 a[60:61], v19 offset:46080
  ds_read_b64_tr_b16 a[62:63], v19 offset:47616
  s_waitcnt lgkmcnt(6)
  ds_read_b64_tr_b16 a[64:65], v19 offset:49152
  ds_read_b64_tr_b16 a[66:67], v19 offset:50688
  ds_read_b64_tr_b16 a[68:69], v19 offset:52224
  ds_read_b64_tr_b16 a[70:71], v19 offset:53760
  ds_read_b64_tr_b16 a[72:73], v19 offset:55296
  ds_read_b64_tr_b16 a[74:75], v19 offset:56832
  ds_read_b64_tr_b16 a[76:77], v19 offset:58368
  ds_read_b64_tr_b16 a[78:79], v19 offset:59904
  s_waitcnt lgkmcnt(6)
  s_waitcnt lgkmcnt(0)
w3a_9:
  s_barrier
  s_xor_b32 s58, s3, 1
  s_mul_i32 s58, s58, 96
  s_mul_i32 s2, s99, 384
  s_add_u32 s2, s2, s58
  s_lshl_b32 s60, s52, 10
  s_add_u32 s60, s60, 0x0
  s_add_u32 m0, s60, 0
  s_nop 0
  buffer_load_dwordx4 v2, s[20:23], s2 offen lds
  s_add_u32 m0, s60, 4096
  s_nop 0
  buffer_load_dwordx4 v3, s[20:23], s2 offen lds
  s_add_u32 m0, s60, 8192
  s_nop 0
  buffer_load_dwordx4 v4, s[20:23], s2 offen lds
  s_add_u32 m0, s60, 12288
  s_nop 0
  buffer_load_dwordx4 v5, s[20:23], s2 offen lds
  s_add_u32 m0, s60, 16384
  s_nop 0
  buffer_load_dwordx4 v6, s[20:23], s2 offen lds
  s_add_u32 m0, s60, 20480
  s_nop 0
  buffer_load_dwordx4 v7, s[20:23], s2 offen lds
  s_add_u32 m0, s60, 24576
  s_nop 0
  buffer_load_dwordx4 v8, s[20:23], s2 offen lds
  s_add_u32 m0, s60, 28672
  s_nop 0
  buffer_load_dwordx4 v9, s[20:23], s2 offen lds
  s_add_u32 m0, s60, 32768
  s_nop 0
  buffer_load_dwordx4 v10, s[20:23], s2 offen lds
  s_add_u32 m0, s60, 36864
  s_nop 0
  buffer_load_dwordx4 v11, s[20:23], s2 offen lds
  s_add_u32 m0, s60, 40960
  s_nop 0
  buffer_load_dwordx4 v12, s[20:23], s2 offen lds
  s_add_u32 m0, s60, 45056
  s_nop 0
  buffer_load_dwordx4 v13, s[20:23], s2 offen lds
  s_add_u32 m0, s60, 49152
  s_nop 0
  buffer_load_dwordx4 v14, s[20:23], s2 offen lds
  s_add_u32 m0, s60, 53248
  s_nop 0
  buffer_load_dwordx4 v15, s[20:23], s2 offen lds
  s_add_u32 m0, s60, 57344
  s_nop 0
  buffer_load_dwordx4 v16, s[20:23], s2 offen lds
  s_waitcnt vmcnt(15)
  s_barrier
  s_cmp_eq_u32 s52, 3
  s_cbranch_scc1 w3b_10
  ds_read_b64_tr_b16 a[80:81], v20 offset:0
  ds_read_b64_tr_b16 a[82:83], v20 offset:1536
  ds_read_b64_tr_b16 a[84:85], v20 offset:3072
  ds_read_b64_tr_b16 a[86:87], v20 offset:4608
  ds_read_b64_tr_b16 a[88:89], v20 offset:6144
  ds_read_b64_tr_b16 a[90:91], v20 offset:7680
  ds_read_b64_tr_b16 a[92:93], v20 offset:9216
  ds_read_b64_tr_b16 a[94:95], v20 offset:10752
  s_waitcnt lgkmcnt(6)
  ds_read_b64_tr_b16 a[96:97], v20 offset:12288
  ds_read_b64_tr_b16 a[98:99], v20 offset:13824
  ds_read_b64_tr_b16 a[100:101], v20 offset:15360
  ds_read_b64_tr_b16 a[102:103], v20 offset:16896
  ds_read_b64_tr_b16 a[104:105], v20 offset:18432
  ds_read_b64_tr_b16 a[106:107], v20 offset:19968
  ds_read_b64_tr_b16 a[108:109], v20 offset:21504
  ds_read_b64_tr_b16 a[110:111], v20 offset:23040
  s_waitcnt lgkmcnt(6)
  ds_read_b64_tr_b16 a[112:113], v20 offset:24576
  ds_read_b64_tr_b16 a[114:115], v20 offset:26112
  ds_read_b64_tr_b16 a[116:117], v20 offset:27648
  ds_read_b64_tr_b16 a[118:119], v20 offset:29184
  ds_read_b64_tr_b16 a[120:121], v20 offset:30720
  ds_read_b64_tr_b16 a[122:123], v20 offset:32256
  ds_read_b64_tr_b16 a[124:125], v20 offset:33792
  ds_read_b64_tr_b16 a[126:127], v20 offset:35328
  s_waitcnt lgkmcnt(6)
  ds_read_b64_tr_b16 a[128:129], v20 offset:36864
  ds_read_b64_tr_b16 a[130:131], v20 offset:38400
  ds_read_b64_tr_b16 a[132:133], v20 offset:39936
  ds_read_b64_tr_b16 a[134:135], v20 offset:41472
  ds_read_b64_tr_b16 a[136:137], v20 offset:43008
  ds_read_b64_tr_b16 a[138:139], v20 offset:44544
  ds_read_b64_tr_b16 a[140:141], v20 offset:46080
  ds_read_b64_tr_b16 a[142:143], v20 offset:47616
  s_waitcnt lgkmcnt(6)
  ds_read_b64_tr_b16 a[144:145], v20 offset:49152
  ds_read_b64_tr_b16 a[146:147], v20 offset:50688
  ds_read_b64_tr_b16 a[148:149], v20 offset:52224
  ds_read_b64_tr_b16 a[150:151], v20 offset:53760
  ds_read_b64_tr_b16 a[152:153], v20 offset:55296
  ds_read_b64_tr_b16 a[154:155], v20 offset:56832
  ds_read_b64_tr_b16 a[156:157], v20 offset:58368
  ds_read_b64_tr_b16 a[158:159], v20 offset:59904
  s_waitcnt lgkmcnt(6)
  s_waitcnt lgkmcnt(0)
w3b_10:
  s_barrier
  v_mov_b32 v30, v0
  v_mul_u32_u24 v31, 3277, v30
  v_lshrrev_b32 v31, 16, v31
  v_mul_u32_u24 v32, 20, v31
  v_sub_u32 v30, v30, v32
  v_mul_u32_u24 v31, 1280, v31
  v_lshlrev_b32 v30, 4, v30
  v_add_u32 v2, v30, v31
  v_add_u32 v30, 256, v0
  v_mul_u32_u24 v31, 3277, v30
  v_lshrrev_b32 v31, 16, v31
  v_mul_u32_u24 v32, 20, v31
  v_sub_u32 v30, v30, v32
  v_mul_u32_u24 v31, 1280, v31
  v_lshlrev_b32 v30, 4, v30
  v_add_u32 v3, v30, v31
  v_add_u32 v30, 512, v0
  v_mul_u32_u24 v31, 3277, v30
  v_lshrrev_b32 v31, 16, v31
  v_mul_u32_u24 v32, 20, v31
  v_sub_u32 v30, v30, v32
  v_mul_u32_u24 v31, 1280, v31
  v_lshlrev_b32 v30, 4, v30
  v_add_u32 v4, v30, v31
  v_add_u32 v30, 768, v0
  v_mul_u32_u24 v31, 3277, v30
  v_lshrrev_b32 v31, 16, v31
  v_mul_u32_u24 v32, 20, v31
  v_sub_u32 v30, v30, v32
  v_mul_u32_u24 v31, 1280, v31
  v_lshlrev_b32 v30, 4, v30
  v_add_u32 v5, v30, v31
  v_add_u32 v30, 1024, v0
  v_mul_u32_u24 v31, 3277, v30
  v_lshrrev_b32 v31, 16, v31
  v_mul_u32_u24 v32, 20, v31
  v_sub_u32 v30, v30, v32
  v_mul_u32_u24 v31, 1280, v31
  v_lshlrev_b32 v30, 4, v30
  v_add_u32 v6, v30, v31
  v_add_u32 v30, 1280, v0
  v_mul_u32_u24 v31, 3277, v30
  v_lshrrev_b32 v31, 16, v31
  v_mul_u32_u24 v32, 20, v31
  v_sub_u32 v30, v30, v32
  v_mul_u32_u24 v31, 1280, v31
  v_lshlrev_b32 v30, 4, v30
  v_add_u32 v7, v30, v31
  v_add_u32 v30, 1536, v0
  v_mul_u32_u24 v31, 3277, v30
  v_lshrrev_b32 v31, 16, v31
  v_mul_u32_u24 v32, 20, v31
  v_sub_u32 v30, v30, v32
  v_mul_u32_u24 v31, 1280, v31
  v_lshlrev_b32 v30, 4, v30
  v_add_u32 v8, v30, v31
  v_add_u32 v30, 1792, v0
  v_mul_u32_u24 v31, 3277, v30
  v_lshrrev_b32 v31, 16, v31
  v_mul_u32_u24 v32, 20, v31
  v_sub_u32 v30, v30, v32
  v_mul_u32_u24 v31, 1280, v31
  v_lshlrev_b32 v30, 4, v30
  v_add_u32 v9, v30, v31
  v_add_u32 v30, 2048, v0
  v_mul_u32_u24 v31, 3277, v30
  v_lshrrev_b32 v31, 16, v31
  v_mul_u32_u24 v32, 20, v31
  v_sub_u32 v30, v30, v32
  v_mul_u32_u24 v31, 1280, v31
  v_lshlrev_b32 v30, 4, v30
  v_add_u32 v10, v30, v31
  v_add_u32 v30, 2304, v0
  v_mul_u32_u24 v31, 3277, v30
  v_lshrrev_b32 v31, 16, v31
  v_mul_u32_u24 v32, 20, v31
  v_sub_u32 v30, v30, v32
  v_mul_u32_u24 v31, 1280, v31
  v_lshlrev_b32 v30, 4, v30
  v_add_u32 v11, v30, v31
  v_add_u32 v30, 2560, v0
  v_mul_u32_u24 v31, 3277, v30
  v_lshrrev_b32 v31, 16, v31
  v_mul_u32_u24 v32, 20, v31
  v_sub_u32 v30, v30, v32
  v_mul_u32_u24 v31, 1280, v31
  v_lshlrev_b32 v30, 4, v30
  v_add_u32 v12, v30, v31
  v_add_u32 v30, 2816, v0
  v_mul_u32_u24 v31, 3277, v30
  v_lshrrev_b32 v31, 16, v31
  v_mul_u32_u24 v32, 20, v31
  v_sub_u32 v30, v30, v32
  v_mul_u32_u24 v31, 1280, v31
  v_lshlrev_b32 v30, 4, v30
  v_add_u32 v13, v30, v31
  v_add_u32 v30, 3072, v0
  v_mul_u32_u24 v31, 3277, v30
  v_lshrrev_b32 v31, 16, v31
  v_mul_u32_u24 v32, 20, v31
  v_sub_u32 v30, v30, v32
  v_mul_u32_u24 v31, 1280, v31
  v_lshlrev_b32 v30, 4, v30
  v_add_u32 v14, v30, v31
  v_add_u32 v30, 3328, v0
  v_mul_u32_u24 v31, 3277, v30
  v_lshrrev_b32 v31, 16, v31
  v_mul_u32_u24 v32, 20, v31
  v_sub_u32 v30, v30, v32
  v_mul_u32_u24 v31, 1280, v31
  v_lshlrev_b32 v30, 4, v30
  v_add_u32 v15, v30, v31
  v_add_u32 v30, 3584, v0
  v_mul_u32_u24 v31, 3277, v30
  v_lshrrev_b32 v31, 16, v31
  v_mul_u32_u24 v32, 20, v31
  v_sub_u32 v30, v30, v32
  v_mul_u32_u24 v31, 1280, v31
  v_lshlrev_b32 v30, 4, v30
  v_add_u32 v16, v30, v31
  s_mul_i32 s2, s99, 245760
  s_mul_i32 s58, s3, 320
  s_add_u32 s2, s2, s58
  s_lshl_b32 s60, s52, 10
  s_add_u32 s60, s60, 0xf000
  s_add_u32 m0, s60, 0
  s_nop 0
  buffer_load_dwordx4 v2, s[24:27], s2 offen lds
  s_add_u32 m0, s60, 4096
  s_nop 0
  buffer_load_dwordx4 v3, s[24:27], s2 offen lds
  s_add_u32 m0, s60, 8192
  s_nop 0
  buffer_load_dwordx4 v4, s[24:27], s2 offen lds
  s_add_u32 m0, s60, 12288
  s_nop 0
  buffer_load_dwordx4 v5, s[24:27], s2 offen lds
  s_add_u32 m0, s60, 16384
  s_nop 0
  buffer_load_dwordx4 v6, s[24:27], s2 offen lds
  s_add_u32 m0, s60, 20480
  s_nop 0
  buffer_load_dwordx4 v7, s[24:27], s2 offen lds
  s_add_u32 m0, s60, 24576
  s_nop 0
  buffer_load_dwordx4 v8, s[24:27], s2 offen lds
  s_add_u32 m0, s60, 28672
  s_nop 0
  buffer_load_dwordx4 v9, s[24:27], s2 offen lds
  s_add_u32 m0, s60, 32768
  s_nop 0
  buffer_load_dwordx4 v10, s[24:27], s2 offen lds
  s_add_u32 m0, s60, 36864
  s_nop 0
  buffer_load_dwordx4 v11, s[24:27], s2 offen lds
  s_add_u32 m0, s60, 40960
  s_nop 0
  buffer_load_dwordx4 v12, s[24:27], s2 offen lds
  s_add_u32 m0, s60, 45056
  s_nop 0
  buffer_load_dwordx4 v13, s[24:27], s2 offen lds
  s_add_u32 m0, s60, 49152
  s_nop 0
  buffer_load_dwordx4 v14, s[24:27], s2 offen lds
  s_add_u32 m0, s60, 53248
  s_nop 0
  buffer_load_dwordx4 v15, s[24:27], s2 offen lds
  s_add_u32 m0, s60, 57344
  s_nop 0
  buffer_load_dwordx4 v16, s[24:27], s2 offen lds
  s_waitcnt vmcnt(15)
  s_barrier
  s_cmp_lg_u32 s52, 3
  s_cbranch_scc1 w3c_11
  ds_read_b64_tr_b16 a[0:1], v17 offset:0
  ds_read_b64_tr_b16 a[2:3], v17 offset:1536
  ds_read_b64_tr_b16 a[4:5], v17 offset:3072
  ds_read_b64_tr_b16 a[6:7], v17 offset:4608
  ds_read_b64_tr_b16 a[8:9], v17 offset:6144
  ds_read_b64_tr_b16 a[10:11], v17 offset:7680
  ds_read_b64_tr_b16 a[12:13], v17 offset:9216
  ds_read_b64_tr_b16 a[14:15], v17 offset:10752
  s_waitcnt lgkmcnt(6)
  ds_read_b64_tr_b16 a[16:17], v17 offset:12288
  ds_read_b64_tr_b16 a[18:19], v17 offset:13824
  ds_read_b64_tr_b16 a[20:21], v17 offset:15360
  ds_read_b64_tr_b16 a[22:23], v17 offset:16896
  ds_read_b64_tr_b16 a[24:25], v17 offset:18432
  ds_read_b64_tr_b16 a[26:27], v17 offset:19968
  ds_read_b64_tr_b16 a[28:29], v17 offset:21504
  ds_read_b64_tr_b16 a[30:31], v17 offset:23040
  s_waitcnt lgkmcnt(6)
  ds_read_b64_tr_b16 a[32:33], v17 offset:24576
  ds_read_b64_tr_b16 a[34:35], v17 offset:26112
  ds_read_b64_tr_b16 a[36:37], v17 offset:27648
  ds_read_b64_tr_b16 a[38:39], v17 offset:29184
  ds_read_b64_tr_b16 a[40:41], v17 offset:30720
  ds_read_b64_tr_b16 a[42:43], v17 offset:32256
  ds_read_b64_tr_b16 a[44:45], v17 offset:33792
  ds_read_b64_tr_b16 a[46:47], v17 offset:35328
  s_waitcnt lgkmcnt(6)
  ds_read_b64_tr_b16 a[48:49], v17 offset:36864
  ds_read_b64_tr_b16 a[50:51], v17 offset:38400
  ds_read_b64_tr_b16 a[52:53], v17 offset:39936
  ds_read_b64_tr_b16 a[54:55], v17 offset:41472
  ds_read_b64_tr_b16 a[56:57], v17 offset:43008
  ds_read_b64_tr_b16 a[58:59], v17 offset:44544
  ds_read_b64_tr_b16 a[60:61], v17 offset:46080
  ds_read_b64_tr_b16 a[62:63], v17 offset:47616
  s_waitcnt lgkmcnt(6)
  ds_read_b64_tr_b16 a[64:65], v17 offset:49152
  ds_read_b64_tr_b16 a[66:67], v17 offset:50688
  ds_read_b64_tr_b16 a[68:69], v17 offset:52224
  ds_read_b64_tr_b16 a[70:71], v17 offset:53760
  ds_read_b64_tr_b16 a[72:73], v17 offset:55296
  ds_read_b64_tr_b16 a[74:75], v17 offset:56832
  ds_read_b64_tr_b16 a[76:77], v17 offset:58368
  ds_read_b64_tr_b16 a[78:79], v17 offset:59904
  s_waitcnt lgkmcnt(6)
  ds_read_b64_tr_b16 a[80:81], v17 offset:32
  ds_read_b64_tr_b16 a[82:83], v17 offset:1568
  ds_read_b64_tr_b16 a[84:85], v17 offset:3104
  ds_read_b64_tr_b16 a[86:87], v17 offset:4640
  ds_read_b64_tr_b16 a[88:89], v17 offset:6176
  ds_read_b64_tr_b16 a[90:91], v17 offset:7712
  ds_read_b64_tr_b16 a[92:93], v17 offset:9248
  ds_read_b64_tr_b16 a[94:95], v17 offset:10784
  s_waitcnt lgkmcnt(6)
  ds_read_b64_tr_b16 a[96:97], v17 offset:12320
  ds_read_b64_tr_b16 a[98:99], v17 offset:13856
  ds_read_b64_tr_b16 a[100:101], v17 offset:15392
  ds_read_b64_tr_b16 a[102:103], v17 offset:16928
  ds_read_b64_tr_b16 a[104:105], v17 offset:18464
  ds_read_b64_tr_b16 a[106:107], v17 offset:20000
  ds_read_b64_tr_b16 a[108:109], v17 offset:21536
  ds_read_b64_tr_b16 a[110:111], v17 offset:23072
  s_waitcnt lgkmcnt(6)
  ds_read_b64_tr_b16 a[112:113], v17 offset:24608
  ds_read_b64_tr_b16 a[114:115], v17 offset:26144
  ds_read_b64_tr_b16 a[116:117], v17 offset:27680
  ds_read_b64_tr_b16 a[118:119], v17 offset:29216
  ds_read_b64_tr_b16 a[120:121], v17 offset:30752
  ds_read_b64_tr_b16 a[122:123], v17 offset:32288
  ds_read_b64_tr_b16 a[124:125], v17 offset:33824
  ds_read_b64_tr_b16 a[126:127], v17 offset:35360
  s_waitcnt lgkmcnt(6)
  ds_read_b64_tr_b16 a[128:129], v17 offset:36896
  ds_read_b64_tr_b16 a[130:131], v17 offset:38432
  ds_read_b64_tr_b16 a[132:133], v17 offset:39968
  ds_read_b64_tr_b16 a[134:135], v17 offset:41504
  ds_read_b64_tr_b16 a[136:137], v17 offset:43040
  ds_read_b64_tr_b16 a[138:139], v17 offset:44576
  ds_read_b64_tr_b16 a[140:141], v17 offset:46112
  ds_read_b64_tr_b16 a[142:143], v17 offset:47648
  s_waitcnt lgkmcnt(6)
  ds_read_b64_tr_b16 a[144:145], v17 offset:49184
  ds_read_b64_tr_b16 a[146:147], v17 offset:50720
  ds_read_b64_tr_b16 a[148:149], v17 offset:52256
  ds_read_b64_tr_b16 a[150:151], v17 offset:53792
  ds_read_b64_tr_b16 a[152:153], v17 offset:55328
  ds_read_b64_tr_b16 a[154:155], v17 offset:56864
  ds_read_b64_tr_b16 a[156:157], v17 offset:58400
  ds_read_b64_tr_b16 a[158:159], v17 offset:59936
  s_waitcnt lgkmcnt(6)
  ds_read_b64_tr_b16 a[160:161], v17 offset:64
  ds_read_b64_tr_b16 a[162:163], v17 offset:1600
  ds_read_b64_tr_b16 a[164:165], v17 offset:3136
  ds_read_b64_tr_b16 a[166:167], v17 offset:4672
  ds_read_b64_tr_b16 a[168:169], v17 offset:6208
  ds_read_b64_tr_b16 a[170:171], v17 offset:7744
  ds_read_b64_tr_b16 a[172:173], v17 offset:9280
  ds_read_b64_tr_b16 a[174:175], v17 offset:10816
  s_waitcnt lgkmcnt(6)
  ds_read_b64_tr_b16 a[176:177], v17 offset:12352
  ds_read_b64_tr_b16 a[178:179], v17 offset:13888
  ds_read_b64_tr_b16 a[180:181], v17 offset:15424
  ds_read_b64_tr_b16 a[182:183], v17 offset:16960
  ds_read_b64_tr_b16 a[184:185], v17 offset:18496
  ds_read_b64_tr_b16 a[186:187], v17 offset:20032
  ds_read_b64_tr_b16 a[188:189], v17 offset:21568
  ds_read_b64_tr_b16 a[190:191], v17 offset:23104
  s_waitcnt lgkmcnt(6)
  ds_read_b64_tr_b16 a[192:193], v17 offset:24640
  ds_read_b64_tr_b16 a[194:195], v17 offset:26176
  ds_read_b64_tr_b16 a[196:197], v17 offset:27712
  ds_read_b64_tr_b16 a[198:199], v17 offset:29248
  ds_read_b64_tr_b16 a[200:201], v17 offset:30784
  ds_read_b64_tr_b16 a[202:203], v17 offset:32320
  ds_read_b64_tr_b16 a[204:205], v17 offset:33856
  ds_read_b64_tr_b16 a[206:207], v17 offset:35392
  s_waitcnt lgkmcnt(6)
  ds_read_b64_tr_b16 a[208:209], v17 offset:36928
  ds_read_b64_tr_b16 a[210:211], v17 offset:38464
  ds_read_b64_tr_b16 a[212:213], v17 offset:40000
  ds_read_b64_tr_b16 a[214:215], v17 offset:41536
  ds_read_b64_tr_b16 a[216:217], v17 offset:43072
  ds_read_b64_tr_b16 a[218:219], v17 offset:44608
  ds_read_b64_tr_b16 a[220:221], v17 offset:46144
  ds_read_b64_tr_b16 a[222:223], v17 offset:47680
  s_waitcnt lgkmcnt(6)
  ds_read_b64_tr_b16 a[224:225], v17 offset:49216
  ds_read_b64_tr_b16 a[226:227], v17 offset:50752
  ds_read_b64_tr_b16 a[228:229], v17 offset:52288
  ds_read_b64_tr_b16 a[230:231], v17 offset:53824
  ds_read_b64_tr_b16 a[232:233], v17 offset:55360
  ds_read_b64_tr_b16 a[234:235], v17 offset:56896
  ds_read_b64_tr_b16 a[236:237], v17 offset:58432
  ds_read_b64_tr_b16 a[238:239], v17 offset:59968
  s_waitcnt lgkmcnt(6)
  s_waitcnt lgkmcnt(0)
w3c_11:
  s_waitcnt vmcnt(0)
  s_barrier
  s_cmp_eq_u32 s52, 3
  s_cbranch_scc1 w3d_12
  ds_read_b64_tr_b16 v[184:185], v18 offset:0
  ds_read_b64_tr_b16 v[186:187], v18 offset:5120
  ds_read_b64_tr_b16 v[188:189], v18 offset:10240
  ds_read_b64_tr_b16 v[190:191], v18 offset:15360
  ds_read_b64_tr_b16 v[192:193], v18 offset:20480
  ds_read_b64_tr_b16 v[194:195], v18 offset:25600
  ds_read_b64_tr_b16 v[196:197], v18 offset:30720
  ds_read_b64_tr_b16 v[198:199], v18 offset:35840
  s_waitcnt lgkmcnt(6)
  ds_read_b64_tr_b16 v[200:201], v18 offset:40960
  ds_read_b64_tr_b16 v[202:203], v18 offset:46080
  ds_read_b64_tr_b16 v[204:205], v18 offset:51200
  ds_read_b64_tr_b16 v[206:207], v18 offset:56320
  ds_read_b64_tr_b16 v[208:209], v18 offset:32
  ds_read_b64_tr_b16 v[210:211], v18 offset:5152
  ds_read_b64_tr_b16 v[212:213], v18 offset:10272
  ds_read_b64_tr_b16 v[214:215], v18 offset:15392
  s_waitcnt lgkmcnt(6)
  ds_read_b64_tr_b16 v[216:217], v18 offset:20512
  ds_read_b64_tr_b16 v[218:219], v18 offset:25632
  ds_read_b64_tr_b16 v[220:221], v18 offset:30752
  ds_read_b64_tr_b16 v[222:223], v18 offset:35872
  ds_read_b64_tr_b16 v[224:225], v18 offset:40992
  ds_read_b64_tr_b16 v[226:227], v18 offset:46112
  ds_read_b64_tr_b16 v[228:229], v18 offset:51232
  ds_read_b64_tr_b16 v[230:231], v18 offset:56352
  s_waitcnt lgkmcnt(6)
  ds_read_b64_tr_b16 v[232:233], v18 offset:64
  ds_read_b64_tr_b16 v[234:235], v18 offset:5184
  ds_read_b64_tr_b16 v[236:237], v18 offset:10304
  ds_read_b64_tr_b16 v[238:239], v18 offset:15424
  ds_read_b64_tr_b16 v[240:241], v18 offset:20544
  ds_read_b64_tr_b16 v[242:243], v18 offset:25664
  ds_read_b64_tr_b16 v[244:245], v18 offset:30784
  ds_read_b64_tr_b16 v[246:247], v18 offset:35904
  s_waitcnt lgkmcnt(6)
  ds_read_b64_tr_b16 v[248:249], v18 offset:41024
  ds_read_b64_tr_b16 v[250:251], v18 offset:46144
  ds_read_b64_tr_b16 v[252:253], v18 offset:51264
  ds_read_b64_tr_b16 v[254:255], v18 offset:56384
  s_waitcnt lgkmcnt(0)
  s_branch w3e_13
w3d_12:
  ds_read_b64_tr_b16 v[184:185], v18 offset:0
  ds_read_b64_tr_b16 v[186:187], v18 offset:5120
  ds_read_b64_tr_b16 v[188:189], v18 offset:10240
  ds_read_b64_tr_b16 v[190:191], v18 offset:15360
  ds_read_b64_tr_b16 v[192:193], v18 offset:20480
  ds_read_b64_tr_b16 v[194:195], v18 offset:25600
  ds_read_b64_tr_b16 v[196:197], v18 offset:30720
  ds_read_b64_tr_b16 v[198:199], v18 offset:35840
  s_waitcnt lgkmcnt(6)
  ds_read_b64_tr_b16 v[200:201], v18 offset:40960
  ds_read_b64_tr_b16 v[202:203], v18 offset:46080
  ds_read_b64_tr_b16 v[204:205], v18 offset:51200
  ds_read_b64_tr_b16 v[206:207], v18 offset:56320
  s_waitcnt lgkmcnt(0)
w3e_13:
  v_lshlrev_b32 v34, 4, v0
  v_add_u32 v34, 122880, v34
  v_lshl_or_b32 v72, v49, 16, v48
  v_lshl_or_b32 v73, v51, 16, v50
  v_lshl_or_b32 v74, v53, 16, v52
  v_lshl_or_b32 v75, v55, 16, v54
  ds_write_b128 v34, v[72:75] offset:0
  s_waitcnt lgkmcnt(0)
m1_14:
  v_lshl_or_b32 v72, v57, 16, v56
  v_lshl_or_b32 v73, v59, 16, v58
  v_lshl_or_b32 v74, v61, 16, v60
  v_lshl_or_b32 v75, v63, 16, v62
  ds_write_b128 v34, v[72:75] offset:4096
  s_waitcnt lgkmcnt(0)
m1_15:
  s_cmp_ge_u32 s52, 2
  s_cbranch_scc1 m1_16
  v_lshl_or_b32 v72, v65, 16, v64
  v_lshl_or_b32 v73, v67, 16, v66
  v_lshl_or_b32 v74, v69, 16, v68
  v_lshl_or_b32 v75, v71, 16, v70
  ds_write_b128 v34, v[72:75] offset:8192
  s_waitcnt lgkmcnt(0)
m1_16:
  v_and_b32 v1, 63, v0
  v_lshlrev_b32 v2, 4, v1
  v_lshlrev_b32 v8, 3, v1
  v_and_b32 v30, 31, v1
  v_lshlrev_b32 v11, 4, v30
  v_add_u32 v3, 2048, v11
  s_mul_i32 s58, s52, 2560
  s_add_u32 s58, s58, 122880
  v_add_u32 v4, s58, v2
  v_add_u32 v5, s58, v3
  v_lshrrev_b32 v30, 2, v1
  v_lshlrev_b32 v31, 4, v30
  v_and_b32 v32, 1, v1
  v_lshlrev_b32 v32, 3, v32
  v_add_u32 v31, v31, v32
  v_add_u32 v6, 122880, v31
  s_mul_i32 s58, s52, 3072
  s_add_u32 s58, s58, 3072
  v_add_u32 v7, s58, v2
  v_lshrrev_b32 v30, 4, v1
  v_and_b32 v30, 1, v30
  v_lshlrev_b32 v30, 3, v30
  v_and_b32 v31, 7, v1
  v_add_u32 v30, v30, v31
  v_lshlrev_b32 v30, 4, v30
  v_add_u32 v9, 1024, v30
  s_mul_i32 s58, s52, 3
  s_add_u32 s58, s58, 0
  s_lshr_b32 s59, s58, 1
  s_lshl_b32 s59, s59, 10
  s_and_b32 s58, s58, 1
  s_lshl_b32 s58, s58, 3
  s_add_u32 s58, s58, s59
  s_add_u32 s58, s58, 148480
  v_add_u32 v12, s58, v2
  s_mul_i32 s58, s52, 3
  s_add_u32 s58, s58, 1
  s_lshr_b32 s59, s58, 1
  s_lshl_b32 s59, s59, 10
  s_and_b32 s58, s58, 1
  s_lshl_b32 s58, s58, 3
  s_add_u32 s58, s58, s59
  s_add_u32 s58, s58, 148480
  v_add_u32 v13, s58, v2
  s_mul_i32 s58, s52, 3
  s_add_u32 s58, s58, 2
  s_lshr_b32 s59, s58, 1
  s_lshl_b32 s59, s59, 10
  s_and_b32 s58, s58, 1
  s_lshl_b32 s58, s58, 3
  s_add_u32 s58, s58, s59
  s_add_u32 s58, s58, 148480
  v_add_u32 v14, s58, v2
  v_add_u32 v23, 148480, v2
  v_add_u32 v20, 143616, v8
  v_add_u32 v21, 146688, v2
  v_add_u32 v22, 147712, v8
  s_mul_i32 s58, s3, 160
  s_mul_i32 s59, s52, 48
  s_add_u32 s58, s58, s59
  v_and_b32 v30, 31, v1
  v_add_u32 v30, s58, v30
  v_lshrrev_b32 v31, 3, v30
  v_lshlrev_b32 v31, 12, v31
  v_and_b32 v30, 7, v30
  v_lshlrev_b32 v30, 4, v30
  v_add_u32 v30, v30, v31
  s_lshl_b32 s58, s99, 7
  v_add_u32 v15, s58, v30
  s_mul_i32 s58, s3, 160
  s_mul_i32 s59, s52, 48
  s_add_u32 s58, s58, s59
  v_and_b32 v30, 15, v1
  v_add_u32 v30, 32, v30
  v_add_u32 v30, s58, v30
  v_lshrrev_b32 v31, 3, v30
  v_lshlrev_b32 v31, 12, v31
  v_and_b32 v30, 7, v30
  v_lshlrev_b32 v30, 4, v30
  v_add_u32 v30, v30, v31
  s_lshl_b32 s58, s99, 7
  v_add_u32 v16, s58, v30
  s_lshl_b32 s58, s52, 5
  s_add_u32 s58, s58, s54
  s_lshl_b32 s58, s58, 7
  v_add_u32 v17, s58, v2
  v_and_b32 v30, 15, v1
  v_mov_b32 v31, 0x3f80
  v_mov_b32 v32, 0
  v_cmp_eq_u32 vcc, 0, v30
  s_nop 1
  v_cndmask_b32 v178, v32, v31, vcc
  v_mov_b32 v31, 0x3f800000
  v_cmp_eq_u32 vcc, 1, v30
  s_nop 1
  v_cndmask_b32 v178, v178, v31, vcc
  v_mov_b32 v31, 0x3f80
  v_mov_b32 v32, 0
  v_cmp_eq_u32 vcc, 2, v30
  s_nop 1
  v_cndmask_b32 v179, v32, v31, vcc
  v_mov_b32 v31, 0x3f800000
  v_cmp_eq_u32 vcc, 3, v30
  s_nop 1
  v_cndmask_b32 v179, v179, v31, vcc
  v_mov_b32 v31, 0x3f80
  v_mov_b32 v32, 0
  v_cmp_eq_u32 vcc, 4, v30
  s_nop 1
  v_cndmask_b32 v180, v32, v31, vcc
  v_mov_b32 v31, 0x3f800000
  v_cmp_eq_u32 vcc, 5, v30
  s_nop 1
  v_cndmask_b32 v180, v180, v31, vcc
  v_mov_b32 v31, 0x3f80
  v_mov_b32 v32, 0
  v_cmp_eq_u32 vcc, 6, v30
  s_nop 1
  v_cndmask_b32 v181, v32, v31, vcc
  v_mov_b32 v31, 0x3f800000
  v_cmp_eq_u32 vcc, 7, v30
  s_nop 1
  v_cndmask_b32 v181, v181, v31, vcc
  s_mul_i32 s58, s3, 160
  v_add_u32 v30, s58, v1
  v_lshrrev_b32 v31, 3, v30
  v_lshlrev_b32 v31, 12, v31
  v_and_b32 v30, 7, v30
  v_lshlrev_b32 v30, 4, v30
  v_add_u32 v30, v30, v31
  s_lshl_b32 s58, s99, 7
  v_add_u32 v182, s58, v30
  v_add_u32 v183, 133120, v2
  s_lshl_b32 s58, s99, 2
  s_add_u32 s58, s58, s3
  s_lshl_b32 s58, s58, 7
  s_add_u32 s58, s58, 8192
  v_mov_b32 v18, s58
  s_lshl_b32 s58, s99, 8
  v_and_b32 v30, 1, v1
  v_lshlrev_b32 v30, 7, v30
  v_add_u32 v19, s58, v30
  v_mov_b32 v24, 0x3f803f80
  v_mov_b32 v25, 0x3f803f80
  v_mov_b32 v26, 0x3f803f80
  v_mov_b32 v27, 0x3f803f80
  v_cmp_gt_u32 vcc, 32, v1
  v_mov_b32 v30, -1
  v_mov_b32 v31, 0
  v_cndmask_b32 v28, v31, v30, vcc
  v_mov_b32 v10, v9
  s_mov_b32 s66, 0x1a000
  s_mul_i32 s58, s53, 10240
  s_add_u32 s66, s66, s58
  s_mul_i32 s58, s52, 2560
  s_add_u32 s66, s66, s58
  s_mov_b32 s73, 0x10000
  s_mul_i32 s58, s53, 10240
  s_add_u32 s73, s73, s58
  s_mov_b32 s67, 0x30000
  s_mul_i32 s58, s99, 5120
  s_add_u32 s67, s67, s58
  s_mul_i32 s58, s3, 1280
  s_add_u32 s67, s67, s58
  s_mov_b32 s68, 0x30000
  s_mul_i32 s58, s99, 5120
  s_add_u32 s68, s68, s58
  s_xor_b32 s59, s3, 1
  s_mov_b32 s69, 0x80000
  s_mul_i32 s58, s99, 6144
  s_add_u32 s69, s69, s58
  s_mul_i32 s58, s59, 1536
  s_add_u32 s69, s69, s58
  s_mov_b32 s70, 0x80000
  s_mul_i32 s58, s99, 6144
  s_add_u32 s70, s70, s58
  s_mul_i32 s58, s52, 1536
  s_add_u32 s70, s70, s58
  s_mov_b32 s71, 0xe0000
  s_mov_b32 s72, 0xe0000
  s_mul_i32 s58, s54, 4096
  s_add_u32 s72, s72, s58
  s_mul_i32 s58, s52, 131072
  s_add_u32 s72, s72, s58
  s_mov_b32 s74, 40960
  s_mov_b32 s75, 163840
  s_mov_b32 s76, 196608
  s_mov_b32 s77, 327680
  s_mov_b32 s78, 0x1a00000
  s_mul_i32 s58, s99, 12288
  s_add_u32 s78, s78, s58
  s_mul_i32 s58, s3, 3072
  s_add_u32 s78, s78, s58
  s_mov_b32 s79, 0x3200000
  s_mul_i32 s58, s99, 12288
  s_add_u32 s79, s79, s58
  s_mov_b32 s62, 0
  s_mov_b32 s63, 1
  s_mov_b32 s64, 0
  s_mov_b32 s65, 0
  s_mov_b32 s101, 0
  s_mov_b32 s56, 0
  v_mov_b32 v32, 128
iw_17:
  buffer_load_dwordx2 v[30:31], v32, s[44:47], 0 offen sc1
  s_waitcnt vmcnt(0)
  v_readfirstlane_b32 s58, v30
  v_readfirstlane_b32 s59, v31
  s_cmp_lg_u32 s59, 0
  s_cbranch_scc1 L_to_irregular
  s_cmpk_ge_u32 s58, 256
  s_cbranch_scc1 iwd_18
  s_cmp_lg_u32 s55, 0
  s_cbranch_scc1 iwd_18
  s_add_u32 s56, s56, 1
  s_cmp_lt_u32 s56, 0x20000
  s_cbranch_scc1 iw_17
  s_mov_b32 s55, 1
iwd_18:
  s_cmp_eq_u32 s52, 0
  s_cbranch_scc1 L_chw0_r
  s_cmp_eq_u32 s52, 3
  s_cbranch_scc1 L_chw3_r
  s_mul_i32 s100, s99, 6144
  s_mul_i32 s58, s3, 1536
  s_add_u32 s100, s100, s58
  s_add_u32 s100, s100, 0x200000
  s_lshl_b32 s58, s52, 9
  s_add_u32 s100, s100, s58
  s_barrier
  s_waitcnt vmcnt(0)
  s_mov_b32 s3, 0x3dd53b95
  s_branch L_ch1a_r
L_ch1_r:
  s_mov_b32 s56, 0
ga_2019:
  buffer_load_dwordx4 v[36:39], v2, s[48:51], s66 offen sc1
  buffer_load_dwordx4 v[40:43], v2, s[48:51], s66 offen offset:1024 sc1
  buffer_load_dwordx4 v[44:47], v3, s[48:51], s66 offen sc1
ga_2019w:
  s_waitcnt vmcnt(0)
  v_xor_b32 v30, s65, v36
  v_xor_b32 v31, s65, v40
  v_and_b32 v30, v30, v31
  v_xor_b32 v31, s65, v44
  v_and_b32 v30, v30, v31
  v_and_b32 v30, 1, v30
  v_cmp_eq_u32 vcc, 0, v30
  s_cbranch_vccnz gar_2020
  s_branch gad_2021
gar_2020:
  s_cmp_lg_u32 s55, 0
  s_cbranch_scc1 gad_2021
  s_add_u32 s56, s56, 1
  s_cmp_lt_u32 s56, 0x20000
  s_cbranch_scc1 ga_2019
  s_mov_b32 s55, 1
gad_2021:
  ds_write_b128 v4, v[36:39]
  ds_write_b128 v4, v[40:43] offset:1024
  ds_write_b128 v5, v[44:47]
L_ch1a_r:
  s_waitcnt lgkmcnt(0)
  s_barrier
  ds_read_b64_tr_b16 v[48:49], v6 offset:0
  ds_read_b64_tr_b16 v[50:51], v6 offset:256
  ds_read_b64_tr_b16 v[52:53], v6 offset:512
  ds_read_b64_tr_b16 v[54:55], v6 offset:768
  ds_read_b64_tr_b16 v[56:57], v6 offset:1024
  ds_read_b64_tr_b16 v[58:59], v6 offset:1280
  ds_read_b64_tr_b16 v[60:61], v6 offset:1536
  ds_read_b64_tr_b16 v[62:63], v6 offset:1792
  ds_read_b64_tr_b16 v[64:65], v6 offset:2048
  ds_read_b64_tr_b16 v[66:67], v6 offset:2304
  ds_read_b64_tr_b16 v[68:69], v6 offset:2560
  ds_read_b64_tr_b16 v[70:71], v6 offset:2816
  ds_read_b64_tr_b16 v[72:73], v6 offset:3072
  ds_read_b64_tr_b16 v[74:75], v6 offset:3328
  s_waitcnt lgkmcnt(12)
  v_mfma_f32_16x16x32_bf16 v[128:131], a[0:3], v[48:51], 0
  v_mfma_f32_16x16x32_bf16 v[132:135], a[80:83], v[48:51], 0
  ds_read_b64_tr_b16 v[76:77], v6 offset:3584
  ds_read_b64_tr_b16 v[78:79], v6 offset:3840
  s_waitcnt lgkmcnt(12)
  v_mfma_f32_16x16x32_bf16 v[128:131], a[4:7], v[52:55], v[128:131]
  v_mfma_f32_16x16x32_bf16 v[132:135], a[84:87], v[52:55], v[132:135]
  ds_read_b64_tr_b16 v[80:81], v6 offset:4096
  ds_read_b64_tr_b16 v[82:83], v6 offset:4352
  s_waitcnt lgkmcnt(12)
  v_mfma_f32_16x16x32_bf16 v[128:131], a[8:11], v[56:59], v[128:131]
  v_mfma_f32_16x16x32_bf16 v[132:135], a[88:91], v[56:59], v[132:135]
  ds_read_b64_tr_b16 v[84:85], v6 offset:4608
  ds_read_b64_tr_b16 v[86:87], v6 offset:4864
  s_waitcnt lgkmcnt(12)
  v_mfma_f32_16x16x32_bf16 v[128:131], a[12:15], v[60:63], v[128:131]
  v_mfma_f32_16x16x32_bf16 v[132:135], a[92:95], v[60:63], v[132:135]
  ds_read_b64_tr_b16 v[88:89], v6 offset:5120
  ds_read_b64_tr_b16 v[90:91], v6 offset:5376
  s_waitcnt lgkmcnt(12)
  v_mfma_f32_16x16x32_bf16 v[128:131], a[16:19], v[64:67], v[128:131]
  v_mfma_f32_16x16x32_bf16 v[132:135], a[96:99], v[64:67], v[132:135]
  ds_read_b64_tr_b16 v[92:93], v6 offset:5632
  ds_read_b64_tr_b16 v[94:95], v6 offset:5888
  s_waitcnt lgkmcnt(12)
  v_mfma_f32_16x16x32_bf16 v[128:131], a[20:23], v[68:71], v[128:131]
  v_mfma_f32_16x16x32_bf16 v[132:135], a[100:103], v[68:71], v[132:135]
  ds_read_b64_tr_b16 v[96:97], v6 offset:6144
  ds_read_b64_tr_b16 v[98:99], v6 offset:6400
  s_waitcnt lgkmcnt(12)
  v_mfma_f32_16x16x32_bf16 v[128:131], a[24:27], v[72:75], v[128:131]
  v_mfma_f32_16x16x32_bf16 v[132:135], a[104:107], v[72:75], v[132:135]
  ds_read_b64_tr_b16 v[100:101], v6 offset:6656
  ds_read_b64_tr_b16 v[102:103], v6 offset:6912
  s_waitcnt lgkmcnt(12)
  v_mfma_f32_16x16x32_bf16 v[128:131], a[28:31], v[76:79], v[128:131]
  v_mfma_f32_16x16x32_bf16 v[132:135], a[108:111], v[76:79], v[132:135]
  ds_read_b64_tr_b16 v[104:105], v6 offset:7168
  ds_read_b64_tr_b16 v[106:107], v6 offset:7424
  s_waitcnt lgkmcnt(12)
  v_mfma_f32_16x16x32_bf16 v[128:131], a[32:35], v[80:83], v[128:131]
  v_mfma_f32_16x16x32_bf16 v[132:135], a[112:115], v[80:83], v[132:135]
  ds_read_b64_tr_b16 v[108:109], v6 offset:7680
  ds_read_b64_tr_b16 v[110:111], v6 offset:7936
  s_waitcnt lgkmcnt(12)
  v_mfma_f32_16x16x32_bf16 v[128:131], a[36:39], v[84:87], v[128:131]
  v_mfma_f32_16x16x32_bf16 v[132:135], a[116:119], v[84:87], v[132:135]
  ds_read_b64_tr_b16 v[112:113], v6 offset:8192
  ds_read_b64_tr_b16 v[114:115], v6 offset:8448
  s_waitcnt lgkmcnt(12)
  v_mfma_f32_16x16x32_bf16 v[128:131], a[40:43], v[88:91], v[128:131]
  v_mfma_f32_16x16x32_bf16 v[132:135], a[120:123], v[88:91], v[132:135]
  ds_read_b64_tr_b16 v[116:117], v6 offset:8704
  ds_read_b64_tr_b16 v[118:119], v6 offset:8960
  s_waitcnt lgkmcnt(12)
  v_mfma_f32_16x16x32_bf16 v[128:131], a[44:47], v[92:95], v[128:131]
  v_mfma_f32_16x16x32_bf16 v[132:135], a[124:127], v[92:95], v[132:135]
  ds_read_b64_tr_b16 v[120:121], v6 offset:9216
  ds_read_b64_tr_b16 v[122:123], v6 offset:9472
  s_waitcnt lgkmcnt(12)
  v_mfma_f32_16x16x32_bf16 v[128:131], a[48:51], v[96:99], v[128:131]
  v_mfma_f32_16x16x32_bf16 v[132:135], a[128:131], v[96:99], v[132:135]
  ds_read_b64_tr_b16 v[124:125], v6 offset:9728
  ds_read_b64_tr_b16 v[126:127], v6 offset:9984
  s_waitcnt lgkmcnt(12)
  v_mfma_f32_16x16x32_bf16 v[128:131], a[52:55], v[100:103], v[128:131]
  v_mfma_f32_16x16x32_bf16 v[132:135], a[132:135], v[100:103], v[132:135]
  s_waitcnt lgkmcnt(10)
  v_mfma_f32_16x16x32_bf16 v[128:131], a[56:59], v[104:107], v[128:131]
  v_mfma_f32_16x16x32_bf16 v[132:135], a[136:139], v[104:107], v[132:135]
  s_waitcnt lgkmcnt(8)
  v_mfma_f32_16x16x32_bf16 v[128:131], a[60:63], v[108:111], v[128:131]
  v_mfma_f32_16x16x32_bf16 v[132:135], a[140:143], v[108:111], v[132:135]
  s_waitcnt lgkmcnt(6)
  v_mfma_f32_16x16x32_bf16 v[128:131], a[64:67], v[112:115], v[128:131]
  v_mfma_f32_16x16x32_bf16 v[132:135], a[144:147], v[112:115], v[132:135]
  s_waitcnt lgkmcnt(4)
  v_mfma_f32_16x16x32_bf16 v[128:131], a[68:71], v[116:119], v[128:131]
  v_mfma_f32_16x16x32_bf16 v[132:135], a[148:151], v[116:119], v[132:135]
  s_waitcnt lgkmcnt(2)
  v_mfma_f32_16x16x32_bf16 v[128:131], a[72:75], v[120:123], v[128:131]
  v_mfma_f32_16x16x32_bf16 v[132:135], a[152:155], v[120:123], v[132:135]
  s_waitcnt lgkmcnt(0)
  v_mfma_f32_16x16x32_bf16 v[128:131], a[76:79], v[124:127], v[128:131]
  v_mfma_f32_16x16x32_bf16 v[132:135], a[156:159], v[124:127], v[132:135]
  s_nop 5
  v_cvt_pk_bf16_f32 v140, v128, v129
  v_cvt_pk_bf16_f32 v141, v130, v131
  s_nop 0
  v_cvt_pk_bf16_f32 v142, v132, v133
  v_cvt_pk_bf16_f32 v143, v134, v135
  s_mul_i32 s58, s52, 512
  v_add_u32 v30, s58, v20
  ds_write_b64 v30, v[140:141]
  ds_write_b64 v30, v[142:143] offset:1536
  s_waitcnt lgkmcnt(0)
  s_barrier
  s_cmp_eq_u32 s62, 63
  s_cbranch_scc1 L_ch1x_r
  ds_read_b128 v[158:161], v7 offset:0
  ds_read_b128 v[162:165], v7 offset:1024
  ds_read_b128 v[166:169], v7 offset:2048
  s_mov_b32 s56, 0
gv_2022:
  buffer_load_dwordx4 v[80:83], v11, s[48:51], s70 offen offset:0 sc1
  buffer_load_dwordx4 v[84:87], v11, s[48:51], s70 offen offset:512 sc1
  buffer_load_dwordx4 v[88:91], v11, s[48:51], s70 offen offset:1024 sc1
gv_2022w:
  s_waitcnt vmcnt(0)
  v_xor_b32 v30, s64, v80
  v_xor_b32 v31, s64, v84
  v_and_b32 v30, v30, v31
  v_xor_b32 v31, s64, v88
  v_and_b32 v30, v30, v31
  v_and_b32 v30, 1, v30
  v_cmp_eq_u32 vcc, 0, v30
  s_cbranch_vccnz gvr_2023
  s_branch gvd_2024
gvr_2023:
  s_cmp_lg_u32 s55, 0
  s_cbranch_scc1 gvd_2024
  s_add_u32 s56, s56, 1
  s_cmp_lt_u32 s56, 0x20000
  s_cbranch_scc1 gv_2022
  s_mov_b32 s55, 1
gvd_2024:
  v_cvt_pk_bf16_f32 v92, v80, v81
  v_cvt_pk_bf16_f32 v93, v82, v83
  v_cvt_pk_bf16_f32 v94, v84, v85
  v_cvt_pk_bf16_f32 v95, v86, v87
  v_cvt_pk_bf16_f32 v96, v88, v89
  v_cvt_pk_bf16_f32 v97, v90, v91
  s_waitcnt lgkmcnt(0)
  s_barrier
  ds_read_b128 v[100:103], v21
  ds_read_b64 v[104:105], v22
  s_waitcnt lgkmcnt(0)
  v_mfma_f32_16x16x32_bf16 v[120:123], v[24:27], v[100:103], 0
  v_mfma_f32_16x16x32_bf16 v[108:111], v[158:161], v[100:103], 0
  v_mfma_f32_16x16x32_bf16 v[112:115], v[162:165], v[100:103], 0
  v_mfma_f32_16x16x32_bf16 v[116:119], v[166:169], v[100:103], 0
  v_mfma_f32_16x16x16_bf16 v[120:123], v[24:25], v[104:105], v[120:123]
  v_mfma_f32_16x16x16_bf16 v[108:111], v[92:93], v[104:105], v[108:111]
  v_mfma_f32_16x16x16_bf16 v[112:115], v[94:95], v[104:105], v[112:115]
  v_mfma_f32_16x16x16_bf16 v[116:119], v[96:97], v[104:105], v[116:119]
  s_nop 4
  v_rcp_f32 v30, v120
  s_nop 2
  v_pk_mul_f32 v[108:109], v[108:109], v[30:31] op_sel_hi:[1,0]
  v_pk_mul_f32 v[110:111], v[110:111], v[30:31] op_sel_hi:[1,0]
  v_cvt_pk_bf16_f32 v108, v108, v109
  v_cvt_pk_bf16_f32 v109, v110, v111
  ds_write_b64 v12, v[108:109]
  v_pk_mul_f32 v[112:113], v[112:113], v[30:31] op_sel_hi:[1,0]
  v_pk_mul_f32 v[114:115], v[114:115], v[30:31] op_sel_hi:[1,0]
  v_cvt_pk_bf16_f32 v112, v112, v113
  v_cvt_pk_bf16_f32 v113, v114, v115
  ds_write_b64 v13, v[112:113]
  v_pk_mul_f32 v[116:117], v[116:117], v[30:31] op_sel_hi:[1,0]
  v_pk_mul_f32 v[118:119], v[118:119], v[30:31] op_sel_hi:[1,0]
  v_cvt_pk_bf16_f32 v116, v116, v117
  v_cvt_pk_bf16_f32 v117, v118, v119
  ds_write_b64 v14, v[116:117]
  s_waitcnt lgkmcnt(0)
  s_barrier
  ds_read_b128 v[48:51], v23 offset:0
  ds_read_b128 v[52:55], v23 offset:1024
  ds_read_b128 v[56:59], v23 offset:2048
  ds_read_b128 v[60:63], v23 offset:3072
  ds_read_b128 v[64:67], v23 offset:4096
  ds_read_b128 v[68:71], v23 offset:5120
  s_waitcnt lgkmcnt(5)
  v_mfma_f32_16x16x32_bf16 v[72:75], v[48:51], v[184:187], 0
  v_mfma_f32_16x16x32_bf16 v[76:79], v[48:51], v[208:211], 0
  v_mfma_f32_16x16x32_bf16 v[80:83], v[48:51], v[232:235], 0
  s_waitcnt lgkmcnt(4)
  v_mfma_f32_16x16x32_bf16 v[72:75], v[52:55], v[188:191], v[72:75]
  v_mfma_f32_16x16x32_bf16 v[76:79], v[52:55], v[212:215], v[76:79]
  v_mfma_f32_16x16x32_bf16 v[80:83], v[52:55], v[236:239], v[80:83]
  s_waitcnt lgkmcnt(3)
  v_mfma_f32_16x16x32_bf16 v[72:75], v[56:59], v[192:195], v[72:75]
  v_mfma_f32_16x16x32_bf16 v[76:79], v[56:59], v[216:219], v[76:79]
  v_mfma_f32_16x16x32_bf16 v[80:83], v[56:59], v[240:243], v[80:83]
  s_waitcnt lgkmcnt(2)
  v_mfma_f32_16x16x32_bf16 v[72:75], v[60:63], v[196:199], v[72:75]
  v_mfma_f32_16x16x32_bf16 v[76:79], v[60:63], v[220:223], v[76:79]
  v_mfma_f32_16x16x32_bf16 v[80:83], v[60:63], v[244:247], v[80:83]
  s_waitcnt lgkmcnt(1)
  v_mfma_f32_16x16x32_bf16 v[72:75], v[64:67], v[200:203], v[72:75]
  v_mfma_f32_16x16x32_bf16 v[76:79], v[64:67], v[224:227], v[76:79]
  v_mfma_f32_16x16x32_bf16 v[80:83], v[64:67], v[248:251], v[80:83]
  s_waitcnt lgkmcnt(0)
  v_mfma_f32_16x16x32_bf16 v[72:75], v[68:71], v[204:207], v[72:75]
  v_mfma_f32_16x16x32_bf16 v[76:79], v[68:71], v[228:231], v[76:79]
  v_mfma_f32_16x16x32_bf16 v[80:83], v[68:71], v[252:255], v[80:83]
  s_nop 3
  v_cvt_pk_bf16_f32 v84, v72, v73
  v_cvt_pk_bf16_f32 v85, v74, v75
  v_cvt_pk_bf16_f32 v86, v76, v77
  v_cvt_pk_bf16_f32 v87, v78, v79
  v_cvt_pk_bf16_f32 v88, v80, v81
  v_cvt_pk_bf16_f32 v89, v82, v83
  v_cvt_pk_bf16_f32 v90, v80, v81
  v_cvt_pk_bf16_f32 v91, v82, v83
  v_permlane16_swap_b32 v84, v86
  v_permlane16_swap_b32 v85, v87
  v_permlane16_swap_b32 v88, v90
  v_permlane16_swap_b32 v89, v91
  s_nop 0
  v_bfi_b32 v84, 1, s63, v84
  v_bfi_b32 v88, 1, s63, v88
  s_mov_b64 exec, 0xffffffff
  buffer_store_dwordx4 v[84:87], v15, s[48:51], s71 offen sc1
  s_mov_b64 exec, 0xffff
  buffer_store_dwordx4 v[88:91], v16, s[48:51], s71 offen sc1
  s_mov_b64 exec, -1
  s_waitcnt vmcnt(0)
  s_lshl_b32 s58, s52, 4
  s_add_u32 s58, s58, s54
  s_cmp_ge_u32 s58, 48
  s_cbranch_scc1 noc_2025
  s_mov_b32 s56, 0
  buffer_load_dwordx4 v[48:51], v2, s[48:51], s72 offen offset:0 sc1
  buffer_load_dwordx4 v[52:55], v2, s[48:51], s72 offen offset:1024 sc1
  buffer_load_dwordx4 v[56:59], v2, s[48:51], s72 offen offset:2048 sc1
  buffer_load_dwordx4 v[60:63], v2, s[48:51], s72 offen offset:3072 sc1
  s_waitcnt vmcnt(0)
gc_2026:
  v_xor_b32 v30, s64, v48
  v_xor_b32 v31, s64, v52
  v_and_b32 v30, v30, v31
  v_xor_b32 v31, s64, v56
  v_and_b32 v30, v30, v31
  v_xor_b32 v31, s64, v60
  v_and_b32 v30, v30, v31
  v_and_b32 v30, 1, v30
  v_cmp_eq_u32 vcc, 0, v30
  s_cbranch_vccnz gcr_2027
  s_branch gcd_2028
gcr_2027:
  s_cmp_lg_u32 s55, 0
  s_cbranch_scc1 gcd_2028
  s_add_u32 s56, s56, 1
  s_cmp_lt_u32 s56, 0x20000
  s_cbranch_scc1 gc_2026x
  s_mov_b32 s55, 1
gc_2026x:
  buffer_load_dwordx4 v[48:51], v2, s[48:51], s72 offen offset:0 sc1
  buffer_load_dwordx4 v[52:55], v2, s[48:51], s72 offen offset:1024 sc1
  buffer_load_dwordx4 v[56:59], v2, s[48:51], s72 offen offset:2048 sc1
  buffer_load_dwordx4 v[60:63], v2, s[48:51], s72 offen offset:3072 sc1
  s_waitcnt vmcnt(0)
  s_branch gc_2026
gcd_2028:
  v_mfma_f32_16x16x32_bf16 v[72:75], v[178:181], v[48:51], 0
  v_mfma_f32_16x16x32_bf16 v[72:75], v[178:181], v[52:55], v[72:75]
  v_mfma_f32_16x16x32_bf16 v[72:75], v[178:181], v[56:59], v[72:75]
  v_mfma_f32_16x16x32_bf16 v[72:75], v[178:181], v[60:63], v[72:75]
  s_nop 7
  v_add_f32_dpp v72, v72, v72 row_ror:8 row_mask:0xf bank_mask:0xf
  v_add_f32_dpp v73, v73, v73 row_ror:8 row_mask:0xf bank_mask:0xf
  v_add_f32_dpp v74, v74, v74 row_ror:8 row_mask:0xf bank_mask:0xf
  v_add_f32_dpp v75, v75, v75 row_ror:8 row_mask:0xf bank_mask:0xf
  s_nop 0
  v_cvt_pk_bf16_f32 v84, v72, v73
  v_cvt_pk_bf16_f32 v85, v74, v75
  v_cvt_pk_bf16_f32 v86, v72, v73
  v_cvt_pk_bf16_f32 v87, v74, v75
  s_nop 1
  v_permlane16_swap_b32 v84, v86
  v_permlane16_swap_b32 v85, v87
  s_nop 0
  v_bfi_b32 v84, 1, s63, v84
  s_mov_b64 exec, 0xff
  buffer_store_dwordx4 v[84:87], v17, s[48:51], s73 offen
  s_mov_b64 exec, -1
  s_branch cdn_2029
noc_2025:
cdn_2029:
  s_sub_u32 s66, s66, s74
  s_add_u32 s73, s73, s74
  s_sub_u32 s74, 0, s74
  s_add_u32 s67, s67, s75
  s_add_u32 s68, s68, s75
  s_sub_u32 s75, 0, s75
  s_add_u32 s69, s69, s76
  s_add_u32 s70, s70, s76
  s_sub_u32 s76, 0, s76
  s_add_u32 s71, s71, s77
  s_add_u32 s72, s72, s77
  s_sub_u32 s77, 0, s77
  s_mov_b32 s65, s64
  s_add_u32 s62, s62, 1
  s_lshr_b32 s63, s62, 1
  s_add_u32 s63, s63, 1
  s_and_b32 s63, s63, 1
  s_sub_u32 s64, s63, 1
  s_add_u32 s100, s100, 196608
  s_barrier
  s_branch L_ch1_r
L_ch1x_r:
  s_waitcnt vmcnt(0)
  s_endpgm
L_chw0_r:
  s_mul_i32 s100, s99, 6144
  s_mul_i32 s58, s3, 1536
  s_add_u32 s100, s100, s58
  s_add_u32 s100, s100, 0x200000
  s_lshl_b32 s58, s52, 9
  s_add_u32 s100, s100, s58
  s_barrier
  s_waitcnt vmcnt(0)
  s_mov_b32 s3, 0x3dd53b95
  s_branch L_ch0a_r
L_ch0_r:
  s_mov_b32 s56, 0
ga_3030:
  buffer_load_dwordx4 v[36:39], v2, s[48:51], s66 offen sc1
  buffer_load_dwordx4 v[40:43], v2, s[48:51], s66 offen offset:1024 sc1
  buffer_load_dwordx4 v[44:47], v3, s[48:51], s66 offen sc1
ga_3030w:
  s_waitcnt vmcnt(0)
  v_xor_b32 v30, s65, v36
  v_xor_b32 v31, s65, v40
  v_and_b32 v30, v30, v31
  v_xor_b32 v31, s65, v44
  v_and_b32 v30, v30, v31
  v_and_b32 v30, 1, v30
  v_cmp_eq_u32 vcc, 0, v30
  s_cbranch_vccnz gar_3031
  s_branch gad_3032
gar_3031:
  s_cmp_lg_u32 s55, 0
  s_cbranch_scc1 gad_3032
  s_add_u32 s56, s56, 1
  s_cmp_lt_u32 s56, 0x20000
  s_cbranch_scc1 ga_3030
  s_mov_b32 s55, 1
gad_3032:
  ds_write_b128 v4, v[36:39]
  ds_write_b128 v4, v[40:43] offset:1024
  ds_write_b128 v5, v[44:47]
L_ch0a_r:
  s_waitcnt lgkmcnt(0)
  s_barrier
  ds_read_b64_tr_b16 v[48:49], v6 offset:0
  ds_read_b64_tr_b16 v[50:51], v6 offset:256
  ds_read_b64_tr_b16 v[52:53], v6 offset:512
  ds_read_b64_tr_b16 v[54:55], v6 offset:768
  ds_read_b64_tr_b16 v[56:57], v6 offset:1024
  ds_read_b64_tr_b16 v[58:59], v6 offset:1280
  ds_read_b64_tr_b16 v[60:61], v6 offset:1536
  ds_read_b64_tr_b16 v[62:63], v6 offset:1792
  ds_read_b64_tr_b16 v[64:65], v6 offset:2048
  ds_read_b64_tr_b16 v[66:67], v6 offset:2304
  ds_read_b64_tr_b16 v[68:69], v6 offset:2560
  ds_read_b64_tr_b16 v[70:71], v6 offset:2816
  ds_read_b64_tr_b16 v[72:73], v6 offset:3072
  ds_read_b64_tr_b16 v[74:75], v6 offset:3328
  s_waitcnt lgkmcnt(12)
  v_mfma_f32_16x16x32_bf16 v[128:131], a[0:3], v[48:51], 0
  v_mfma_f32_16x16x32_bf16 v[132:135], a[80:83], v[48:51], 0
  ds_read_b64_tr_b16 v[76:77], v6 offset:3584
  ds_read_b64_tr_b16 v[78:79], v6 offset:3840
  s_waitcnt lgkmcnt(12)
  v_mfma_f32_16x16x32_bf16 v[128:131], a[4:7], v[52:55], v[128:131]
  v_mfma_f32_16x16x32_bf16 v[132:135], a[84:87], v[52:55], v[132:135]
  ds_read_b64_tr_b16 v[80:81], v6 offset:4096
  ds_read_b64_tr_b16 v[82:83], v6 offset:4352
  s_waitcnt lgkmcnt(12)
  v_mfma_f32_16x16x32_bf16 v[128:131], a[8:11], v[56:59], v[128:131]
  v_mfma_f32_16x16x32_bf16 v[132:135], a[88:91], v[56:59], v[132:135]
  ds_read_b64_tr_b16 v[84:85], v6 offset:4608
  ds_read_b64_tr_b16 v[86:87], v6 offset:4864
  s_waitcnt lgkmcnt(12)
  v_mfma_f32_16x16x32_bf16 v[128:131], a[12:15], v[60:63], v[128:131]
  v_mfma_f32_16x16x32_bf16 v[132:135], a[92:95], v[60:63], v[132:135]
  ds_read_b64_tr_b16 v[88:89], v6 offset:5120
  ds_read_b64_tr_b16 v[90:91], v6 offset:5376
  s_waitcnt lgkmcnt(12)
  v_mfma_f32_16x16x32_bf16 v[128:131], a[16:19], v[64:67], v[128:131]
  v_mfma_f32_16x16x32_bf16 v[132:135], a[96:99], v[64:67], v[132:135]
  ds_read_b64_tr_b16 v[92:93], v6 offset:5632
  ds_read_b64_tr_b16 v[94:95], v6 offset:5888
  s_waitcnt lgkmcnt(12)
  v_mfma_f32_16x16x32_bf16 v[128:131], a[20:23], v[68:71], v[128:131]
  v_mfma_f32_16x16x32_bf16 v[132:135], a[100:103], v[68:71], v[132:135]
  ds_read_b64_tr_b16 v[96:97], v6 offset:6144
  ds_read_b64_tr_b16 v[98:99], v6 offset:6400
  s_waitcnt lgkmcnt(12)
  v_mfma_f32_16x16x32_bf16 v[128:131], a[24:27], v[72:75], v[128:131]
  v_mfma_f32_16x16x32_bf16 v[132:135], a[104:107], v[72:75], v[132:135]
  ds_read_b64_tr_b16 v[100:101], v6 offset:6656
  ds_read_b64_tr_b16 v[102:103], v6 offset:6912
  s_waitcnt lgkmcnt(12)
  v_mfma_f32_16x16x32_bf16 v[128:131], a[28:31], v[76:79], v[128:131]
  v_mfma_f32_16x16x32_bf16 v[132:135], a[108:111], v[76:79], v[132:135]
  ds_read_b64_tr_b16 v[104:105], v6 offset:7168
  ds_read_b64_tr_b16 v[106:107], v6 offset:7424
  s_waitcnt lgkmcnt(12)
  v_mfma_f32_16x16x32_bf16 v[128:131], a[32:35], v[80:83], v[128:131]
  v_mfma_f32_16x16x32_bf16 v[132:135], a[112:115], v[80:83], v[132:135]
  ds_read_b64_tr_b16 v[108:109], v6 offset:7680
  ds_read_b64_tr_b16 v[110:111], v6 offset:7936
  s_waitcnt lgkmcnt(12)
  v_mfma_f32_16x16x32_bf16 v[128:131], a[36:39], v[84:87], v[128:131]
  v_mfma_f32_16x16x32_bf16 v[132:135], a[116:119], v[84:87], v[132:135]
  ds_read_b64_tr_b16 v[112:113], v6 offset:8192
  ds_read_b64_tr_b16 v[114:115], v6 offset:8448
  s_waitcnt lgkmcnt(12)
  v_mfma_f32_16x16x32_bf16 v[128:131], a[40:43], v[88:91], v[128:131]
  v_mfma_f32_16x16x32_bf16 v[132:135], a[120:123], v[88:91], v[132:135]
  ds_read_b64_tr_b16 v[116:117], v6 offset:8704
  ds_read_b64_tr_b16 v[118:119], v6 offset:8960
  s_waitcnt lgkmcnt(12)
  v_mfma_f32_16x16x32_bf16 v[128:131], a[44:47], v[92:95], v[128:131]
  v_mfma_f32_16x16x32_bf16 v[132:135], a[124:127], v[92:95], v[132:135]
  ds_read_b64_tr_b16 v[120:121], v6 offset:9216
  ds_read_b64_tr_b16 v[122:123], v6 offset:9472
  s_waitcnt lgkmcnt(12)
  v_mfma_f32_16x16x32_bf16 v[128:131], a[48:51], v[96:99], v[128:131]
  v_mfma_f32_16x16x32_bf16 v[132:135], a[128:131], v[96:99], v[132:135]
  ds_read_b64_tr_b16 v[124:125], v6 offset:9728
  ds_read_b64_tr_b16 v[126:127], v6 offset:9984
  s_waitcnt lgkmcnt(12)
  v_mfma_f32_16x16x32_bf16 v[128:131], a[52:55], v[100:103], v[128:131]
  v_mfma_f32_16x16x32_bf16 v[132:135], a[132:135], v[100:103], v[132:135]
  ds_read_b128 v[146:149], v2 offset:0
  ds_read_b128 v[150:153], v2 offset:1024
  ds_read_b128 v[154:157], v2 offset:2048
  s_waitcnt lgkmcnt(13)
  v_mfma_f32_16x16x32_bf16 v[128:131], a[56:59], v[104:107], v[128:131]
  v_mfma_f32_16x16x32_bf16 v[132:135], a[136:139], v[104:107], v[132:135]
  s_waitcnt lgkmcnt(11)
  v_mfma_f32_16x16x32_bf16 v[128:131], a[60:63], v[108:111], v[128:131]
  v_mfma_f32_16x16x32_bf16 v[132:135], a[140:143], v[108:111], v[132:135]
  s_waitcnt lgkmcnt(9)
  v_mfma_f32_16x16x32_bf16 v[128:131], a[64:67], v[112:115], v[128:131]
  v_mfma_f32_16x16x32_bf16 v[132:135], a[144:147], v[112:115], v[132:135]
  s_waitcnt lgkmcnt(7)
  v_mfma_f32_16x16x32_bf16 v[128:131], a[68:71], v[116:119], v[128:131]
  v_mfma_f32_16x16x32_bf16 v[132:135], a[148:151], v[116:119], v[132:135]
  s_waitcnt lgkmcnt(5)
  v_mfma_f32_16x16x32_bf16 v[128:131], a[72:75], v[120:123], v[128:131]
  v_mfma_f32_16x16x32_bf16 v[132:135], a[152:155], v[120:123], v[132:135]
  s_waitcnt lgkmcnt(3)
  v_mfma_f32_16x16x32_bf16 v[128:131], a[76:79], v[124:127], v[128:131]
  v_mfma_f32_16x16x32_bf16 v[132:135], a[156:159], v[124:127], v[132:135]
  s_waitcnt lgkmcnt(0)
  s_nop 5
  v_cvt_pk_bf16_f32 v140, v128, v129
  v_cvt_pk_bf16_f32 v141, v130, v131
  s_nop 0
  v_cvt_pk_bf16_f32 v142, v132, v133
  v_cvt_pk_bf16_f32 v143, v134, v135
  ds_write_b64 v20, v[142:143] offset:1536
  s_nop 0
  v_mfma_f32_16x16x16_bf16 v[112:115], v[142:143], v[140:141], 0
  v_mfma_f32_16x16x16_bf16 v[116:119], v[146:147], v[140:141], 0
  v_mfma_f32_16x16x16_bf16 v[120:123], v[148:149], v[140:141], 0
  s_waitcnt lgkmcnt(0)
  s_barrier
  s_cmp_eq_u32 s62, 63
  s_cbranch_scc1 L_ch0x_r
  ds_read_b64 v[170:171], v20 offset:512
  ds_read_b64 v[172:173], v20 offset:2048
  ds_read_b64 v[174:175], v20 offset:1024
  ds_read_b64 v[176:177], v20 offset:2560
  s_waitcnt lgkmcnt(2)
  v_mfma_f32_16x16x16_bf16 v[112:115], v[172:173], v[170:171], v[112:115]
  v_mfma_f32_16x16x16_bf16 v[116:119], v[150:151], v[170:171], v[116:119]
  v_mfma_f32_16x16x16_bf16 v[120:123], v[152:153], v[170:171], v[120:123]
  s_waitcnt lgkmcnt(0)
  v_mfma_f32_16x16x16_bf16 v[112:115], v[176:177], v[174:175], v[112:115]
  v_mfma_f32_16x16x16_bf16 v[116:119], v[154:155], v[174:175], v[116:119]
  v_mfma_f32_16x16x16_bf16 v[120:123], v[156:157], v[174:175], v[120:123]
  v_and_b32 v30, 8, v1
  v_cmp_eq_u32 vcc, 0, v30
  s_nop 5
  v_bfi_b32 v112, 1, s63, v112
  v_cndmask_b32 v116, v120, v116, vcc
  v_cndmask_b32 v117, v121, v117, vcc
  v_cndmask_b32 v118, v122, v118, vcc
  v_cndmask_b32 v119, v123, v119, vcc
  v_bfi_b32 v116, 1, s63, v116
  buffer_store_dwordx4 v[116:119], v2, s[48:51], s67 offen
  s_mov_b64 exec, 0x00ff00ff
  buffer_store_dwordx4 v[112:115], v10, s[48:51], s67 offen
  s_mov_b64 exec, -1
  ds_read_b128 v[158:161], v7 offset:0
  ds_read_b128 v[162:165], v7 offset:1024
  ds_read_b128 v[166:169], v7 offset:2048
  s_mov_b32 s56, 0
gs_3033:
  buffer_load_dwordx4 v[48:51], v2, s[48:51], s68 offen offset:0 sc1
  buffer_load_dwordx4 v[52:55], v2, s[48:51], s68 offen offset:1280 sc1
  buffer_load_dwordx4 v[56:59], v2, s[48:51], s68 offen offset:2560 sc1
  buffer_load_dwordx4 v[60:63], v2, s[48:51], s68 offen offset:3840 sc1
  buffer_load_dwordx4 v[64:67], v9, s[48:51], s68 offen offset:0 sc1
  buffer_load_dwordx4 v[68:71], v9, s[48:51], s68 offen offset:1280 sc1
  buffer_load_dwordx4 v[72:75], v9, s[48:51], s68 offen offset:2560 sc1
  buffer_load_dwordx4 v[76:79], v9, s[48:51], s68 offen offset:3840 sc1
  buffer_load_dwordx4 v[80:83], v11, s[48:51], s70 offen offset:0 sc1
  buffer_load_dwordx4 v[84:87], v11, s[48:51], s70 offen offset:512 sc1
  buffer_load_dwordx4 v[88:91], v11, s[48:51], s70 offen offset:1024 sc1
gs_3033w:
  s_waitcnt vmcnt(0)
  v_xor_b32 v30, s64, v48
  v_xor_b32 v31, s64, v52
  v_and_b32 v30, v30, v31
  v_xor_b32 v31, s64, v56
  v_and_b32 v30, v30, v31
  v_xor_b32 v31, s64, v60
  v_and_b32 v30, v30, v31
  v_xor_b32 v31, s64, v64
  v_and_b32 v30, v30, v31
  v_xor_b32 v31, s64, v68
  v_and_b32 v30, v30, v31
  v_xor_b32 v31, s64, v72
  v_and_b32 v30, v30, v31
  v_xor_b32 v31, s64, v76
  v_and_b32 v30, v30, v31
  v_xor_b32 v31, s64, v80
  v_and_b32 v30, v30, v31
  v_xor_b32 v31, s64, v84
  v_and_b32 v30, v30, v31
  v_xor_b32 v31, s64, v88
  v_and_b32 v30, v30, v31
  v_and_b32 v30, 1, v30
  v_cmp_eq_u32 vcc, 0, v30
  s_cbranch_vccnz gsr_3034
  s_branch gsd_3035
gsr_3034:
  s_cmp_lg_u32 s55, 0
  s_cbranch_scc1 gsd_3035
  s_add_u32 s56, s56, 1
  s_cmp_lt_u32 s56, 0x20000
  s_cbranch_scc1 gs_3033
  s_mov_b32 s55, 1
gsd_3035:
  v_pk_add_f32 v[48:49], v[48:49], v[52:53]
  v_pk_add_f32 v[50:51], v[50:51], v[54:55]
  v_pk_add_f32 v[56:57], v[56:57], v[60:61]
  v_pk_add_f32 v[58:59], v[58:59], v[62:63]
  v_pk_add_f32 v[64:65], v[64:65], v[68:69]
  v_pk_add_f32 v[66:67], v[66:67], v[70:71]
  v_pk_add_f32 v[72:73], v[72:73], v[76:77]
  v_pk_add_f32 v[74:75], v[74:75], v[78:79]
  v_pk_add_f32 v[48:49], v[48:49], v[56:57]
  v_pk_add_f32 v[50:51], v[50:51], v[58:59]
  v_pk_add_f32 v[64:65], v[64:65], v[72:73]
  v_pk_add_f32 v[66:67], v[66:67], v[74:75]
  v_max3_f32 v30, v48, v49, v50
  v_max3_f32 v31, v51, v64, v65
  v_max3_f32 v30, v30, v66, v67
  v_max_f32 v30, v30, v31
  s_nop 1
  v_max_f32_dpp v30, v30, v30 row_ror:8 row_mask:0xf bank_mask:0xf
  v_mov_b32 v31, v30
  s_nop 1
  v_permlane16_swap_b32 v30, v31
  s_nop 0
  v_max_f32 v30, v30, v31
  v_mov_b32 v31, v30
  s_nop 1
  v_permlane32_swap_b32 v30, v31
  s_nop 0
  v_max_f32 v30, v30, v31
  v_mul_f32 v30, s3, v30
  v_fma_f32 v48, v48, s3, -v30
  v_fma_f32 v49, v49, s3, -v30
  v_fma_f32 v50, v50, s3, -v30
  v_fma_f32 v51, v51, s3, -v30
  v_fma_f32 v64, v64, s3, -v30
  v_fma_f32 v65, v65, s3, -v30
  v_fma_f32 v66, v66, s3, -v30
  v_fma_f32 v67, v67, s3, -v30
  v_exp_f32 v48, v48
  v_exp_f32 v49, v49
  v_exp_f32 v50, v50
  v_exp_f32 v51, v51
  v_exp_f32 v64, v64
  v_exp_f32 v65, v65
  v_exp_f32 v66, v66
  v_exp_f32 v67, v67
  v_cvt_pk_bf16_f32 v100, v48, v49
  v_cvt_pk_bf16_f32 v101, v50, v51
  v_cvt_pk_bf16_f32 v104, v64, v65
  v_cvt_pk_bf16_f32 v105, v66, v67
  v_mov_b32_dpp v102, v100 row_ror:8 row_mask:0xf bank_mask:0xf
  v_mov_b32_dpp v103, v101 row_ror:8 row_mask:0xf bank_mask:0xf
  v_and_b32 v104, v104, v28
  v_and_b32 v105, v105, v28
  ds_write_b128 v21, v[100:103]
  ds_write_b64 v22, v[104:105]
  v_cvt_pk_bf16_f32 v92, v80, v81
  v_cvt_pk_bf16_f32 v93, v82, v83
  v_cvt_pk_bf16_f32 v94, v84, v85
  v_cvt_pk_bf16_f32 v95, v86, v87
  v_cvt_pk_bf16_f32 v96, v88, v89
  v_cvt_pk_bf16_f32 v97, v90, v91
  s_waitcnt lgkmcnt(0)
  s_barrier
  v_mfma_f32_16x16x32_bf16 v[120:123], v[24:27], v[100:103], 0
  v_mfma_f32_16x16x32_bf16 v[108:111], v[158:161], v[100:103], 0
  v_mfma_f32_16x16x32_bf16 v[112:115], v[162:165], v[100:103], 0
  v_mfma_f32_16x16x32_bf16 v[116:119], v[166:169], v[100:103], 0
  v_mfma_f32_16x16x16_bf16 v[120:123], v[24:25], v[104:105], v[120:123]
  v_mfma_f32_16x16x16_bf16 v[108:111], v[92:93], v[104:105], v[108:111]
  v_mfma_f32_16x16x16_bf16 v[112:115], v[94:95], v[104:105], v[112:115]
  v_mfma_f32_16x16x16_bf16 v[116:119], v[96:97], v[104:105], v[116:119]
  s_nop 4
  v_rcp_f32 v30, v120
  s_nop 2
  v_pk_mul_f32 v[108:109], v[108:109], v[30:31] op_sel_hi:[1,0]
  v_pk_mul_f32 v[110:111], v[110:111], v[30:31] op_sel_hi:[1,0]
  v_cvt_pk_bf16_f32 v108, v108, v109
  v_cvt_pk_bf16_f32 v109, v110, v111
  ds_write_b64 v12, v[108:109]
  v_pk_mul_f32 v[112:113], v[112:113], v[30:31] op_sel_hi:[1,0]
  v_pk_mul_f32 v[114:115], v[114:115], v[30:31] op_sel_hi:[1,0]
  v_cvt_pk_bf16_f32 v112, v112, v113
  v_cvt_pk_bf16_f32 v113, v114, v115
  ds_write_b64 v13, v[112:113]
  v_pk_mul_f32 v[116:117], v[116:117], v[30:31] op_sel_hi:[1,0]
  v_pk_mul_f32 v[118:119], v[118:119], v[30:31] op_sel_hi:[1,0]
  v_cvt_pk_bf16_f32 v116, v116, v117
  v_cvt_pk_bf16_f32 v117, v118, v119
  ds_write_b64 v14, v[116:117]
  s_waitcnt lgkmcnt(0)
  s_barrier
  ds_read_b128 v[48:51], v23 offset:0
  ds_read_b128 v[52:55], v23 offset:1024
  ds_read_b128 v[56:59], v23 offset:2048
  ds_read_b128 v[60:63], v23 offset:3072
  ds_read_b128 v[64:67], v23 offset:4096
  ds_read_b128 v[68:71], v23 offset:5120
  s_waitcnt lgkmcnt(5)
  v_mfma_f32_16x16x32_bf16 v[72:75], v[48:51], v[184:187], 0
  v_mfma_f32_16x16x32_bf16 v[76:79], v[48:51], v[208:211], 0
  v_mfma_f32_16x16x32_bf16 v[80:83], v[48:51], v[232:235], 0
  s_waitcnt lgkmcnt(4)
  v_mfma_f32_16x16x32_bf16 v[72:75], v[52:55], v[188:191], v[72:75]
  v_mfma_f32_16x16x32_bf16 v[76:79], v[52:55], v[212:215], v[76:79]
  v_mfma_f32_16x16x32_bf16 v[80:83], v[52:55], v[236:239], v[80:83]
  s_waitcnt lgkmcnt(3)
  v_mfma_f32_16x16x32_bf16 v[72:75], v[56:59], v[192:195], v[72:75]
  v_mfma_f32_16x16x32_bf16 v[76:79], v[56:59], v[216:219], v[76:79]
  v_mfma_f32_16x16x32_bf16 v[80:83], v[56:59], v[240:243], v[80:83]
  s_waitcnt lgkmcnt(2)
  v_mfma_f32_16x16x32_bf16 v[72:75], v[60:63], v[196:199], v[72:75]
  v_mfma_f32_16x16x32_bf16 v[76:79], v[60:63], v[220:223], v[76:79]
  v_mfma_f32_16x16x32_bf16 v[80:83], v[60:63], v[244:247], v[80:83]
  s_waitcnt lgkmcnt(1)
  v_mfma_f32_16x16x32_bf16 v[72:75], v[64:67], v[200:203], v[72:75]
  v_mfma_f32_16x16x32_bf16 v[76:79], v[64:67], v[224:227], v[76:79]
  v_mfma_f32_16x16x32_bf16 v[80:83], v[64:67], v[248:251], v[80:83]
  s_waitcnt lgkmcnt(0)
  v_mfma_f32_16x16x32_bf16 v[72:75], v[68:71], v[204:207], v[72:75]
  v_mfma_f32_16x16x32_bf16 v[76:79], v[68:71], v[228:231], v[76:79]
  v_mfma_f32_16x16x32_bf16 v[80:83], v[68:71], v[252:255], v[80:83]
  s_nop 3
  v_cvt_pk_bf16_f32 v84, v72, v73
  v_cvt_pk_bf16_f32 v85, v74, v75
  v_cvt_pk_bf16_f32 v86, v76, v77
  v_cvt_pk_bf16_f32 v87, v78, v79
  v_cvt_pk_bf16_f32 v88, v80, v81
  v_cvt_pk_bf16_f32 v89, v82, v83
  v_cvt_pk_bf16_f32 v90, v80, v81
  v_cvt_pk_bf16_f32 v91, v82, v83
  v_permlane16_swap_b32 v84, v86
  v_permlane16_swap_b32 v85, v87
  v_permlane16_swap_b32 v88, v90
  v_permlane16_swap_b32 v89, v91
  s_nop 0
  v_bfi_b32 v84, 1, s63, v84
  v_bfi_b32 v88, 1, s63, v88
  s_mov_b64 exec, 0xffffffff
  buffer_store_dwordx4 v[84:87], v15, s[48:51], s71 offen sc1
  s_mov_b64 exec, 0xffff
  buffer_store_dwordx4 v[88:91], v16, s[48:51], s71 offen sc1
  s_mov_b64 exec, -1
  s_waitcnt vmcnt(0)
  s_mov_b32 s56, 0
  buffer_load_dwordx4 v[48:51], v2, s[48:51], s72 offen offset:0 sc1
  buffer_load_dwordx4 v[52:55], v2, s[48:51], s72 offen offset:1024 sc1
  buffer_load_dwordx4 v[56:59], v2, s[48:51], s72 offen offset:2048 sc1
  buffer_load_dwordx4 v[60:63], v2, s[48:51], s72 offen offset:3072 sc1
  s_waitcnt vmcnt(0)
gc_3037:
  v_xor_b32 v30, s64, v48
  v_xor_b32 v31, s64, v52
  v_and_b32 v30, v30, v31
  v_xor_b32 v31, s64, v56
  v_and_b32 v30, v30, v31
  v_xor_b32 v31, s64, v60
  v_and_b32 v30, v30, v31
  v_and_b32 v30, 1, v30
  v_cmp_eq_u32 vcc, 0, v30
  s_cbranch_vccnz gcr_3038
  s_branch gcd_3039
gcr_3038:
  s_cmp_lg_u32 s55, 0
  s_cbranch_scc1 gcd_3039
  s_add_u32 s56, s56, 1
  s_cmp_lt_u32 s56, 0x20000
  s_cbranch_scc1 gc_3037x
  s_mov_b32 s55, 1
gc_3037x:
  buffer_load_dwordx4 v[48:51], v2, s[48:51], s72 offen offset:0 sc1
  buffer_load_dwordx4 v[52:55], v2, s[48:51], s72 offen offset:1024 sc1
  buffer_load_dwordx4 v[56:59], v2, s[48:51], s72 offen offset:2048 sc1
  buffer_load_dwordx4 v[60:63], v2, s[48:51], s72 offen offset:3072 sc1
  s_waitcnt vmcnt(0)
  s_branch gc_3037
gcd_3039:
  v_mfma_f32_16x16x32_bf16 v[72:75], v[178:181], v[48:51], 0
  v_mfma_f32_16x16x32_bf16 v[72:75], v[178:181], v[52:55], v[72:75]
  v_mfma_f32_16x16x32_bf16 v[72:75], v[178:181], v[56:59], v[72:75]
  v_mfma_f32_16x16x32_bf16 v[72:75], v[178:181], v[60:63], v[72:75]
  s_nop 7
  v_add_f32_dpp v72, v72, v72 row_ror:8 row_mask:0xf bank_mask:0xf
  v_add_f32_dpp v73, v73, v73 row_ror:8 row_mask:0xf bank_mask:0xf
  v_add_f32_dpp v74, v74, v74 row_ror:8 row_mask:0xf bank_mask:0xf
  v_add_f32_dpp v75, v75, v75 row_ror:8 row_mask:0xf bank_mask:0xf
  s_nop 0
  v_cvt_pk_bf16_f32 v84, v72, v73
  v_cvt_pk_bf16_f32 v85, v74, v75
  v_cvt_pk_bf16_f32 v86, v72, v73
  v_cvt_pk_bf16_f32 v87, v74, v75
  s_nop 1
  v_permlane16_swap_b32 v84, v86
  v_permlane16_swap_b32 v85, v87
  s_nop 0
  v_bfi_b32 v84, 1, s63, v84
  s_mov_b64 exec, 0xff
  buffer_store_dwordx4 v[84:87], v17, s[48:51], s73 offen
  s_mov_b64 exec, -1
  s_branch cdn_3040
noc_3036:
cdn_3040:
  s_sub_u32 s66, s66, s74
  s_add_u32 s73, s73, s74
  s_sub_u32 s74, 0, s74
  s_add_u32 s67, s67, s75
  s_add_u32 s68, s68, s75
  s_sub_u32 s75, 0, s75
  s_add_u32 s69, s69, s76
  s_add_u32 s70, s70, s76
  s_sub_u32 s76, 0, s76
  s_add_u32 s71, s71, s77
  s_add_u32 s72, s72, s77
  s_sub_u32 s77, 0, s77
  s_mov_b32 s65, s64
  s_add_u32 s62, s62, 1
  s_lshr_b32 s63, s62, 1
  s_add_u32 s63, s63, 1
  s_and_b32 s63, s63, 1
  s_sub_u32 s64, s63, 1
  s_add_u32 s100, s100, 196608
  s_barrier
  s_branch L_ch0_r
L_ch0x_r:
  s_waitcnt vmcnt(0)
  s_endpgm
L_chw3_r:
  s_mul_i32 s100, s99, 6144
  s_mul_i32 s58, s3, 1536
  s_add_u32 s100, s100, s58
  s_add_u32 s100, s100, 0xe00000
  s_xor_b32 s59, s3, 1
  s_mul_i32 s59, s59, 1536
  s_sub_u32 s59, s59, s58
  s_add_u32 s100, s100, s59
  s_add_u32 s60, s59, 0xc00000
  s_barrier
  s_mov_b32 s59, 1
  s_cmp_ge_u32 s101, s59
  s_cbranch_scc1 t1ok_7041
  s_mov_b32 s56, 0
t1p_7042:
  buffer_load_dword v30, v19, s[48:51], 0 offen sc1
  s_waitcnt vmcnt(0)
  v_readlane_b32 s58, v30, 0
  v_readlane_b32 s101, v30, 1
  s_min_u32 s101, s101, s58
  s_cmp_ge_u32 s101, s59
  s_cbranch_scc1 t1ok_7041
  s_cmp_lg_u32 s55, 0
  s_cbranch_scc1 t1ok_7041
  s_add_u32 s56, s56, 1
  s_cmp_lt_u32 s56, 0x20000
  s_cbranch_scc1 t1p_7042
  s_mov_b32 s55, 1
t1ok_7041:
  s_mov_b32 m0, 0
  s_nop 0
  buffer_load_dwordx4 v2, s[48:51], s78 offen offset:0 sc1 lds
  buffer_load_dwordx4 v2, s[48:51], s78 offen offset:1024 sc1 lds
  buffer_load_dwordx4 v2, s[48:51], s78 offen offset:2048 sc1 lds
  s_add_u32 s58, s79, 0
  s_mov_b32 m0, 3072
  s_nop 0
  buffer_load_dwordx4 v2, s[48:51], s58 offen offset:0 sc1 lds
  buffer_load_dwordx4 v2, s[48:51], s58 offen offset:1024 sc1 lds
  buffer_load_dwordx4 v2, s[48:51], s58 offen offset:2048 sc1 lds
  buffer_load_dwordx4 v2, s[48:51], s58 offen offset:3072 sc1 lds
  s_add_u32 s58, s79, 4096
  s_mov_b32 m0, 7168
  s_nop 0
  buffer_load_dwordx4 v2, s[48:51], s58 offen offset:0 sc1 lds
  buffer_load_dwordx4 v2, s[48:51], s58 offen offset:1024 sc1 lds
  buffer_load_dwordx4 v2, s[48:51], s58 offen offset:2048 sc1 lds
  buffer_load_dwordx4 v2, s[48:51], s58 offen offset:3072 sc1 lds
  s_add_u32 s58, s79, 8192
  s_mov_b32 m0, 11264
  s_nop 0
  buffer_load_dwordx4 v2, s[48:51], s58 offen offset:0 sc1 lds
  buffer_load_dwordx4 v2, s[48:51], s58 offen offset:1024 sc1 lds
  buffer_load_dwordx4 v2, s[48:51], s58 offen offset:2048 sc1 lds
  buffer_load_dwordx4 v2, s[48:51], s58 offen offset:3072 sc1 lds
  s_add_u32 s78, s78, 393216
  s_add_u32 s79, s79, 393216
  s_waitcnt vmcnt(0)
  s_mov_b32 s3, 0x3dd53b95
  s_branch L_ch3a_r
L_ch3_r:
  s_mov_b32 s56, 0
ga_7043:
  buffer_load_dwordx4 v[36:39], v2, s[48:51], s66 offen sc1
  buffer_load_dwordx4 v[40:43], v2, s[48:51], s66 offen offset:1024 sc1
  buffer_load_dwordx4 v[44:47], v3, s[48:51], s66 offen sc1
ga_7043w:
  s_waitcnt vmcnt(0)
  v_xor_b32 v30, s65, v36
  v_xor_b32 v31, s65, v40
  v_and_b32 v30, v30, v31
  v_xor_b32 v31, s65, v44
  v_and_b32 v30, v30, v31
  v_and_b32 v30, 1, v30
  v_cmp_eq_u32 vcc, 0, v30
  s_cbranch_vccnz gar_7044
  s_branch gad_7045
gar_7044:
  s_cmp_lg_u32 s55, 0
  s_cbranch_scc1 gad_7045
  s_add_u32 s56, s56, 1
  s_cmp_lt_u32 s56, 0x20000
  s_cbranch_scc1 ga_7043
  s_mov_b32 s55, 1
gad_7045:
  ds_write_b128 v4, v[36:39]
  ds_write_b128 v4, v[40:43] offset:1024
  ds_write_b128 v5, v[44:47]
L_ch3a_r:
  s_waitcnt lgkmcnt(0)
  s_barrier
  ds_read_b64_tr_b16 v[48:49], v6 offset:0
  ds_read_b64_tr_b16 v[50:51], v6 offset:256
  ds_read_b64_tr_b16 v[52:53], v6 offset:512
  ds_read_b64_tr_b16 v[54:55], v6 offset:768
  ds_read_b64_tr_b16 v[56:57], v6 offset:1024
  ds_read_b64_tr_b16 v[58:59], v6 offset:1280
  ds_read_b64_tr_b16 v[60:61], v6 offset:1536
  ds_read_b64_tr_b16 v[62:63], v6 offset:1792
  ds_read_b64_tr_b16 v[64:65], v6 offset:2048
  ds_read_b64_tr_b16 v[66:67], v6 offset:2304
  ds_read_b64_tr_b16 v[68:69], v6 offset:2560
  ds_read_b64_tr_b16 v[70:71], v6 offset:2816
  ds_read_b64_tr_b16 v[72:73], v6 offset:3072
  ds_read_b64_tr_b16 v[74:75], v6 offset:3328
  s_waitcnt lgkmcnt(12)
  v_mfma_f32_16x16x32_bf16 v[128:131], v[48:51], a[0:3], 0
  v_mfma_f32_16x16x32_bf16 v[132:135], v[48:51], a[80:83], 0
  v_mfma_f32_16x16x32_bf16 v[136:139], v[48:51], a[160:163], 0
  ds_read_b64_tr_b16 v[76:77], v6 offset:3584
  ds_read_b64_tr_b16 v[78:79], v6 offset:3840
  s_waitcnt lgkmcnt(12)
  v_mfma_f32_16x16x32_bf16 v[128:131], v[52:55], a[4:7], v[128:131]
  v_mfma_f32_16x16x32_bf16 v[132:135], v[52:55], a[84:87], v[132:135]
  v_mfma_f32_16x16x32_bf16 v[136:139], v[52:55], a[164:167], v[136:139]
  ds_read_b64_tr_b16 v[80:81], v6 offset:4096
  ds_read_b64_tr_b16 v[82:83], v6 offset:4352
  s_waitcnt lgkmcnt(12)
  v_mfma_f32_16x16x32_bf16 v[128:131], v[56:59], a[8:11], v[128:131]
  v_mfma_f32_16x16x32_bf16 v[132:135], v[56:59], a[88:91], v[132:135]
  v_mfma_f32_16x16x32_bf16 v[136:139], v[56:59], a[168:171], v[136:139]
  ds_read_b64_tr_b16 v[84:85], v6 offset:4608
  ds_read_b64_tr_b16 v[86:87], v6 offset:4864
  s_waitcnt lgkmcnt(12)
  v_mfma_f32_16x16x32_bf16 v[128:131], v[60:63], a[12:15], v[128:131]
  v_mfma_f32_16x16x32_bf16 v[132:135], v[60:63], a[92:95], v[132:135]
  v_mfma_f32_16x16x32_bf16 v[136:139], v[60:63], a[172:175], v[136:139]
  ds_read_b64_tr_b16 v[88:89], v6 offset:5120
  ds_read_b64_tr_b16 v[90:91], v6 offset:5376
  s_waitcnt lgkmcnt(12)
  v_mfma_f32_16x16x32_bf16 v[128:131], v[64:67], a[16:19], v[128:131]
  v_mfma_f32_16x16x32_bf16 v[132:135], v[64:67], a[96:99], v[132:135]
  v_mfma_f32_16x16x32_bf16 v[136:139], v[64:67], a[176:179], v[136:139]
  ds_read_b64_tr_b16 v[92:93], v6 offset:5632
  ds_read_b64_tr_b16 v[94:95], v6 offset:5888
  s_waitcnt lgkmcnt(12)
  v_mfma_f32_16x16x32_bf16 v[128:131], v[68:71], a[20:23], v[128:131]
  v_mfma_f32_16x16x32_bf16 v[132:135], v[68:71], a[100:103], v[132:135]
  v_mfma_f32_16x16x32_bf16 v[136:139], v[68:71], a[180:183], v[136:139]
  ds_read_b64_tr_b16 v[96:97], v6 offset:6144
  ds_read_b64_tr_b16 v[98:99], v6 offset:6400
  s_waitcnt lgkmcnt(12)
  v_mfma_f32_16x16x32_bf16 v[128:131], v[72:75], a[24:27], v[128:131]
  v_mfma_f32_16x16x32_bf16 v[132:135], v[72:75], a[104:107], v[132:135]
  v_mfma_f32_16x16x32_bf16 v[136:139], v[72:75], a[184:187], v[136:139]
  ds_read_b64_tr_b16 v[100:101], v6 offset:6656
  ds_read_b64_tr_b16 v[102:103], v6 offset:6912
  s_waitcnt lgkmcnt(12)
  v_mfma_f32_16x16x32_bf16 v[128:131], v[76:79], a[28:31], v[128:131]
  v_mfma_f32_16x16x32_bf16 v[132:135], v[76:79], a[108:111], v[132:135]
  v_mfma_f32_16x16x32_bf16 v[136:139], v[76:79], a[188:191], v[136:139]
  ds_read_b64_tr_b16 v[104:105], v6 offset:7168
  ds_read_b64_tr_b16 v[106:107], v6 offset:7424
  s_waitcnt lgkmcnt(12)
  v_mfma_f32_16x16x32_bf16 v[128:131], v[80:83], a[32:35], v[128:131]
  v_mfma_f32_16x16x32_bf16 v[132:135], v[80:83], a[112:115], v[132:135]
  v_mfma_f32_16x16x32_bf16 v[136:139], v[80:83], a[192:195], v[136:139]
  ds_read_b64_tr_b16 v[108:109], v6 offset:7680
  ds_read_b64_tr_b16 v[110:111], v6 offset:7936
  s_waitcnt lgkmcnt(12)
  v_mfma_f32_16x16x32_bf16 v[128:131], v[84:87], a[36:39], v[128:131]
  v_mfma_f32_16x16x32_bf16 v[132:135], v[84:87], a[116:119], v[132:135]
  v_mfma_f32_16x16x32_bf16 v[136:139], v[84:87], a[196:199], v[136:139]
  ds_read_b64_tr_b16 v[112:113], v6 offset:8192
  ds_read_b64_tr_b16 v[114:115], v6 offset:8448
  s_waitcnt lgkmcnt(12)
  v_mfma_f32_16x16x32_bf16 v[128:131], v[88:91], a[40:43], v[128:131]
  v_mfma_f32_16x16x32_bf16 v[132:135], v[88:91], a[120:123], v[132:135]
  v_mfma_f32_16x16x32_bf16 v[136:139], v[88:91], a[200:203], v[136:139]
  ds_read_b64_tr_b16 v[116:117], v6 offset:8704
  ds_read_b64_tr_b16 v[118:119], v6 offset:8960
  s_waitcnt lgkmcnt(12)
  v_mfma_f32_16x16x32_bf16 v[128:131], v[92:95], a[44:47], v[128:131]
  v_mfma_f32_16x16x32_bf16 v[132:135], v[92:95], a[124:127], v[132:135]
  v_mfma_f32_16x16x32_bf16 v[136:139], v[92:95], a[204:207], v[136:139]
  ds_read_b64_tr_b16 v[120:121], v6 offset:9216
  ds_read_b64_tr_b16 v[122:123], v6 offset:9472
  s_waitcnt lgkmcnt(12)
  v_mfma_f32_16x16x32_bf16 v[128:131], v[96:99], a[48:51], v[128:131]
  v_mfma_f32_16x16x32_bf16 v[132:135], v[96:99], a[128:131], v[132:135]
  v_mfma_f32_16x16x32_bf16 v[136:139], v[96:99], a[208:211], v[136:139]
  ds_read_b64_tr_b16 v[124:125], v6 offset:9728
  ds_read_b64_tr_b16 v[126:127], v6 offset:9984
  s_waitcnt lgkmcnt(12)
  v_mfma_f32_16x16x32_bf16 v[128:131], v[100:103], a[52:55], v[128:131]
  v_mfma_f32_16x16x32_bf16 v[132:135], v[100:103], a[132:135], v[132:135]
  v_mfma_f32_16x16x32_bf16 v[136:139], v[100:103], a[212:215], v[136:139]
  s_waitcnt lgkmcnt(10)
  v_mfma_f32_16x16x32_bf16 v[128:131], v[104:107], a[56:59], v[128:131]
  v_mfma_f32_16x16x32_bf16 v[132:135], v[104:107], a[136:139], v[132:135]
  v_mfma_f32_16x16x32_bf16 v[136:139], v[104:107], a[216:219], v[136:139]
  s_waitcnt lgkmcnt(8)
  v_mfma_f32_16x16x32_bf16 v[128:131], v[108:111], a[60:63], v[128:131]
  v_mfma_f32_16x16x32_bf16 v[132:135], v[108:111], a[140:143], v[132:135]
  v_mfma_f32_16x16x32_bf16 v[136:139], v[108:111], a[220:223], v[136:139]
  s_waitcnt lgkmcnt(6)
  v_mfma_f32_16x16x32_bf16 v[128:131], v[112:115], a[64:67], v[128:131]
  v_mfma_f32_16x16x32_bf16 v[132:135], v[112:115], a[144:147], v[132:135]
  v_mfma_f32_16x16x32_bf16 v[136:139], v[112:115], a[224:227], v[136:139]
  s_barrier
  s_waitcnt lgkmcnt(4)
  v_mfma_f32_16x16x32_bf16 v[128:131], v[116:119], a[68:71], v[128:131]
  v_mfma_f32_16x16x32_bf16 v[132:135], v[116:119], a[148:151], v[132:135]
  v_mfma_f32_16x16x32_bf16 v[136:139], v[116:119], a[228:231], v[136:139]
  s_waitcnt lgkmcnt(2)
  v_mfma_f32_16x16x32_bf16 v[128:131], v[120:123], a[72:75], v[128:131]
  v_mfma_f32_16x16x32_bf16 v[132:135], v[120:123], a[152:155], v[132:135]
  v_mfma_f32_16x16x32_bf16 v[136:139], v[120:123], a[232:235], v[136:139]
  s_waitcnt lgkmcnt(0)
  v_mfma_f32_16x16x32_bf16 v[128:131], v[124:127], a[76:79], v[128:131]
  v_mfma_f32_16x16x32_bf16 v[132:135], v[124:127], a[156:159], v[132:135]
  v_mfma_f32_16x16x32_bf16 v[136:139], v[124:127], a[236:239], v[136:139]
  s_nop 7
  v_cvt_pk_bf16_f32 v140, v128, v129
  v_cvt_pk_bf16_f32 v141, v130, v131
  v_cvt_pk_bf16_f32 v142, v132, v133
  v_cvt_pk_bf16_f32 v143, v134, v135
  v_cvt_pk_bf16_f32 v144, v136, v137
  v_cvt_pk_bf16_f32 v145, v138, v139
  s_cmp_eq_u32 s62, 63
  s_cbranch_scc1 L_ch3x_r
  v_bfi_b32 v128, 1, s63, v128
  v_bfi_b32 v132, 1, s63, v132
  v_bfi_b32 v136, 1, s63, v136
  s_mov_b64 exec, 0xffffffff
  buffer_store_dwordx4 v[128:131], v2, s[48:51], s69 offen offset:0
  buffer_store_dwordx4 v[132:135], v2, s[48:51], s69 offen offset:512
  buffer_store_dwordx4 v[136:139], v2, s[48:51], s69 offen offset:1024
  s_mov_b64 exec, -1
  ds_read_b64 v[170:171], v20 offset:1536
  ds_read_b64 v[172:173], v20 offset:2048
  ds_read_b64 v[174:175], v20 offset:2560
  ds_read_b128 v[158:161], v7 offset:0
  ds_read_b128 v[162:165], v7 offset:1024
  ds_read_b128 v[166:169], v7 offset:2048
  s_mov_b32 s56, 0
gv_7046:
  buffer_load_dwordx4 v[80:83], v11, s[48:51], s70 offen offset:0 sc1
  buffer_load_dwordx4 v[84:87], v11, s[48:51], s70 offen offset:512 sc1
  buffer_load_dwordx4 v[88:91], v11, s[48:51], s70 offen offset:1024 sc1
gv_7046w:
  s_waitcnt vmcnt(0)
  v_xor_b32 v30, s64, v80
  v_xor_b32 v31, s64, v84
  v_and_b32 v30, v30, v31
  v_xor_b32 v31, s64, v88
  v_and_b32 v30, v30, v31
  v_and_b32 v30, 1, v30
  v_cmp_eq_u32 vcc, 0, v30
  s_cbranch_vccnz gvr_7047
  s_branch gvd_7048
gvr_7047:
  s_cmp_lg_u32 s55, 0
  s_cbranch_scc1 gvd_7048
  s_add_u32 s56, s56, 1
  s_cmp_lt_u32 s56, 0x20000
  s_cbranch_scc1 gv_7046
  s_mov_b32 s55, 1
gvd_7048:
  v_cvt_pk_bf16_f32 v92, v80, v81
  v_cvt_pk_bf16_f32 v93, v82, v83
  v_cvt_pk_bf16_f32 v94, v84, v85
  v_cvt_pk_bf16_f32 v95, v86, v87
  v_cvt_pk_bf16_f32 v96, v88, v89
  v_cvt_pk_bf16_f32 v97, v90, v91
  s_waitcnt lgkmcnt(0)
  s_barrier
  ds_read_b128 v[100:103], v21
  ds_read_b64 v[104:105], v22
  s_waitcnt lgkmcnt(0)
  v_mfma_f32_16x16x32_bf16 v[120:123], v[24:27], v[100:103], 0
  v_mfma_f32_16x16x32_bf16 v[108:111], v[158:161], v[100:103], 0
  v_mfma_f32_16x16x32_bf16 v[112:115], v[162:165], v[100:103], 0
  v_mfma_f32_16x16x32_bf16 v[116:119], v[166:169], v[100:103], 0
  v_mfma_f32_16x16x16_bf16 v[120:123], v[24:25], v[104:105], v[120:123]
  v_mfma_f32_16x16x16_bf16 v[108:111], v[92:93], v[104:105], v[108:111]
  v_mfma_f32_16x16x16_bf16 v[112:115], v[94:95], v[104:105], v[112:115]
  v_mfma_f32_16x16x16_bf16 v[116:119], v[96:97], v[104:105], v[116:119]
  s_nop 4
  v_rcp_f32 v30, v120
  s_nop 2
  v_pk_mul_f32 v[108:109], v[108:109], v[30:31] op_sel_hi:[1,0]
  v_pk_mul_f32 v[110:111], v[110:111], v[30:31] op_sel_hi:[1,0]
  v_cvt_pk_bf16_f32 v108, v108, v109
  v_cvt_pk_bf16_f32 v109, v110, v111
  ds_write_b64 v12, v[108:109]
  v_pk_mul_f32 v[112:113], v[112:113], v[30:31] op_sel_hi:[1,0]
  v_pk_mul_f32 v[114:115], v[114:115], v[30:31] op_sel_hi:[1,0]
  v_cvt_pk_bf16_f32 v112, v112, v113
  v_cvt_pk_bf16_f32 v113, v114, v115
  ds_write_b64 v13, v[112:113]
  v_pk_mul_f32 v[116:117], v[116:117], v[30:31] op_sel_hi:[1,0]
  v_pk_mul_f32 v[118:119], v[118:119], v[30:31] op_sel_hi:[1,0]
  v_cvt_pk_bf16_f32 v116, v116, v117
  v_cvt_pk_bf16_f32 v117, v118, v119
  ds_write_b64 v14, v[116:117]
  s_waitcnt lgkmcnt(0)
  s_barrier
  ds_read_b128 v[48:51], v23 offset:0
  ds_read_b128 v[52:55], v23 offset:1024
  ds_read_b128 v[56:59], v23 offset:2048
  ds_read_b128 v[60:63], v23 offset:3072
  ds_read_b128 v[64:67], v23 offset:4096
  ds_read_b128 v[68:71], v23 offset:5120
  buffer_store_dwordx2 v[140:141], v8, s[48:51], s100 offen offset:0 sc1
  buffer_store_dwordx2 v[142:143], v8, s[48:51], s100 offen offset:512 sc1
  buffer_store_dwordx2 v[144:145], v8, s[48:51], s100 offen offset:1024 sc1
  s_sub_u32 s58, s100, s60
  buffer_store_dwordx2 v[170:171], v8, s[48:51], s58 offen offset:0 sc1
  buffer_store_dwordx2 v[172:173], v8, s[48:51], s58 offen offset:512 sc1
  buffer_store_dwordx2 v[174:175], v8, s[48:51], s58 offen offset:1024 sc1
  s_add_u32 s59, s62, 2
  s_min_u32 s59, s59, 64
  s_cmp_ge_u32 s101, s59
  s_cbranch_scc1 t1ok_7049
  s_mov_b32 s56, 0
t1p_7050:
  buffer_load_dword v30, v19, s[48:51], 0 offen sc1
  s_waitcnt vmcnt(0)
  v_readlane_b32 s58, v30, 0
  v_readlane_b32 s101, v30, 1
  s_min_u32 s101, s101, s58
  s_cmp_ge_u32 s101, s59
  s_cbranch_scc1 t1ok_7049
  s_cmp_lg_u32 s55, 0
  s_cbranch_scc1 t1ok_7049
  s_add_u32 s56, s56, 1
  s_cmp_lt_u32 s56, 0x20000
  s_cbranch_scc1 t1p_7050
  s_mov_b32 s55, 1
t1ok_7049:
  s_mov_b32 m0, 0
  s_nop 0
  buffer_load_dwordx4 v2, s[48:51], s78 offen offset:0 sc1 lds
  buffer_load_dwordx4 v2, s[48:51], s78 offen offset:1024 sc1 lds
  buffer_load_dwordx4 v2, s[48:51], s78 offen offset:2048 sc1 lds
  s_add_u32 s58, s79, 0
  s_mov_b32 m0, 3072
  s_nop 0
  buffer_load_dwordx4 v2, s[48:51], s58 offen offset:0 sc1 lds
  buffer_load_dwordx4 v2, s[48:51], s58 offen offset:1024 sc1 lds
  buffer_load_dwordx4 v2, s[48:51], s58 offen offset:2048 sc1 lds
  buffer_load_dwordx4 v2, s[48:51], s58 offen offset:3072 sc1 lds
  s_add_u32 s58, s79, 4096
  s_mov_b32 m0, 7168
  s_nop 0
  buffer_load_dwordx4 v2, s[48:51], s58 offen offset:0 sc1 lds
  buffer_load_dwordx4 v2, s[48:51], s58 offen offset:1024 sc1 lds
  buffer_load_dwordx4 v2, s[48:51], s58 offen offset:2048 sc1 lds
  buffer_load_dwordx4 v2, s[48:51], s58 offen offset:3072 sc1 lds
  s_add_u32 s58, s79, 8192
  s_mov_b32 m0, 11264
  s_nop 0
  buffer_load_dwordx4 v2, s[48:51], s58 offen offset:0 sc1 lds
  buffer_load_dwordx4 v2, s[48:51], s58 offen offset:1024 sc1 lds
  buffer_load_dwordx4 v2, s[48:51], s58 offen offset:2048 sc1 lds
  buffer_load_dwordx4 v2, s[48:51], s58 offen offset:3072 sc1 lds
  s_add_u32 s78, s78, 393216
  s_add_u32 s79, s79, 393216
  s_waitcnt lgkmcnt(5)
  v_mfma_f32_16x16x32_bf16 v[72:75], v[48:51], v[184:187], 0
  s_waitcnt lgkmcnt(4)
  v_mfma_f32_16x16x32_bf16 v[72:75], v[52:55], v[188:191], v[72:75]
  s_waitcnt lgkmcnt(3)
  v_mfma_f32_16x16x32_bf16 v[72:75], v[56:59], v[192:195], v[72:75]
  s_waitcnt lgkmcnt(2)
  v_mfma_f32_16x16x32_bf16 v[72:75], v[60:63], v[196:199], v[72:75]
  s_waitcnt lgkmcnt(1)
  v_mfma_f32_16x16x32_bf16 v[72:75], v[64:67], v[200:203], v[72:75]
  s_waitcnt lgkmcnt(0)
  v_mfma_f32_16x16x32_bf16 v[72:75], v[68:71], v[204:207], v[72:75]
  s_nop 7
  s_nop 0
  v_cvt_pk_bf16_f32 v84, v72, v73
  v_cvt_pk_bf16_f32 v85, v74, v75
  v_cvt_pk_bf16_f32 v86, v72, v73
  v_cvt_pk_bf16_f32 v87, v74, v75
  s_nop 1
  v_permlane16_swap_b32 v84, v86
  v_permlane16_swap_b32 v85, v87
  s_nop 0
  v_bfi_b32 v84, 1, s63, v84
  s_mov_b64 exec, 0xffff
  buffer_store_dwordx4 v[84:87], v15, s[48:51], s71 offen sc1
  s_mov_b64 exec, -1
  s_waitcnt vmcnt(16)
  s_add_u32 s58, s62, 1
  v_mov_b32 v30, s58
  s_mov_b64 exec, 1
  buffer_store_dword v30, v18, s[48:51], 0 offen sc1
  s_mov_b64 exec, -1
noc_7051:
  s_sub_u32 s66, s66, s74
  s_add_u32 s73, s73, s74
  s_sub_u32 s74, 0, s74
  s_add_u32 s67, s67, s75
  s_add_u32 s68, s68, s75
  s_sub_u32 s75, 0, s75
  s_add_u32 s69, s69, s76
  s_add_u32 s70, s70, s76
  s_sub_u32 s76, 0, s76
  s_add_u32 s71, s71, s77
  s_add_u32 s72, s72, s77
  s_sub_u32 s77, 0, s77
  s_mov_b32 s65, s64
  s_add_u32 s62, s62, 1
  s_lshr_b32 s63, s62, 1
  s_add_u32 s63, s63, 1
  s_and_b32 s63, s63, 1
  s_sub_u32 s64, s63, 1
  s_add_u32 s100, s100, 196608
  s_barrier
  s_branch L_ch3_r
L_ch3x_r:
  ds_read_b64 v[170:171], v20 offset:1536
  ds_read_b64 v[172:173], v20 offset:2048
  ds_read_b64 v[174:175], v20 offset:2560
  buffer_store_dwordx2 v[140:141], v8, s[48:51], s100 offen offset:0 sc1
  buffer_store_dwordx2 v[142:143], v8, s[48:51], s100 offen offset:512 sc1
  buffer_store_dwordx2 v[144:145], v8, s[48:51], s100 offen offset:1024 sc1
  s_sub_u32 s58, s100, s60
  s_waitcnt lgkmcnt(0)
  buffer_store_dwordx2 v[170:171], v8, s[48:51], s58 offen offset:0 sc1
  buffer_store_dwordx2 v[172:173], v8, s[48:51], s58 offen offset:512 sc1
  buffer_store_dwordx2 v[174:175], v8, s[48:51], s58 offen offset:1024 sc1
  s_waitcnt vmcnt(0)
  s_add_u32 s58, s62, 1
  v_mov_b32 v30, s58
  s_mov_b64 exec, 1
  buffer_store_dword v30, v18, s[48:51], 0 offen sc1
  s_mov_b64 exec, -1
  s_waitcnt vmcnt(0)
  s_endpgm
L_bulk_r:
  s_sub_u32 s53, s53, 4
  s_cmp_lt_u32 s54, 16
  s_cbranch_scc0 L_t23_r
  s_lshl_b32 s69, s53, 3
  s_lshr_b32 s58, s54, 1
  s_add_u32 s69, s69, s58
  s_bitcmp1_b32 s54, 0
  s_cbranch_scc1 L_t1v_r
  v_and_b32 v1, 63, v0
  s_mul_i32 s58, s52, 640
  s_add_u32 s59, s58, 0
  v_add_u32 v18, s59, v1
  v_mul_u32_u24 v19, 3277, v18
  v_lshrrev_b32 v19, 18, v19
  v_mul_u32_u24 v20, 80, v19
  v_sub_u32 v18, v18, v20
  v_and_b32 v20, 15, v19
  v_xor_b32 v18, v18, v20
  v_lshlrev_b32 v18, 4, v18
  v_mul_u32_u24 v19, 1280, v19
  v_add_u32 v92, v18, v19
  s_add_u32 s59, s58, 64
  v_add_u32 v18, s59, v1
  v_mul_u32_u24 v19, 3277, v18
  v_lshrrev_b32 v19, 18, v19
  v_mul_u32_u24 v20, 80, v19
  v_sub_u32 v18, v18, v20
  v_and_b32 v20, 15, v19
  v_xor_b32 v18, v18, v20
  v_lshlrev_b32 v18, 4, v18
  v_mul_u32_u24 v19, 1280, v19
  v_add_u32 v93, v18, v19
  s_add_u32 s59, s58, 128
  v_add_u32 v18, s59, v1
  v_mul_u32_u24 v19, 3277, v18
  v_lshrrev_b32 v19, 18, v19
  v_mul_u32_u24 v20, 80, v19
  v_sub_u32 v18, v18, v20
  v_and_b32 v20, 15, v19
  v_xor_b32 v18, v18, v20
  v_lshlrev_b32 v18, 4, v18
  v_mul_u32_u24 v19, 1280, v19
  v_add_u32 v94, v18, v19
  s_add_u32 s59, s58, 192
  v_add_u32 v18, s59, v1
  v_mul_u32_u24 v19, 3277, v18
  v_lshrrev_b32 v19, 18, v19
  v_mul_u32_u24 v20, 80, v19
  v_sub_u32 v18, v18, v20
  v_and_b32 v20, 15, v19
  v_xor_b32 v18, v18, v20
  v_lshlrev_b32 v18, 4, v18
  v_mul_u32_u24 v19, 1280, v19
  v_add_u32 v95, v18, v19
  s_add_u32 s59, s58, 256
  v_add_u32 v18, s59, v1
  v_mul_u32_u24 v19, 3277, v18
  v_lshrrev_b32 v19, 18, v19
  v_mul_u32_u24 v20, 80, v19
  v_sub_u32 v18, v18, v20
  v_and_b32 v20, 15, v19
  v_xor_b32 v18, v18, v20
  v_lshlrev_b32 v18, 4, v18
  v_mul_u32_u24 v19, 1280, v19
  v_add_u32 v96, v18, v19
  s_add_u32 s59, s58, 320
  v_add_u32 v18, s59, v1
  v_mul_u32_u24 v19, 3277, v18
  v_lshrrev_b32 v19, 18, v19
  v_mul_u32_u24 v20, 80, v19
  v_sub_u32 v18, v18, v20
  v_and_b32 v20, 15, v19
  v_xor_b32 v18, v18, v20
  v_lshlrev_b32 v18, 4, v18
  v_mul_u32_u24 v19, 1280, v19
  v_add_u32 v97, v18, v19
  s_add_u32 s59, s58, 384
  v_add_u32 v18, s59, v1
  v_mul_u32_u24 v19, 3277, v18
  v_lshrrev_b32 v19, 18, v19
  v_mul_u32_u24 v20, 80, v19
  v_sub_u32 v18, v18, v20
  v_and_b32 v20, 15, v19
  v_xor_b32 v18, v18, v20
  v_lshlrev_b32 v18, 4, v18
  v_mul_u32_u24 v19, 1280, v19
  v_add_u32 v98, v18, v19
  s_add_u32 s59, s58, 448
  v_add_u32 v18, s59, v1
  v_mul_u32_u24 v19, 3277, v18
  v_lshrrev_b32 v19, 18, v19
  v_mul_u32_u24 v20, 80, v19
  v_sub_u32 v18, v18, v20
  v_and_b32 v20, 15, v19
  v_xor_b32 v18, v18, v20
  v_lshlrev_b32 v18, 4, v18
  v_mul_u32_u24 v19, 1280, v19
  v_add_u32 v99, v18, v19
  s_add_u32 s59, s58, 512
  v_add_u32 v18, s59, v1
  v_mul_u32_u24 v19, 3277, v18
  v_lshrrev_b32 v19, 18, v19
  v_mul_u32_u24 v20, 80, v19
  v_sub_u32 v18, v18, v20
  v_and_b32 v20, 15, v19
  v_xor_b32 v18, v18, v20
  v_lshlrev_b32 v18, 4, v18
  v_mul_u32_u24 v19, 1280, v19
  v_add_u32 v100, v18, v19
  s_add_u32 s59, s58, 576
  v_add_u32 v18, s59, v1
  v_mul_u32_u24 v19, 3277, v18
  v_lshrrev_b32 v19, 18, v19
  v_mul_u32_u24 v20, 80, v19
  v_sub_u32 v18, v18, v20
  v_and_b32 v20, 15, v19
  v_xor_b32 v18, v18, v20
  v_lshlrev_b32 v18, 4, v18
  v_mul_u32_u24 v19, 1280, v19
  v_add_u32 v101, v18, v19
  v_and_b32 v18, 15, v1
  v_lshrrev_b32 v19, 4, v1
  v_xor_b32 v19, v19, v18
  v_mul_u32_u24 v18, 1280, v18
  v_add_u32 v18, 0x1e000, v18
  v_xor_b32 v20, 0, v19
  v_lshlrev_b32 v20, 4, v20
  v_add_u32 v102, v18, v20
  v_xor_b32 v20, 4, v19
  v_lshlrev_b32 v20, 4, v20
  v_add_u32 v103, v18, v20
  v_xor_b32 v20, 8, v19
  v_lshlrev_b32 v20, 4, v20
  v_add_u32 v104, v18, v20
  v_xor_b32 v20, 12, v19
  v_lshlrev_b32 v20, 4, v20
  v_add_u32 v105, v18, v20
  v_lshrrev_b32 v18, 4, v1
  v_lshrrev_b32 v19, 2, v1
  v_and_b32 v19, 3, v19
  v_lshlrev_b32 v20, 3, v18
  v_add_u32 v20, v20, v19
  v_mul_u32_u24 v20, 384, v20
  v_and_b32 v21, 3, v1
  v_lshlrev_b32 v21, 3, v21
  v_add_u32 v20, v20, v21
  v_lshrrev_b32 v19, 1, v19
  v_and_b32 v18, 1, v18
  v_lshlrev_b32 v18, 1, v18
  v_or_b32 v18, v18, v19
  s_mul_i32 s58, s52, 3
  s_add_u32 s59, s58, 0
  v_xor_b32 v19, s59, v18
  v_lshlrev_b32 v19, 5, v19
  v_add_u32 v26, v19, v20
  s_add_u32 s59, s58, 1
  v_xor_b32 v19, s59, v18
  v_lshlrev_b32 v19, 5, v19
  v_add_u32 v27, v19, v20
  s_add_u32 s59, s58, 2
  v_xor_b32 v19, s59, v18
  v_lshlrev_b32 v19, 5, v19
  v_add_u32 v28, v19, v20
  s_mul_i32 s67, s69, 384
  s_mov_b32 s64, 0
  s_mul_i32 s65, s52, 10240
  s_add_u32 s65, s65, 122880
  v_mov_b32 v18, v0
  v_mul_u32_u24 v19, 2731, v18
  v_lshrrev_b32 v19, 16, v19
  v_mul_u32_u24 v20, 24, v19
  v_sub_u32 v18, v18, v20
  v_and_b32 v20, 2, v19
  v_lshrrev_b32 v21, 1, v19
  v_and_b32 v21, 4, v21
  v_or_b32 v20, v20, v21
  v_xor_b32 v18, v18, v20
  v_mul_u32_u24 v19, 12288, v19
  v_lshlrev_b32 v18, 4, v18
  v_add_u32 v2, v18, v19
  v_add_u32 v18, 256, v0
  v_mul_u32_u24 v19, 2731, v18
  v_lshrrev_b32 v19, 16, v19
  v_mul_u32_u24 v20, 24, v19
  v_sub_u32 v18, v18, v20
  v_and_b32 v20, 2, v19
  v_lshrrev_b32 v21, 1, v19
  v_and_b32 v21, 4, v21
  v_or_b32 v20, v20, v21
  v_xor_b32 v18, v18, v20
  v_mul_u32_u24 v19, 12288, v19
  v_lshlrev_b32 v18, 4, v18
  v_add_u32 v3, v18, v19
  v_add_u32 v18, 512, v0
  v_mul_u32_u24 v19, 2731, v18
  v_lshrrev_b32 v19, 16, v19
  v_mul_u32_u24 v20, 24, v19
  v_sub_u32 v18, v18, v20
  v_and_b32 v20, 2, v19
  v_lshrrev_b32 v21, 1, v19
  v_and_b32 v21, 4, v21
  v_or_b32 v20, v20, v21
  v_xor_b32 v18, v18, v20
  v_mul_u32_u24 v19, 12288, v19
  v_lshlrev_b32 v18, 4, v18
  v_add_u32 v4, v18, v19
  v_add_u32 v18, 768, v0
  v_mul_u32_u24 v19, 2731, v18
  v_lshrrev_b32 v19, 16, v19
  v_mul_u32_u24 v20, 24, v19
  v_sub_u32 v18, v18, v20
  v_and_b32 v20, 2, v19
  v_lshrrev_b32 v21, 1, v19
  v_and_b32 v21, 4, v21
  v_or_b32 v20, v20, v21
  v_xor_b32 v18, v18, v20
  v_mul_u32_u24 v19, 12288, v19
  v_lshlrev_b32 v18, 4, v18
  v_add_u32 v5, v18, v19
  v_add_u32 v18, 1024, v0
  v_mul_u32_u24 v19, 2731, v18
  v_lshrrev_b32 v19, 16, v19
  v_mul_u32_u24 v20, 24, v19
  v_sub_u32 v18, v18, v20
  v_and_b32 v20, 2, v19
  v_lshrrev_b32 v21, 1, v19
  v_and_b32 v21, 4, v21
  v_or_b32 v20, v20, v21
  v_xor_b32 v18, v18, v20
  v_mul_u32_u24 v19, 12288, v19
  v_lshlrev_b32 v18, 4, v18
  v_add_u32 v6, v18, v19
  v_add_u32 v18, 1280, v0
  v_mul_u32_u24 v19, 2731, v18
  v_lshrrev_b32 v19, 16, v19
  v_mul_u32_u24 v20, 24, v19
  v_sub_u32 v18, v18, v20
  v_and_b32 v20, 2, v19
  v_lshrrev_b32 v21, 1, v19
  v_and_b32 v21, 4, v21
  v_or_b32 v20, v20, v21
  v_xor_b32 v18, v18, v20
  v_mul_u32_u24 v19, 12288, v19
  v_lshlrev_b32 v18, 4, v18
  v_add_u32 v7, v18, v19
  v_add_u32 v18, 1536, v0
  v_mul_u32_u24 v19, 2731, v18
  v_lshrrev_b32 v19, 16, v19
  v_mul_u32_u24 v20, 24, v19
  v_sub_u32 v18, v18, v20
  v_and_b32 v20, 2, v19
  v_lshrrev_b32 v21, 1, v19
  v_and_b32 v21, 4, v21
  v_or_b32 v20, v20, v21
  v_xor_b32 v18, v18, v20
  v_mul_u32_u24 v19, 12288, v19
  v_lshlrev_b32 v18, 4, v18
  v_add_u32 v8, v18, v19
  v_add_u32 v18, 1792, v0
  v_mul_u32_u24 v19, 2731, v18
  v_lshrrev_b32 v19, 16, v19
  v_mul_u32_u24 v20, 24, v19
  v_sub_u32 v18, v18, v20
  v_and_b32 v20, 2, v19
  v_lshrrev_b32 v21, 1, v19
  v_and_b32 v21, 4, v21
  v_or_b32 v20, v20, v21
  v_xor_b32 v18, v18, v20
  v_mul_u32_u24 v19, 12288, v19
  v_lshlrev_b32 v18, 4, v18
  v_add_u32 v9, v18, v19
  v_add_u32 v18, 2048, v0
  v_mul_u32_u24 v19, 2731, v18
  v_lshrrev_b32 v19, 16, v19
  v_mul_u32_u24 v20, 24, v19
  v_sub_u32 v18, v18, v20
  v_and_b32 v20, 2, v19
  v_lshrrev_b32 v21, 1, v19
  v_and_b32 v21, 4, v21
  v_or_b32 v20, v20, v21
  v_xor_b32 v18, v18, v20
  v_mul_u32_u24 v19, 12288, v19
  v_lshlrev_b32 v18, 4, v18
  v_add_u32 v10, v18, v19
  v_add_u32 v18, 2304, v0
  v_mul_u32_u24 v19, 2731, v18
  v_lshrrev_b32 v19, 16, v19
  v_mul_u32_u24 v20, 24, v19
  v_sub_u32 v18, v18, v20
  v_and_b32 v20, 2, v19
  v_lshrrev_b32 v21, 1, v19
  v_and_b32 v21, 4, v21
  v_or_b32 v20, v20, v21
  v_xor_b32 v18, v18, v20
  v_mul_u32_u24 v19, 12288, v19
  v_lshlrev_b32 v18, 4, v18
  v_add_u32 v11, v18, v19
  v_add_u32 v18, 2560, v0
  v_mul_u32_u24 v19, 2731, v18
  v_lshrrev_b32 v19, 16, v19
  v_mul_u32_u24 v20, 24, v19
  v_sub_u32 v18, v18, v20
  v_and_b32 v20, 2, v19
  v_lshrrev_b32 v21, 1, v19
  v_and_b32 v21, 4, v21
  v_or_b32 v20, v20, v21
  v_xor_b32 v18, v18, v20
  v_mul_u32_u24 v19, 12288, v19
  v_lshlrev_b32 v18, 4, v18
  v_add_u32 v12, v18, v19
  v_add_u32 v18, 2816, v0
  v_mul_u32_u24 v19, 2731, v18
  v_lshrrev_b32 v19, 16, v19
  v_mul_u32_u24 v20, 24, v19
  v_sub_u32 v18, v18, v20
  v_and_b32 v20, 2, v19
  v_lshrrev_b32 v21, 1, v19
  v_and_b32 v21, 4, v21
  v_or_b32 v20, v20, v21
  v_xor_b32 v18, v18, v20
  v_mul_u32_u24 v19, 12288, v19
  v_lshlrev_b32 v18, 4, v18
  v_add_u32 v13, v18, v19
  v_add_u32 v18, 3072, v0
  v_mul_u32_u24 v19, 2731, v18
  v_lshrrev_b32 v19, 16, v19
  v_mul_u32_u24 v20, 24, v19
  v_sub_u32 v18, v18, v20
  v_and_b32 v20, 2, v19
  v_lshrrev_b32 v21, 1, v19
  v_and_b32 v21, 4, v21
  v_or_b32 v20, v20, v21
  v_xor_b32 v18, v18, v20
  v_mul_u32_u24 v19, 12288, v19
  v_lshlrev_b32 v18, 4, v18
  v_add_u32 v14, v18, v19
  v_add_u32 v18, 3328, v0
  v_mul_u32_u24 v19, 2731, v18
  v_lshrrev_b32 v19, 16, v19
  v_mul_u32_u24 v20, 24, v19
  v_sub_u32 v18, v18, v20
  v_and_b32 v20, 2, v19
  v_lshrrev_b32 v21, 1, v19
  v_and_b32 v21, 4, v21
  v_or_b32 v20, v20, v21
  v_xor_b32 v18, v18, v20
  v_mul_u32_u24 v19, 12288, v19
  v_lshlrev_b32 v18, 4, v18
  v_add_u32 v15, v18, v19
  v_add_u32 v18, 3584, v0
  v_mul_u32_u24 v19, 2731, v18
  v_lshrrev_b32 v19, 16, v19
  v_mul_u32_u24 v20, 24, v19
  v_sub_u32 v18, v18, v20
  v_and_b32 v20, 2, v19
  v_lshrrev_b32 v21, 1, v19
  v_and_b32 v21, 4, v21
  v_or_b32 v20, v20, v21
  v_xor_b32 v18, v18, v20
  v_mul_u32_u24 v19, 12288, v19
  v_lshlrev_b32 v18, 4, v18
  v_add_u32 v16, v18, v19
  s_add_u32 m0, s65, 0
  s_nop 0
  buffer_load_dwordx4 v92, s[4:7], s64 offen lds
  s_add_u32 m0, s65, 1024
  s_nop 0
  buffer_load_dwordx4 v93, s[4:7], s64 offen lds
  s_add_u32 m0, s65, 2048
  s_nop 0
  buffer_load_dwordx4 v94, s[4:7], s64 offen lds
  s_add_u32 m0, s65, 3072
  s_nop 0
  buffer_load_dwordx4 v95, s[4:7], s64 offen lds
  s_add_u32 m0, s65, 4096
  s_nop 0
  buffer_load_dwordx4 v96, s[4:7], s64 offen lds
  s_add_u32 m0, s65, 5120
  s_nop 0
  buffer_load_dwordx4 v97, s[4:7], s64 offen lds
  s_add_u32 m0, s65, 6144
  s_nop 0
  buffer_load_dwordx4 v98, s[4:7], s64 offen lds
  s_add_u32 m0, s65, 7168
  s_nop 0
  buffer_load_dwordx4 v99, s[4:7], s64 offen lds
  s_add_u32 m0, s65, 8192
  s_nop 0
  buffer_load_dwordx4 v100, s[4:7], s64 offen lds
  s_add_u32 m0, s65, 9216
  s_nop 0
  buffer_load_dwordx4 v101, s[4:7], s64 offen lds
  s_mov_b32 s70, s67
  s_lshl_b32 s60, s52, 10
  s_add_u32 s60, s60, 0x0
  s_add_u32 m0, s60, 0
  s_nop 0
  buffer_load_dwordx4 v2, s[16:19], s70 offen lds
  s_add_u32 m0, s60, 4096
  s_nop 0
  buffer_load_dwordx4 v3, s[16:19], s70 offen lds
  s_add_u32 m0, s60, 8192
  s_nop 0
  buffer_load_dwordx4 v4, s[16:19], s70 offen lds
  s_add_u32 m0, s60, 12288
  s_nop 0
  buffer_load_dwordx4 v5, s[16:19], s70 offen lds
  s_add_u32 m0, s60, 16384
  s_nop 0
  buffer_load_dwordx4 v6, s[16:19], s70 offen lds
  s_add_u32 m0, s60, 20480
  s_nop 0
  buffer_load_dwordx4 v7, s[16:19], s70 offen lds
  s_add_u32 m0, s60, 24576
  s_nop 0
  buffer_load_dwordx4 v8, s[16:19], s70 offen lds
  s_add_u32 m0, s60, 28672
  s_nop 0
  buffer_load_dwordx4 v9, s[16:19], s70 offen lds
  s_add_u32 m0, s60, 32768
  s_nop 0
  buffer_load_dwordx4 v10, s[16:19], s70 offen lds
  s_add_u32 m0, s60, 36864
  s_nop 0
  buffer_load_dwordx4 v11, s[16:19], s70 offen lds
  s_add_u32 m0, s60, 40960
  s_nop 0
  buffer_load_dwordx4 v12, s[16:19], s70 offen lds
  s_add_u32 m0, s60, 45056
  s_nop 0
  buffer_load_dwordx4 v13, s[16:19], s70 offen lds
  s_add_u32 m0, s60, 49152
  s_nop 0
  buffer_load_dwordx4 v14, s[16:19], s70 offen lds
  s_add_u32 m0, s60, 53248
  s_nop 0
  buffer_load_dwordx4 v15, s[16:19], s70 offen lds
  s_add_u32 m0, s60, 57344
  s_nop 0
  buffer_load_dwordx4 v16, s[16:19], s70 offen lds
  s_add_u32 s70, s70, 1966080
  s_lshl_b32 s60, s52, 10
  s_add_u32 s60, s60, 0xf000
  s_add_u32 m0, s60, 0
  s_nop 0
  buffer_load_dwordx4 v2, s[16:19], s70 offen lds
  s_add_u32 m0, s60, 4096
  s_nop 0
  buffer_load_dwordx4 v3, s[16:19], s70 offen lds
  s_add_u32 m0, s60, 8192
  s_nop 0
  buffer_load_dwordx4 v4, s[16:19], s70 offen lds
  s_add_u32 m0, s60, 12288
  s_nop 0
  buffer_load_dwordx4 v5, s[16:19], s70 offen lds
  s_add_u32 m0, s60, 16384
  s_nop 0
  buffer_load_dwordx4 v6, s[16:19], s70 offen lds
  s_add_u32 m0, s60, 20480
  s_nop 0
  buffer_load_dwordx4 v7, s[16:19], s70 offen lds
  s_add_u32 m0, s60, 24576
  s_nop 0
  buffer_load_dwordx4 v8, s[16:19], s70 offen lds
  s_add_u32 m0, s60, 28672
  s_nop 0
  buffer_load_dwordx4 v9, s[16:19], s70 offen lds
  s_add_u32 m0, s60, 32768
  s_nop 0
  buffer_load_dwordx4 v10, s[16:19], s70 offen lds
  s_add_u32 m0, s60, 36864
  s_nop 0
  buffer_load_dwordx4 v11, s[16:19], s70 offen lds
  s_add_u32 m0, s60, 40960
  s_nop 0
  buffer_load_dwordx4 v12, s[16:19], s70 offen lds
  s_add_u32 m0, s60, 45056
  s_nop 0
  buffer_load_dwordx4 v13, s[16:19], s70 offen lds
  s_add_u32 m0, s60, 49152
  s_nop 0
  buffer_load_dwordx4 v14, s[16:19], s70 offen lds
  s_add_u32 m0, s60, 53248
  s_nop 0
  buffer_load_dwordx4 v15, s[16:19], s70 offen lds
  s_add_u32 m0, s60, 57344
  s_nop 0
  buffer_load_dwordx4 v16, s[16:19], s70 offen lds
  s_waitcnt vmcnt(15)
  s_barrier
  ds_read_b64_tr_b16 a[0:1], v26 offset:0
  ds_read_b64_tr_b16 a[2:3], v26 offset:1536
  ds_read_b64_tr_b16 a[4:5], v26 offset:12288
  ds_read_b64_tr_b16 a[6:7], v26 offset:13824
  ds_read_b64_tr_b16 a[8:9], v26 offset:24576
  ds_read_b64_tr_b16 a[10:11], v26 offset:26112
  s_waitcnt lgkmcnt(4)
  ds_read_b64_tr_b16 a[12:13], v26 offset:36864
  ds_read_b64_tr_b16 a[14:15], v26 offset:38400
  ds_read_b64_tr_b16 a[16:17], v26 offset:49152
  ds_read_b64_tr_b16 a[18:19], v26 offset:50688
  s_waitcnt lgkmcnt(4)
  ds_read_b64_tr_b16 a[80:81], v27 offset:0
  ds_read_b64_tr_b16 a[82:83], v27 offset:1536
  ds_read_b64_tr_b16 a[84:85], v27 offset:12288
  ds_read_b64_tr_b16 a[86:87], v27 offset:13824
  ds_read_b64_tr_b16 a[88:89], v27 offset:24576
  ds_read_b64_tr_b16 a[90:91], v27 offset:26112
  s_waitcnt lgkmcnt(4)
  ds_read_b64_tr_b16 a[92:93], v27 offset:36864
  ds_read_b64_tr_b16 a[94:95], v27 offset:38400
  ds_read_b64_tr_b16 a[96:97], v27 offset:49152
  ds_read_b64_tr_b16 a[98:99], v27 offset:50688
  s_waitcnt lgkmcnt(4)
  ds_read_b64_tr_b16 a[160:161], v28 offset:0
  ds_read_b64_tr_b16 a[162:163], v28 offset:1536
  ds_read_b64_tr_b16 a[164:165], v28 offset:12288
  ds_read_b64_tr_b16 a[166:167], v28 offset:13824
  ds_read_b64_tr_b16 a[168:169], v28 offset:24576
  ds_read_b64_tr_b16 a[170:171], v28 offset:26112
  s_waitcnt lgkmcnt(4)
  ds_read_b64_tr_b16 a[172:173], v28 offset:36864
  ds_read_b64_tr_b16 a[174:175], v28 offset:38400
  ds_read_b64_tr_b16 a[176:177], v28 offset:49152
  ds_read_b64_tr_b16 a[178:179], v28 offset:50688
  s_waitcnt lgkmcnt(4)
  s_waitcnt lgkmcnt(0)
  v_add_u32 v26, 61440, v26
  v_add_u32 v27, 61440, v27
  v_add_u32 v28, 61440, v28
  s_barrier
  s_add_u32 s70, s70, 1966080
  s_lshl_b32 s60, s52, 10
  s_add_u32 s60, s60, 0x0
  s_add_u32 m0, s60, 0
  s_nop 0
  buffer_load_dwordx4 v2, s[16:19], s70 offen lds
  s_add_u32 m0, s60, 4096
  s_nop 0
  buffer_load_dwordx4 v3, s[16:19], s70 offen lds
  s_add_u32 m0, s60, 8192
  s_nop 0
  buffer_load_dwordx4 v4, s[16:19], s70 offen lds
  s_add_u32 m0, s60, 12288
  s_nop 0
  buffer_load_dwordx4 v5, s[16:19], s70 offen lds
  s_add_u32 m0, s60, 16384
  s_nop 0
  buffer_load_dwordx4 v6, s[16:19], s70 offen lds
  s_add_u32 m0, s60, 20480
  s_nop 0
  buffer_load_dwordx4 v7, s[16:19], s70 offen lds
  s_add_u32 m0, s60, 24576
  s_nop 0
  buffer_load_dwordx4 v8, s[16:19], s70 offen lds
  s_add_u32 m0, s60, 28672
  s_nop 0
  buffer_load_dwordx4 v9, s[16:19], s70 offen lds
  s_add_u32 m0, s60, 32768
  s_nop 0
  buffer_load_dwordx4 v10, s[16:19], s70 offen lds
  s_add_u32 m0, s60, 36864
  s_nop 0
  buffer_load_dwordx4 v11, s[16:19], s70 offen lds
  s_add_u32 m0, s60, 40960
  s_nop 0
  buffer_load_dwordx4 v12, s[16:19], s70 offen lds
  s_add_u32 m0, s60, 45056
  s_nop 0
  buffer_load_dwordx4 v13, s[16:19], s70 offen lds
  s_add_u32 m0, s60, 49152
  s_nop 0
  buffer_load_dwordx4 v14, s[16:19], s70 offen lds
  s_add_u32 m0, s60, 53248
  s_nop 0
  buffer_load_dwordx4 v15, s[16:19], s70 offen lds
  s_add_u32 m0, s60, 57344
  s_nop 0
  buffer_load_dwordx4 v16, s[16:19], s70 offen lds
  s_waitcnt vmcnt(15)
  s_barrier
  ds_read_b64_tr_b16 a[20:21], v26 offset:0
  ds_read_b64_tr_b16 a[22:23], v26 offset:1536
  ds_read_b64_tr_b16 a[24:25], v26 offset:12288
  ds_read_b64_tr_b16 a[26:27], v26 offset:13824
  ds_read_b64_tr_b16 a[28:29], v26 offset:24576
  ds_read_b64_tr_b16 a[30:31], v26 offset:26112
  s_waitcnt lgkmcnt(4)
  ds_read_b64_tr_b16 a[32:33], v26 offset:36864
  ds_read_b64_tr_b16 a[34:35], v26 offset:38400
  ds_read_b64_tr_b16 a[36:37], v26 offset:49152
  ds_read_b64_tr_b16 a[38:39], v26 offset:50688
  s_waitcnt lgkmcnt(4)
  ds_read_b64_tr_b16 a[100:101], v27 offset:0
  ds_read_b64_tr_b16 a[102:103], v27 offset:1536
  ds_read_b64_tr_b16 a[104:105], v27 offset:12288
  ds_read_b64_tr_b16 a[106:107], v27 offset:13824
  ds_read_b64_tr_b16 a[108:109], v27 offset:24576
  ds_read_b64_tr_b16 a[110:111], v27 offset:26112
  s_waitcnt lgkmcnt(4)
  ds_read_b64_tr_b16 a[112:113], v27 offset:36864
  ds_read_b64_tr_b16 a[114:115], v27 offset:38400
  ds_read_b64_tr_b16 a[116:117], v27 offset:49152
  ds_read_b64_tr_b16 a[118:119], v27 offset:50688
  s_waitcnt lgkmcnt(4)
  ds_read_b64_tr_b16 a[180:181], v28 offset:0
  ds_read_b64_tr_b16 a[182:183], v28 offset:1536
  ds_read_b64_tr_b16 a[184:185], v28 offset:12288
  ds_read_b64_tr_b16 a[186:187], v28 offset:13824
  ds_read_b64_tr_b16 a[188:189], v28 offset:24576
  ds_read_b64_tr_b16 a[190:191], v28 offset:26112
  s_waitcnt lgkmcnt(4)
  ds_read_b64_tr_b16 a[192:193], v28 offset:36864
  ds_read_b64_tr_b16 a[194:195], v28 offset:38400
  ds_read_b64_tr_b16 a[196:197], v28 offset:49152
  ds_read_b64_tr_b16 a[198:199], v28 offset:50688
  s_waitcnt lgkmcnt(4)
  s_waitcnt lgkmcnt(0)
  v_subrev_u32 v26, 61440, v26
  v_subrev_u32 v27, 61440, v27
  v_subrev_u32 v28, 61440, v28
  s_barrier
  s_add_u32 s70, s70, 1966080
  s_lshl_b32 s60, s52, 10
  s_add_u32 s60, s60, 0xf000
  s_add_u32 m0, s60, 0
  s_nop 0
  buffer_load_dwordx4 v2, s[16:19], s70 offen lds
  s_add_u32 m0, s60, 4096
  s_nop 0
  buffer_load_dwordx4 v3, s[16:19], s70 offen lds
  s_add_u32 m0, s60, 8192
  s_nop 0
  buffer_load_dwordx4 v4, s[16:19], s70 offen lds
  s_add_u32 m0, s60, 12288
  s_nop 0
  buffer_load_dwordx4 v5, s[16:19], s70 offen lds
  s_add_u32 m0, s60, 16384
  s_nop 0
  buffer_load_dwordx4 v6, s[16:19], s70 offen lds
  s_add_u32 m0, s60, 20480
  s_nop 0
  buffer_load_dwordx4 v7, s[16:19], s70 offen lds
  s_add_u32 m0, s60, 24576
  s_nop 0
  buffer_load_dwordx4 v8, s[16:19], s70 offen lds
  s_add_u32 m0, s60, 28672
  s_nop 0
  buffer_load_dwordx4 v9, s[16:19], s70 offen lds
  s_add_u32 m0, s60, 32768
  s_nop 0
  buffer_load_dwordx4 v10, s[16:19], s70 offen lds
  s_add_u32 m0, s60, 36864
  s_nop 0
  buffer_load_dwordx4 v11, s[16:19], s70 offen lds
  s_add_u32 m0, s60, 40960
  s_nop 0
  buffer_load_dwordx4 v12, s[16:19], s70 offen lds
  s_add_u32 m0, s60, 45056
  s_nop 0
  buffer_load_dwordx4 v13, s[16:19], s70 offen lds
  s_add_u32 m0, s60, 49152
  s_nop 0
  buffer_load_dwordx4 v14, s[16:19], s70 offen lds
  s_add_u32 m0, s60, 53248
  s_nop 0
  buffer_load_dwordx4 v15, s[16:19], s70 offen lds
  s_add_u32 m0, s60, 57344
  s_nop 0
  buffer_load_dwordx4 v16, s[16:19], s70 offen lds
  s_waitcnt vmcnt(15)
  s_barrier
  ds_read_b64_tr_b16 a[40:41], v26 offset:0
  ds_read_b64_tr_b16 a[42:43], v26 offset:1536
  ds_read_b64_tr_b16 a[44:45], v26 offset:12288
  ds_read_b64_tr_b16 a[46:47], v26 offset:13824
  ds_read_b64_tr_b16 a[48:49], v26 offset:24576
  ds_read_b64_tr_b16 a[50:51], v26 offset:26112
  s_waitcnt lgkmcnt(4)
  ds_read_b64_tr_b16 a[52:53], v26 offset:36864
  ds_read_b64_tr_b16 a[54:55], v26 offset:38400
  ds_read_b64_tr_b16 a[56:57], v26 offset:49152
  ds_read_b64_tr_b16 a[58:59], v26 offset:50688
  s_waitcnt lgkmcnt(4)
  ds_read_b64_tr_b16 a[120:121], v27 offset:0
  ds_read_b64_tr_b16 a[122:123], v27 offset:1536
  ds_read_b64_tr_b16 a[124:125], v27 offset:12288
  ds_read_b64_tr_b16 a[126:127], v27 offset:13824
  ds_read_b64_tr_b16 a[128:129], v27 offset:24576
  ds_read_b64_tr_b16 a[130:131], v27 offset:26112
  s_waitcnt lgkmcnt(4)
  ds_read_b64_tr_b16 a[132:133], v27 offset:36864
  ds_read_b64_tr_b16 a[134:135], v27 offset:38400
  ds_read_b64_tr_b16 a[136:137], v27 offset:49152
  ds_read_b64_tr_b16 a[138:139], v27 offset:50688
  s_waitcnt lgkmcnt(4)
  ds_read_b64_tr_b16 a[200:201], v28 offset:0
  ds_read_b64_tr_b16 a[202:203], v28 offset:1536
  ds_read_b64_tr_b16 a[204:205], v28 offset:12288
  ds_read_b64_tr_b16 a[206:207], v28 offset:13824
  ds_read_b64_tr_b16 a[208:209], v28 offset:24576
  ds_read_b64_tr_b16 a[210:211], v28 offset:26112
  s_waitcnt lgkmcnt(4)
  ds_read_b64_tr_b16 a[212:213], v28 offset:36864
  ds_read_b64_tr_b16 a[214:215], v28 offset:38400
  ds_read_b64_tr_b16 a[216:217], v28 offset:49152
  ds_read_b64_tr_b16 a[218:219], v28 offset:50688
  s_waitcnt lgkmcnt(4)
  s_waitcnt lgkmcnt(0)
  v_add_u32 v26, 61440, v26
  v_add_u32 v27, 61440, v27
  v_add_u32 v28, 61440, v28
  s_barrier
  s_waitcnt vmcnt(0)
  s_barrier
  ds_read_b64_tr_b16 a[60:61], v26 offset:0
  ds_read_b64_tr_b16 a[62:63], v26 offset:1536
  ds_read_b64_tr_b16 a[64:65], v26 offset:12288
  ds_read_b64_tr_b16 a[66:67], v26 offset:13824
  ds_read_b64_tr_b16 a[68:69], v26 offset:24576
  ds_read_b64_tr_b16 a[70:71], v26 offset:26112
  s_waitcnt lgkmcnt(4)
  ds_read_b64_tr_b16 a[72:73], v26 offset:36864
  ds_read_b64_tr_b16 a[74:75], v26 offset:38400
  ds_read_b64_tr_b16 a[76:77], v26 offset:49152
  ds_read_b64_tr_b16 a[78:79], v26 offset:50688
  s_waitcnt lgkmcnt(4)
  ds_read_b64_tr_b16 a[140:141], v27 offset:0
  ds_read_b64_tr_b16 a[142:143], v27 offset:1536
  ds_read_b64_tr_b16 a[144:145], v27 offset:12288
  ds_read_b64_tr_b16 a[146:147], v27 offset:13824
  ds_read_b64_tr_b16 a[148:149], v27 offset:24576
  ds_read_b64_tr_b16 a[150:151], v27 offset:26112
  s_waitcnt lgkmcnt(4)
  ds_read_b64_tr_b16 a[152:153], v27 offset:36864
  ds_read_b64_tr_b16 a[154:155], v27 offset:38400
  ds_read_b64_tr_b16 a[156:157], v27 offset:49152
  ds_read_b64_tr_b16 a[158:159], v27 offset:50688
  s_waitcnt lgkmcnt(4)
  ds_read_b64_tr_b16 a[220:221], v28 offset:0
  ds_read_b64_tr_b16 a[222:223], v28 offset:1536
  ds_read_b64_tr_b16 a[224:225], v28 offset:12288
  ds_read_b64_tr_b16 a[226:227], v28 offset:13824
  ds_read_b64_tr_b16 a[228:229], v28 offset:24576
  ds_read_b64_tr_b16 a[230:231], v28 offset:26112
  s_waitcnt lgkmcnt(4)
  ds_read_b64_tr_b16 a[232:233], v28 offset:36864
  ds_read_b64_tr_b16 a[234:235], v28 offset:38400
  ds_read_b64_tr_b16 a[236:237], v28 offset:49152
  ds_read_b64_tr_b16 a[238:239], v28 offset:50688
  s_waitcnt lgkmcnt(4)
  s_waitcnt lgkmcnt(0)
  v_subrev_u32 v26, 61440, v26
  v_subrev_u32 v27, 61440, v27
  v_subrev_u32 v28, 61440, v28
  s_barrier
  s_mov_b32 s56, 0
  v_mov_b32 v20, 128
iw_7052:
  buffer_load_dwordx2 v[18:19], v20, s[44:47], 0 offen sc1
  s_waitcnt vmcnt(0)
  v_readfirstlane_b32 s58, v18
  v_readfirstlane_b32 s59, v19
  s_cmp_lg_u32 s59, 0
  s_cbranch_scc1 L_to_irregular
  s_cmpk_ge_u32 s58, 256
  s_cbranch_scc1 iwd_7053
  s_cmp_lg_u32 s55, 0
  s_cbranch_scc1 iwd_7053
  s_add_u32 s56, s56, 1
  s_cmp_lt_u32 s56, 0x20000
  s_cbranch_scc1 iw_7052
  s_mov_b32 s55, 1
iwd_7053:
  s_mov_b32 s71, 0xfffe2000
  s_mul_i32 s58, s52, 3072
  v_lshlrev_b32 v25, 4, v1
  v_add_u32 v25, s58, v25
  s_mul_i32 s66, s69, 12288
  s_add_u32 s66, s66, 0x1a00000
  s_lshl_b32 s58, s69, 8
  s_add_u32 s58, s58, 0
  v_mov_b32 v29, s58
  s_mov_b32 s62, 0
L_t1_kr:
  s_waitcnt vmcnt(3)
  s_cmp_lg_u32 s62, 1
  s_cbranch_scc1 t1w_7054
  s_waitcnt vmcnt(0)
t1w_7054:
  s_barrier
  s_cmp_lg_u32 s52, 0
  s_cbranch_scc1 t1f_7055
  s_cmp_lt_u32 s62, 1
  s_cbranch_scc1 t1f_7055
  s_sub_u32 s58, s62, 1
  s_max_u32 s58, s58, 1
  v_mov_b32 v18, s58
  s_mov_b64 exec, 1
  buffer_store_dword v18, v29, s[48:51], 0 offen sc1
  s_mov_b64 exec, -1
t1f_7055:
  s_cmp_lt_u32 s62, 63
  s_cselect_b32 s58, 40960, 0
  s_add_u32 s64, s64, s58
  s_add_u32 s65, s65, s71
  ds_read_b128 v[32:35], v102 offset:0
  ds_read_b128 v[36:39], v102 offset:20480
  ds_read_b128 v[40:43], v103 offset:0
  ds_read_b128 v[44:47], v103 offset:20480
  ds_read_b128 v[48:51], v104 offset:0
  ds_read_b128 v[52:55], v104 offset:20480
  s_waitcnt lgkmcnt(4)
  v_mfma_f32_16x16x32_bf16 v[56:59], a[0:3], v[32:35], 0
  v_mfma_f32_16x16x32_bf16 v[64:67], a[80:83], v[32:35], 0
  v_mfma_f32_16x16x32_bf16 v[72:75], a[160:163], v[32:35], 0
  v_mfma_f32_16x16x32_bf16 v[60:63], a[0:3], v[36:39], 0
  v_mfma_f32_16x16x32_bf16 v[68:71], a[80:83], v[36:39], 0
  v_mfma_f32_16x16x32_bf16 v[76:79], a[160:163], v[36:39], 0
  ds_read_b128 v[32:35], v105 offset:0
  ds_read_b128 v[36:39], v105 offset:20480
  s_waitcnt lgkmcnt(4)
  v_mfma_f32_16x16x32_bf16 v[56:59], a[4:7], v[40:43], v[56:59]
  s_add_u32 m0, s65, 0
  s_nop 0
  buffer_load_dwordx4 v92, s[4:7], s64 offen lds
  v_mfma_f32_16x16x32_bf16 v[64:67], a[84:87], v[40:43], v[64:67]
  v_mfma_f32_16x16x32_bf16 v[72:75], a[164:167], v[40:43], v[72:75]
  v_mfma_f32_16x16x32_bf16 v[60:63], a[4:7], v[44:47], v[60:63]
  v_mfma_f32_16x16x32_bf16 v[68:71], a[84:87], v[44:47], v[68:71]
  v_mfma_f32_16x16x32_bf16 v[76:79], a[164:167], v[44:47], v[76:79]
  ds_read_b128 v[40:43], v102 offset:256
  ds_read_b128 v[44:47], v102 offset:20736
  s_waitcnt lgkmcnt(4)
  v_mfma_f32_16x16x32_bf16 v[56:59], a[8:11], v[48:51], v[56:59]
  v_mfma_f32_16x16x32_bf16 v[64:67], a[88:91], v[48:51], v[64:67]
  v_mfma_f32_16x16x32_bf16 v[72:75], a[168:171], v[48:51], v[72:75]
  v_mfma_f32_16x16x32_bf16 v[60:63], a[8:11], v[52:55], v[60:63]
  v_mfma_f32_16x16x32_bf16 v[68:71], a[88:91], v[52:55], v[68:71]
  s_add_u32 m0, s65, 1024
  s_nop 0
  buffer_load_dwordx4 v93, s[4:7], s64 offen lds
  v_mfma_f32_16x16x32_bf16 v[76:79], a[168:171], v[52:55], v[76:79]
  ds_read_b128 v[48:51], v103 offset:256
  ds_read_b128 v[52:55], v103 offset:20736
  s_waitcnt lgkmcnt(4)
  v_mfma_f32_16x16x32_bf16 v[56:59], a[12:15], v[32:35], v[56:59]
  v_mfma_f32_16x16x32_bf16 v[64:67], a[92:95], v[32:35], v[64:67]
  v_mfma_f32_16x16x32_bf16 v[72:75], a[172:175], v[32:35], v[72:75]
  v_mfma_f32_16x16x32_bf16 v[60:63], a[12:15], v[36:39], v[60:63]
  v_mfma_f32_16x16x32_bf16 v[68:71], a[92:95], v[36:39], v[68:71]
  v_mfma_f32_16x16x32_bf16 v[76:79], a[172:175], v[36:39], v[76:79]
  ds_read_b128 v[32:35], v104 offset:256
  ds_read_b128 v[36:39], v104 offset:20736
  s_waitcnt lgkmcnt(4)
  v_mfma_f32_16x16x32_bf16 v[56:59], a[16:19], v[40:43], v[56:59]
  v_mfma_f32_16x16x32_bf16 v[64:67], a[96:99], v[40:43], v[64:67]
  v_mfma_f32_16x16x32_bf16 v[72:75], a[176:179], v[40:43], v[72:75]
  s_add_u32 m0, s65, 2048
  s_nop 0
  buffer_load_dwordx4 v94, s[4:7], s64 offen lds
  v_mfma_f32_16x16x32_bf16 v[60:63], a[16:19], v[44:47], v[60:63]
  v_mfma_f32_16x16x32_bf16 v[68:71], a[96:99], v[44:47], v[68:71]
  v_mfma_f32_16x16x32_bf16 v[76:79], a[176:179], v[44:47], v[76:79]
  ds_read_b128 v[40:43], v105 offset:256
  ds_read_b128 v[44:47], v105 offset:20736
  s_waitcnt lgkmcnt(4)
  v_mfma_f32_16x16x32_bf16 v[56:59], a[20:23], v[48:51], v[56:59]
  v_mfma_f32_16x16x32_bf16 v[64:67], a[100:103], v[48:51], v[64:67]
  v_mfma_f32_16x16x32_bf16 v[72:75], a[180:183], v[48:51], v[72:75]
  v_mfma_f32_16x16x32_bf16 v[60:63], a[20:23], v[52:55], v[60:63]
  v_mfma_f32_16x16x32_bf16 v[68:71], a[100:103], v[52:55], v[68:71]
  v_mfma_f32_16x16x32_bf16 v[76:79], a[180:183], v[52:55], v[76:79]
  ds_read_b128 v[48:51], v102 offset:512
  ds_read_b128 v[52:55], v102 offset:20992
  s_waitcnt lgkmcnt(4)
  v_mfma_f32_16x16x32_bf16 v[56:59], a[24:27], v[32:35], v[56:59]
  s_add_u32 m0, s65, 3072
  s_nop 0
  buffer_load_dwordx4 v95, s[4:7], s64 offen lds
  v_mfma_f32_16x16x32_bf16 v[64:67], a[104:107], v[32:35], v[64:67]
  v_mfma_f32_16x16x32_bf16 v[72:75], a[184:187], v[32:35], v[72:75]
  v_mfma_f32_16x16x32_bf16 v[60:63], a[24:27], v[36:39], v[60:63]
  v_mfma_f32_16x16x32_bf16 v[68:71], a[104:107], v[36:39], v[68:71]
  v_mfma_f32_16x16x32_bf16 v[76:79], a[184:187], v[36:39], v[76:79]
  ds_read_b128 v[32:35], v103 offset:512
  ds_read_b128 v[36:39], v103 offset:20992
  s_waitcnt lgkmcnt(4)
  v_mfma_f32_16x16x32_bf16 v[56:59], a[28:31], v[40:43], v[56:59]
  v_mfma_f32_16x16x32_bf16 v[64:67], a[108:111], v[40:43], v[64:67]
  v_mfma_f32_16x16x32_bf16 v[72:75], a[188:191], v[40:43], v[72:75]
  v_mfma_f32_16x16x32_bf16 v[60:63], a[28:31], v[44:47], v[60:63]
  v_mfma_f32_16x16x32_bf16 v[68:71], a[108:111], v[44:47], v[68:71]
  s_add_u32 m0, s65, 4096
  s_nop 0
  buffer_load_dwordx4 v96, s[4:7], s64 offen lds
  v_mfma_f32_16x16x32_bf16 v[76:79], a[188:191], v[44:47], v[76:79]
  ds_read_b128 v[40:43], v104 offset:512
  ds_read_b128 v[44:47], v104 offset:20992
  s_waitcnt lgkmcnt(4)
  v_mfma_f32_16x16x32_bf16 v[56:59], a[32:35], v[48:51], v[56:59]
  v_mfma_f32_16x16x32_bf16 v[64:67], a[112:115], v[48:51], v[64:67]
  v_mfma_f32_16x16x32_bf16 v[72:75], a[192:195], v[48:51], v[72:75]
  v_mfma_f32_16x16x32_bf16 v[60:63], a[32:35], v[52:55], v[60:63]
  v_mfma_f32_16x16x32_bf16 v[68:71], a[112:115], v[52:55], v[68:71]
  v_mfma_f32_16x16x32_bf16 v[76:79], a[192:195], v[52:55], v[76:79]
  ds_read_b128 v[48:51], v105 offset:512
  ds_read_b128 v[52:55], v105 offset:20992
  s_waitcnt lgkmcnt(4)
  v_mfma_f32_16x16x32_bf16 v[56:59], a[36:39], v[32:35], v[56:59]
  v_mfma_f32_16x16x32_bf16 v[64:67], a[116:119], v[32:35], v[64:67]
  v_mfma_f32_16x16x32_bf16 v[72:75], a[196:199], v[32:35], v[72:75]
  s_add_u32 m0, s65, 5120
  s_nop 0
  buffer_load_dwordx4 v97, s[4:7], s64 offen lds
  v_mfma_f32_16x16x32_bf16 v[60:63], a[36:39], v[36:39], v[60:63]
  v_mfma_f32_16x16x32_bf16 v[68:71], a[116:119], v[36:39], v[68:71]
  v_mfma_f32_16x16x32_bf16 v[76:79], a[196:199], v[36:39], v[76:79]
  ds_read_b128 v[32:35], v102 offset:768
  ds_read_b128 v[36:39], v102 offset:21248
  s_waitcnt lgkmcnt(4)
  v_mfma_f32_16x16x32_bf16 v[56:59], a[40:43], v[40:43], v[56:59]
  v_mfma_f32_16x16x32_bf16 v[64:67], a[120:123], v[40:43], v[64:67]
  v_mfma_f32_16x16x32_bf16 v[72:75], a[200:203], v[40:43], v[72:75]
  v_mfma_f32_16x16x32_bf16 v[60:63], a[40:43], v[44:47], v[60:63]
  v_mfma_f32_16x16x32_bf16 v[68:71], a[120:123], v[44:47], v[68:71]
  v_mfma_f32_16x16x32_bf16 v[76:79], a[200:203], v[44:47], v[76:79]
  ds_read_b128 v[40:43], v103 offset:768
  ds_read_b128 v[44:47], v103 offset:21248
  s_waitcnt lgkmcnt(4)
  v_mfma_f32_16x16x32_bf16 v[56:59], a[44:47], v[48:51], v[56:59]
  s_add_u32 m0, s65, 6144
  s_nop 0
  buffer_load_dwordx4 v98, s[4:7], s64 offen lds
  v_mfma_f32_16x16x32_bf16 v[64:67], a[124:127], v[48:51], v[64:67]
  v_mfma_f32_16x16x32_bf16 v[72:75], a[204:207], v[48:51], v[72:75]
  v_mfma_f32_16x16x32_bf16 v[60:63], a[44:47], v[52:55], v[60:63]
  v_mfma_f32_16x16x32_bf16 v[68:71], a[124:127], v[52:55], v[68:71]
  v_mfma_f32_16x16x32_bf16 v[76:79], a[204:207], v[52:55], v[76:79]
  ds_read_b128 v[48:51], v104 offset:768
  ds_read_b128 v[52:55], v104 offset:21248
  s_waitcnt lgkmcnt(4)
  v_mfma_f32_16x16x32_bf16 v[56:59], a[48:51], v[32:35], v[56:59]
  v_mfma_f32_16x16x32_bf16 v[64:67], a[128:131], v[32:35], v[64:67]
  v_mfma_f32_16x16x32_bf16 v[72:75], a[208:211], v[32:35], v[72:75]
  v_mfma_f32_16x16x32_bf16 v[60:63], a[48:51], v[36:39], v[60:63]
  v_mfma_f32_16x16x32_bf16 v[68:71], a[128:131], v[36:39], v[68:71]
  s_add_u32 m0, s65, 7168
  s_nop 0
  buffer_load_dwordx4 v99, s[4:7], s64 offen lds
  v_mfma_f32_16x16x32_bf16 v[76:79], a[208:211], v[36:39], v[76:79]
  ds_read_b128 v[32:35], v105 offset:768
  ds_read_b128 v[36:39], v105 offset:21248
  s_waitcnt lgkmcnt(4)
  v_mfma_f32_16x16x32_bf16 v[56:59], a[52:55], v[40:43], v[56:59]
  v_mfma_f32_16x16x32_bf16 v[64:67], a[132:135], v[40:43], v[64:67]
  v_mfma_f32_16x16x32_bf16 v[72:75], a[212:215], v[40:43], v[72:75]
  v_mfma_f32_16x16x32_bf16 v[60:63], a[52:55], v[44:47], v[60:63]
  v_mfma_f32_16x16x32_bf16 v[68:71], a[132:135], v[44:47], v[68:71]
  v_mfma_f32_16x16x32_bf16 v[76:79], a[212:215], v[44:47], v[76:79]
  ds_read_b128 v[40:43], v102 offset:1024
  ds_read_b128 v[44:47], v102 offset:21504
  s_waitcnt lgkmcnt(4)
  v_mfma_f32_16x16x32_bf16 v[56:59], a[56:59], v[48:51], v[56:59]
  v_mfma_f32_16x16x32_bf16 v[64:67], a[136:139], v[48:51], v[64:67]
  v_mfma_f32_16x16x32_bf16 v[72:75], a[216:219], v[48:51], v[72:75]
  s_add_u32 m0, s65, 8192
  s_nop 0
  buffer_load_dwordx4 v100, s[4:7], s64 offen lds
  v_mfma_f32_16x16x32_bf16 v[60:63], a[56:59], v[52:55], v[60:63]
  v_mfma_f32_16x16x32_bf16 v[68:71], a[136:139], v[52:55], v[68:71]
  v_mfma_f32_16x16x32_bf16 v[76:79], a[216:219], v[52:55], v[76:79]
  ds_read_b128 v[48:51], v103 offset:1024
  ds_read_b128 v[52:55], v103 offset:21504
  s_waitcnt lgkmcnt(4)
  v_mfma_f32_16x16x32_bf16 v[56:59], a[60:63], v[32:35], v[56:59]
  v_mfma_f32_16x16x32_bf16 v[64:67], a[140:143], v[32:35], v[64:67]
  v_mfma_f32_16x16x32_bf16 v[72:75], a[220:223], v[32:35], v[72:75]
  v_mfma_f32_16x16x32_bf16 v[60:63], a[60:63], v[36:39], v[60:63]
  v_mfma_f32_16x16x32_bf16 v[68:71], a[140:143], v[36:39], v[68:71]
  v_mfma_f32_16x16x32_bf16 v[76:79], a[220:223], v[36:39], v[76:79]
  ds_read_b128 v[32:35], v104 offset:1024
  ds_read_b128 v[36:39], v104 offset:21504
  s_waitcnt lgkmcnt(4)
  v_mfma_f32_16x16x32_bf16 v[56:59], a[64:67], v[40:43], v[56:59]
  s_add_u32 m0, s65, 9216
  s_nop 0
  buffer_load_dwordx4 v101, s[4:7], s64 offen lds
  v_mfma_f32_16x16x32_bf16 v[64:67], a[144:147], v[40:43], v[64:67]
  v_mfma_f32_16x16x32_bf16 v[72:75], a[224:227], v[40:43], v[72:75]
  v_mfma_f32_16x16x32_bf16 v[60:63], a[64:67], v[44:47], v[60:63]
  v_mfma_f32_16x16x32_bf16 v[68:71], a[144:147], v[44:47], v[68:71]
  v_mfma_f32_16x16x32_bf16 v[76:79], a[224:227], v[44:47], v[76:79]
  ds_read_b128 v[40:43], v105 offset:1024
  ds_read_b128 v[44:47], v105 offset:21504
  s_waitcnt lgkmcnt(4)
  v_mfma_f32_16x16x32_bf16 v[56:59], a[68:71], v[48:51], v[56:59]
  v_mfma_f32_16x16x32_bf16 v[64:67], a[148:151], v[48:51], v[64:67]
  v_mfma_f32_16x16x32_bf16 v[72:75], a[228:231], v[48:51], v[72:75]
  v_mfma_f32_16x16x32_bf16 v[60:63], a[68:71], v[52:55], v[60:63]
  v_mfma_f32_16x16x32_bf16 v[68:71], a[148:151], v[52:55], v[68:71]
  v_mfma_f32_16x16x32_bf16 v[76:79], a[228:231], v[52:55], v[76:79]
  s_waitcnt lgkmcnt(2)
  v_mfma_f32_16x16x32_bf16 v[56:59], a[72:75], v[32:35], v[56:59]
  v_mfma_f32_16x16x32_bf16 v[64:67], a[152:155], v[32:35], v[64:67]
  v_mfma_f32_16x16x32_bf16 v[72:75], a[232:235], v[32:35], v[72:75]
  v_mfma_f32_16x16x32_bf16 v[60:63], a[72:75], v[36:39], v[60:63]
  v_mfma_f32_16x16x32_bf16 v[68:71], a[152:155], v[36:39], v[68:71]
  v_mfma_f32_16x16x32_bf16 v[76:79], a[232:235], v[36:39], v[76:79]
  s_waitcnt lgkmcnt(0)
  v_mfma_f32_16x16x32_bf16 v[56:59], a[76:79], v[40:43], v[56:59]
  v_mfma_f32_16x16x32_bf16 v[64:67], a[156:159], v[40:43], v[64:67]
  v_mfma_f32_16x16x32_bf16 v[72:75], a[236:239], v[40:43], v[72:75]
  v_mfma_f32_16x16x32_bf16 v[60:63], a[76:79], v[44:47], v[60:63]
  v_mfma_f32_16x16x32_bf16 v[68:71], a[156:159], v[44:47], v[68:71]
  v_mfma_f32_16x16x32_bf16 v[76:79], a[236:239], v[44:47], v[76:79]
  v_add_u32 v102, s71, v102
  v_add_u32 v103, s71, v103
  v_add_u32 v104, s71, v104
  v_add_u32 v105, s71, v105
  s_sub_u32 s71, 0, s71
  s_nop 2
  v_cvt_pk_bf16_f32 v80, v56, v57
  v_cvt_pk_bf16_f32 v81, v58, v59
  v_cvt_pk_bf16_f32 v82, v60, v61
  v_cvt_pk_bf16_f32 v83, v62, v63
  buffer_store_dwordx4 v[80:83], v25, s[48:51], s66 offen offset:0 sc1
  v_cvt_pk_bf16_f32 v84, v64, v65
  v_cvt_pk_bf16_f32 v85, v66, v67
  v_cvt_pk_bf16_f32 v86, v68, v69
  v_cvt_pk_bf16_f32 v87, v70, v71
  buffer_store_dwordx4 v[84:87], v25, s[48:51], s66 offen offset:1024 sc1
  v_cvt_pk_bf16_f32 v88, v72, v73
  v_cvt_pk_bf16_f32 v89, v74, v75
  v_cvt_pk_bf16_f32 v90, v76, v77
  v_cvt_pk_bf16_f32 v91, v78, v79
  buffer_store_dwordx4 v[88:91], v25, s[48:51], s66 offen offset:2048 sc1
  s_add_u32 s66, s66, 393216
  s_add_u32 s62, s62, 1
  s_cmp_lt_u32 s62, 64
  s_cbranch_scc1 L_t1_kr
  s_waitcnt vmcnt(0)
  s_barrier
  s_cmp_lg_u32 s52, 0
  s_cbranch_scc1 t1e_7056
  v_mov_b32 v18, 64
  s_mov_b64 exec, 1
  buffer_store_dword v18, v29, s[48:51], 0 offen sc1
  s_mov_b64 exec, -1
t1e_7056:
  s_branch L_t1done_r
L_t1v_r:
  v_and_b32 v1, 63, v0
  s_mul_i32 s58, s52, 640
  s_add_u32 s59, s58, 0
  v_add_u32 v18, s59, v1
  v_mul_u32_u24 v19, 3277, v18
  v_lshrrev_b32 v19, 18, v19
  v_mul_u32_u24 v20, 80, v19
  v_sub_u32 v18, v18, v20
  v_and_b32 v20, 15, v19
  v_xor_b32 v18, v18, v20
  v_lshlrev_b32 v18, 4, v18
  v_mul_u32_u24 v19, 1280, v19
  v_add_u32 v92, v18, v19
  s_add_u32 s59, s58, 64
  v_add_u32 v18, s59, v1
  v_mul_u32_u24 v19, 3277, v18
  v_lshrrev_b32 v19, 18, v19
  v_mul_u32_u24 v20, 80, v19
  v_sub_u32 v18, v18, v20
  v_and_b32 v20, 15, v19
  v_xor_b32 v18, v18, v20
  v_lshlrev_b32 v18, 4, v18
  v_mul_u32_u24 v19, 1280, v19
  v_add_u32 v93, v18, v19
  s_add_u32 s59, s58, 128
  v_add_u32 v18, s59, v1
  v_mul_u32_u24 v19, 3277, v18
  v_lshrrev_b32 v19, 18, v19
  v_mul_u32_u24 v20, 80, v19
  v_sub_u32 v18, v18, v20
  v_and_b32 v20, 15, v19
  v_xor_b32 v18, v18, v20
  v_lshlrev_b32 v18, 4, v18
  v_mul_u32_u24 v19, 1280, v19
  v_add_u32 v94, v18, v19
  s_add_u32 s59, s58, 192
  v_add_u32 v18, s59, v1
  v_mul_u32_u24 v19, 3277, v18
  v_lshrrev_b32 v19, 18, v19
  v_mul_u32_u24 v20, 80, v19
  v_sub_u32 v18, v18, v20
  v_and_b32 v20, 15, v19
  v_xor_b32 v18, v18, v20
  v_lshlrev_b32 v18, 4, v18
  v_mul_u32_u24 v19, 1280, v19
  v_add_u32 v95, v18, v19
  s_add_u32 s59, s58, 256
  v_add_u32 v18, s59, v1
  v_mul_u32_u24 v19, 3277, v18
  v_lshrrev_b32 v19, 18, v19
  v_mul_u32_u24 v20, 80, v19
  v_sub_u32 v18, v18, v20
  v_and_b32 v20, 15, v19
  v_xor_b32 v18, v18, v20
  v_lshlrev_b32 v18, 4, v18
  v_mul_u32_u24 v19, 1280, v19
  v_add_u32 v96, v18, v19
  s_add_u32 s59, s58, 320
  v_add_u32 v18, s59, v1
  v_mul_u32_u24 v19, 3277, v18
  v_lshrrev_b32 v19, 18, v19
  v_mul_u32_u24 v20, 80, v19
  v_sub_u32 v18, v18, v20
  v_and_b32 v20, 15, v19
  v_xor_b32 v18, v18, v20
  v_lshlrev_b32 v18, 4, v18
  v_mul_u32_u24 v19, 1280, v19
  v_add_u32 v97, v18, v19
  s_add_u32 s59, s58, 384
  v_add_u32 v18, s59, v1
  v_mul_u32_u24 v19, 3277, v18
  v_lshrrev_b32 v19, 18, v19
  v_mul_u32_u24 v20, 80, v19
  v_sub_u32 v18, v18, v20
  v_and_b32 v20, 15, v19
  v_xor_b32 v18, v18, v20
  v_lshlrev_b32 v18, 4, v18
  v_mul_u32_u24 v19, 1280, v19
  v_add_u32 v98, v18, v19
  s_add_u32 s59, s58, 448
  v_add_u32 v18, s59, v1
  v_mul_u32_u24 v19, 3277, v18
  v_lshrrev_b32 v19, 18, v19
  v_mul_u32_u24 v20, 80, v19
  v_sub_u32 v18, v18, v20
  v_and_b32 v20, 15, v19
  v_xor_b32 v18, v18, v20
  v_lshlrev_b32 v18, 4, v18
  v_mul_u32_u24 v19, 1280, v19
  v_add_u32 v99, v18, v19
  s_add_u32 s59, s58, 512
  v_add_u32 v18, s59, v1
  v_mul_u32_u24 v19, 3277, v18
  v_lshrrev_b32 v19, 18, v19
  v_mul_u32_u24 v20, 80, v19
  v_sub_u32 v18, v18, v20
  v_and_b32 v20, 15, v19
  v_xor_b32 v18, v18, v20
  v_lshlrev_b32 v18, 4, v18
  v_mul_u32_u24 v19, 1280, v19
  v_add_u32 v100, v18, v19
  s_add_u32 s59, s58, 576
  v_add_u32 v18, s59, v1
  v_mul_u32_u24 v19, 3277, v18
  v_lshrrev_b32 v19, 18, v19
  v_mul_u32_u24 v20, 80, v19
  v_sub_u32 v18, v18, v20
  v_and_b32 v20, 15, v19
  v_xor_b32 v18, v18, v20
  v_lshlrev_b32 v18, 4, v18
  v_mul_u32_u24 v19, 1280, v19
  v_add_u32 v101, v18, v19
  v_and_b32 v18, 15, v1
  v_lshrrev_b32 v19, 4, v1
  v_xor_b32 v19, v19, v18
  v_mul_u32_u24 v18, 1280, v18
  v_add_u32 v18, 0x1e000, v18
  v_xor_b32 v20, 0, v19
  v_lshlrev_b32 v20, 4, v20
  v_add_u32 v102, v18, v20
  v_xor_b32 v20, 4, v19
  v_lshlrev_b32 v20, 4, v20
  v_add_u32 v103, v18, v20
  v_xor_b32 v20, 8, v19
  v_lshlrev_b32 v20, 4, v20
  v_add_u32 v104, v18, v20
  v_xor_b32 v20, 12, v19
  v_lshlrev_b32 v20, 4, v20
  v_add_u32 v105, v18, v20
  v_lshrrev_b32 v18, 4, v1
  v_lshrrev_b32 v19, 2, v1
  v_and_b32 v19, 3, v19
  v_lshlrev_b32 v20, 3, v18
  v_add_u32 v20, v20, v19
  v_mul_u32_u24 v20, 384, v20
  v_and_b32 v21, 3, v1
  v_lshlrev_b32 v21, 3, v21
  v_add_u32 v20, v20, v21
  v_lshrrev_b32 v19, 1, v19
  v_and_b32 v18, 1, v18
  v_lshlrev_b32 v18, 1, v18
  v_or_b32 v18, v18, v19
  s_mul_i32 s58, s52, 3
  s_add_u32 s59, s58, 0
  v_xor_b32 v19, s59, v18
  v_lshlrev_b32 v19, 5, v19
  v_add_u32 v26, v19, v20
  s_add_u32 s59, s58, 1
  v_xor_b32 v19, s59, v18
  v_lshlrev_b32 v19, 5, v19
  v_add_u32 v27, v19, v20
  s_add_u32 s59, s58, 2
  v_xor_b32 v19, s59, v18
  v_lshlrev_b32 v19, 5, v19
  v_add_u32 v28, v19, v20
  s_mul_i32 s67, s69, 384
  s_mov_b32 s64, 0
  s_mul_i32 s65, s52, 10240
  s_add_u32 s65, s65, 122880
  v_mov_b32 v18, v0
  v_mul_u32_u24 v19, 2731, v18
  v_lshrrev_b32 v19, 16, v19
  v_mul_u32_u24 v20, 24, v19
  v_sub_u32 v18, v18, v20
  v_and_b32 v20, 2, v19
  v_lshrrev_b32 v21, 1, v19
  v_and_b32 v21, 4, v21
  v_or_b32 v20, v20, v21
  v_xor_b32 v18, v18, v20
  v_mul_u32_u24 v19, 12288, v19
  v_lshlrev_b32 v18, 4, v18
  v_add_u32 v2, v18, v19
  v_add_u32 v18, 256, v0
  v_mul_u32_u24 v19, 2731, v18
  v_lshrrev_b32 v19, 16, v19
  v_mul_u32_u24 v20, 24, v19
  v_sub_u32 v18, v18, v20
  v_and_b32 v20, 2, v19
  v_lshrrev_b32 v21, 1, v19
  v_and_b32 v21, 4, v21
  v_or_b32 v20, v20, v21
  v_xor_b32 v18, v18, v20
  v_mul_u32_u24 v19, 12288, v19
  v_lshlrev_b32 v18, 4, v18
  v_add_u32 v3, v18, v19
  v_add_u32 v18, 512, v0
  v_mul_u32_u24 v19, 2731, v18
  v_lshrrev_b32 v19, 16, v19
  v_mul_u32_u24 v20, 24, v19
  v_sub_u32 v18, v18, v20
  v_and_b32 v20, 2, v19
  v_lshrrev_b32 v21, 1, v19
  v_and_b32 v21, 4, v21
  v_or_b32 v20, v20, v21
  v_xor_b32 v18, v18, v20
  v_mul_u32_u24 v19, 12288, v19
  v_lshlrev_b32 v18, 4, v18
  v_add_u32 v4, v18, v19
  v_add_u32 v18, 768, v0
  v_mul_u32_u24 v19, 2731, v18
  v_lshrrev_b32 v19, 16, v19
  v_mul_u32_u24 v20, 24, v19
  v_sub_u32 v18, v18, v20
  v_and_b32 v20, 2, v19
  v_lshrrev_b32 v21, 1, v19
  v_and_b32 v21, 4, v21
  v_or_b32 v20, v20, v21
  v_xor_b32 v18, v18, v20
  v_mul_u32_u24 v19, 12288, v19
  v_lshlrev_b32 v18, 4, v18
  v_add_u32 v5, v18, v19
  v_add_u32 v18, 1024, v0
  v_mul_u32_u24 v19, 2731, v18
  v_lshrrev_b32 v19, 16, v19
  v_mul_u32_u24 v20, 24, v19
  v_sub_u32 v18, v18, v20
  v_and_b32 v20, 2, v19
  v_lshrrev_b32 v21, 1, v19
  v_and_b32 v21, 4, v21
  v_or_b32 v20, v20, v21
  v_xor_b32 v18, v18, v20
  v_mul_u32_u24 v19, 12288, v19
  v_lshlrev_b32 v18, 4, v18
  v_add_u32 v6, v18, v19
  v_add_u32 v18, 1280, v0
  v_mul_u32_u24 v19, 2731, v18
  v_lshrrev_b32 v19, 16, v19
  v_mul_u32_u24 v20, 24, v19
  v_sub_u32 v18, v18, v20
  v_and_b32 v20, 2, v19
  v_lshrrev_b32 v21, 1, v19
  v_and_b32 v21, 4, v21
  v_or_b32 v20, v20, v21
  v_xor_b32 v18, v18, v20
  v_mul_u32_u24 v19, 12288, v19
  v_lshlrev_b32 v18, 4, v18
  v_add_u32 v7, v18, v19
  v_add_u32 v18, 1536, v0
  v_mul_u32_u24 v19, 2731, v18
  v_lshrrev_b32 v19, 16, v19
  v_mul_u32_u24 v20, 24, v19
  v_sub_u32 v18, v18, v20
  v_and_b32 v20, 2, v19
  v_lshrrev_b32 v21, 1, v19
  v_and_b32 v21, 4, v21
  v_or_b32 v20, v20, v21
  v_xor_b32 v18, v18, v20
  v_mul_u32_u24 v19, 12288, v19
  v_lshlrev_b32 v18, 4, v18
  v_add_u32 v8, v18, v19
  v_add_u32 v18, 1792, v0
  v_mul_u32_u24 v19, 2731, v18
  v_lshrrev_b32 v19, 16, v19
  v_mul_u32_u24 v20, 24, v19
  v_sub_u32 v18, v18, v20
  v_and_b32 v20, 2, v19
  v_lshrrev_b32 v21, 1, v19
  v_and_b32 v21, 4, v21
  v_or_b32 v20, v20, v21
  v_xor_b32 v18, v18, v20
  v_mul_u32_u24 v19, 12288, v19
  v_lshlrev_b32 v18, 4, v18
  v_add_u32 v9, v18, v19
  v_add_u32 v18, 2048, v0
  v_mul_u32_u24 v19, 2731, v18
  v_lshrrev_b32 v19, 16, v19
  v_mul_u32_u24 v20, 24, v19
  v_sub_u32 v18, v18, v20
  v_and_b32 v20, 2, v19
  v_lshrrev_b32 v21, 1, v19
  v_and_b32 v21, 4, v21
  v_or_b32 v20, v20, v21
  v_xor_b32 v18, v18, v20
  v_mul_u32_u24 v19, 12288, v19
  v_lshlrev_b32 v18, 4, v18
  v_add_u32 v10, v18, v19
  v_add_u32 v18, 2304, v0
  v_mul_u32_u24 v19, 2731, v18
  v_lshrrev_b32 v19, 16, v19
  v_mul_u32_u24 v20, 24, v19
  v_sub_u32 v18, v18, v20
  v_and_b32 v20, 2, v19
  v_lshrrev_b32 v21, 1, v19
  v_and_b32 v21, 4, v21
  v_or_b32 v20, v20, v21
  v_xor_b32 v18, v18, v20
  v_mul_u32_u24 v19, 12288, v19
  v_lshlrev_b32 v18, 4, v18
  v_add_u32 v11, v18, v19
  v_add_u32 v18, 2560, v0
  v_mul_u32_u24 v19, 2731, v18
  v_lshrrev_b32 v19, 16, v19
  v_mul_u32_u24 v20, 24, v19
  v_sub_u32 v18, v18, v20
  v_and_b32 v20, 2, v19
  v_lshrrev_b32 v21, 1, v19
  v_and_b32 v21, 4, v21
  v_or_b32 v20, v20, v21
  v_xor_b32 v18, v18, v20
  v_mul_u32_u24 v19, 12288, v19
  v_lshlrev_b32 v18, 4, v18
  v_add_u32 v12, v18, v19
  v_add_u32 v18, 2816, v0
  v_mul_u32_u24 v19, 2731, v18
  v_lshrrev_b32 v19, 16, v19
  v_mul_u32_u24 v20, 24, v19
  v_sub_u32 v18, v18, v20
  v_and_b32 v20, 2, v19
  v_lshrrev_b32 v21, 1, v19
  v_and_b32 v21, 4, v21
  v_or_b32 v20, v20, v21
  v_xor_b32 v18, v18, v20
  v_mul_u32_u24 v19, 12288, v19
  v_lshlrev_b32 v18, 4, v18
  v_add_u32 v13, v18, v19
  v_add_u32 v18, 3072, v0
  v_mul_u32_u24 v19, 2731, v18
  v_lshrrev_b32 v19, 16, v19
  v_mul_u32_u24 v20, 24, v19
  v_sub_u32 v18, v18, v20
  v_and_b32 v20, 2, v19
  v_lshrrev_b32 v21, 1, v19
  v_and_b32 v21, 4, v21
  v_or_b32 v20, v20, v21
  v_xor_b32 v18, v18, v20
  v_mul_u32_u24 v19, 12288, v19
  v_lshlrev_b32 v18, 4, v18
  v_add_u32 v14, v18, v19
  v_add_u32 v18, 3328, v0
  v_mul_u32_u24 v19, 2731, v18
  v_lshrrev_b32 v19, 16, v19
  v_mul_u32_u24 v20, 24, v19
  v_sub_u32 v18, v18, v20
  v_and_b32 v20, 2, v19
  v_lshrrev_b32 v21, 1, v19
  v_and_b32 v21, 4, v21
  v_or_b32 v20, v20, v21
  v_xor_b32 v18, v18, v20
  v_mul_u32_u24 v19, 12288, v19
  v_lshlrev_b32 v18, 4, v18
  v_add_u32 v15, v18, v19
  v_add_u32 v18, 3584, v0
  v_mul_u32_u24 v19, 2731, v18
  v_lshrrev_b32 v19, 16, v19
  v_mul_u32_u24 v20, 24, v19
  v_sub_u32 v18, v18, v20
  v_and_b32 v20, 2, v19
  v_lshrrev_b32 v21, 1, v19
  v_and_b32 v21, 4, v21
  v_or_b32 v20, v20, v21
  v_xor_b32 v18, v18, v20
  v_mul_u32_u24 v19, 12288, v19
  v_lshlrev_b32 v18, 4, v18
  v_add_u32 v16, v18, v19
  s_add_u32 m0, s65, 0
  s_nop 0
  buffer_load_dwordx4 v92, s[4:7], s64 offen lds
  s_add_u32 m0, s65, 1024
  s_nop 0
  buffer_load_dwordx4 v93, s[4:7], s64 offen lds
  s_add_u32 m0, s65, 2048
  s_nop 0
  buffer_load_dwordx4 v94, s[4:7], s64 offen lds
  s_add_u32 m0, s65, 3072
  s_nop 0
  buffer_load_dwordx4 v95, s[4:7], s64 offen lds
  s_add_u32 m0, s65, 4096
  s_nop 0
  buffer_load_dwordx4 v96, s[4:7], s64 offen lds
  s_add_u32 m0, s65, 5120
  s_nop 0
  buffer_load_dwordx4 v97, s[4:7], s64 offen lds
  s_add_u32 m0, s65, 6144
  s_nop 0
  buffer_load_dwordx4 v98, s[4:7], s64 offen lds
  s_add_u32 m0, s65, 7168
  s_nop 0
  buffer_load_dwordx4 v99, s[4:7], s64 offen lds
  s_add_u32 m0, s65, 8192
  s_nop 0
  buffer_load_dwordx4 v100, s[4:7], s64 offen lds
  s_add_u32 m0, s65, 9216
  s_nop 0
  buffer_load_dwordx4 v101, s[4:7], s64 offen lds
  s_mov_b32 s70, s67
  s_lshl_b32 s60, s52, 10
  s_add_u32 s60, s60, 0x0
  s_add_u32 m0, s60, 0
  s_nop 0
  buffer_load_dwordx4 v2, s[20:23], s70 offen lds
  s_add_u32 m0, s60, 4096
  s_nop 0
  buffer_load_dwordx4 v3, s[20:23], s70 offen lds
  s_add_u32 m0, s60, 8192
  s_nop 0
  buffer_load_dwordx4 v4, s[20:23], s70 offen lds
  s_add_u32 m0, s60, 12288
  s_nop 0
  buffer_load_dwordx4 v5, s[20:23], s70 offen lds
  s_add_u32 m0, s60, 16384
  s_nop 0
  buffer_load_dwordx4 v6, s[20:23], s70 offen lds
  s_add_u32 m0, s60, 20480
  s_nop 0
  buffer_load_dwordx4 v7, s[20:23], s70 offen lds
  s_add_u32 m0, s60, 24576
  s_nop 0
  buffer_load_dwordx4 v8, s[20:23], s70 offen lds
  s_add_u32 m0, s60, 28672
  s_nop 0
  buffer_load_dwordx4 v9, s[20:23], s70 offen lds
  s_add_u32 m0, s60, 32768
  s_nop 0
  buffer_load_dwordx4 v10, s[20:23], s70 offen lds
  s_add_u32 m0, s60, 36864
  s_nop 0
  buffer_load_dwordx4 v11, s[20:23], s70 offen lds
  s_add_u32 m0, s60, 40960
  s_nop 0
  buffer_load_dwordx4 v12, s[20:23], s70 offen lds
  s_add_u32 m0, s60, 45056
  s_nop 0
  buffer_load_dwordx4 v13, s[20:23], s70 offen lds
  s_add_u32 m0, s60, 49152
  s_nop 0
  buffer_load_dwordx4 v14, s[20:23], s70 offen lds
  s_add_u32 m0, s60, 53248
  s_nop 0
  buffer_load_dwordx4 v15, s[20:23], s70 offen lds
  s_add_u32 m0, s60, 57344
  s_nop 0
  buffer_load_dwordx4 v16, s[20:23], s70 offen lds
  s_add_u32 s70, s70, 1966080
  s_lshl_b32 s60, s52, 10
  s_add_u32 s60, s60, 0xf000
  s_add_u32 m0, s60, 0
  s_nop 0
  buffer_load_dwordx4 v2, s[20:23], s70 offen lds
  s_add_u32 m0, s60, 4096
  s_nop 0
  buffer_load_dwordx4 v3, s[20:23], s70 offen lds
  s_add_u32 m0, s60, 8192
  s_nop 0
  buffer_load_dwordx4 v4, s[20:23], s70 offen lds
  s_add_u32 m0, s60, 12288
  s_nop 0
  buffer_load_dwordx4 v5, s[20:23], s70 offen lds
  s_add_u32 m0, s60, 16384
  s_nop 0
  buffer_load_dwordx4 v6, s[20:23], s70 offen lds
  s_add_u32 m0, s60, 20480
  s_nop 0
  buffer_load_dwordx4 v7, s[20:23], s70 offen lds
  s_add_u32 m0, s60, 24576
  s_nop 0
  buffer_load_dwordx4 v8, s[20:23], s70 offen lds
  s_add_u32 m0, s60, 28672
  s_nop 0
  buffer_load_dwordx4 v9, s[20:23], s70 offen lds
  s_add_u32 m0, s60, 32768
  s_nop 0
  buffer_load_dwordx4 v10, s[20:23], s70 offen lds
  s_add_u32 m0, s60, 36864
  s_nop 0
  buffer_load_dwordx4 v11, s[20:23], s70 offen lds
  s_add_u32 m0, s60, 40960
  s_nop 0
  buffer_load_dwordx4 v12, s[20:23], s70 offen lds
  s_add_u32 m0, s60, 45056
  s_nop 0
  buffer_load_dwordx4 v13, s[20:23], s70 offen lds
  s_add_u32 m0, s60, 49152
  s_nop 0
  buffer_load_dwordx4 v14, s[20:23], s70 offen lds
  s_add_u32 m0, s60, 53248
  s_nop 0
  buffer_load_dwordx4 v15, s[20:23], s70 offen lds
  s_add_u32 m0, s60, 57344
  s_nop 0
  buffer_load_dwordx4 v16, s[20:23], s70 offen lds
  s_waitcnt vmcnt(15)
  s_barrier
  ds_read_b64_tr_b16 a[0:1], v26 offset:0
  ds_read_b64_tr_b16 a[2:3], v26 offset:1536
  ds_read_b64_tr_b16 a[4:5], v26 offset:12288
  ds_read_b64_tr_b16 a[6:7], v26 offset:13824
  ds_read_b64_tr_b16 a[8:9], v26 offset:24576
  ds_read_b64_tr_b16 a[10:11], v26 offset:26112
  s_waitcnt lgkmcnt(4)
  ds_read_b64_tr_b16 a[12:13], v26 offset:36864
  ds_read_b64_tr_b16 a[14:15], v26 offset:38400
  ds_read_b64_tr_b16 a[16:17], v26 offset:49152
  ds_read_b64_tr_b16 a[18:19], v26 offset:50688
  s_waitcnt lgkmcnt(4)
  ds_read_b64_tr_b16 a[80:81], v27 offset:0
  ds_read_b64_tr_b16 a[82:83], v27 offset:1536
  ds_read_b64_tr_b16 a[84:85], v27 offset:12288
  ds_read_b64_tr_b16 a[86:87], v27 offset:13824
  ds_read_b64_tr_b16 a[88:89], v27 offset:24576
  ds_read_b64_tr_b16 a[90:91], v27 offset:26112
  s_waitcnt lgkmcnt(4)
  ds_read_b64_tr_b16 a[92:93], v27 offset:36864
  ds_read_b64_tr_b16 a[94:95], v27 offset:38400
  ds_read_b64_tr_b16 a[96:97], v27 offset:49152
  ds_read_b64_tr_b16 a[98:99], v27 offset:50688
  s_waitcnt lgkmcnt(4)
  ds_read_b64_tr_b16 a[160:161], v28 offset:0
  ds_read_b64_tr_b16 a[162:163], v28 offset:1536
  ds_read_b64_tr_b16 a[164:165], v28 offset:12288
  ds_read_b64_tr_b16 a[166:167], v28 offset:13824
  ds_read_b64_tr_b16 a[168:169], v28 offset:24576
  ds_read_b64_tr_b16 a[170:171], v28 offset:26112
  s_waitcnt lgkmcnt(4)
  ds_read_b64_tr_b16 a[172:173], v28 offset:36864
  ds_read_b64_tr_b16 a[174:175], v28 offset:38400
  ds_read_b64_tr_b16 a[176:177], v28 offset:49152
  ds_read_b64_tr_b16 a[178:179], v28 offset:50688
  s_waitcnt lgkmcnt(4)
  s_waitcnt lgkmcnt(0)
  v_add_u32 v26, 61440, v26
  v_add_u32 v27, 61440, v27
  v_add_u32 v28, 61440, v28
  s_barrier
  s_add_u32 s70, s70, 1966080
  s_lshl_b32 s60, s52, 10
  s_add_u32 s60, s60, 0x0
  s_add_u32 m0, s60, 0
  s_nop 0
  buffer_load_dwordx4 v2, s[20:23], s70 offen lds
  s_add_u32 m0, s60, 4096
  s_nop 0
  buffer_load_dwordx4 v3, s[20:23], s70 offen lds
  s_add_u32 m0, s60, 8192
  s_nop 0
  buffer_load_dwordx4 v4, s[20:23], s70 offen lds
  s_add_u32 m0, s60, 12288
  s_nop 0
  buffer_load_dwordx4 v5, s[20:23], s70 offen lds
  s_add_u32 m0, s60, 16384
  s_nop 0
  buffer_load_dwordx4 v6, s[20:23], s70 offen lds
  s_add_u32 m0, s60, 20480
  s_nop 0
  buffer_load_dwordx4 v7, s[20:23], s70 offen lds
  s_add_u32 m0, s60, 24576
  s_nop 0
  buffer_load_dwordx4 v8, s[20:23], s70 offen lds
  s_add_u32 m0, s60, 28672
  s_nop 0
  buffer_load_dwordx4 v9, s[20:23], s70 offen lds
  s_add_u32 m0, s60, 32768
  s_nop 0
  buffer_load_dwordx4 v10, s[20:23], s70 offen lds
  s_add_u32 m0, s60, 36864
  s_nop 0
  buffer_load_dwordx4 v11, s[20:23], s70 offen lds
  s_add_u32 m0, s60, 40960
  s_nop 0
  buffer_load_dwordx4 v12, s[20:23], s70 offen lds
  s_add_u32 m0, s60, 45056
  s_nop 0
  buffer_load_dwordx4 v13, s[20:23], s70 offen lds
  s_add_u32 m0, s60, 49152
  s_nop 0
  buffer_load_dwordx4 v14, s[20:23], s70 offen lds
  s_add_u32 m0, s60, 53248
  s_nop 0
  buffer_load_dwordx4 v15, s[20:23], s70 offen lds
  s_add_u32 m0, s60, 57344
  s_nop 0
  buffer_load_dwordx4 v16, s[20:23], s70 offen lds
  s_waitcnt vmcnt(15)
  s_barrier
  ds_read_b64_tr_b16 a[20:21], v26 offset:0
  ds_read_b64_tr_b16 a[22:23], v26 offset:1536
  ds_read_b64_tr_b16 a[24:25], v26 offset:12288
  ds_read_b64_tr_b16 a[26:27], v26 offset:13824
  ds_read_b64_tr_b16 a[28:29], v26 offset:24576
  ds_read_b64_tr_b16 a[30:31], v26 offset:26112
  s_waitcnt lgkmcnt(4)
  ds_read_b64_tr_b16 a[32:33], v26 offset:36864
  ds_read_b64_tr_b16 a[34:35], v26 offset:38400
  ds_read_b64_tr_b16 a[36:37], v26 offset:49152
  ds_read_b64_tr_b16 a[38:39], v26 offset:50688
  s_waitcnt lgkmcnt(4)
  ds_read_b64_tr_b16 a[100:101], v27 offset:0
  ds_read_b64_tr_b16 a[102:103], v27 offset:1536
  ds_read_b64_tr_b16 a[104:105], v27 offset:12288
  ds_read_b64_tr_b16 a[106:107], v27 offset:13824
  ds_read_b64_tr_b16 a[108:109], v27 offset:24576
  ds_read_b64_tr_b16 a[110:111], v27 offset:26112
  s_waitcnt lgkmcnt(4)
  ds_read_b64_tr_b16 a[112:113], v27 offset:36864
  ds_read_b64_tr_b16 a[114:115], v27 offset:38400
  ds_read_b64_tr_b16 a[116:117], v27 offset:49152
  ds_read_b64_tr_b16 a[118:119], v27 offset:50688
  s_waitcnt lgkmcnt(4)
  ds_read_b64_tr_b16 a[180:181], v28 offset:0
  ds_read_b64_tr_b16 a[182:183], v28 offset:1536
  ds_read_b64_tr_b16 a[184:185], v28 offset:12288
  ds_read_b64_tr_b16 a[186:187], v28 offset:13824
  ds_read_b64_tr_b16 a[188:189], v28 offset:24576
  ds_read_b64_tr_b16 a[190:191], v28 offset:26112
  s_waitcnt lgkmcnt(4)
  ds_read_b64_tr_b16 a[192:193], v28 offset:36864
  ds_read_b64_tr_b16 a[194:195], v28 offset:38400
  ds_read_b64_tr_b16 a[196:197], v28 offset:49152
  ds_read_b64_tr_b16 a[198:199], v28 offset:50688
  s_waitcnt lgkmcnt(4)
  s_waitcnt lgkmcnt(0)
  v_subrev_u32 v26, 61440, v26
  v_subrev_u32 v27, 61440, v27
  v_subrev_u32 v28, 61440, v28
  s_barrier
  s_add_u32 s70, s70, 1966080
  s_lshl_b32 s60, s52, 10
  s_add_u32 s60, s60, 0xf000
  s_add_u32 m0, s60, 0
  s_nop 0
  buffer_load_dwordx4 v2, s[20:23], s70 offen lds
  s_add_u32 m0, s60, 4096
  s_nop 0
  buffer_load_dwordx4 v3, s[20:23], s70 offen lds
  s_add_u32 m0, s60, 8192
  s_nop 0
  buffer_load_dwordx4 v4, s[20:23], s70 offen lds
  s_add_u32 m0, s60, 12288
  s_nop 0
  buffer_load_dwordx4 v5, s[20:23], s70 offen lds
  s_add_u32 m0, s60, 16384
  s_nop 0
  buffer_load_dwordx4 v6, s[20:23], s70 offen lds
  s_add_u32 m0, s60, 20480
  s_nop 0
  buffer_load_dwordx4 v7, s[20:23], s70 offen lds
  s_add_u32 m0, s60, 24576
  s_nop 0
  buffer_load_dwordx4 v8, s[20:23], s70 offen lds
  s_add_u32 m0, s60, 28672
  s_nop 0
  buffer_load_dwordx4 v9, s[20:23], s70 offen lds
  s_add_u32 m0, s60, 32768
  s_nop 0
  buffer_load_dwordx4 v10, s[20:23], s70 offen lds
  s_add_u32 m0, s60, 36864
  s_nop 0
  buffer_load_dwordx4 v11, s[20:23], s70 offen lds
  s_add_u32 m0, s60, 40960
  s_nop 0
  buffer_load_dwordx4 v12, s[20:23], s70 offen lds
  s_add_u32 m0, s60, 45056
  s_nop 0
  buffer_load_dwordx4 v13, s[20:23], s70 offen lds
  s_add_u32 m0, s60, 49152
  s_nop 0
  buffer_load_dwordx4 v14, s[20:23], s70 offen lds
  s_add_u32 m0, s60, 53248
  s_nop 0
  buffer_load_dwordx4 v15, s[20:23], s70 offen lds
  s_add_u32 m0, s60, 57344
  s_nop 0
  buffer_load_dwordx4 v16, s[20:23], s70 offen lds
  s_waitcnt vmcnt(15)
  s_barrier
  ds_read_b64_tr_b16 a[40:41], v26 offset:0
  ds_read_b64_tr_b16 a[42:43], v26 offset:1536
  ds_read_b64_tr_b16 a[44:45], v26 offset:12288
  ds_read_b64_tr_b16 a[46:47], v26 offset:13824
  ds_read_b64_tr_b16 a[48:49], v26 offset:24576
  ds_read_b64_tr_b16 a[50:51], v26 offset:26112
  s_waitcnt lgkmcnt(4)
  ds_read_b64_tr_b16 a[52:53], v26 offset:36864
  ds_read_b64_tr_b16 a[54:55], v26 offset:38400
  ds_read_b64_tr_b16 a[56:57], v26 offset:49152
  ds_read_b64_tr_b16 a[58:59], v26 offset:50688
  s_waitcnt lgkmcnt(4)
  ds_read_b64_tr_b16 a[120:121], v27 offset:0
  ds_read_b64_tr_b16 a[122:123], v27 offset:1536
  ds_read_b64_tr_b16 a[124:125], v27 offset:12288
  ds_read_b64_tr_b16 a[126:127], v27 offset:13824
  ds_read_b64_tr_b16 a[128:129], v27 offset:24576
  ds_read_b64_tr_b16 a[130:131], v27 offset:26112
  s_waitcnt lgkmcnt(4)
  ds_read_b64_tr_b16 a[132:133], v27 offset:36864
  ds_read_b64_tr_b16 a[134:135], v27 offset:38400
  ds_read_b64_tr_b16 a[136:137], v27 offset:49152
  ds_read_b64_tr_b16 a[138:139], v27 offset:50688
  s_waitcnt lgkmcnt(4)
  ds_read_b64_tr_b16 a[200:201], v28 offset:0
  ds_read_b64_tr_b16 a[202:203], v28 offset:1536
  ds_read_b64_tr_b16 a[204:205], v28 offset:12288
  ds_read_b64_tr_b16 a[206:207], v28 offset:13824
  ds_read_b64_tr_b16 a[208:209], v28 offset:24576
  ds_read_b64_tr_b16 a[210:211], v28 offset:26112
  s_waitcnt lgkmcnt(4)
  ds_read_b64_tr_b16 a[212:213], v28 offset:36864
  ds_read_b64_tr_b16 a[214:215], v28 offset:38400
  ds_read_b64_tr_b16 a[216:217], v28 offset:49152
  ds_read_b64_tr_b16 a[218:219], v28 offset:50688
  s_waitcnt lgkmcnt(4)
  s_waitcnt lgkmcnt(0)
  v_add_u32 v26, 61440, v26
  v_add_u32 v27, 61440, v27
  v_add_u32 v28, 61440, v28
  s_barrier
  s_waitcnt vmcnt(0)
  s_barrier
  ds_read_b64_tr_b16 a[60:61], v26 offset:0
  ds_read_b64_tr_b16 a[62:63], v26 offset:1536
  ds_read_b64_tr_b16 a[64:65], v26 offset:12288
  ds_read_b64_tr_b16 a[66:67], v26 offset:13824
  ds_read_b64_tr_b16 a[68:69], v26 offset:24576
  ds_read_b64_tr_b16 a[70:71], v26 offset:26112
  s_waitcnt lgkmcnt(4)
  ds_read_b64_tr_b16 a[72:73], v26 offset:36864
  ds_read_b64_tr_b16 a[74:75], v26 offset:38400
  ds_read_b64_tr_b16 a[76:77], v26 offset:49152
  ds_read_b64_tr_b16 a[78:79], v26 offset:50688
  s_waitcnt lgkmcnt(4)
  ds_read_b64_tr_b16 a[140:141], v27 offset:0
  ds_read_b64_tr_b16 a[142:143], v27 offset:1536
  ds_read_b64_tr_b16 a[144:145], v27 offset:12288
  ds_read_b64_tr_b16 a[146:147], v27 offset:13824
  ds_read_b64_tr_b16 a[148:149], v27 offset:24576
  ds_read_b64_tr_b16 a[150:151], v27 offset:26112
  s_waitcnt lgkmcnt(4)
  ds_read_b64_tr_b16 a[152:153], v27 offset:36864
  ds_read_b64_tr_b16 a[154:155], v27 offset:38400
  ds_read_b64_tr_b16 a[156:157], v27 offset:49152
  ds_read_b64_tr_b16 a[158:159], v27 offset:50688
  s_waitcnt lgkmcnt(4)
  ds_read_b64_tr_b16 a[220:221], v28 offset:0
  ds_read_b64_tr_b16 a[222:223], v28 offset:1536
  ds_read_b64_tr_b16 a[224:225], v28 offset:12288
  ds_read_b64_tr_b16 a[226:227], v28 offset:13824
  ds_read_b64_tr_b16 a[228:229], v28 offset:24576
  ds_read_b64_tr_b16 a[230:231], v28 offset:26112
  s_waitcnt lgkmcnt(4)
  ds_read_b64_tr_b16 a[232:233], v28 offset:36864
  ds_read_b64_tr_b16 a[234:235], v28 offset:38400
  ds_read_b64_tr_b16 a[236:237], v28 offset:49152
  ds_read_b64_tr_b16 a[238:239], v28 offset:50688
  s_waitcnt lgkmcnt(4)
  s_waitcnt lgkmcnt(0)
  v_subrev_u32 v26, 61440, v26
  v_subrev_u32 v27, 61440, v27
  v_subrev_u32 v28, 61440, v28
  s_barrier
  s_mov_b32 s56, 0
  v_mov_b32 v20, 128
iw_7057:
  buffer_load_dwordx2 v[18:19], v20, s[44:47], 0 offen sc1
  s_waitcnt vmcnt(0)
  v_readfirstlane_b32 s58, v18
  v_readfirstlane_b32 s59, v19
  s_cmp_lg_u32 s59, 0
  s_cbranch_scc1 L_to_irregular
  s_cmpk_ge_u32 s58, 256
  s_cbranch_scc1 iwd_7058
  s_cmp_lg_u32 s55, 0
  s_cbranch_scc1 iwd_7058
  s_add_u32 s56, s56, 1
  s_cmp_lt_u32 s56, 0x20000
  s_cbranch_scc1 iw_7057
  s_mov_b32 s55, 1
iwd_7058:
  s_mov_b32 s71, 0xfffe2000
  s_mul_i32 s58, s52, 3072
  v_lshlrev_b32 v25, 4, v1
  v_add_u32 v25, s58, v25
  s_mul_i32 s66, s69, 12288
  s_add_u32 s66, s66, 0x3200000
  s_lshl_b32 s58, s69, 8
  s_add_u32 s58, s58, 128
  v_mov_b32 v29, s58
  s_mov_b32 s62, 0
L_t1_vr:
  s_waitcnt vmcnt(3)
  s_cmp_lg_u32 s62, 1
  s_cbranch_scc1 t1w_7059
  s_waitcnt vmcnt(0)
t1w_7059:
  s_barrier
  s_cmp_lg_u32 s52, 0
  s_cbranch_scc1 t1f_7060
  s_cmp_lt_u32 s62, 1
  s_cbranch_scc1 t1f_7060
  s_sub_u32 s58, s62, 1
  s_max_u32 s58, s58, 1
  v_mov_b32 v18, s58
  s_mov_b64 exec, 1
  buffer_store_dword v18, v29, s[48:51], 0 offen sc1
  s_mov_b64 exec, -1
t1f_7060:
  s_cmp_lt_u32 s62, 63
  s_cselect_b32 s58, 40960, 0
  s_add_u32 s64, s64, s58
  s_add_u32 s65, s65, s71
  ds_read_b128 v[32:35], v102 offset:0
  ds_read_b128 v[36:39], v102 offset:20480
  ds_read_b128 v[40:43], v103 offset:0
  ds_read_b128 v[44:47], v103 offset:20480
  ds_read_b128 v[48:51], v104 offset:0
  ds_read_b128 v[52:55], v104 offset:20480
  s_waitcnt lgkmcnt(4)
  v_mfma_f32_16x16x32_bf16 v[56:59], v[32:35], a[0:3], 0
  v_mfma_f32_16x16x32_bf16 v[64:67], v[32:35], a[80:83], 0
  v_mfma_f32_16x16x32_bf16 v[72:75], v[32:35], a[160:163], 0
  v_mfma_f32_16x16x32_bf16 v[60:63], v[36:39], a[0:3], 0
  v_mfma_f32_16x16x32_bf16 v[68:71], v[36:39], a[80:83], 0
  v_mfma_f32_16x16x32_bf16 v[76:79], v[36:39], a[160:163], 0
  ds_read_b128 v[32:35], v105 offset:0
  ds_read_b128 v[36:39], v105 offset:20480
  s_waitcnt lgkmcnt(4)
  v_mfma_f32_16x16x32_bf16 v[56:59], v[40:43], a[4:7], v[56:59]
  s_add_u32 m0, s65, 0
  s_nop 0
  buffer_load_dwordx4 v92, s[4:7], s64 offen lds
  v_mfma_f32_16x16x32_bf16 v[64:67], v[40:43], a[84:87], v[64:67]
  v_mfma_f32_16x16x32_bf16 v[72:75], v[40:43], a[164:167], v[72:75]
  v_mfma_f32_16x16x32_bf16 v[60:63], v[44:47], a[4:7], v[60:63]
  v_mfma_f32_16x16x32_bf16 v[68:71], v[44:47], a[84:87], v[68:71]
  v_mfma_f32_16x16x32_bf16 v[76:79], v[44:47], a[164:167], v[76:79]
  ds_read_b128 v[40:43], v102 offset:256
  ds_read_b128 v[44:47], v102 offset:20736
  s_waitcnt lgkmcnt(4)
  v_mfma_f32_16x16x32_bf16 v[56:59], v[48:51], a[8:11], v[56:59]
  v_mfma_f32_16x16x32_bf16 v[64:67], v[48:51], a[88:91], v[64:67]
  v_mfma_f32_16x16x32_bf16 v[72:75], v[48:51], a[168:171], v[72:75]
  v_mfma_f32_16x16x32_bf16 v[60:63], v[52:55], a[8:11], v[60:63]
  v_mfma_f32_16x16x32_bf16 v[68:71], v[52:55], a[88:91], v[68:71]
  s_add_u32 m0, s65, 1024
  s_nop 0
  buffer_load_dwordx4 v93, s[4:7], s64 offen lds
  v_mfma_f32_16x16x32_bf16 v[76:79], v[52:55], a[168:171], v[76:79]
  ds_read_b128 v[48:51], v103 offset:256
  ds_read_b128 v[52:55], v103 offset:20736
  s_waitcnt lgkmcnt(4)
  v_mfma_f32_16x16x32_bf16 v[56:59], v[32:35], a[12:15], v[56:59]
  v_mfma_f32_16x16x32_bf16 v[64:67], v[32:35], a[92:95], v[64:67]
  v_mfma_f32_16x16x32_bf16 v[72:75], v[32:35], a[172:175], v[72:75]
  v_mfma_f32_16x16x32_bf16 v[60:63], v[36:39], a[12:15], v[60:63]
  v_mfma_f32_16x16x32_bf16 v[68:71], v[36:39], a[92:95], v[68:71]
  v_mfma_f32_16x16x32_bf16 v[76:79], v[36:39], a[172:175], v[76:79]
  ds_read_b128 v[32:35], v104 offset:256
  ds_read_b128 v[36:39], v104 offset:20736
  s_waitcnt lgkmcnt(4)
  v_mfma_f32_16x16x32_bf16 v[56:59], v[40:43], a[16:19], v[56:59]
  v_mfma_f32_16x16x32_bf16 v[64:67], v[40:43], a[96:99], v[64:67]
  v_mfma_f32_16x16x32_bf16 v[72:75], v[40:43], a[176:179], v[72:75]
  s_add_u32 m0, s65, 2048
  s_nop 0
  buffer_load_dwordx4 v94, s[4:7], s64 offen lds
  v_mfma_f32_16x16x32_bf16 v[60:63], v[44:47], a[16:19], v[60:63]
  v_mfma_f32_16x16x32_bf16 v[68:71], v[44:47], a[96:99], v[68:71]
  v_mfma_f32_16x16x32_bf16 v[76:79], v[44:47], a[176:179], v[76:79]
  ds_read_b128 v[40:43], v105 offset:256
  ds_read_b128 v[44:47], v105 offset:20736
  s_waitcnt lgkmcnt(4)
  v_mfma_f32_16x16x32_bf16 v[56:59], v[48:51], a[20:23], v[56:59]
  v_mfma_f32_16x16x32_bf16 v[64:67], v[48:51], a[100:103], v[64:67]
  v_mfma_f32_16x16x32_bf16 v[72:75], v[48:51], a[180:183], v[72:75]
  v_mfma_f32_16x16x32_bf16 v[60:63], v[52:55], a[20:23], v[60:63]
  v_mfma_f32_16x16x32_bf16 v[68:71], v[52:55], a[100:103], v[68:71]
  v_mfma_f32_16x16x32_bf16 v[76:79], v[52:55], a[180:183], v[76:79]
  ds_read_b128 v[48:51], v102 offset:512
  ds_read_b128 v[52:55], v102 offset:20992
  s_waitcnt lgkmcnt(4)
  v_mfma_f32_16x16x32_bf16 v[56:59], v[32:35], a[24:27], v[56:59]
  s_add_u32 m0, s65, 3072
  s_nop 0
  buffer_load_dwordx4 v95, s[4:7], s64 offen lds
  v_mfma_f32_16x16x32_bf16 v[64:67], v[32:35], a[104:107], v[64:67]
  v_mfma_f32_16x16x32_bf16 v[72:75], v[32:35], a[184:187], v[72:75]
  v_mfma_f32_16x16x32_bf16 v[60:63], v[36:39], a[24:27], v[60:63]
  v_mfma_f32_16x16x32_bf16 v[68:71], v[36:39], a[104:107], v[68:71]
  v_mfma_f32_16x16x32_bf16 v[76:79], v[36:39], a[184:187], v[76:79]
  ds_read_b128 v[32:35], v103 offset:512
  ds_read_b128 v[36:39], v103 offset:20992
  s_waitcnt lgkmcnt(4)
  v_mfma_f32_16x16x32_bf16 v[56:59], v[40:43], a[28:31], v[56:59]
  v_mfma_f32_16x16x32_bf16 v[64:67], v[40:43], a[108:111], v[64:67]
  v_mfma_f32_16x16x32_bf16 v[72:75], v[40:43], a[188:191], v[72:75]
  v_mfma_f32_16x16x32_bf16 v[60:63], v[44:47], a[28:31], v[60:63]
  v_mfma_f32_16x16x32_bf16 v[68:71], v[44:47], a[108:111], v[68:71]
  s_add_u32 m0, s65, 4096
  s_nop 0
  buffer_load_dwordx4 v96, s[4:7], s64 offen lds
  v_mfma_f32_16x16x32_bf16 v[76:79], v[44:47], a[188:191], v[76:79]
  ds_read_b128 v[40:43], v104 offset:512
  ds_read_b128 v[44:47], v104 offset:20992
  s_waitcnt lgkmcnt(4)
  v_mfma_f32_16x16x32_bf16 v[56:59], v[48:51], a[32:35], v[56:59]
  v_mfma_f32_16x16x32_bf16 v[64:67], v[48:51], a[112:115], v[64:67]
  v_mfma_f32_16x16x32_bf16 v[72:75], v[48:51], a[192:195], v[72:75]
  v_mfma_f32_16x16x32_bf16 v[60:63], v[52:55], a[32:35], v[60:63]
  v_mfma_f32_16x16x32_bf16 v[68:71], v[52:55], a[112:115], v[68:71]
  v_mfma_f32_16x16x32_bf16 v[76:79], v[52:55], a[192:195], v[76:79]
  ds_read_b128 v[48:51], v105 offset:512
  ds_read_b128 v[52:55], v105 offset:20992
  s_waitcnt lgkmcnt(4)
  v_mfma_f32_16x16x32_bf16 v[56:59], v[32:35], a[36:39], v[56:59]
  v_mfma_f32_16x16x32_bf16 v[64:67], v[32:35], a[116:119], v[64:67]
  v_mfma_f32_16x16x32_bf16 v[72:75], v[32:35], a[196:199], v[72:75]
  s_add_u32 m0, s65, 5120
  s_nop 0
  buffer_load_dwordx4 v97, s[4:7], s64 offen lds
  v_mfma_f32_16x16x32_bf16 v[60:63], v[36:39], a[36:39], v[60:63]
  v_mfma_f32_16x16x32_bf16 v[68:71], v[36:39], a[116:119], v[68:71]
  v_mfma_f32_16x16x32_bf16 v[76:79], v[36:39], a[196:199], v[76:79]
  ds_read_b128 v[32:35], v102 offset:768
  ds_read_b128 v[36:39], v102 offset:21248
  s_waitcnt lgkmcnt(4)
  v_mfma_f32_16x16x32_bf16 v[56:59], v[40:43], a[40:43], v[56:59]
  v_mfma_f32_16x16x32_bf16 v[64:67], v[40:43], a[120:123], v[64:67]
  v_mfma_f32_16x16x32_bf16 v[72:75], v[40:43], a[200:203], v[72:75]
  v_mfma_f32_16x16x32_bf16 v[60:63], v[44:47], a[40:43], v[60:63]
  v_mfma_f32_16x16x32_bf16 v[68:71], v[44:47], a[120:123], v[68:71]
  v_mfma_f32_16x16x32_bf16 v[76:79], v[44:47], a[200:203], v[76:79]
  ds_read_b128 v[40:43], v103 offset:768
  ds_read_b128 v[44:47], v103 offset:21248
  s_waitcnt lgkmcnt(4)
  v_mfma_f32_16x16x32_bf16 v[56:59], v[48:51], a[44:47], v[56:59]
  s_add_u32 m0, s65, 6144
  s_nop 0
  buffer_load_dwordx4 v98, s[4:7], s64 offen lds
  v_mfma_f32_16x16x32_bf16 v[64:67], v[48:51], a[124:127], v[64:67]
  v_mfma_f32_16x16x32_bf16 v[72:75], v[48:51], a[204:207], v[72:75]
  v_mfma_f32_16x16x32_bf16 v[60:63], v[52:55], a[44:47], v[60:63]
  v_mfma_f32_16x16x32_bf16 v[68:71], v[52:55], a[124:127], v[68:71]
  v_mfma_f32_16x16x32_bf16 v[76:79], v[52:55], a[204:207], v[76:79]
  ds_read_b128 v[48:51], v104 offset:768
  ds_read_b128 v[52:55], v104 offset:21248
  s_waitcnt lgkmcnt(4)
  v_mfma_f32_16x16x32_bf16 v[56:59], v[32:35], a[48:51], v[56:59]
  v_mfma_f32_16x16x32_bf16 v[64:67], v[32:35], a[128:131], v[64:67]
  v_mfma_f32_16x16x32_bf16 v[72:75], v[32:35], a[208:211], v[72:75]
  v_mfma_f32_16x16x32_bf16 v[60:63], v[36:39], a[48:51], v[60:63]
  v_mfma_f32_16x16x32_bf16 v[68:71], v[36:39], a[128:131], v[68:71]
  s_add_u32 m0, s65, 7168
  s_nop 0
  buffer_load_dwordx4 v99, s[4:7], s64 offen lds
  v_mfma_f32_16x16x32_bf16 v[76:79], v[36:39], a[208:211], v[76:79]
  ds_read_b128 v[32:35], v105 offset:768
  ds_read_b128 v[36:39], v105 offset:21248
  s_waitcnt lgkmcnt(4)
  v_mfma_f32_16x16x32_bf16 v[56:59], v[40:43], a[52:55], v[56:59]
  v_mfma_f32_16x16x32_bf16 v[64:67], v[40:43], a[132:135], v[64:67]
  v_mfma_f32_16x16x32_bf16 v[72:75], v[40:43], a[212:215], v[72:75]
  v_mfma_f32_16x16x32_bf16 v[60:63], v[44:47], a[52:55], v[60:63]
  v_mfma_f32_16x16x32_bf16 v[68:71], v[44:47], a[132:135], v[68:71]
  v_mfma_f32_16x16x32_bf16 v[76:79], v[44:47], a[212:215], v[76:79]
  ds_read_b128 v[40:43], v102 offset:1024
  ds_read_b128 v[44:47], v102 offset:21504
  s_waitcnt lgkmcnt(4)
  v_mfma_f32_16x16x32_bf16 v[56:59], v[48:51], a[56:59], v[56:59]
  v_mfma_f32_16x16x32_bf16 v[64:67], v[48:51], a[136:139], v[64:67]
  v_mfma_f32_16x16x32_bf16 v[72:75], v[48:51], a[216:219], v[72:75]
  s_add_u32 m0, s65, 8192
  s_nop 0
  buffer_load_dwordx4 v100, s[4:7], s64 offen lds
  v_mfma_f32_16x16x32_bf16 v[60:63], v[52:55], a[56:59], v[60:63]
  v_mfma_f32_16x16x32_bf16 v[68:71], v[52:55], a[136:139], v[68:71]
  v_mfma_f32_16x16x32_bf16 v[76:79], v[52:55], a[216:219], v[76:79]
  ds_read_b128 v[48:51], v103 offset:1024
  ds_read_b128 v[52:55], v103 offset:21504
  s_waitcnt lgkmcnt(4)
  v_mfma_f32_16x16x32_bf16 v[56:59], v[32:35], a[60:63], v[56:59]
  v_mfma_f32_16x16x32_bf16 v[64:67], v[32:35], a[140:143], v[64:67]
  v_mfma_f32_16x16x32_bf16 v[72:75], v[32:35], a[220:223], v[72:75]
  v_mfma_f32_16x16x32_bf16 v[60:63], v[36:39], a[60:63], v[60:63]
  v_mfma_f32_16x16x32_bf16 v[68:71], v[36:39], a[140:143], v[68:71]
  v_mfma_f32_16x16x32_bf16 v[76:79], v[36:39], a[220:223], v[76:79]
  ds_read_b128 v[32:35], v104 offset:1024
  ds_read_b128 v[36:39], v104 offset:21504
  s_waitcnt lgkmcnt(4)
  v_mfma_f32_16x16x32_bf16 v[56:59], v[40:43], a[64:67], v[56:59]
  s_add_u32 m0, s65, 9216
  s_nop 0
  buffer_load_dwordx4 v101, s[4:7], s64 offen lds
  v_mfma_f32_16x16x32_bf16 v[64:67], v[40:43], a[144:147], v[64:67]
  v_mfma_f32_16x16x32_bf16 v[72:75], v[40:43], a[224:227], v[72:75]
  v_mfma_f32_16x16x32_bf16 v[60:63], v[44:47], a[64:67], v[60:63]
  v_mfma_f32_16x16x32_bf16 v[68:71], v[44:47], a[144:147], v[68:71]
  v_mfma_f32_16x16x32_bf16 v[76:79], v[44:47], a[224:227], v[76:79]
  ds_read_b128 v[40:43], v105 offset:1024
  ds_read_b128 v[44:47], v105 offset:21504
  s_waitcnt lgkmcnt(4)
  v_mfma_f32_16x16x32_bf16 v[56:59], v[48:51], a[68:71], v[56:59]
  v_mfma_f32_16x16x32_bf16 v[64:67], v[48:51], a[148:151], v[64:67]
  v_mfma_f32_16x16x32_bf16 v[72:75], v[48:51], a[228:231], v[72:75]
  v_mfma_f32_16x16x32_bf16 v[60:63], v[52:55], a[68:71], v[60:63]
  v_mfma_f32_16x16x32_bf16 v[68:71], v[52:55], a[148:151], v[68:71]
  v_mfma_f32_16x16x32_bf16 v[76:79], v[52:55], a[228:231], v[76:79]
  s_waitcnt lgkmcnt(2)
  v_mfma_f32_16x16x32_bf16 v[56:59], v[32:35], a[72:75], v[56:59]
  v_mfma_f32_16x16x32_bf16 v[64:67], v[32:35], a[152:155], v[64:67]
  v_mfma_f32_16x16x32_bf16 v[72:75], v[32:35], a[232:235], v[72:75]
  v_mfma_f32_16x16x32_bf16 v[60:63], v[36:39], a[72:75], v[60:63]
  v_mfma_f32_16x16x32_bf16 v[68:71], v[36:39], a[152:155], v[68:71]
  v_mfma_f32_16x16x32_bf16 v[76:79], v[36:39], a[232:235], v[76:79]
  s_waitcnt lgkmcnt(0)
  v_mfma_f32_16x16x32_bf16 v[56:59], v[40:43], a[76:79], v[56:59]
  v_mfma_f32_16x16x32_bf16 v[64:67], v[40:43], a[156:159], v[64:67]
  v_mfma_f32_16x16x32_bf16 v[72:75], v[40:43], a[236:239], v[72:75]
  v_mfma_f32_16x16x32_bf16 v[60:63], v[44:47], a[76:79], v[60:63]
  v_mfma_f32_16x16x32_bf16 v[68:71], v[44:47], a[156:159], v[68:71]
  v_mfma_f32_16x16x32_bf16 v[76:79], v[44:47], a[236:239], v[76:79]
  v_add_u32 v102, s71, v102
  v_add_u32 v103, s71, v103
  v_add_u32 v104, s71, v104
  v_add_u32 v105, s71, v105
  s_sub_u32 s71, 0, s71
  s_nop 2
  v_cvt_pk_bf16_f32 v80, v56, v57
  v_cvt_pk_bf16_f32 v81, v58, v59
  v_cvt_pk_bf16_f32 v82, v60, v61
  v_cvt_pk_bf16_f32 v83, v62, v63
  buffer_store_dwordx4 v[80:83], v25, s[48:51], s66 offen offset:0 sc1
  v_cvt_pk_bf16_f32 v84, v64, v65
  v_cvt_pk_bf16_f32 v85, v66, v67
  v_cvt_pk_bf16_f32 v86, v68, v69
  v_cvt_pk_bf16_f32 v87, v70, v71
  buffer_store_dwordx4 v[84:87], v25, s[48:51], s66 offen offset:1024 sc1
  v_cvt_pk_bf16_f32 v88, v72, v73
  v_cvt_pk_bf16_f32 v89, v74, v75
  v_cvt_pk_bf16_f32 v90, v76, v77
  v_cvt_pk_bf16_f32 v91, v78, v79
  buffer_store_dwordx4 v[88:91], v25, s[48:51], s66 offen offset:2048 sc1
  s_add_u32 s66, s66, 393216
  s_add_u32 s62, s62, 1
  s_cmp_lt_u32 s62, 64
  s_cbranch_scc1 L_t1_vr
  s_waitcnt vmcnt(0)
  s_barrier
  s_cmp_lg_u32 s52, 0
  s_cbranch_scc1 t1e_7061
  v_mov_b32 v18, 64
  s_mov_b64 exec, 1
  buffer_store_dword v18, v29, s[48:51], 0 offen sc1
  s_mov_b64 exec, -1
t1e_7061:
L_t1done_r:
  s_lshl_b32 s61, s53, 4
  s_add_u32 s61, s61, s54
  s_lshr_b32 s62, s61, 1
  s_and_b32 s63, s61, 1
  s_mul_i32 s63, s63, 4
  s_mov_b32 s64, 4
  s_waitcnt vmcnt(0)
  v_mov_b32 v19, 32768
  s_mov_b32 s56, 0
poll_7062:
  buffer_load_dword v18, v19, s[48:51], 0 offen sc1
  s_waitcnt vmcnt(0)
  v_readfirstlane_b32 s58, v18
  s_cmp_ge_u32 s58, 30
  s_cbranch_scc1 polldone_7063
  s_cmp_lg_u32 s55, 0
  s_cbranch_scc1 polldone_7063
  s_add_u32 s56, s56, 1
  s_cmp_lt_u32 s56, 0x20000
  s_cbranch_scc1 poll_7062
  s_mov_b32 s55, 1
polldone_7063:
  v_and_b32 v1, 63, v0
  v_lshlrev_b32 v2, 4, v1
  s_mul_i32 s72, s52, 3072
  s_mul_i32 s59, s62, 98304
  s_add_u32 s59, s59, 0x7900000
  v_mul_u32_u24 v18, 48, v0
  v_mov_b32 v19, 0
  s_add_u32 s58, s59, 0
  buffer_load_dwordx4 v[64:67], v18, s[48:51], s58 offen sc1
  buffer_load_dwordx4 v[68:71], v18, s[48:51], s58 offen offset:16 sc1
  buffer_load_dwordx2 v[72:73], v18, s[48:51], s58 offen offset:32 sc1
  s_add_u32 s58, s59, 12288
  buffer_load_dwordx4 v[76:79], v18, s[48:51], s58 offen sc1
  buffer_load_dwordx4 v[80:83], v18, s[48:51], s58 offen offset:16 sc1
  buffer_load_dwordx2 v[84:85], v18, s[48:51], s58 offen offset:32 sc1
  s_add_u32 s58, s59, 24576
  buffer_load_dwordx4 v[88:91], v18, s[48:51], s58 offen sc1
  buffer_load_dwordx4 v[92:95], v18, s[48:51], s58 offen offset:16 sc1
  buffer_load_dwordx2 v[96:97], v18, s[48:51], s58 offen offset:32 sc1
  s_add_u32 s58, s59, 36864
  buffer_load_dwordx4 v[100:103], v18, s[48:51], s58 offen sc1
  buffer_load_dwordx4 v[104:107], v18, s[48:51], s58 offen offset:16 sc1
  buffer_load_dwordx2 v[108:109], v18, s[48:51], s58 offen offset:32 sc1
  s_waitcnt vmcnt(0)
  v_mov_b32 v192, 0
  v_mov_b32 v193, 0
  v_mov_b32 v194, 0
  v_mov_b32 v195, 0
  v_dot2c_f32_bf16 v192, v64, v64
  v_dot2c_f32_bf16 v193, v76, v76
  v_dot2c_f32_bf16 v194, v88, v88
  v_dot2c_f32_bf16 v195, v100, v100
  v_dot2c_f32_bf16 v192, v65, v65
  v_dot2c_f32_bf16 v193, v77, v77
  v_dot2c_f32_bf16 v194, v89, v89
  v_dot2c_f32_bf16 v195, v101, v101
  v_dot2c_f32_bf16 v192, v66, v66
  v_dot2c_f32_bf16 v193, v78, v78
  v_dot2c_f32_bf16 v194, v90, v90
  v_dot2c_f32_bf16 v195, v102, v102
  v_dot2c_f32_bf16 v192, v67, v67
  v_dot2c_f32_bf16 v193, v79, v79
  v_dot2c_f32_bf16 v194, v91, v91
  v_dot2c_f32_bf16 v195, v103, v103
  v_dot2c_f32_bf16 v192, v68, v68
  v_dot2c_f32_bf16 v193, v80, v80
  v_dot2c_f32_bf16 v194, v92, v92
  v_dot2c_f32_bf16 v195, v104, v104
  v_dot2c_f32_bf16 v192, v69, v69
  v_dot2c_f32_bf16 v193, v81, v81
  v_dot2c_f32_bf16 v194, v93, v93
  v_dot2c_f32_bf16 v195, v105, v105
  v_dot2c_f32_bf16 v192, v70, v70
  v_dot2c_f32_bf16 v193, v82, v82
  v_dot2c_f32_bf16 v194, v94, v94
  v_dot2c_f32_bf16 v195, v106, v106
  v_dot2c_f32_bf16 v192, v71, v71
  v_dot2c_f32_bf16 v193, v83, v83
  v_dot2c_f32_bf16 v194, v95, v95
  v_dot2c_f32_bf16 v195, v107, v107
  v_dot2c_f32_bf16 v192, v72, v72
  v_dot2c_f32_bf16 v193, v84, v84
  v_dot2c_f32_bf16 v194, v96, v96
  v_dot2c_f32_bf16 v195, v108, v108
  v_dot2c_f32_bf16 v192, v73, v73
  v_dot2c_f32_bf16 v193, v85, v85
  v_dot2c_f32_bf16 v194, v97, v97
  v_dot2c_f32_bf16 v195, v109, v109
  s_nop 2
  v_max3_f32 v19, v19, v192, v193
  v_max3_f32 v19, v19, v194, v195
  s_add_u32 s58, s59, 49152
  buffer_load_dwordx4 v[64:67], v18, s[48:51], s58 offen sc1
  buffer_load_dwordx4 v[68:71], v18, s[48:51], s58 offen offset:16 sc1
  buffer_load_dwordx2 v[72:73], v18, s[48:51], s58 offen offset:32 sc1
  s_add_u32 s58, s59, 61440
  buffer_load_dwordx4 v[76:79], v18, s[48:51], s58 offen sc1
  buffer_load_dwordx4 v[80:83], v18, s[48:51], s58 offen offset:16 sc1
  buffer_load_dwordx2 v[84:85], v18, s[48:51], s58 offen offset:32 sc1
  s_add_u32 s58, s59, 73728
  buffer_load_dwordx4 v[88:91], v18, s[48:51], s58 offen sc1
  buffer_load_dwordx4 v[92:95], v18, s[48:51], s58 offen offset:16 sc1
  buffer_load_dwordx2 v[96:97], v18, s[48:51], s58 offen offset:32 sc1
  s_add_u32 s58, s59, 86016
  buffer_load_dwordx4 v[100:103], v18, s[48:51], s58 offen sc1
  buffer_load_dwordx4 v[104:107], v18, s[48:51], s58 offen offset:16 sc1
  buffer_load_dwordx2 v[108:109], v18, s[48:51], s58 offen offset:32 sc1
  s_waitcnt vmcnt(0)
  v_mov_b32 v192, 0
  v_mov_b32 v193, 0
  v_mov_b32 v194, 0
  v_mov_b32 v195, 0
  v_dot2c_f32_bf16 v192, v64, v64
  v_dot2c_f32_bf16 v193, v76, v76
  v_dot2c_f32_bf16 v194, v88, v88
  v_dot2c_f32_bf16 v195, v100, v100
  v_dot2c_f32_bf16 v192, v65, v65
  v_dot2c_f32_bf16 v193, v77, v77
  v_dot2c_f32_bf16 v194, v89, v89
  v_dot2c_f32_bf16 v195, v101, v101
  v_dot2c_f32_bf16 v192, v66, v66
  v_dot2c_f32_bf16 v193, v78, v78
  v_dot2c_f32_bf16 v194, v90, v90
  v_dot2c_f32_bf16 v195, v102, v102
  v_dot2c_f32_bf16 v192, v67, v67
  v_dot2c_f32_bf16 v193, v79, v79
  v_dot2c_f32_bf16 v194, v91, v91
  v_dot2c_f32_bf16 v195, v103, v103
  v_dot2c_f32_bf16 v192, v68, v68
  v_dot2c_f32_bf16 v193, v80, v80
  v_dot2c_f32_bf16 v194, v92, v92
  v_dot2c_f32_bf16 v195, v104, v104
  v_dot2c_f32_bf16 v192, v69, v69
  v_dot2c_f32_bf16 v193, v81, v81
  v_dot2c_f32_bf16 v194, v93, v93
  v_dot2c_f32_bf16 v195, v105, v105
  v_dot2c_f32_bf16 v192, v70, v70
  v_dot2c_f32_bf16 v193, v82, v82
  v_dot2c_f32_bf16 v194, v94, v94
  v_dot2c_f32_bf16 v195, v106, v106
  v_dot2c_f32_bf16 v192, v71, v71
  v_dot2c_f32_bf16 v193, v83, v83
  v_dot2c_f32_bf16 v194, v95, v95
  v_dot2c_f32_bf16 v195, v107, v107
  v_dot2c_f32_bf16 v192, v72, v72
  v_dot2c_f32_bf16 v193, v84, v84
  v_dot2c_f32_bf16 v194, v96, v96
  v_dot2c_f32_bf16 v195, v108, v108
  v_dot2c_f32_bf16 v192, v73, v73
  v_dot2c_f32_bf16 v193, v85, v85
  v_dot2c_f32_bf16 v194, v97, v97
  v_dot2c_f32_bf16 v195, v109, v109
  s_nop 2
  v_max3_f32 v19, v19, v192, v193
  v_max3_f32 v19, v19, v194, v195
  v_mov_b32 v20, 73728
  v_mov_b32 v21, 0
  ds_write_b32 v20, v21
  ds_write_b32 v20, v21 offset:4
  s_waitcnt lgkmcnt(0)
  s_barrier
  ds_max_u32 v20, v19
  s_waitcnt lgkmcnt(0)
  s_barrier
  ds_read_b32 v19, v20
  s_waitcnt lgkmcnt(0)
  v_readfirstlane_b32 s69, v19
  v_and_b32 v18, 31, v1
  v_mul_u32_u24 v18, 48, v18
  v_lshrrev_b32 v19, 5, v1
  v_lshlrev_b32 v20, 4, v19
  v_add_u32 v3, v18, v20
  v_add_u32 v4, 32, v18
  v_mov_b32 v6, v3
  v_lshlrev_b32 v20, 2, v19
  v_lshrrev_b32 v21, 2, v1
  v_and_b32 v21, 3, v21
  v_add_u32 v20, v20, v21
  v_mul_u32_u24 v20, 48, v20
  v_lshrrev_b32 v21, 4, v1
  v_and_b32 v21, 1, v21
  v_lshlrev_b32 v21, 5, v21
  v_add_u32 v20, v20, v21
  v_and_b32 v21, 3, v1
  v_lshlrev_b32 v21, 3, v21
  v_add_u32 v20, v20, v21
  v_add_u32 v5, 12288, v20
  v_and_b32 v18, 31, v1
  v_mul_u32_u24 v18, 1280, v18
  v_lshlrev_b32 v19, 3, v19
  v_add_u32 v7, v18, v19
  s_mov_b32 s68, 0
L_b2_br:
  s_lshl_b32 s58, s63, 8
  s_lshl_b32 s59, s52, 6
  s_add_u32 s58, s58, s59
  s_mul_i32 s71, s58, 1280
  s_mul_i32 s59, s62, 40
  s_add_u32 s71, s71, s59
  s_add_u32 s71, s71, 0x7f00000
  s_mul_i32 s58, s58, 48
  s_mul_i32 s59, s62, 98304
  s_add_u32 s70, s58, s59
  s_add_u32 s70, s70, 0x7600000
  v_and_b32 v18, 31, v1
  v_mul_u32_u24 v18, 48, v18
  buffer_load_dwordx4 v[208:211], v6, s[48:51], s70 offen offset:0 sc1
  buffer_load_dwordx2 v[212:213], v18, s[48:51], s70 offen offset:32 sc1
  buffer_load_dwordx4 v[216:219], v6, s[48:51], s70 offen offset:1536 sc1
  buffer_load_dwordx2 v[220:221], v18, s[48:51], s70 offen offset:1568 sc1
  v_cmp_gt_u32 vcc, 32, v1
  v_mov_b32 v19, 0
  s_waitcnt vmcnt(0)
  v_cndmask_b32 v212, v19, v212, vcc
  v_cndmask_b32 v213, v19, v213, vcc
  v_mov_b32 v214, 0
  v_mov_b32 v215, 0
  v_mov_b32 v192, 0
  v_cndmask_b32 v220, v19, v220, vcc
  v_cndmask_b32 v221, v19, v221, vcc
  v_mov_b32 v222, 0
  v_mov_b32 v223, 0
  v_mov_b32 v193, 0
  v_dot2c_f32_bf16 v192, v208, v208
  v_dot2c_f32_bf16 v193, v216, v216
  v_dot2c_f32_bf16 v192, v209, v209
  v_dot2c_f32_bf16 v193, v217, v217
  v_dot2c_f32_bf16 v192, v210, v210
  v_dot2c_f32_bf16 v193, v218, v218
  v_dot2c_f32_bf16 v192, v211, v211
  v_dot2c_f32_bf16 v193, v219, v219
  v_dot2c_f32_bf16 v192, v212, v212
  v_dot2c_f32_bf16 v193, v220, v220
  v_dot2c_f32_bf16 v192, v213, v213
  v_dot2c_f32_bf16 v193, v221, v221
  s_nop 2
  v_mov_b32 v194, v192
  s_nop 1
  v_permlane32_swap_b32 v192, v194
  s_nop 0
  v_add_f32 v192, v192, v194
  v_mov_b32 v194, v193
  s_nop 1
  v_permlane32_swap_b32 v193, v194
  s_nop 0
  v_add_f32 v193, v193, v194
  v_mul_f32 v192, s69, v192
  v_sqrt_f32 v192, v192
  s_nop 0
  v_mul_f32 v192, 0x3f828f5c, v192
  v_add_u32 v192, 0x10000, v192
  v_lshrrev_b32 v192, 16, v192
  v_or_b32 v192, 0x8000, v192
  v_cndmask_b32 v214, v19, v192, vcc
  v_mul_f32 v193, s69, v193
  v_sqrt_f32 v193, v193
  s_nop 0
  v_mul_f32 v193, 0x3f828f5c, v193
  v_add_u32 v193, 0x10000, v193
  v_lshrrev_b32 v193, 16, v193
  v_or_b32 v193, 0x8000, v193
  v_cndmask_b32 v222, v19, v193, vcc
  s_mul_i32 s65, s62, 98304
  s_add_u32 s65, s65, 0x7900000
  s_barrier
  s_mov_b32 s67, 0
  s_add_u32 m0, s67, s72
  s_add_u32 s58, s65, s72
  buffer_load_dwordx4 v2, s[48:51], s58 offen offset:0 sc1 lds
  buffer_load_dwordx4 v2, s[48:51], s58 offen offset:1024 sc1 lds
  buffer_load_dwordx4 v2, s[48:51], s58 offen offset:2048 sc1 lds
  s_add_u32 m0, m0, 12288
  s_add_u32 s58, s58, 3145728
  buffer_load_dwordx4 v2, s[48:51], s58 offen offset:0 sc1 lds
  buffer_load_dwordx4 v2, s[48:51], s58 offen offset:1024 sc1 lds
  buffer_load_dwordx4 v2, s[48:51], s58 offen offset:2048 sc1 lds
  s_add_u32 s65, s65, 12288
  s_mov_b32 s67, 24576
  s_add_u32 m0, s67, s72
  s_add_u32 s58, s65, s72
  buffer_load_dwordx4 v2, s[48:51], s58 offen offset:0 sc1 lds
  buffer_load_dwordx4 v2, s[48:51], s58 offen offset:1024 sc1 lds
  buffer_load_dwordx4 v2, s[48:51], s58 offen offset:2048 sc1 lds
  s_add_u32 m0, m0, 12288
  s_add_u32 s58, s58, 3145728
  buffer_load_dwordx4 v2, s[48:51], s58 offen offset:0 sc1 lds
  buffer_load_dwordx4 v2, s[48:51], s58 offen offset:1024 sc1 lds
  buffer_load_dwordx4 v2, s[48:51], s58 offen offset:2048 sc1 lds
  s_add_u32 s65, s65, 12288
  v_mov_b32 v160, 0
  v_mov_b32 v161, 0
  v_mov_b32 v162, 0
  v_mov_b32 v163, 0
  v_mov_b32 v164, 0
  v_mov_b32 v165, 0
  v_mov_b32 v166, 0
  v_mov_b32 v167, 0
  v_mov_b32 v168, 0
  v_mov_b32 v169, 0
  v_mov_b32 v170, 0
  v_mov_b32 v171, 0
  v_mov_b32 v172, 0
  v_mov_b32 v173, 0
  v_mov_b32 v174, 0
  v_mov_b32 v175, 0
  v_mov_b32 v176, 0
  v_mov_b32 v177, 0
  v_mov_b32 v178, 0
  v_mov_b32 v179, 0
  v_mov_b32 v180, 0
  v_mov_b32 v181, 0
  v_mov_b32 v182, 0
  v_mov_b32 v183, 0
  v_mov_b32 v184, 0
  v_mov_b32 v185, 0
  v_mov_b32 v186, 0
  v_mov_b32 v187, 0
  v_mov_b32 v188, 0
  v_mov_b32 v189, 0
  v_mov_b32 v190, 0
  v_mov_b32 v191, 0
  v_mov_b32 v128, 0
  v_mov_b32 v129, 0
  v_mov_b32 v130, 0
  v_mov_b32 v131, 0
  v_mov_b32 v132, 0
  v_mov_b32 v133, 0
  v_mov_b32 v134, 0
  v_mov_b32 v135, 0
  v_mov_b32 v136, 0
  v_mov_b32 v137, 0
  v_mov_b32 v138, 0
  v_mov_b32 v139, 0
  v_mov_b32 v140, 0
  v_mov_b32 v141, 0
  v_mov_b32 v142, 0
  v_mov_b32 v143, 0
  v_mov_b32 v144, 0
  v_mov_b32 v145, 0
  v_mov_b32 v146, 0
  v_mov_b32 v147, 0
  v_mov_b32 v148, 0
  v_mov_b32 v149, 0
  v_mov_b32 v150, 0
  v_mov_b32 v151, 0
  v_mov_b32 v152, 0
  v_mov_b32 v153, 0
  v_mov_b32 v154, 0
  v_mov_b32 v155, 0
  v_mov_b32 v156, 0
  v_mov_b32 v157, 0
  v_mov_b32 v158, 0
  v_mov_b32 v159, 0
  s_waitcnt vmcnt(6)
  s_barrier
  ds_read_b128 v[32:35], v3 offset:0
  ds_read_b128 v[36:39], v4 offset:0
  ds_read_b64_tr_b16 v[56:57], v5 offset:0
  ds_read_b64_tr_b16 v[58:59], v5 offset:384
  ds_read_b64_tr_b16 v[60:61], v5 offset:768
  ds_read_b64_tr_b16 v[62:63], v5 offset:1152
  s_waitcnt lgkmcnt(4)
  v_mfma_f32_32x32x16_bf16 v[64:79], v[32:35], v[208:211], 0
  v_mfma_f32_32x32x16_bf16 v[64:79], v[36:39], v[212:215], v[64:79]
  v_mfma_f32_32x32x16_bf16 v[80:95], v[32:35], v[216:219], 0
  v_mfma_f32_32x32x16_bf16 v[80:95], v[36:39], v[220:223], v[80:95]
  ds_read_b128 v[40:43], v3 offset:1536
  ds_read_b128 v[44:47], v4 offset:1536
  s_mov_b32 s66, 0
  s_mov_b32 s67, 49152
L_b2_br_m:
  s_waitcnt lgkmcnt(0)
  v_mfma_f32_32x32x16_bf16 v[96:111], v[40:43], v[208:211], 0
  v_exp_f32 v64, v64
  v_exp_f32 v65, v65
  v_exp_f32 v66, v66
  v_exp_f32 v67, v67
  v_cvt_pk_bf16_f32 v128, v64, v65
  v_exp_f32 v68, v68
  v_mfma_f32_32x32x16_bf16 v[160:175], v[56:59], v[144:147], v[160:175]
  ds_read_b64_tr_b16 v[48:49], v5 offset:0
  ds_read_b64_tr_b16 v[50:51], v5 offset:384
  ds_read_b64_tr_b16 v[52:53], v5 offset:768
  ds_read_b64_tr_b16 v[54:55], v5 offset:1152
  v_exp_f32 v69, v69
  v_cvt_pk_bf16_f32 v129, v66, v67
  v_exp_f32 v70, v70
  v_exp_f32 v71, v71
  v_cvt_pk_bf16_f32 v130, v68, v69
  v_exp_f32 v72, v72
  v_mfma_f32_32x32x16_bf16 v[112:127], v[40:43], v[216:219], 0
  v_exp_f32 v73, v73
  v_cvt_pk_bf16_f32 v131, v70, v71
  v_exp_f32 v74, v74
  v_exp_f32 v75, v75
  v_cvt_pk_bf16_f32 v132, v72, v73
  v_exp_f32 v76, v76
  v_mfma_f32_32x32x16_bf16 v[176:191], v[56:59], v[152:155], v[176:191]
  v_exp_f32 v77, v77
  v_cvt_pk_bf16_f32 v133, v74, v75
  v_exp_f32 v78, v78
  v_exp_f32 v79, v79
  v_cvt_pk_bf16_f32 v134, v76, v77
  v_exp_f32 v80, v80
  v_mfma_f32_32x32x16_bf16 v[96:111], v[44:47], v[212:215], v[96:111]
  v_exp_f32 v81, v81
  v_cvt_pk_bf16_f32 v135, v78, v79
  v_exp_f32 v82, v82
  v_exp_f32 v83, v83
  v_cvt_pk_bf16_f32 v136, v80, v81
  v_exp_f32 v84, v84
  v_mfma_f32_32x32x16_bf16 v[160:175], v[60:63], v[148:151], v[160:175]
  v_exp_f32 v85, v85
  v_cvt_pk_bf16_f32 v137, v82, v83
  v_exp_f32 v86, v86
  v_exp_f32 v87, v87
  v_cvt_pk_bf16_f32 v138, v84, v85
  v_exp_f32 v88, v88
  v_mfma_f32_32x32x16_bf16 v[112:127], v[44:47], v[220:223], v[112:127]
  ds_read_b128 v[32:35], v3 offset:3072
  ds_read_b128 v[36:39], v4 offset:3072
  v_exp_f32 v89, v89
  v_cvt_pk_bf16_f32 v139, v86, v87
  v_exp_f32 v90, v90
  v_exp_f32 v91, v91
  v_cvt_pk_bf16_f32 v140, v88, v89
  v_exp_f32 v92, v92
  v_mfma_f32_32x32x16_bf16 v[176:191], v[60:63], v[156:159], v[176:191]
  v_exp_f32 v93, v93
  v_cvt_pk_bf16_f32 v141, v90, v91
  v_exp_f32 v94, v94
  v_exp_f32 v95, v95
  v_cvt_pk_bf16_f32 v142, v92, v93
  v_cvt_pk_bf16_f32 v143, v94, v95
  s_waitcnt lgkmcnt(0)
  v_mfma_f32_32x32x16_bf16 v[64:79], v[32:35], v[208:211], 0
  v_exp_f32 v96, v96
  v_exp_f32 v97, v97
  v_exp_f32 v98, v98
  v_exp_f32 v99, v99
  v_cvt_pk_bf16_f32 v144, v96, v97
  v_exp_f32 v100, v100
  v_mfma_f32_32x32x16_bf16 v[160:175], v[48:51], v[128:131], v[160:175]
  ds_read_b64_tr_b16 v[56:57], v5 offset:1536
  ds_read_b64_tr_b16 v[58:59], v5 offset:1920
  ds_read_b64_tr_b16 v[60:61], v5 offset:2304
  ds_read_b64_tr_b16 v[62:63], v5 offset:2688
  v_exp_f32 v101, v101
  v_cvt_pk_bf16_f32 v145, v98, v99
  v_exp_f32 v102, v102
  v_exp_f32 v103, v103
  v_cvt_pk_bf16_f32 v146, v100, v101
  v_exp_f32 v104, v104
  v_mfma_f32_32x32x16_bf16 v[80:95], v[32:35], v[216:219], 0
  v_exp_f32 v105, v105
  v_cvt_pk_bf16_f32 v147, v102, v103
  v_exp_f32 v106, v106
  v_exp_f32 v107, v107
  v_cvt_pk_bf16_f32 v148, v104, v105
  v_exp_f32 v108, v108
  v_mfma_f32_32x32x16_bf16 v[176:191], v[48:51], v[136:139], v[176:191]
  v_exp_f32 v109, v109
  v_cvt_pk_bf16_f32 v149, v106, v107
  v_exp_f32 v110, v110
  v_exp_f32 v111, v111
  v_cvt_pk_bf16_f32 v150, v108, v109
  v_exp_f32 v112, v112
  v_mfma_f32_32x32x16_bf16 v[64:79], v[36:39], v[212:215], v[64:79]
  v_exp_f32 v113, v113
  v_cvt_pk_bf16_f32 v151, v110, v111
  v_exp_f32 v114, v114
  v_exp_f32 v115, v115
  v_cvt_pk_bf16_f32 v152, v112, v113
  v_exp_f32 v116, v116
  v_mfma_f32_32x32x16_bf16 v[160:175], v[52:55], v[132:135], v[160:175]
  v_exp_f32 v117, v117
  v_cvt_pk_bf16_f32 v153, v114, v115
  v_exp_f32 v118, v118
  v_exp_f32 v119, v119
  v_cvt_pk_bf16_f32 v154, v116, v117
  v_exp_f32 v120, v120
  v_mfma_f32_32x32x16_bf16 v[80:95], v[36:39], v[220:223], v[80:95]
  ds_read_b128 v[40:43], v3 offset:4608
  ds_read_b128 v[44:47], v4 offset:4608
  v_exp_f32 v121, v121
  v_cvt_pk_bf16_f32 v155, v118, v119
  v_exp_f32 v122, v122
  v_exp_f32 v123, v123
  v_cvt_pk_bf16_f32 v156, v120, v121
  v_exp_f32 v124, v124
  v_mfma_f32_32x32x16_bf16 v[176:191], v[52:55], v[140:143], v[176:191]
  v_exp_f32 v125, v125
  v_cvt_pk_bf16_f32 v157, v122, v123
  v_exp_f32 v126, v126
  v_exp_f32 v127, v127
  v_cvt_pk_bf16_f32 v158, v124, v125
  v_cvt_pk_bf16_f32 v159, v126, v127
  s_waitcnt lgkmcnt(0)
  v_mfma_f32_32x32x16_bf16 v[96:111], v[40:43], v[208:211], 0
  v_exp_f32 v64, v64
  v_exp_f32 v65, v65
  v_exp_f32 v66, v66
  v_exp_f32 v67, v67
  v_cvt_pk_bf16_f32 v128, v64, v65
  v_exp_f32 v68, v68
  v_mfma_f32_32x32x16_bf16 v[160:175], v[56:59], v[144:147], v[160:175]
  ds_read_b64_tr_b16 v[48:49], v5 offset:3072
  ds_read_b64_tr_b16 v[50:51], v5 offset:3456
  ds_read_b64_tr_b16 v[52:53], v5 offset:3840
  ds_read_b64_tr_b16 v[54:55], v5 offset:4224
  v_exp_f32 v69, v69
  v_cvt_pk_bf16_f32 v129, v66, v67
  v_exp_f32 v70, v70
  v_exp_f32 v71, v71
  v_cvt_pk_bf16_f32 v130, v68, v69
  v_exp_f32 v72, v72
  v_mfma_f32_32x32x16_bf16 v[112:127], v[40:43], v[216:219], 0
  v_exp_f32 v73, v73
  v_cvt_pk_bf16_f32 v131, v70, v71
  v_exp_f32 v74, v74
  v_exp_f32 v75, v75
  v_cvt_pk_bf16_f32 v132, v72, v73
  v_exp_f32 v76, v76
  v_mfma_f32_32x32x16_bf16 v[176:191], v[56:59], v[152:155], v[176:191]
  v_exp_f32 v77, v77
  v_cvt_pk_bf16_f32 v133, v74, v75
  v_exp_f32 v78, v78
  v_exp_f32 v79, v79
  v_cvt_pk_bf16_f32 v134, v76, v77
  v_exp_f32 v80, v80
  v_mfma_f32_32x32x16_bf16 v[96:111], v[44:47], v[212:215], v[96:111]
  v_exp_f32 v81, v81
  v_cvt_pk_bf16_f32 v135, v78, v79
  v_exp_f32 v82, v82
  v_exp_f32 v83, v83
  v_cvt_pk_bf16_f32 v136, v80, v81
  v_exp_f32 v84, v84
  v_mfma_f32_32x32x16_bf16 v[160:175], v[60:63], v[148:151], v[160:175]
  v_exp_f32 v85, v85
  v_cvt_pk_bf16_f32 v137, v82, v83
  v_exp_f32 v86, v86
  v_exp_f32 v87, v87
  v_cvt_pk_bf16_f32 v138, v84, v85
  v_exp_f32 v88, v88
  v_mfma_f32_32x32x16_bf16 v[112:127], v[44:47], v[220:223], v[112:127]
  ds_read_b128 v[32:35], v3 offset:6144
  ds_read_b128 v[36:39], v4 offset:6144
  v_exp_f32 v89, v89
  v_cvt_pk_bf16_f32 v139, v86, v87
  v_exp_f32 v90, v90
  v_exp_f32 v91, v91
  v_cvt_pk_bf16_f32 v140, v88, v89
  v_exp_f32 v92, v92
  v_mfma_f32_32x32x16_bf16 v[176:191], v[60:63], v[156:159], v[176:191]
  v_exp_f32 v93, v93
  v_cvt_pk_bf16_f32 v141, v90, v91
  v_exp_f32 v94, v94
  v_exp_f32 v95, v95
  v_cvt_pk_bf16_f32 v142, v92, v93
  v_cvt_pk_bf16_f32 v143, v94, v95
  s_waitcnt lgkmcnt(0)
  v_mfma_f32_32x32x16_bf16 v[64:79], v[32:35], v[208:211], 0
  v_exp_f32 v96, v96
  v_exp_f32 v97, v97
  v_exp_f32 v98, v98
  v_exp_f32 v99, v99
  v_cvt_pk_bf16_f32 v144, v96, v97
  v_exp_f32 v100, v100
  v_mfma_f32_32x32x16_bf16 v[160:175], v[48:51], v[128:131], v[160:175]
  ds_read_b64_tr_b16 v[56:57], v5 offset:4608
  ds_read_b64_tr_b16 v[58:59], v5 offset:4992
  ds_read_b64_tr_b16 v[60:61], v5 offset:5376
  ds_read_b64_tr_b16 v[62:63], v5 offset:5760
  v_exp_f32 v101, v101
  v_cvt_pk_bf16_f32 v145, v98, v99
  v_exp_f32 v102, v102
  v_exp_f32 v103, v103
  v_cvt_pk_bf16_f32 v146, v100, v101
  v_exp_f32 v104, v104
  v_mfma_f32_32x32x16_bf16 v[80:95], v[32:35], v[216:219], 0
  v_exp_f32 v105, v105
  v_cvt_pk_bf16_f32 v147, v102, v103
  v_exp_f32 v106, v106
  v_exp_f32 v107, v107
  v_cvt_pk_bf16_f32 v148, v104, v105
  v_exp_f32 v108, v108
  v_mfma_f32_32x32x16_bf16 v[176:191], v[48:51], v[136:139], v[176:191]
  v_exp_f32 v109, v109
  v_cvt_pk_bf16_f32 v149, v106, v107
  v_exp_f32 v110, v110
  v_exp_f32 v111, v111
  v_cvt_pk_bf16_f32 v150, v108, v109
  v_exp_f32 v112, v112
  v_mfma_f32_32x32x16_bf16 v[64:79], v[36:39], v[212:215], v[64:79]
  v_exp_f32 v113, v113
  v_cvt_pk_bf16_f32 v151, v110, v111
  v_exp_f32 v114, v114
  v_exp_f32 v115, v115
  v_cvt_pk_bf16_f32 v152, v112, v113
  v_exp_f32 v116, v116
  v_mfma_f32_32x32x16_bf16 v[160:175], v[52:55], v[132:135], v[160:175]
  v_exp_f32 v117, v117
  v_cvt_pk_bf16_f32 v153, v114, v115
  v_exp_f32 v118, v118
  v_exp_f32 v119, v119
  v_cvt_pk_bf16_f32 v154, v116, v117
  v_exp_f32 v120, v120
  v_mfma_f32_32x32x16_bf16 v[80:95], v[36:39], v[220:223], v[80:95]
  ds_read_b128 v[40:43], v3 offset:7680
  ds_read_b128 v[44:47], v4 offset:7680
  v_exp_f32 v121, v121
  v_cvt_pk_bf16_f32 v155, v118, v119
  v_exp_f32 v122, v122
  v_exp_f32 v123, v123
  v_cvt_pk_bf16_f32 v156, v120, v121
  v_exp_f32 v124, v124
  v_mfma_f32_32x32x16_bf16 v[176:191], v[52:55], v[140:143], v[176:191]
  v_exp_f32 v125, v125
  v_cvt_pk_bf16_f32 v157, v122, v123
  v_exp_f32 v126, v126
  v_exp_f32 v127, v127
  v_cvt_pk_bf16_f32 v158, v124, v125
  v_cvt_pk_bf16_f32 v159, v126, v127
  s_waitcnt lgkmcnt(0)
  v_mfma_f32_32x32x16_bf16 v[96:111], v[40:43], v[208:211], 0
  v_exp_f32 v64, v64
  v_exp_f32 v65, v65
  v_exp_f32 v66, v66
  v_exp_f32 v67, v67
  v_cvt_pk_bf16_f32 v128, v64, v65
  v_exp_f32 v68, v68
  v_mfma_f32_32x32x16_bf16 v[160:175], v[56:59], v[144:147], v[160:175]
  ds_read_b64_tr_b16 v[48:49], v5 offset:6144
  ds_read_b64_tr_b16 v[50:51], v5 offset:6528
  ds_read_b64_tr_b16 v[52:53], v5 offset:6912
  ds_read_b64_tr_b16 v[54:55], v5 offset:7296
  v_exp_f32 v69, v69
  v_cvt_pk_bf16_f32 v129, v66, v67
  v_exp_f32 v70, v70
  v_exp_f32 v71, v71
  v_cvt_pk_bf16_f32 v130, v68, v69
  v_exp_f32 v72, v72
  v_mfma_f32_32x32x16_bf16 v[112:127], v[40:43], v[216:219], 0
  v_exp_f32 v73, v73
  v_cvt_pk_bf16_f32 v131, v70, v71
  v_exp_f32 v74, v74
  v_exp_f32 v75, v75
  v_cvt_pk_bf16_f32 v132, v72, v73
  v_exp_f32 v76, v76
  v_mfma_f32_32x32x16_bf16 v[176:191], v[56:59], v[152:155], v[176:191]
  v_exp_f32 v77, v77
  v_cvt_pk_bf16_f32 v133, v74, v75
  v_exp_f32 v78, v78
  v_exp_f32 v79, v79
  v_cvt_pk_bf16_f32 v134, v76, v77
  v_exp_f32 v80, v80
  v_mfma_f32_32x32x16_bf16 v[96:111], v[44:47], v[212:215], v[96:111]
  v_exp_f32 v81, v81
  v_cvt_pk_bf16_f32 v135, v78, v79
  v_exp_f32 v82, v82
  v_exp_f32 v83, v83
  v_cvt_pk_bf16_f32 v136, v80, v81
  v_exp_f32 v84, v84
  v_mfma_f32_32x32x16_bf16 v[160:175], v[60:63], v[148:151], v[160:175]
  v_exp_f32 v85, v85
  v_cvt_pk_bf16_f32 v137, v82, v83
  v_exp_f32 v86, v86
  v_exp_f32 v87, v87
  v_cvt_pk_bf16_f32 v138, v84, v85
  v_exp_f32 v88, v88
  v_mfma_f32_32x32x16_bf16 v[112:127], v[44:47], v[220:223], v[112:127]
  ds_read_b128 v[32:35], v3 offset:9216
  ds_read_b128 v[36:39], v4 offset:9216
  v_exp_f32 v89, v89
  v_cvt_pk_bf16_f32 v139, v86, v87
  v_exp_f32 v90, v90
  v_exp_f32 v91, v91
  v_cvt_pk_bf16_f32 v140, v88, v89
  v_exp_f32 v92, v92
  v_mfma_f32_32x32x16_bf16 v[176:191], v[60:63], v[156:159], v[176:191]
  v_exp_f32 v93, v93
  v_cvt_pk_bf16_f32 v141, v90, v91
  v_exp_f32 v94, v94
  v_exp_f32 v95, v95
  v_cvt_pk_bf16_f32 v142, v92, v93
  v_cvt_pk_bf16_f32 v143, v94, v95
  s_waitcnt lgkmcnt(0)
  v_mfma_f32_32x32x16_bf16 v[64:79], v[32:35], v[208:211], 0
  v_exp_f32 v96, v96
  v_exp_f32 v97, v97
  v_exp_f32 v98, v98
  v_exp_f32 v99, v99
  v_cvt_pk_bf16_f32 v144, v96, v97
  v_exp_f32 v100, v100
  v_mfma_f32_32x32x16_bf16 v[160:175], v[48:51], v[128:131], v[160:175]
  ds_read_b64_tr_b16 v[56:57], v5 offset:7680
  ds_read_b64_tr_b16 v[58:59], v5 offset:8064
  ds_read_b64_tr_b16 v[60:61], v5 offset:8448
  ds_read_b64_tr_b16 v[62:63], v5 offset:8832
  v_exp_f32 v101, v101
  v_cvt_pk_bf16_f32 v145, v98, v99
  v_exp_f32 v102, v102
  v_exp_f32 v103, v103
  v_cvt_pk_bf16_f32 v146, v100, v101
  v_exp_f32 v104, v104
  v_mfma_f32_32x32x16_bf16 v[80:95], v[32:35], v[216:219], 0
  v_exp_f32 v105, v105
  v_cvt_pk_bf16_f32 v147, v102, v103
  v_exp_f32 v106, v106
  v_exp_f32 v107, v107
  v_cvt_pk_bf16_f32 v148, v104, v105
  v_exp_f32 v108, v108
  v_mfma_f32_32x32x16_bf16 v[176:191], v[48:51], v[136:139], v[176:191]
  v_exp_f32 v109, v109
  v_cvt_pk_bf16_f32 v149, v106, v107
  v_exp_f32 v110, v110
  v_exp_f32 v111, v111
  v_cvt_pk_bf16_f32 v150, v108, v109
  v_exp_f32 v112, v112
  v_mfma_f32_32x32x16_bf16 v[64:79], v[36:39], v[212:215], v[64:79]
  v_exp_f32 v113, v113
  v_cvt_pk_bf16_f32 v151, v110, v111
  v_exp_f32 v114, v114
  v_exp_f32 v115, v115
  v_cvt_pk_bf16_f32 v152, v112, v113
  v_exp_f32 v116, v116
  v_mfma_f32_32x32x16_bf16 v[160:175], v[52:55], v[132:135], v[160:175]
  v_exp_f32 v117, v117
  v_cvt_pk_bf16_f32 v153, v114, v115
  v_exp_f32 v118, v118
  v_exp_f32 v119, v119
  v_cvt_pk_bf16_f32 v154, v116, v117
  v_exp_f32 v120, v120
  v_mfma_f32_32x32x16_bf16 v[80:95], v[36:39], v[220:223], v[80:95]
  ds_read_b128 v[40:43], v3 offset:10752
  ds_read_b128 v[44:47], v4 offset:10752
  v_exp_f32 v121, v121
  v_cvt_pk_bf16_f32 v155, v118, v119
  v_exp_f32 v122, v122
  v_exp_f32 v123, v123
  v_cvt_pk_bf16_f32 v156, v120, v121
  v_exp_f32 v124, v124
  v_mfma_f32_32x32x16_bf16 v[176:191], v[52:55], v[140:143], v[176:191]
  v_exp_f32 v125, v125
  v_cvt_pk_bf16_f32 v157, v122, v123
  v_exp_f32 v126, v126
  v_exp_f32 v127, v127
  v_cvt_pk_bf16_f32 v158, v124, v125
  v_cvt_pk_bf16_f32 v159, v126, v127
  s_waitcnt lgkmcnt(0)
  v_mfma_f32_32x32x16_bf16 v[96:111], v[40:43], v[208:211], 0
  v_exp_f32 v64, v64
  v_exp_f32 v65, v65
  v_exp_f32 v66, v66
  v_exp_f32 v67, v67
  v_cvt_pk_bf16_f32 v128, v64, v65
  v_exp_f32 v68, v68
  v_mfma_f32_32x32x16_bf16 v[160:175], v[56:59], v[144:147], v[160:175]
  ds_read_b64_tr_b16 v[48:49], v5 offset:9216
  ds_read_b64_tr_b16 v[50:51], v5 offset:9600
  ds_read_b64_tr_b16 v[52:53], v5 offset:9984
  ds_read_b64_tr_b16 v[54:55], v5 offset:10368
  v_exp_f32 v69, v69
  v_cvt_pk_bf16_f32 v129, v66, v67
  v_exp_f32 v70, v70
  v_exp_f32 v71, v71
  v_cvt_pk_bf16_f32 v130, v68, v69
  v_exp_f32 v72, v72
  v_mfma_f32_32x32x16_bf16 v[112:127], v[40:43], v[216:219], 0
  v_exp_f32 v73, v73
  v_cvt_pk_bf16_f32 v131, v70, v71
  v_exp_f32 v74, v74
  v_exp_f32 v75, v75
  v_cvt_pk_bf16_f32 v132, v72, v73
  v_exp_f32 v76, v76
  v_mfma_f32_32x32x16_bf16 v[176:191], v[56:59], v[152:155], v[176:191]
  v_exp_f32 v77, v77
  v_cvt_pk_bf16_f32 v133, v74, v75
  v_exp_f32 v78, v78
  v_exp_f32 v79, v79
  v_cvt_pk_bf16_f32 v134, v76, v77
  v_exp_f32 v80, v80
  v_mfma_f32_32x32x16_bf16 v[96:111], v[44:47], v[212:215], v[96:111]
  v_exp_f32 v81, v81
  v_cvt_pk_bf16_f32 v135, v78, v79
  v_exp_f32 v82, v82
  v_exp_f32 v83, v83
  v_cvt_pk_bf16_f32 v136, v80, v81
  v_exp_f32 v84, v84
  v_mfma_f32_32x32x16_bf16 v[160:175], v[60:63], v[148:151], v[160:175]
  v_exp_f32 v85, v85
  v_cvt_pk_bf16_f32 v137, v82, v83
  v_exp_f32 v86, v86
  v_exp_f32 v87, v87
  v_cvt_pk_bf16_f32 v138, v84, v85
  v_exp_f32 v88, v88
  v_mfma_f32_32x32x16_bf16 v[112:127], v[44:47], v[220:223], v[112:127]
  s_waitcnt vmcnt(0)
  s_barrier
  s_cmp_ge_u32 s66, 6
  s_cbranch_scc1 b2nd_7064
  s_add_u32 m0, s67, s72
  s_add_u32 s58, s65, s72
  buffer_load_dwordx4 v2, s[48:51], s58 offen offset:0 sc1 lds
  buffer_load_dwordx4 v2, s[48:51], s58 offen offset:1024 sc1 lds
  buffer_load_dwordx4 v2, s[48:51], s58 offen offset:2048 sc1 lds
  s_add_u32 m0, m0, 12288
  s_add_u32 s58, s58, 3145728
  buffer_load_dwordx4 v2, s[48:51], s58 offen offset:0 sc1 lds
  buffer_load_dwordx4 v2, s[48:51], s58 offen offset:1024 sc1 lds
  buffer_load_dwordx4 v2, s[48:51], s58 offen offset:2048 sc1 lds
  s_add_u32 s65, s65, 12288
b2nd_7064:
  s_add_u32 s67, s67, 24576
  s_cmp_eq_u32 s67, 73728
  s_cselect_b32 s67, 0, s67
  s_add_u32 s68, s68, 24576
  s_cmp_eq_u32 s68, 73728
  s_mov_b32 s59, 24576
  s_cselect_b32 s58, 0xffff4000, s59
  s_cselect_b32 s68, 0, s68
  v_add_u32 v3, s58, v3
  v_add_u32 v4, s58, v4
  s_mov_b32 s59, s58
  ds_read_b128 v[32:35], v3 offset:0
  ds_read_b128 v[36:39], v4 offset:0
  v_exp_f32 v89, v89
  v_cvt_pk_bf16_f32 v139, v86, v87
  v_exp_f32 v90, v90
  v_exp_f32 v91, v91
  v_cvt_pk_bf16_f32 v140, v88, v89
  v_exp_f32 v92, v92
  v_mfma_f32_32x32x16_bf16 v[176:191], v[60:63], v[156:159], v[176:191]
  v_exp_f32 v93, v93
  v_cvt_pk_bf16_f32 v141, v90, v91
  v_exp_f32 v94, v94
  v_exp_f32 v95, v95
  v_cvt_pk_bf16_f32 v142, v92, v93
  v_cvt_pk_bf16_f32 v143, v94, v95
  s_waitcnt lgkmcnt(0)
  v_mfma_f32_32x32x16_bf16 v[64:79], v[32:35], v[208:211], 0
  v_exp_f32 v96, v96
  v_exp_f32 v97, v97
  v_exp_f32 v98, v98
  v_exp_f32 v99, v99
  v_cvt_pk_bf16_f32 v144, v96, v97
  v_exp_f32 v100, v100
  v_mfma_f32_32x32x16_bf16 v[160:175], v[48:51], v[128:131], v[160:175]
  ds_read_b64_tr_b16 v[56:57], v5 offset:10752
  ds_read_b64_tr_b16 v[58:59], v5 offset:11136
  ds_read_b64_tr_b16 v[60:61], v5 offset:11520
  ds_read_b64_tr_b16 v[62:63], v5 offset:11904
  v_exp_f32 v101, v101
  v_cvt_pk_bf16_f32 v145, v98, v99
  v_exp_f32 v102, v102
  v_exp_f32 v103, v103
  v_cvt_pk_bf16_f32 v146, v100, v101
  v_exp_f32 v104, v104
  v_mfma_f32_32x32x16_bf16 v[80:95], v[32:35], v[216:219], 0
  v_exp_f32 v105, v105
  v_cvt_pk_bf16_f32 v147, v102, v103
  v_exp_f32 v106, v106
  v_exp_f32 v107, v107
  v_cvt_pk_bf16_f32 v148, v104, v105
  v_exp_f32 v108, v108
  v_mfma_f32_32x32x16_bf16 v[176:191], v[48:51], v[136:139], v[176:191]
  v_exp_f32 v109, v109
  v_cvt_pk_bf16_f32 v149, v106, v107
  v_exp_f32 v110, v110
  v_exp_f32 v111, v111
  v_cvt_pk_bf16_f32 v150, v108, v109
  v_exp_f32 v112, v112
  v_mfma_f32_32x32x16_bf16 v[64:79], v[36:39], v[212:215], v[64:79]
  v_exp_f32 v113, v113
  v_cvt_pk_bf16_f32 v151, v110, v111
  v_exp_f32 v114, v114
  v_exp_f32 v115, v115
  v_cvt_pk_bf16_f32 v152, v112, v113
  v_exp_f32 v116, v116
  v_mfma_f32_32x32x16_bf16 v[160:175], v[52:55], v[132:135], v[160:175]
  v_exp_f32 v117, v117
  v_cvt_pk_bf16_f32 v153, v114, v115
  v_exp_f32 v118, v118
  v_exp_f32 v119, v119
  v_cvt_pk_bf16_f32 v154, v116, v117
  v_exp_f32 v120, v120
  v_mfma_f32_32x32x16_bf16 v[80:95], v[36:39], v[220:223], v[80:95]
  ds_read_b128 v[40:43], v3 offset:1536
  ds_read_b128 v[44:47], v4 offset:1536
  v_exp_f32 v121, v121
  v_cvt_pk_bf16_f32 v155, v118, v119
  v_exp_f32 v122, v122
  v_exp_f32 v123, v123
  v_cvt_pk_bf16_f32 v156, v120, v121
  v_exp_f32 v124, v124
  v_mfma_f32_32x32x16_bf16 v[176:191], v[52:55], v[140:143], v[176:191]
  v_exp_f32 v125, v125
  v_cvt_pk_bf16_f32 v157, v122, v123
  v_exp_f32 v126, v126
  v_exp_f32 v127, v127
  v_cvt_pk_bf16_f32 v158, v124, v125
  v_cvt_pk_bf16_f32 v159, v126, v127
  v_add_u32 v5, s59, v5
  s_add_u32 s66, s66, 1
  s_cmp_lt_u32 s66, 8
  s_cbranch_scc1 L_b2_br_m
  s_waitcnt lgkmcnt(0)
  s_nop 1
  v_mfma_f32_32x32x16_bf16 v[160:175], v[56:59], v[144:147], v[160:175]
  v_mfma_f32_32x32x16_bf16 v[160:175], v[60:63], v[148:151], v[160:175]
  v_mfma_f32_32x32x16_bf16 v[176:191], v[56:59], v[152:155], v[176:191]
  v_mfma_f32_32x32x16_bf16 v[176:191], v[60:63], v[156:159], v[176:191]
  v_subrev_u32 v3, s68, v3
  v_subrev_u32 v4, s68, v4
  v_subrev_u32 v5, s68, v5
  s_mov_b32 s68, 0
  s_nop 7
  s_nop 1
  v_mov_b32 v18, 0x1f800000
  v_mov_b32 v19, 0x71800000
  v_cmp_nle_f32 vcc, v18, v168
  s_mov_b64 s[58:59], vcc
  v_cmp_nle_f32 vcc, v18, v184
  s_or_b64 s[58:59], s[58:59], vcc
  v_cmp_nge_f32 vcc, v19, v168
  s_or_b64 s[58:59], s[58:59], vcc
  v_cmp_nge_f32 vcc, v19, v184
  s_or_b64 s[58:59], s[58:59], vcc
  s_cmp_lg_u32 s59, 0
  s_cselect_b32 s58, 1, 0
  v_mov_b32 v18, 73732
  v_mov_b32 v19, s58
  ds_max_u32 v18, v19
  s_waitcnt lgkmcnt(0)
  s_barrier
  ds_read_b32 v19, v18
  s_waitcnt lgkmcnt(0)
  v_readfirstlane_b32 s58, v19
  s_barrier
  v_mov_b32 v19, 0
  ds_write_b32 v18, v19
  s_cmp_lg_u32 s58, 0
  s_cbranch_scc1 L_b2fb_br
L_b2st_br:
  v_mov_b32 v18, v168
  v_mov_b32 v19, v168
  s_nop 1
  v_permlane32_swap_b32 v18, v19
  s_nop 0
  v_rcp_f32 v18, v19
  s_nop 0
  v_mul_f32 v160, v160, v18
  v_mul_f32 v161, v161, v18
  v_mul_f32 v162, v162, v18
  v_mul_f32 v163, v163, v18
  v_mul_f32 v164, v164, v18
  v_mul_f32 v165, v165, v18
  v_mul_f32 v166, v166, v18
  v_mul_f32 v167, v167, v18
  v_mul_f32 v168, v168, v18
  v_mul_f32 v169, v169, v18
  v_mul_f32 v170, v170, v18
  v_mul_f32 v171, v171, v18
  v_cvt_pk_bf16_f32 v160, v160, v161
  v_cvt_pk_bf16_f32 v161, v162, v163
  v_cvt_pk_bf16_f32 v164, v164, v165
  v_cvt_pk_bf16_f32 v165, v166, v167
  v_cvt_pk_bf16_f32 v168, v168, v169
  v_cvt_pk_bf16_f32 v169, v170, v171
  s_add_u32 s58, s71, 0
  buffer_store_dwordx2 v[160:161], v7, s[48:51], s58 offen offset:0 sc1
  buffer_store_dwordx2 v[164:165], v7, s[48:51], s58 offen offset:16 sc1
  s_mov_b32 exec_hi, 0
  buffer_store_dwordx2 v[168:169], v7, s[48:51], s58 offen offset:32 sc1
  s_mov_b64 exec, -1
  v_mov_b32 v18, v184
  v_mov_b32 v19, v184
  s_nop 1
  v_permlane32_swap_b32 v18, v19
  s_nop 0
  v_rcp_f32 v18, v19
  s_nop 0
  v_mul_f32 v176, v176, v18
  v_mul_f32 v177, v177, v18
  v_mul_f32 v178, v178, v18
  v_mul_f32 v179, v179, v18
  v_mul_f32 v180, v180, v18
  v_mul_f32 v181, v181, v18
  v_mul_f32 v182, v182, v18
  v_mul_f32 v183, v183, v18
  v_mul_f32 v184, v184, v18
  v_mul_f32 v185, v185, v18
  v_mul_f32 v186, v186, v18
  v_mul_f32 v187, v187, v18
  v_cvt_pk_bf16_f32 v176, v176, v177
  v_cvt_pk_bf16_f32 v177, v178, v179
  v_cvt_pk_bf16_f32 v180, v180, v181
  v_cvt_pk_bf16_f32 v181, v182, v183
  v_cvt_pk_bf16_f32 v184, v184, v185
  v_cvt_pk_bf16_f32 v185, v186, v187
  s_add_u32 s58, s71, 40960
  buffer_store_dwordx2 v[176:177], v7, s[48:51], s58 offen offset:0 sc1
  buffer_store_dwordx2 v[180:181], v7, s[48:51], s58 offen offset:16 sc1
  s_mov_b32 exec_hi, 0
  buffer_store_dwordx2 v[184:185], v7, s[48:51], s58 offen offset:32 sc1
  s_mov_b64 exec, -1
  s_add_u32 s63, s63, 1
  s_sub_u32 s64, s64, 1
  s_cmp_lg_u32 s64, 0
  s_cbranch_scc1 L_b2_br
  s_branch L_b2_br_end
L_b2fb_br:
  v_mov_b32 v214, 0
  v_mov_b32 v8, 0xff7fffff
  v_mov_b32 v222, 0
  v_mov_b32 v9, 0xff7fffff
  v_mov_b32 v160, 0
  v_mov_b32 v161, 0
  v_mov_b32 v162, 0
  v_mov_b32 v163, 0
  v_mov_b32 v164, 0
  v_mov_b32 v165, 0
  v_mov_b32 v166, 0
  v_mov_b32 v167, 0
  v_mov_b32 v168, 0
  v_mov_b32 v169, 0
  v_mov_b32 v170, 0
  v_mov_b32 v171, 0
  v_mov_b32 v172, 0
  v_mov_b32 v173, 0
  v_mov_b32 v174, 0
  v_mov_b32 v175, 0
  v_mov_b32 v176, 0
  v_mov_b32 v177, 0
  v_mov_b32 v178, 0
  v_mov_b32 v179, 0
  v_mov_b32 v180, 0
  v_mov_b32 v181, 0
  v_mov_b32 v182, 0
  v_mov_b32 v183, 0
  v_mov_b32 v184, 0
  v_mov_b32 v185, 0
  v_mov_b32 v186, 0
  v_mov_b32 v187, 0
  v_mov_b32 v188, 0
  v_mov_b32 v189, 0
  v_mov_b32 v190, 0
  v_mov_b32 v191, 0
  s_mul_i32 s65, s62, 98304
  s_add_u32 s65, s65, 0x7900000
  s_mov_b32 s66, 0
  s_mov_b32 s67, 0
L_b2fb_br_c0:
  s_waitcnt lgkmcnt(0)
  s_barrier
  s_add_u32 m0, s67, s72
  s_add_u32 s58, s65, s72
  buffer_load_dwordx4 v2, s[48:51], s58 offen offset:0 sc1 lds
  buffer_load_dwordx4 v2, s[48:51], s58 offen offset:1024 sc1 lds
  buffer_load_dwordx4 v2, s[48:51], s58 offen offset:2048 sc1 lds
  s_add_u32 m0, m0, 12288
  s_add_u32 s58, s58, 3145728
  buffer_load_dwordx4 v2, s[48:51], s58 offen offset:0 sc1 lds
  buffer_load_dwordx4 v2, s[48:51], s58 offen offset:1024 sc1 lds
  buffer_load_dwordx4 v2, s[48:51], s58 offen offset:2048 sc1 lds
  s_add_u32 s65, s65, 12288
  s_waitcnt vmcnt(0)
  s_barrier
  v_mov_b32 v192, v3
  v_mov_b32 v193, v4
  v_mov_b32 v194, v5
  s_mov_b32 s60, 0
L_b2fb_br_t0:
  ds_read_b128 v[32:35], v192
  ds_read_b128 v[36:39], v193
  s_waitcnt lgkmcnt(0)
  v_mfma_f32_32x32x16_bf16 v[64:79], v[32:35], v[208:211], 0
  v_mfma_f32_32x32x16_bf16 v[64:79], v[36:39], v[212:215], v[64:79]
  v_mfma_f32_32x32x16_bf16 v[80:95], v[32:35], v[216:219], 0
  v_mfma_f32_32x32x16_bf16 v[80:95], v[36:39], v[220:223], v[80:95]
  s_nop 7
  s_nop 7
  v_max3_f32 v8, v8, v64, v65
  v_max3_f32 v8, v8, v66, v67
  v_max3_f32 v8, v8, v68, v69
  v_max3_f32 v8, v8, v70, v71
  v_max3_f32 v8, v8, v72, v73
  v_max3_f32 v8, v8, v74, v75
  v_max3_f32 v8, v8, v76, v77
  v_max3_f32 v8, v8, v78, v79
  v_max3_f32 v9, v9, v80, v81
  v_max3_f32 v9, v9, v82, v83
  v_max3_f32 v9, v9, v84, v85
  v_max3_f32 v9, v9, v86, v87
  v_max3_f32 v9, v9, v88, v89
  v_max3_f32 v9, v9, v90, v91
  v_max3_f32 v9, v9, v92, v93
  v_max3_f32 v9, v9, v94, v95
  v_add_u32 v192, 1536, v192
  v_add_u32 v193, 1536, v193
  v_add_u32 v194, 1536, v194
  s_add_u32 s60, s60, 1
  s_cmp_lt_u32 s60, 8
  s_cbranch_scc1 L_b2fb_br_t0
  s_add_u32 s66, s66, 1
  s_cmp_lt_u32 s66, 8
  s_cbranch_scc1 L_b2fb_br_c0
  v_mov_b32 v18, v8
  s_nop 1
  v_permlane32_swap_b32 v8, v18
  s_nop 0
  v_max_f32 v8, v8, v18
  v_mov_b32 v18, v9
  s_nop 1
  v_permlane32_swap_b32 v9, v18
  s_nop 0
  v_max_f32 v9, v9, v18
  s_mul_i32 s65, s62, 98304
  s_add_u32 s65, s65, 0x7900000
  s_mov_b32 s66, 0
  s_mov_b32 s67, 0
L_b2fb_br_c1:
  s_waitcnt lgkmcnt(0)
  s_barrier
  s_add_u32 m0, s67, s72
  s_add_u32 s58, s65, s72
  buffer_load_dwordx4 v2, s[48:51], s58 offen offset:0 sc1 lds
  buffer_load_dwordx4 v2, s[48:51], s58 offen offset:1024 sc1 lds
  buffer_load_dwordx4 v2, s[48:51], s58 offen offset:2048 sc1 lds
  s_add_u32 m0, m0, 12288
  s_add_u32 s58, s58, 3145728
  buffer_load_dwordx4 v2, s[48:51], s58 offen offset:0 sc1 lds
  buffer_load_dwordx4 v2, s[48:51], s58 offen offset:1024 sc1 lds
  buffer_load_dwordx4 v2, s[48:51], s58 offen offset:2048 sc1 lds
  s_add_u32 s65, s65, 12288
  s_waitcnt vmcnt(0)
  s_barrier
  v_mov_b32 v192, v3
  v_mov_b32 v193, v4
  v_mov_b32 v194, v5
  s_mov_b32 s60, 0
L_b2fb_br_t1:
  ds_read_b128 v[32:35], v192
  ds_read_b128 v[36:39], v193
  ds_read_b64_tr_b16 v[48:49], v194 offset:0
  ds_read_b64_tr_b16 v[50:51], v194 offset:384
  ds_read_b64_tr_b16 v[52:53], v194 offset:768
  ds_read_b64_tr_b16 v[54:55], v194 offset:1152
  s_waitcnt lgkmcnt(0)
  v_mfma_f32_32x32x16_bf16 v[64:79], v[32:35], v[208:211], 0
  v_mfma_f32_32x32x16_bf16 v[64:79], v[36:39], v[212:215], v[64:79]
  v_mfma_f32_32x32x16_bf16 v[80:95], v[32:35], v[216:219], 0
  v_mfma_f32_32x32x16_bf16 v[80:95], v[36:39], v[220:223], v[80:95]
  s_nop 7
  s_nop 7
  v_sub_f32 v64, v64, v8
  v_sub_f32 v65, v65, v8
  v_sub_f32 v66, v66, v8
  v_sub_f32 v67, v67, v8
  v_sub_f32 v68, v68, v8
  v_sub_f32 v69, v69, v8
  v_sub_f32 v70, v70, v8
  v_sub_f32 v71, v71, v8
  v_sub_f32 v72, v72, v8
  v_sub_f32 v73, v73, v8
  v_sub_f32 v74, v74, v8
  v_sub_f32 v75, v75, v8
  v_sub_f32 v76, v76, v8
  v_sub_f32 v77, v77, v8
  v_sub_f32 v78, v78, v8
  v_sub_f32 v79, v79, v8
  v_exp_f32 v64, v64
  v_exp_f32 v65, v65
  v_exp_f32 v66, v66
  v_exp_f32 v67, v67
  v_exp_f32 v68, v68
  v_exp_f32 v69, v69
  v_exp_f32 v70, v70
  v_exp_f32 v71, v71
  v_exp_f32 v72, v72
  v_exp_f32 v73, v73
  v_exp_f32 v74, v74
  v_exp_f32 v75, v75
  v_exp_f32 v76, v76
  v_exp_f32 v77, v77
  v_exp_f32 v78, v78
  v_exp_f32 v79, v79
  s_nop 0
  v_cvt_pk_bf16_f32 v128, v64, v65
  v_cvt_pk_bf16_f32 v129, v66, v67
  v_cvt_pk_bf16_f32 v130, v68, v69
  v_cvt_pk_bf16_f32 v131, v70, v71
  v_cvt_pk_bf16_f32 v132, v72, v73
  v_cvt_pk_bf16_f32 v133, v74, v75
  v_cvt_pk_bf16_f32 v134, v76, v77
  v_cvt_pk_bf16_f32 v135, v78, v79
  v_sub_f32 v80, v80, v9
  v_sub_f32 v81, v81, v9
  v_sub_f32 v82, v82, v9
  v_sub_f32 v83, v83, v9
  v_sub_f32 v84, v84, v9
  v_sub_f32 v85, v85, v9
  v_sub_f32 v86, v86, v9
  v_sub_f32 v87, v87, v9
  v_sub_f32 v88, v88, v9
  v_sub_f32 v89, v89, v9
  v_sub_f32 v90, v90, v9
  v_sub_f32 v91, v91, v9
  v_sub_f32 v92, v92, v9
  v_sub_f32 v93, v93, v9
  v_sub_f32 v94, v94, v9
  v_sub_f32 v95, v95, v9
  v_exp_f32 v80, v80
  v_exp_f32 v81, v81
  v_exp_f32 v82, v82
  v_exp_f32 v83, v83
  v_exp_f32 v84, v84
  v_exp_f32 v85, v85
  v_exp_f32 v86, v86
  v_exp_f32 v87, v87
  v_exp_f32 v88, v88
  v_exp_f32 v89, v89
  v_exp_f32 v90, v90
  v_exp_f32 v91, v91
  v_exp_f32 v92, v92
  v_exp_f32 v93, v93
  v_exp_f32 v94, v94
  v_exp_f32 v95, v95
  s_nop 0
  v_cvt_pk_bf16_f32 v136, v80, v81
  v_cvt_pk_bf16_f32 v137, v82, v83
  v_cvt_pk_bf16_f32 v138, v84, v85
  v_cvt_pk_bf16_f32 v139, v86, v87
  v_cvt_pk_bf16_f32 v140, v88, v89
  v_cvt_pk_bf16_f32 v141, v90, v91
  v_cvt_pk_bf16_f32 v142, v92, v93
  v_cvt_pk_bf16_f32 v143, v94, v95
  s_nop 1
  v_mfma_f32_32x32x16_bf16 v[160:175], v[48:51], v[128:131], v[160:175]
  v_mfma_f32_32x32x16_bf16 v[160:175], v[52:55], v[132:135], v[160:175]
  v_mfma_f32_32x32x16_bf16 v[176:191], v[48:51], v[136:139], v[176:191]
  v_mfma_f32_32x32x16_bf16 v[176:191], v[52:55], v[140:143], v[176:191]
  v_add_u32 v192, 1536, v192
  v_add_u32 v193, 1536, v193
  v_add_u32 v194, 1536, v194
  s_add_u32 s60, s60, 1
  s_cmp_lt_u32 s60, 8
  s_cbranch_scc1 L_b2fb_br_t1
  s_add_u32 s66, s66, 1
  s_cmp_lt_u32 s66, 8
  s_cbranch_scc1 L_b2fb_br_c1
  s_nop 7
  s_nop 7
  s_branch L_b2st_br
L_b2_br_end:
  s_waitcnt vmcnt(0) lgkmcnt(0)
  s_barrier
  s_cmp_lg_u32 s52, 0
  s_cbranch_scc1 cnt_7065
  v_mov_b32 v19, 32896
  v_mov_b32 v18, 1
  s_mov_b64 exec, 1
  buffer_atomic_add v18, v19, s[48:51], 0 offen sc1
  s_mov_b64 exec, -1
cnt_7065:
  s_waitcnt vmcnt(0)
  s_lshl_b32 s61, s53, 4
  s_add_u32 s61, s61, s54
  s_and_b32 s58, s61, 3
  s_mul_i32 s78, s58, 192
  s_min_u32 s78, s78, 448
  s_lshr_b32 s62, s61, 2
  s_lshl_b32 s62, s62, 2
  s_add_u32 s63, s62, 4
  v_and_b32 v1, 63, v0
  s_mul_i32 s58, s52, 640
  s_add_u32 s59, s58, 0
  v_add_u32 v18, s59, v1
  v_mul_u32_u24 v19, 3277, v18
  v_lshrrev_b32 v19, 18, v19
  v_mul_u32_u24 v20, 80, v19
  v_sub_u32 v18, v18, v20
  v_and_b32 v20, 15, v19
  v_xor_b32 v18, v18, v20
  v_lshlrev_b32 v18, 4, v18
  v_mul_u32_u24 v19, 1280, v19
  v_add_u32 v92, v18, v19
  s_add_u32 s59, s58, 64
  v_add_u32 v18, s59, v1
  v_mul_u32_u24 v19, 3277, v18
  v_lshrrev_b32 v19, 18, v19
  v_mul_u32_u24 v20, 80, v19
  v_sub_u32 v18, v18, v20
  v_and_b32 v20, 15, v19
  v_xor_b32 v18, v18, v20
  v_lshlrev_b32 v18, 4, v18
  v_mul_u32_u24 v19, 1280, v19
  v_add_u32 v93, v18, v19
  s_add_u32 s59, s58, 128
  v_add_u32 v18, s59, v1
  v_mul_u32_u24 v19, 3277, v18
  v_lshrrev_b32 v19, 18, v19
  v_mul_u32_u24 v20, 80, v19
  v_sub_u32 v18, v18, v20
  v_and_b32 v20, 15, v19
  v_xor_b32 v18, v18, v20
  v_lshlrev_b32 v18, 4, v18
  v_mul_u32_u24 v19, 1280, v19
  v_add_u32 v94, v18, v19
  s_add_u32 s59, s58, 192
  v_add_u32 v18, s59, v1
  v_mul_u32_u24 v19, 3277, v18
  v_lshrrev_b32 v19, 18, v19
  v_mul_u32_u24 v20, 80, v19
  v_sub_u32 v18, v18, v20
  v_and_b32 v20, 15, v19
  v_xor_b32 v18, v18, v20
  v_lshlrev_b32 v18, 4, v18
  v_mul_u32_u24 v19, 1280, v19
  v_add_u32 v95, v18, v19
  s_add_u32 s59, s58, 256
  v_add_u32 v18, s59, v1
  v_mul_u32_u24 v19, 3277, v18
  v_lshrrev_b32 v19, 18, v19
  v_mul_u32_u24 v20, 80, v19
  v_sub_u32 v18, v18, v20
  v_and_b32 v20, 15, v19
  v_xor_b32 v18, v18, v20
  v_lshlrev_b32 v18, 4, v18
  v_mul_u32_u24 v19, 1280, v19
  v_add_u32 v96, v18, v19
  s_add_u32 s59, s58, 320
  v_add_u32 v18, s59, v1
  v_mul_u32_u24 v19, 3277, v18
  v_lshrrev_b32 v19, 18, v19
  v_mul_u32_u24 v20, 80, v19
  v_sub_u32 v18, v18, v20
  v_and_b32 v20, 15, v19
  v_xor_b32 v18, v18, v20
  v_lshlrev_b32 v18, 4, v18
  v_mul_u32_u24 v19, 1280, v19
  v_add_u32 v97, v18, v19
  s_add_u32 s59, s58, 384
  v_add_u32 v18, s59, v1
  v_mul_u32_u24 v19, 3277, v18
  v_lshrrev_b32 v19, 18, v19
  v_mul_u32_u24 v20, 80, v19
  v_sub_u32 v18, v18, v20
  v_and_b32 v20, 15, v19
  v_xor_b32 v18, v18, v20
  v_lshlrev_b32 v18, 4, v18
  v_mul_u32_u24 v19, 1280, v19
  v_add_u32 v98, v18, v19
  s_add_u32 s59, s58, 448
  v_add_u32 v18, s59, v1
  v_mul_u32_u24 v19, 3277, v18
  v_lshrrev_b32 v19, 18, v19
  v_mul_u32_u24 v20, 80, v19
  v_sub_u32 v18, v18, v20
  v_and_b32 v20, 15, v19
  v_xor_b32 v18, v18, v20
  v_lshlrev_b32 v18, 4, v18
  v_mul_u32_u24 v19, 1280, v19
  v_add_u32 v99, v18, v19
  s_add_u32 s59, s58, 512
  v_add_u32 v18, s59, v1
  v_mul_u32_u24 v19, 3277, v18
  v_lshrrev_b32 v19, 18, v19
  v_mul_u32_u24 v20, 80, v19
  v_sub_u32 v18, v18, v20
  v_and_b32 v20, 15, v19
  v_xor_b32 v18, v18, v20
  v_lshlrev_b32 v18, 4, v18
  v_mul_u32_u24 v19, 1280, v19
  v_add_u32 v100, v18, v19
  s_add_u32 s59, s58, 576
  v_add_u32 v18, s59, v1
  v_mul_u32_u24 v19, 3277, v18
  v_lshrrev_b32 v19, 18, v19
  v_mul_u32_u24 v20, 80, v19
  v_sub_u32 v18, v18, v20
  v_and_b32 v20, 15, v19
  v_xor_b32 v18, v18, v20
  v_lshlrev_b32 v18, 4, v18
  v_mul_u32_u24 v19, 1280, v19
  v_add_u32 v101, v18, v19
  v_and_b32 v18, 15, v1
  v_lshrrev_b32 v19, 4, v1
  v_xor_b32 v19, v19, v18
  v_mul_u32_u24 v18, 1280, v18
  v_add_u32 v18, 0x1e000, v18
  v_xor_b32 v20, 0, v19
  v_lshlrev_b32 v20, 4, v20
  v_add_u32 v102, v18, v20
  v_xor_b32 v20, 4, v19
  v_lshlrev_b32 v20, 4, v20
  v_add_u32 v103, v18, v20
  v_xor_b32 v20, 8, v19
  v_lshlrev_b32 v20, 4, v20
  v_add_u32 v104, v18, v20
  v_xor_b32 v20, 12, v19
  v_lshlrev_b32 v20, 4, v20
  v_add_u32 v105, v18, v20
  v_lshrrev_b32 v18, 4, v1
  v_lshrrev_b32 v19, 2, v1
  v_and_b32 v19, 3, v19
  v_lshlrev_b32 v20, 3, v18
  v_add_u32 v20, v20, v19
  v_mul_u32_u24 v20, 384, v20
  v_and_b32 v21, 3, v1
  v_lshlrev_b32 v21, 3, v21
  v_add_u32 v20, v20, v21
  v_lshrrev_b32 v19, 1, v19
  v_and_b32 v18, 1, v18
  v_lshlrev_b32 v18, 1, v18
  v_or_b32 v18, v18, v19
  s_mul_i32 s58, s52, 3
  s_add_u32 s59, s58, 0
  v_xor_b32 v19, s59, v18
  v_lshlrev_b32 v19, 5, v19
  v_add_u32 v26, v19, v20
  s_add_u32 s59, s58, 1
  v_xor_b32 v19, s59, v18
  v_lshlrev_b32 v19, 5, v19
  v_add_u32 v27, v19, v20
  s_add_u32 s59, s58, 2
  v_xor_b32 v19, s59, v18
  v_lshlrev_b32 v19, 5, v19
  v_add_u32 v28, v19, v20
  s_lshl_b32 s67, s78, 1
  s_mul_i32 s64, s62, 40960
  s_add_u32 s64, s64, 0x7f00000
  s_mul_i32 s65, s52, 10240
  s_add_u32 s65, s65, 122880
  v_mov_b32 v18, v0
  v_mul_u32_u24 v19, 2731, v18
  v_lshrrev_b32 v19, 16, v19
  v_mul_u32_u24 v20, 24, v19
  v_sub_u32 v18, v18, v20
  v_and_b32 v20, 2, v19
  v_lshrrev_b32 v21, 1, v19
  v_and_b32 v21, 4, v21
  v_or_b32 v20, v20, v21
  v_xor_b32 v18, v18, v20
  v_mul_u32_u24 v19, 1280, v19
  v_lshlrev_b32 v18, 4, v18
  v_add_u32 v2, v18, v19
  v_add_u32 v18, 256, v0
  v_mul_u32_u24 v19, 2731, v18
  v_lshrrev_b32 v19, 16, v19
  v_mul_u32_u24 v20, 24, v19
  v_sub_u32 v18, v18, v20
  v_and_b32 v20, 2, v19
  v_lshrrev_b32 v21, 1, v19
  v_and_b32 v21, 4, v21
  v_or_b32 v20, v20, v21
  v_xor_b32 v18, v18, v20
  v_mul_u32_u24 v19, 1280, v19
  v_lshlrev_b32 v18, 4, v18
  v_add_u32 v3, v18, v19
  v_add_u32 v18, 512, v0
  v_mul_u32_u24 v19, 2731, v18
  v_lshrrev_b32 v19, 16, v19
  v_mul_u32_u24 v20, 24, v19
  v_sub_u32 v18, v18, v20
  v_and_b32 v20, 2, v19
  v_lshrrev_b32 v21, 1, v19
  v_and_b32 v21, 4, v21
  v_or_b32 v20, v20, v21
  v_xor_b32 v18, v18, v20
  v_mul_u32_u24 v19, 1280, v19
  v_lshlrev_b32 v18, 4, v18
  v_add_u32 v4, v18, v19
  v_add_u32 v18, 768, v0
  v_mul_u32_u24 v19, 2731, v18
  v_lshrrev_b32 v19, 16, v19
  v_mul_u32_u24 v20, 24, v19
  v_sub_u32 v18, v18, v20
  v_and_b32 v20, 2, v19
  v_lshrrev_b32 v21, 1, v19
  v_and_b32 v21, 4, v21
  v_or_b32 v20, v20, v21
  v_xor_b32 v18, v18, v20
  v_mul_u32_u24 v19, 1280, v19
  v_lshlrev_b32 v18, 4, v18
  v_add_u32 v5, v18, v19
  v_add_u32 v18, 1024, v0
  v_mul_u32_u24 v19, 2731, v18
  v_lshrrev_b32 v19, 16, v19
  v_mul_u32_u24 v20, 24, v19
  v_sub_u32 v18, v18, v20
  v_and_b32 v20, 2, v19
  v_lshrrev_b32 v21, 1, v19
  v_and_b32 v21, 4, v21
  v_or_b32 v20, v20, v21
  v_xor_b32 v18, v18, v20
  v_mul_u32_u24 v19, 1280, v19
  v_lshlrev_b32 v18, 4, v18
  v_add_u32 v6, v18, v19
  v_add_u32 v18, 1280, v0
  v_mul_u32_u24 v19, 2731, v18
  v_lshrrev_b32 v19, 16, v19
  v_mul_u32_u24 v20, 24, v19
  v_sub_u32 v18, v18, v20
  v_and_b32 v20, 2, v19
  v_lshrrev_b32 v21, 1, v19
  v_and_b32 v21, 4, v21
  v_or_b32 v20, v20, v21
  v_xor_b32 v18, v18, v20
  v_mul_u32_u24 v19, 1280, v19
  v_lshlrev_b32 v18, 4, v18
  v_add_u32 v7, v18, v19
  v_add_u32 v18, 1536, v0
  v_mul_u32_u24 v19, 2731, v18
  v_lshrrev_b32 v19, 16, v19
  v_mul_u32_u24 v20, 24, v19
  v_sub_u32 v18, v18, v20
  v_and_b32 v20, 2, v19
  v_lshrrev_b32 v21, 1, v19
  v_and_b32 v21, 4, v21
  v_or_b32 v20, v20, v21
  v_xor_b32 v18, v18, v20
  v_mul_u32_u24 v19, 1280, v19
  v_lshlrev_b32 v18, 4, v18
  v_add_u32 v8, v18, v19
  v_add_u32 v18, 1792, v0
  v_mul_u32_u24 v19, 2731, v18
  v_lshrrev_b32 v19, 16, v19
  v_mul_u32_u24 v20, 24, v19
  v_sub_u32 v18, v18, v20
  v_and_b32 v20, 2, v19
  v_lshrrev_b32 v21, 1, v19
  v_and_b32 v21, 4, v21
  v_or_b32 v20, v20, v21
  v_xor_b32 v18, v18, v20
  v_mul_u32_u24 v19, 1280, v19
  v_lshlrev_b32 v18, 4, v18
  v_add_u32 v9, v18, v19
  v_add_u32 v18, 2048, v0
  v_mul_u32_u24 v19, 2731, v18
  v_lshrrev_b32 v19, 16, v19
  v_mul_u32_u24 v20, 24, v19
  v_sub_u32 v18, v18, v20
  v_and_b32 v20, 2, v19
  v_lshrrev_b32 v21, 1, v19
  v_and_b32 v21, 4, v21
  v_or_b32 v20, v20, v21
  v_xor_b32 v18, v18, v20
  v_mul_u32_u24 v19, 1280, v19
  v_lshlrev_b32 v18, 4, v18
  v_add_u32 v10, v18, v19
  v_add_u32 v18, 2304, v0
  v_mul_u32_u24 v19, 2731, v18
  v_lshrrev_b32 v19, 16, v19
  v_mul_u32_u24 v20, 24, v19
  v_sub_u32 v18, v18, v20
  v_and_b32 v20, 2, v19
  v_lshrrev_b32 v21, 1, v19
  v_and_b32 v21, 4, v21
  v_or_b32 v20, v20, v21
  v_xor_b32 v18, v18, v20
  v_mul_u32_u24 v19, 1280, v19
  v_lshlrev_b32 v18, 4, v18
  v_add_u32 v11, v18, v19
  v_add_u32 v18, 2560, v0
  v_mul_u32_u24 v19, 2731, v18
  v_lshrrev_b32 v19, 16, v19
  v_mul_u32_u24 v20, 24, v19
  v_sub_u32 v18, v18, v20
  v_and_b32 v20, 2, v19
  v_lshrrev_b32 v21, 1, v19
  v_and_b32 v21, 4, v21
  v_or_b32 v20, v20, v21
  v_xor_b32 v18, v18, v20
  v_mul_u32_u24 v19, 1280, v19
  v_lshlrev_b32 v18, 4, v18
  v_add_u32 v12, v18, v19
  v_add_u32 v18, 2816, v0
  v_mul_u32_u24 v19, 2731, v18
  v_lshrrev_b32 v19, 16, v19
  v_mul_u32_u24 v20, 24, v19
  v_sub_u32 v18, v18, v20
  v_and_b32 v20, 2, v19
  v_lshrrev_b32 v21, 1, v19
  v_and_b32 v21, 4, v21
  v_or_b32 v20, v20, v21
  v_xor_b32 v18, v18, v20
  v_mul_u32_u24 v19, 1280, v19
  v_lshlrev_b32 v18, 4, v18
  v_add_u32 v13, v18, v19
  v_add_u32 v18, 3072, v0
  v_mul_u32_u24 v19, 2731, v18
  v_lshrrev_b32 v19, 16, v19
  v_mul_u32_u24 v20, 24, v19
  v_sub_u32 v18, v18, v20
  v_and_b32 v20, 2, v19
  v_lshrrev_b32 v21, 1, v19
  v_and_b32 v21, 4, v21
  v_or_b32 v20, v20, v21
  v_xor_b32 v18, v18, v20
  v_mul_u32_u24 v19, 1280, v19
  v_lshlrev_b32 v18, 4, v18
  v_add_u32 v14, v18, v19
  v_add_u32 v18, 3328, v0
  v_mul_u32_u24 v19, 2731, v18
  v_lshrrev_b32 v19, 16, v19
  v_mul_u32_u24 v20, 24, v19
  v_sub_u32 v18, v18, v20
  v_and_b32 v20, 2, v19
  v_lshrrev_b32 v21, 1, v19
  v_and_b32 v21, 4, v21
  v_or_b32 v20, v20, v21
  v_xor_b32 v18, v18, v20
  v_mul_u32_u24 v19, 1280, v19
  v_lshlrev_b32 v18, 4, v18
  v_add_u32 v15, v18, v19
  v_add_u32 v18, 3584, v0
  v_mul_u32_u24 v19, 2731, v18
  v_lshrrev_b32 v19, 16, v19
  v_mul_u32_u24 v20, 24, v19
  v_sub_u32 v18, v18, v20
  v_and_b32 v20, 2, v19
  v_lshrrev_b32 v21, 1, v19
  v_and_b32 v21, 4, v21
  v_or_b32 v20, v20, v21
  v_xor_b32 v18, v18, v20
  v_mul_u32_u24 v19, 1280, v19
  v_lshlrev_b32 v18, 4, v18
  v_add_u32 v16, v18, v19
  s_mov_b32 s70, s67
  s_lshl_b32 s60, s52, 10
  s_add_u32 s60, s60, 0x0
  s_add_u32 m0, s60, 0
  s_nop 0
  buffer_load_dwordx4 v2, s[36:39], s70 offen lds
  s_add_u32 m0, s60, 4096
  s_nop 0
  buffer_load_dwordx4 v3, s[36:39], s70 offen lds
  s_add_u32 m0, s60, 8192
  s_nop 0
  buffer_load_dwordx4 v4, s[36:39], s70 offen lds
  s_add_u32 m0, s60, 12288
  s_nop 0
  buffer_load_dwordx4 v5, s[36:39], s70 offen lds
  s_add_u32 m0, s60, 16384
  s_nop 0
  buffer_load_dwordx4 v6, s[36:39], s70 offen lds
  s_add_u32 m0, s60, 20480
  s_nop 0
  buffer_load_dwordx4 v7, s[36:39], s70 offen lds
  s_add_u32 m0, s60, 24576
  s_nop 0
  buffer_load_dwordx4 v8, s[36:39], s70 offen lds
  s_add_u32 m0, s60, 28672
  s_nop 0
  buffer_load_dwordx4 v9, s[36:39], s70 offen lds
  s_add_u32 m0, s60, 32768
  s_nop 0
  buffer_load_dwordx4 v10, s[36:39], s70 offen lds
  s_add_u32 m0, s60, 36864
  s_nop 0
  buffer_load_dwordx4 v11, s[36:39], s70 offen lds
  s_add_u32 m0, s60, 40960
  s_nop 0
  buffer_load_dwordx4 v12, s[36:39], s70 offen lds
  s_add_u32 m0, s60, 45056
  s_nop 0
  buffer_load_dwordx4 v13, s[36:39], s70 offen lds
  s_add_u32 m0, s60, 49152
  s_nop 0
  buffer_load_dwordx4 v14, s[36:39], s70 offen lds
  s_add_u32 m0, s60, 53248
  s_nop 0
  buffer_load_dwordx4 v15, s[36:39], s70 offen lds
  s_add_u32 m0, s60, 57344
  s_nop 0
  buffer_load_dwordx4 v16, s[36:39], s70 offen lds
  s_add_u32 s70, s70, 204800
  s_lshl_b32 s60, s52, 10
  s_add_u32 s60, s60, 0xf000
  s_add_u32 m0, s60, 0
  s_nop 0
  buffer_load_dwordx4 v2, s[36:39], s70 offen lds
  s_add_u32 m0, s60, 4096
  s_nop 0
  buffer_load_dwordx4 v3, s[36:39], s70 offen lds
  s_add_u32 m0, s60, 8192
  s_nop 0
  buffer_load_dwordx4 v4, s[36:39], s70 offen lds
  s_add_u32 m0, s60, 12288
  s_nop 0
  buffer_load_dwordx4 v5, s[36:39], s70 offen lds
  s_add_u32 m0, s60, 16384
  s_nop 0
  buffer_load_dwordx4 v6, s[36:39], s70 offen lds
  s_add_u32 m0, s60, 20480
  s_nop 0
  buffer_load_dwordx4 v7, s[36:39], s70 offen lds
  s_add_u32 m0, s60, 24576
  s_nop 0
  buffer_load_dwordx4 v8, s[36:39], s70 offen lds
  s_add_u32 m0, s60, 28672
  s_nop 0
  buffer_load_dwordx4 v9, s[36:39], s70 offen lds
  s_add_u32 m0, s60, 32768
  s_nop 0
  buffer_load_dwordx4 v10, s[36:39], s70 offen lds
  s_add_u32 m0, s60, 36864
  s_nop 0
  buffer_load_dwordx4 v11, s[36:39], s70 offen lds
  s_add_u32 m0, s60, 40960
  s_nop 0
  buffer_load_dwordx4 v12, s[36:39], s70 offen lds
  s_add_u32 m0, s60, 45056
  s_nop 0
  buffer_load_dwordx4 v13, s[36:39], s70 offen lds
  s_add_u32 m0, s60, 49152
  s_nop 0
  buffer_load_dwordx4 v14, s[36:39], s70 offen lds
  s_add_u32 m0, s60, 53248
  s_nop 0
  buffer_load_dwordx4 v15, s[36:39], s70 offen lds
  s_add_u32 m0, s60, 57344
  s_nop 0
  buffer_load_dwordx4 v16, s[36:39], s70 offen lds
  s_waitcnt vmcnt(15)
  s_barrier
  ds_read_b64_tr_b16 a[0:1], v26 offset:0
  ds_read_b64_tr_b16 a[2:3], v26 offset:1536
  ds_read_b64_tr_b16 a[4:5], v26 offset:12288
  ds_read_b64_tr_b16 a[6:7], v26 offset:13824
  ds_read_b64_tr_b16 a[8:9], v26 offset:24576
  ds_read_b64_tr_b16 a[10:11], v26 offset:26112
  s_waitcnt lgkmcnt(4)
  ds_read_b64_tr_b16 a[12:13], v26 offset:36864
  ds_read_b64_tr_b16 a[14:15], v26 offset:38400
  ds_read_b64_tr_b16 a[16:17], v26 offset:49152
  ds_read_b64_tr_b16 a[18:19], v26 offset:50688
  s_waitcnt lgkmcnt(4)
  ds_read_b64_tr_b16 a[80:81], v27 offset:0
  ds_read_b64_tr_b16 a[82:83], v27 offset:1536
  ds_read_b64_tr_b16 a[84:85], v27 offset:12288
  ds_read_b64_tr_b16 a[86:87], v27 offset:13824
  ds_read_b64_tr_b16 a[88:89], v27 offset:24576
  ds_read_b64_tr_b16 a[90:91], v27 offset:26112
  s_waitcnt lgkmcnt(4)
  ds_read_b64_tr_b16 a[92:93], v27 offset:36864
  ds_read_b64_tr_b16 a[94:95], v27 offset:38400
  ds_read_b64_tr_b16 a[96:97], v27 offset:49152
  ds_read_b64_tr_b16 a[98:99], v27 offset:50688
  s_waitcnt lgkmcnt(4)
  ds_read_b64_tr_b16 a[160:161], v28 offset:0
  ds_read_b64_tr_b16 a[162:163], v28 offset:1536
  ds_read_b64_tr_b16 a[164:165], v28 offset:12288
  ds_read_b64_tr_b16 a[166:167], v28 offset:13824
  ds_read_b64_tr_b16 a[168:169], v28 offset:24576
  ds_read_b64_tr_b16 a[170:171], v28 offset:26112
  s_waitcnt lgkmcnt(4)
  ds_read_b64_tr_b16 a[172:173], v28 offset:36864
  ds_read_b64_tr_b16 a[174:175], v28 offset:38400
  ds_read_b64_tr_b16 a[176:177], v28 offset:49152
  ds_read_b64_tr_b16 a[178:179], v28 offset:50688
  s_waitcnt lgkmcnt(4)
  s_waitcnt lgkmcnt(0)
  v_add_u32 v26, 61440, v26
  v_add_u32 v27, 61440, v27
  v_add_u32 v28, 61440, v28
  s_barrier
  s_add_u32 s70, s70, 204800
  s_lshl_b32 s60, s52, 10
  s_add_u32 s60, s60, 0x0
  s_add_u32 m0, s60, 0
  s_nop 0
  buffer_load_dwordx4 v2, s[36:39], s70 offen lds
  s_add_u32 m0, s60, 4096
  s_nop 0
  buffer_load_dwordx4 v3, s[36:39], s70 offen lds
  s_add_u32 m0, s60, 8192
  s_nop 0
  buffer_load_dwordx4 v4, s[36:39], s70 offen lds
  s_add_u32 m0, s60, 12288
  s_nop 0
  buffer_load_dwordx4 v5, s[36:39], s70 offen lds
  s_add_u32 m0, s60, 16384
  s_nop 0
  buffer_load_dwordx4 v6, s[36:39], s70 offen lds
  s_add_u32 m0, s60, 20480
  s_nop 0
  buffer_load_dwordx4 v7, s[36:39], s70 offen lds
  s_add_u32 m0, s60, 24576
  s_nop 0
  buffer_load_dwordx4 v8, s[36:39], s70 offen lds
  s_add_u32 m0, s60, 28672
  s_nop 0
  buffer_load_dwordx4 v9, s[36:39], s70 offen lds
  s_add_u32 m0, s60, 32768
  s_nop 0
  buffer_load_dwordx4 v10, s[36:39], s70 offen lds
  s_add_u32 m0, s60, 36864
  s_nop 0
  buffer_load_dwordx4 v11, s[36:39], s70 offen lds
  s_add_u32 m0, s60, 40960
  s_nop 0
  buffer_load_dwordx4 v12, s[36:39], s70 offen lds
  s_add_u32 m0, s60, 45056
  s_nop 0
  buffer_load_dwordx4 v13, s[36:39], s70 offen lds
  s_add_u32 m0, s60, 49152
  s_nop 0
  buffer_load_dwordx4 v14, s[36:39], s70 offen lds
  s_add_u32 m0, s60, 53248
  s_nop 0
  buffer_load_dwordx4 v15, s[36:39], s70 offen lds
  s_add_u32 m0, s60, 57344
  s_nop 0
  buffer_load_dwordx4 v16, s[36:39], s70 offen lds
  s_waitcnt vmcnt(15)
  s_barrier
  ds_read_b64_tr_b16 a[20:21], v26 offset:0
  ds_read_b64_tr_b16 a[22:23], v26 offset:1536
  ds_read_b64_tr_b16 a[24:25], v26 offset:12288
  ds_read_b64_tr_b16 a[26:27], v26 offset:13824
  ds_read_b64_tr_b16 a[28:29], v26 offset:24576
  ds_read_b64_tr_b16 a[30:31], v26 offset:26112
  s_waitcnt lgkmcnt(4)
  ds_read_b64_tr_b16 a[32:33], v26 offset:36864
  ds_read_b64_tr_b16 a[34:35], v26 offset:38400
  ds_read_b64_tr_b16 a[36:37], v26 offset:49152
  ds_read_b64_tr_b16 a[38:39], v26 offset:50688
  s_waitcnt lgkmcnt(4)
  ds_read_b64_tr_b16 a[100:101], v27 offset:0
  ds_read_b64_tr_b16 a[102:103], v27 offset:1536
  ds_read_b64_tr_b16 a[104:105], v27 offset:12288
  ds_read_b64_tr_b16 a[106:107], v27 offset:13824
  ds_read_b64_tr_b16 a[108:109], v27 offset:24576
  ds_read_b64_tr_b16 a[110:111], v27 offset:26112
  s_waitcnt lgkmcnt(4)
  ds_read_b64_tr_b16 a[112:113], v27 offset:36864
  ds_read_b64_tr_b16 a[114:115], v27 offset:38400
  ds_read_b64_tr_b16 a[116:117], v27 offset:49152
  ds_read_b64_tr_b16 a[118:119], v27 offset:50688
  s_waitcnt lgkmcnt(4)
  ds_read_b64_tr_b16 a[180:181], v28 offset:0
  ds_read_b64_tr_b16 a[182:183], v28 offset:1536
  ds_read_b64_tr_b16 a[184:185], v28 offset:12288
  ds_read_b64_tr_b16 a[186:187], v28 offset:13824
  ds_read_b64_tr_b16 a[188:189], v28 offset:24576
  ds_read_b64_tr_b16 a[190:191], v28 offset:26112
  s_waitcnt lgkmcnt(4)
  ds_read_b64_tr_b16 a[192:193], v28 offset:36864
  ds_read_b64_tr_b16 a[194:195], v28 offset:38400
  ds_read_b64_tr_b16 a[196:197], v28 offset:49152
  ds_read_b64_tr_b16 a[198:199], v28 offset:50688
  s_waitcnt lgkmcnt(4)
  s_waitcnt lgkmcnt(0)
  v_subrev_u32 v26, 61440, v26
  v_subrev_u32 v27, 61440, v27
  v_subrev_u32 v28, 61440, v28
  s_barrier
  s_add_u32 s70, s70, 204800
  s_lshl_b32 s60, s52, 10
  s_add_u32 s60, s60, 0xf000
  s_add_u32 m0, s60, 0
  s_nop 0
  buffer_load_dwordx4 v2, s[36:39], s70 offen lds
  s_add_u32 m0, s60, 4096
  s_nop 0
  buffer_load_dwordx4 v3, s[36:39], s70 offen lds
  s_add_u32 m0, s60, 8192
  s_nop 0
  buffer_load_dwordx4 v4, s[36:39], s70 offen lds
  s_add_u32 m0, s60, 12288
  s_nop 0
  buffer_load_dwordx4 v5, s[36:39], s70 offen lds
  s_add_u32 m0, s60, 16384
  s_nop 0
  buffer_load_dwordx4 v6, s[36:39], s70 offen lds
  s_add_u32 m0, s60, 20480
  s_nop 0
  buffer_load_dwordx4 v7, s[36:39], s70 offen lds
  s_add_u32 m0, s60, 24576
  s_nop 0
  buffer_load_dwordx4 v8, s[36:39], s70 offen lds
  s_add_u32 m0, s60, 28672
  s_nop 0
  buffer_load_dwordx4 v9, s[36:39], s70 offen lds
  s_add_u32 m0, s60, 32768
  s_nop 0
  buffer_load_dwordx4 v10, s[36:39], s70 offen lds
  s_add_u32 m0, s60, 36864
  s_nop 0
  buffer_load_dwordx4 v11, s[36:39], s70 offen lds
  s_add_u32 m0, s60, 40960
  s_nop 0
  buffer_load_dwordx4 v12, s[36:39], s70 offen lds
  s_add_u32 m0, s60, 45056
  s_nop 0
  buffer_load_dwordx4 v13, s[36:39], s70 offen lds
  s_add_u32 m0, s60, 49152
  s_nop 0
  buffer_load_dwordx4 v14, s[36:39], s70 offen lds
  s_add_u32 m0, s60, 53248
  s_nop 0
  buffer_load_dwordx4 v15, s[36:39], s70 offen lds
  s_add_u32 m0, s60, 57344
  s_nop 0
  buffer_load_dwordx4 v16, s[36:39], s70 offen lds
  s_waitcnt vmcnt(15)
  s_barrier
  ds_read_b64_tr_b16 a[40:41], v26 offset:0
  ds_read_b64_tr_b16 a[42:43], v26 offset:1536
  ds_read_b64_tr_b16 a[44:45], v26 offset:12288
  ds_read_b64_tr_b16 a[46:47], v26 offset:13824
  ds_read_b64_tr_b16 a[48:49], v26 offset:24576
  ds_read_b64_tr_b16 a[50:51], v26 offset:26112
  s_waitcnt lgkmcnt(4)
  ds_read_b64_tr_b16 a[52:53], v26 offset:36864
  ds_read_b64_tr_b16 a[54:55], v26 offset:38400
  ds_read_b64_tr_b16 a[56:57], v26 offset:49152
  ds_read_b64_tr_b16 a[58:59], v26 offset:50688
  s_waitcnt lgkmcnt(4)
  ds_read_b64_tr_b16 a[120:121], v27 offset:0
  ds_read_b64_tr_b16 a[122:123], v27 offset:1536
  ds_read_b64_tr_b16 a[124:125], v27 offset:12288
  ds_read_b64_tr_b16 a[126:127], v27 offset:13824
  ds_read_b64_tr_b16 a[128:129], v27 offset:24576
  ds_read_b64_tr_b16 a[130:131], v27 offset:26112
  s_waitcnt lgkmcnt(4)
  ds_read_b64_tr_b16 a[132:133], v27 offset:36864
  ds_read_b64_tr_b16 a[134:135], v27 offset:38400
  ds_read_b64_tr_b16 a[136:137], v27 offset:49152
  ds_read_b64_tr_b16 a[138:139], v27 offset:50688
  s_waitcnt lgkmcnt(4)
  ds_read_b64_tr_b16 a[200:201], v28 offset:0
  ds_read_b64_tr_b16 a[202:203], v28 offset:1536
  ds_read_b64_tr_b16 a[204:205], v28 offset:12288
  ds_read_b64_tr_b16 a[206:207], v28 offset:13824
  ds_read_b64_tr_b16 a[208:209], v28 offset:24576
  ds_read_b64_tr_b16 a[210:211], v28 offset:26112
  s_waitcnt lgkmcnt(4)
  ds_read_b64_tr_b16 a[212:213], v28 offset:36864
  ds_read_b64_tr_b16 a[214:215], v28 offset:38400
  ds_read_b64_tr_b16 a[216:217], v28 offset:49152
  ds_read_b64_tr_b16 a[218:219], v28 offset:50688
  s_waitcnt lgkmcnt(4)
  s_waitcnt lgkmcnt(0)
  v_add_u32 v26, 61440, v26
  v_add_u32 v27, 61440, v27
  v_add_u32 v28, 61440, v28
  s_barrier
  s_waitcnt vmcnt(0)
  s_barrier
  ds_read_b64_tr_b16 a[60:61], v26 offset:0
  ds_read_b64_tr_b16 a[62:63], v26 offset:1536
  ds_read_b64_tr_b16 a[64:65], v26 offset:12288
  ds_read_b64_tr_b16 a[66:67], v26 offset:13824
  ds_read_b64_tr_b16 a[68:69], v26 offset:24576
  ds_read_b64_tr_b16 a[70:71], v26 offset:26112
  s_waitcnt lgkmcnt(4)
  ds_read_b64_tr_b16 a[72:73], v26 offset:36864
  ds_read_b64_tr_b16 a[74:75], v26 offset:38400
  ds_read_b64_tr_b16 a[76:77], v26 offset:49152
  ds_read_b64_tr_b16 a[78:79], v26 offset:50688
  s_waitcnt lgkmcnt(4)
  ds_read_b64_tr_b16 a[140:141], v27 offset:0
  ds_read_b64_tr_b16 a[142:143], v27 offset:1536
  ds_read_b64_tr_b16 a[144:145], v27 offset:12288
  ds_read_b64_tr_b16 a[146:147], v27 offset:13824
  ds_read_b64_tr_b16 a[148:149], v27 offset:24576
  ds_read_b64_tr_b16 a[150:151], v27 offset:26112
  s_waitcnt lgkmcnt(4)
  ds_read_b64_tr_b16 a[152:153], v27 offset:36864
  ds_read_b64_tr_b16 a[154:155], v27 offset:38400
  ds_read_b64_tr_b16 a[156:157], v27 offset:49152
  ds_read_b64_tr_b16 a[158:159], v27 offset:50688
  s_waitcnt lgkmcnt(4)
  ds_read_b64_tr_b16 a[220:221], v28 offset:0
  ds_read_b64_tr_b16 a[222:223], v28 offset:1536
  ds_read_b64_tr_b16 a[224:225], v28 offset:12288
  ds_read_b64_tr_b16 a[226:227], v28 offset:13824
  ds_read_b64_tr_b16 a[228:229], v28 offset:24576
  ds_read_b64_tr_b16 a[230:231], v28 offset:26112
  s_waitcnt lgkmcnt(4)
  ds_read_b64_tr_b16 a[232:233], v28 offset:36864
  ds_read_b64_tr_b16 a[234:235], v28 offset:38400
  ds_read_b64_tr_b16 a[236:237], v28 offset:49152
  ds_read_b64_tr_b16 a[238:239], v28 offset:50688
  s_waitcnt lgkmcnt(4)
  s_waitcnt lgkmcnt(0)
  v_subrev_u32 v26, 61440, v26
  v_subrev_u32 v27, 61440, v27
  v_subrev_u32 v28, 61440, v28
  s_barrier
  v_mov_b32 v19, 32896
  s_mov_b32 s56, 0
poll_7066:
  buffer_load_dword v18, v19, s[48:51], 0 offen sc1
  s_waitcnt vmcnt(0)
  v_readfirstlane_b32 s58, v18
  s_cmp_ge_u32 s58, 64
  s_cbranch_scc1 polldone_7067
  s_cmp_lg_u32 s55, 0
  s_cbranch_scc1 polldone_7067
  s_add_u32 s56, s56, 1
  s_cmp_lt_u32 s56, 0x20000
  s_cbranch_scc1 poll_7066
  s_mov_b32 s55, 1
polldone_7067:
  s_add_u32 m0, s65, 0
  s_nop 0
  buffer_load_dwordx4 v92, s[48:51], s64 offen sc1 lds
  s_add_u32 m0, s65, 1024
  s_nop 0
  buffer_load_dwordx4 v93, s[48:51], s64 offen sc1 lds
  s_add_u32 m0, s65, 2048
  s_nop 0
  buffer_load_dwordx4 v94, s[48:51], s64 offen sc1 lds
  s_add_u32 m0, s65, 3072
  s_nop 0
  buffer_load_dwordx4 v95, s[48:51], s64 offen sc1 lds
  s_add_u32 m0, s65, 4096
  s_nop 0
  buffer_load_dwordx4 v96, s[48:51], s64 offen sc1 lds
  s_add_u32 m0, s65, 5120
  s_nop 0
  buffer_load_dwordx4 v97, s[48:51], s64 offen sc1 lds
  s_add_u32 m0, s65, 6144
  s_nop 0
  buffer_load_dwordx4 v98, s[48:51], s64 offen sc1 lds
  s_add_u32 m0, s65, 7168
  s_nop 0
  buffer_load_dwordx4 v99, s[48:51], s64 offen sc1 lds
  s_add_u32 m0, s65, 8192
  s_nop 0
  buffer_load_dwordx4 v100, s[48:51], s64 offen sc1 lds
  s_add_u32 m0, s65, 9216
  s_nop 0
  buffer_load_dwordx4 v101, s[48:51], s64 offen sc1 lds
  s_waitcnt vmcnt(0)
  s_mul_i32 s58, s52, 48
  s_add_u32 s58, s58, s78
  s_lshl_b32 s58, s58, 1
  s_add_u32 s58, s58, 1280
  v_and_b32 v18, 15, v1
  v_mul_u32_u24 v18, 2560, v18
  v_lshrrev_b32 v19, 4, v1
  v_lshlrev_b32 v19, 3, v19
  v_add_u32 v18, v18, v19
  v_add_u32 v2, s58, v18
  v_add_u32 v3, 40960, v2
  s_mul_i32 s66, s62, 81920
  s_mov_b32 s71, 0xfffe2000
L_b3_r:
  s_waitcnt vmcnt(6)
  s_barrier
  s_add_u32 s58, s62, 1
  s_cmp_lt_u32 s58, s63
  s_cselect_b32 s58, 40960, 0
  s_add_u32 s64, s64, s58
  s_add_u32 s65, s65, s71
  ds_read_b128 v[32:35], v102 offset:0
  ds_read_b128 v[36:39], v102 offset:20480
  ds_read_b128 v[40:43], v103 offset:0
  ds_read_b128 v[44:47], v103 offset:20480
  ds_read_b128 v[48:51], v104 offset:0
  ds_read_b128 v[52:55], v104 offset:20480
  s_waitcnt lgkmcnt(4)
  v_mfma_f32_16x16x32_bf16 v[56:59], a[0:3], v[32:35], 0
  v_mfma_f32_16x16x32_bf16 v[64:67], a[80:83], v[32:35], 0
  v_mfma_f32_16x16x32_bf16 v[72:75], a[160:163], v[32:35], 0
  v_mfma_f32_16x16x32_bf16 v[60:63], a[0:3], v[36:39], 0
  v_mfma_f32_16x16x32_bf16 v[68:71], a[80:83], v[36:39], 0
  v_mfma_f32_16x16x32_bf16 v[76:79], a[160:163], v[36:39], 0
  ds_read_b128 v[32:35], v105 offset:0
  ds_read_b128 v[36:39], v105 offset:20480
  s_waitcnt lgkmcnt(4)
  v_mfma_f32_16x16x32_bf16 v[56:59], a[4:7], v[40:43], v[56:59]
  s_add_u32 m0, s65, 0
  s_nop 0
  buffer_load_dwordx4 v92, s[48:51], s64 offen sc1 lds
  v_mfma_f32_16x16x32_bf16 v[64:67], a[84:87], v[40:43], v[64:67]
  v_mfma_f32_16x16x32_bf16 v[72:75], a[164:167], v[40:43], v[72:75]
  v_mfma_f32_16x16x32_bf16 v[60:63], a[4:7], v[44:47], v[60:63]
  v_mfma_f32_16x16x32_bf16 v[68:71], a[84:87], v[44:47], v[68:71]
  v_mfma_f32_16x16x32_bf16 v[76:79], a[164:167], v[44:47], v[76:79]
  ds_read_b128 v[40:43], v102 offset:256
  ds_read_b128 v[44:47], v102 offset:20736
  s_waitcnt lgkmcnt(4)
  v_mfma_f32_16x16x32_bf16 v[56:59], a[8:11], v[48:51], v[56:59]
  v_mfma_f32_16x16x32_bf16 v[64:67], a[88:91], v[48:51], v[64:67]
  v_mfma_f32_16x16x32_bf16 v[72:75], a[168:171], v[48:51], v[72:75]
  v_mfma_f32_16x16x32_bf16 v[60:63], a[8:11], v[52:55], v[60:63]
  v_mfma_f32_16x16x32_bf16 v[68:71], a[88:91], v[52:55], v[68:71]
  s_add_u32 m0, s65, 1024
  s_nop 0
  buffer_load_dwordx4 v93, s[48:51], s64 offen sc1 lds
  v_mfma_f32_16x16x32_bf16 v[76:79], a[168:171], v[52:55], v[76:79]
  ds_read_b128 v[48:51], v103 offset:256
  ds_read_b128 v[52:55], v103 offset:20736
  s_waitcnt lgkmcnt(4)
  v_mfma_f32_16x16x32_bf16 v[56:59], a[12:15], v[32:35], v[56:59]
  v_mfma_f32_16x16x32_bf16 v[64:67], a[92:95], v[32:35], v[64:67]
  v_mfma_f32_16x16x32_bf16 v[72:75], a[172:175], v[32:35], v[72:75]
  v_mfma_f32_16x16x32_bf16 v[60:63], a[12:15], v[36:39], v[60:63]
  v_mfma_f32_16x16x32_bf16 v[68:71], a[92:95], v[36:39], v[68:71]
  v_mfma_f32_16x16x32_bf16 v[76:79], a[172:175], v[36:39], v[76:79]
  ds_read_b128 v[32:35], v104 offset:256
  ds_read_b128 v[36:39], v104 offset:20736
  s_waitcnt lgkmcnt(4)
  v_mfma_f32_16x16x32_bf16 v[56:59], a[16:19], v[40:43], v[56:59]
  v_mfma_f32_16x16x32_bf16 v[64:67], a[96:99], v[40:43], v[64:67]
  v_mfma_f32_16x16x32_bf16 v[72:75], a[176:179], v[40:43], v[72:75]
  s_add_u32 m0, s65, 2048
  s_nop 0
  buffer_load_dwordx4 v94, s[48:51], s64 offen sc1 lds
  v_mfma_f32_16x16x32_bf16 v[60:63], a[16:19], v[44:47], v[60:63]
  v_mfma_f32_16x16x32_bf16 v[68:71], a[96:99], v[44:47], v[68:71]
  v_mfma_f32_16x16x32_bf16 v[76:79], a[176:179], v[44:47], v[76:79]
  ds_read_b128 v[40:43], v105 offset:256
  ds_read_b128 v[44:47], v105 offset:20736
  s_waitcnt lgkmcnt(4)
  v_mfma_f32_16x16x32_bf16 v[56:59], a[20:23], v[48:51], v[56:59]
  v_mfma_f32_16x16x32_bf16 v[64:67], a[100:103], v[48:51], v[64:67]
  v_mfma_f32_16x16x32_bf16 v[72:75], a[180:183], v[48:51], v[72:75]
  v_mfma_f32_16x16x32_bf16 v[60:63], a[20:23], v[52:55], v[60:63]
  v_mfma_f32_16x16x32_bf16 v[68:71], a[100:103], v[52:55], v[68:71]
  v_mfma_f32_16x16x32_bf16 v[76:79], a[180:183], v[52:55], v[76:79]
  ds_read_b128 v[48:51], v102 offset:512
  ds_read_b128 v[52:55], v102 offset:20992
  s_waitcnt lgkmcnt(4)
  v_mfma_f32_16x16x32_bf16 v[56:59], a[24:27], v[32:35], v[56:59]
  s_add_u32 m0, s65, 3072
  s_nop 0
  buffer_load_dwordx4 v95, s[48:51], s64 offen sc1 lds
  v_mfma_f32_16x16x32_bf16 v[64:67], a[104:107], v[32:35], v[64:67]
  v_mfma_f32_16x16x32_bf16 v[72:75], a[184:187], v[32:35], v[72:75]
  v_mfma_f32_16x16x32_bf16 v[60:63], a[24:27], v[36:39], v[60:63]
  v_mfma_f32_16x16x32_bf16 v[68:71], a[104:107], v[36:39], v[68:71]
  v_mfma_f32_16x16x32_bf16 v[76:79], a[184:187], v[36:39], v[76:79]
  ds_read_b128 v[32:35], v103 offset:512
  ds_read_b128 v[36:39], v103 offset:20992
  s_waitcnt lgkmcnt(4)
  v_mfma_f32_16x16x32_bf16 v[56:59], a[28:31], v[40:43], v[56:59]
  v_mfma_f32_16x16x32_bf16 v[64:67], a[108:111], v[40:43], v[64:67]
  v_mfma_f32_16x16x32_bf16 v[72:75], a[188:191], v[40:43], v[72:75]
  v_mfma_f32_16x16x32_bf16 v[60:63], a[28:31], v[44:47], v[60:63]
  v_mfma_f32_16x16x32_bf16 v[68:71], a[108:111], v[44:47], v[68:71]
  s_add_u32 m0, s65, 4096
  s_nop 0
  buffer_load_dwordx4 v96, s[48:51], s64 offen sc1 lds
  v_mfma_f32_16x16x32_bf16 v[76:79], a[188:191], v[44:47], v[76:79]
  ds_read_b128 v[40:43], v104 offset:512
  ds_read_b128 v[44:47], v104 offset:20992
  s_waitcnt lgkmcnt(4)
  v_mfma_f32_16x16x32_bf16 v[56:59], a[32:35], v[48:51], v[56:59]
  v_mfma_f32_16x16x32_bf16 v[64:67], a[112:115], v[48:51], v[64:67]
  v_mfma_f32_16x16x32_bf16 v[72:75], a[192:195], v[48:51], v[72:75]
  v_mfma_f32_16x16x32_bf16 v[60:63], a[32:35], v[52:55], v[60:63]
  v_mfma_f32_16x16x32_bf16 v[68:71], a[112:115], v[52:55], v[68:71]
  v_mfma_f32_16x16x32_bf16 v[76:79], a[192:195], v[52:55], v[76:79]
  ds_read_b128 v[48:51], v105 offset:512
  ds_read_b128 v[52:55], v105 offset:20992
  s_waitcnt lgkmcnt(4)
  v_mfma_f32_16x16x32_bf16 v[56:59], a[36:39], v[32:35], v[56:59]
  v_mfma_f32_16x16x32_bf16 v[64:67], a[116:119], v[32:35], v[64:67]
  v_mfma_f32_16x16x32_bf16 v[72:75], a[196:199], v[32:35], v[72:75]
  s_add_u32 m0, s65, 5120
  s_nop 0
  buffer_load_dwordx4 v97, s[48:51], s64 offen sc1 lds
  v_mfma_f32_16x16x32_bf16 v[60:63], a[36:39], v[36:39], v[60:63]
  v_mfma_f32_16x16x32_bf16 v[68:71], a[116:119], v[36:39], v[68:71]
  v_mfma_f32_16x16x32_bf16 v[76:79], a[196:199], v[36:39], v[76:79]
  ds_read_b128 v[32:35], v102 offset:768
  ds_read_b128 v[36:39], v102 offset:21248
  s_waitcnt lgkmcnt(4)
  v_mfma_f32_16x16x32_bf16 v[56:59], a[40:43], v[40:43], v[56:59]
  v_mfma_f32_16x16x32_bf16 v[64:67], a[120:123], v[40:43], v[64:67]
  v_mfma_f32_16x16x32_bf16 v[72:75], a[200:203], v[40:43], v[72:75]
  v_mfma_f32_16x16x32_bf16 v[60:63], a[40:43], v[44:47], v[60:63]
  v_mfma_f32_16x16x32_bf16 v[68:71], a[120:123], v[44:47], v[68:71]
  v_mfma_f32_16x16x32_bf16 v[76:79], a[200:203], v[44:47], v[76:79]
  ds_read_b128 v[40:43], v103 offset:768
  ds_read_b128 v[44:47], v103 offset:21248
  s_waitcnt lgkmcnt(4)
  v_mfma_f32_16x16x32_bf16 v[56:59], a[44:47], v[48:51], v[56:59]
  s_add_u32 m0, s65, 6144
  s_nop 0
  buffer_load_dwordx4 v98, s[48:51], s64 offen sc1 lds
  v_mfma_f32_16x16x32_bf16 v[64:67], a[124:127], v[48:51], v[64:67]
  v_mfma_f32_16x16x32_bf16 v[72:75], a[204:207], v[48:51], v[72:75]
  v_mfma_f32_16x16x32_bf16 v[60:63], a[44:47], v[52:55], v[60:63]
  v_mfma_f32_16x16x32_bf16 v[68:71], a[124:127], v[52:55], v[68:71]
  v_mfma_f32_16x16x32_bf16 v[76:79], a[204:207], v[52:55], v[76:79]
  ds_read_b128 v[48:51], v104 offset:768
  ds_read_b128 v[52:55], v104 offset:21248
  s_waitcnt lgkmcnt(4)
  v_mfma_f32_16x16x32_bf16 v[56:59], a[48:51], v[32:35], v[56:59]
  v_mfma_f32_16x16x32_bf16 v[64:67], a[128:131], v[32:35], v[64:67]
  v_mfma_f32_16x16x32_bf16 v[72:75], a[208:211], v[32:35], v[72:75]
  v_mfma_f32_16x16x32_bf16 v[60:63], a[48:51], v[36:39], v[60:63]
  v_mfma_f32_16x16x32_bf16 v[68:71], a[128:131], v[36:39], v[68:71]
  s_add_u32 m0, s65, 7168
  s_nop 0
  buffer_load_dwordx4 v99, s[48:51], s64 offen sc1 lds
  v_mfma_f32_16x16x32_bf16 v[76:79], a[208:211], v[36:39], v[76:79]
  ds_read_b128 v[32:35], v105 offset:768
  ds_read_b128 v[36:39], v105 offset:21248
  s_waitcnt lgkmcnt(4)
  v_mfma_f32_16x16x32_bf16 v[56:59], a[52:55], v[40:43], v[56:59]
  v_mfma_f32_16x16x32_bf16 v[64:67], a[132:135], v[40:43], v[64:67]
  v_mfma_f32_16x16x32_bf16 v[72:75], a[212:215], v[40:43], v[72:75]
  v_mfma_f32_16x16x32_bf16 v[60:63], a[52:55], v[44:47], v[60:63]
  v_mfma_f32_16x16x32_bf16 v[68:71], a[132:135], v[44:47], v[68:71]
  v_mfma_f32_16x16x32_bf16 v[76:79], a[212:215], v[44:47], v[76:79]
  ds_read_b128 v[40:43], v102 offset:1024
  ds_read_b128 v[44:47], v102 offset:21504
  s_waitcnt lgkmcnt(4)
  v_mfma_f32_16x16x32_bf16 v[56:59], a[56:59], v[48:51], v[56:59]
  v_mfma_f32_16x16x32_bf16 v[64:67], a[136:139], v[48:51], v[64:67]
  v_mfma_f32_16x16x32_bf16 v[72:75], a[216:219], v[48:51], v[72:75]
  s_add_u32 m0, s65, 8192
  s_nop 0
  buffer_load_dwordx4 v100, s[48:51], s64 offen sc1 lds
  v_mfma_f32_16x16x32_bf16 v[60:63], a[56:59], v[52:55], v[60:63]
  v_mfma_f32_16x16x32_bf16 v[68:71], a[136:139], v[52:55], v[68:71]
  v_mfma_f32_16x16x32_bf16 v[76:79], a[216:219], v[52:55], v[76:79]
  ds_read_b128 v[48:51], v103 offset:1024
  ds_read_b128 v[52:55], v103 offset:21504
  s_waitcnt lgkmcnt(4)
  v_mfma_f32_16x16x32_bf16 v[56:59], a[60:63], v[32:35], v[56:59]
  v_mfma_f32_16x16x32_bf16 v[64:67], a[140:143], v[32:35], v[64:67]
  v_mfma_f32_16x16x32_bf16 v[72:75], a[220:223], v[32:35], v[72:75]
  v_mfma_f32_16x16x32_bf16 v[60:63], a[60:63], v[36:39], v[60:63]
  v_mfma_f32_16x16x32_bf16 v[68:71], a[140:143], v[36:39], v[68:71]
  v_mfma_f32_16x16x32_bf16 v[76:79], a[220:223], v[36:39], v[76:79]
  ds_read_b128 v[32:35], v104 offset:1024
  ds_read_b128 v[36:39], v104 offset:21504
  s_waitcnt lgkmcnt(4)
  v_mfma_f32_16x16x32_bf16 v[56:59], a[64:67], v[40:43], v[56:59]
  s_add_u32 m0, s65, 9216
  s_nop 0
  buffer_load_dwordx4 v101, s[48:51], s64 offen sc1 lds
  v_mfma_f32_16x16x32_bf16 v[64:67], a[144:147], v[40:43], v[64:67]
  v_mfma_f32_16x16x32_bf16 v[72:75], a[224:227], v[40:43], v[72:75]
  v_mfma_f32_16x16x32_bf16 v[60:63], a[64:67], v[44:47], v[60:63]
  v_mfma_f32_16x16x32_bf16 v[68:71], a[144:147], v[44:47], v[68:71]
  v_mfma_f32_16x16x32_bf16 v[76:79], a[224:227], v[44:47], v[76:79]
  ds_read_b128 v[40:43], v105 offset:1024
  ds_read_b128 v[44:47], v105 offset:21504
  s_waitcnt lgkmcnt(4)
  v_mfma_f32_16x16x32_bf16 v[56:59], a[68:71], v[48:51], v[56:59]
  v_mfma_f32_16x16x32_bf16 v[64:67], a[148:151], v[48:51], v[64:67]
  v_mfma_f32_16x16x32_bf16 v[72:75], a[228:231], v[48:51], v[72:75]
  v_mfma_f32_16x16x32_bf16 v[60:63], a[68:71], v[52:55], v[60:63]
  v_mfma_f32_16x16x32_bf16 v[68:71], a[148:151], v[52:55], v[68:71]
  v_mfma_f32_16x16x32_bf16 v[76:79], a[228:231], v[52:55], v[76:79]
  s_waitcnt lgkmcnt(2)
  v_mfma_f32_16x16x32_bf16 v[56:59], a[72:75], v[32:35], v[56:59]
  v_mfma_f32_16x16x32_bf16 v[64:67], a[152:155], v[32:35], v[64:67]
  v_mfma_f32_16x16x32_bf16 v[72:75], a[232:235], v[32:35], v[72:75]
  v_mfma_f32_16x16x32_bf16 v[60:63], a[72:75], v[36:39], v[60:63]
  v_mfma_f32_16x16x32_bf16 v[68:71], a[152:155], v[36:39], v[68:71]
  v_mfma_f32_16x16x32_bf16 v[76:79], a[232:235], v[36:39], v[76:79]
  s_waitcnt lgkmcnt(0)
  v_mfma_f32_16x16x32_bf16 v[56:59], a[76:79], v[40:43], v[56:59]
  v_mfma_f32_16x16x32_bf16 v[64:67], a[156:159], v[40:43], v[64:67]
  v_mfma_f32_16x16x32_bf16 v[72:75], a[236:239], v[40:43], v[72:75]
  v_mfma_f32_16x16x32_bf16 v[60:63], a[76:79], v[44:47], v[60:63]
  v_mfma_f32_16x16x32_bf16 v[68:71], a[156:159], v[44:47], v[68:71]
  v_mfma_f32_16x16x32_bf16 v[76:79], a[236:239], v[44:47], v[76:79]
  v_add_u32 v102, s71, v102
  v_add_u32 v103, s71, v103
  v_add_u32 v104, s71, v104
  v_add_u32 v105, s71, v105
  s_sub_u32 s71, 0, s71
  s_nop 2
  v_cvt_pk_bf16_f32 v80, v56, v57
  v_cvt_pk_bf16_f32 v81, v58, v59
  buffer_store_dwordx2 v[80:81], v2, s[40:43], s66 offen offset:0
  v_cvt_pk_bf16_f32 v82, v60, v61
  v_cvt_pk_bf16_f32 v83, v62, v63
  buffer_store_dwordx2 v[82:83], v3, s[40:43], s66 offen offset:0
  v_cvt_pk_bf16_f32 v84, v64, v65
  v_cvt_pk_bf16_f32 v85, v66, v67
  buffer_store_dwordx2 v[84:85], v2, s[40:43], s66 offen offset:32
  v_cvt_pk_bf16_f32 v86, v68, v69
  v_cvt_pk_bf16_f32 v87, v70, v71
  buffer_store_dwordx2 v[86:87], v3, s[40:43], s66 offen offset:32
  v_cvt_pk_bf16_f32 v88, v72, v73
  v_cvt_pk_bf16_f32 v89, v74, v75
  buffer_store_dwordx2 v[88:89], v2, s[40:43], s66 offen offset:64
  v_cvt_pk_bf16_f32 v90, v76, v77
  v_cvt_pk_bf16_f32 v91, v78, v79
  buffer_store_dwordx2 v[90:91], v3, s[40:43], s66 offen offset:64
  s_add_u32 s66, s66, 81920
  s_add_u32 s62, s62, 1
  s_cmp_lt_u32 s62, s63
  s_cbranch_scc1 L_b3_r
  s_waitcnt vmcnt(0)
  s_barrier
  s_endpgm
L_t23_r:
  s_waitcnt vmcnt(0)
  s_barrier
  s_waitcnt vmcnt(0)
  s_mov_b32 s56, 0
  v_mov_b32 v20, 128
iw_7070:
  buffer_load_dwordx2 v[18:19], v20, s[44:47], 0 offen sc1
  s_waitcnt vmcnt(0)
  v_readfirstlane_b32 s58, v18
  v_readfirstlane_b32 s59, v19
  s_cmp_lg_u32 s59, 0
  s_cbranch_scc1 L_to_irregular
  s_cmpk_ge_u32 s58, 256
  s_cbranch_scc1 iwd_7071
  s_cmp_lg_u32 s55, 0
  s_cbranch_scc1 iwd_7071
  s_add_u32 s56, s56, 1
  s_cmp_lt_u32 s56, 0x20000
  s_cbranch_scc1 iw_7070
  s_mov_b32 s55, 1
iwd_7071:
  s_cmp_lg_u32 s52, 0
  s_cbranch_scc1 gate_7072
  s_lshl_b32 s59, s53, 3
  s_and_b32 s60, s54, 7
  s_add_u32 s59, s59, s60
  s_lshl_b32 s59, s59, 8
  s_add_u32 s59, s59, 0
  v_mov_b32 v19, s59
  s_mov_b32 s56, 0
poll_7073:
  buffer_load_dword v18, v19, s[48:51], 0 offen sc1
  s_waitcnt vmcnt(0)
  v_readfirstlane_b32 s58, v18
  s_cmp_ge_u32 s58, 1
  s_cbranch_scc1 polldone_7074
  s_cmp_lg_u32 s55, 0
  s_cbranch_scc1 polldone_7074
  s_add_u32 s56, s56, 1
  s_cmp_lt_u32 s56, 0x20000
  s_cbranch_scc1 poll_7073
  s_mov_b32 s55, 1
polldone_7074:
gate_7072:
  s_barrier
  s_cmp_lt_u32 s54, 24
  s_cbranch_scc1 nob1_7068
  s_lshl_b32 s61, s53, 3
  s_add_u32 s61, s61, s54
  s_sub_u32 s61, s61, 24
  s_cmp_ge_u32 s61, 30
  s_cbranch_scc1 nob1_7068
  s_mul_i32 s58, s61, 6554
  s_lshr_b32 s58, s58, 16
  s_mul_i32 s59, s58, 10
  s_sub_u32 s78, s61, s59
  s_mul_i32 s62, s58, 22
  s_cmp_eq_u32 s58, 2
  s_cselect_b32 s59, 1, 0
  s_sub_u32 s62, s62, s59
  s_cmp_lt_u32 s58, 1
  s_cselect_b32 s59, 22, 21
  s_add_u32 s63, s62, s59
  v_and_b32 v1, 63, v0
  s_mul_i32 s58, s52, 640
  s_add_u32 s59, s58, 0
  v_add_u32 v18, s59, v1
  v_mul_u32_u24 v19, 3277, v18
  v_lshrrev_b32 v19, 18, v19
  v_mul_u32_u24 v20, 80, v19
  v_sub_u32 v18, v18, v20
  v_and_b32 v20, 15, v19
  v_xor_b32 v18, v18, v20
  v_lshlrev_b32 v18, 4, v18
  v_mul_u32_u24 v19, 1280, v19
  v_add_u32 v92, v18, v19
  s_add_u32 s59, s58, 64
  v_add_u32 v18, s59, v1
  v_mul_u32_u24 v19, 3277, v18
  v_lshrrev_b32 v19, 18, v19
  v_mul_u32_u24 v20, 80, v19
  v_sub_u32 v18, v18, v20
  v_and_b32 v20, 15, v19
  v_xor_b32 v18, v18, v20
  v_lshlrev_b32 v18, 4, v18
  v_mul_u32_u24 v19, 1280, v19
  v_add_u32 v93, v18, v19
  s_add_u32 s59, s58, 128
  v_add_u32 v18, s59, v1
  v_mul_u32_u24 v19, 3277, v18
  v_lshrrev_b32 v19, 18, v19
  v_mul_u32_u24 v20, 80, v19
  v_sub_u32 v18, v18, v20
  v_and_b32 v20, 15, v19
  v_xor_b32 v18, v18, v20
  v_lshlrev_b32 v18, 4, v18
  v_mul_u32_u24 v19, 1280, v19
  v_add_u32 v94, v18, v19
  s_add_u32 s59, s58, 192
  v_add_u32 v18, s59, v1
  v_mul_u32_u24 v19, 3277, v18
  v_lshrrev_b32 v19, 18, v19
  v_mul_u32_u24 v20, 80, v19
  v_sub_u32 v18, v18, v20
  v_and_b32 v20, 15, v19
  v_xor_b32 v18, v18, v20
  v_lshlrev_b32 v18, 4, v18
  v_mul_u32_u24 v19, 1280, v19
  v_add_u32 v95, v18, v19
  s_add_u32 s59, s58, 256
  v_add_u32 v18, s59, v1
  v_mul_u32_u24 v19, 3277, v18
  v_lshrrev_b32 v19, 18, v19
  v_mul_u32_u24 v20, 80, v19
  v_sub_u32 v18, v18, v20
  v_and_b32 v20, 15, v19
  v_xor_b32 v18, v18, v20
  v_lshlrev_b32 v18, 4, v18
  v_mul_u32_u24 v19, 1280, v19
  v_add_u32 v96, v18, v19
  s_add_u32 s59, s58, 320
  v_add_u32 v18, s59, v1
  v_mul_u32_u24 v19, 3277, v18
  v_lshrrev_b32 v19, 18, v19
  v_mul_u32_u24 v20, 80, v19
  v_sub_u32 v18, v18, v20
  v_and_b32 v20, 15, v19
  v_xor_b32 v18, v18, v20
  v_lshlrev_b32 v18, 4, v18
  v_mul_u32_u24 v19, 1280, v19
  v_add_u32 v97, v18, v19
  s_add_u32 s59, s58, 384
  v_add_u32 v18, s59, v1
  v_mul_u32_u24 v19, 3277, v18
  v_lshrrev_b32 v19, 18, v19
  v_mul_u32_u24 v20, 80, v19
  v_sub_u32 v18, v18, v20
  v_and_b32 v20, 15, v19
  v_xor_b32 v18, v18, v20
  v_lshlrev_b32 v18, 4, v18
  v_mul_u32_u24 v19, 1280, v19
  v_add_u32 v98, v18, v19
  s_add_u32 s59, s58, 448
  v_add_u32 v18, s59, v1
  v_mul_u32_u24 v19, 3277, v18
  v_lshrrev_b32 v19, 18, v19
  v_mul_u32_u24 v20, 80, v19
  v_sub_u32 v18, v18, v20
  v_and_b32 v20, 15, v19
  v_xor_b32 v18, v18, v20
  v_lshlrev_b32 v18, 4, v18
  v_mul_u32_u24 v19, 1280, v19
  v_add_u32 v99, v18, v19
  s_add_u32 s59, s58, 512
  v_add_u32 v18, s59, v1
  v_mul_u32_u24 v19, 3277, v18
  v_lshrrev_b32 v19, 18, v19
  v_mul_u32_u24 v20, 80, v19
  v_sub_u32 v18, v18, v20
  v_and_b32 v20, 15, v19
  v_xor_b32 v18, v18, v20
  v_lshlrev_b32 v18, 4, v18
  v_mul_u32_u24 v19, 1280, v19
  v_add_u32 v100, v18, v19
  s_add_u32 s59, s58, 576
  v_add_u32 v18, s59, v1
  v_mul_u32_u24 v19, 3277, v18
  v_lshrrev_b32 v19, 18, v19
  v_mul_u32_u24 v20, 80, v19
  v_sub_u32 v18, v18, v20
  v_and_b32 v20, 15, v19
  v_xor_b32 v18, v18, v20
  v_lshlrev_b32 v18, 4, v18
  v_mul_u32_u24 v19, 1280, v19
  v_add_u32 v101, v18, v19
  v_and_b32 v18, 15, v1
  v_lshrrev_b32 v19, 4, v1
  v_xor_b32 v19, v19, v18
  v_mul_u32_u24 v18, 1280, v18
  v_add_u32 v18, 0x1e000, v18
  v_xor_b32 v20, 0, v19
  v_lshlrev_b32 v20, 4, v20
  v_add_u32 v102, v18, v20
  v_xor_b32 v20, 4, v19
  v_lshlrev_b32 v20, 4, v20
  v_add_u32 v103, v18, v20
  v_xor_b32 v20, 8, v19
  v_lshlrev_b32 v20, 4, v20
  v_add_u32 v104, v18, v20
  v_xor_b32 v20, 12, v19
  v_lshlrev_b32 v20, 4, v20
  v_add_u32 v105, v18, v20
  v_lshrrev_b32 v18, 4, v1
  v_lshrrev_b32 v19, 2, v1
  v_and_b32 v19, 3, v19
  v_lshlrev_b32 v20, 3, v18
  v_add_u32 v20, v20, v19
  v_mul_u32_u24 v20, 384, v20
  v_and_b32 v21, 3, v1
  v_lshlrev_b32 v21, 3, v21
  v_add_u32 v20, v20, v21
  v_lshrrev_b32 v19, 1, v19
  v_and_b32 v18, 1, v18
  v_lshlrev_b32 v18, 1, v18
  v_or_b32 v18, v18, v19
  s_mul_i32 s58, s52, 3
  s_add_u32 s59, s58, 0
  v_xor_b32 v19, s59, v18
  v_lshlrev_b32 v19, 5, v19
  v_add_u32 v26, v19, v20
  s_add_u32 s59, s58, 1
  v_xor_b32 v19, s59, v18
  v_lshlrev_b32 v19, 5, v19
  v_add_u32 v27, v19, v20
  s_add_u32 s59, s58, 2
  v_xor_b32 v19, s59, v18
  v_lshlrev_b32 v19, 5, v19
  v_add_u32 v28, v19, v20
  s_mul_i32 s67, s78, 384
  s_mul_i32 s64, s62, 40960
  s_mul_i32 s65, s52, 10240
  s_add_u32 s65, s65, 122880
  v_mov_b32 v18, v0
  v_mul_u32_u24 v19, 2731, v18
  v_lshrrev_b32 v19, 16, v19
  v_mul_u32_u24 v20, 24, v19
  v_sub_u32 v18, v18, v20
  v_and_b32 v20, 2, v19
  v_lshrrev_b32 v21, 1, v19
  v_and_b32 v21, 4, v21
  v_or_b32 v20, v20, v21
  v_xor_b32 v18, v18, v20
  v_mul_u32_u24 v19, 3840, v19
  v_lshlrev_b32 v18, 4, v18
  v_add_u32 v2, v18, v19
  v_add_u32 v18, 256, v0
  v_mul_u32_u24 v19, 2731, v18
  v_lshrrev_b32 v19, 16, v19
  v_mul_u32_u24 v20, 24, v19
  v_sub_u32 v18, v18, v20
  v_and_b32 v20, 2, v19
  v_lshrrev_b32 v21, 1, v19
  v_and_b32 v21, 4, v21
  v_or_b32 v20, v20, v21
  v_xor_b32 v18, v18, v20
  v_mul_u32_u24 v19, 3840, v19
  v_lshlrev_b32 v18, 4, v18
  v_add_u32 v3, v18, v19
  v_add_u32 v18, 512, v0
  v_mul_u32_u24 v19, 2731, v18
  v_lshrrev_b32 v19, 16, v19
  v_mul_u32_u24 v20, 24, v19
  v_sub_u32 v18, v18, v20
  v_and_b32 v20, 2, v19
  v_lshrrev_b32 v21, 1, v19
  v_and_b32 v21, 4, v21
  v_or_b32 v20, v20, v21
  v_xor_b32 v18, v18, v20
  v_mul_u32_u24 v19, 3840, v19
  v_lshlrev_b32 v18, 4, v18
  v_add_u32 v4, v18, v19
  v_add_u32 v18, 768, v0
  v_mul_u32_u24 v19, 2731, v18
  v_lshrrev_b32 v19, 16, v19
  v_mul_u32_u24 v20, 24, v19
  v_sub_u32 v18, v18, v20
  v_and_b32 v20, 2, v19
  v_lshrrev_b32 v21, 1, v19
  v_and_b32 v21, 4, v21
  v_or_b32 v20, v20, v21
  v_xor_b32 v18, v18, v20
  v_mul_u32_u24 v19, 3840, v19
  v_lshlrev_b32 v18, 4, v18
  v_add_u32 v5, v18, v19
  v_add_u32 v18, 1024, v0
  v_mul_u32_u24 v19, 2731, v18
  v_lshrrev_b32 v19, 16, v19
  v_mul_u32_u24 v20, 24, v19
  v_sub_u32 v18, v18, v20
  v_and_b32 v20, 2, v19
  v_lshrrev_b32 v21, 1, v19
  v_and_b32 v21, 4, v21
  v_or_b32 v20, v20, v21
  v_xor_b32 v18, v18, v20
  v_mul_u32_u24 v19, 3840, v19
  v_lshlrev_b32 v18, 4, v18
  v_add_u32 v6, v18, v19
  v_add_u32 v18, 1280, v0
  v_mul_u32_u24 v19, 2731, v18
  v_lshrrev_b32 v19, 16, v19
  v_mul_u32_u24 v20, 24, v19
  v_sub_u32 v18, v18, v20
  v_and_b32 v20, 2, v19
  v_lshrrev_b32 v21, 1, v19
  v_and_b32 v21, 4, v21
  v_or_b32 v20, v20, v21
  v_xor_b32 v18, v18, v20
  v_mul_u32_u24 v19, 3840, v19
  v_lshlrev_b32 v18, 4, v18
  v_add_u32 v7, v18, v19
  v_add_u32 v18, 1536, v0
  v_mul_u32_u24 v19, 2731, v18
  v_lshrrev_b32 v19, 16, v19
  v_mul_u32_u24 v20, 24, v19
  v_sub_u32 v18, v18, v20
  v_and_b32 v20, 2, v19
  v_lshrrev_b32 v21, 1, v19
  v_and_b32 v21, 4, v21
  v_or_b32 v20, v20, v21
  v_xor_b32 v18, v18, v20
  v_mul_u32_u24 v19, 3840, v19
  v_lshlrev_b32 v18, 4, v18
  v_add_u32 v8, v18, v19
  v_add_u32 v18, 1792, v0
  v_mul_u32_u24 v19, 2731, v18
  v_lshrrev_b32 v19, 16, v19
  v_mul_u32_u24 v20, 24, v19
  v_sub_u32 v18, v18, v20
  v_and_b32 v20, 2, v19
  v_lshrrev_b32 v21, 1, v19
  v_and_b32 v21, 4, v21
  v_or_b32 v20, v20, v21
  v_xor_b32 v18, v18, v20
  v_mul_u32_u24 v19, 3840, v19
  v_lshlrev_b32 v18, 4, v18
  v_add_u32 v9, v18, v19
  v_add_u32 v18, 2048, v0
  v_mul_u32_u24 v19, 2731, v18
  v_lshrrev_b32 v19, 16, v19
  v_mul_u32_u24 v20, 24, v19
  v_sub_u32 v18, v18, v20
  v_and_b32 v20, 2, v19
  v_lshrrev_b32 v21, 1, v19
  v_and_b32 v21, 4, v21
  v_or_b32 v20, v20, v21
  v_xor_b32 v18, v18, v20
  v_mul_u32_u24 v19, 3840, v19
  v_lshlrev_b32 v18, 4, v18
  v_add_u32 v10, v18, v19
  v_add_u32 v18, 2304, v0
  v_mul_u32_u24 v19, 2731, v18
  v_lshrrev_b32 v19, 16, v19
  v_mul_u32_u24 v20, 24, v19
  v_sub_u32 v18, v18, v20
  v_and_b32 v20, 2, v19
  v_lshrrev_b32 v21, 1, v19
  v_and_b32 v21, 4, v21
  v_or_b32 v20, v20, v21
  v_xor_b32 v18, v18, v20
  v_mul_u32_u24 v19, 3840, v19
  v_lshlrev_b32 v18, 4, v18
  v_add_u32 v11, v18, v19
  v_add_u32 v18, 2560, v0
  v_mul_u32_u24 v19, 2731, v18
  v_lshrrev_b32 v19, 16, v19
  v_mul_u32_u24 v20, 24, v19
  v_sub_u32 v18, v18, v20
  v_and_b32 v20, 2, v19
  v_lshrrev_b32 v21, 1, v19
  v_and_b32 v21, 4, v21
  v_or_b32 v20, v20, v21
  v_xor_b32 v18, v18, v20
  v_mul_u32_u24 v19, 3840, v19
  v_lshlrev_b32 v18, 4, v18
  v_add_u32 v12, v18, v19
  v_add_u32 v18, 2816, v0
  v_mul_u32_u24 v19, 2731, v18
  v_lshrrev_b32 v19, 16, v19
  v_mul_u32_u24 v20, 24, v19
  v_sub_u32 v18, v18, v20
  v_and_b32 v20, 2, v19
  v_lshrrev_b32 v21, 1, v19
  v_and_b32 v21, 4, v21
  v_or_b32 v20, v20, v21
  v_xor_b32 v18, v18, v20
  v_mul_u32_u24 v19, 3840, v19
  v_lshlrev_b32 v18, 4, v18
  v_add_u32 v13, v18, v19
  v_add_u32 v18, 3072, v0
  v_mul_u32_u24 v19, 2731, v18
  v_lshrrev_b32 v19, 16, v19
  v_mul_u32_u24 v20, 24, v19
  v_sub_u32 v18, v18, v20
  v_and_b32 v20, 2, v19
  v_lshrrev_b32 v21, 1, v19
  v_and_b32 v21, 4, v21
  v_or_b32 v20, v20, v21
  v_xor_b32 v18, v18, v20
  v_mul_u32_u24 v19, 3840, v19
  v_lshlrev_b32 v18, 4, v18
  v_add_u32 v14, v18, v19
  v_add_u32 v18, 3328, v0
  v_mul_u32_u24 v19, 2731, v18
  v_lshrrev_b32 v19, 16, v19
  v_mul_u32_u24 v20, 24, v19
  v_sub_u32 v18, v18, v20
  v_and_b32 v20, 2, v19
  v_lshrrev_b32 v21, 1, v19
  v_and_b32 v21, 4, v21
  v_or_b32 v20, v20, v21
  v_xor_b32 v18, v18, v20
  v_mul_u32_u24 v19, 3840, v19
  v_lshlrev_b32 v18, 4, v18
  v_add_u32 v15, v18, v19
  v_add_u32 v18, 3584, v0
  v_mul_u32_u24 v19, 2731, v18
  v_lshrrev_b32 v19, 16, v19
  v_mul_u32_u24 v20, 24, v19
  v_sub_u32 v18, v18, v20
  v_and_b32 v20, 2, v19
  v_lshrrev_b32 v21, 1, v19
  v_and_b32 v21, 4, v21
  v_or_b32 v20, v20, v21
  v_xor_b32 v18, v18, v20
  v_mul_u32_u24 v19, 3840, v19
  v_lshlrev_b32 v18, 4, v18
  v_add_u32 v16, v18, v19
  s_add_u32 m0, s65, 0
  s_nop 0
  buffer_load_dwordx4 v92, s[28:31], s64 offen lds
  s_add_u32 m0, s65, 1024
  s_nop 0
  buffer_load_dwordx4 v93, s[28:31], s64 offen lds
  s_add_u32 m0, s65, 2048
  s_nop 0
  buffer_load_dwordx4 v94, s[28:31], s64 offen lds
  s_add_u32 m0, s65, 3072
  s_nop 0
  buffer_load_dwordx4 v95, s[28:31], s64 offen lds
  s_add_u32 m0, s65, 4096
  s_nop 0
  buffer_load_dwordx4 v96, s[28:31], s64 offen lds
  s_add_u32 m0, s65, 5120
  s_nop 0
  buffer_load_dwordx4 v97, s[28:31], s64 offen lds
  s_add_u32 m0, s65, 6144
  s_nop 0
  buffer_load_dwordx4 v98, s[28:31], s64 offen lds
  s_add_u32 m0, s65, 7168
  s_nop 0
  buffer_load_dwordx4 v99, s[28:31], s64 offen lds
  s_add_u32 m0, s65, 8192
  s_nop 0
  buffer_load_dwordx4 v100, s[28:31], s64 offen lds
  s_add_u32 m0, s65, 9216
  s_nop 0
  buffer_load_dwordx4 v101, s[28:31], s64 offen lds
  s_mov_b32 s70, s67
  s_lshl_b32 s60, s52, 10
  s_add_u32 s60, s60, 0x0
  s_add_u32 m0, s60, 0
  s_nop 0
  buffer_load_dwordx4 v2, s[32:35], s70 offen lds
  s_add_u32 m0, s60, 4096
  s_nop 0
  buffer_load_dwordx4 v3, s[32:35], s70 offen lds
  s_add_u32 m0, s60, 8192
  s_nop 0
  buffer_load_dwordx4 v4, s[32:35], s70 offen lds
  s_add_u32 m0, s60, 12288
  s_nop 0
  buffer_load_dwordx4 v5, s[32:35], s70 offen lds
  s_add_u32 m0, s60, 16384
  s_nop 0
  buffer_load_dwordx4 v6, s[32:35], s70 offen lds
  s_add_u32 m0, s60, 20480
  s_nop 0
  buffer_load_dwordx4 v7, s[32:35], s70 offen lds
  s_add_u32 m0, s60, 24576
  s_nop 0
  buffer_load_dwordx4 v8, s[32:35], s70 offen lds
  s_add_u32 m0, s60, 28672
  s_nop 0
  buffer_load_dwordx4 v9, s[32:35], s70 offen lds
  s_add_u32 m0, s60, 32768
  s_nop 0
  buffer_load_dwordx4 v10, s[32:35], s70 offen lds
  s_add_u32 m0, s60, 36864
  s_nop 0
  buffer_load_dwordx4 v11, s[32:35], s70 offen lds
  s_add_u32 m0, s60, 40960
  s_nop 0
  buffer_load_dwordx4 v12, s[32:35], s70 offen lds
  s_add_u32 m0, s60, 45056
  s_nop 0
  buffer_load_dwordx4 v13, s[32:35], s70 offen lds
  s_add_u32 m0, s60, 49152
  s_nop 0
  buffer_load_dwordx4 v14, s[32:35], s70 offen lds
  s_add_u32 m0, s60, 53248
  s_nop 0
  buffer_load_dwordx4 v15, s[32:35], s70 offen lds
  s_add_u32 m0, s60, 57344
  s_nop 0
  buffer_load_dwordx4 v16, s[32:35], s70 offen lds
  s_add_u32 s70, s70, 614400
  s_lshl_b32 s60, s52, 10
  s_add_u32 s60, s60, 0xf000
  s_add_u32 m0, s60, 0
  s_nop 0
  buffer_load_dwordx4 v2, s[32:35], s70 offen lds
  s_add_u32 m0, s60, 4096
  s_nop 0
  buffer_load_dwordx4 v3, s[32:35], s70 offen lds
  s_add_u32 m0, s60, 8192
  s_nop 0
  buffer_load_dwordx4 v4, s[32:35], s70 offen lds
  s_add_u32 m0, s60, 12288
  s_nop 0
  buffer_load_dwordx4 v5, s[32:35], s70 offen lds
  s_add_u32 m0, s60, 16384
  s_nop 0
  buffer_load_dwordx4 v6, s[32:35], s70 offen lds
  s_add_u32 m0, s60, 20480
  s_nop 0
  buffer_load_dwordx4 v7, s[32:35], s70 offen lds
  s_add_u32 m0, s60, 24576
  s_nop 0
  buffer_load_dwordx4 v8, s[32:35], s70 offen lds
  s_add_u32 m0, s60, 28672
  s_nop 0
  buffer_load_dwordx4 v9, s[32:35], s70 offen lds
  s_add_u32 m0, s60, 32768
  s_nop 0
  buffer_load_dwordx4 v10, s[32:35], s70 offen lds
  s_add_u32 m0, s60, 36864
  s_nop 0
  buffer_load_dwordx4 v11, s[32:35], s70 offen lds
  s_add_u32 m0, s60, 40960
  s_nop 0
  buffer_load_dwordx4 v12, s[32:35], s70 offen lds
  s_add_u32 m0, s60, 45056
  s_nop 0
  buffer_load_dwordx4 v13, s[32:35], s70 offen lds
  s_add_u32 m0, s60, 49152
  s_nop 0
  buffer_load_dwordx4 v14, s[32:35], s70 offen lds
  s_add_u32 m0, s60, 53248
  s_nop 0
  buffer_load_dwordx4 v15, s[32:35], s70 offen lds
  s_add_u32 m0, s60, 57344
  s_nop 0
  buffer_load_dwordx4 v16, s[32:35], s70 offen lds
  s_waitcnt vmcnt(15)
  s_barrier
  ds_read_b64_tr_b16 a[0:1], v26 offset:0
  ds_read_b64_tr_b16 a[2:3], v26 offset:1536
  ds_read_b64_tr_b16 a[4:5], v26 offset:12288
  ds_read_b64_tr_b16 a[6:7], v26 offset:13824
  ds_read_b64_tr_b16 a[8:9], v26 offset:24576
  ds_read_b64_tr_b16 a[10:11], v26 offset:26112
  s_waitcnt lgkmcnt(4)
  ds_read_b64_tr_b16 a[12:13], v26 offset:36864
  ds_read_b64_tr_b16 a[14:15], v26 offset:38400
  ds_read_b64_tr_b16 a[16:17], v26 offset:49152
  ds_read_b64_tr_b16 a[18:19], v26 offset:50688
  s_waitcnt lgkmcnt(4)
  ds_read_b64_tr_b16 a[80:81], v27 offset:0
  ds_read_b64_tr_b16 a[82:83], v27 offset:1536
  ds_read_b64_tr_b16 a[84:85], v27 offset:12288
  ds_read_b64_tr_b16 a[86:87], v27 offset:13824
  ds_read_b64_tr_b16 a[88:89], v27 offset:24576
  ds_read_b64_tr_b16 a[90:91], v27 offset:26112
  s_waitcnt lgkmcnt(4)
  ds_read_b64_tr_b16 a[92:93], v27 offset:36864
  ds_read_b64_tr_b16 a[94:95], v27 offset:38400
  ds_read_b64_tr_b16 a[96:97], v27 offset:49152
  ds_read_b64_tr_b16 a[98:99], v27 offset:50688
  s_waitcnt lgkmcnt(4)
  ds_read_b64_tr_b16 a[160:161], v28 offset:0
  ds_read_b64_tr_b16 a[162:163], v28 offset:1536
  ds_read_b64_tr_b16 a[164:165], v28 offset:12288
  ds_read_b64_tr_b16 a[166:167], v28 offset:13824
  ds_read_b64_tr_b16 a[168:169], v28 offset:24576
  ds_read_b64_tr_b16 a[170:171], v28 offset:26112
  s_waitcnt lgkmcnt(4)
  ds_read_b64_tr_b16 a[172:173], v28 offset:36864
  ds_read_b64_tr_b16 a[174:175], v28 offset:38400
  ds_read_b64_tr_b16 a[176:177], v28 offset:49152
  ds_read_b64_tr_b16 a[178:179], v28 offset:50688
  s_waitcnt lgkmcnt(4)
  s_waitcnt lgkmcnt(0)
  v_add_u32 v26, 61440, v26
  v_add_u32 v27, 61440, v27
  v_add_u32 v28, 61440, v28
  s_barrier
  s_add_u32 s70, s70, 614400
  s_lshl_b32 s60, s52, 10
  s_add_u32 s60, s60, 0x0
  s_add_u32 m0, s60, 0
  s_nop 0
  buffer_load_dwordx4 v2, s[32:35], s70 offen lds
  s_add_u32 m0, s60, 4096
  s_nop 0
  buffer_load_dwordx4 v3, s[32:35], s70 offen lds
  s_add_u32 m0, s60, 8192
  s_nop 0
  buffer_load_dwordx4 v4, s[32:35], s70 offen lds
  s_add_u32 m0, s60, 12288
  s_nop 0
  buffer_load_dwordx4 v5, s[32:35], s70 offen lds
  s_add_u32 m0, s60, 16384
  s_nop 0
  buffer_load_dwordx4 v6, s[32:35], s70 offen lds
  s_add_u32 m0, s60, 20480
  s_nop 0
  buffer_load_dwordx4 v7, s[32:35], s70 offen lds
  s_add_u32 m0, s60, 24576
  s_nop 0
  buffer_load_dwordx4 v8, s[32:35], s70 offen lds
  s_add_u32 m0, s60, 28672
  s_nop 0
  buffer_load_dwordx4 v9, s[32:35], s70 offen lds
  s_add_u32 m0, s60, 32768
  s_nop 0
  buffer_load_dwordx4 v10, s[32:35], s70 offen lds
  s_add_u32 m0, s60, 36864
  s_nop 0
  buffer_load_dwordx4 v11, s[32:35], s70 offen lds
  s_add_u32 m0, s60, 40960
  s_nop 0
  buffer_load_dwordx4 v12, s[32:35], s70 offen lds
  s_add_u32 m0, s60, 45056
  s_nop 0
  buffer_load_dwordx4 v13, s[32:35], s70 offen lds
  s_add_u32 m0, s60, 49152
  s_nop 0
  buffer_load_dwordx4 v14, s[32:35], s70 offen lds
  s_add_u32 m0, s60, 53248
  s_nop 0
  buffer_load_dwordx4 v15, s[32:35], s70 offen lds
  s_add_u32 m0, s60, 57344
  s_nop 0
  buffer_load_dwordx4 v16, s[32:35], s70 offen lds
  s_waitcnt vmcnt(15)
  s_barrier
  ds_read_b64_tr_b16 a[20:21], v26 offset:0
  ds_read_b64_tr_b16 a[22:23], v26 offset:1536
  ds_read_b64_tr_b16 a[24:25], v26 offset:12288
  ds_read_b64_tr_b16 a[26:27], v26 offset:13824
  ds_read_b64_tr_b16 a[28:29], v26 offset:24576
  ds_read_b64_tr_b16 a[30:31], v26 offset:26112
  s_waitcnt lgkmcnt(4)
  ds_read_b64_tr_b16 a[32:33], v26 offset:36864
  ds_read_b64_tr_b16 a[34:35], v26 offset:38400
  ds_read_b64_tr_b16 a[36:37], v26 offset:49152
  ds_read_b64_tr_b16 a[38:39], v26 offset:50688
  s_waitcnt lgkmcnt(4)
  ds_read_b64_tr_b16 a[100:101], v27 offset:0
  ds_read_b64_tr_b16 a[102:103], v27 offset:1536
  ds_read_b64_tr_b16 a[104:105], v27 offset:12288
  ds_read_b64_tr_b16 a[106:107], v27 offset:13824
  ds_read_b64_tr_b16 a[108:109], v27 offset:24576
  ds_read_b64_tr_b16 a[110:111], v27 offset:26112
  s_waitcnt lgkmcnt(4)
  ds_read_b64_tr_b16 a[112:113], v27 offset:36864
  ds_read_b64_tr_b16 a[114:115], v27 offset:38400
  ds_read_b64_tr_b16 a[116:117], v27 offset:49152
  ds_read_b64_tr_b16 a[118:119], v27 offset:50688
  s_waitcnt lgkmcnt(4)
  ds_read_b64_tr_b16 a[180:181], v28 offset:0
  ds_read_b64_tr_b16 a[182:183], v28 offset:1536
  ds_read_b64_tr_b16 a[184:185], v28 offset:12288
  ds_read_b64_tr_b16 a[186:187], v28 offset:13824
  ds_read_b64_tr_b16 a[188:189], v28 offset:24576
  ds_read_b64_tr_b16 a[190:191], v28 offset:26112
  s_waitcnt lgkmcnt(4)
  ds_read_b64_tr_b16 a[192:193], v28 offset:36864
  ds_read_b64_tr_b16 a[194:195], v28 offset:38400
  ds_read_b64_tr_b16 a[196:197], v28 offset:49152
  ds_read_b64_tr_b16 a[198:199], v28 offset:50688
  s_waitcnt lgkmcnt(4)
  s_waitcnt lgkmcnt(0)
  v_subrev_u32 v26, 61440, v26
  v_subrev_u32 v27, 61440, v27
  v_subrev_u32 v28, 61440, v28
  s_barrier
  s_add_u32 s70, s70, 614400
  s_lshl_b32 s60, s52, 10
  s_add_u32 s60, s60, 0xf000
  s_add_u32 m0, s60, 0
  s_nop 0
  buffer_load_dwordx4 v2, s[32:35], s70 offen lds
  s_add_u32 m0, s60, 4096
  s_nop 0
  buffer_load_dwordx4 v3, s[32:35], s70 offen lds
  s_add_u32 m0, s60, 8192
  s_nop 0
  buffer_load_dwordx4 v4, s[32:35], s70 offen lds
  s_add_u32 m0, s60, 12288
  s_nop 0
  buffer_load_dwordx4 v5, s[32:35], s70 offen lds
  s_add_u32 m0, s60, 16384
  s_nop 0
  buffer_load_dwordx4 v6, s[32:35], s70 offen lds
  s_add_u32 m0, s60, 20480
  s_nop 0
  buffer_load_dwordx4 v7, s[32:35], s70 offen lds
  s_add_u32 m0, s60, 24576
  s_nop 0
  buffer_load_dwordx4 v8, s[32:35], s70 offen lds
  s_add_u32 m0, s60, 28672
  s_nop 0
  buffer_load_dwordx4 v9, s[32:35], s70 offen lds
  s_add_u32 m0, s60, 32768
  s_nop 0
  buffer_load_dwordx4 v10, s[32:35], s70 offen lds
  s_add_u32 m0, s60, 36864
  s_nop 0
  buffer_load_dwordx4 v11, s[32:35], s70 offen lds
  s_add_u32 m0, s60, 40960
  s_nop 0
  buffer_load_dwordx4 v12, s[32:35], s70 offen lds
  s_add_u32 m0, s60, 45056
  s_nop 0
  buffer_load_dwordx4 v13, s[32:35], s70 offen lds
  s_add_u32 m0, s60, 49152
  s_nop 0
  buffer_load_dwordx4 v14, s[32:35], s70 offen lds
  s_add_u32 m0, s60, 53248
  s_nop 0
  buffer_load_dwordx4 v15, s[32:35], s70 offen lds
  s_add_u32 m0, s60, 57344
  s_nop 0
  buffer_load_dwordx4 v16, s[32:35], s70 offen lds
  s_waitcnt vmcnt(15)
  s_barrier
  ds_read_b64_tr_b16 a[40:41], v26 offset:0
  ds_read_b64_tr_b16 a[42:43], v26 offset:1536
  ds_read_b64_tr_b16 a[44:45], v26 offset:12288
  ds_read_b64_tr_b16 a[46:47], v26 offset:13824
  ds_read_b64_tr_b16 a[48:49], v26 offset:24576
  ds_read_b64_tr_b16 a[50:51], v26 offset:26112
  s_waitcnt lgkmcnt(4)
  ds_read_b64_tr_b16 a[52:53], v26 offset:36864
  ds_read_b64_tr_b16 a[54:55], v26 offset:38400
  ds_read_b64_tr_b16 a[56:57], v26 offset:49152
  ds_read_b64_tr_b16 a[58:59], v26 offset:50688
  s_waitcnt lgkmcnt(4)
  ds_read_b64_tr_b16 a[120:121], v27 offset:0
  ds_read_b64_tr_b16 a[122:123], v27 offset:1536
  ds_read_b64_tr_b16 a[124:125], v27 offset:12288
  ds_read_b64_tr_b16 a[126:127], v27 offset:13824
  ds_read_b64_tr_b16 a[128:129], v27 offset:24576
  ds_read_b64_tr_b16 a[130:131], v27 offset:26112
  s_waitcnt lgkmcnt(4)
  ds_read_b64_tr_b16 a[132:133], v27 offset:36864
  ds_read_b64_tr_b16 a[134:135], v27 offset:38400
  ds_read_b64_tr_b16 a[136:137], v27 offset:49152
  ds_read_b64_tr_b16 a[138:139], v27 offset:50688
  s_waitcnt lgkmcnt(4)
  ds_read_b64_tr_b16 a[200:201], v28 offset:0
  ds_read_b64_tr_b16 a[202:203], v28 offset:1536
  ds_read_b64_tr_b16 a[204:205], v28 offset:12288
  ds_read_b64_tr_b16 a[206:207], v28 offset:13824
  ds_read_b64_tr_b16 a[208:209], v28 offset:24576
  ds_read_b64_tr_b16 a[210:211], v28 offset:26112
  s_waitcnt lgkmcnt(4)
  ds_read_b64_tr_b16 a[212:213], v28 offset:36864
  ds_read_b64_tr_b16 a[214:215], v28 offset:38400
  ds_read_b64_tr_b16 a[216:217], v28 offset:49152
  ds_read_b64_tr_b16 a[218:219], v28 offset:50688
  s_waitcnt lgkmcnt(4)
  s_waitcnt lgkmcnt(0)
  v_add_u32 v26, 61440, v26
  v_add_u32 v27, 61440, v27
  v_add_u32 v28, 61440, v28
  s_barrier
  s_waitcnt vmcnt(0)
  s_barrier
  ds_read_b64_tr_b16 a[60:61], v26 offset:0
  ds_read_b64_tr_b16 a[62:63], v26 offset:1536
  ds_read_b64_tr_b16 a[64:65], v26 offset:12288
  ds_read_b64_tr_b16 a[66:67], v26 offset:13824
  ds_read_b64_tr_b16 a[68:69], v26 offset:24576
  ds_read_b64_tr_b16 a[70:71], v26 offset:26112
  s_waitcnt lgkmcnt(4)
  ds_read_b64_tr_b16 a[72:73], v26 offset:36864
  ds_read_b64_tr_b16 a[74:75], v26 offset:38400
  ds_read_b64_tr_b16 a[76:77], v26 offset:49152
  ds_read_b64_tr_b16 a[78:79], v26 offset:50688
  s_waitcnt lgkmcnt(4)
  ds_read_b64_tr_b16 a[140:141], v27 offset:0
  ds_read_b64_tr_b16 a[142:143], v27 offset:1536
  ds_read_b64_tr_b16 a[144:145], v27 offset:12288
  ds_read_b64_tr_b16 a[146:147], v27 offset:13824
  ds_read_b64_tr_b16 a[148:149], v27 offset:24576
  ds_read_b64_tr_b16 a[150:151], v27 offset:26112
  s_waitcnt lgkmcnt(4)
  ds_read_b64_tr_b16 a[152:153], v27 offset:36864
  ds_read_b64_tr_b16 a[154:155], v27 offset:38400
  ds_read_b64_tr_b16 a[156:157], v27 offset:49152
  ds_read_b64_tr_b16 a[158:159], v27 offset:50688
  s_waitcnt lgkmcnt(4)
  ds_read_b64_tr_b16 a[220:221], v28 offset:0
  ds_read_b64_tr_b16 a[222:223], v28 offset:1536
  ds_read_b64_tr_b16 a[224:225], v28 offset:12288
  ds_read_b64_tr_b16 a[226:227], v28 offset:13824
  ds_read_b64_tr_b16 a[228:229], v28 offset:24576
  ds_read_b64_tr_b16 a[230:231], v28 offset:26112
  s_waitcnt lgkmcnt(4)
  ds_read_b64_tr_b16 a[232:233], v28 offset:36864
  ds_read_b64_tr_b16 a[234:235], v28 offset:38400
  ds_read_b64_tr_b16 a[236:237], v28 offset:49152
  ds_read_b64_tr_b16 a[238:239], v28 offset:50688
  s_waitcnt lgkmcnt(4)
  s_waitcnt lgkmcnt(0)
  v_subrev_u32 v26, 61440, v26
  v_subrev_u32 v27, 61440, v27
  v_subrev_u32 v28, 61440, v28
  s_barrier
  s_mul_i32 s58, s78, 192
  s_mul_i32 s59, s52, 48
  s_add_u32 s58, s58, s59
  s_add_u32 s58, s58, 0
  v_lshrrev_b32 v18, 4, v1
  v_lshlrev_b32 v18, 2, v18
  v_add_u32 v18, s58, v18
  v_mov_b32 v19, 0
  v_mov_b32 v20, 1
  v_cmp_le_u32 vcc, 640, v18
  s_nop 1
  v_cndmask_b32 v19, v19, v20, vcc
  v_mov_b32 v20, 2
  v_cmp_le_u32 vcc, 1280, v18
  s_nop 1
  v_cndmask_b32 v19, v19, v20, vcc
  v_mul_u32_u24 v20, 640, v19
  v_sub_u32 v18, v18, v20
  v_mul_u32_u24 v2, 3145728, v19
  v_cmp_eq_u32 vcc, 0, v19
  v_mov_b32 v20, 0x3ea52b5c
  v_mov_b32 v21, 1.0
  v_cndmask_b32 v5, v21, v20, vcc
  v_mul_u32_u24 v19, 3277, v18
  v_lshrrev_b32 v19, 16, v19
  v_mul_u32_u24 v20, 20, v19
  v_sub_u32 v18, v18, v20
  v_mul_u32_u24 v19, 98304, v19
  v_add_u32 v2, v2, v19
  v_cmp_eq_u32 vcc, 16, v18
  v_lshlrev_b32 v18, 1, v18
  v_add_u32 v2, v2, v18
  s_mov_b64 s[72:73], vcc
  v_and_b32 v18, 15, v1
  v_mul_u32_u24 v18, 48, v18
  v_add_u32 v2, v2, v18
  s_mul_i32 s58, s78, 192
  s_mul_i32 s59, s52, 48
  s_add_u32 s58, s58, s59
  s_add_u32 s58, s58, 16
  v_lshrrev_b32 v18, 4, v1
  v_lshlrev_b32 v18, 2, v18
  v_add_u32 v18, s58, v18
  v_mov_b32 v19, 0
  v_mov_b32 v20, 1
  v_cmp_le_u32 vcc, 640, v18
  s_nop 1
  v_cndmask_b32 v19, v19, v20, vcc
  v_mov_b32 v20, 2
  v_cmp_le_u32 vcc, 1280, v18
  s_nop 1
  v_cndmask_b32 v19, v19, v20, vcc
  v_mul_u32_u24 v20, 640, v19
  v_sub_u32 v18, v18, v20
  v_mul_u32_u24 v3, 3145728, v19
  v_cmp_eq_u32 vcc, 0, v19
  v_mov_b32 v20, 0x3ea52b5c
  v_mov_b32 v21, 1.0
  v_cndmask_b32 v6, v21, v20, vcc
  v_mul_u32_u24 v19, 3277, v18
  v_lshrrev_b32 v19, 16, v19
  v_mul_u32_u24 v20, 20, v19
  v_sub_u32 v18, v18, v20
  v_mul_u32_u24 v19, 98304, v19
  v_add_u32 v3, v3, v19
  v_cmp_eq_u32 vcc, 16, v18
  v_lshlrev_b32 v18, 1, v18
  v_add_u32 v3, v3, v18
  s_mov_b64 s[74:75], vcc
  v_and_b32 v18, 15, v1
  v_mul_u32_u24 v18, 48, v18
  v_add_u32 v3, v3, v18
  s_mul_i32 s58, s78, 192
  s_mul_i32 s59, s52, 48
  s_add_u32 s58, s58, s59
  s_add_u32 s58, s58, 32
  v_lshrrev_b32 v18, 4, v1
  v_lshlrev_b32 v18, 2, v18
  v_add_u32 v18, s58, v18
  v_mov_b32 v19, 0
  v_mov_b32 v20, 1
  v_cmp_le_u32 vcc, 640, v18
  s_nop 1
  v_cndmask_b32 v19, v19, v20, vcc
  v_mov_b32 v20, 2
  v_cmp_le_u32 vcc, 1280, v18
  s_nop 1
  v_cndmask_b32 v19, v19, v20, vcc
  v_mul_u32_u24 v20, 640, v19
  v_sub_u32 v18, v18, v20
  v_mul_u32_u24 v4, 3145728, v19
  v_cmp_eq_u32 vcc, 0, v19
  v_mov_b32 v20, 0x3ea52b5c
  v_mov_b32 v21, 1.0
  v_cndmask_b32 v7, v21, v20, vcc
  v_mul_u32_u24 v19, 3277, v18
  v_lshrrev_b32 v19, 16, v19
  v_mul_u32_u24 v20, 20, v19
  v_sub_u32 v18, v18, v20
  v_mul_u32_u24 v19, 98304, v19
  v_add_u32 v4, v4, v19
  v_cmp_eq_u32 vcc, 16, v18
  v_lshlrev_b32 v18, 1, v18
  v_add_u32 v4, v4, v18
  s_mov_b64 s[76:77], vcc
  v_and_b32 v18, 15, v1
  v_mul_u32_u24 v18, 48, v18
  v_add_u32 v4, v4, v18
  v_mov_b32 v8, 0x3f80
  v_mov_b32 v9, 0
  s_mul_i32 s66, s62, 1536
  s_add_u32 s66, s66, 0x7600000
  s_mov_b32 s71, 0xfffe2000
L_b1_r:
  s_waitcnt vmcnt(12)
  s_barrier
  s_add_u32 s58, s62, 1
  s_cmp_lt_u32 s58, s63
  s_cselect_b32 s58, 40960, 0
  s_add_u32 s64, s64, s58
  s_add_u32 s65, s65, s71
  ds_read_b128 v[32:35], v102 offset:0
  ds_read_b128 v[36:39], v102 offset:20480
  ds_read_b128 v[40:43], v103 offset:0
  ds_read_b128 v[44:47], v103 offset:20480
  ds_read_b128 v[48:51], v104 offset:0
  ds_read_b128 v[52:55], v104 offset:20480
  s_waitcnt lgkmcnt(4)
  v_mfma_f32_16x16x32_bf16 v[56:59], a[0:3], v[32:35], 0
  v_mfma_f32_16x16x32_bf16 v[64:67], a[80:83], v[32:35], 0
  v_mfma_f32_16x16x32_bf16 v[72:75], a[160:163], v[32:35], 0
  v_mfma_f32_16x16x32_bf16 v[60:63], a[0:3], v[36:39], 0
  v_mfma_f32_16x16x32_bf16 v[68:71], a[80:83], v[36:39], 0
  v_mfma_f32_16x16x32_bf16 v[76:79], a[160:163], v[36:39], 0
  ds_read_b128 v[32:35], v105 offset:0
  ds_read_b128 v[36:39], v105 offset:20480
  s_waitcnt lgkmcnt(4)
  v_mfma_f32_16x16x32_bf16 v[56:59], a[4:7], v[40:43], v[56:59]
  s_add_u32 m0, s65, 0
  s_nop 0
  buffer_load_dwordx4 v92, s[28:31], s64 offen lds
  v_mfma_f32_16x16x32_bf16 v[64:67], a[84:87], v[40:43], v[64:67]
  v_mfma_f32_16x16x32_bf16 v[72:75], a[164:167], v[40:43], v[72:75]
  v_mfma_f32_16x16x32_bf16 v[60:63], a[4:7], v[44:47], v[60:63]
  v_mfma_f32_16x16x32_bf16 v[68:71], a[84:87], v[44:47], v[68:71]
  v_mfma_f32_16x16x32_bf16 v[76:79], a[164:167], v[44:47], v[76:79]
  ds_read_b128 v[40:43], v102 offset:256
  ds_read_b128 v[44:47], v102 offset:20736
  s_waitcnt lgkmcnt(4)
  v_mfma_f32_16x16x32_bf16 v[56:59], a[8:11], v[48:51], v[56:59]
  v_mfma_f32_16x16x32_bf16 v[64:67], a[88:91], v[48:51], v[64:67]
  v_mfma_f32_16x16x32_bf16 v[72:75], a[168:171], v[48:51], v[72:75]
  v_mfma_f32_16x16x32_bf16 v[60:63], a[8:11], v[52:55], v[60:63]
  v_mfma_f32_16x16x32_bf16 v[68:71], a[88:91], v[52:55], v[68:71]
  s_add_u32 m0, s65, 1024
  s_nop 0
  buffer_load_dwordx4 v93, s[28:31], s64 offen lds
  v_mfma_f32_16x16x32_bf16 v[76:79], a[168:171], v[52:55], v[76:79]
  ds_read_b128 v[48:51], v103 offset:256
  ds_read_b128 v[52:55], v103 offset:20736
  s_waitcnt lgkmcnt(4)
  v_mfma_f32_16x16x32_bf16 v[56:59], a[12:15], v[32:35], v[56:59]
  v_mfma_f32_16x16x32_bf16 v[64:67], a[92:95], v[32:35], v[64:67]
  v_mfma_f32_16x16x32_bf16 v[72:75], a[172:175], v[32:35], v[72:75]
  v_mfma_f32_16x16x32_bf16 v[60:63], a[12:15], v[36:39], v[60:63]
  v_mfma_f32_16x16x32_bf16 v[68:71], a[92:95], v[36:39], v[68:71]
  v_mfma_f32_16x16x32_bf16 v[76:79], a[172:175], v[36:39], v[76:79]
  ds_read_b128 v[32:35], v104 offset:256
  ds_read_b128 v[36:39], v104 offset:20736
  s_waitcnt lgkmcnt(4)
  v_mfma_f32_16x16x32_bf16 v[56:59], a[16:19], v[40:43], v[56:59]
  v_mfma_f32_16x16x32_bf16 v[64:67], a[96:99], v[40:43], v[64:67]
  v_mfma_f32_16x16x32_bf16 v[72:75], a[176:179], v[40:43], v[72:75]
  s_add_u32 m0, s65, 2048
  s_nop 0
  buffer_load_dwordx4 v94, s[28:31], s64 offen lds
  v_mfma_f32_16x16x32_bf16 v[60:63], a[16:19], v[44:47], v[60:63]
  v_mfma_f32_16x16x32_bf16 v[68:71], a[96:99], v[44:47], v[68:71]
  v_mfma_f32_16x16x32_bf16 v[76:79], a[176:179], v[44:47], v[76:79]
  ds_read_b128 v[40:43], v105 offset:256
  ds_read_b128 v[44:47], v105 offset:20736
  s_waitcnt lgkmcnt(4)
  v_mfma_f32_16x16x32_bf16 v[56:59], a[20:23], v[48:51], v[56:59]
  v_mfma_f32_16x16x32_bf16 v[64:67], a[100:103], v[48:51], v[64:67]
  v_mfma_f32_16x16x32_bf16 v[72:75], a[180:183], v[48:51], v[72:75]
  v_mfma_f32_16x16x32_bf16 v[60:63], a[20:23], v[52:55], v[60:63]
  v_mfma_f32_16x16x32_bf16 v[68:71], a[100:103], v[52:55], v[68:71]
  v_mfma_f32_16x16x32_bf16 v[76:79], a[180:183], v[52:55], v[76:79]
  ds_read_b128 v[48:51], v102 offset:512
  ds_read_b128 v[52:55], v102 offset:20992
  s_waitcnt lgkmcnt(4)
  v_mfma_f32_16x16x32_bf16 v[56:59], a[24:27], v[32:35], v[56:59]
  s_add_u32 m0, s65, 3072
  s_nop 0
  buffer_load_dwordx4 v95, s[28:31], s64 offen lds
  v_mfma_f32_16x16x32_bf16 v[64:67], a[104:107], v[32:35], v[64:67]
  v_mfma_f32_16x16x32_bf16 v[72:75], a[184:187], v[32:35], v[72:75]
  v_mfma_f32_16x16x32_bf16 v[60:63], a[24:27], v[36:39], v[60:63]
  v_mfma_f32_16x16x32_bf16 v[68:71], a[104:107], v[36:39], v[68:71]
  v_mfma_f32_16x16x32_bf16 v[76:79], a[184:187], v[36:39], v[76:79]
  ds_read_b128 v[32:35], v103 offset:512
  ds_read_b128 v[36:39], v103 offset:20992
  s_waitcnt lgkmcnt(4)
  v_mfma_f32_16x16x32_bf16 v[56:59], a[28:31], v[40:43], v[56:59]
  v_mfma_f32_16x16x32_bf16 v[64:67], a[108:111], v[40:43], v[64:67]
  v_mfma_f32_16x16x32_bf16 v[72:75], a[188:191], v[40:43], v[72:75]
  v_mfma_f32_16x16x32_bf16 v[60:63], a[28:31], v[44:47], v[60:63]
  v_mfma_f32_16x16x32_bf16 v[68:71], a[108:111], v[44:47], v[68:71]
  s_add_u32 m0, s65, 4096
  s_nop 0
  buffer_load_dwordx4 v96, s[28:31], s64 offen lds
  v_mfma_f32_16x16x32_bf16 v[76:79], a[188:191], v[44:47], v[76:79]
  ds_read_b128 v[40:43], v104 offset:512
  ds_read_b128 v[44:47], v104 offset:20992
  s_waitcnt lgkmcnt(4)
  v_mfma_f32_16x16x32_bf16 v[56:59], a[32:35], v[48:51], v[56:59]
  v_mfma_f32_16x16x32_bf16 v[64:67], a[112:115], v[48:51], v[64:67]
  v_mfma_f32_16x16x32_bf16 v[72:75], a[192:195], v[48:51], v[72:75]
  v_mfma_f32_16x16x32_bf16 v[60:63], a[32:35], v[52:55], v[60:63]
  v_mfma_f32_16x16x32_bf16 v[68:71], a[112:115], v[52:55], v[68:71]
  v_mfma_f32_16x16x32_bf16 v[76:79], a[192:195], v[52:55], v[76:79]
  ds_read_b128 v[48:51], v105 offset:512
  ds_read_b128 v[52:55], v105 offset:20992
  s_waitcnt lgkmcnt(4)
  v_mfma_f32_16x16x32_bf16 v[56:59], a[36:39], v[32:35], v[56:59]
  v_mfma_f32_16x16x32_bf16 v[64:67], a[116:119], v[32:35], v[64:67]
  v_mfma_f32_16x16x32_bf16 v[72:75], a[196:199], v[32:35], v[72:75]
  s_add_u32 m0, s65, 5120
  s_nop 0
  buffer_load_dwordx4 v97, s[28:31], s64 offen lds
  v_mfma_f32_16x16x32_bf16 v[60:63], a[36:39], v[36:39], v[60:63]
  v_mfma_f32_16x16x32_bf16 v[68:71], a[116:119], v[36:39], v[68:71]
  v_mfma_f32_16x16x32_bf16 v[76:79], a[196:199], v[36:39], v[76:79]
  ds_read_b128 v[32:35], v102 offset:768
  ds_read_b128 v[36:39], v102 offset:21248
  s_waitcnt lgkmcnt(4)
  v_mfma_f32_16x16x32_bf16 v[56:59], a[40:43], v[40:43], v[56:59]
  v_mfma_f32_16x16x32_bf16 v[64:67], a[120:123], v[40:43], v[64:67]
  v_mfma_f32_16x16x32_bf16 v[72:75], a[200:203], v[40:43], v[72:75]
  v_mfma_f32_16x16x32_bf16 v[60:63], a[40:43], v[44:47], v[60:63]
  v_mfma_f32_16x16x32_bf16 v[68:71], a[120:123], v[44:47], v[68:71]
  v_mfma_f32_16x16x32_bf16 v[76:79], a[200:203], v[44:47], v[76:79]
  ds_read_b128 v[40:43], v103 offset:768
  ds_read_b128 v[44:47], v103 offset:21248
  s_waitcnt lgkmcnt(4)
  v_mfma_f32_16x16x32_bf16 v[56:59], a[44:47], v[48:51], v[56:59]
  s_add_u32 m0, s65, 6144
  s_nop 0
  buffer_load_dwordx4 v98, s[28:31], s64 offen lds
  v_mfma_f32_16x16x32_bf16 v[64:67], a[124:127], v[48:51], v[64:67]
  v_mfma_f32_16x16x32_bf16 v[72:75], a[204:207], v[48:51], v[72:75]
  v_mfma_f32_16x16x32_bf16 v[60:63], a[44:47], v[52:55], v[60:63]
  v_mfma_f32_16x16x32_bf16 v[68:71], a[124:127], v[52:55], v[68:71]
  v_mfma_f32_16x16x32_bf16 v[76:79], a[204:207], v[52:55], v[76:79]
  ds_read_b128 v[48:51], v104 offset:768
  ds_read_b128 v[52:55], v104 offset:21248
  s_waitcnt lgkmcnt(4)
  v_mfma_f32_16x16x32_bf16 v[56:59], a[48:51], v[32:35], v[56:59]
  v_mfma_f32_16x16x32_bf16 v[64:67], a[128:131], v[32:35], v[64:67]
  v_mfma_f32_16x16x32_bf16 v[72:75], a[208:211], v[32:35], v[72:75]
  v_mfma_f32_16x16x32_bf16 v[60:63], a[48:51], v[36:39], v[60:63]
  v_mfma_f32_16x16x32_bf16 v[68:71], a[128:131], v[36:39], v[68:71]
  s_add_u32 m0, s65, 7168
  s_nop 0
  buffer_load_dwordx4 v99, s[28:31], s64 offen lds
  v_mfma_f32_16x16x32_bf16 v[76:79], a[208:211], v[36:39], v[76:79]
  ds_read_b128 v[32:35], v105 offset:768
  ds_read_b128 v[36:39], v105 offset:21248
  s_waitcnt lgkmcnt(4)
  v_mfma_f32_16x16x32_bf16 v[56:59], a[52:55], v[40:43], v[56:59]
  v_mfma_f32_16x16x32_bf16 v[64:67], a[132:135], v[40:43], v[64:67]
  v_mfma_f32_16x16x32_bf16 v[72:75], a[212:215], v[40:43], v[72:75]
  v_mfma_f32_16x16x32_bf16 v[60:63], a[52:55], v[44:47], v[60:63]
  v_mfma_f32_16x16x32_bf16 v[68:71], a[132:135], v[44:47], v[68:71]
  v_mfma_f32_16x16x32_bf16 v[76:79], a[212:215], v[44:47], v[76:79]
  ds_read_b128 v[40:43], v102 offset:1024
  ds_read_b128 v[44:47], v102 offset:21504
  s_waitcnt lgkmcnt(4)
  v_mfma_f32_16x16x32_bf16 v[56:59], a[56:59], v[48:51], v[56:59]
  v_mfma_f32_16x16x32_bf16 v[64:67], a[136:139], v[48:51], v[64:67]
  v_mfma_f32_16x16x32_bf16 v[72:75], a[216:219], v[48:51], v[72:75]
  s_add_u32 m0, s65, 8192
  s_nop 0
  buffer_load_dwordx4 v100, s[28:31], s64 offen lds
  v_mfma_f32_16x16x32_bf16 v[60:63], a[56:59], v[52:55], v[60:63]
  v_mfma_f32_16x16x32_bf16 v[68:71], a[136:139], v[52:55], v[68:71]
  v_mfma_f32_16x16x32_bf16 v[76:79], a[216:219], v[52:55], v[76:79]
  ds_read_b128 v[48:51], v103 offset:1024
  ds_read_b128 v[52:55], v103 offset:21504
  s_waitcnt lgkmcnt(4)
  v_mfma_f32_16x16x32_bf16 v[56:59], a[60:63], v[32:35], v[56:59]
  v_mfma_f32_16x16x32_bf16 v[64:67], a[140:143], v[32:35], v[64:67]
  v_mfma_f32_16x16x32_bf16 v[72:75], a[220:223], v[32:35], v[72:75]
  v_mfma_f32_16x16x32_bf16 v[60:63], a[60:63], v[36:39], v[60:63]
  v_mfma_f32_16x16x32_bf16 v[68:71], a[140:143], v[36:39], v[68:71]
  v_mfma_f32_16x16x32_bf16 v[76:79], a[220:223], v[36:39], v[76:79]
  ds_read_b128 v[32:35], v104 offset:1024
  ds_read_b128 v[36:39], v104 offset:21504
  s_waitcnt lgkmcnt(4)
  v_mfma_f32_16x16x32_bf16 v[56:59], a[64:67], v[40:43], v[56:59]
  s_add_u32 m0, s65, 9216
  s_nop 0
  buffer_load_dwordx4 v101, s[28:31], s64 offen lds
  v_mfma_f32_16x16x32_bf16 v[64:67], a[144:147], v[40:43], v[64:67]
  v_mfma_f32_16x16x32_bf16 v[72:75], a[224:227], v[40:43], v[72:75]
  v_mfma_f32_16x16x32_bf16 v[60:63], a[64:67], v[44:47], v[60:63]
  v_mfma_f32_16x16x32_bf16 v[68:71], a[144:147], v[44:47], v[68:71]
  v_mfma_f32_16x16x32_bf16 v[76:79], a[224:227], v[44:47], v[76:79]
  ds_read_b128 v[40:43], v105 offset:1024
  ds_read_b128 v[44:47], v105 offset:21504
  s_waitcnt lgkmcnt(4)
  v_mfma_f32_16x16x32_bf16 v[56:59], a[68:71], v[48:51], v[56:59]
  v_mfma_f32_16x16x32_bf16 v[64:67], a[148:151], v[48:51], v[64:67]
  v_mfma_f32_16x16x32_bf16 v[72:75], a[228:231], v[48:51], v[72:75]
  v_mfma_f32_16x16x32_bf16 v[60:63], a[68:71], v[52:55], v[60:63]
  v_mfma_f32_16x16x32_bf16 v[68:71], a[148:151], v[52:55], v[68:71]
  v_mfma_f32_16x16x32_bf16 v[76:79], a[228:231], v[52:55], v[76:79]
  s_waitcnt lgkmcnt(2)
  v_mfma_f32_16x16x32_bf16 v[56:59], a[72:75], v[32:35], v[56:59]
  v_mfma_f32_16x16x32_bf16 v[64:67], a[152:155], v[32:35], v[64:67]
  v_mfma_f32_16x16x32_bf16 v[72:75], a[232:235], v[32:35], v[72:75]
  v_mfma_f32_16x16x32_bf16 v[60:63], a[72:75], v[36:39], v[60:63]
  v_mfma_f32_16x16x32_bf16 v[68:71], a[152:155], v[36:39], v[68:71]
  v_mfma_f32_16x16x32_bf16 v[76:79], a[232:235], v[36:39], v[76:79]
  s_waitcnt lgkmcnt(0)
  v_mfma_f32_16x16x32_bf16 v[56:59], a[76:79], v[40:43], v[56:59]
  v_mfma_f32_16x16x32_bf16 v[64:67], a[156:159], v[40:43], v[64:67]
  v_mfma_f32_16x16x32_bf16 v[72:75], a[236:239], v[40:43], v[72:75]
  v_mfma_f32_16x16x32_bf16 v[60:63], a[76:79], v[44:47], v[60:63]
  v_mfma_f32_16x16x32_bf16 v[68:71], a[156:159], v[44:47], v[68:71]
  v_mfma_f32_16x16x32_bf16 v[76:79], a[236:239], v[44:47], v[76:79]
  v_add_u32 v102, s71, v102
  v_add_u32 v103, s71, v103
  v_add_u32 v104, s71, v104
  v_add_u32 v105, s71, v105
  s_sub_u32 s71, 0, s71
  s_nop 2
  v_mul_f32 v56, v56, v5
  v_mul_f32 v57, v57, v5
  v_mul_f32 v58, v58, v5
  v_mul_f32 v59, v59, v5
  v_cvt_pk_bf16_f32 v80, v56, v57
  v_cvt_pk_bf16_f32 v81, v58, v59
  buffer_store_dwordx2 v[80:81], v2, s[48:51], s66 offen offset:0 sc1
  v_mul_f32 v60, v60, v5
  v_mul_f32 v61, v61, v5
  v_mul_f32 v62, v62, v5
  v_mul_f32 v63, v63, v5
  v_cvt_pk_bf16_f32 v82, v60, v61
  v_cvt_pk_bf16_f32 v83, v62, v63
  buffer_store_dwordx2 v[82:83], v2, s[48:51], s66 offen offset:768 sc1
  v_mul_f32 v64, v64, v6
  v_mul_f32 v65, v65, v6
  v_mul_f32 v66, v66, v6
  v_mul_f32 v67, v67, v6
  v_cvt_pk_bf16_f32 v84, v64, v65
  v_cvt_pk_bf16_f32 v85, v66, v67
  buffer_store_dwordx2 v[84:85], v3, s[48:51], s66 offen offset:0 sc1
  v_mul_f32 v68, v68, v6
  v_mul_f32 v69, v69, v6
  v_mul_f32 v70, v70, v6
  v_mul_f32 v71, v71, v6
  v_cvt_pk_bf16_f32 v86, v68, v69
  v_cvt_pk_bf16_f32 v87, v70, v71
  buffer_store_dwordx2 v[86:87], v3, s[48:51], s66 offen offset:768 sc1
  v_mul_f32 v72, v72, v7
  v_mul_f32 v73, v73, v7
  v_mul_f32 v74, v74, v7
  v_mul_f32 v75, v75, v7
  v_cvt_pk_bf16_f32 v88, v72, v73
  v_cvt_pk_bf16_f32 v89, v74, v75
  buffer_store_dwordx2 v[88:89], v4, s[48:51], s66 offen offset:0 sc1
  v_mul_f32 v76, v76, v7
  v_mul_f32 v77, v77, v7
  v_mul_f32 v78, v78, v7
  v_mul_f32 v79, v79, v7
  v_cvt_pk_bf16_f32 v90, v76, v77
  v_cvt_pk_bf16_f32 v91, v78, v79
  buffer_store_dwordx2 v[90:91], v4, s[48:51], s66 offen offset:768 sc1
  s_mov_b64 exec, s[72:73]
  buffer_store_dwordx2 v[8:9], v2, s[48:51], s66 offen offset:8 sc1
  buffer_store_dwordx2 v[8:9], v2, s[48:51], s66 offen offset:776 sc1
  s_mov_b64 exec, s[74:75]
  buffer_store_dwordx2 v[8:9], v3, s[48:51], s66 offen offset:8 sc1
  buffer_store_dwordx2 v[8:9], v3, s[48:51], s66 offen offset:776 sc1
  s_mov_b64 exec, s[76:77]
  buffer_store_dwordx2 v[8:9], v4, s[48:51], s66 offen offset:8 sc1
  buffer_store_dwordx2 v[8:9], v4, s[48:51], s66 offen offset:776 sc1
  s_mov_b64 exec, -1
  s_add_u32 s66, s66, 1536
  s_add_u32 s62, s62, 1
  s_cmp_lt_u32 s62, s63
  s_cbranch_scc1 L_b1_r
  s_waitcnt vmcnt(0)
  s_barrier
  s_cmp_lg_u32 s52, 0
  s_cbranch_scc1 cnt_7075
  v_mov_b32 v19, 32768
  v_mov_b32 v18, 1
  s_mov_b64 exec, 1
  buffer_atomic_add v18, v19, s[48:51], 0 offen sc1
  s_mov_b64 exec, -1
cnt_7075:
  s_branch b1dn_7069
nob1_7068:
b1dn_7069:
  s_cmp_lt_u32 s54, 24
  s_cbranch_scc0 L_t3role_r
  s_lshl_b32 s69, s53, 3
  s_add_u32 s69, s69, s54
  s_sub_u32 s69, s69, 16
  v_and_b32 v1, 63, v0
  s_mul_i32 s58, s52, 640
  s_add_u32 s59, s58, 0
  v_add_u32 v18, s59, v1
  v_mul_u32_u24 v19, 3277, v18
  v_lshrrev_b32 v19, 18, v19
  v_mul_u32_u24 v20, 80, v19
  v_sub_u32 v18, v18, v20
  v_and_b32 v20, 15, v19
  v_xor_b32 v18, v18, v20
  v_lshlrev_b32 v18, 4, v18
  v_mul_u32_u24 v19, 1280, v19
  v_add_u32 v92, v18, v19
  s_add_u32 s59, s58, 64
  v_add_u32 v18, s59, v1
  v_mul_u32_u24 v19, 3277, v18
  v_lshrrev_b32 v19, 18, v19
  v_mul_u32_u24 v20, 80, v19
  v_sub_u32 v18, v18, v20
  v_and_b32 v20, 15, v19
  v_xor_b32 v18, v18, v20
  v_lshlrev_b32 v18, 4, v18
  v_mul_u32_u24 v19, 1280, v19
  v_add_u32 v93, v18, v19
  s_add_u32 s59, s58, 128
  v_add_u32 v18, s59, v1
  v_mul_u32_u24 v19, 3277, v18
  v_lshrrev_b32 v19, 18, v19
  v_mul_u32_u24 v20, 80, v19
  v_sub_u32 v18, v18, v20
  v_and_b32 v20, 15, v19
  v_xor_b32 v18, v18, v20
  v_lshlrev_b32 v18, 4, v18
  v_mul_u32_u24 v19, 1280, v19
  v_add_u32 v94, v18, v19
  s_add_u32 s59, s58, 192
  v_add_u32 v18, s59, v1
  v_mul_u32_u24 v19, 3277, v18
  v_lshrrev_b32 v19, 18, v19
  v_mul_u32_u24 v20, 80, v19
  v_sub_u32 v18, v18, v20
  v_and_b32 v20, 15, v19
  v_xor_b32 v18, v18, v20
  v_lshlrev_b32 v18, 4, v18
  v_mul_u32_u24 v19, 1280, v19
  v_add_u32 v95, v18, v19
  s_add_u32 s59, s58, 256
  v_add_u32 v18, s59, v1
  v_mul_u32_u24 v19, 3277, v18
  v_lshrrev_b32 v19, 18, v19
  v_mul_u32_u24 v20, 80, v19
  v_sub_u32 v18, v18, v20
  v_and_b32 v20, 15, v19
  v_xor_b32 v18, v18, v20
  v_lshlrev_b32 v18, 4, v18
  v_mul_u32_u24 v19, 1280, v19
  v_add_u32 v96, v18, v19
  s_add_u32 s59, s58, 320
  v_add_u32 v18, s59, v1
  v_mul_u32_u24 v19, 3277, v18
  v_lshrrev_b32 v19, 18, v19
  v_mul_u32_u24 v20, 80, v19
  v_sub_u32 v18, v18, v20
  v_and_b32 v20, 15, v19
  v_xor_b32 v18, v18, v20
  v_lshlrev_b32 v18, 4, v18
  v_mul_u32_u24 v19, 1280, v19
  v_add_u32 v97, v18, v19
  s_add_u32 s59, s58, 384
  v_add_u32 v18, s59, v1
  v_mul_u32_u24 v19, 3277, v18
  v_lshrrev_b32 v19, 18, v19
  v_mul_u32_u24 v20, 80, v19
  v_sub_u32 v18, v18, v20
  v_and_b32 v20, 15, v19
  v_xor_b32 v18, v18, v20
  v_lshlrev_b32 v18, 4, v18
  v_mul_u32_u24 v19, 1280, v19
  v_add_u32 v98, v18, v19
  s_add_u32 s59, s58, 448
  v_add_u32 v18, s59, v1
  v_mul_u32_u24 v19, 3277, v18
  v_lshrrev_b32 v19, 18, v19
  v_mul_u32_u24 v20, 80, v19
  v_sub_u32 v18, v18, v20
  v_and_b32 v20, 15, v19
  v_xor_b32 v18, v18, v20
  v_lshlrev_b32 v18, 4, v18
  v_mul_u32_u24 v19, 1280, v19
  v_add_u32 v99, v18, v19
  s_add_u32 s59, s58, 512
  v_add_u32 v18, s59, v1
  v_mul_u32_u24 v19, 3277, v18
  v_lshrrev_b32 v19, 18, v19
  v_mul_u32_u24 v20, 80, v19
  v_sub_u32 v18, v18, v20
  v_and_b32 v20, 15, v19
  v_xor_b32 v18, v18, v20
  v_lshlrev_b32 v18, 4, v18
  v_mul_u32_u24 v19, 1280, v19
  v_add_u32 v100, v18, v19
  s_add_u32 s59, s58, 576
  v_add_u32 v18, s59, v1
  v_mul_u32_u24 v19, 3277, v18
  v_lshrrev_b32 v19, 18, v19
  v_mul_u32_u24 v20, 80, v19
  v_sub_u32 v18, v18, v20
  v_and_b32 v20, 15, v19
  v_xor_b32 v18, v18, v20
  v_lshlrev_b32 v18, 4, v18
  v_mul_u32_u24 v19, 1280, v19
  v_add_u32 v101, v18, v19
  v_and_b32 v18, 15, v1
  v_lshrrev_b32 v19, 4, v1
  v_xor_b32 v19, v19, v18
  v_mul_u32_u24 v18, 1280, v18
  v_add_u32 v18, 0x1e000, v18
  v_xor_b32 v20, 0, v19
  v_lshlrev_b32 v20, 4, v20
  v_add_u32 v102, v18, v20
  v_xor_b32 v20, 4, v19
  v_lshlrev_b32 v20, 4, v20
  v_add_u32 v103, v18, v20
  v_xor_b32 v20, 8, v19
  v_lshlrev_b32 v20, 4, v20
  v_add_u32 v104, v18, v20
  v_xor_b32 v20, 12, v19
  v_lshlrev_b32 v20, 4, v20
  v_add_u32 v105, v18, v20
  v_lshrrev_b32 v18, 4, v1
  v_lshrrev_b32 v19, 2, v1
  v_and_b32 v19, 3, v19
  v_lshlrev_b32 v20, 3, v18
  v_add_u32 v20, v20, v19
  v_mul_u32_u24 v20, 384, v20
  v_and_b32 v21, 3, v1
  v_lshlrev_b32 v21, 3, v21
  v_add_u32 v20, v20, v21
  v_lshrrev_b32 v19, 1, v19
  v_and_b32 v18, 1, v18
  v_lshlrev_b32 v18, 1, v18
  v_or_b32 v18, v18, v19
  s_mul_i32 s58, s52, 3
  s_add_u32 s59, s58, 0
  v_xor_b32 v19, s59, v18
  v_lshlrev_b32 v19, 5, v19
  v_add_u32 v26, v19, v20
  s_add_u32 s59, s58, 1
  v_xor_b32 v19, s59, v18
  v_lshlrev_b32 v19, 5, v19
  v_add_u32 v27, v19, v20
  s_add_u32 s59, s58, 2
  v_xor_b32 v19, s59, v18
  v_lshlrev_b32 v19, 5, v19
  v_add_u32 v28, v19, v20
  s_mul_i32 s67, s69, 384
  s_mov_b32 s64, 0
  s_mul_i32 s65, s52, 10240
  s_add_u32 s65, s65, 122880
  v_mov_b32 v18, v0
  v_mul_u32_u24 v19, 2731, v18
  v_lshrrev_b32 v19, 16, v19
  v_mul_u32_u24 v20, 24, v19
  v_sub_u32 v18, v18, v20
  v_and_b32 v20, 2, v19
  v_lshrrev_b32 v21, 1, v19
  v_and_b32 v21, 4, v21
  v_or_b32 v20, v20, v21
  v_xor_b32 v18, v18, v20
  v_mul_u32_u24 v19, 12288, v19
  v_lshlrev_b32 v18, 4, v18
  v_add_u32 v2, v18, v19
  v_add_u32 v18, 256, v0
  v_mul_u32_u24 v19, 2731, v18
  v_lshrrev_b32 v19, 16, v19
  v_mul_u32_u24 v20, 24, v19
  v_sub_u32 v18, v18, v20
  v_and_b32 v20, 2, v19
  v_lshrrev_b32 v21, 1, v19
  v_and_b32 v21, 4, v21
  v_or_b32 v20, v20, v21
  v_xor_b32 v18, v18, v20
  v_mul_u32_u24 v19, 12288, v19
  v_lshlrev_b32 v18, 4, v18
  v_add_u32 v3, v18, v19
  v_add_u32 v18, 512, v0
  v_mul_u32_u24 v19, 2731, v18
  v_lshrrev_b32 v19, 16, v19
  v_mul_u32_u24 v20, 24, v19
  v_sub_u32 v18, v18, v20
  v_and_b32 v20, 2, v19
  v_lshrrev_b32 v21, 1, v19
  v_and_b32 v21, 4, v21
  v_or_b32 v20, v20, v21
  v_xor_b32 v18, v18, v20
  v_mul_u32_u24 v19, 12288, v19
  v_lshlrev_b32 v18, 4, v18
  v_add_u32 v4, v18, v19
  v_add_u32 v18, 768, v0
  v_mul_u32_u24 v19, 2731, v18
  v_lshrrev_b32 v19, 16, v19
  v_mul_u32_u24 v20, 24, v19
  v_sub_u32 v18, v18, v20
  v_and_b32 v20, 2, v19
  v_lshrrev_b32 v21, 1, v19
  v_and_b32 v21, 4, v21
  v_or_b32 v20, v20, v21
  v_xor_b32 v18, v18, v20
  v_mul_u32_u24 v19, 12288, v19
  v_lshlrev_b32 v18, 4, v18
  v_add_u32 v5, v18, v19
  v_add_u32 v18, 1024, v0
  v_mul_u32_u24 v19, 2731, v18
  v_lshrrev_b32 v19, 16, v19
  v_mul_u32_u24 v20, 24, v19
  v_sub_u32 v18, v18, v20
  v_and_b32 v20, 2, v19
  v_lshrrev_b32 v21, 1, v19
  v_and_b32 v21, 4, v21
  v_or_b32 v20, v20, v21
  v_xor_b32 v18, v18, v20
  v_mul_u32_u24 v19, 12288, v19
  v_lshlrev_b32 v18, 4, v18
  v_add_u32 v6, v18, v19
  v_add_u32 v18, 1280, v0
  v_mul_u32_u24 v19, 2731, v18
  v_lshrrev_b32 v19, 16, v19
  v_mul_u32_u24 v20, 24, v19
  v_sub_u32 v18, v18, v20
  v_and_b32 v20, 2, v19
  v_lshrrev_b32 v21, 1, v19
  v_and_b32 v21, 4, v21
  v_or_b32 v20, v20, v21
  v_xor_b32 v18, v18, v20
  v_mul_u32_u24 v19, 12288, v19
  v_lshlrev_b32 v18, 4, v18
  v_add_u32 v7, v18, v19
  v_add_u32 v18, 1536, v0
  v_mul_u32_u24 v19, 2731, v18
  v_lshrrev_b32 v19, 16, v19
  v_mul_u32_u24 v20, 24, v19
  v_sub_u32 v18, v18, v20
  v_and_b32 v20, 2, v19
  v_lshrrev_b32 v21, 1, v19
  v_and_b32 v21, 4, v21
  v_or_b32 v20, v20, v21
  v_xor_b32 v18, v18, v20
  v_mul_u32_u24 v19, 12288, v19
  v_lshlrev_b32 v18, 4, v18
  v_add_u32 v8, v18, v19
  v_add_u32 v18, 1792, v0
  v_mul_u32_u24 v19, 2731, v18
  v_lshrrev_b32 v19, 16, v19
  v_mul_u32_u24 v20, 24, v19
  v_sub_u32 v18, v18, v20
  v_and_b32 v20, 2, v19
  v_lshrrev_b32 v21, 1, v19
  v_and_b32 v21, 4, v21
  v_or_b32 v20, v20, v21
  v_xor_b32 v18, v18, v20
  v_mul_u32_u24 v19, 12288, v19
  v_lshlrev_b32 v18, 4, v18
  v_add_u32 v9, v18, v19
  v_add_u32 v18, 2048, v0
  v_mul_u32_u24 v19, 2731, v18
  v_lshrrev_b32 v19, 16, v19
  v_mul_u32_u24 v20, 24, v19
  v_sub_u32 v18, v18, v20
  v_and_b32 v20, 2, v19
  v_lshrrev_b32 v21, 1, v19
  v_and_b32 v21, 4, v21
  v_or_b32 v20, v20, v21
  v_xor_b32 v18, v18, v20
  v_mul_u32_u24 v19, 12288, v19
  v_lshlrev_b32 v18, 4, v18
  v_add_u32 v10, v18, v19
  v_add_u32 v18, 2304, v0
  v_mul_u32_u24 v19, 2731, v18
  v_lshrrev_b32 v19, 16, v19
  v_mul_u32_u24 v20, 24, v19
  v_sub_u32 v18, v18, v20
  v_and_b32 v20, 2, v19
  v_lshrrev_b32 v21, 1, v19
  v_and_b32 v21, 4, v21
  v_or_b32 v20, v20, v21
  v_xor_b32 v18, v18, v20
  v_mul_u32_u24 v19, 12288, v19
  v_lshlrev_b32 v18, 4, v18
  v_add_u32 v11, v18, v19
  v_add_u32 v18, 2560, v0
  v_mul_u32_u24 v19, 2731, v18
  v_lshrrev_b32 v19, 16, v19
  v_mul_u32_u24 v20, 24, v19
  v_sub_u32 v18, v18, v20
  v_and_b32 v20, 2, v19
  v_lshrrev_b32 v21, 1, v19
  v_and_b32 v21, 4, v21
  v_or_b32 v20, v20, v21
  v_xor_b32 v18, v18, v20
  v_mul_u32_u24 v19, 12288, v19
  v_lshlrev_b32 v18, 4, v18
  v_add_u32 v12, v18, v19
  v_add_u32 v18, 2816, v0
  v_mul_u32_u24 v19, 2731, v18
  v_lshrrev_b32 v19, 16, v19
  v_mul_u32_u24 v20, 24, v19
  v_sub_u32 v18, v18, v20
  v_and_b32 v20, 2, v19
  v_lshrrev_b32 v21, 1, v19
  v_and_b32 v21, 4, v21
  v_or_b32 v20, v20, v21
  v_xor_b32 v18, v18, v20
  v_mul_u32_u24 v19, 12288, v19
  v_lshlrev_b32 v18, 4, v18
  v_add_u32 v13, v18, v19
  v_add_u32 v18, 3072, v0
  v_mul_u32_u24 v19, 2731, v18
  v_lshrrev_b32 v19, 16, v19
  v_mul_u32_u24 v20, 24, v19
  v_sub_u32 v18, v18, v20
  v_and_b32 v20, 2, v19
  v_lshrrev_b32 v21, 1, v19
  v_and_b32 v21, 4, v21
  v_or_b32 v20, v20, v21
  v_xor_b32 v18, v18, v20
  v_mul_u32_u24 v19, 12288, v19
  v_lshlrev_b32 v18, 4, v18
  v_add_u32 v14, v18, v19
  v_add_u32 v18, 3328, v0
  v_mul_u32_u24 v19, 2731, v18
  v_lshrrev_b32 v19, 16, v19
  v_mul_u32_u24 v20, 24, v19
  v_sub_u32 v18, v18, v20
  v_and_b32 v20, 2, v19
  v_lshrrev_b32 v21, 1, v19
  v_and_b32 v21, 4, v21
  v_or_b32 v20, v20, v21
  v_xor_b32 v18, v18, v20
  v_mul_u32_u24 v19, 12288, v19
  v_lshlrev_b32 v18, 4, v18
  v_add_u32 v15, v18, v19
  v_add_u32 v18, 3584, v0
  v_mul_u32_u24 v19, 2731, v18
  v_lshrrev_b32 v19, 16, v19
  v_mul_u32_u24 v20, 24, v19
  v_sub_u32 v18, v18, v20
  v_and_b32 v20, 2, v19
  v_lshrrev_b32 v21, 1, v19
  v_and_b32 v21, 4, v21
  v_or_b32 v20, v20, v21
  v_xor_b32 v18, v18, v20
  v_mul_u32_u24 v19, 12288, v19
  v_lshlrev_b32 v18, 4, v18
  v_add_u32 v16, v18, v19
  s_add_u32 m0, s65, 0
  s_nop 0
  buffer_load_dwordx4 v92, s[4:7], s64 offen lds
  s_add_u32 m0, s65, 1024
  s_nop 0
  buffer_load_dwordx4 v93, s[4:7], s64 offen lds
  s_add_u32 m0, s65, 2048
  s_nop 0
  buffer_load_dwordx4 v94, s[4:7], s64 offen lds
  s_add_u32 m0, s65, 3072
  s_nop 0
  buffer_load_dwordx4 v95, s[4:7], s64 offen lds
  s_add_u32 m0, s65, 4096
  s_nop 0
  buffer_load_dwordx4 v96, s[4:7], s64 offen lds
  s_add_u32 m0, s65, 5120
  s_nop 0
  buffer_load_dwordx4 v97, s[4:7], s64 offen lds
  s_add_u32 m0, s65, 6144
  s_nop 0
  buffer_load_dwordx4 v98, s[4:7], s64 offen lds
  s_add_u32 m0, s65, 7168
  s_nop 0
  buffer_load_dwordx4 v99, s[4:7], s64 offen lds
  s_add_u32 m0, s65, 8192
  s_nop 0
  buffer_load_dwordx4 v100, s[4:7], s64 offen lds
  s_add_u32 m0, s65, 9216
  s_nop 0
  buffer_load_dwordx4 v101, s[4:7], s64 offen lds
  s_mov_b32 s70, s67
  s_lshl_b32 s60, s52, 10
  s_add_u32 s60, s60, 0x0
  s_add_u32 m0, s60, 0
  s_nop 0
  buffer_load_dwordx4 v2, s[12:15], s70 offen lds
  s_add_u32 m0, s60, 4096
  s_nop 0
  buffer_load_dwordx4 v3, s[12:15], s70 offen lds
  s_add_u32 m0, s60, 8192
  s_nop 0
  buffer_load_dwordx4 v4, s[12:15], s70 offen lds
  s_add_u32 m0, s60, 12288
  s_nop 0
  buffer_load_dwordx4 v5, s[12:15], s70 offen lds
  s_add_u32 m0, s60, 16384
  s_nop 0
  buffer_load_dwordx4 v6, s[12:15], s70 offen lds
  s_add_u32 m0, s60, 20480
  s_nop 0
  buffer_load_dwordx4 v7, s[12:15], s70 offen lds
  s_add_u32 m0, s60, 24576
  s_nop 0
  buffer_load_dwordx4 v8, s[12:15], s70 offen lds
  s_add_u32 m0, s60, 28672
  s_nop 0
  buffer_load_dwordx4 v9, s[12:15], s70 offen lds
  s_add_u32 m0, s60, 32768
  s_nop 0
  buffer_load_dwordx4 v10, s[12:15], s70 offen lds
  s_add_u32 m0, s60, 36864
  s_nop 0
  buffer_load_dwordx4 v11, s[12:15], s70 offen lds
  s_add_u32 m0, s60, 40960
  s_nop 0
  buffer_load_dwordx4 v12, s[12:15], s70 offen lds
  s_add_u32 m0, s60, 45056
  s_nop 0
  buffer_load_dwordx4 v13, s[12:15], s70 offen lds
  s_add_u32 m0, s60, 49152
  s_nop 0
  buffer_load_dwordx4 v14, s[12:15], s70 offen lds
  s_add_u32 m0, s60, 53248
  s_nop 0
  buffer_load_dwordx4 v15, s[12:15], s70 offen lds
  s_add_u32 m0, s60, 57344
  s_nop 0
  buffer_load_dwordx4 v16, s[12:15], s70 offen lds
  s_add_u32 s70, s70, 1966080
  s_lshl_b32 s60, s52, 10
  s_add_u32 s60, s60, 0xf000
  s_add_u32 m0, s60, 0
  s_nop 0
  buffer_load_dwordx4 v2, s[12:15], s70 offen lds
  s_add_u32 m0, s60, 4096
  s_nop 0
  buffer_load_dwordx4 v3, s[12:15], s70 offen lds
  s_add_u32 m0, s60, 8192
  s_nop 0
  buffer_load_dwordx4 v4, s[12:15], s70 offen lds
  s_add_u32 m0, s60, 12288
  s_nop 0
  buffer_load_dwordx4 v5, s[12:15], s70 offen lds
  s_add_u32 m0, s60, 16384
  s_nop 0
  buffer_load_dwordx4 v6, s[12:15], s70 offen lds
  s_add_u32 m0, s60, 20480
  s_nop 0
  buffer_load_dwordx4 v7, s[12:15], s70 offen lds
  s_add_u32 m0, s60, 24576
  s_nop 0
  buffer_load_dwordx4 v8, s[12:15], s70 offen lds
  s_add_u32 m0, s60, 28672
  s_nop 0
  buffer_load_dwordx4 v9, s[12:15], s70 offen lds
  s_add_u32 m0, s60, 32768
  s_nop 0
  buffer_load_dwordx4 v10, s[12:15], s70 offen lds
  s_add_u32 m0, s60, 36864
  s_nop 0
  buffer_load_dwordx4 v11, s[12:15], s70 offen lds
  s_add_u32 m0, s60, 40960
  s_nop 0
  buffer_load_dwordx4 v12, s[12:15], s70 offen lds
  s_add_u32 m0, s60, 45056
  s_nop 0
  buffer_load_dwordx4 v13, s[12:15], s70 offen lds
  s_add_u32 m0, s60, 49152
  s_nop 0
  buffer_load_dwordx4 v14, s[12:15], s70 offen lds
  s_add_u32 m0, s60, 53248
  s_nop 0
  buffer_load_dwordx4 v15, s[12:15], s70 offen lds
  s_add_u32 m0, s60, 57344
  s_nop 0
  buffer_load_dwordx4 v16, s[12:15], s70 offen lds
  s_waitcnt vmcnt(15)
  s_barrier
  ds_read_b64_tr_b16 a[0:1], v26 offset:0
  ds_read_b64_tr_b16 a[2:3], v26 offset:1536
  ds_read_b64_tr_b16 a[4:5], v26 offset:12288
  ds_read_b64_tr_b16 a[6:7], v26 offset:13824
  ds_read_b64_tr_b16 a[8:9], v26 offset:24576
  ds_read_b64_tr_b16 a[10:11], v26 offset:26112
  s_waitcnt lgkmcnt(4)
  ds_read_b64_tr_b16 a[12:13], v26 offset:36864
  ds_read_b64_tr_b16 a[14:15], v26 offset:38400
  ds_read_b64_tr_b16 a[16:17], v26 offset:49152
  ds_read_b64_tr_b16 a[18:19], v26 offset:50688
  s_waitcnt lgkmcnt(4)
  ds_read_b64_tr_b16 a[80:81], v27 offset:0
  ds_read_b64_tr_b16 a[82:83], v27 offset:1536
  ds_read_b64_tr_b16 a[84:85], v27 offset:12288
  ds_read_b64_tr_b16 a[86:87], v27 offset:13824
  ds_read_b64_tr_b16 a[88:89], v27 offset:24576
  ds_read_b64_tr_b16 a[90:91], v27 offset:26112
  s_waitcnt lgkmcnt(4)
  ds_read_b64_tr_b16 a[92:93], v27 offset:36864
  ds_read_b64_tr_b16 a[94:95], v27 offset:38400
  ds_read_b64_tr_b16 a[96:97], v27 offset:49152
  ds_read_b64_tr_b16 a[98:99], v27 offset:50688
  s_waitcnt lgkmcnt(4)
  ds_read_b64_tr_b16 a[160:161], v28 offset:0
  ds_read_b64_tr_b16 a[162:163], v28 offset:1536
  ds_read_b64_tr_b16 a[164:165], v28 offset:12288
  ds_read_b64_tr_b16 a[166:167], v28 offset:13824
  ds_read_b64_tr_b16 a[168:169], v28 offset:24576
  ds_read_b64_tr_b16 a[170:171], v28 offset:26112
  s_waitcnt lgkmcnt(4)
  ds_read_b64_tr_b16 a[172:173], v28 offset:36864
  ds_read_b64_tr_b16 a[174:175], v28 offset:38400
  ds_read_b64_tr_b16 a[176:177], v28 offset:49152
  ds_read_b64_tr_b16 a[178:179], v28 offset:50688
  s_waitcnt lgkmcnt(4)
  s_waitcnt lgkmcnt(0)
  v_add_u32 v26, 61440, v26
  v_add_u32 v27, 61440, v27
  v_add_u32 v28, 61440, v28
  s_barrier
  s_add_u32 s70, s70, 1966080
  s_lshl_b32 s60, s52, 10
  s_add_u32 s60, s60, 0x0
  s_add_u32 m0, s60, 0
  s_nop 0
  buffer_load_dwordx4 v2, s[12:15], s70 offen lds
  s_add_u32 m0, s60, 4096
  s_nop 0
  buffer_load_dwordx4 v3, s[12:15], s70 offen lds
  s_add_u32 m0, s60, 8192
  s_nop 0
  buffer_load_dwordx4 v4, s[12:15], s70 offen lds
  s_add_u32 m0, s60, 12288
  s_nop 0
  buffer_load_dwordx4 v5, s[12:15], s70 offen lds
  s_add_u32 m0, s60, 16384
  s_nop 0
  buffer_load_dwordx4 v6, s[12:15], s70 offen lds
  s_add_u32 m0, s60, 20480
  s_nop 0
  buffer_load_dwordx4 v7, s[12:15], s70 offen lds
  s_add_u32 m0, s60, 24576
  s_nop 0
  buffer_load_dwordx4 v8, s[12:15], s70 offen lds
  s_add_u32 m0, s60, 28672
  s_nop 0
  buffer_load_dwordx4 v9, s[12:15], s70 offen lds
  s_add_u32 m0, s60, 32768
  s_nop 0
  buffer_load_dwordx4 v10, s[12:15], s70 offen lds
  s_add_u32 m0, s60, 36864
  s_nop 0
  buffer_load_dwordx4 v11, s[12:15], s70 offen lds
  s_add_u32 m0, s60, 40960
  s_nop 0
  buffer_load_dwordx4 v12, s[12:15], s70 offen lds
  s_add_u32 m0, s60, 45056
  s_nop 0
  buffer_load_dwordx4 v13, s[12:15], s70 offen lds
  s_add_u32 m0, s60, 49152
  s_nop 0
  buffer_load_dwordx4 v14, s[12:15], s70 offen lds
  s_add_u32 m0, s60, 53248
  s_nop 0
  buffer_load_dwordx4 v15, s[12:15], s70 offen lds
  s_add_u32 m0, s60, 57344
  s_nop 0
  buffer_load_dwordx4 v16, s[12:15], s70 offen lds
  s_waitcnt vmcnt(15)
  s_barrier
  ds_read_b64_tr_b16 a[20:21], v26 offset:0
  ds_read_b64_tr_b16 a[22:23], v26 offset:1536
  ds_read_b64_tr_b16 a[24:25], v26 offset:12288
  ds_read_b64_tr_b16 a[26:27], v26 offset:13824
  ds_read_b64_tr_b16 a[28:29], v26 offset:24576
  ds_read_b64_tr_b16 a[30:31], v26 offset:26112
  s_waitcnt lgkmcnt(4)
  ds_read_b64_tr_b16 a[32:33], v26 offset:36864
  ds_read_b64_tr_b16 a[34:35], v26 offset:38400
  ds_read_b64_tr_b16 a[36:37], v26 offset:49152
  ds_read_b64_tr_b16 a[38:39], v26 offset:50688
  s_waitcnt lgkmcnt(4)
  ds_read_b64_tr_b16 a[100:101], v27 offset:0
  ds_read_b64_tr_b16 a[102:103], v27 offset:1536
  ds_read_b64_tr_b16 a[104:105], v27 offset:12288
  ds_read_b64_tr_b16 a[106:107], v27 offset:13824
  ds_read_b64_tr_b16 a[108:109], v27 offset:24576
  ds_read_b64_tr_b16 a[110:111], v27 offset:26112
  s_waitcnt lgkmcnt(4)
  ds_read_b64_tr_b16 a[112:113], v27 offset:36864
  ds_read_b64_tr_b16 a[114:115], v27 offset:38400
  ds_read_b64_tr_b16 a[116:117], v27 offset:49152
  ds_read_b64_tr_b16 a[118:119], v27 offset:50688
  s_waitcnt lgkmcnt(4)
  ds_read_b64_tr_b16 a[180:181], v28 offset:0
  ds_read_b64_tr_b16 a[182:183], v28 offset:1536
  ds_read_b64_tr_b16 a[184:185], v28 offset:12288
  ds_read_b64_tr_b16 a[186:187], v28 offset:13824
  ds_read_b64_tr_b16 a[188:189], v28 offset:24576
  ds_read_b64_tr_b16 a[190:191], v28 offset:26112
  s_waitcnt lgkmcnt(4)
  ds_read_b64_tr_b16 a[192:193], v28 offset:36864
  ds_read_b64_tr_b16 a[194:195], v28 offset:38400
  ds_read_b64_tr_b16 a[196:197], v28 offset:49152
  ds_read_b64_tr_b16 a[198:199], v28 offset:50688
  s_waitcnt lgkmcnt(4)
  s_waitcnt lgkmcnt(0)
  v_subrev_u32 v26, 61440, v26
  v_subrev_u32 v27, 61440, v27
  v_subrev_u32 v28, 61440, v28
  s_barrier
  s_add_u32 s70, s70, 1966080
  s_lshl_b32 s60, s52, 10
  s_add_u32 s60, s60, 0xf000
  s_add_u32 m0, s60, 0
  s_nop 0
  buffer_load_dwordx4 v2, s[12:15], s70 offen lds
  s_add_u32 m0, s60, 4096
  s_nop 0
  buffer_load_dwordx4 v3, s[12:15], s70 offen lds
  s_add_u32 m0, s60, 8192
  s_nop 0
  buffer_load_dwordx4 v4, s[12:15], s70 offen lds
  s_add_u32 m0, s60, 12288
  s_nop 0
  buffer_load_dwordx4 v5, s[12:15], s70 offen lds
  s_add_u32 m0, s60, 16384
  s_nop 0
  buffer_load_dwordx4 v6, s[12:15], s70 offen lds
  s_add_u32 m0, s60, 20480
  s_nop 0
  buffer_load_dwordx4 v7, s[12:15], s70 offen lds
  s_add_u32 m0, s60, 24576
  s_nop 0
  buffer_load_dwordx4 v8, s[12:15], s70 offen lds
  s_add_u32 m0, s60, 28672
  s_nop 0
  buffer_load_dwordx4 v9, s[12:15], s70 offen lds
  s_add_u32 m0, s60, 32768
  s_nop 0
  buffer_load_dwordx4 v10, s[12:15], s70 offen lds
  s_add_u32 m0, s60, 36864
  s_nop 0
  buffer_load_dwordx4 v11, s[12:15], s70 offen lds
  s_add_u32 m0, s60, 40960
  s_nop 0
  buffer_load_dwordx4 v12, s[12:15], s70 offen lds
  s_add_u32 m0, s60, 45056
  s_nop 0
  buffer_load_dwordx4 v13, s[12:15], s70 offen lds
  s_add_u32 m0, s60, 49152
  s_nop 0
  buffer_load_dwordx4 v14, s[12:15], s70 offen lds
  s_add_u32 m0, s60, 53248
  s_nop 0
  buffer_load_dwordx4 v15, s[12:15], s70 offen lds
  s_add_u32 m0, s60, 57344
  s_nop 0
  buffer_load_dwordx4 v16, s[12:15], s70 offen lds
  s_waitcnt vmcnt(15)
  s_barrier
  ds_read_b64_tr_b16 a[40:41], v26 offset:0
  ds_read_b64_tr_b16 a[42:43], v26 offset:1536
  ds_read_b64_tr_b16 a[44:45], v26 offset:12288
  ds_read_b64_tr_b16 a[46:47], v26 offset:13824
  ds_read_b64_tr_b16 a[48:49], v26 offset:24576
  ds_read_b64_tr_b16 a[50:51], v26 offset:26112
  s_waitcnt lgkmcnt(4)
  ds_read_b64_tr_b16 a[52:53], v26 offset:36864
  ds_read_b64_tr_b16 a[54:55], v26 offset:38400
  ds_read_b64_tr_b16 a[56:57], v26 offset:49152
  ds_read_b64_tr_b16 a[58:59], v26 offset:50688
  s_waitcnt lgkmcnt(4)
  ds_read_b64_tr_b16 a[120:121], v27 offset:0
  ds_read_b64_tr_b16 a[122:123], v27 offset:1536
  ds_read_b64_tr_b16 a[124:125], v27 offset:12288
  ds_read_b64_tr_b16 a[126:127], v27 offset:13824
  ds_read_b64_tr_b16 a[128:129], v27 offset:24576
  ds_read_b64_tr_b16 a[130:131], v27 offset:26112
  s_waitcnt lgkmcnt(4)
  ds_read_b64_tr_b16 a[132:133], v27 offset:36864
  ds_read_b64_tr_b16 a[134:135], v27 offset:38400
  ds_read_b64_tr_b16 a[136:137], v27 offset:49152
  ds_read_b64_tr_b16 a[138:139], v27 offset:50688
  s_waitcnt lgkmcnt(4)
  ds_read_b64_tr_b16 a[200:201], v28 offset:0
  ds_read_b64_tr_b16 a[202:203], v28 offset:1536
  ds_read_b64_tr_b16 a[204:205], v28 offset:12288
  ds_read_b64_tr_b16 a[206:207], v28 offset:13824
  ds_read_b64_tr_b16 a[208:209], v28 offset:24576
  ds_read_b64_tr_b16 a[210:211], v28 offset:26112
  s_waitcnt lgkmcnt(4)
  ds_read_b64_tr_b16 a[212:213], v28 offset:36864
  ds_read_b64_tr_b16 a[214:215], v28 offset:38400
  ds_read_b64_tr_b16 a[216:217], v28 offset:49152
  ds_read_b64_tr_b16 a[218:219], v28 offset:50688
  s_waitcnt lgkmcnt(4)
  s_waitcnt lgkmcnt(0)
  v_add_u32 v26, 61440, v26
  v_add_u32 v27, 61440, v27
  v_add_u32 v28, 61440, v28
  s_barrier
  s_waitcnt vmcnt(0)
  s_barrier
  ds_read_b64_tr_b16 a[60:61], v26 offset:0
  ds_read_b64_tr_b16 a[62:63], v26 offset:1536
  ds_read_b64_tr_b16 a[64:65], v26 offset:12288
  ds_read_b64_tr_b16 a[66:67], v26 offset:13824
  ds_read_b64_tr_b16 a[68:69], v26 offset:24576
  ds_read_b64_tr_b16 a[70:71], v26 offset:26112
  s_waitcnt lgkmcnt(4)
  ds_read_b64_tr_b16 a[72:73], v26 offset:36864
  ds_read_b64_tr_b16 a[74:75], v26 offset:38400
  ds_read_b64_tr_b16 a[76:77], v26 offset:49152
  ds_read_b64_tr_b16 a[78:79], v26 offset:50688
  s_waitcnt lgkmcnt(4)
  ds_read_b64_tr_b16 a[140:141], v27 offset:0
  ds_read_b64_tr_b16 a[142:143], v27 offset:1536
  ds_read_b64_tr_b16 a[144:145], v27 offset:12288
  ds_read_b64_tr_b16 a[146:147], v27 offset:13824
  ds_read_b64_tr_b16 a[148:149], v27 offset:24576
  ds_read_b64_tr_b16 a[150:151], v27 offset:26112
  s_waitcnt lgkmcnt(4)
  ds_read_b64_tr_b16 a[152:153], v27 offset:36864
  ds_read_b64_tr_b16 a[154:155], v27 offset:38400
  ds_read_b64_tr_b16 a[156:157], v27 offset:49152
  ds_read_b64_tr_b16 a[158:159], v27 offset:50688
  s_waitcnt lgkmcnt(4)
  ds_read_b64_tr_b16 a[220:221], v28 offset:0
  ds_read_b64_tr_b16 a[222:223], v28 offset:1536
  ds_read_b64_tr_b16 a[224:225], v28 offset:12288
  ds_read_b64_tr_b16 a[226:227], v28 offset:13824
  ds_read_b64_tr_b16 a[228:229], v28 offset:24576
  ds_read_b64_tr_b16 a[230:231], v28 offset:26112
  s_waitcnt lgkmcnt(4)
  ds_read_b64_tr_b16 a[232:233], v28 offset:36864
  ds_read_b64_tr_b16 a[234:235], v28 offset:38400
  ds_read_b64_tr_b16 a[236:237], v28 offset:49152
  ds_read_b64_tr_b16 a[238:239], v28 offset:50688
  s_waitcnt lgkmcnt(4)
  s_waitcnt lgkmcnt(0)
  v_subrev_u32 v26, 61440, v26
  v_subrev_u32 v27, 61440, v27
  v_subrev_u32 v28, 61440, v28
  s_barrier
  s_mov_b32 s71, 0xfffe2000
  v_mov_b32 v2, 0x3f803f80
  v_mov_b32 v3, 0x3f803f80
  v_mov_b32 v4, 0x3f803f80
  v_mov_b32 v5, 0x3f803f80
  v_lshlrev_b32 v15, 4, v1
  v_lshlrev_b32 v16, 3, v1
  v_lshrrev_b32 v18, 4, v1
  v_lshlrev_b32 v18, 2, v18
  v_and_b32 v19, 15, v1
  v_mov_b32 v20, 0
  v_mov_b32 v21, 0xf149f2ca
  v_add_u32 v6, 0, v18
  v_cmp_le_u32 vcc, v6, v19
  s_nop 1
  v_cndmask_b32 v6, v21, v20, vcc
  v_add_u32 v7, 1, v18
  v_cmp_le_u32 vcc, v7, v19
  s_nop 1
  v_cndmask_b32 v7, v21, v20, vcc
  v_add_u32 v8, 2, v18
  v_cmp_le_u32 vcc, v8, v19
  s_nop 1
  v_cndmask_b32 v8, v21, v20, vcc
  v_add_u32 v9, 3, v18
  v_cmp_le_u32 vcc, v9, v19
  s_nop 1
  v_cndmask_b32 v9, v21, v20, vcc
  v_cmp_gt_u32 vcc, 32, v1
  s_nop 1
  v_cndmask_b32 v10, v21, v20, vcc
  s_lshl_b32 s58, s69, 8
  v_and_b32 v18, 1, v1
  v_lshlrev_b32 v18, 7, v18
  v_add_u32 v18, s58, v18
  s_lshl_b32 s58, s69, 9
  s_add_u32 s58, s58, 8192
  v_and_b32 v19, 3, v1
  v_lshlrev_b32 v19, 7, v19
  v_add_u32 v19, s58, v19
  v_cmp_gt_u32 vcc, 16, v1
  s_nop 1
  v_cndmask_b32 v11, v18, v19, vcc
  s_mul_i32 s58, s52, 3
  s_add_u32 s58, s58, 0
  s_lshr_b32 s59, s58, 1
  s_lshl_b32 s59, s59, 11
  s_and_b32 s58, s58, 1
  s_lshl_b32 s58, s58, 3
  s_add_u32 s58, s58, s59
  v_add_u32 v12, s58, v15
  s_mul_i32 s58, s52, 3
  s_add_u32 s58, s58, 1
  s_lshr_b32 s59, s58, 1
  s_lshl_b32 s59, s59, 11
  s_and_b32 s58, s58, 1
  s_lshl_b32 s58, s58, 3
  s_add_u32 s58, s58, s59
  v_add_u32 v13, s58, v15
  s_mul_i32 s58, s52, 3
  s_add_u32 s58, s58, 2
  s_lshr_b32 s59, s58, 1
  s_lshl_b32 s59, s59, 11
  s_and_b32 s58, s58, 1
  s_lshl_b32 s58, s58, 3
  s_add_u32 s58, s58, s59
  v_add_u32 v14, s58, v15
  s_lshl_b32 s58, s52, 10
  s_add_u32 s58, s58, 40960
  v_add_u32 v22, s58, v15
  v_add_u32 v23, 40960, v15
  s_mul_i32 s73, s69, 12288
  s_mul_i32 s58, s52, 3072
  s_add_u32 s73, s73, s58
  s_add_u32 s73, s73, 0x1a00000
  s_mul_i32 s74, s69, 6144
  s_mul_i32 s58, s52, 1536
  s_add_u32 s74, s74, s58
  s_add_u32 s74, s74, 0x200000
  s_mul_i32 s75, s69, 12288
  s_add_u32 s75, s75, 0x4a00000
  s_lshl_b32 s58, s69, 7
  s_add_u32 s58, s58, 24576
  v_mov_b32 v17, s58
  s_mov_b32 s77, 0x3dd53b95
  s_mov_b32 s62, 0
  s_mov_b32 s72, 0
  s_waitcnt vmcnt(0)
  s_barrier
  s_cmp_lt_u32 s62, 63
  s_cselect_b32 s58, 40960, 0
  s_add_u32 s64, s64, s58
  s_add_u32 s65, s65, s71
  ds_read_b128 v[32:35], v102 offset:0
  ds_read_b128 v[36:39], v102 offset:20480
  ds_read_b128 v[40:43], v103 offset:0
  ds_read_b128 v[44:47], v103 offset:20480
  ds_read_b128 v[48:51], v104 offset:0
  ds_read_b128 v[52:55], v104 offset:20480
  s_waitcnt lgkmcnt(4)
  v_mfma_f32_16x16x32_bf16 v[56:59], a[0:3], v[32:35], 0
  v_mfma_f32_16x16x32_bf16 v[64:67], a[80:83], v[32:35], 0
  v_mfma_f32_16x16x32_bf16 v[72:75], a[160:163], v[32:35], 0
  v_mfma_f32_16x16x32_bf16 v[60:63], a[0:3], v[36:39], 0
  v_mfma_f32_16x16x32_bf16 v[68:71], a[80:83], v[36:39], 0
  v_mfma_f32_16x16x32_bf16 v[76:79], a[160:163], v[36:39], 0
  ds_read_b128 v[32:35], v105 offset:0
  ds_read_b128 v[36:39], v105 offset:20480
  s_waitcnt lgkmcnt(4)
  v_mfma_f32_16x16x32_bf16 v[56:59], a[4:7], v[40:43], v[56:59]
  s_add_u32 m0, s65, 0
  s_nop 0
  buffer_load_dwordx4 v92, s[4:7], s64 offen lds
  v_mfma_f32_16x16x32_bf16 v[64:67], a[84:87], v[40:43], v[64:67]
  v_mfma_f32_16x16x32_bf16 v[72:75], a[164:167], v[40:43], v[72:75]
  v_mfma_f32_16x16x32_bf16 v[60:63], a[4:7], v[44:47], v[60:63]
  v_mfma_f32_16x16x32_bf16 v[68:71], a[84:87], v[44:47], v[68:71]
  v_mfma_f32_16x16x32_bf16 v[76:79], a[164:167], v[44:47], v[76:79]
  ds_read_b128 v[40:43], v102 offset:256
  ds_read_b128 v[44:47], v102 offset:20736
  s_waitcnt lgkmcnt(4)
  v_mfma_f32_16x16x32_bf16 v[56:59], a[8:11], v[48:51], v[56:59]
  v_mfma_f32_16x16x32_bf16 v[64:67], a[88:91], v[48:51], v[64:67]
  v_mfma_f32_16x16x32_bf16 v[72:75], a[168:171], v[48:51], v[72:75]
  v_mfma_f32_16x16x32_bf16 v[60:63], a[8:11], v[52:55], v[60:63]
  v_mfma_f32_16x16x32_bf16 v[68:71], a[88:91], v[52:55], v[68:71]
  s_add_u32 m0, s65, 1024
  s_nop 0
  buffer_load_dwordx4 v93, s[4:7], s64 offen lds
  v_mfma_f32_16x16x32_bf16 v[76:79], a[168:171], v[52:55], v[76:79]
  ds_read_b128 v[48:51], v103 offset:256
  ds_read_b128 v[52:55], v103 offset:20736
  s_waitcnt lgkmcnt(4)
  v_mfma_f32_16x16x32_bf16 v[56:59], a[12:15], v[32:35], v[56:59]
  v_mfma_f32_16x16x32_bf16 v[64:67], a[92:95], v[32:35], v[64:67]
  v_mfma_f32_16x16x32_bf16 v[72:75], a[172:175], v[32:35], v[72:75]
  v_mfma_f32_16x16x32_bf16 v[60:63], a[12:15], v[36:39], v[60:63]
  v_mfma_f32_16x16x32_bf16 v[68:71], a[92:95], v[36:39], v[68:71]
  v_mfma_f32_16x16x32_bf16 v[76:79], a[172:175], v[36:39], v[76:79]
  ds_read_b128 v[32:35], v104 offset:256
  ds_read_b128 v[36:39], v104 offset:20736
  s_waitcnt lgkmcnt(4)
  v_mfma_f32_16x16x32_bf16 v[56:59], a[16:19], v[40:43], v[56:59]
  v_mfma_f32_16x16x32_bf16 v[64:67], a[96:99], v[40:43], v[64:67]
  v_mfma_f32_16x16x32_bf16 v[72:75], a[176:179], v[40:43], v[72:75]
  s_add_u32 m0, s65, 2048
  s_nop 0
  buffer_load_dwordx4 v94, s[4:7], s64 offen lds
  v_mfma_f32_16x16x32_bf16 v[60:63], a[16:19], v[44:47], v[60:63]
  v_mfma_f32_16x16x32_bf16 v[68:71], a[96:99], v[44:47], v[68:71]
  v_mfma_f32_16x16x32_bf16 v[76:79], a[176:179], v[44:47], v[76:79]
  ds_read_b128 v[40:43], v105 offset:256
  ds_read_b128 v[44:47], v105 offset:20736
  s_waitcnt lgkmcnt(4)
  v_mfma_f32_16x16x32_bf16 v[56:59], a[20:23], v[48:51], v[56:59]
  v_mfma_f32_16x16x32_bf16 v[64:67], a[100:103], v[48:51], v[64:67]
  v_mfma_f32_16x16x32_bf16 v[72:75], a[180:183], v[48:51], v[72:75]
  v_mfma_f32_16x16x32_bf16 v[60:63], a[20:23], v[52:55], v[60:63]
  v_mfma_f32_16x16x32_bf16 v[68:71], a[100:103], v[52:55], v[68:71]
  v_mfma_f32_16x16x32_bf16 v[76:79], a[180:183], v[52:55], v[76:79]
  ds_read_b128 v[48:51], v102 offset:512
  ds_read_b128 v[52:55], v102 offset:20992
  s_waitcnt lgkmcnt(4)
  v_mfma_f32_16x16x32_bf16 v[56:59], a[24:27], v[32:35], v[56:59]
  s_add_u32 m0, s65, 3072
  s_nop 0
  buffer_load_dwordx4 v95, s[4:7], s64 offen lds
  v_mfma_f32_16x16x32_bf16 v[64:67], a[104:107], v[32:35], v[64:67]
  v_mfma_f32_16x16x32_bf16 v[72:75], a[184:187], v[32:35], v[72:75]
  v_mfma_f32_16x16x32_bf16 v[60:63], a[24:27], v[36:39], v[60:63]
  v_mfma_f32_16x16x32_bf16 v[68:71], a[104:107], v[36:39], v[68:71]
  v_mfma_f32_16x16x32_bf16 v[76:79], a[184:187], v[36:39], v[76:79]
  ds_read_b128 v[32:35], v103 offset:512
  ds_read_b128 v[36:39], v103 offset:20992
  s_waitcnt lgkmcnt(4)
  v_mfma_f32_16x16x32_bf16 v[56:59], a[28:31], v[40:43], v[56:59]
  v_mfma_f32_16x16x32_bf16 v[64:67], a[108:111], v[40:43], v[64:67]
  v_mfma_f32_16x16x32_bf16 v[72:75], a[188:191], v[40:43], v[72:75]
  v_mfma_f32_16x16x32_bf16 v[60:63], a[28:31], v[44:47], v[60:63]
  v_mfma_f32_16x16x32_bf16 v[68:71], a[108:111], v[44:47], v[68:71]
  s_add_u32 m0, s65, 4096
  s_nop 0
  buffer_load_dwordx4 v96, s[4:7], s64 offen lds
  v_mfma_f32_16x16x32_bf16 v[76:79], a[188:191], v[44:47], v[76:79]
  ds_read_b128 v[40:43], v104 offset:512
  ds_read_b128 v[44:47], v104 offset:20992
  s_waitcnt lgkmcnt(4)
  v_mfma_f32_16x16x32_bf16 v[56:59], a[32:35], v[48:51], v[56:59]
  v_mfma_f32_16x16x32_bf16 v[64:67], a[112:115], v[48:51], v[64:67]
  v_mfma_f32_16x16x32_bf16 v[72:75], a[192:195], v[48:51], v[72:75]
  v_mfma_f32_16x16x32_bf16 v[60:63], a[32:35], v[52:55], v[60:63]
  v_mfma_f32_16x16x32_bf16 v[68:71], a[112:115], v[52:55], v[68:71]
  v_mfma_f32_16x16x32_bf16 v[76:79], a[192:195], v[52:55], v[76:79]
  ds_read_b128 v[48:51], v105 offset:512
  ds_read_b128 v[52:55], v105 offset:20992
  s_waitcnt lgkmcnt(4)
  v_mfma_f32_16x16x32_bf16 v[56:59], a[36:39], v[32:35], v[56:59]
  v_mfma_f32_16x16x32_bf16 v[64:67], a[116:119], v[32:35], v[64:67]
  v_mfma_f32_16x16x32_bf16 v[72:75], a[196:199], v[32:35], v[72:75]
  s_add_u32 m0, s65, 5120
  s_nop 0
  buffer_load_dwordx4 v97, s[4:7], s64 offen lds
  v_mfma_f32_16x16x32_bf16 v[60:63], a[36:39], v[36:39], v[60:63]
  v_mfma_f32_16x16x32_bf16 v[68:71], a[116:119], v[36:39], v[68:71]
  v_mfma_f32_16x16x32_bf16 v[76:79], a[196:199], v[36:39], v[76:79]
  ds_read_b128 v[32:35], v102 offset:768
  ds_read_b128 v[36:39], v102 offset:21248
  s_waitcnt lgkmcnt(4)
  v_mfma_f32_16x16x32_bf16 v[56:59], a[40:43], v[40:43], v[56:59]
  v_mfma_f32_16x16x32_bf16 v[64:67], a[120:123], v[40:43], v[64:67]
  v_mfma_f32_16x16x32_bf16 v[72:75], a[200:203], v[40:43], v[72:75]
  v_mfma_f32_16x16x32_bf16 v[60:63], a[40:43], v[44:47], v[60:63]
  v_mfma_f32_16x16x32_bf16 v[68:71], a[120:123], v[44:47], v[68:71]
  v_mfma_f32_16x16x32_bf16 v[76:79], a[200:203], v[44:47], v[76:79]
  ds_read_b128 v[40:43], v103 offset:768
  ds_read_b128 v[44:47], v103 offset:21248
  s_waitcnt lgkmcnt(4)
  v_mfma_f32_16x16x32_bf16 v[56:59], a[44:47], v[48:51], v[56:59]
  s_add_u32 m0, s65, 6144
  s_nop 0
  buffer_load_dwordx4 v98, s[4:7], s64 offen lds
  v_mfma_f32_16x16x32_bf16 v[64:67], a[124:127], v[48:51], v[64:67]
  v_mfma_f32_16x16x32_bf16 v[72:75], a[204:207], v[48:51], v[72:75]
  v_mfma_f32_16x16x32_bf16 v[60:63], a[44:47], v[52:55], v[60:63]
  v_mfma_f32_16x16x32_bf16 v[68:71], a[124:127], v[52:55], v[68:71]
  v_mfma_f32_16x16x32_bf16 v[76:79], a[204:207], v[52:55], v[76:79]
  ds_read_b128 v[48:51], v104 offset:768
  ds_read_b128 v[52:55], v104 offset:21248
  s_waitcnt lgkmcnt(4)
  v_mfma_f32_16x16x32_bf16 v[56:59], a[48:51], v[32:35], v[56:59]
  v_mfma_f32_16x16x32_bf16 v[64:67], a[128:131], v[32:35], v[64:67]
  v_mfma_f32_16x16x32_bf16 v[72:75], a[208:211], v[32:35], v[72:75]
  v_mfma_f32_16x16x32_bf16 v[60:63], a[48:51], v[36:39], v[60:63]
  v_mfma_f32_16x16x32_bf16 v[68:71], a[128:131], v[36:39], v[68:71]
  s_add_u32 m0, s65, 7168
  s_nop 0
  buffer_load_dwordx4 v99, s[4:7], s64 offen lds
  v_mfma_f32_16x16x32_bf16 v[76:79], a[208:211], v[36:39], v[76:79]
  ds_read_b128 v[32:35], v105 offset:768
  ds_read_b128 v[36:39], v105 offset:21248
  s_waitcnt lgkmcnt(4)
  v_mfma_f32_16x16x32_bf16 v[56:59], a[52:55], v[40:43], v[56:59]
  v_mfma_f32_16x16x32_bf16 v[64:67], a[132:135], v[40:43], v[64:67]
  v_mfma_f32_16x16x32_bf16 v[72:75], a[212:215], v[40:43], v[72:75]
  v_mfma_f32_16x16x32_bf16 v[60:63], a[52:55], v[44:47], v[60:63]
  v_mfma_f32_16x16x32_bf16 v[68:71], a[132:135], v[44:47], v[68:71]
  v_mfma_f32_16x16x32_bf16 v[76:79], a[212:215], v[44:47], v[76:79]
  ds_read_b128 v[40:43], v102 offset:1024
  ds_read_b128 v[44:47], v102 offset:21504
  s_waitcnt lgkmcnt(4)
  v_mfma_f32_16x16x32_bf16 v[56:59], a[56:59], v[48:51], v[56:59]
  v_mfma_f32_16x16x32_bf16 v[64:67], a[136:139], v[48:51], v[64:67]
  v_mfma_f32_16x16x32_bf16 v[72:75], a[216:219], v[48:51], v[72:75]
  s_add_u32 m0, s65, 8192
  s_nop 0
  buffer_load_dwordx4 v100, s[4:7], s64 offen lds
  v_mfma_f32_16x16x32_bf16 v[60:63], a[56:59], v[52:55], v[60:63]
  v_mfma_f32_16x16x32_bf16 v[68:71], a[136:139], v[52:55], v[68:71]
  v_mfma_f32_16x16x32_bf16 v[76:79], a[216:219], v[52:55], v[76:79]
  ds_read_b128 v[48:51], v103 offset:1024
  ds_read_b128 v[52:55], v103 offset:21504
  s_waitcnt lgkmcnt(4)
  v_mfma_f32_16x16x32_bf16 v[56:59], a[60:63], v[32:35], v[56:59]
  v_mfma_f32_16x16x32_bf16 v[64:67], a[140:143], v[32:35], v[64:67]
  v_mfma_f32_16x16x32_bf16 v[72:75], a[220:223], v[32:35], v[72:75]
  v_mfma_f32_16x16x32_bf16 v[60:63], a[60:63], v[36:39], v[60:63]
  v_mfma_f32_16x16x32_bf16 v[68:71], a[140:143], v[36:39], v[68:71]
  v_mfma_f32_16x16x32_bf16 v[76:79], a[220:223], v[36:39], v[76:79]
  ds_read_b128 v[32:35], v104 offset:1024
  ds_read_b128 v[36:39], v104 offset:21504
  s_waitcnt lgkmcnt(4)
  v_mfma_f32_16x16x32_bf16 v[56:59], a[64:67], v[40:43], v[56:59]
  s_add_u32 m0, s65, 9216
  s_nop 0
  buffer_load_dwordx4 v101, s[4:7], s64 offen lds
  v_mfma_f32_16x16x32_bf16 v[64:67], a[144:147], v[40:43], v[64:67]
  v_mfma_f32_16x16x32_bf16 v[72:75], a[224:227], v[40:43], v[72:75]
  v_mfma_f32_16x16x32_bf16 v[60:63], a[64:67], v[44:47], v[60:63]
  v_mfma_f32_16x16x32_bf16 v[68:71], a[144:147], v[44:47], v[68:71]
  v_mfma_f32_16x16x32_bf16 v[76:79], a[224:227], v[44:47], v[76:79]
  ds_read_b128 v[40:43], v105 offset:1024
  ds_read_b128 v[44:47], v105 offset:21504
  s_waitcnt lgkmcnt(4)
  v_mfma_f32_16x16x32_bf16 v[56:59], a[68:71], v[48:51], v[56:59]
  v_mfma_f32_16x16x32_bf16 v[64:67], a[148:151], v[48:51], v[64:67]
  v_mfma_f32_16x16x32_bf16 v[72:75], a[228:231], v[48:51], v[72:75]
  v_mfma_f32_16x16x32_bf16 v[60:63], a[68:71], v[52:55], v[60:63]
  v_mfma_f32_16x16x32_bf16 v[68:71], a[148:151], v[52:55], v[68:71]
  v_mfma_f32_16x16x32_bf16 v[76:79], a[228:231], v[52:55], v[76:79]
  s_waitcnt lgkmcnt(2)
  v_mfma_f32_16x16x32_bf16 v[56:59], a[72:75], v[32:35], v[56:59]
  v_mfma_f32_16x16x32_bf16 v[64:67], a[152:155], v[32:35], v[64:67]
  v_mfma_f32_16x16x32_bf16 v[72:75], a[232:235], v[32:35], v[72:75]
  v_mfma_f32_16x16x32_bf16 v[60:63], a[72:75], v[36:39], v[60:63]
  v_mfma_f32_16x16x32_bf16 v[68:71], a[152:155], v[36:39], v[68:71]
  v_mfma_f32_16x16x32_bf16 v[76:79], a[232:235], v[36:39], v[76:79]
  s_waitcnt lgkmcnt(0)
  v_mfma_f32_16x16x32_bf16 v[56:59], a[76:79], v[40:43], v[56:59]
  v_mfma_f32_16x16x32_bf16 v[64:67], a[156:159], v[40:43], v[64:67]
  v_mfma_f32_16x16x32_bf16 v[72:75], a[236:239], v[40:43], v[72:75]
  v_mfma_f32_16x16x32_bf16 v[60:63], a[76:79], v[44:47], v[60:63]
  v_mfma_f32_16x16x32_bf16 v[68:71], a[156:159], v[44:47], v[68:71]
  v_mfma_f32_16x16x32_bf16 v[76:79], a[236:239], v[44:47], v[76:79]
  v_add_u32 v102, s71, v102
  v_add_u32 v103, s71, v103
  v_add_u32 v104, s71, v104
  v_add_u32 v105, s71, v105
  s_sub_u32 s71, 0, s71
  s_nop 3
  v_cvt_pk_bf16_f32 v80, v56, v57
  v_cvt_pk_bf16_f32 v81, v58, v59
  v_cvt_pk_bf16_f32 v82, v60, v61
  v_cvt_pk_bf16_f32 v83, v62, v63
  v_cvt_pk_bf16_f32 v84, v64, v65
  v_cvt_pk_bf16_f32 v85, v66, v67
  v_cvt_pk_bf16_f32 v86, v68, v69
  v_cvt_pk_bf16_f32 v87, v70, v71
  v_cvt_pk_bf16_f32 v88, v72, v73
  v_cvt_pk_bf16_f32 v89, v74, v75
  v_cvt_pk_bf16_f32 v90, v76, v77
  v_cvt_pk_bf16_f32 v91, v78, v79
  s_waitcnt vmcnt(0)
  s_barrier
L_t2_r:
  s_cmp_eq_u32 s62, 62
  s_cbranch_scc1 t2late_7076
  s_add_u32 s60, s62, 1
  s_cmp_ge_u32 s72, s60
  s_cbranch_scc1 t2wd_7079
  s_mov_b32 s56, 0
t2w_7078:
  buffer_load_dword v18, v11, s[48:51], 0 offen sc1
  s_waitcnt vmcnt(0)
  s_nop 1
  v_min_u32_dpp v18, v18, v18 row_ror:8 row_mask:0xf bank_mask:0xf
  s_nop 1
  v_min_u32_dpp v18, v18, v18 row_ror:4 row_mask:0xf bank_mask:0xf
  s_nop 1
  v_min_u32_dpp v18, v18, v18 row_ror:2 row_mask:0xf bank_mask:0xf
  s_nop 1
  v_min_u32_dpp v18, v18, v18 row_ror:1 row_mask:0xf bank_mask:0xf
  s_nop 0
  v_readlane_b32 s72, v18, 0
  v_readlane_b32 s58, v18, 16
  s_min_u32 s72, s72, s58
  s_cmp_ge_u32 s72, s60
  s_cbranch_scc1 t2wd_7079
  s_cmp_lg_u32 s55, 0
  s_cbranch_scc1 t2wd_7079
  s_add_u32 s56, s56, 1
  s_cmp_lt_u32 s56, 0x20000
  s_cbranch_scc1 t2w_7078
  s_mov_b32 s55, 1
t2wd_7079:
  s_add_u32 s58, s73, 0x1800000
  s_add_u32 s59, s74, 0xc00000
  buffer_load_dwordx4 v[106:109], v15, s[48:51], s73 offen offset:0 sc1
  buffer_load_dwordx2 v[118:119], v16, s[48:51], s74 offen offset:0 sc1
  buffer_load_dwordx4 v[110:113], v15, s[48:51], s73 offen offset:1024 sc1
  buffer_load_dwordx2 v[120:121], v16, s[48:51], s74 offen offset:512 sc1
  buffer_load_dwordx4 v[114:117], v15, s[48:51], s73 offen offset:2048 sc1
  buffer_load_dwordx2 v[122:123], v16, s[48:51], s74 offen offset:1024 sc1
  buffer_load_dwordx4 v[124:127], v15, s[48:51], s58 offen offset:0 sc1
  buffer_load_dwordx2 v[136:137], v16, s[48:51], s59 offen offset:0 sc1
  buffer_load_dwordx4 v[128:131], v15, s[48:51], s58 offen offset:1024 sc1
  buffer_load_dwordx2 v[138:139], v16, s[48:51], s59 offen offset:512 sc1
  buffer_load_dwordx4 v[132:135], v15, s[48:51], s58 offen offset:2048 sc1
  buffer_load_dwordx2 v[140:141], v16, s[48:51], s59 offen offset:1024 sc1
t2late_7076:
  s_cmp_eq_u32 s62, 63
  s_cbranch_scc1 t2go_7077
  s_cmp_lt_u32 s62, 62
  s_cselect_b32 s58, 40960, 0
  s_add_u32 s64, s64, s58
  s_add_u32 s65, s65, s71
  ds_read_b128 v[32:35], v102 offset:0
  ds_read_b128 v[36:39], v102 offset:20480
  ds_read_b128 v[40:43], v103 offset:0
  ds_read_b128 v[44:47], v103 offset:20480
  ds_read_b128 v[48:51], v104 offset:0
  ds_read_b128 v[52:55], v104 offset:20480
  s_waitcnt lgkmcnt(4)
  v_mfma_f32_16x16x32_bf16 v[56:59], a[0:3], v[32:35], 0
  v_mfma_f32_16x16x32_bf16 v[64:67], a[80:83], v[32:35], 0
  v_mfma_f32_16x16x32_bf16 v[72:75], a[160:163], v[32:35], 0
  v_mfma_f32_16x16x32_bf16 v[60:63], a[0:3], v[36:39], 0
  v_mfma_f32_16x16x32_bf16 v[68:71], a[80:83], v[36:39], 0
  v_mfma_f32_16x16x32_bf16 v[76:79], a[160:163], v[36:39], 0
  ds_read_b128 v[32:35], v105 offset:0
  ds_read_b128 v[36:39], v105 offset:20480
  s_waitcnt lgkmcnt(4)
  v_mfma_f32_16x16x32_bf16 v[56:59], a[4:7], v[40:43], v[56:59]
  s_add_u32 m0, s65, 0
  s_nop 0
  buffer_load_dwordx4 v92, s[4:7], s64 offen lds
  v_mfma_f32_16x16x32_bf16 v[64:67], a[84:87], v[40:43], v[64:67]
  v_mfma_f32_16x16x32_bf16 v[72:75], a[164:167], v[40:43], v[72:75]
  v_mfma_f32_16x16x32_bf16 v[60:63], a[4:7], v[44:47], v[60:63]
  v_mfma_f32_16x16x32_bf16 v[68:71], a[84:87], v[44:47], v[68:71]
  v_mfma_f32_16x16x32_bf16 v[76:79], a[164:167], v[44:47], v[76:79]
  ds_read_b128 v[40:43], v102 offset:256
  ds_read_b128 v[44:47], v102 offset:20736
  s_waitcnt lgkmcnt(4)
  v_mfma_f32_16x16x32_bf16 v[56:59], a[8:11], v[48:51], v[56:59]
  v_mfma_f32_16x16x32_bf16 v[64:67], a[88:91], v[48:51], v[64:67]
  v_mfma_f32_16x16x32_bf16 v[72:75], a[168:171], v[48:51], v[72:75]
  v_mfma_f32_16x16x32_bf16 v[60:63], a[8:11], v[52:55], v[60:63]
  v_mfma_f32_16x16x32_bf16 v[68:71], a[88:91], v[52:55], v[68:71]
  s_add_u32 m0, s65, 1024
  s_nop 0
  buffer_load_dwordx4 v93, s[4:7], s64 offen lds
  v_mfma_f32_16x16x32_bf16 v[76:79], a[168:171], v[52:55], v[76:79]
  ds_read_b128 v[48:51], v103 offset:256
  ds_read_b128 v[52:55], v103 offset:20736
  s_waitcnt lgkmcnt(4)
  v_mfma_f32_16x16x32_bf16 v[56:59], a[12:15], v[32:35], v[56:59]
  v_mfma_f32_16x16x32_bf16 v[64:67], a[92:95], v[32:35], v[64:67]
  v_mfma_f32_16x16x32_bf16 v[72:75], a[172:175], v[32:35], v[72:75]
  v_mfma_f32_16x16x32_bf16 v[60:63], a[12:15], v[36:39], v[60:63]
  v_mfma_f32_16x16x32_bf16 v[68:71], a[92:95], v[36:39], v[68:71]
  v_mfma_f32_16x16x32_bf16 v[76:79], a[172:175], v[36:39], v[76:79]
  ds_read_b128 v[32:35], v104 offset:256
  ds_read_b128 v[36:39], v104 offset:20736
  s_waitcnt lgkmcnt(4)
  v_mfma_f32_16x16x32_bf16 v[56:59], a[16:19], v[40:43], v[56:59]
  v_mfma_f32_16x16x32_bf16 v[64:67], a[96:99], v[40:43], v[64:67]
  v_mfma_f32_16x16x32_bf16 v[72:75], a[176:179], v[40:43], v[72:75]
  s_add_u32 m0, s65, 2048
  s_nop 0
  buffer_load_dwordx4 v94, s[4:7], s64 offen lds
  v_mfma_f32_16x16x32_bf16 v[60:63], a[16:19], v[44:47], v[60:63]
  v_mfma_f32_16x16x32_bf16 v[68:71], a[96:99], v[44:47], v[68:71]
  v_mfma_f32_16x16x32_bf16 v[76:79], a[176:179], v[44:47], v[76:79]
  ds_read_b128 v[40:43], v105 offset:256
  ds_read_b128 v[44:47], v105 offset:20736
  s_waitcnt lgkmcnt(4)
  v_mfma_f32_16x16x32_bf16 v[56:59], a[20:23], v[48:51], v[56:59]
  v_mfma_f32_16x16x32_bf16 v[64:67], a[100:103], v[48:51], v[64:67]
  v_mfma_f32_16x16x32_bf16 v[72:75], a[180:183], v[48:51], v[72:75]
  v_mfma_f32_16x16x32_bf16 v[60:63], a[20:23], v[52:55], v[60:63]
  v_mfma_f32_16x16x32_bf16 v[68:71], a[100:103], v[52:55], v[68:71]
  v_mfma_f32_16x16x32_bf16 v[76:79], a[180:183], v[52:55], v[76:79]
  ds_read_b128 v[48:51], v102 offset:512
  ds_read_b128 v[52:55], v102 offset:20992
  s_waitcnt lgkmcnt(4)
  v_mfma_f32_16x16x32_bf16 v[56:59], a[24:27], v[32:35], v[56:59]
  s_add_u32 m0, s65, 3072
  s_nop 0
  buffer_load_dwordx4 v95, s[4:7], s64 offen lds
  v_mfma_f32_16x16x32_bf16 v[64:67], a[104:107], v[32:35], v[64:67]
  v_mfma_f32_16x16x32_bf16 v[72:75], a[184:187], v[32:35], v[72:75]
  v_mfma_f32_16x16x32_bf16 v[60:63], a[24:27], v[36:39], v[60:63]
  v_mfma_f32_16x16x32_bf16 v[68:71], a[104:107], v[36:39], v[68:71]
  v_mfma_f32_16x16x32_bf16 v[76:79], a[184:187], v[36:39], v[76:79]
  ds_read_b128 v[32:35], v103 offset:512
  ds_read_b128 v[36:39], v103 offset:20992
  s_waitcnt lgkmcnt(4)
  v_mfma_f32_16x16x32_bf16 v[56:59], a[28:31], v[40:43], v[56:59]
  v_mfma_f32_16x16x32_bf16 v[64:67], a[108:111], v[40:43], v[64:67]
  v_mfma_f32_16x16x32_bf16 v[72:75], a[188:191], v[40:43], v[72:75]
  v_mfma_f32_16x16x32_bf16 v[60:63], a[28:31], v[44:47], v[60:63]
  v_mfma_f32_16x16x32_bf16 v[68:71], a[108:111], v[44:47], v[68:71]
  s_add_u32 m0, s65, 4096
  s_nop 0
  buffer_load_dwordx4 v96, s[4:7], s64 offen lds
  v_mfma_f32_16x16x32_bf16 v[76:79], a[188:191], v[44:47], v[76:79]
  ds_read_b128 v[40:43], v104 offset:512
  ds_read_b128 v[44:47], v104 offset:20992
  s_waitcnt lgkmcnt(4)
  v_mfma_f32_16x16x32_bf16 v[56:59], a[32:35], v[48:51], v[56:59]
  v_mfma_f32_16x16x32_bf16 v[64:67], a[112:115], v[48:51], v[64:67]
  v_mfma_f32_16x16x32_bf16 v[72:75], a[192:195], v[48:51], v[72:75]
  v_mfma_f32_16x16x32_bf16 v[60:63], a[32:35], v[52:55], v[60:63]
  v_mfma_f32_16x16x32_bf16 v[68:71], a[112:115], v[52:55], v[68:71]
  v_mfma_f32_16x16x32_bf16 v[76:79], a[192:195], v[52:55], v[76:79]
  ds_read_b128 v[48:51], v105 offset:512
  ds_read_b128 v[52:55], v105 offset:20992
  s_waitcnt lgkmcnt(4)
  v_mfma_f32_16x16x32_bf16 v[56:59], a[36:39], v[32:35], v[56:59]
  v_mfma_f32_16x16x32_bf16 v[64:67], a[116:119], v[32:35], v[64:67]
  v_mfma_f32_16x16x32_bf16 v[72:75], a[196:199], v[32:35], v[72:75]
  s_add_u32 m0, s65, 5120
  s_nop 0
  buffer_load_dwordx4 v97, s[4:7], s64 offen lds
  v_mfma_f32_16x16x32_bf16 v[60:63], a[36:39], v[36:39], v[60:63]
  v_mfma_f32_16x16x32_bf16 v[68:71], a[116:119], v[36:39], v[68:71]
  v_mfma_f32_16x16x32_bf16 v[76:79], a[196:199], v[36:39], v[76:79]
  ds_read_b128 v[32:35], v102 offset:768
  ds_read_b128 v[36:39], v102 offset:21248
  s_waitcnt lgkmcnt(4)
  v_mfma_f32_16x16x32_bf16 v[56:59], a[40:43], v[40:43], v[56:59]
  v_mfma_f32_16x16x32_bf16 v[64:67], a[120:123], v[40:43], v[64:67]
  v_mfma_f32_16x16x32_bf16 v[72:75], a[200:203], v[40:43], v[72:75]
  v_mfma_f32_16x16x32_bf16 v[60:63], a[40:43], v[44:47], v[60:63]
  v_mfma_f32_16x16x32_bf16 v[68:71], a[120:123], v[44:47], v[68:71]
  v_mfma_f32_16x16x32_bf16 v[76:79], a[200:203], v[44:47], v[76:79]
  ds_read_b128 v[40:43], v103 offset:768
  ds_read_b128 v[44:47], v103 offset:21248
  s_waitcnt lgkmcnt(4)
  v_mfma_f32_16x16x32_bf16 v[56:59], a[44:47], v[48:51], v[56:59]
  s_add_u32 m0, s65, 6144
  s_nop 0
  buffer_load_dwordx4 v98, s[4:7], s64 offen lds
  v_mfma_f32_16x16x32_bf16 v[64:67], a[124:127], v[48:51], v[64:67]
  v_mfma_f32_16x16x32_bf16 v[72:75], a[204:207], v[48:51], v[72:75]
  v_mfma_f32_16x16x32_bf16 v[60:63], a[44:47], v[52:55], v[60:63]
  v_mfma_f32_16x16x32_bf16 v[68:71], a[124:127], v[52:55], v[68:71]
  v_mfma_f32_16x16x32_bf16 v[76:79], a[204:207], v[52:55], v[76:79]
  ds_read_b128 v[48:51], v104 offset:768
  ds_read_b128 v[52:55], v104 offset:21248
  s_waitcnt lgkmcnt(4)
  v_mfma_f32_16x16x32_bf16 v[56:59], a[48:51], v[32:35], v[56:59]
  v_mfma_f32_16x16x32_bf16 v[64:67], a[128:131], v[32:35], v[64:67]
  v_mfma_f32_16x16x32_bf16 v[72:75], a[208:211], v[32:35], v[72:75]
  v_mfma_f32_16x16x32_bf16 v[60:63], a[48:51], v[36:39], v[60:63]
  v_mfma_f32_16x16x32_bf16 v[68:71], a[128:131], v[36:39], v[68:71]
  s_add_u32 m0, s65, 7168
  s_nop 0
  buffer_load_dwordx4 v99, s[4:7], s64 offen lds
  v_mfma_f32_16x16x32_bf16 v[76:79], a[208:211], v[36:39], v[76:79]
  ds_read_b128 v[32:35], v105 offset:768
  ds_read_b128 v[36:39], v105 offset:21248
  s_waitcnt lgkmcnt(4)
  v_mfma_f32_16x16x32_bf16 v[56:59], a[52:55], v[40:43], v[56:59]
  v_mfma_f32_16x16x32_bf16 v[64:67], a[132:135], v[40:43], v[64:67]
  v_mfma_f32_16x16x32_bf16 v[72:75], a[212:215], v[40:43], v[72:75]
  v_mfma_f32_16x16x32_bf16 v[60:63], a[52:55], v[44:47], v[60:63]
  v_mfma_f32_16x16x32_bf16 v[68:71], a[132:135], v[44:47], v[68:71]
  v_mfma_f32_16x16x32_bf16 v[76:79], a[212:215], v[44:47], v[76:79]
  ds_read_b128 v[40:43], v102 offset:1024
  ds_read_b128 v[44:47], v102 offset:21504
  s_waitcnt lgkmcnt(4)
  v_mfma_f32_16x16x32_bf16 v[56:59], a[56:59], v[48:51], v[56:59]
  v_mfma_f32_16x16x32_bf16 v[64:67], a[136:139], v[48:51], v[64:67]
  v_mfma_f32_16x16x32_bf16 v[72:75], a[216:219], v[48:51], v[72:75]
  s_add_u32 m0, s65, 8192
  s_nop 0
  buffer_load_dwordx4 v100, s[4:7], s64 offen lds
  v_mfma_f32_16x16x32_bf16 v[60:63], a[56:59], v[52:55], v[60:63]
  v_mfma_f32_16x16x32_bf16 v[68:71], a[136:139], v[52:55], v[68:71]
  v_mfma_f32_16x16x32_bf16 v[76:79], a[216:219], v[52:55], v[76:79]
  ds_read_b128 v[48:51], v103 offset:1024
  ds_read_b128 v[52:55], v103 offset:21504
  s_waitcnt lgkmcnt(4)
  v_mfma_f32_16x16x32_bf16 v[56:59], a[60:63], v[32:35], v[56:59]
  v_mfma_f32_16x16x32_bf16 v[64:67], a[140:143], v[32:35], v[64:67]
  v_mfma_f32_16x16x32_bf16 v[72:75], a[220:223], v[32:35], v[72:75]
  v_mfma_f32_16x16x32_bf16 v[60:63], a[60:63], v[36:39], v[60:63]
  v_mfma_f32_16x16x32_bf16 v[68:71], a[140:143], v[36:39], v[68:71]
  v_mfma_f32_16x16x32_bf16 v[76:79], a[220:223], v[36:39], v[76:79]
  ds_read_b128 v[32:35], v104 offset:1024
  ds_read_b128 v[36:39], v104 offset:21504
  s_waitcnt lgkmcnt(4)
  v_mfma_f32_16x16x32_bf16 v[56:59], a[64:67], v[40:43], v[56:59]
  s_add_u32 m0, s65, 9216
  s_nop 0
  buffer_load_dwordx4 v101, s[4:7], s64 offen lds
  v_mfma_f32_16x16x32_bf16 v[64:67], a[144:147], v[40:43], v[64:67]
  v_mfma_f32_16x16x32_bf16 v[72:75], a[224:227], v[40:43], v[72:75]
  v_mfma_f32_16x16x32_bf16 v[60:63], a[64:67], v[44:47], v[60:63]
  v_mfma_f32_16x16x32_bf16 v[68:71], a[144:147], v[44:47], v[68:71]
  v_mfma_f32_16x16x32_bf16 v[76:79], a[224:227], v[44:47], v[76:79]
  ds_read_b128 v[40:43], v105 offset:1024
  ds_read_b128 v[44:47], v105 offset:21504
  s_waitcnt lgkmcnt(4)
  v_mfma_f32_16x16x32_bf16 v[56:59], a[68:71], v[48:51], v[56:59]
  v_mfma_f32_16x16x32_bf16 v[64:67], a[148:151], v[48:51], v[64:67]
  v_mfma_f32_16x16x32_bf16 v[72:75], a[228:231], v[48:51], v[72:75]
  v_mfma_f32_16x16x32_bf16 v[60:63], a[68:71], v[52:55], v[60:63]
  v_mfma_f32_16x16x32_bf16 v[68:71], a[148:151], v[52:55], v[68:71]
  v_mfma_f32_16x16x32_bf16 v[76:79], a[228:231], v[52:55], v[76:79]
  s_waitcnt lgkmcnt(2)
  v_mfma_f32_16x16x32_bf16 v[56:59], a[72:75], v[32:35], v[56:59]
  v_mfma_f32_16x16x32_bf16 v[64:67], a[152:155], v[32:35], v[64:67]
  v_mfma_f32_16x16x32_bf16 v[72:75], a[232:235], v[32:35], v[72:75]
  v_mfma_f32_16x16x32_bf16 v[60:63], a[72:75], v[36:39], v[60:63]
  v_mfma_f32_16x16x32_bf16 v[68:71], a[152:155], v[36:39], v[68:71]
  v_mfma_f32_16x16x32_bf16 v[76:79], a[232:235], v[36:39], v[76:79]
  s_waitcnt lgkmcnt(0)
  v_mfma_f32_16x16x32_bf16 v[56:59], a[76:79], v[40:43], v[56:59]
  v_mfma_f32_16x16x32_bf16 v[64:67], a[156:159], v[40:43], v[64:67]
  v_mfma_f32_16x16x32_bf16 v[72:75], a[236:239], v[40:43], v[72:75]
  v_mfma_f32_16x16x32_bf16 v[60:63], a[76:79], v[44:47], v[60:63]
  v_mfma_f32_16x16x32_bf16 v[68:71], a[156:159], v[44:47], v[68:71]
  v_mfma_f32_16x16x32_bf16 v[76:79], a[236:239], v[44:47], v[76:79]
  v_add_u32 v102, s71, v102
  v_add_u32 v103, s71, v103
  v_add_u32 v104, s71, v104
  v_add_u32 v105, s71, v105
  s_sub_u32 s71, 0, s71
  s_cmp_lg_u32 s62, 62
  s_cbranch_scc1 t2go_7077
  s_add_u32 s60, s62, 1
  s_cmp_ge_u32 s72, s60
  s_cbranch_scc1 t2wd_7081
  s_mov_b32 s56, 0
t2w_7080:
  buffer_load_dword v18, v11, s[48:51], 0 offen sc1
  s_waitcnt vmcnt(0)
  s_nop 1
  v_min_u32_dpp v18, v18, v18 row_ror:8 row_mask:0xf bank_mask:0xf
  s_nop 1
  v_min_u32_dpp v18, v18, v18 row_ror:4 row_mask:0xf bank_mask:0xf
  s_nop 1
  v_min_u32_dpp v18, v18, v18 row_ror:2 row_mask:0xf bank_mask:0xf
  s_nop 1
  v_min_u32_dpp v18, v18, v18 row_ror:1 row_mask:0xf bank_mask:0xf
  s_nop 0
  v_readlane_b32 s72, v18, 0
  v_readlane_b32 s58, v18, 16
  s_min_u32 s72, s72, s58
  s_cmp_ge_u32 s72, s60
  s_cbranch_scc1 t2wd_7081
  s_cmp_lg_u32 s55, 0
  s_cbranch_scc1 t2wd_7081
  s_add_u32 s56, s56, 1
  s_cmp_lt_u32 s56, 0x20000
  s_cbranch_scc1 t2w_7080
  s_mov_b32 s55, 1
t2wd_7081:
  s_add_u32 s58, s73, 0x1800000
  s_add_u32 s59, s74, 0xc00000
  buffer_load_dwordx4 v[106:109], v15, s[48:51], s73 offen offset:0 sc1
  buffer_load_dwordx2 v[118:119], v16, s[48:51], s74 offen offset:0 sc1
  buffer_load_dwordx4 v[110:113], v15, s[48:51], s73 offen offset:1024 sc1
  buffer_load_dwordx2 v[120:121], v16, s[48:51], s74 offen offset:512 sc1
  buffer_load_dwordx4 v[114:117], v15, s[48:51], s73 offen offset:2048 sc1
  buffer_load_dwordx2 v[122:123], v16, s[48:51], s74 offen offset:1024 sc1
  buffer_load_dwordx4 v[124:127], v15, s[48:51], s58 offen offset:0 sc1
  buffer_load_dwordx2 v[136:137], v16, s[48:51], s59 offen offset:0 sc1
  buffer_load_dwordx4 v[128:131], v15, s[48:51], s58 offen offset:1024 sc1
  buffer_load_dwordx2 v[138:139], v16, s[48:51], s59 offen offset:512 sc1
  buffer_load_dwordx4 v[132:135], v15, s[48:51], s58 offen offset:2048 sc1
  buffer_load_dwordx2 v[140:141], v16, s[48:51], s59 offen offset:1024 sc1
t2go_7077:
  s_waitcnt vmcnt(0)
  v_mfma_f32_16x16x16_bf16 v[144:147], v[118:119], v[80:81], 0
  v_mfma_f32_16x16x16_bf16 v[148:151], v[106:107], v[80:81], 0
  v_mfma_f32_16x16x16_bf16 v[152:155], v[118:119], v[82:83], 0
  v_mfma_f32_16x16x16_bf16 v[156:159], v[106:107], v[82:83], 0
  v_mfma_f32_16x16x16_bf16 v[160:163], v[108:109], v[82:83], 0
  v_mfma_f32_16x16x16_bf16 v[144:147], v[120:121], v[84:85], v[144:147]
  v_mfma_f32_16x16x16_bf16 v[148:151], v[110:111], v[84:85], v[148:151]
  v_mfma_f32_16x16x16_bf16 v[152:155], v[120:121], v[86:87], v[152:155]
  v_mfma_f32_16x16x16_bf16 v[156:159], v[110:111], v[86:87], v[156:159]
  v_mfma_f32_16x16x16_bf16 v[160:163], v[112:113], v[86:87], v[160:163]
  v_mfma_f32_16x16x16_bf16 v[144:147], v[122:123], v[88:89], v[144:147]
  v_mfma_f32_16x16x16_bf16 v[148:151], v[114:115], v[88:89], v[148:151]
  v_mfma_f32_16x16x16_bf16 v[152:155], v[122:123], v[90:91], v[152:155]
  v_mfma_f32_16x16x16_bf16 v[156:159], v[114:115], v[90:91], v[156:159]
  v_mfma_f32_16x16x16_bf16 v[160:163], v[116:117], v[90:91], v[160:163]
  s_nop 3
  ds_write_b128 v22, v[144:147] offset:0
  ds_write_b128 v22, v[148:151] offset:4096
  ds_write_b128 v22, v[152:155] offset:8192
  ds_write_b128 v22, v[156:159] offset:12288
  ds_write_b128 v22, v[160:163] offset:16384
  s_waitcnt lgkmcnt(0)
  s_barrier
  v_cvt_pk_bf16_f32 v80, v56, v57
  v_cvt_pk_bf16_f32 v81, v58, v59
  v_cvt_pk_bf16_f32 v82, v60, v61
  v_cvt_pk_bf16_f32 v83, v62, v63
  v_cvt_pk_bf16_f32 v84, v64, v65
  v_cvt_pk_bf16_f32 v85, v66, v67
  v_cvt_pk_bf16_f32 v86, v68, v69
  v_cvt_pk_bf16_f32 v87, v70, v71
  v_cvt_pk_bf16_f32 v88, v72, v73
  v_cvt_pk_bf16_f32 v89, v74, v75
  v_cvt_pk_bf16_f32 v90, v76, v77
  v_cvt_pk_bf16_f32 v91, v78, v79
  ds_read_b128 v[144:147], v23 offset:0
  ds_read_b128 v[148:151], v23 offset:1024
  ds_read_b128 v[152:155], v23 offset:2048
  ds_read_b128 v[156:159], v23 offset:3072
  ds_read_b128 v[160:163], v23 offset:4096
  ds_read_b128 v[164:167], v23 offset:5120
  ds_read_b128 v[168:171], v23 offset:6144
  ds_read_b128 v[172:175], v23 offset:7168
  ds_read_b128 v[176:179], v23 offset:8192
  ds_read_b128 v[180:183], v23 offset:9216
  ds_read_b128 v[184:187], v23 offset:10240
  ds_read_b128 v[188:191], v23 offset:11264
  s_waitcnt lgkmcnt(8)
  ds_read_b128 v[192:195], v23 offset:12288
  ds_read_b128 v[196:199], v23 offset:13312
  ds_read_b128 v[200:203], v23 offset:14336
  ds_read_b128 v[204:207], v23 offset:15360
  v_add_f32 v144, v144, v148
  v_add_f32 v152, v152, v156
  v_add_f32 v145, v145, v149
  v_add_f32 v153, v153, v157
  v_add_f32 v146, v146, v150
  v_add_f32 v154, v154, v158
  v_add_f32 v147, v147, v151
  v_add_f32 v155, v155, v159
  v_add_f32 v144, v144, v152
  v_add_f32 v145, v145, v153
  v_add_f32 v146, v146, v154
  v_add_f32 v147, v147, v155
  v_add_f32 v144, v144, v10
  v_add_f32 v145, v145, v10
  v_add_f32 v146, v146, v10
  v_add_f32 v147, v147, v10
  s_waitcnt lgkmcnt(8)
  ds_read_b128 v[208:211], v23 offset:16384
  ds_read_b128 v[212:215], v23 offset:17408
  ds_read_b128 v[216:219], v23 offset:18432
  ds_read_b128 v[220:223], v23 offset:19456
  v_add_f32 v160, v160, v164
  v_add_f32 v168, v168, v172
  v_add_f32 v161, v161, v165
  v_add_f32 v169, v169, v173
  v_add_f32 v162, v162, v166
  v_add_f32 v170, v170, v174
  v_add_f32 v163, v163, v167
  v_add_f32 v171, v171, v175
  v_add_f32 v160, v160, v168
  v_add_f32 v161, v161, v169
  v_add_f32 v162, v162, v170
  v_add_f32 v163, v163, v171
  v_add_f32 v160, v160, v6
  v_add_f32 v161, v161, v7
  v_add_f32 v162, v162, v8
  v_add_f32 v163, v163, v9
  s_waitcnt lgkmcnt(8)
  v_add_f32 v176, v176, v180
  v_add_f32 v184, v184, v188
  v_add_f32 v177, v177, v181
  v_add_f32 v185, v185, v189
  v_add_f32 v178, v178, v182
  v_add_f32 v186, v186, v190
  v_add_f32 v179, v179, v183
  v_add_f32 v187, v187, v191
  v_add_f32 v176, v176, v184
  v_add_f32 v177, v177, v185
  v_add_f32 v178, v178, v186
  v_add_f32 v179, v179, v187
  v_add_f32 v176, v176, v10
  v_add_f32 v177, v177, v10
  v_add_f32 v178, v178, v10
  v_add_f32 v179, v179, v10
  s_waitcnt lgkmcnt(4)
  v_add_f32 v192, v192, v196
  v_add_f32 v200, v200, v204
  v_add_f32 v193, v193, v197
  v_add_f32 v201, v201, v205
  v_add_f32 v194, v194, v198
  v_add_f32 v202, v202, v206
  v_add_f32 v195, v195, v199
  v_add_f32 v203, v203, v207
  v_add_f32 v192, v192, v200
  v_add_f32 v193, v193, v201
  v_add_f32 v194, v194, v202
  v_add_f32 v195, v195, v203
  s_waitcnt lgkmcnt(0)
  v_add_f32 v208, v208, v212
  v_add_f32 v216, v216, v220
  v_add_f32 v209, v209, v213
  v_add_f32 v217, v217, v221
  v_add_f32 v210, v210, v214
  v_add_f32 v218, v218, v222
  v_add_f32 v211, v211, v215
  v_add_f32 v219, v219, v223
  v_add_f32 v208, v208, v216
  v_add_f32 v209, v209, v217
  v_add_f32 v210, v210, v218
  v_add_f32 v211, v211, v219
  v_add_f32 v208, v208, v6
  v_add_f32 v209, v209, v7
  v_add_f32 v210, v210, v8
  v_add_f32 v211, v211, v9
  v_max3_f32 v18, v144, v145, v146
  v_max3_f32 v19, v176, v177, v178
  v_max3_f32 v18, v18, v147, v160
  v_max3_f32 v19, v19, v179, v192
  v_max3_f32 v18, v18, v161, v162
  v_max3_f32 v19, v19, v193, v194
  v_max_f32 v18, v18, v163
  v_max3_f32 v19, v19, v195, v208
  v_max3_f32 v19, v19, v209, v210
  v_max_f32 v19, v19, v211
  v_mov_b32 v20, v18
  s_nop 1
  v_permlane16_swap_b32 v18, v20
  s_nop 0
  v_max_f32 v18, v18, v20
  v_mov_b32 v20, v18
  s_nop 1
  v_permlane32_swap_b32 v18, v20
  s_nop 0
  v_max_f32 v18, v18, v20
  v_mov_b32 v20, v19
  s_nop 1
  v_permlane16_swap_b32 v19, v20
  s_nop 0
  v_max_f32 v19, v19, v20
  v_mov_b32 v20, v19
  s_nop 1
  v_permlane32_swap_b32 v19, v20
  s_nop 0
  v_max_f32 v19, v19, v20
  v_mul_f32 v18, s77, v18
  v_mul_f32 v19, s77, v19
  v_fma_f32 v144, v144, s77, -v18
  v_fma_f32 v145, v145, s77, -v18
  v_fma_f32 v146, v146, s77, -v18
  v_fma_f32 v147, v147, s77, -v18
  v_fma_f32 v160, v160, s77, -v18
  v_fma_f32 v161, v161, s77, -v18
  v_fma_f32 v162, v162, s77, -v18
  v_fma_f32 v163, v163, s77, -v18
  v_fma_f32 v176, v176, s77, -v19
  v_fma_f32 v177, v177, s77, -v19
  v_fma_f32 v178, v178, s77, -v19
  v_fma_f32 v179, v179, s77, -v19
  v_fma_f32 v192, v192, s77, -v19
  v_fma_f32 v193, v193, s77, -v19
  v_fma_f32 v194, v194, s77, -v19
  v_fma_f32 v195, v195, s77, -v19
  v_fma_f32 v208, v208, s77, -v19
  v_fma_f32 v209, v209, s77, -v19
  v_fma_f32 v210, v210, s77, -v19
  v_fma_f32 v211, v211, s77, -v19
  v_exp_f32 v144, v144
  v_exp_f32 v145, v145
  v_exp_f32 v146, v146
  v_exp_f32 v147, v147
  v_exp_f32 v160, v160
  v_exp_f32 v161, v161
  v_exp_f32 v162, v162
  v_exp_f32 v163, v163
  v_exp_f32 v176, v176
  v_exp_f32 v177, v177
  v_exp_f32 v178, v178
  v_exp_f32 v179, v179
  v_exp_f32 v192, v192
  v_exp_f32 v193, v193
  v_exp_f32 v194, v194
  v_exp_f32 v195, v195
  v_exp_f32 v208, v208
  v_exp_f32 v209, v209
  v_exp_f32 v210, v210
  v_exp_f32 v211, v211
  s_nop 0
  v_cvt_pk_bf16_f32 v150, v144, v145
  v_cvt_pk_bf16_f32 v151, v146, v147
  v_cvt_pk_bf16_f32 v148, v160, v161
  v_cvt_pk_bf16_f32 v149, v162, v163
  v_cvt_pk_bf16_f32 v156, v176, v177
  v_cvt_pk_bf16_f32 v157, v178, v179
  v_cvt_pk_bf16_f32 v152, v192, v193
  v_cvt_pk_bf16_f32 v153, v194, v195
  v_cvt_pk_bf16_f32 v154, v208, v209
  v_cvt_pk_bf16_f32 v155, v210, v211
  s_nop 1
  v_mfma_f32_16x16x16_bf16 v[248:251], v[2:3], v[148:149], 0
  v_mfma_f32_16x16x32_bf16 v[252:255], v[2:5], v[152:155], 0
  v_mfma_f32_16x16x16_bf16 v[224:227], v[124:125], v[148:149], 0
  v_mfma_f32_16x16x32_bf16 v[228:231], v[124:127], v[152:155], 0
  v_mfma_f32_16x16x16_bf16 v[232:235], v[128:129], v[148:149], 0
  v_mfma_f32_16x16x32_bf16 v[236:239], v[128:131], v[152:155], 0
  v_mfma_f32_16x16x16_bf16 v[240:243], v[132:133], v[148:149], 0
  v_mfma_f32_16x16x32_bf16 v[244:247], v[132:135], v[152:155], 0
  v_mfma_f32_16x16x16_bf16 v[248:251], v[2:3], v[150:151], v[248:251]
  v_mfma_f32_16x16x16_bf16 v[252:255], v[2:3], v[156:157], v[252:255]
  v_mfma_f32_16x16x16_bf16 v[224:227], v[136:137], v[150:151], v[224:227]
  v_mfma_f32_16x16x16_bf16 v[228:231], v[136:137], v[156:157], v[228:231]
  v_mfma_f32_16x16x16_bf16 v[232:235], v[138:139], v[150:151], v[232:235]
  v_mfma_f32_16x16x16_bf16 v[236:239], v[138:139], v[156:157], v[236:239]
  v_mfma_f32_16x16x16_bf16 v[240:243], v[140:141], v[150:151], v[240:243]
  v_mfma_f32_16x16x16_bf16 v[244:247], v[140:141], v[156:157], v[244:247]
  s_nop 1
  v_rcp_f32 v18, v248
  v_rcp_f32 v19, v252
  s_nop 1
  v_mul_f32 v224, v224, v18
  v_mul_f32 v225, v225, v18
  v_mul_f32 v226, v226, v18
  v_mul_f32 v227, v227, v18
  v_cvt_pk_bf16_f32 v224, v224, v225
  v_cvt_pk_bf16_f32 v225, v226, v227
  buffer_store_dwordx2 v[224:225], v12, s[48:51], s75 offen offset:0
  v_mul_f32 v228, v228, v19
  v_mul_f32 v229, v229, v19
  v_mul_f32 v230, v230, v19
  v_mul_f32 v231, v231, v19
  v_cvt_pk_bf16_f32 v228, v228, v229
  v_cvt_pk_bf16_f32 v229, v230, v231
  buffer_store_dwordx2 v[228:229], v12, s[48:51], s75 offen offset:1024
  v_mul_f32 v232, v232, v18
  v_mul_f32 v233, v233, v18
  v_mul_f32 v234, v234, v18
  v_mul_f32 v235, v235, v18
  v_cvt_pk_bf16_f32 v232, v232, v233
  v_cvt_pk_bf16_f32 v233, v234, v235
  buffer_store_dwordx2 v[232:233], v13, s[48:51], s75 offen offset:0
  v_mul_f32 v236, v236, v19
  v_mul_f32 v237, v237, v19
  v_mul_f32 v238, v238, v19
  v_mul_f32 v239, v239, v19
  v_cvt_pk_bf16_f32 v236, v236, v237
  v_cvt_pk_bf16_f32 v237, v238, v239
  buffer_store_dwordx2 v[236:237], v13, s[48:51], s75 offen offset:1024
  v_mul_f32 v240, v240, v18
  v_mul_f32 v241, v241, v18
  v_mul_f32 v242, v242, v18
  v_mul_f32 v243, v243, v18
  v_cvt_pk_bf16_f32 v240, v240, v241
  v_cvt_pk_bf16_f32 v241, v242, v243
  buffer_store_dwordx2 v[240:241], v14, s[48:51], s75 offen offset:0
  v_mul_f32 v244, v244, v19
  v_mul_f32 v245, v245, v19
  v_mul_f32 v246, v246, v19
  v_mul_f32 v247, v247, v19
  v_cvt_pk_bf16_f32 v244, v244, v245
  v_cvt_pk_bf16_f32 v245, v246, v247
  buffer_store_dwordx2 v[244:245], v14, s[48:51], s75 offen offset:1024
  s_waitcnt vmcnt(0)
  s_barrier
  s_cmp_lg_u32 s52, 0
  s_cbranch_scc1 t2f_7082
  s_add_u32 s58, s62, 1
  v_mov_b32 v18, s58
  s_mov_b64 exec, 1
  buffer_store_dword v18, v17, s[48:51], 0 offen
  s_mov_b64 exec, -1
t2f_7082:
  s_add_u32 s73, s73, 393216
  s_add_u32 s74, s74, 196608
  s_add_u32 s75, s75, 393216
  s_add_u32 s62, s62, 1
  s_cmp_lt_u32 s62, 64
  s_cbranch_scc1 L_t2_r
  s_waitcnt vmcnt(0)
  s_endpgm
L_t3role_r:
  s_sub_u32 s62, s54, 24
  v_mov_b32 v18, v0
  v_mul_u32_u24 v19, 6554, v18
  v_lshrrev_b32 v19, 16, v19
  v_mul_u32_u24 v20, 10, v19
  v_sub_u32 v18, v18, v20
  v_mul_u32_u24 v19, 1280, v19
  v_lshlrev_b32 v18, 4, v18
  v_add_u32 v2, v18, v19
  v_add_u32 v18, 256, v0
  v_mul_u32_u24 v19, 6554, v18
  v_lshrrev_b32 v19, 16, v19
  v_mul_u32_u24 v20, 10, v19
  v_sub_u32 v18, v18, v20
  v_mul_u32_u24 v19, 1280, v19
  v_lshlrev_b32 v18, 4, v18
  v_add_u32 v3, v18, v19
  v_add_u32 v18, 512, v0
  v_mul_u32_u24 v19, 6554, v18
  v_lshrrev_b32 v19, 16, v19
  v_mul_u32_u24 v20, 10, v19
  v_sub_u32 v18, v18, v20
  v_mul_u32_u24 v19, 1280, v19
  v_lshlrev_b32 v18, 4, v18
  v_add_u32 v4, v18, v19
  v_add_u32 v18, 768, v0
  v_mul_u32_u24 v19, 6554, v18
  v_lshrrev_b32 v19, 16, v19
  v_mul_u32_u24 v20, 10, v19
  v_sub_u32 v18, v18, v20
  v_mul_u32_u24 v19, 1280, v19
  v_lshlrev_b32 v18, 4, v18
  v_add_u32 v5, v18, v19
  v_add_u32 v18, 1024, v0
  v_mul_u32_u24 v19, 6554, v18
  v_lshrrev_b32 v19, 16, v19
  v_mul_u32_u24 v20, 10, v19
  v_sub_u32 v18, v18, v20
  v_mul_u32_u24 v19, 1280, v19
  v_lshlrev_b32 v18, 4, v18
  v_add_u32 v6, v18, v19
  v_add_u32 v18, 1280, v0
  v_mul_u32_u24 v19, 6554, v18
  v_lshrrev_b32 v19, 16, v19
  v_mul_u32_u24 v20, 10, v19
  v_sub_u32 v18, v18, v20
  v_mul_u32_u24 v19, 1280, v19
  v_lshlrev_b32 v18, 4, v18
  v_add_u32 v7, v18, v19
  v_add_u32 v18, 1536, v0
  v_mul_u32_u24 v19, 6554, v18
  v_lshrrev_b32 v19, 16, v19
  v_mul_u32_u24 v20, 10, v19
  v_sub_u32 v18, v18, v20
  v_mul_u32_u24 v19, 1280, v19
  v_lshlrev_b32 v18, 4, v18
  v_add_u32 v8, v18, v19
  v_add_u32 v18, 1792, v0
  v_mul_u32_u24 v19, 6554, v18
  v_lshrrev_b32 v19, 16, v19
  v_mul_u32_u24 v20, 10, v19
  v_sub_u32 v18, v18, v20
  v_mul_u32_u24 v19, 1280, v19
  v_lshlrev_b32 v18, 4, v18
  v_add_u32 v9, v18, v19
  v_add_u32 v18, 2048, v0
  v_mul_u32_u24 v19, 6554, v18
  v_lshrrev_b32 v19, 16, v19
  v_mul_u32_u24 v20, 10, v19
  v_sub_u32 v18, v18, v20
  v_mul_u32_u24 v19, 1280, v19
  v_lshlrev_b32 v18, 4, v18
  v_add_u32 v10, v18, v19
  v_add_u32 v18, 2304, v0
  v_mul_u32_u24 v19, 6554, v18
  v_lshrrev_b32 v19, 16, v19
  v_mul_u32_u24 v20, 10, v19
  v_sub_u32 v18, v18, v20
  v_mul_u32_u24 v19, 1280, v19
  v_lshlrev_b32 v18, 4, v18
  v_add_u32 v11, v18, v19
  v_add_u32 v18, 2560, v0
  v_mul_u32_u24 v19, 6554, v18
  v_lshrrev_b32 v19, 16, v19
  v_mul_u32_u24 v20, 10, v19
  v_sub_u32 v18, v18, v20
  v_mul_u32_u24 v19, 1280, v19
  v_lshlrev_b32 v18, 4, v18
  v_add_u32 v12, v18, v19
  v_add_u32 v18, 2816, v0
  v_mul_u32_u24 v19, 6554, v18
  v_lshrrev_b32 v19, 16, v19
  v_mul_u32_u24 v20, 10, v19
  v_sub_u32 v18, v18, v20
  v_mul_u32_u24 v19, 1280, v19
  v_lshlrev_b32 v18, 4, v18
  v_add_u32 v13, v18, v19
  v_add_u32 v18, 3072, v0
  v_mul_u32_u24 v19, 6554, v18
  v_lshrrev_b32 v19, 16, v19
  v_mul_u32_u24 v20, 10, v19
  v_sub_u32 v18, v18, v20
  v_mul_u32_u24 v19, 1280, v19
  v_lshlrev_b32 v18, 4, v18
  v_add_u32 v14, v18, v19
  v_add_u32 v18, 3328, v0
  v_mul_u32_u24 v19, 6554, v18
  v_lshrrev_b32 v19, 16, v19
  v_mul_u32_u24 v20, 10, v19
  v_sub_u32 v18, v18, v20
  v_mul_u32_u24 v19, 1280, v19
  v_lshlrev_b32 v18, 4, v18
  v_add_u32 v15, v18, v19
  v_add_u32 v18, 3584, v0
  v_mul_u32_u24 v19, 6554, v18
  v_lshrrev_b32 v19, 16, v19
  v_mul_u32_u24 v20, 10, v19
  v_sub_u32 v18, v18, v20
  v_mul_u32_u24 v19, 1280, v19
  v_lshlrev_b32 v18, 4, v18
  v_add_u32 v16, v18, v19
  s_mul_i32 s63, s53, 1966080
  s_mul_i32 s58, s62, 160
  s_add_u32 s63, s63, s58
  s_lshl_b32 s60, s52, 10
  s_add_u32 s60, s60, 0x0
  s_add_u32 m0, s60, 0
  s_nop 0
  buffer_load_dwordx4 v2, s[24:27], s63 offen lds
  s_add_u32 m0, s60, 4096
  s_nop 0
  buffer_load_dwordx4 v3, s[24:27], s63 offen lds
  s_add_u32 m0, s60, 8192
  s_nop 0
  buffer_load_dwordx4 v4, s[24:27], s63 offen lds
  s_add_u32 m0, s60, 12288
  s_nop 0
  buffer_load_dwordx4 v5, s[24:27], s63 offen lds
  s_add_u32 m0, s60, 16384
  s_nop 0
  buffer_load_dwordx4 v6, s[24:27], s63 offen lds
  s_add_u32 m0, s60, 20480
  s_nop 0
  buffer_load_dwordx4 v7, s[24:27], s63 offen lds
  s_add_u32 m0, s60, 24576
  s_nop 0
  buffer_load_dwordx4 v8, s[24:27], s63 offen lds
  s_add_u32 m0, s60, 28672
  s_nop 0
  buffer_load_dwordx4 v9, s[24:27], s63 offen lds
  s_add_u32 m0, s60, 32768
  s_nop 0
  buffer_load_dwordx4 v10, s[24:27], s63 offen lds
  s_add_u32 m0, s60, 36864
  s_nop 0
  buffer_load_dwordx4 v11, s[24:27], s63 offen lds
  s_add_u32 m0, s60, 40960
  s_nop 0
  buffer_load_dwordx4 v12, s[24:27], s63 offen lds
  s_add_u32 m0, s60, 45056
  s_nop 0
  buffer_load_dwordx4 v13, s[24:27], s63 offen lds
  s_add_u32 m0, s60, 49152
  s_nop 0
  buffer_load_dwordx4 v14, s[24:27], s63 offen lds
  s_add_u32 m0, s60, 53248
  s_nop 0
  buffer_load_dwordx4 v15, s[24:27], s63 offen lds
  s_add_u32 m0, s60, 57344
  s_nop 0
  buffer_load_dwordx4 v16, s[24:27], s63 offen lds
  s_add_u32 s63, s63, 491520
  s_lshl_b32 s60, s52, 10
  s_add_u32 s60, s60, 0xf000
  s_add_u32 m0, s60, 0
  s_nop 0
  buffer_load_dwordx4 v2, s[24:27], s63 offen lds
  s_add_u32 m0, s60, 4096
  s_nop 0
  buffer_load_dwordx4 v3, s[24:27], s63 offen lds
  s_add_u32 m0, s60, 8192
  s_nop 0
  buffer_load_dwordx4 v4, s[24:27], s63 offen lds
  s_add_u32 m0, s60, 12288
  s_nop 0
  buffer_load_dwordx4 v5, s[24:27], s63 offen lds
  s_add_u32 m0, s60, 16384
  s_nop 0
  buffer_load_dwordx4 v6, s[24:27], s63 offen lds
  s_add_u32 m0, s60, 20480
  s_nop 0
  buffer_load_dwordx4 v7, s[24:27], s63 offen lds
  s_add_u32 m0, s60, 24576
  s_nop 0
  buffer_load_dwordx4 v8, s[24:27], s63 offen lds
  s_add_u32 m0, s60, 28672
  s_nop 0
  buffer_load_dwordx4 v9, s[24:27], s63 offen lds
  s_add_u32 m0, s60, 32768
  s_nop 0
  buffer_load_dwordx4 v10, s[24:27], s63 offen lds
  s_add_u32 m0, s60, 36864
  s_nop 0
  buffer_load_dwordx4 v11, s[24:27], s63 offen lds
  s_add_u32 m0, s60, 40960
  s_nop 0
  buffer_load_dwordx4 v12, s[24:27], s63 offen lds
  s_add_u32 m0, s60, 45056
  s_nop 0
  buffer_load_dwordx4 v13, s[24:27], s63 offen lds
  s_add_u32 m0, s60, 49152
  s_nop 0
  buffer_load_dwordx4 v14, s[24:27], s63 offen lds
  s_add_u32 m0, s60, 53248
  s_nop 0
  buffer_load_dwordx4 v15, s[24:27], s63 offen lds
  s_add_u32 m0, s60, 57344
  s_nop 0
  buffer_load_dwordx4 v16, s[24:27], s63 offen lds
  v_and_b32 v1, 63, v0
  v_lshrrev_b32 v18, 2, v1
  v_mul_u32_u24 v18, 160, v18
  v_and_b32 v19, 3, v1
  v_lshlrev_b32 v19, 3, v19
  v_add_u32 v22, v18, v19
  s_waitcnt vmcnt(15)
  s_barrier
  s_cmp_lg_u32 s52, 0
  s_cbranch_scc1 t3w_7083
  ds_read_b64_tr_b16 a[0:1], v22 offset:0
  ds_read_b64_tr_b16 a[2:3], v22 offset:2560
  ds_read_b64_tr_b16 a[4:5], v22 offset:32
  ds_read_b64_tr_b16 a[6:7], v22 offset:2592
  ds_read_b64_tr_b16 a[8:9], v22 offset:64
  ds_read_b64_tr_b16 a[10:11], v22 offset:2624
  ds_read_b64_tr_b16 a[12:13], v22 offset:96
  ds_read_b64_tr_b16 a[14:15], v22 offset:2656
  s_waitcnt lgkmcnt(6)
  ds_read_b64_tr_b16 a[16:17], v22 offset:128
  ds_read_b64_tr_b16 a[18:19], v22 offset:2688
  ds_read_b64_tr_b16 a[20:21], v22 offset:5120
  ds_read_b64_tr_b16 a[22:23], v22 offset:7680
  ds_read_b64_tr_b16 a[24:25], v22 offset:5152
  ds_read_b64_tr_b16 a[26:27], v22 offset:7712
  ds_read_b64_tr_b16 a[28:29], v22 offset:5184
  ds_read_b64_tr_b16 a[30:31], v22 offset:7744
  s_waitcnt lgkmcnt(6)
  ds_read_b64_tr_b16 a[32:33], v22 offset:5216
  ds_read_b64_tr_b16 a[34:35], v22 offset:7776
  ds_read_b64_tr_b16 a[36:37], v22 offset:5248
  ds_read_b64_tr_b16 a[38:39], v22 offset:7808
  ds_read_b64_tr_b16 a[40:41], v22 offset:10240
  ds_read_b64_tr_b16 a[42:43], v22 offset:12800
  ds_read_b64_tr_b16 a[44:45], v22 offset:10272
  ds_read_b64_tr_b16 a[46:47], v22 offset:12832
  s_waitcnt lgkmcnt(6)
  ds_read_b64_tr_b16 a[48:49], v22 offset:10304
  ds_read_b64_tr_b16 a[50:51], v22 offset:12864
  ds_read_b64_tr_b16 a[52:53], v22 offset:10336
  ds_read_b64_tr_b16 a[54:55], v22 offset:12896
  ds_read_b64_tr_b16 a[56:57], v22 offset:10368
  ds_read_b64_tr_b16 a[58:59], v22 offset:12928
  ds_read_b64_tr_b16 a[60:61], v22 offset:15360
  ds_read_b64_tr_b16 a[62:63], v22 offset:17920
  s_waitcnt lgkmcnt(6)
  ds_read_b64_tr_b16 a[64:65], v22 offset:15392
  ds_read_b64_tr_b16 a[66:67], v22 offset:17952
  ds_read_b64_tr_b16 a[68:69], v22 offset:15424
  ds_read_b64_tr_b16 a[70:71], v22 offset:17984
  ds_read_b64_tr_b16 a[72:73], v22 offset:15456
  ds_read_b64_tr_b16 a[74:75], v22 offset:18016
  ds_read_b64_tr_b16 a[76:77], v22 offset:15488
  ds_read_b64_tr_b16 a[78:79], v22 offset:18048
  s_waitcnt lgkmcnt(6)
  ds_read_b64_tr_b16 a[80:81], v22 offset:20480
  ds_read_b64_tr_b16 a[82:83], v22 offset:23040
  ds_read_b64_tr_b16 a[84:85], v22 offset:20512
  ds_read_b64_tr_b16 a[86:87], v22 offset:23072
  ds_read_b64_tr_b16 a[88:89], v22 offset:20544
  ds_read_b64_tr_b16 a[90:91], v22 offset:23104
  ds_read_b64_tr_b16 a[92:93], v22 offset:20576
  ds_read_b64_tr_b16 a[94:95], v22 offset:23136
  s_waitcnt lgkmcnt(6)
  ds_read_b64_tr_b16 a[96:97], v22 offset:20608
  ds_read_b64_tr_b16 a[98:99], v22 offset:23168
  ds_read_b64_tr_b16 a[100:101], v22 offset:25600
  ds_read_b64_tr_b16 a[102:103], v22 offset:28160
  ds_read_b64_tr_b16 a[104:105], v22 offset:25632
  ds_read_b64_tr_b16 a[106:107], v22 offset:28192
  ds_read_b64_tr_b16 a[108:109], v22 offset:25664
  ds_read_b64_tr_b16 a[110:111], v22 offset:28224
  s_waitcnt lgkmcnt(6)
  ds_read_b64_tr_b16 a[112:113], v22 offset:25696
  ds_read_b64_tr_b16 a[114:115], v22 offset:28256
  ds_read_b64_tr_b16 a[116:117], v22 offset:25728
  ds_read_b64_tr_b16 a[118:119], v22 offset:28288
  ds_read_b64_tr_b16 a[120:121], v22 offset:30720
  ds_read_b64_tr_b16 a[122:123], v22 offset:33280
  ds_read_b64_tr_b16 a[124:125], v22 offset:30752
  ds_read_b64_tr_b16 a[126:127], v22 offset:33312
  s_waitcnt lgkmcnt(6)
  ds_read_b64_tr_b16 a[128:129], v22 offset:30784
  ds_read_b64_tr_b16 a[130:131], v22 offset:33344
  ds_read_b64_tr_b16 a[132:133], v22 offset:30816
  ds_read_b64_tr_b16 a[134:135], v22 offset:33376
  ds_read_b64_tr_b16 a[136:137], v22 offset:30848
  ds_read_b64_tr_b16 a[138:139], v22 offset:33408
  ds_read_b64_tr_b16 a[140:141], v22 offset:35840
  ds_read_b64_tr_b16 a[142:143], v22 offset:38400
  s_waitcnt lgkmcnt(6)
  ds_read_b64_tr_b16 a[144:145], v22 offset:35872
  ds_read_b64_tr_b16 a[146:147], v22 offset:38432
  ds_read_b64_tr_b16 a[148:149], v22 offset:35904
  ds_read_b64_tr_b16 a[150:151], v22 offset:38464
  ds_read_b64_tr_b16 a[152:153], v22 offset:35936
  ds_read_b64_tr_b16 a[154:155], v22 offset:38496
  ds_read_b64_tr_b16 a[156:157], v22 offset:35968
  ds_read_b64_tr_b16 a[158:159], v22 offset:38528
  s_waitcnt lgkmcnt(6)
  ds_read_b64_tr_b16 a[160:161], v22 offset:40960
  ds_read_b64_tr_b16 a[162:163], v22 offset:43520
  ds_read_b64_tr_b16 a[164:165], v22 offset:40992
  ds_read_b64_tr_b16 a[166:167], v22 offset:43552
  ds_read_b64_tr_b16 a[168:169], v22 offset:41024
  ds_read_b64_tr_b16 a[170:171], v22 offset:43584
  ds_read_b64_tr_b16 a[172:173], v22 offset:41056
  ds_read_b64_tr_b16 a[174:175], v22 offset:43616
  s_waitcnt lgkmcnt(6)
  ds_read_b64_tr_b16 a[176:177], v22 offset:41088
  ds_read_b64_tr_b16 a[178:179], v22 offset:43648
  ds_read_b64_tr_b16 a[180:181], v22 offset:46080
  ds_read_b64_tr_b16 a[182:183], v22 offset:48640
  ds_read_b64_tr_b16 a[184:185], v22 offset:46112
  ds_read_b64_tr_b16 a[186:187], v22 offset:48672
  ds_read_b64_tr_b16 a[188:189], v22 offset:46144
  ds_read_b64_tr_b16 a[190:191], v22 offset:48704
  s_waitcnt lgkmcnt(6)
  ds_read_b64_tr_b16 a[192:193], v22 offset:46176
  ds_read_b64_tr_b16 a[194:195], v22 offset:48736
  ds_read_b64_tr_b16 a[196:197], v22 offset:46208
  ds_read_b64_tr_b16 a[198:199], v22 offset:48768
  ds_read_b64_tr_b16 a[200:201], v22 offset:51200
  ds_read_b64_tr_b16 a[202:203], v22 offset:53760
  ds_read_b64_tr_b16 a[204:205], v22 offset:51232
  ds_read_b64_tr_b16 a[206:207], v22 offset:53792
  s_waitcnt lgkmcnt(6)
  ds_read_b64_tr_b16 a[208:209], v22 offset:51264
  ds_read_b64_tr_b16 a[210:211], v22 offset:53824
  ds_read_b64_tr_b16 a[212:213], v22 offset:51296
  ds_read_b64_tr_b16 a[214:215], v22 offset:53856
  ds_read_b64_tr_b16 a[216:217], v22 offset:51328
  ds_read_b64_tr_b16 a[218:219], v22 offset:53888
  ds_read_b64_tr_b16 a[220:221], v22 offset:56320
  ds_read_b64_tr_b16 a[222:223], v22 offset:58880
  s_waitcnt lgkmcnt(6)
  ds_read_b64_tr_b16 a[224:225], v22 offset:56352
  ds_read_b64_tr_b16 a[226:227], v22 offset:58912
  ds_read_b64_tr_b16 a[228:229], v22 offset:56384
  ds_read_b64_tr_b16 a[230:231], v22 offset:58944
  ds_read_b64_tr_b16 a[232:233], v22 offset:56416
  ds_read_b64_tr_b16 a[234:235], v22 offset:58976
  ds_read_b64_tr_b16 a[236:237], v22 offset:56448
  ds_read_b64_tr_b16 a[238:239], v22 offset:59008
  s_waitcnt lgkmcnt(6)
  s_waitcnt lgkmcnt(0)
t3w_7083:
  s_barrier
  s_add_u32 s63, s63, 491520
  s_lshl_b32 s60, s52, 10
  s_add_u32 s60, s60, 0x0
  s_add_u32 m0, s60, 0
  s_nop 0
  buffer_load_dwordx4 v2, s[24:27], s63 offen lds
  s_add_u32 m0, s60, 4096
  s_nop 0
  buffer_load_dwordx4 v3, s[24:27], s63 offen lds
  s_add_u32 m0, s60, 8192
  s_nop 0
  buffer_load_dwordx4 v4, s[24:27], s63 offen lds
  s_add_u32 m0, s60, 12288
  s_nop 0
  buffer_load_dwordx4 v5, s[24:27], s63 offen lds
  s_add_u32 m0, s60, 16384
  s_nop 0
  buffer_load_dwordx4 v6, s[24:27], s63 offen lds
  s_add_u32 m0, s60, 20480
  s_nop 0
  buffer_load_dwordx4 v7, s[24:27], s63 offen lds
  s_add_u32 m0, s60, 24576
  s_nop 0
  buffer_load_dwordx4 v8, s[24:27], s63 offen lds
  s_add_u32 m0, s60, 28672
  s_nop 0
  buffer_load_dwordx4 v9, s[24:27], s63 offen lds
  s_add_u32 m0, s60, 32768
  s_nop 0
  buffer_load_dwordx4 v10, s[24:27], s63 offen lds
  s_add_u32 m0, s60, 36864
  s_nop 0
  buffer_load_dwordx4 v11, s[24:27], s63 offen lds
  s_add_u32 m0, s60, 40960
  s_nop 0
  buffer_load_dwordx4 v12, s[24:27], s63 offen lds
  s_add_u32 m0, s60, 45056
  s_nop 0
  buffer_load_dwordx4 v13, s[24:27], s63 offen lds
  s_add_u32 m0, s60, 49152
  s_nop 0
  buffer_load_dwordx4 v14, s[24:27], s63 offen lds
  s_add_u32 m0, s60, 53248
  s_nop 0
  buffer_load_dwordx4 v15, s[24:27], s63 offen lds
  s_add_u32 m0, s60, 57344
  s_nop 0
  buffer_load_dwordx4 v16, s[24:27], s63 offen lds
  s_waitcnt vmcnt(15)
  s_barrier
  s_cmp_lg_u32 s52, 1
  s_cbranch_scc1 t3w_7084
  v_add_u32 v22, 61440, v22
  ds_read_b64_tr_b16 a[0:1], v22 offset:0
  ds_read_b64_tr_b16 a[2:3], v22 offset:2560
  ds_read_b64_tr_b16 a[4:5], v22 offset:32
  ds_read_b64_tr_b16 a[6:7], v22 offset:2592
  ds_read_b64_tr_b16 a[8:9], v22 offset:64
  ds_read_b64_tr_b16 a[10:11], v22 offset:2624
  ds_read_b64_tr_b16 a[12:13], v22 offset:96
  ds_read_b64_tr_b16 a[14:15], v22 offset:2656
  s_waitcnt lgkmcnt(6)
  ds_read_b64_tr_b16 a[16:17], v22 offset:128
  ds_read_b64_tr_b16 a[18:19], v22 offset:2688
  ds_read_b64_tr_b16 a[20:21], v22 offset:5120
  ds_read_b64_tr_b16 a[22:23], v22 offset:7680
  ds_read_b64_tr_b16 a[24:25], v22 offset:5152
  ds_read_b64_tr_b16 a[26:27], v22 offset:7712
  ds_read_b64_tr_b16 a[28:29], v22 offset:5184
  ds_read_b64_tr_b16 a[30:31], v22 offset:7744
  s_waitcnt lgkmcnt(6)
  ds_read_b64_tr_b16 a[32:33], v22 offset:5216
  ds_read_b64_tr_b16 a[34:35], v22 offset:7776
  ds_read_b64_tr_b16 a[36:37], v22 offset:5248
  ds_read_b64_tr_b16 a[38:39], v22 offset:7808
  ds_read_b64_tr_b16 a[40:41], v22 offset:10240
  ds_read_b64_tr_b16 a[42:43], v22 offset:12800
  ds_read_b64_tr_b16 a[44:45], v22 offset:10272
  ds_read_b64_tr_b16 a[46:47], v22 offset:12832
  s_waitcnt lgkmcnt(6)
  ds_read_b64_tr_b16 a[48:49], v22 offset:10304
  ds_read_b64_tr_b16 a[50:51], v22 offset:12864
  ds_read_b64_tr_b16 a[52:53], v22 offset:10336
  ds_read_b64_tr_b16 a[54:55], v22 offset:12896
  ds_read_b64_tr_b16 a[56:57], v22 offset:10368
  ds_read_b64_tr_b16 a[58:59], v22 offset:12928
  ds_read_b64_tr_b16 a[60:61], v22 offset:15360
  ds_read_b64_tr_b16 a[62:63], v22 offset:17920
  s_waitcnt lgkmcnt(6)
  ds_read_b64_tr_b16 a[64:65], v22 offset:15392
  ds_read_b64_tr_b16 a[66:67], v22 offset:17952
  ds_read_b64_tr_b16 a[68:69], v22 offset:15424
  ds_read_b64_tr_b16 a[70:71], v22 offset:17984
  ds_read_b64_tr_b16 a[72:73], v22 offset:15456
  ds_read_b64_tr_b16 a[74:75], v22 offset:18016
  ds_read_b64_tr_b16 a[76:77], v22 offset:15488
  ds_read_b64_tr_b16 a[78:79], v22 offset:18048
  s_waitcnt lgkmcnt(6)
  ds_read_b64_tr_b16 a[80:81], v22 offset:20480
  ds_read_b64_tr_b16 a[82:83], v22 offset:23040
  ds_read_b64_tr_b16 a[84:85], v22 offset:20512
  ds_read_b64_tr_b16 a[86:87], v22 offset:23072
  ds_read_b64_tr_b16 a[88:89], v22 offset:20544
  ds_read_b64_tr_b16 a[90:91], v22 offset:23104
  ds_read_b64_tr_b16 a[92:93], v22 offset:20576
  ds_read_b64_tr_b16 a[94:95], v22 offset:23136
  s_waitcnt lgkmcnt(6)
  ds_read_b64_tr_b16 a[96:97], v22 offset:20608
  ds_read_b64_tr_b16 a[98:99], v22 offset:23168
  ds_read_b64_tr_b16 a[100:101], v22 offset:25600
  ds_read_b64_tr_b16 a[102:103], v22 offset:28160
  ds_read_b64_tr_b16 a[104:105], v22 offset:25632
  ds_read_b64_tr_b16 a[106:107], v22 offset:28192
  ds_read_b64_tr_b16 a[108:109], v22 offset:25664
  ds_read_b64_tr_b16 a[110:111], v22 offset:28224
  s_waitcnt lgkmcnt(6)
  ds_read_b64_tr_b16 a[112:113], v22 offset:25696
  ds_read_b64_tr_b16 a[114:115], v22 offset:28256
  ds_read_b64_tr_b16 a[116:117], v22 offset:25728
  ds_read_b64_tr_b16 a[118:119], v22 offset:28288
  ds_read_b64_tr_b16 a[120:121], v22 offset:30720
  ds_read_b64_tr_b16 a[122:123], v22 offset:33280
  ds_read_b64_tr_b16 a[124:125], v22 offset:30752
  ds_read_b64_tr_b16 a[126:127], v22 offset:33312
  s_waitcnt lgkmcnt(6)
  ds_read_b64_tr_b16 a[128:129], v22 offset:30784
  ds_read_b64_tr_b16 a[130:131], v22 offset:33344
  ds_read_b64_tr_b16 a[132:133], v22 offset:30816
  ds_read_b64_tr_b16 a[134:135], v22 offset:33376
  ds_read_b64_tr_b16 a[136:137], v22 offset:30848
  ds_read_b64_tr_b16 a[138:139], v22 offset:33408
  ds_read_b64_tr_b16 a[140:141], v22 offset:35840
  ds_read_b64_tr_b16 a[142:143], v22 offset:38400
  s_waitcnt lgkmcnt(6)
  ds_read_b64_tr_b16 a[144:145], v22 offset:35872
  ds_read_b64_tr_b16 a[146:147], v22 offset:38432
  ds_read_b64_tr_b16 a[148:149], v22 offset:35904
  ds_read_b64_tr_b16 a[150:151], v22 offset:38464
  ds_read_b64_tr_b16 a[152:153], v22 offset:35936
  ds_read_b64_tr_b16 a[154:155], v22 offset:38496
  ds_read_b64_tr_b16 a[156:157], v22 offset:35968
  ds_read_b64_tr_b16 a[158:159], v22 offset:38528
  s_waitcnt lgkmcnt(6)
  ds_read_b64_tr_b16 a[160:161], v22 offset:40960
  ds_read_b64_tr_b16 a[162:163], v22 offset:43520
  ds_read_b64_tr_b16 a[164:165], v22 offset:40992
  ds_read_b64_tr_b16 a[166:167], v22 offset:43552
  ds_read_b64_tr_b16 a[168:169], v22 offset:41024
  ds_read_b64_tr_b16 a[170:171], v22 offset:43584
  ds_read_b64_tr_b16 a[172:173], v22 offset:41056
  ds_read_b64_tr_b16 a[174:175], v22 offset:43616
  s_waitcnt lgkmcnt(6)
  ds_read_b64_tr_b16 a[176:177], v22 offset:41088
  ds_read_b64_tr_b16 a[178:179], v22 offset:43648
  ds_read_b64_tr_b16 a[180:181], v22 offset:46080
  ds_read_b64_tr_b16 a[182:183], v22 offset:48640
  ds_read_b64_tr_b16 a[184:185], v22 offset:46112
  ds_read_b64_tr_b16 a[186:187], v22 offset:48672
  ds_read_b64_tr_b16 a[188:189], v22 offset:46144
  ds_read_b64_tr_b16 a[190:191], v22 offset:48704
  s_waitcnt lgkmcnt(6)
  ds_read_b64_tr_b16 a[192:193], v22 offset:46176
  ds_read_b64_tr_b16 a[194:195], v22 offset:48736
  ds_read_b64_tr_b16 a[196:197], v22 offset:46208
  ds_read_b64_tr_b16 a[198:199], v22 offset:48768
  ds_read_b64_tr_b16 a[200:201], v22 offset:51200
  ds_read_b64_tr_b16 a[202:203], v22 offset:53760
  ds_read_b64_tr_b16 a[204:205], v22 offset:51232
  ds_read_b64_tr_b16 a[206:207], v22 offset:53792
  s_waitcnt lgkmcnt(6)
  ds_read_b64_tr_b16 a[208:209], v22 offset:51264
  ds_read_b64_tr_b16 a[210:211], v22 offset:53824
  ds_read_b64_tr_b16 a[212:213], v22 offset:51296
  ds_read_b64_tr_b16 a[214:215], v22 offset:53856
  ds_read_b64_tr_b16 a[216:217], v22 offset:51328
  ds_read_b64_tr_b16 a[218:219], v22 offset:53888
  ds_read_b64_tr_b16 a[220:221], v22 offset:56320
  ds_read_b64_tr_b16 a[222:223], v22 offset:58880
  s_waitcnt lgkmcnt(6)
  ds_read_b64_tr_b16 a[224:225], v22 offset:56352
  ds_read_b64_tr_b16 a[226:227], v22 offset:58912
  ds_read_b64_tr_b16 a[228:229], v22 offset:56384
  ds_read_b64_tr_b16 a[230:231], v22 offset:58944
  ds_read_b64_tr_b16 a[232:233], v22 offset:56416
  ds_read_b64_tr_b16 a[234:235], v22 offset:58976
  ds_read_b64_tr_b16 a[236:237], v22 offset:56448
  ds_read_b64_tr_b16 a[238:239], v22 offset:59008
  s_waitcnt lgkmcnt(6)
  s_waitcnt lgkmcnt(0)
t3w_7084:
  s_barrier
  s_add_u32 s63, s63, 491520
  s_lshl_b32 s60, s52, 10
  s_add_u32 s60, s60, 0xf000
  s_add_u32 m0, s60, 0
  s_nop 0
  buffer_load_dwordx4 v2, s[24:27], s63 offen lds
  s_add_u32 m0, s60, 4096
  s_nop 0
  buffer_load_dwordx4 v3, s[24:27], s63 offen lds
  s_add_u32 m0, s60, 8192
  s_nop 0
  buffer_load_dwordx4 v4, s[24:27], s63 offen lds
  s_add_u32 m0, s60, 12288
  s_nop 0
  buffer_load_dwordx4 v5, s[24:27], s63 offen lds
  s_add_u32 m0, s60, 16384
  s_nop 0
  buffer_load_dwordx4 v6, s[24:27], s63 offen lds
  s_add_u32 m0, s60, 20480
  s_nop 0
  buffer_load_dwordx4 v7, s[24:27], s63 offen lds
  s_add_u32 m0, s60, 24576
  s_nop 0
  buffer_load_dwordx4 v8, s[24:27], s63 offen lds
  s_add_u32 m0, s60, 28672
  s_nop 0
  buffer_load_dwordx4 v9, s[24:27], s63 offen lds
  s_add_u32 m0, s60, 32768
  s_nop 0
  buffer_load_dwordx4 v10, s[24:27], s63 offen lds
  s_add_u32 m0, s60, 36864
  s_nop 0
  buffer_load_dwordx4 v11, s[24:27], s63 offen lds
  s_add_u32 m0, s60, 40960
  s_nop 0
  buffer_load_dwordx4 v12, s[24:27], s63 offen lds
  s_add_u32 m0, s60, 45056
  s_nop 0
  buffer_load_dwordx4 v13, s[24:27], s63 offen lds
  s_add_u32 m0, s60, 49152
  s_nop 0
  buffer_load_dwordx4 v14, s[24:27], s63 offen lds
  s_add_u32 m0, s60, 53248
  s_nop 0
  buffer_load_dwordx4 v15, s[24:27], s63 offen lds
  s_add_u32 m0, s60, 57344
  s_nop 0
  buffer_load_dwordx4 v16, s[24:27], s63 offen lds
  s_waitcnt vmcnt(15)
  s_barrier
  s_cmp_lg_u32 s52, 2
  s_cbranch_scc1 t3w_7085
  ds_read_b64_tr_b16 a[0:1], v22 offset:0
  ds_read_b64_tr_b16 a[2:3], v22 offset:2560
  ds_read_b64_tr_b16 a[4:5], v22 offset:32
  ds_read_b64_tr_b16 a[6:7], v22 offset:2592
  ds_read_b64_tr_b16 a[8:9], v22 offset:64
  ds_read_b64_tr_b16 a[10:11], v22 offset:2624
  ds_read_b64_tr_b16 a[12:13], v22 offset:96
  ds_read_b64_tr_b16 a[14:15], v22 offset:2656
  s_waitcnt lgkmcnt(6)
  ds_read_b64_tr_b16 a[16:17], v22 offset:128
  ds_read_b64_tr_b16 a[18:19], v22 offset:2688
  ds_read_b64_tr_b16 a[20:21], v22 offset:5120
  ds_read_b64_tr_b16 a[22:23], v22 offset:7680
  ds_read_b64_tr_b16 a[24:25], v22 offset:5152
  ds_read_b64_tr_b16 a[26:27], v22 offset:7712
  ds_read_b64_tr_b16 a[28:29], v22 offset:5184
  ds_read_b64_tr_b16 a[30:31], v22 offset:7744
  s_waitcnt lgkmcnt(6)
  ds_read_b64_tr_b16 a[32:33], v22 offset:5216
  ds_read_b64_tr_b16 a[34:35], v22 offset:7776
  ds_read_b64_tr_b16 a[36:37], v22 offset:5248
  ds_read_b64_tr_b16 a[38:39], v22 offset:7808
  ds_read_b64_tr_b16 a[40:41], v22 offset:10240
  ds_read_b64_tr_b16 a[42:43], v22 offset:12800
  ds_read_b64_tr_b16 a[44:45], v22 offset:10272
  ds_read_b64_tr_b16 a[46:47], v22 offset:12832
  s_waitcnt lgkmcnt(6)
  ds_read_b64_tr_b16 a[48:49], v22 offset:10304
  ds_read_b64_tr_b16 a[50:51], v22 offset:12864
  ds_read_b64_tr_b16 a[52:53], v22 offset:10336
  ds_read_b64_tr_b16 a[54:55], v22 offset:12896
  ds_read_b64_tr_b16 a[56:57], v22 offset:10368
  ds_read_b64_tr_b16 a[58:59], v22 offset:12928
  ds_read_b64_tr_b16 a[60:61], v22 offset:15360
  ds_read_b64_tr_b16 a[62:63], v22 offset:17920
  s_waitcnt lgkmcnt(6)
  ds_read_b64_tr_b16 a[64:65], v22 offset:15392
  ds_read_b64_tr_b16 a[66:67], v22 offset:17952
  ds_read_b64_tr_b16 a[68:69], v22 offset:15424
  ds_read_b64_tr_b16 a[70:71], v22 offset:17984
  ds_read_b64_tr_b16 a[72:73], v22 offset:15456
  ds_read_b64_tr_b16 a[74:75], v22 offset:18016
  ds_read_b64_tr_b16 a[76:77], v22 offset:15488
  ds_read_b64_tr_b16 a[78:79], v22 offset:18048
  s_waitcnt lgkmcnt(6)
  ds_read_b64_tr_b16 a[80:81], v22 offset:20480
  ds_read_b64_tr_b16 a[82:83], v22 offset:23040
  ds_read_b64_tr_b16 a[84:85], v22 offset:20512
  ds_read_b64_tr_b16 a[86:87], v22 offset:23072
  ds_read_b64_tr_b16 a[88:89], v22 offset:20544
  ds_read_b64_tr_b16 a[90:91], v22 offset:23104
  ds_read_b64_tr_b16 a[92:93], v22 offset:20576
  ds_read_b64_tr_b16 a[94:95], v22 offset:23136
  s_waitcnt lgkmcnt(6)
  ds_read_b64_tr_b16 a[96:97], v22 offset:20608
  ds_read_b64_tr_b16 a[98:99], v22 offset:23168
  ds_read_b64_tr_b16 a[100:101], v22 offset:25600
  ds_read_b64_tr_b16 a[102:103], v22 offset:28160
  ds_read_b64_tr_b16 a[104:105], v22 offset:25632
  ds_read_b64_tr_b16 a[106:107], v22 offset:28192
  ds_read_b64_tr_b16 a[108:109], v22 offset:25664
  ds_read_b64_tr_b16 a[110:111], v22 offset:28224
  s_waitcnt lgkmcnt(6)
  ds_read_b64_tr_b16 a[112:113], v22 offset:25696
  ds_read_b64_tr_b16 a[114:115], v22 offset:28256
  ds_read_b64_tr_b16 a[116:117], v22 offset:25728
  ds_read_b64_tr_b16 a[118:119], v22 offset:28288
  ds_read_b64_tr_b16 a[120:121], v22 offset:30720
  ds_read_b64_tr_b16 a[122:123], v22 offset:33280
  ds_read_b64_tr_b16 a[124:125], v22 offset:30752
  ds_read_b64_tr_b16 a[126:127], v22 offset:33312
  s_waitcnt lgkmcnt(6)
  ds_read_b64_tr_b16 a[128:129], v22 offset:30784
  ds_read_b64_tr_b16 a[130:131], v22 offset:33344
  ds_read_b64_tr_b16 a[132:133], v22 offset:30816
  ds_read_b64_tr_b16 a[134:135], v22 offset:33376
  ds_read_b64_tr_b16 a[136:137], v22 offset:30848
  ds_read_b64_tr_b16 a[138:139], v22 offset:33408
  ds_read_b64_tr_b16 a[140:141], v22 offset:35840
  ds_read_b64_tr_b16 a[142:143], v22 offset:38400
  s_waitcnt lgkmcnt(6)
  ds_read_b64_tr_b16 a[144:145], v22 offset:35872
  ds_read_b64_tr_b16 a[146:147], v22 offset:38432
  ds_read_b64_tr_b16 a[148:149], v22 offset:35904
  ds_read_b64_tr_b16 a[150:151], v22 offset:38464
  ds_read_b64_tr_b16 a[152:153], v22 offset:35936
  ds_read_b64_tr_b16 a[154:155], v22 offset:38496
  ds_read_b64_tr_b16 a[156:157], v22 offset:35968
  ds_read_b64_tr_b16 a[158:159], v22 offset:38528
  s_waitcnt lgkmcnt(6)
  ds_read_b64_tr_b16 a[160:161], v22 offset:40960
  ds_read_b64_tr_b16 a[162:163], v22 offset:43520
  ds_read_b64_tr_b16 a[164:165], v22 offset:40992
  ds_read_b64_tr_b16 a[166:167], v22 offset:43552
  ds_read_b64_tr_b16 a[168:169], v22 offset:41024
  ds_read_b64_tr_b16 a[170:171], v22 offset:43584
  ds_read_b64_tr_b16 a[172:173], v22 offset:41056
  ds_read_b64_tr_b16 a[174:175], v22 offset:43616
  s_waitcnt lgkmcnt(6)
  ds_read_b64_tr_b16 a[176:177], v22 offset:41088
  ds_read_b64_tr_b16 a[178:179], v22 offset:43648
  ds_read_b64_tr_b16 a[180:181], v22 offset:46080
  ds_read_b64_tr_b16 a[182:183], v22 offset:48640
  ds_read_b64_tr_b16 a[184:185], v22 offset:46112
  ds_read_b64_tr_b16 a[186:187], v22 offset:48672
  ds_read_b64_tr_b16 a[188:189], v22 offset:46144
  ds_read_b64_tr_b16 a[190:191], v22 offset:48704
  s_waitcnt lgkmcnt(6)
  ds_read_b64_tr_b16 a[192:193], v22 offset:46176
  ds_read_b64_tr_b16 a[194:195], v22 offset:48736
  ds_read_b64_tr_b16 a[196:197], v22 offset:46208
  ds_read_b64_tr_b16 a[198:199], v22 offset:48768
  ds_read_b64_tr_b16 a[200:201], v22 offset:51200
  ds_read_b64_tr_b16 a[202:203], v22 offset:53760
  ds_read_b64_tr_b16 a[204:205], v22 offset:51232
  ds_read_b64_tr_b16 a[206:207], v22 offset:53792
  s_waitcnt lgkmcnt(6)
  ds_read_b64_tr_b16 a[208:209], v22 offset:51264
  ds_read_b64_tr_b16 a[210:211], v22 offset:53824
  ds_read_b64_tr_b16 a[212:213], v22 offset:51296
  ds_read_b64_tr_b16 a[214:215], v22 offset:53856
  ds_read_b64_tr_b16 a[216:217], v22 offset:51328
  ds_read_b64_tr_b16 a[218:219], v22 offset:53888
  ds_read_b64_tr_b16 a[220:221], v22 offset:56320
  ds_read_b64_tr_b16 a[222:223], v22 offset:58880
  s_waitcnt lgkmcnt(6)
  ds_read_b64_tr_b16 a[224:225], v22 offset:56352
  ds_read_b64_tr_b16 a[226:227], v22 offset:58912
  ds_read_b64_tr_b16 a[228:229], v22 offset:56384
  ds_read_b64_tr_b16 a[230:231], v22 offset:58944
  ds_read_b64_tr_b16 a[232:233], v22 offset:56416
  ds_read_b64_tr_b16 a[234:235], v22 offset:58976
  ds_read_b64_tr_b16 a[236:237], v22 offset:56448
  ds_read_b64_tr_b16 a[238:239], v22 offset:59008
  s_waitcnt lgkmcnt(6)
  s_waitcnt lgkmcnt(0)
t3w_7085:
  s_barrier
  s_waitcnt vmcnt(0)
  s_barrier
  s_cmp_lg_u32 s52, 3
  s_cbranch_scc1 t3w_7086
  v_add_u32 v22, 61440, v22
  ds_read_b64_tr_b16 a[0:1], v22 offset:0
  ds_read_b64_tr_b16 a[2:3], v22 offset:2560
  ds_read_b64_tr_b16 a[4:5], v22 offset:32
  ds_read_b64_tr_b16 a[6:7], v22 offset:2592
  ds_read_b64_tr_b16 a[8:9], v22 offset:64
  ds_read_b64_tr_b16 a[10:11], v22 offset:2624
  ds_read_b64_tr_b16 a[12:13], v22 offset:96
  ds_read_b64_tr_b16 a[14:15], v22 offset:2656
  s_waitcnt lgkmcnt(6)
  ds_read_b64_tr_b16 a[16:17], v22 offset:128
  ds_read_b64_tr_b16 a[18:19], v22 offset:2688
  ds_read_b64_tr_b16 a[20:21], v22 offset:5120
  ds_read_b64_tr_b16 a[22:23], v22 offset:7680
  ds_read_b64_tr_b16 a[24:25], v22 offset:5152
  ds_read_b64_tr_b16 a[26:27], v22 offset:7712
  ds_read_b64_tr_b16 a[28:29], v22 offset:5184
  ds_read_b64_tr_b16 a[30:31], v22 offset:7744
  s_waitcnt lgkmcnt(6)
  ds_read_b64_tr_b16 a[32:33], v22 offset:5216
  ds_read_b64_tr_b16 a[34:35], v22 offset:7776
  ds_read_b64_tr_b16 a[36:37], v22 offset:5248
  ds_read_b64_tr_b16 a[38:39], v22 offset:7808
  ds_read_b64_tr_b16 a[40:41], v22 offset:10240
  ds_read_b64_tr_b16 a[42:43], v22 offset:12800
  ds_read_b64_tr_b16 a[44:45], v22 offset:10272
  ds_read_b64_tr_b16 a[46:47], v22 offset:12832
  s_waitcnt lgkmcnt(6)
  ds_read_b64_tr_b16 a[48:49], v22 offset:10304
  ds_read_b64_tr_b16 a[50:51], v22 offset:12864
  ds_read_b64_tr_b16 a[52:53], v22 offset:10336
  ds_read_b64_tr_b16 a[54:55], v22 offset:12896
  ds_read_b64_tr_b16 a[56:57], v22 offset:10368
  ds_read_b64_tr_b16 a[58:59], v22 offset:12928
  ds_read_b64_tr_b16 a[60:61], v22 offset:15360
  ds_read_b64_tr_b16 a[62:63], v22 offset:17920
  s_waitcnt lgkmcnt(6)
  ds_read_b64_tr_b16 a[64:65], v22 offset:15392
  ds_read_b64_tr_b16 a[66:67], v22 offset:17952
  ds_read_b64_tr_b16 a[68:69], v22 offset:15424
  ds_read_b64_tr_b16 a[70:71], v22 offset:17984
  ds_read_b64_tr_b16 a[72:73], v22 offset:15456
  ds_read_b64_tr_b16 a[74:75], v22 offset:18016
  ds_read_b64_tr_b16 a[76:77], v22 offset:15488
  ds_read_b64_tr_b16 a[78:79], v22 offset:18048
  s_waitcnt lgkmcnt(6)
  ds_read_b64_tr_b16 a[80:81], v22 offset:20480
  ds_read_b64_tr_b16 a[82:83], v22 offset:23040
  ds_read_b64_tr_b16 a[84:85], v22 offset:20512
  ds_read_b64_tr_b16 a[86:87], v22 offset:23072
  ds_read_b64_tr_b16 a[88:89], v22 offset:20544
  ds_read_b64_tr_b16 a[90:91], v22 offset:23104
  ds_read_b64_tr_b16 a[92:93], v22 offset:20576
  ds_read_b64_tr_b16 a[94:95], v22 offset:23136
  s_waitcnt lgkmcnt(6)
  ds_read_b64_tr_b16 a[96:97], v22 offset:20608
  ds_read_b64_tr_b16 a[98:99], v22 offset:23168
  ds_read_b64_tr_b16 a[100:101], v22 offset:25600
  ds_read_b64_tr_b16 a[102:103], v22 offset:28160
  ds_read_b64_tr_b16 a[104:105], v22 offset:25632
  ds_read_b64_tr_b16 a[106:107], v22 offset:28192
  ds_read_b64_tr_b16 a[108:109], v22 offset:25664
  ds_read_b64_tr_b16 a[110:111], v22 offset:28224
  s_waitcnt lgkmcnt(6)
  ds_read_b64_tr_b16 a[112:113], v22 offset:25696
  ds_read_b64_tr_b16 a[114:115], v22 offset:28256
  ds_read_b64_tr_b16 a[116:117], v22 offset:25728
  ds_read_b64_tr_b16 a[118:119], v22 offset:28288
  ds_read_b64_tr_b16 a[120:121], v22 offset:30720
  ds_read_b64_tr_b16 a[122:123], v22 offset:33280
  ds_read_b64_tr_b16 a[124:125], v22 offset:30752
  ds_read_b64_tr_b16 a[126:127], v22 offset:33312
  s_waitcnt lgkmcnt(6)
  ds_read_b64_tr_b16 a[128:129], v22 offset:30784
  ds_read_b64_tr_b16 a[130:131], v22 offset:33344
  ds_read_b64_tr_b16 a[132:133], v22 offset:30816
  ds_read_b64_tr_b16 a[134:135], v22 offset:33376
  ds_read_b64_tr_b16 a[136:137], v22 offset:30848
  ds_read_b64_tr_b16 a[138:139], v22 offset:33408
  ds_read_b64_tr_b16 a[140:141], v22 offset:35840
  ds_read_b64_tr_b16 a[142:143], v22 offset:38400
  s_waitcnt lgkmcnt(6)
  ds_read_b64_tr_b16 a[144:145], v22 offset:35872
  ds_read_b64_tr_b16 a[146:147], v22 offset:38432
  ds_read_b64_tr_b16 a[148:149], v22 offset:35904
  ds_read_b64_tr_b16 a[150:151], v22 offset:38464
  ds_read_b64_tr_b16 a[152:153], v22 offset:35936
  ds_read_b64_tr_b16 a[154:155], v22 offset:38496
  ds_read_b64_tr_b16 a[156:157], v22 offset:35968
  ds_read_b64_tr_b16 a[158:159], v22 offset:38528
  s_waitcnt lgkmcnt(6)
  ds_read_b64_tr_b16 a[160:161], v22 offset:40960
  ds_read_b64_tr_b16 a[162:163], v22 offset:43520
  ds_read_b64_tr_b16 a[164:165], v22 offset:40992
  ds_read_b64_tr_b16 a[166:167], v22 offset:43552
  ds_read_b64_tr_b16 a[168:169], v22 offset:41024
  ds_read_b64_tr_b16 a[170:171], v22 offset:43584
  ds_read_b64_tr_b16 a[172:173], v22 offset:41056
  ds_read_b64_tr_b16 a[174:175], v22 offset:43616
  s_waitcnt lgkmcnt(6)
  ds_read_b64_tr_b16 a[176:177], v22 offset:41088
  ds_read_b64_tr_b16 a[178:179], v22 offset:43648
  ds_read_b64_tr_b16 a[180:181], v22 offset:46080
  ds_read_b64_tr_b16 a[182:183], v22 offset:48640
  ds_read_b64_tr_b16 a[184:185], v22 offset:46112
  ds_read_b64_tr_b16 a[186:187], v22 offset:48672
  ds_read_b64_tr_b16 a[188:189], v22 offset:46144
  ds_read_b64_tr_b16 a[190:191], v22 offset:48704
  s_waitcnt lgkmcnt(6)
  ds_read_b64_tr_b16 a[192:193], v22 offset:46176
  ds_read_b64_tr_b16 a[194:195], v22 offset:48736
  ds_read_b64_tr_b16 a[196:197], v22 offset:46208
  ds_read_b64_tr_b16 a[198:199], v22 offset:48768
  ds_read_b64_tr_b16 a[200:201], v22 offset:51200
  ds_read_b64_tr_b16 a[202:203], v22 offset:53760
  ds_read_b64_tr_b16 a[204:205], v22 offset:51232
  ds_read_b64_tr_b16 a[206:207], v22 offset:53792
  s_waitcnt lgkmcnt(6)
  ds_read_b64_tr_b16 a[208:209], v22 offset:51264
  ds_read_b64_tr_b16 a[210:211], v22 offset:53824
  ds_read_b64_tr_b16 a[212:213], v22 offset:51296
  ds_read_b64_tr_b16 a[214:215], v22 offset:53856
  ds_read_b64_tr_b16 a[216:217], v22 offset:51328
  ds_read_b64_tr_b16 a[218:219], v22 offset:53888
  ds_read_b64_tr_b16 a[220:221], v22 offset:56320
  ds_read_b64_tr_b16 a[222:223], v22 offset:58880
  s_waitcnt lgkmcnt(6)
  ds_read_b64_tr_b16 a[224:225], v22 offset:56352
  ds_read_b64_tr_b16 a[226:227], v22 offset:58912
  ds_read_b64_tr_b16 a[228:229], v22 offset:56384
  ds_read_b64_tr_b16 a[230:231], v22 offset:58944
  ds_read_b64_tr_b16 a[232:233], v22 offset:56416
  ds_read_b64_tr_b16 a[234:235], v22 offset:58976
  ds_read_b64_tr_b16 a[236:237], v22 offset:56448
  ds_read_b64_tr_b16 a[238:239], v22 offset:59008
  s_waitcnt lgkmcnt(6)
  s_waitcnt lgkmcnt(0)
t3w_7086:
  s_barrier
  v_lshlrev_b32 v23, 4, v1
  s_lshl_b32 s58, s53, 10
  s_add_u32 s58, s58, 24576
  v_and_b32 v18, 7, v1
  v_lshlrev_b32 v18, 7, v18
  v_add_u32 v24, s58, v18
  s_lshl_b32 s58, s62, 7
  s_add_u32 s58, s58, 28672
  v_and_b32 v18, 3, v1
  v_lshlrev_b32 v18, 10, v18
  v_bfe_u32 v19, v1, 2, 2
  v_lshlrev_b32 v19, 5, v19
  v_add_u32 v18, v18, v19
  v_add_u32 v25, s58, v18
  s_lshl_b32 s59, s53, 10
  s_add_u32 s58, s58, s59
  s_lshl_b32 s59, s52, 5
  s_add_u32 s58, s58, s59
  v_mov_b32 v26, s58
  s_mul_i32 s58, s52, 10240
  v_add_u32 v27, s58, v23
  s_lshl_b32 s58, s52, 10
  v_add_u32 v28, s58, v23
  s_and_b32 s58, s52, 1
  s_mul_i32 s58, s58, 40960
  s_lshr_b32 s59, s52, 1
  s_lshl_b32 s59, s59, 6
  s_add_u32 s58, s58, s59
  s_mul_i32 s59, s62, 320
  s_add_u32 s58, s58, s59
  v_and_b32 v18, 15, v1
  v_mul_u32_u24 v18, 2560, v18
  v_lshrrev_b32 v19, 4, v1
  v_lshlrev_b32 v19, 4, v19
  v_add_u32 v18, v18, v19
  v_add_u32 v29, s58, v18
  v_mov_b32 v18, v0
  v_mul_u32_u24 v19, 3277, v18
  v_lshrrev_b32 v19, 16, v19
  v_mul_u32_u24 v20, 20, v19
  v_sub_u32 v18, v18, v20
  s_mul_i32 s58, s62, 320
  v_mul_u32_u24 v20, 2560, v19
  v_lshlrev_b32 v21, 4, v18
  v_add_u32 v20, v20, v21
  v_add_u32 v184, s58, v20
  v_mul_u32_u24 v20, 2560, v19
  v_lshlrev_b32 v21, 3, v18
  s_mul_i32 s58, s62, 160
  v_add_u32 v20, v20, v21
  v_add_u32 v187, s58, v20
  v_add_u32 v18, 256, v0
  v_mul_u32_u24 v19, 3277, v18
  v_lshrrev_b32 v19, 16, v19
  v_mul_u32_u24 v20, 20, v19
  v_sub_u32 v18, v18, v20
  s_mul_i32 s58, s62, 320
  v_mul_u32_u24 v20, 2560, v19
  v_lshlrev_b32 v21, 4, v18
  v_add_u32 v20, v20, v21
  v_add_u32 v185, s58, v20
  v_mul_u32_u24 v20, 2560, v19
  v_lshlrev_b32 v21, 3, v18
  s_mul_i32 s58, s62, 160
  v_add_u32 v20, v20, v21
  v_add_u32 v188, s58, v20
  v_add_u32 v18, 512, v0
  v_mul_u32_u24 v19, 3277, v18
  v_lshrrev_b32 v19, 16, v19
  v_mul_u32_u24 v20, 20, v19
  v_sub_u32 v18, v18, v20
  s_mul_i32 s58, s62, 320
  v_mul_u32_u24 v20, 2560, v19
  v_lshlrev_b32 v21, 4, v18
  v_add_u32 v20, v20, v21
  v_add_u32 v186, s58, v20
  v_mul_u32_u24 v20, 2560, v19
  v_lshlrev_b32 v21, 3, v18
  s_mul_i32 s58, s62, 160
  v_add_u32 v20, v20, v21
  v_add_u32 v189, s58, v20
  s_mul_i32 s64, s53, 98304
  s_mul_i32 s58, s52, 24576
  s_add_u32 s64, s64, s58
  s_add_u32 s64, s64, 0x4a00000
  s_mul_i32 s65, s53, 81920
  s_add_u32 s65, s65, 0x6200000
  s_mov_b32 s68, 0
  s_mov_b32 s72, 0
  s_mov_b32 s66, 0
  s_mov_b32 s69, 0
  s_mov_b32 s71, 0
L_t3_r:
  s_cmp_eq_u32 s69, 1
  s_cbranch_scc1 t3h_7087
  s_add_u32 s60, s68, 1
  s_cmp_ge_u32 s72, s60
  s_cbranch_scc1 t3wd_7089
  s_mov_b32 s56, 0
t3w_7088:
  buffer_load_dword v18, v24, s[48:51], 0 offen sc1
  s_waitcnt vmcnt(0)
  s_nop 1
  v_min_u32_dpp v18, v18, v18 row_ror:4 row_mask:0xf bank_mask:0xf
  s_nop 1
  v_min_u32_dpp v18, v18, v18 row_ror:2 row_mask:0xf bank_mask:0xf
  s_nop 1
  v_min_u32_dpp v18, v18, v18 row_ror:1 row_mask:0xf bank_mask:0xf
  s_nop 0
  v_readlane_b32 s72, v18, 0
  s_cmp_ge_u32 s72, s60
  s_cbranch_scc1 t3wd_7089
  s_cmp_lg_u32 s55, 0
  s_cbranch_scc1 t3wd_7089
  s_add_u32 s56, s56, 1
  s_cmp_lt_u32 s56, 0x20000
  s_cbranch_scc1 t3w_7088
  s_mov_b32 s55, 1
t3wd_7089:
  s_add_u32 s58, s64, 0
  buffer_load_dwordx4 v[32:35], v23, s[48:51], s58 offen offset:0 sc1
  buffer_load_dwordx4 v[36:39], v23, s[48:51], s58 offen offset:1024 sc1
  buffer_load_dwordx4 v[40:43], v23, s[48:51], s58 offen offset:2048 sc1
  buffer_load_dwordx4 v[44:47], v23, s[48:51], s58 offen offset:3072 sc1
  s_add_u32 s58, s64, 4096
  buffer_load_dwordx4 v[48:51], v23, s[48:51], s58 offen offset:0 sc1
  buffer_load_dwordx4 v[52:55], v23, s[48:51], s58 offen offset:1024 sc1
  buffer_load_dwordx4 v[56:59], v23, s[48:51], s58 offen offset:2048 sc1
  buffer_load_dwordx4 v[60:63], v23, s[48:51], s58 offen offset:3072 sc1
  s_add_u32 s58, s64, 8192
  buffer_load_dwordx4 v[64:67], v23, s[48:51], s58 offen offset:0 sc1
  buffer_load_dwordx4 v[68:71], v23, s[48:51], s58 offen offset:1024 sc1
  buffer_load_dwordx4 v[72:75], v23, s[48:51], s58 offen offset:2048 sc1
  buffer_load_dwordx4 v[76:79], v23, s[48:51], s58 offen offset:3072 sc1
  s_add_u32 s58, s64, 12288
  buffer_load_dwordx4 v[80:83], v23, s[48:51], s58 offen offset:0 sc1
  buffer_load_dwordx4 v[84:87], v23, s[48:51], s58 offen offset:1024 sc1
  buffer_load_dwordx4 v[88:91], v23, s[48:51], s58 offen offset:2048 sc1
  buffer_load_dwordx4 v[92:95], v23, s[48:51], s58 offen offset:3072 sc1
  s_add_u32 s58, s64, 16384
  buffer_load_dwordx4 v[96:99], v23, s[48:51], s58 offen offset:0 sc1
  buffer_load_dwordx4 v[100:103], v23, s[48:51], s58 offen offset:1024 sc1
  buffer_load_dwordx4 v[104:107], v23, s[48:51], s58 offen offset:2048 sc1
  buffer_load_dwordx4 v[108:111], v23, s[48:51], s58 offen offset:3072 sc1
  s_add_u32 s58, s64, 20480
  buffer_load_dwordx4 v[112:115], v23, s[48:51], s58 offen offset:0 sc1
  buffer_load_dwordx4 v[116:119], v23, s[48:51], s58 offen offset:1024 sc1
  buffer_load_dwordx4 v[120:123], v23, s[48:51], s58 offen offset:2048 sc1
  buffer_load_dwordx4 v[124:127], v23, s[48:51], s58 offen offset:3072 sc1
t3h_7087:
  s_mov_b32 s74, 0
  s_sub_u32 s67, s68, 2
  s_and_b32 s58, s67, 3
  s_cmp_lt_u32 s68, 2
  s_cbranch_scc1 t3fe_7090
  s_cmp_lg_u32 s58, s53
  s_cbranch_scc1 t3fe_7090
  s_cmp_ge_u32 s68, 62
  s_cbranch_scc1 t3fe_7090
  s_cmp_gt_u32 s66, s67
  s_cbranch_scc0 t3fe_7090
  s_mul_i32 s60, s67, 327680
  s_add_u32 s60, s60, 0x6200000
  s_add_u32 s58, s60, 0
  buffer_load_dwordx4 v[192:195], v184, s[48:51], s58 offen sc1
  s_add_u32 s58, s60, 81920
  buffer_load_dwordx4 v[196:199], v184, s[48:51], s58 offen sc1
  s_add_u32 s58, s60, 163840
  buffer_load_dwordx4 v[200:203], v184, s[48:51], s58 offen sc1
  s_add_u32 s58, s60, 245760
  buffer_load_dwordx4 v[204:207], v184, s[48:51], s58 offen sc1
t3k_7091:
  s_add_u32 s58, s60, 0
  buffer_load_dwordx4 v[208:211], v185, s[48:51], s58 offen sc1
  s_add_u32 s58, s60, 81920
  buffer_load_dwordx4 v[212:215], v185, s[48:51], s58 offen sc1
  s_add_u32 s58, s60, 163840
  buffer_load_dwordx4 v[216:219], v185, s[48:51], s58 offen sc1
  s_add_u32 s58, s60, 245760
  buffer_load_dwordx4 v[220:223], v185, s[48:51], s58 offen sc1
t3k_7092:
  s_cmp_ge_u32 s52, 2
  s_cbranch_scc1 t3k_7093
  s_add_u32 s58, s60, 0
  buffer_load_dwordx4 v[224:227], v186, s[48:51], s58 offen sc1
  s_add_u32 s58, s60, 81920
  buffer_load_dwordx4 v[228:231], v186, s[48:51], s58 offen sc1
  s_add_u32 s58, s60, 163840
  buffer_load_dwordx4 v[232:235], v186, s[48:51], s58 offen sc1
  s_add_u32 s58, s60, 245760
  buffer_load_dwordx4 v[236:239], v186, s[48:51], s58 offen sc1
t3k_7093:
  s_mov_b32 s74, 1
t3fe_7090:
  s_add_u32 s73, s64, 393216
  s_add_u32 s60, s68, 2
  s_mov_b32 s70, 0
  s_cmp_ge_u32 s72, s60
  s_cbranch_scc0 t3b_7094
  s_mov_b32 s70, 1
  s_waitcnt vmcnt(22)
  v_mfma_f32_16x16x32_bf16 v[128:131], a[0:3], v[32:35], 0
  v_mfma_f32_16x16x32_bf16 v[132:135], a[0:3], v[36:39], 0
  v_mfma_f32_16x16x32_bf16 v[136:139], a[4:7], v[32:35], 0
  v_mfma_f32_16x16x32_bf16 v[140:143], a[4:7], v[36:39], 0
  v_mfma_f32_16x16x32_bf16 v[144:147], a[8:11], v[32:35], 0
  v_mfma_f32_16x16x32_bf16 v[148:151], a[8:11], v[36:39], 0
  v_mfma_f32_16x16x32_bf16 v[152:155], a[12:15], v[32:35], 0
  v_mfma_f32_16x16x32_bf16 v[156:159], a[12:15], v[36:39], 0
  v_mfma_f32_16x16x32_bf16 v[160:163], a[16:19], v[32:35], 0
  v_mfma_f32_16x16x32_bf16 v[164:167], a[16:19], v[36:39], 0
  s_add_u32 s58, s73, 0
  buffer_load_dwordx4 v[32:35], v23, s[48:51], s58 offen offset:0 sc1
  buffer_load_dwordx4 v[36:39], v23, s[48:51], s58 offen offset:1024 sc1
  s_waitcnt vmcnt(22)
  v_mfma_f32_16x16x32_bf16 v[128:131], a[20:23], v[40:43], v[128:131]
  v_mfma_f32_16x16x32_bf16 v[132:135], a[20:23], v[44:47], v[132:135]
  v_mfma_f32_16x16x32_bf16 v[136:139], a[24:27], v[40:43], v[136:139]
  v_mfma_f32_16x16x32_bf16 v[140:143], a[24:27], v[44:47], v[140:143]
  v_mfma_f32_16x16x32_bf16 v[144:147], a[28:31], v[40:43], v[144:147]
  v_mfma_f32_16x16x32_bf16 v[148:151], a[28:31], v[44:47], v[148:151]
  v_mfma_f32_16x16x32_bf16 v[152:155], a[32:35], v[40:43], v[152:155]
  v_mfma_f32_16x16x32_bf16 v[156:159], a[32:35], v[44:47], v[156:159]
  v_mfma_f32_16x16x32_bf16 v[160:163], a[36:39], v[40:43], v[160:163]
  v_mfma_f32_16x16x32_bf16 v[164:167], a[36:39], v[44:47], v[164:167]
  buffer_load_dwordx4 v[40:43], v23, s[48:51], s58 offen offset:2048 sc1
  buffer_load_dwordx4 v[44:47], v23, s[48:51], s58 offen offset:3072 sc1
  s_waitcnt vmcnt(22)
  v_mfma_f32_16x16x32_bf16 v[128:131], a[40:43], v[48:51], v[128:131]
  v_mfma_f32_16x16x32_bf16 v[132:135], a[40:43], v[52:55], v[132:135]
  v_mfma_f32_16x16x32_bf16 v[136:139], a[44:47], v[48:51], v[136:139]
  v_mfma_f32_16x16x32_bf16 v[140:143], a[44:47], v[52:55], v[140:143]
  v_mfma_f32_16x16x32_bf16 v[144:147], a[48:51], v[48:51], v[144:147]
  v_mfma_f32_16x16x32_bf16 v[148:151], a[48:51], v[52:55], v[148:151]
  v_mfma_f32_16x16x32_bf16 v[152:155], a[52:55], v[48:51], v[152:155]
  v_mfma_f32_16x16x32_bf16 v[156:159], a[52:55], v[52:55], v[156:159]
  v_mfma_f32_16x16x32_bf16 v[160:163], a[56:59], v[48:51], v[160:163]
  v_mfma_f32_16x16x32_bf16 v[164:167], a[56:59], v[52:55], v[164:167]
  s_add_u32 s58, s73, 4096
  buffer_load_dwordx4 v[48:51], v23, s[48:51], s58 offen offset:0 sc1
  buffer_load_dwordx4 v[52:55], v23, s[48:51], s58 offen offset:1024 sc1
  s_waitcnt vmcnt(22)
  v_mfma_f32_16x16x32_bf16 v[128:131], a[60:63], v[56:59], v[128:131]
  v_mfma_f32_16x16x32_bf16 v[132:135], a[60:63], v[60:63], v[132:135]
  v_mfma_f32_16x16x32_bf16 v[136:139], a[64:67], v[56:59], v[136:139]
  v_mfma_f32_16x16x32_bf16 v[140:143], a[64:67], v[60:63], v[140:143]
  v_mfma_f32_16x16x32_bf16 v[144:147], a[68:71], v[56:59], v[144:147]
  v_mfma_f32_16x16x32_bf16 v[148:151], a[68:71], v[60:63], v[148:151]
  v_mfma_f32_16x16x32_bf16 v[152:155], a[72:75], v[56:59], v[152:155]
  v_mfma_f32_16x16x32_bf16 v[156:159], a[72:75], v[60:63], v[156:159]
  v_mfma_f32_16x16x32_bf16 v[160:163], a[76:79], v[56:59], v[160:163]
  v_mfma_f32_16x16x32_bf16 v[164:167], a[76:79], v[60:63], v[164:167]
  buffer_load_dwordx4 v[56:59], v23, s[48:51], s58 offen offset:2048 sc1
  buffer_load_dwordx4 v[60:63], v23, s[48:51], s58 offen offset:3072 sc1
  s_waitcnt vmcnt(22)
  v_mfma_f32_16x16x32_bf16 v[128:131], a[80:83], v[64:67], v[128:131]
  v_mfma_f32_16x16x32_bf16 v[132:135], a[80:83], v[68:71], v[132:135]
  v_mfma_f32_16x16x32_bf16 v[136:139], a[84:87], v[64:67], v[136:139]
  v_mfma_f32_16x16x32_bf16 v[140:143], a[84:87], v[68:71], v[140:143]
  v_mfma_f32_16x16x32_bf16 v[144:147], a[88:91], v[64:67], v[144:147]
  v_mfma_f32_16x16x32_bf16 v[148:151], a[88:91], v[68:71], v[148:151]
  v_mfma_f32_16x16x32_bf16 v[152:155], a[92:95], v[64:67], v[152:155]
  v_mfma_f32_16x16x32_bf16 v[156:159], a[92:95], v[68:71], v[156:159]
  v_mfma_f32_16x16x32_bf16 v[160:163], a[96:99], v[64:67], v[160:163]
  v_mfma_f32_16x16x32_bf16 v[164:167], a[96:99], v[68:71], v[164:167]
  s_add_u32 s58, s73, 8192
  buffer_load_dwordx4 v[64:67], v23, s[48:51], s58 offen offset:0 sc1
  buffer_load_dwordx4 v[68:71], v23, s[48:51], s58 offen offset:1024 sc1
  s_waitcnt vmcnt(22)
  v_mfma_f32_16x16x32_bf16 v[128:131], a[100:103], v[72:75], v[128:131]
  v_mfma_f32_16x16x32_bf16 v[132:135], a[100:103], v[76:79], v[132:135]
  v_mfma_f32_16x16x32_bf16 v[136:139], a[104:107], v[72:75], v[136:139]
  v_mfma_f32_16x16x32_bf16 v[140:143], a[104:107], v[76:79], v[140:143]
  v_mfma_f32_16x16x32_bf16 v[144:147], a[108:111], v[72:75], v[144:147]
  v_mfma_f32_16x16x32_bf16 v[148:151], a[108:111], v[76:79], v[148:151]
  v_mfma_f32_16x16x32_bf16 v[152:155], a[112:115], v[72:75], v[152:155]
  v_mfma_f32_16x16x32_bf16 v[156:159], a[112:115], v[76:79], v[156:159]
  v_mfma_f32_16x16x32_bf16 v[160:163], a[116:119], v[72:75], v[160:163]
  v_mfma_f32_16x16x32_bf16 v[164:167], a[116:119], v[76:79], v[164:167]
  buffer_load_dwordx4 v[72:75], v23, s[48:51], s58 offen offset:2048 sc1
  buffer_load_dwordx4 v[76:79], v23, s[48:51], s58 offen offset:3072 sc1
  s_waitcnt vmcnt(22)
  v_mfma_f32_16x16x32_bf16 v[128:131], a[120:123], v[80:83], v[128:131]
  v_mfma_f32_16x16x32_bf16 v[132:135], a[120:123], v[84:87], v[132:135]
  v_mfma_f32_16x16x32_bf16 v[136:139], a[124:127], v[80:83], v[136:139]
  v_mfma_f32_16x16x32_bf16 v[140:143], a[124:127], v[84:87], v[140:143]
  v_mfma_f32_16x16x32_bf16 v[144:147], a[128:131], v[80:83], v[144:147]
  v_mfma_f32_16x16x32_bf16 v[148:151], a[128:131], v[84:87], v[148:151]
  v_mfma_f32_16x16x32_bf16 v[152:155], a[132:135], v[80:83], v[152:155]
  v_mfma_f32_16x16x32_bf16 v[156:159], a[132:135], v[84:87], v[156:159]
  v_mfma_f32_16x16x32_bf16 v[160:163], a[136:139], v[80:83], v[160:163]
  v_mfma_f32_16x16x32_bf16 v[164:167], a[136:139], v[84:87], v[164:167]
  s_add_u32 s58, s73, 12288
  buffer_load_dwordx4 v[80:83], v23, s[48:51], s58 offen offset:0 sc1
  buffer_load_dwordx4 v[84:87], v23, s[48:51], s58 offen offset:1024 sc1
  s_waitcnt vmcnt(22)
  v_mfma_f32_16x16x32_bf16 v[128:131], a[140:143], v[88:91], v[128:131]
  v_mfma_f32_16x16x32_bf16 v[132:135], a[140:143], v[92:95], v[132:135]
  v_mfma_f32_16x16x32_bf16 v[136:139], a[144:147], v[88:91], v[136:139]
  v_mfma_f32_16x16x32_bf16 v[140:143], a[144:147], v[92:95], v[140:143]
  v_mfma_f32_16x16x32_bf16 v[144:147], a[148:151], v[88:91], v[144:147]
  v_mfma_f32_16x16x32_bf16 v[148:151], a[148:151], v[92:95], v[148:151]
  v_mfma_f32_16x16x32_bf16 v[152:155], a[152:155], v[88:91], v[152:155]
  v_mfma_f32_16x16x32_bf16 v[156:159], a[152:155], v[92:95], v[156:159]
  v_mfma_f32_16x16x32_bf16 v[160:163], a[156:159], v[88:91], v[160:163]
  v_mfma_f32_16x16x32_bf16 v[164:167], a[156:159], v[92:95], v[164:167]
  buffer_load_dwordx4 v[88:91], v23, s[48:51], s58 offen offset:2048 sc1
  buffer_load_dwordx4 v[92:95], v23, s[48:51], s58 offen offset:3072 sc1
  s_waitcnt vmcnt(22)
  v_mfma_f32_16x16x32_bf16 v[128:131], a[160:163], v[96:99], v[128:131]
  v_mfma_f32_16x16x32_bf16 v[132:135], a[160:163], v[100:103], v[132:135]
  v_mfma_f32_16x16x32_bf16 v[136:139], a[164:167], v[96:99], v[136:139]
  v_mfma_f32_16x16x32_bf16 v[140:143], a[164:167], v[100:103], v[140:143]
  v_mfma_f32_16x16x32_bf16 v[144:147], a[168:171], v[96:99], v[144:147]
  v_mfma_f32_16x16x32_bf16 v[148:151], a[168:171], v[100:103], v[148:151]
  v_mfma_f32_16x16x32_bf16 v[152:155], a[172:175], v[96:99], v[152:155]
  v_mfma_f32_16x16x32_bf16 v[156:159], a[172:175], v[100:103], v[156:159]
  v_mfma_f32_16x16x32_bf16 v[160:163], a[176:179], v[96:99], v[160:163]
  v_mfma_f32_16x16x32_bf16 v[164:167], a[176:179], v[100:103], v[164:167]
  s_add_u32 s58, s73, 16384
  buffer_load_dwordx4 v[96:99], v23, s[48:51], s58 offen offset:0 sc1
  buffer_load_dwordx4 v[100:103], v23, s[48:51], s58 offen offset:1024 sc1
  s_waitcnt vmcnt(22)
  v_mfma_f32_16x16x32_bf16 v[128:131], a[180:183], v[104:107], v[128:131]
  v_mfma_f32_16x16x32_bf16 v[132:135], a[180:183], v[108:111], v[132:135]
  v_mfma_f32_16x16x32_bf16 v[136:139], a[184:187], v[104:107], v[136:139]
  v_mfma_f32_16x16x32_bf16 v[140:143], a[184:187], v[108:111], v[140:143]
  v_mfma_f32_16x16x32_bf16 v[144:147], a[188:191], v[104:107], v[144:147]
  v_mfma_f32_16x16x32_bf16 v[148:151], a[188:191], v[108:111], v[148:151]
  v_mfma_f32_16x16x32_bf16 v[152:155], a[192:195], v[104:107], v[152:155]
  v_mfma_f32_16x16x32_bf16 v[156:159], a[192:195], v[108:111], v[156:159]
  v_mfma_f32_16x16x32_bf16 v[160:163], a[196:199], v[104:107], v[160:163]
  v_mfma_f32_16x16x32_bf16 v[164:167], a[196:199], v[108:111], v[164:167]
  buffer_load_dwordx4 v[104:107], v23, s[48:51], s58 offen offset:2048 sc1
  buffer_load_dwordx4 v[108:111], v23, s[48:51], s58 offen offset:3072 sc1
  s_waitcnt vmcnt(22)
  v_mfma_f32_16x16x32_bf16 v[128:131], a[200:203], v[112:115], v[128:131]
  v_mfma_f32_16x16x32_bf16 v[132:135], a[200:203], v[116:119], v[132:135]
  v_mfma_f32_16x16x32_bf16 v[136:139], a[204:207], v[112:115], v[136:139]
  v_mfma_f32_16x16x32_bf16 v[140:143], a[204:207], v[116:119], v[140:143]
  v_mfma_f32_16x16x32_bf16 v[144:147], a[208:211], v[112:115], v[144:147]
  v_mfma_f32_16x16x32_bf16 v[148:151], a[208:211], v[116:119], v[148:151]
  v_mfma_f32_16x16x32_bf16 v[152:155], a[212:215], v[112:115], v[152:155]
  v_mfma_f32_16x16x32_bf16 v[156:159], a[212:215], v[116:119], v[156:159]
  v_mfma_f32_16x16x32_bf16 v[160:163], a[216:219], v[112:115], v[160:163]
  v_mfma_f32_16x16x32_bf16 v[164:167], a[216:219], v[116:119], v[164:167]
  s_add_u32 s58, s73, 20480
  buffer_load_dwordx4 v[112:115], v23, s[48:51], s58 offen offset:0 sc1
  buffer_load_dwordx4 v[116:119], v23, s[48:51], s58 offen offset:1024 sc1
  s_waitcnt vmcnt(22)
  v_mfma_f32_16x16x32_bf16 v[128:131], a[220:223], v[120:123], v[128:131]
  v_mfma_f32_16x16x32_bf16 v[132:135], a[220:223], v[124:127], v[132:135]
  v_mfma_f32_16x16x32_bf16 v[136:139], a[224:227], v[120:123], v[136:139]
  v_mfma_f32_16x16x32_bf16 v[140:143], a[224:227], v[124:127], v[140:143]
  v_mfma_f32_16x16x32_bf16 v[144:147], a[228:231], v[120:123], v[144:147]
  v_mfma_f32_16x16x32_bf16 v[148:151], a[228:231], v[124:127], v[148:151]
  v_mfma_f32_16x16x32_bf16 v[152:155], a[232:235], v[120:123], v[152:155]
  v_mfma_f32_16x16x32_bf16 v[156:159], a[232:235], v[124:127], v[156:159]
  v_mfma_f32_16x16x32_bf16 v[160:163], a[236:239], v[120:123], v[160:163]
  v_mfma_f32_16x16x32_bf16 v[164:167], a[236:239], v[124:127], v[164:167]
  buffer_load_dwordx4 v[120:123], v23, s[48:51], s58 offen offset:2048 sc1
  buffer_load_dwordx4 v[124:127], v23, s[48:51], s58 offen offset:3072 sc1
  s_branch t3x_7095
t3b_7094:
  s_waitcnt vmcnt(22)
  v_mfma_f32_16x16x32_bf16 v[128:131], a[0:3], v[32:35], 0
  v_mfma_f32_16x16x32_bf16 v[132:135], a[0:3], v[36:39], 0
  v_mfma_f32_16x16x32_bf16 v[136:139], a[4:7], v[32:35], 0
  v_mfma_f32_16x16x32_bf16 v[140:143], a[4:7], v[36:39], 0
  v_mfma_f32_16x16x32_bf16 v[144:147], a[8:11], v[32:35], 0
  v_mfma_f32_16x16x32_bf16 v[148:151], a[8:11], v[36:39], 0
  v_mfma_f32_16x16x32_bf16 v[152:155], a[12:15], v[32:35], 0
  v_mfma_f32_16x16x32_bf16 v[156:159], a[12:15], v[36:39], 0
  v_mfma_f32_16x16x32_bf16 v[160:163], a[16:19], v[32:35], 0
  v_mfma_f32_16x16x32_bf16 v[164:167], a[16:19], v[36:39], 0
  s_waitcnt vmcnt(20)
  v_mfma_f32_16x16x32_bf16 v[128:131], a[20:23], v[40:43], v[128:131]
  v_mfma_f32_16x16x32_bf16 v[132:135], a[20:23], v[44:47], v[132:135]
  v_mfma_f32_16x16x32_bf16 v[136:139], a[24:27], v[40:43], v[136:139]
  v_mfma_f32_16x16x32_bf16 v[140:143], a[24:27], v[44:47], v[140:143]
  v_mfma_f32_16x16x32_bf16 v[144:147], a[28:31], v[40:43], v[144:147]
  v_mfma_f32_16x16x32_bf16 v[148:151], a[28:31], v[44:47], v[148:151]
  v_mfma_f32_16x16x32_bf16 v[152:155], a[32:35], v[40:43], v[152:155]
  v_mfma_f32_16x16x32_bf16 v[156:159], a[32:35], v[44:47], v[156:159]
  v_mfma_f32_16x16x32_bf16 v[160:163], a[36:39], v[40:43], v[160:163]
  v_mfma_f32_16x16x32_bf16 v[164:167], a[36:39], v[44:47], v[164:167]
  s_waitcnt vmcnt(18)
  v_mfma_f32_16x16x32_bf16 v[128:131], a[40:43], v[48:51], v[128:131]
  v_mfma_f32_16x16x32_bf16 v[132:135], a[40:43], v[52:55], v[132:135]
  v_mfma_f32_16x16x32_bf16 v[136:139], a[44:47], v[48:51], v[136:139]
  v_mfma_f32_16x16x32_bf16 v[140:143], a[44:47], v[52:55], v[140:143]
  v_mfma_f32_16x16x32_bf16 v[144:147], a[48:51], v[48:51], v[144:147]
  v_mfma_f32_16x16x32_bf16 v[148:151], a[48:51], v[52:55], v[148:151]
  v_mfma_f32_16x16x32_bf16 v[152:155], a[52:55], v[48:51], v[152:155]
  v_mfma_f32_16x16x32_bf16 v[156:159], a[52:55], v[52:55], v[156:159]
  v_mfma_f32_16x16x32_bf16 v[160:163], a[56:59], v[48:51], v[160:163]
  v_mfma_f32_16x16x32_bf16 v[164:167], a[56:59], v[52:55], v[164:167]
  s_waitcnt vmcnt(16)
  v_mfma_f32_16x16x32_bf16 v[128:131], a[60:63], v[56:59], v[128:131]
  v_mfma_f32_16x16x32_bf16 v[132:135], a[60:63], v[60:63], v[132:135]
  v_mfma_f32_16x16x32_bf16 v[136:139], a[64:67], v[56:59], v[136:139]
  v_mfma_f32_16x16x32_bf16 v[140:143], a[64:67], v[60:63], v[140:143]
  v_mfma_f32_16x16x32_bf16 v[144:147], a[68:71], v[56:59], v[144:147]
  v_mfma_f32_16x16x32_bf16 v[148:151], a[68:71], v[60:63], v[148:151]
  v_mfma_f32_16x16x32_bf16 v[152:155], a[72:75], v[56:59], v[152:155]
  v_mfma_f32_16x16x32_bf16 v[156:159], a[72:75], v[60:63], v[156:159]
  v_mfma_f32_16x16x32_bf16 v[160:163], a[76:79], v[56:59], v[160:163]
  v_mfma_f32_16x16x32_bf16 v[164:167], a[76:79], v[60:63], v[164:167]
  s_waitcnt vmcnt(14)
  v_mfma_f32_16x16x32_bf16 v[128:131], a[80:83], v[64:67], v[128:131]
  v_mfma_f32_16x16x32_bf16 v[132:135], a[80:83], v[68:71], v[132:135]
  v_mfma_f32_16x16x32_bf16 v[136:139], a[84:87], v[64:67], v[136:139]
  v_mfma_f32_16x16x32_bf16 v[140:143], a[84:87], v[68:71], v[140:143]
  v_mfma_f32_16x16x32_bf16 v[144:147], a[88:91], v[64:67], v[144:147]
  v_mfma_f32_16x16x32_bf16 v[148:151], a[88:91], v[68:71], v[148:151]
  v_mfma_f32_16x16x32_bf16 v[152:155], a[92:95], v[64:67], v[152:155]
  v_mfma_f32_16x16x32_bf16 v[156:159], a[92:95], v[68:71], v[156:159]
  v_mfma_f32_16x16x32_bf16 v[160:163], a[96:99], v[64:67], v[160:163]
  v_mfma_f32_16x16x32_bf16 v[164:167], a[96:99], v[68:71], v[164:167]
  s_waitcnt vmcnt(12)
  v_mfma_f32_16x16x32_bf16 v[128:131], a[100:103], v[72:75], v[128:131]
  v_mfma_f32_16x16x32_bf16 v[132:135], a[100:103], v[76:79], v[132:135]
  v_mfma_f32_16x16x32_bf16 v[136:139], a[104:107], v[72:75], v[136:139]
  v_mfma_f32_16x16x32_bf16 v[140:143], a[104:107], v[76:79], v[140:143]
  v_mfma_f32_16x16x32_bf16 v[144:147], a[108:111], v[72:75], v[144:147]
  v_mfma_f32_16x16x32_bf16 v[148:151], a[108:111], v[76:79], v[148:151]
  v_mfma_f32_16x16x32_bf16 v[152:155], a[112:115], v[72:75], v[152:155]
  v_mfma_f32_16x16x32_bf16 v[156:159], a[112:115], v[76:79], v[156:159]
  v_mfma_f32_16x16x32_bf16 v[160:163], a[116:119], v[72:75], v[160:163]
  v_mfma_f32_16x16x32_bf16 v[164:167], a[116:119], v[76:79], v[164:167]
  s_waitcnt vmcnt(10)
  v_mfma_f32_16x16x32_bf16 v[128:131], a[120:123], v[80:83], v[128:131]
  v_mfma_f32_16x16x32_bf16 v[132:135], a[120:123], v[84:87], v[132:135]
  v_mfma_f32_16x16x32_bf16 v[136:139], a[124:127], v[80:83], v[136:139]
  v_mfma_f32_16x16x32_bf16 v[140:143], a[124:127], v[84:87], v[140:143]
  v_mfma_f32_16x16x32_bf16 v[144:147], a[128:131], v[80:83], v[144:147]
  v_mfma_f32_16x16x32_bf16 v[148:151], a[128:131], v[84:87], v[148:151]
  v_mfma_f32_16x16x32_bf16 v[152:155], a[132:135], v[80:83], v[152:155]
  v_mfma_f32_16x16x32_bf16 v[156:159], a[132:135], v[84:87], v[156:159]
  v_mfma_f32_16x16x32_bf16 v[160:163], a[136:139], v[80:83], v[160:163]
  v_mfma_f32_16x16x32_bf16 v[164:167], a[136:139], v[84:87], v[164:167]
  s_waitcnt vmcnt(8)
  v_mfma_f32_16x16x32_bf16 v[128:131], a[140:143], v[88:91], v[128:131]
  v_mfma_f32_16x16x32_bf16 v[132:135], a[140:143], v[92:95], v[132:135]
  v_mfma_f32_16x16x32_bf16 v[136:139], a[144:147], v[88:91], v[136:139]
  v_mfma_f32_16x16x32_bf16 v[140:143], a[144:147], v[92:95], v[140:143]
  v_mfma_f32_16x16x32_bf16 v[144:147], a[148:151], v[88:91], v[144:147]
  v_mfma_f32_16x16x32_bf16 v[148:151], a[148:151], v[92:95], v[148:151]
  v_mfma_f32_16x16x32_bf16 v[152:155], a[152:155], v[88:91], v[152:155]
  v_mfma_f32_16x16x32_bf16 v[156:159], a[152:155], v[92:95], v[156:159]
  v_mfma_f32_16x16x32_bf16 v[160:163], a[156:159], v[88:91], v[160:163]
  v_mfma_f32_16x16x32_bf16 v[164:167], a[156:159], v[92:95], v[164:167]
  s_waitcnt vmcnt(6)
  v_mfma_f32_16x16x32_bf16 v[128:131], a[160:163], v[96:99], v[128:131]
  v_mfma_f32_16x16x32_bf16 v[132:135], a[160:163], v[100:103], v[132:135]
  v_mfma_f32_16x16x32_bf16 v[136:139], a[164:167], v[96:99], v[136:139]
  v_mfma_f32_16x16x32_bf16 v[140:143], a[164:167], v[100:103], v[140:143]
  v_mfma_f32_16x16x32_bf16 v[144:147], a[168:171], v[96:99], v[144:147]
  v_mfma_f32_16x16x32_bf16 v[148:151], a[168:171], v[100:103], v[148:151]
  v_mfma_f32_16x16x32_bf16 v[152:155], a[172:175], v[96:99], v[152:155]
  v_mfma_f32_16x16x32_bf16 v[156:159], a[172:175], v[100:103], v[156:159]
  v_mfma_f32_16x16x32_bf16 v[160:163], a[176:179], v[96:99], v[160:163]
  v_mfma_f32_16x16x32_bf16 v[164:167], a[176:179], v[100:103], v[164:167]
  s_waitcnt vmcnt(4)
  v_mfma_f32_16x16x32_bf16 v[128:131], a[180:183], v[104:107], v[128:131]
  v_mfma_f32_16x16x32_bf16 v[132:135], a[180:183], v[108:111], v[132:135]
  v_mfma_f32_16x16x32_bf16 v[136:139], a[184:187], v[104:107], v[136:139]
  v_mfma_f32_16x16x32_bf16 v[140:143], a[184:187], v[108:111], v[140:143]
  v_mfma_f32_16x16x32_bf16 v[144:147], a[188:191], v[104:107], v[144:147]
  v_mfma_f32_16x16x32_bf16 v[148:151], a[188:191], v[108:111], v[148:151]
  v_mfma_f32_16x16x32_bf16 v[152:155], a[192:195], v[104:107], v[152:155]
  v_mfma_f32_16x16x32_bf16 v[156:159], a[192:195], v[108:111], v[156:159]
  v_mfma_f32_16x16x32_bf16 v[160:163], a[196:199], v[104:107], v[160:163]
  v_mfma_f32_16x16x32_bf16 v[164:167], a[196:199], v[108:111], v[164:167]
  s_waitcnt vmcnt(2)
  v_mfma_f32_16x16x32_bf16 v[128:131], a[200:203], v[112:115], v[128:131]
  v_mfma_f32_16x16x32_bf16 v[132:135], a[200:203], v[116:119], v[132:135]
  v_mfma_f32_16x16x32_bf16 v[136:139], a[204:207], v[112:115], v[136:139]
  v_mfma_f32_16x16x32_bf16 v[140:143], a[204:207], v[116:119], v[140:143]
  v_mfma_f32_16x16x32_bf16 v[144:147], a[208:211], v[112:115], v[144:147]
  v_mfma_f32_16x16x32_bf16 v[148:151], a[208:211], v[116:119], v[148:151]
  v_mfma_f32_16x16x32_bf16 v[152:155], a[212:215], v[112:115], v[152:155]
  v_mfma_f32_16x16x32_bf16 v[156:159], a[212:215], v[116:119], v[156:159]
  v_mfma_f32_16x16x32_bf16 v[160:163], a[216:219], v[112:115], v[160:163]
  v_mfma_f32_16x16x32_bf16 v[164:167], a[216:219], v[116:119], v[164:167]
  s_waitcnt vmcnt(0)
  v_mfma_f32_16x16x32_bf16 v[128:131], a[220:223], v[120:123], v[128:131]
  v_mfma_f32_16x16x32_bf16 v[132:135], a[220:223], v[124:127], v[132:135]
  v_mfma_f32_16x16x32_bf16 v[136:139], a[224:227], v[120:123], v[136:139]
  v_mfma_f32_16x16x32_bf16 v[140:143], a[224:227], v[124:127], v[140:143]
  v_mfma_f32_16x16x32_bf16 v[144:147], a[228:231], v[120:123], v[144:147]
  v_mfma_f32_16x16x32_bf16 v[148:151], a[228:231], v[124:127], v[148:151]
  v_mfma_f32_16x16x32_bf16 v[152:155], a[232:235], v[120:123], v[152:155]
  v_mfma_f32_16x16x32_bf16 v[156:159], a[232:235], v[124:127], v[156:159]
  v_mfma_f32_16x16x32_bf16 v[160:163], a[236:239], v[120:123], v[160:163]
  v_mfma_f32_16x16x32_bf16 v[164:167], a[236:239], v[124:127], v[164:167]
t3x_7095:
  s_cmp_eq_u32 s68, 63
  s_cbranch_scc1 t3q_7096
  buffer_load_dword v31, v25, s[48:51], 0 offen sc1
  buffer_load_dword v30, v24, s[48:51], 0 offen sc1
t3q_7096:
  s_nop 1
  ds_write_b128 v27, v[128:131] offset:0
  ds_write_b128 v27, v[132:135] offset:1024
  ds_write_b128 v27, v[136:139] offset:2048
  ds_write_b128 v27, v[140:143] offset:3072
  ds_write_b128 v27, v[144:147] offset:4096
  ds_write_b128 v27, v[148:151] offset:5120
  ds_write_b128 v27, v[152:155] offset:6144
  ds_write_b128 v27, v[156:159] offset:7168
  ds_write_b128 v27, v[160:163] offset:8192
  ds_write_b128 v27, v[164:167] offset:9216
  s_waitcnt lgkmcnt(0)
  s_barrier
  ds_read_b128 v[168:171], v28 offset:0
  ds_read_b128 v[172:175], v28 offset:10240
  ds_read_b128 v[176:179], v28 offset:20480
  ds_read_b128 v[180:183], v28 offset:30720
  s_waitcnt vmcnt(0)
  s_nop 1
  v_min_u32_dpp v30, v30, v30 row_ror:4 row_mask:0xf bank_mask:0xf
  s_nop 1
  v_min_u32_dpp v30, v30, v30 row_ror:2 row_mask:0xf bank_mask:0xf
  s_nop 1
  v_min_u32_dpp v30, v30, v30 row_ror:1 row_mask:0xf bank_mask:0xf
  s_nop 0
  v_readlane_b32 s72, v30, 0
  s_nop 1
  v_min_u32_dpp v31, v31, v31 row_ror:8 row_mask:0xf bank_mask:0xf
  s_nop 1
  v_min_u32_dpp v31, v31, v31 row_ror:4 row_mask:0xf bank_mask:0xf
  s_nop 1
  v_min_u32_dpp v31, v31, v31 row_ror:2 row_mask:0xf bank_mask:0xf
  s_nop 1
  v_min_u32_dpp v31, v31, v31 row_ror:1 row_mask:0xf bank_mask:0xf
  s_nop 0
  v_readlane_b32 s66, v31, 0
  s_cmp_eq_u32 s71, 0
  s_cbranch_scc1 t3p_7098
  s_add_u32 s58, s68, 0
  v_mov_b32 v18, s58
  s_mov_b64 exec, 1
  buffer_store_dword v18, v26, s[48:51], 0 offen sc1
  s_mov_b64 exec, -1
t3p_7098:
  s_cmp_eq_u32 s70, 1
  s_cbranch_scc1 t3l_7099
  s_add_u32 s60, s68, 2
  s_cmp_ge_u32 s72, s60
  s_cbranch_scc0 t3l_7099
  s_add_u32 s58, s73, 0
  buffer_load_dwordx4 v[32:35], v23, s[48:51], s58 offen offset:0 sc1
  buffer_load_dwordx4 v[36:39], v23, s[48:51], s58 offen offset:1024 sc1
  buffer_load_dwordx4 v[40:43], v23, s[48:51], s58 offen offset:2048 sc1
  buffer_load_dwordx4 v[44:47], v23, s[48:51], s58 offen offset:3072 sc1
  s_add_u32 s58, s73, 4096
  buffer_load_dwordx4 v[48:51], v23, s[48:51], s58 offen offset:0 sc1
  buffer_load_dwordx4 v[52:55], v23, s[48:51], s58 offen offset:1024 sc1
  buffer_load_dwordx4 v[56:59], v23, s[48:51], s58 offen offset:2048 sc1
  buffer_load_dwordx4 v[60:63], v23, s[48:51], s58 offen offset:3072 sc1
  s_add_u32 s58, s73, 8192
  buffer_load_dwordx4 v[64:67], v23, s[48:51], s58 offen offset:0 sc1
  buffer_load_dwordx4 v[68:71], v23, s[48:51], s58 offen offset:1024 sc1
  buffer_load_dwordx4 v[72:75], v23, s[48:51], s58 offen offset:2048 sc1
  buffer_load_dwordx4 v[76:79], v23, s[48:51], s58 offen offset:3072 sc1
  s_add_u32 s58, s73, 12288
  buffer_load_dwordx4 v[80:83], v23, s[48:51], s58 offen offset:0 sc1
  buffer_load_dwordx4 v[84:87], v23, s[48:51], s58 offen offset:1024 sc1
  buffer_load_dwordx4 v[88:91], v23, s[48:51], s58 offen offset:2048 sc1
  buffer_load_dwordx4 v[92:95], v23, s[48:51], s58 offen offset:3072 sc1
  s_add_u32 s58, s73, 16384
  buffer_load_dwordx4 v[96:99], v23, s[48:51], s58 offen offset:0 sc1
  buffer_load_dwordx4 v[100:103], v23, s[48:51], s58 offen offset:1024 sc1
  buffer_load_dwordx4 v[104:107], v23, s[48:51], s58 offen offset:2048 sc1
  buffer_load_dwordx4 v[108:111], v23, s[48:51], s58 offen offset:3072 sc1
  s_add_u32 s58, s73, 20480
  buffer_load_dwordx4 v[112:115], v23, s[48:51], s58 offen offset:0 sc1
  buffer_load_dwordx4 v[116:119], v23, s[48:51], s58 offen offset:1024 sc1
  buffer_load_dwordx4 v[120:123], v23, s[48:51], s58 offen offset:2048 sc1
  buffer_load_dwordx4 v[124:127], v23, s[48:51], s58 offen offset:3072 sc1
  s_mov_b32 s70, 1
t3l_7099:
  s_waitcnt lgkmcnt(2)
  v_add_f32 v168, v168, v172
  v_add_f32 v169, v169, v173
  v_add_f32 v170, v170, v174
  v_add_f32 v171, v171, v175
  s_waitcnt lgkmcnt(0)
  v_add_f32 v176, v176, v180
  v_add_f32 v177, v177, v181
  v_add_f32 v178, v178, v182
  v_add_f32 v179, v179, v183
  v_add_f32 v128, v168, v176
  v_add_f32 v129, v169, v177
  v_add_f32 v130, v170, v178
  v_add_f32 v131, v171, v179
  buffer_store_dwordx4 v[128:131], v29, s[48:51], s65 offen offset:0 sc1
t3r_7097:
  ds_read_b128 v[168:171], v28 offset:4096
  ds_read_b128 v[172:175], v28 offset:14336
  ds_read_b128 v[176:179], v28 offset:24576
  ds_read_b128 v[180:183], v28 offset:34816
  s_waitcnt lgkmcnt(2)
  v_add_f32 v168, v168, v172
  v_add_f32 v169, v169, v173
  v_add_f32 v170, v170, v174
  v_add_f32 v171, v171, v175
  s_waitcnt lgkmcnt(0)
  v_add_f32 v176, v176, v180
  v_add_f32 v177, v177, v181
  v_add_f32 v178, v178, v182
  v_add_f32 v179, v179, v183
  v_add_f32 v132, v168, v176
  v_add_f32 v133, v169, v177
  v_add_f32 v134, v170, v178
  v_add_f32 v135, v171, v179
  buffer_store_dwordx4 v[132:135], v29, s[48:51], s65 offen offset:128 sc1
t3r_7100:
  s_cmp_ge_u32 s52, 2
  s_cbranch_scc1 t3r_7101
  ds_read_b128 v[168:171], v28 offset:8192
  ds_read_b128 v[172:175], v28 offset:18432
  ds_read_b128 v[176:179], v28 offset:28672
  ds_read_b128 v[180:183], v28 offset:38912
  s_waitcnt lgkmcnt(2)
  v_add_f32 v168, v168, v172
  v_add_f32 v169, v169, v173
  v_add_f32 v170, v170, v174
  v_add_f32 v171, v171, v175
  s_waitcnt lgkmcnt(0)
  v_add_f32 v176, v176, v180
  v_add_f32 v177, v177, v181
  v_add_f32 v178, v178, v182
  v_add_f32 v179, v179, v183
  v_add_f32 v136, v168, v176
  v_add_f32 v137, v169, v177
  v_add_f32 v138, v170, v178
  v_add_f32 v139, v171, v179
  buffer_store_dwordx4 v[136:139], v29, s[48:51], s65 offen offset:256 sc1
t3r_7101:
  v_xor_b32 v27, 0x10000, v27
  v_xor_b32 v28, 0x10000, v28
  s_mov_b32 s69, s70
  s_mov_b32 s71, s70
  s_cmp_eq_u32 s70, 1
  s_cbranch_scc1 t3d_7102
  s_waitcnt vmcnt(0)
  s_add_u32 s58, s68, 1
  v_mov_b32 v18, s58
  s_mov_b64 exec, 1
  buffer_store_dword v18, v26, s[48:51], 0 offen sc1
  s_mov_b64 exec, -1
t3d_7102:
  s_sub_u32 s67, s68, 2
  s_and_b32 s58, s67, 3
  s_cmp_lt_u32 s68, 2
  s_cbranch_scc1 t3n_7103
  s_cmp_lg_u32 s58, s53
  s_cbranch_scc1 t3n_7103
  s_cmp_ge_u32 s68, 62
  s_cbranch_scc1 t3n_7103
  s_cmp_eq_u32 s74, 1
  s_cbranch_scc0 t3fl_7104
  s_mul_i32 s61, s67, 81920
  v_add_f32 v192, v192, v196
  v_add_f32 v200, v200, v204
  v_add_f32 v193, v193, v197
  v_add_f32 v201, v201, v205
  v_add_f32 v194, v194, v198
  v_add_f32 v202, v202, v206
  v_add_f32 v195, v195, v199
  v_add_f32 v203, v203, v207
  v_add_f32 v192, v192, v200
  v_add_f32 v193, v193, v201
  v_add_f32 v194, v194, v202
  v_add_f32 v195, v195, v203
  v_cvt_pk_bf16_f32 v192, v192, v193
  v_cvt_pk_bf16_f32 v193, v194, v195
  buffer_store_dwordx2 v[192:193], v187, s[40:43], s61 offen
t3s_7105:
  v_add_f32 v208, v208, v212
  v_add_f32 v216, v216, v220
  v_add_f32 v209, v209, v213
  v_add_f32 v217, v217, v221
  v_add_f32 v210, v210, v214
  v_add_f32 v218, v218, v222
  v_add_f32 v211, v211, v215
  v_add_f32 v219, v219, v223
  v_add_f32 v208, v208, v216
  v_add_f32 v209, v209, v217
  v_add_f32 v210, v210, v218
  v_add_f32 v211, v211, v219
  v_cvt_pk_bf16_f32 v208, v208, v209
  v_cvt_pk_bf16_f32 v209, v210, v211
  buffer_store_dwordx2 v[208:209], v188, s[40:43], s61 offen
t3s_7106:
  s_cmp_ge_u32 s52, 2
  s_cbranch_scc1 t3s_7107
  v_add_f32 v224, v224, v228
  v_add_f32 v232, v232, v236
  v_add_f32 v225, v225, v229
  v_add_f32 v233, v233, v237
  v_add_f32 v226, v226, v230
  v_add_f32 v234, v234, v238
  v_add_f32 v227, v227, v231
  v_add_f32 v235, v235, v239
  v_add_f32 v224, v224, v232
  v_add_f32 v225, v225, v233
  v_add_f32 v226, v226, v234
  v_add_f32 v227, v227, v235
  v_cvt_pk_bf16_f32 v224, v224, v225
  v_cvt_pk_bf16_f32 v225, v226, v227
  buffer_store_dwordx2 v[224:225], v189, s[40:43], s61 offen
t3s_7107:
  s_branch t3n_7103
t3fl_7104:
  s_add_u32 s60, s67, 1
  s_cmp_ge_u32 s66, s60
  s_cbranch_scc1 t3fad_7109
  s_mov_b32 s56, 0
t3fa_7108:
  buffer_load_dword v18, v25, s[48:51], 0 offen sc1
  s_waitcnt vmcnt(0)
  s_nop 1
  v_min_u32_dpp v18, v18, v18 row_ror:8 row_mask:0xf bank_mask:0xf
  s_nop 1
  v_min_u32_dpp v18, v18, v18 row_ror:4 row_mask:0xf bank_mask:0xf
  s_nop 1
  v_min_u32_dpp v18, v18, v18 row_ror:2 row_mask:0xf bank_mask:0xf
  s_nop 1
  v_min_u32_dpp v18, v18, v18 row_ror:1 row_mask:0xf bank_mask:0xf
  s_nop 0
  v_readlane_b32 s66, v18, 0
  s_cmp_ge_u32 s66, s60
  s_cbranch_scc1 t3fad_7109
  s_cmp_lg_u32 s55, 0
  s_cbranch_scc1 t3fad_7109
  s_add_u32 s56, s56, 1
  s_cmp_lt_u32 s56, 0x20000
  s_cbranch_scc1 t3fa_7108
  s_mov_b32 s55, 1
t3fad_7109:
  s_mul_i32 s60, s67, 327680
  s_add_u32 s60, s60, 0x6200000
  s_add_u32 s58, s60, 0
  buffer_load_dwordx4 v[192:195], v184, s[48:51], s58 offen sc1
  s_add_u32 s58, s60, 81920
  buffer_load_dwordx4 v[196:199], v184, s[48:51], s58 offen sc1
  s_add_u32 s58, s60, 163840
  buffer_load_dwordx4 v[200:203], v184, s[48:51], s58 offen sc1
  s_add_u32 s58, s60, 245760
  buffer_load_dwordx4 v[204:207], v184, s[48:51], s58 offen sc1
t3k_7110:
  s_add_u32 s58, s60, 0
  buffer_load_dwordx4 v[208:211], v185, s[48:51], s58 offen sc1
  s_add_u32 s58, s60, 81920
  buffer_load_dwordx4 v[212:215], v185, s[48:51], s58 offen sc1
  s_add_u32 s58, s60, 163840
  buffer_load_dwordx4 v[216:219], v185, s[48:51], s58 offen sc1
  s_add_u32 s58, s60, 245760
  buffer_load_dwordx4 v[220:223], v185, s[48:51], s58 offen sc1
t3k_7111:
  s_cmp_ge_u32 s52, 2
  s_cbranch_scc1 t3k_7112
  s_add_u32 s58, s60, 0
  buffer_load_dwordx4 v[224:227], v186, s[48:51], s58 offen sc1
  s_add_u32 s58, s60, 81920
  buffer_load_dwordx4 v[228:231], v186, s[48:51], s58 offen sc1
  s_add_u32 s58, s60, 163840
  buffer_load_dwordx4 v[232:235], v186, s[48:51], s58 offen sc1
  s_add_u32 s58, s60, 245760
  buffer_load_dwordx4 v[236:239], v186, s[48:51], s58 offen sc1
t3k_7112:
  s_waitcnt vmcnt(0)
  s_mul_i32 s61, s67, 81920
  v_add_f32 v192, v192, v196
  v_add_f32 v200, v200, v204
  v_add_f32 v193, v193, v197
  v_add_f32 v201, v201, v205
  v_add_f32 v194, v194, v198
  v_add_f32 v202, v202, v206
  v_add_f32 v195, v195, v199
  v_add_f32 v203, v203, v207
  v_add_f32 v192, v192, v200
  v_add_f32 v193, v193, v201
  v_add_f32 v194, v194, v202
  v_add_f32 v195, v195, v203
  v_cvt_pk_bf16_f32 v192, v192, v193
  v_cvt_pk_bf16_f32 v193, v194, v195
  buffer_store_dwordx2 v[192:193], v187, s[40:43], s61 offen
t3s_7113:
  v_add_f32 v208, v208, v212
  v_add_f32 v216, v216, v220
  v_add_f32 v209, v209, v213
  v_add_f32 v217, v217, v221
  v_add_f32 v210, v210, v214
  v_add_f32 v218, v218, v222
  v_add_f32 v211, v211, v215
  v_add_f32 v219, v219, v223
  v_add_f32 v208, v208, v216
  v_add_f32 v209, v209, v217
  v_add_f32 v210, v210, v218
  v_add_f32 v211, v211, v219
  v_cvt_pk_bf16_f32 v208, v208, v209
  v_cvt_pk_bf16_f32 v209, v210, v211
  buffer_store_dwordx2 v[208:209], v188, s[40:43], s61 offen
t3s_7114:
  s_cmp_ge_u32 s52, 2
  s_cbranch_scc1 t3s_7115
  v_add_f32 v224, v224, v228
  v_add_f32 v232, v232, v236
  v_add_f32 v225, v225, v229
  v_add_f32 v233, v233, v237
  v_add_f32 v226, v226, v230
  v_add_f32 v234, v234, v238
  v_add_f32 v227, v227, v231
  v_add_f32 v235, v235, v239
  v_add_f32 v224, v224, v232
  v_add_f32 v225, v225, v233
  v_add_f32 v226, v226, v234
  v_add_f32 v227, v227, v235
  v_cvt_pk_bf16_f32 v224, v224, v225
  v_cvt_pk_bf16_f32 v225, v226, v227
  buffer_store_dwordx2 v[224:225], v189, s[40:43], s61 offen
t3s_7115:
t3n_7103:
  s_add_u32 s64, s64, 393216
  s_add_u32 s65, s65, 327680
  s_add_u32 s68, s68, 1
  s_cmp_lt_u32 s68, 64
  s_cbranch_scc1 L_t3_r
  s_add_u32 s67, s53, 60
  s_add_u32 s60, s67, 1
  s_cmp_ge_u32 s66, s60
  s_cbranch_scc1 t3fbd_7118
  s_mov_b32 s56, 0
t3fb_7117:
  buffer_load_dword v18, v25, s[48:51], 0 offen sc1
  s_waitcnt vmcnt(0)
  s_nop 1
  v_min_u32_dpp v18, v18, v18 row_ror:8 row_mask:0xf bank_mask:0xf
  s_nop 1
  v_min_u32_dpp v18, v18, v18 row_ror:4 row_mask:0xf bank_mask:0xf
  s_nop 1
  v_min_u32_dpp v18, v18, v18 row_ror:2 row_mask:0xf bank_mask:0xf
  s_nop 1
  v_min_u32_dpp v18, v18, v18 row_ror:1 row_mask:0xf bank_mask:0xf
  s_nop 0
  v_readlane_b32 s66, v18, 0
  s_cmp_ge_u32 s66, s60
  s_cbranch_scc1 t3fbd_7118
  s_cmp_lg_u32 s55, 0
  s_cbranch_scc1 t3fbd_7118
  s_add_u32 s56, s56, 1
  s_cmp_lt_u32 s56, 0x20000
  s_cbranch_scc1 t3fb_7117
  s_mov_b32 s55, 1
t3fbd_7118:
  s_mul_i32 s60, s67, 327680
  s_add_u32 s60, s60, 0x6200000
  s_add_u32 s58, s60, 0
  buffer_load_dwordx4 v[192:195], v184, s[48:51], s58 offen sc1
  s_add_u32 s58, s60, 81920
  buffer_load_dwordx4 v[196:199], v184, s[48:51], s58 offen sc1
  s_add_u32 s58, s60, 163840
  buffer_load_dwordx4 v[200:203], v184, s[48:51], s58 offen sc1
  s_add_u32 s58, s60, 245760
  buffer_load_dwordx4 v[204:207], v184, s[48:51], s58 offen sc1
t3k_7119:
  s_add_u32 s58, s60, 0
  buffer_load_dwordx4 v[208:211], v185, s[48:51], s58 offen sc1
  s_add_u32 s58, s60, 81920
  buffer_load_dwordx4 v[212:215], v185, s[48:51], s58 offen sc1
  s_add_u32 s58, s60, 163840
  buffer_load_dwordx4 v[216:219], v185, s[48:51], s58 offen sc1
  s_add_u32 s58, s60, 245760
  buffer_load_dwordx4 v[220:223], v185, s[48:51], s58 offen sc1
t3k_7120:
  s_cmp_ge_u32 s52, 2
  s_cbranch_scc1 t3k_7121
  s_add_u32 s58, s60, 0
  buffer_load_dwordx4 v[224:227], v186, s[48:51], s58 offen sc1
  s_add_u32 s58, s60, 81920
  buffer_load_dwordx4 v[228:231], v186, s[48:51], s58 offen sc1
  s_add_u32 s58, s60, 163840
  buffer_load_dwordx4 v[232:235], v186, s[48:51], s58 offen sc1
  s_add_u32 s58, s60, 245760
  buffer_load_dwordx4 v[236:239], v186, s[48:51], s58 offen sc1
t3k_7121:
  s_waitcnt vmcnt(0)
  s_mul_i32 s61, s67, 81920
  v_add_f32 v192, v192, v196
  v_add_f32 v200, v200, v204
  v_add_f32 v193, v193, v197
  v_add_f32 v201, v201, v205
  v_add_f32 v194, v194, v198
  v_add_f32 v202, v202, v206
  v_add_f32 v195, v195, v199
  v_add_f32 v203, v203, v207
  v_add_f32 v192, v192, v200
  v_add_f32 v193, v193, v201
  v_add_f32 v194, v194, v202
  v_add_f32 v195, v195, v203
  v_cvt_pk_bf16_f32 v192, v192, v193
  v_cvt_pk_bf16_f32 v193, v194, v195
  buffer_store_dwordx2 v[192:193], v187, s[40:43], s61 offen
t3s_7122:
  v_add_f32 v208, v208, v212
  v_add_f32 v216, v216, v220
  v_add_f32 v209, v209, v213
  v_add_f32 v217, v217, v221
  v_add_f32 v210, v210, v214
  v_add_f32 v218, v218, v222
  v_add_f32 v211, v211, v215
  v_add_f32 v219, v219, v223
  v_add_f32 v208, v208, v216
  v_add_f32 v209, v209, v217
  v_add_f32 v210, v210, v218
  v_add_f32 v211, v211, v219
  v_cvt_pk_bf16_f32 v208, v208, v209
  v_cvt_pk_bf16_f32 v209, v210, v211
  buffer_store_dwordx2 v[208:209], v188, s[40:43], s61 offen
t3s_7123:
  s_cmp_ge_u32 s52, 2
  s_cbranch_scc1 t3s_7124
  v_add_f32 v224, v224, v228
  v_add_f32 v232, v232, v236
  v_add_f32 v225, v225, v229
  v_add_f32 v233, v233, v237
  v_add_f32 v226, v226, v230
  v_add_f32 v234, v234, v238
  v_add_f32 v227, v227, v231
  v_add_f32 v235, v235, v239
  v_add_f32 v224, v224, v232
  v_add_f32 v225, v225, v233
  v_add_f32 v226, v226, v234
  v_add_f32 v227, v227, v235
  v_cvt_pk_bf16_f32 v224, v224, v225
  v_cvt_pk_bf16_f32 v225, v226, v227
  buffer_store_dwordx2 v[224:225], v189, s[40:43], s61 offen
t3s_7124:
t3e_7116:
  s_waitcnt vmcnt(0)
  s_endpgm
L_to_irregular:
L_irregular:
  s_waitcnt vmcnt(0) lgkmcnt(0)
  s_barrier
  s_cmp_lg_u32 s52, 0
  s_cbranch_scc1 irr1_7125
  v_mov_b32 v3, 136
  v_mov_b32 v2, 1
  s_mov_b64 exec, 1
  buffer_atomic_add v2, v3, s[44:47], 0 offen sc0 sc1
  v_mov_b32 v3, 140
  v_mov_b32 v4, 1
  buffer_atomic_add v4, v3, s[44:47], 0 offen sc1
  s_waitcnt vmcnt(0)
  v_mov_b32 v3, 0
  ds_write_b32 v3, v2
  s_mov_b64 exec, -1
  s_waitcnt lgkmcnt(0)
irr1_7125:
  s_barrier
  v_mov_b32 v3, 0
  ds_read_b32 v2, v3
  s_waitcnt lgkmcnt(0)
  v_readfirstlane_b32 s58, v2
  s_barrier
  s_and_b32 s58, s58, 255
  s_lshr_b32 s53, s58, 5
  s_and_b32 s54, s58, 31
L_dispatch_i:
  s_cmp_lt_u32 s53, 4
  s_cbranch_scc0 L_bulk_i
  s_lshl_b32 s99, s53, 3
  s_lshr_b32 s58, s54, 2
  s_add_u32 s99, s99, s58
  s_and_b32 s3, s54, 3
  v_mov_b32 v30, v0
  v_mul_u32_u24 v31, 10923, v30
  v_lshrrev_b32 v31, 16, v31
  v_mul_u32_u24 v32, 6, v31
  v_sub_u32 v30, v30, v32
  v_mul_u32_u24 v31, 12288, v31
  v_lshlrev_b32 v30, 4, v30
  v_add_u32 v2, v30, v31
  v_add_u32 v30, 256, v0
  v_mul_u32_u24 v31, 10923, v30
  v_lshrrev_b32 v31, 16, v31
  v_mul_u32_u24 v32, 6, v31
  v_sub_u32 v30, v30, v32
  v_mul_u32_u24 v31, 12288, v31
  v_lshlrev_b32 v30, 4, v30
  v_add_u32 v3, v30, v31
  v_add_u32 v30, 512, v0
  v_mul_u32_u24 v31, 10923, v30
  v_lshrrev_b32 v31, 16, v31
  v_mul_u32_u24 v32, 6, v31
  v_sub_u32 v30, v30, v32
  v_mul_u32_u24 v31, 12288, v31
  v_lshlrev_b32 v30, 4, v30
  v_add_u32 v4, v30, v31
  v_add_u32 v30, 768, v0
  v_mul_u32_u24 v31, 10923, v30
  v_lshrrev_b32 v31, 16, v31
  v_mul_u32_u24 v32, 6, v31
  v_sub_u32 v30, v30, v32
  v_mul_u32_u24 v31, 12288, v31
  v_lshlrev_b32 v30, 4, v30
  v_add_u32 v5, v30, v31
  v_add_u32 v30, 1024, v0
  v_mul_u32_u24 v31, 10923, v30
  v_lshrrev_b32 v31, 16, v31
  v_mul_u32_u24 v32, 6, v31
  v_sub_u32 v30, v30, v32
  v_mul_u32_u24 v31, 12288, v31
  v_lshlrev_b32 v30, 4, v30
  v_add_u32 v6, v30, v31
  v_add_u32 v30, 1280, v0
  v_mul_u32_u24 v31, 10923, v30
  v_lshrrev_b32 v31, 16, v31
  v_mul_u32_u24 v32, 6, v31
  v_sub_u32 v30, v30, v32
  v_mul_u32_u24 v31, 12288, v31
  v_lshlrev_b32 v30, 4, v30
  v_add_u32 v7, v30, v31
  v_add_u32 v30, 1536, v0
  v_mul_u32_u24 v31, 10923, v30
  v_lshrrev_b32 v31, 16, v31
  v_mul_u32_u24 v32, 6, v31
  v_sub_u32 v30, v30, v32
  v_mul_u32_u24 v31, 12288, v31
  v_lshlrev_b32 v30, 4, v30
  v_add_u32 v8, v30, v31
  v_add_u32 v30, 1792, v0
  v_mul_u32_u24 v31, 10923, v30
  v_lshrrev_b32 v31, 16, v31
  v_mul_u32_u24 v32, 6, v31
  v_sub_u32 v30, v30, v32
  v_mul_u32_u24 v31, 12288, v31
  v_lshlrev_b32 v30, 4, v30
  v_add_u32 v9, v30, v31
  v_add_u32 v30, 2048, v0
  v_mul_u32_u24 v31, 10923, v30
  v_lshrrev_b32 v31, 16, v31
  v_mul_u32_u24 v32, 6, v31
  v_sub_u32 v30, v30, v32
  v_mul_u32_u24 v31, 12288, v31
  v_lshlrev_b32 v30, 4, v30
  v_add_u32 v10, v30, v31
  v_add_u32 v30, 2304, v0
  v_mul_u32_u24 v31, 10923, v30
  v_lshrrev_b32 v31, 16, v31
  v_mul_u32_u24 v32, 6, v31
  v_sub_u32 v30, v30, v32
  v_mul_u32_u24 v31, 12288, v31
  v_lshlrev_b32 v30, 4, v30
  v_add_u32 v11, v30, v31
  v_add_u32 v30, 2560, v0
  v_mul_u32_u24 v31, 10923, v30
  v_lshrrev_b32 v31, 16, v31
  v_mul_u32_u24 v32, 6, v31
  v_sub_u32 v30, v30, v32
  v_mul_u32_u24 v31, 12288, v31
  v_lshlrev_b32 v30, 4, v30
  v_add_u32 v12, v30, v31
  v_add_u32 v30, 2816, v0
  v_mul_u32_u24 v31, 10923, v30
  v_lshrrev_b32 v31, 16, v31
  v_mul_u32_u24 v32, 6, v31
  v_sub_u32 v30, v30, v32
  v_mul_u32_u24 v31, 12288, v31
  v_lshlrev_b32 v30, 4, v30
  v_add_u32 v13, v30, v31
  v_add_u32 v30, 3072, v0
  v_mul_u32_u24 v31, 10923, v30
  v_lshrrev_b32 v31, 16, v31
  v_mul_u32_u24 v32, 6, v31
  v_sub_u32 v30, v30, v32
  v_mul_u32_u24 v31, 12288, v31
  v_lshlrev_b32 v30, 4, v30
  v_add_u32 v14, v30, v31
  v_add_u32 v30, 3328, v0
  v_mul_u32_u24 v31, 10923, v30
  v_lshrrev_b32 v31, 16, v31
  v_mul_u32_u24 v32, 6, v31
  v_sub_u32 v30, v30, v32
  v_mul_u32_u24 v31, 12288, v31
  v_lshlrev_b32 v30, 4, v30
  v_add_u32 v15, v30, v31
  v_add_u32 v30, 3584, v0
  v_mul_u32_u24 v31, 10923, v30
  v_lshrrev_b32 v31, 16, v31
  v_mul_u32_u24 v32, 6, v31
  v_sub_u32 v30, v30, v32
  v_mul_u32_u24 v31, 12288, v31
  v_lshlrev_b32 v30, 4, v30
  v_add_u32 v16, v30, v31
  s_mul_i32 s2, s99, 384
  s_mul_i32 s58, s3, 96
  s_add_u32 s2, s2, s58
  s_lshl_b32 s60, s52, 10
  s_add_u32 s60, s60, 0x0
  s_add_u32 m0, s60, 0
  s_nop 0
  buffer_load_dwordx4 v2, s[12:15], s2 offen lds
  s_add_u32 m0, s60, 4096
  s_nop 0
  buffer_load_dwordx4 v3, s[12:15], s2 offen lds
  s_add_u32 m0, s60, 8192
  s_nop 0
  buffer_load_dwordx4 v4, s[12:15], s2 offen lds
  s_add_u32 m0, s60, 12288
  s_nop 0
  buffer_load_dwordx4 v5, s[12:15], s2 offen lds
  s_add_u32 m0, s60, 16384
  s_nop 0
  buffer_load_dwordx4 v6, s[12:15], s2 offen lds
  s_add_u32 m0, s60, 20480
  s_nop 0
  buffer_load_dwordx4 v7, s[12:15], s2 offen lds
  s_add_u32 m0, s60, 24576
  s_nop 0
  buffer_load_dwordx4 v8, s[12:15], s2 offen lds
  s_add_u32 m0, s60, 28672
  s_nop 0
  buffer_load_dwordx4 v9, s[12:15], s2 offen lds
  s_add_u32 m0, s60, 32768
  s_nop 0
  buffer_load_dwordx4 v10, s[12:15], s2 offen lds
  s_add_u32 m0, s60, 36864
  s_nop 0
  buffer_load_dwordx4 v11, s[12:15], s2 offen lds
  s_add_u32 m0, s60, 40960
  s_nop 0
  buffer_load_dwordx4 v12, s[12:15], s2 offen lds
  s_add_u32 m0, s60, 45056
  s_nop 0
  buffer_load_dwordx4 v13, s[12:15], s2 offen lds
  s_add_u32 m0, s60, 49152
  s_nop 0
  buffer_load_dwordx4 v14, s[12:15], s2 offen lds
  s_add_u32 m0, s60, 53248
  s_nop 0
  buffer_load_dwordx4 v15, s[12:15], s2 offen lds
  s_add_u32 m0, s60, 57344
  s_nop 0
  buffer_load_dwordx4 v16, s[12:15], s2 offen lds
  s_lshl_b32 s60, s52, 10
  s_add_u32 s60, s60, 0xf000
  s_add_u32 m0, s60, 0
  s_nop 0
  buffer_load_dwordx4 v2, s[16:19], s2 offen lds
  s_add_u32 m0, s60, 4096
  s_nop 0
  buffer_load_dwordx4 v3, s[16:19], s2 offen lds
  s_add_u32 m0, s60, 8192
  s_nop 0
  buffer_load_dwordx4 v4, s[16:19], s2 offen lds
  s_add_u32 m0, s60, 12288
  s_nop 0
  buffer_load_dwordx4 v5, s[16:19], s2 offen lds
  s_add_u32 m0, s60, 16384
  s_nop 0
  buffer_load_dwordx4 v6, s[16:19], s2 offen lds
  s_add_u32 m0, s60, 20480
  s_nop 0
  buffer_load_dwordx4 v7, s[16:19], s2 offen lds
  s_add_u32 m0, s60, 24576
  s_nop 0
  buffer_load_dwordx4 v8, s[16:19], s2 offen lds
  s_add_u32 m0, s60, 28672
  s_nop 0
  buffer_load_dwordx4 v9, s[16:19], s2 offen lds
  s_add_u32 m0, s60, 32768
  s_nop 0
  buffer_load_dwordx4 v10, s[16:19], s2 offen lds
  s_add_u32 m0, s60, 36864
  s_nop 0
  buffer_load_dwordx4 v11, s[16:19], s2 offen lds
  s_add_u32 m0, s60, 40960
  s_nop 0
  buffer_load_dwordx4 v12, s[16:19], s2 offen lds
  s_add_u32 m0, s60, 45056
  s_nop 0
  buffer_load_dwordx4 v13, s[16:19], s2 offen lds
  s_add_u32 m0, s60, 49152
  s_nop 0
  buffer_load_dwordx4 v14, s[16:19], s2 offen lds
  s_add_u32 m0, s60, 53248
  s_nop 0
  buffer_load_dwordx4 v15, s[16:19], s2 offen lds
  s_add_u32 m0, s60, 57344
  s_nop 0
  buffer_load_dwordx4 v16, s[16:19], s2 offen lds
  v_lshlrev_b32 v34, 1, v0
  s_mov_b32 s58, 0
  buffer_load_ushort v48, v34, s[8:11], s58 offen
  s_mov_b32 s58, 1280
  buffer_load_ushort v49, v34, s[8:11], s58 offen
  s_mov_b32 s58, 2560
  buffer_load_ushort v50, v34, s[8:11], s58 offen
  s_mov_b32 s58, 3840
  buffer_load_ushort v51, v34, s[8:11], s58 offen
  s_mov_b32 s58, 5120
  buffer_load_ushort v52, v34, s[8:11], s58 offen
  s_mov_b32 s58, 6400
  buffer_load_ushort v53, v34, s[8:11], s58 offen
  s_mov_b32 s58, 7680
  buffer_load_ushort v54, v34, s[8:11], s58 offen
  s_mov_b32 s58, 8960
  buffer_load_ushort v55, v34, s[8:11], s58 offen
m0_7126:
  s_mov_b32 s58, 512
  buffer_load_ushort v56, v34, s[8:11], s58 offen
  s_mov_b32 s58, 1792
  buffer_load_ushort v57, v34, s[8:11], s58 offen
  s_mov_b32 s58, 3072
  buffer_load_ushort v58, v34, s[8:11], s58 offen
  s_mov_b32 s58, 4352
  buffer_load_ushort v59, v34, s[8:11], s58 offen
  s_mov_b32 s58, 5632
  buffer_load_ushort v60, v34, s[8:11], s58 offen
  s_mov_b32 s58, 6912
  buffer_load_ushort v61, v34, s[8:11], s58 offen
  s_mov_b32 s58, 8192
  buffer_load_ushort v62, v34, s[8:11], s58 offen
  s_mov_b32 s58, 9472
  buffer_load_ushort v63, v34, s[8:11], s58 offen
m0_7127:
  s_cmp_ge_u32 s52, 2
  s_cbranch_scc1 m0_7128
  s_mov_b32 s58, 1024
  buffer_load_ushort v64, v34, s[8:11], s58 offen
  s_mov_b32 s58, 2304
  buffer_load_ushort v65, v34, s[8:11], s58 offen
  s_mov_b32 s58, 3584
  buffer_load_ushort v66, v34, s[8:11], s58 offen
  s_mov_b32 s58, 4864
  buffer_load_ushort v67, v34, s[8:11], s58 offen
  s_mov_b32 s58, 6144
  buffer_load_ushort v68, v34, s[8:11], s58 offen
  s_mov_b32 s58, 7424
  buffer_load_ushort v69, v34, s[8:11], s58 offen
  s_mov_b32 s58, 8704
  buffer_load_ushort v70, v34, s[8:11], s58 offen
  s_mov_b32 s58, 9984
  buffer_load_ushort v71, v34, s[8:11], s58 offen
m0_7128:
  v_and_b32 v31, 63, v0
  v_lshrrev_b32 v32, 2, v31
  v_and_b32 v33, 3, v31
  v_lshlrev_b32 v33, 3, v33
  v_mul_u32_u24 v17, 96, v32
  v_add_u32 v17, v17, v33
  v_mul_u32_u24 v18, 320, v32
  v_add_u32 v18, v18, v33
  s_mul_i32 s58, s52, 96
  s_add_u32 s58, s58, 61440
  v_add_u32 v18, s58, v18
  s_lshl_b32 s58, s52, 5
  v_add_u32 v19, s58, v17
  v_add_u32 v20, 61440, v19
  s_waitcnt vmcnt(31)
  s_barrier
  s_cmp_eq_u32 s52, 3
  s_cbranch_scc1 w3a_7129
  ds_read_b64_tr_b16 a[0:1], v19 offset:0
  ds_read_b64_tr_b16 a[2:3], v19 offset:1536
  ds_read_b64_tr_b16 a[4:5], v19 offset:3072
  ds_read_b64_tr_b16 a[6:7], v19 offset:4608
  ds_read_b64_tr_b16 a[8:9], v19 offset:6144
  ds_read_b64_tr_b16 a[10:11], v19 offset:7680
  ds_read_b64_tr_b16 a[12:13], v19 offset:9216
  ds_read_b64_tr_b16 a[14:15], v19 offset:10752
  s_waitcnt lgkmcnt(6)
  ds_read_b64_tr_b16 a[16:17], v19 offset:12288
  ds_read_b64_tr_b16 a[18:19], v19 offset:13824
  ds_read_b64_tr_b16 a[20:21], v19 offset:15360
  ds_read_b64_tr_b16 a[22:23], v19 offset:16896
  ds_read_b64_tr_b16 a[24:25], v19 offset:18432
  ds_read_b64_tr_b16 a[26:27], v19 offset:19968
  ds_read_b64_tr_b16 a[28:29], v19 offset:21504
  ds_read_b64_tr_b16 a[30:31], v19 offset:23040
  s_waitcnt lgkmcnt(6)
  ds_read_b64_tr_b16 a[32:33], v19 offset:24576
  ds_read_b64_tr_b16 a[34:35], v19 offset:26112
  ds_read_b64_tr_b16 a[36:37], v19 offset:27648
  ds_read_b64_tr_b16 a[38:39], v19 offset:29184
  ds_read_b64_tr_b16 a[40:41], v19 offset:30720
  ds_read_b64_tr_b16 a[42:43], v19 offset:32256
  ds_read_b64_tr_b16 a[44:45], v19 offset:33792
  ds_read_b64_tr_b16 a[46:47], v19 offset:35328
  s_waitcnt lgkmcnt(6)
  ds_read_b64_tr_b16 a[48:49], v19 offset:36864
  ds_read_b64_tr_b16 a[50:51], v19 offset:38400
  ds_read_b64_tr_b16 a[52:53], v19 offset:39936
  ds_read_b64_tr_b16 a[54:55], v19 offset:41472
  ds_read_b64_tr_b16 a[56:57], v19 offset:43008
  ds_read_b64_tr_b16 a[58:59], v19 offset:44544
  ds_read_b64_tr_b16 a[60:61], v19 offset:46080
  ds_read_b64_tr_b16 a[62:63], v19 offset:47616
  s_waitcnt lgkmcnt(6)
  ds_read_b64_tr_b16 a[64:65], v19 offset:49152
  ds_read_b64_tr_b16 a[66:67], v19 offset:50688
  ds_read_b64_tr_b16 a[68:69], v19 offset:52224
  ds_read_b64_tr_b16 a[70:71], v19 offset:53760
  ds_read_b64_tr_b16 a[72:73], v19 offset:55296
  ds_read_b64_tr_b16 a[74:75], v19 offset:56832
  ds_read_b64_tr_b16 a[76:77], v19 offset:58368
  ds_read_b64_tr_b16 a[78:79], v19 offset:59904
  s_waitcnt lgkmcnt(6)
  s_waitcnt lgkmcnt(0)
w3a_7129:
  s_barrier
  s_xor_b32 s58, s3, 1
  s_mul_i32 s58, s58, 96
  s_mul_i32 s2, s99, 384
  s_add_u32 s2, s2, s58
  s_lshl_b32 s60, s52, 10
  s_add_u32 s60, s60, 0x0
  s_add_u32 m0, s60, 0
  s_nop 0
  buffer_load_dwordx4 v2, s[20:23], s2 offen lds
  s_add_u32 m0, s60, 4096
  s_nop 0
  buffer_load_dwordx4 v3, s[20:23], s2 offen lds
  s_add_u32 m0, s60, 8192
  s_nop 0
  buffer_load_dwordx4 v4, s[20:23], s2 offen lds
  s_add_u32 m0, s60, 12288
  s_nop 0
  buffer_load_dwordx4 v5, s[20:23], s2 offen lds
  s_add_u32 m0, s60, 16384
  s_nop 0
  buffer_load_dwordx4 v6, s[20:23], s2 offen lds
  s_add_u32 m0, s60, 20480
  s_nop 0
  buffer_load_dwordx4 v7, s[20:23], s2 offen lds
  s_add_u32 m0, s60, 24576
  s_nop 0
  buffer_load_dwordx4 v8, s[20:23], s2 offen lds
  s_add_u32 m0, s60, 28672
  s_nop 0
  buffer_load_dwordx4 v9, s[20:23], s2 offen lds
  s_add_u32 m0, s60, 32768
  s_nop 0
  buffer_load_dwordx4 v10, s[20:23], s2 offen lds
  s_add_u32 m0, s60, 36864
  s_nop 0
  buffer_load_dwordx4 v11, s[20:23], s2 offen lds
  s_add_u32 m0, s60, 40960
  s_nop 0
  buffer_load_dwordx4 v12, s[20:23], s2 offen lds
  s_add_u32 m0, s60, 45056
  s_nop 0
  buffer_load_dwordx4 v13, s[20:23], s2 offen lds
  s_add_u32 m0, s60, 49152
  s_nop 0
  buffer_load_dwordx4 v14, s[20:23], s2 offen lds
  s_add_u32 m0, s60, 53248
  s_nop 0
  buffer_load_dwordx4 v15, s[20:23], s2 offen lds
  s_add_u32 m0, s60, 57344
  s_nop 0
  buffer_load_dwordx4 v16, s[20:23], s2 offen lds
  s_waitcnt vmcnt(15)
  s_barrier
  s_cmp_eq_u32 s52, 3
  s_cbranch_scc1 w3b_7130
  ds_read_b64_tr_b16 a[80:81], v20 offset:0
  ds_read_b64_tr_b16 a[82:83], v20 offset:1536
  ds_read_b64_tr_b16 a[84:85], v20 offset:3072
  ds_read_b64_tr_b16 a[86:87], v20 offset:4608
  ds_read_b64_tr_b16 a[88:89], v20 offset:6144
  ds_read_b64_tr_b16 a[90:91], v20 offset:7680
  ds_read_b64_tr_b16 a[92:93], v20 offset:9216
  ds_read_b64_tr_b16 a[94:95], v20 offset:10752
  s_waitcnt lgkmcnt(6)
  ds_read_b64_tr_b16 a[96:97], v20 offset:12288
  ds_read_b64_tr_b16 a[98:99], v20 offset:13824
  ds_read_b64_tr_b16 a[100:101], v20 offset:15360
  ds_read_b64_tr_b16 a[102:103], v20 offset:16896
  ds_read_b64_tr_b16 a[104:105], v20 offset:18432
  ds_read_b64_tr_b16 a[106:107], v20 offset:19968
  ds_read_b64_tr_b16 a[108:109], v20 offset:21504
  ds_read_b64_tr_b16 a[110:111], v20 offset:23040
  s_waitcnt lgkmcnt(6)
  ds_read_b64_tr_b16 a[112:113], v20 offset:24576
  ds_read_b64_tr_b16 a[114:115], v20 offset:26112
  ds_read_b64_tr_b16 a[116:117], v20 offset:27648
  ds_read_b64_tr_b16 a[118:119], v20 offset:29184
  ds_read_b64_tr_b16 a[120:121], v20 offset:30720
  ds_read_b64_tr_b16 a[122:123], v20 offset:32256
  ds_read_b64_tr_b16 a[124:125], v20 offset:33792
  ds_read_b64_tr_b16 a[126:127], v20 offset:35328
  s_waitcnt lgkmcnt(6)
  ds_read_b64_tr_b16 a[128:129], v20 offset:36864
  ds_read_b64_tr_b16 a[130:131], v20 offset:38400
  ds_read_b64_tr_b16 a[132:133], v20 offset:39936
  ds_read_b64_tr_b16 a[134:135], v20 offset:41472
  ds_read_b64_tr_b16 a[136:137], v20 offset:43008
  ds_read_b64_tr_b16 a[138:139], v20 offset:44544
  ds_read_b64_tr_b16 a[140:141], v20 offset:46080
  ds_read_b64_tr_b16 a[142:143], v20 offset:47616
  s_waitcnt lgkmcnt(6)
  ds_read_b64_tr_b16 a[144:145], v20 offset:49152
  ds_read_b64_tr_b16 a[146:147], v20 offset:50688
  ds_read_b64_tr_b16 a[148:149], v20 offset:52224
  ds_read_b64_tr_b16 a[150:151], v20 offset:53760
  ds_read_b64_tr_b16 a[152:153], v20 offset:55296
  ds_read_b64_tr_b16 a[154:155], v20 offset:56832
  ds_read_b64_tr_b16 a[156:157], v20 offset:58368
  ds_read_b64_tr_b16 a[158:159], v20 offset:59904
  s_waitcnt lgkmcnt(6)
  s_waitcnt lgkmcnt(0)
w3b_7130:
  s_barrier
  v_mov_b32 v30, v0
  v_mul_u32_u24 v31, 3277, v30
  v_lshrrev_b32 v31, 16, v31
  v_mul_u32_u24 v32, 20, v31
  v_sub_u32 v30, v30, v32
  v_mul_u32_u24 v31, 1280, v31
  v_lshlrev_b32 v30, 4, v30
  v_add_u32 v2, v30, v31
  v_add_u32 v30, 256, v0
  v_mul_u32_u24 v31, 3277, v30
  v_lshrrev_b32 v31, 16, v31
  v_mul_u32_u24 v32, 20, v31
  v_sub_u32 v30, v30, v32
  v_mul_u32_u24 v31, 1280, v31
  v_lshlrev_b32 v30, 4, v30
  v_add_u32 v3, v30, v31
  v_add_u32 v30, 512, v0
  v_mul_u32_u24 v31, 3277, v30
  v_lshrrev_b32 v31, 16, v31
  v_mul_u32_u24 v32, 20, v31
  v_sub_u32 v30, v30, v32
  v_mul_u32_u24 v31, 1280, v31
  v_lshlrev_b32 v30, 4, v30
  v_add_u32 v4, v30, v31
  v_add_u32 v30, 768, v0
  v_mul_u32_u24 v31, 3277, v30
  v_lshrrev_b32 v31, 16, v31
  v_mul_u32_u24 v32, 20, v31
  v_sub_u32 v30, v30, v32
  v_mul_u32_u24 v31, 1280, v31
  v_lshlrev_b32 v30, 4, v30
  v_add_u32 v5, v30, v31
  v_add_u32 v30, 1024, v0
  v_mul_u32_u24 v31, 3277, v30
  v_lshrrev_b32 v31, 16, v31
  v_mul_u32_u24 v32, 20, v31
  v_sub_u32 v30, v30, v32
  v_mul_u32_u24 v31, 1280, v31
  v_lshlrev_b32 v30, 4, v30
  v_add_u32 v6, v30, v31
  v_add_u32 v30, 1280, v0
  v_mul_u32_u24 v31, 3277, v30
  v_lshrrev_b32 v31, 16, v31
  v_mul_u32_u24 v32, 20, v31
  v_sub_u32 v30, v30, v32
  v_mul_u32_u24 v31, 1280, v31
  v_lshlrev_b32 v30, 4, v30
  v_add_u32 v7, v30, v31
  v_add_u32 v30, 1536, v0
  v_mul_u32_u24 v31, 3277, v30
  v_lshrrev_b32 v31, 16, v31
  v_mul_u32_u24 v32, 20, v31
  v_sub_u32 v30, v30, v32
  v_mul_u32_u24 v31, 1280, v31
  v_lshlrev_b32 v30, 4, v30
  v_add_u32 v8, v30, v31
  v_add_u32 v30, 1792, v0
  v_mul_u32_u24 v31, 3277, v30
  v_lshrrev_b32 v31, 16, v31
  v_mul_u32_u24 v32, 20, v31
  v_sub_u32 v30, v30, v32
  v_mul_u32_u24 v31, 1280, v31
  v_lshlrev_b32 v30, 4, v30
  v_add_u32 v9, v30, v31
  v_add_u32 v30, 2048, v0
  v_mul_u32_u24 v31, 3277, v30
  v_lshrrev_b32 v31, 16, v31
  v_mul_u32_u24 v32, 20, v31
  v_sub_u32 v30, v30, v32
  v_mul_u32_u24 v31, 1280, v31
  v_lshlrev_b32 v30, 4, v30
  v_add_u32 v10, v30, v31
  v_add_u32 v30, 2304, v0
  v_mul_u32_u24 v31, 3277, v30
  v_lshrrev_b32 v31, 16, v31
  v_mul_u32_u24 v32, 20, v31
  v_sub_u32 v30, v30, v32
  v_mul_u32_u24 v31, 1280, v31
  v_lshlrev_b32 v30, 4, v30
  v_add_u32 v11, v30, v31
  v_add_u32 v30, 2560, v0
  v_mul_u32_u24 v31, 3277, v30
  v_lshrrev_b32 v31, 16, v31
  v_mul_u32_u24 v32, 20, v31
  v_sub_u32 v30, v30, v32
  v_mul_u32_u24 v31, 1280, v31
  v_lshlrev_b32 v30, 4, v30
  v_add_u32 v12, v30, v31
  v_add_u32 v30, 2816, v0
  v_mul_u32_u24 v31, 3277, v30
  v_lshrrev_b32 v31, 16, v31
  v_mul_u32_u24 v32, 20, v31
  v_sub_u32 v30, v30, v32
  v_mul_u32_u24 v31, 1280, v31
  v_lshlrev_b32 v30, 4, v30
  v_add_u32 v13, v30, v31
  v_add_u32 v30, 3072, v0
  v_mul_u32_u24 v31, 3277, v30
  v_lshrrev_b32 v31, 16, v31
  v_mul_u32_u24 v32, 20, v31
  v_sub_u32 v30, v30, v32
  v_mul_u32_u24 v31, 1280, v31
  v_lshlrev_b32 v30, 4, v30
  v_add_u32 v14, v30, v31
  v_add_u32 v30, 3328, v0
  v_mul_u32_u24 v31, 3277, v30
  v_lshrrev_b32 v31, 16, v31
  v_mul_u32_u24 v32, 20, v31
  v_sub_u32 v30, v30, v32
  v_mul_u32_u24 v31, 1280, v31
  v_lshlrev_b32 v30, 4, v30
  v_add_u32 v15, v30, v31
  v_add_u32 v30, 3584, v0
  v_mul_u32_u24 v31, 3277, v30
  v_lshrrev_b32 v31, 16, v31
  v_mul_u32_u24 v32, 20, v31
  v_sub_u32 v30, v30, v32
  v_mul_u32_u24 v31, 1280, v31
  v_lshlrev_b32 v30, 4, v30
  v_add_u32 v16, v30, v31
  s_mul_i32 s2, s99, 245760
  s_mul_i32 s58, s3, 320
  s_add_u32 s2, s2, s58
  s_lshl_b32 s60, s52, 10
  s_add_u32 s60, s60, 0xf000
  s_add_u32 m0, s60, 0
  s_nop 0
  buffer_load_dwordx4 v2, s[24:27], s2 offen lds
  s_add_u32 m0, s60, 4096
  s_nop 0
  buffer_load_dwordx4 v3, s[24:27], s2 offen lds
  s_add_u32 m0, s60, 8192
  s_nop 0
  buffer_load_dwordx4 v4, s[24:27], s2 offen lds
  s_add_u32 m0, s60, 12288
  s_nop 0
  buffer_load_dwordx4 v5, s[24:27], s2 offen lds
  s_add_u32 m0, s60, 16384
  s_nop 0
  buffer_load_dwordx4 v6, s[24:27], s2 offen lds
  s_add_u32 m0, s60, 20480
  s_nop 0
  buffer_load_dwordx4 v7, s[24:27], s2 offen lds
  s_add_u32 m0, s60, 24576
  s_nop 0
  buffer_load_dwordx4 v8, s[24:27], s2 offen lds
  s_add_u32 m0, s60, 28672
  s_nop 0
  buffer_load_dwordx4 v9, s[24:27], s2 offen lds
  s_add_u32 m0, s60, 32768
  s_nop 0
  buffer_load_dwordx4 v10, s[24:27], s2 offen lds
  s_add_u32 m0, s60, 36864
  s_nop 0
  buffer_load_dwordx4 v11, s[24:27], s2 offen lds
  s_add_u32 m0, s60, 40960
  s_nop 0
  buffer_load_dwordx4 v12, s[24:27], s2 offen lds
  s_add_u32 m0, s60, 45056
  s_nop 0
  buffer_load_dwordx4 v13, s[24:27], s2 offen lds
  s_add_u32 m0, s60, 49152
  s_nop 0
  buffer_load_dwordx4 v14, s[24:27], s2 offen lds
  s_add_u32 m0, s60, 53248
  s_nop 0
  buffer_load_dwordx4 v15, s[24:27], s2 offen lds
  s_add_u32 m0, s60, 57344
  s_nop 0
  buffer_load_dwordx4 v16, s[24:27], s2 offen lds
  s_waitcnt vmcnt(15)
  s_barrier
  s_cmp_lg_u32 s52, 3
  s_cbranch_scc1 w3c_7131
  ds_read_b64_tr_b16 a[0:1], v17 offset:0
  ds_read_b64_tr_b16 a[2:3], v17 offset:1536
  ds_read_b64_tr_b16 a[4:5], v17 offset:3072
  ds_read_b64_tr_b16 a[6:7], v17 offset:4608
  ds_read_b64_tr_b16 a[8:9], v17 offset:6144
  ds_read_b64_tr_b16 a[10:11], v17 offset:7680
  ds_read_b64_tr_b16 a[12:13], v17 offset:9216
  ds_read_b64_tr_b16 a[14:15], v17 offset:10752
  s_waitcnt lgkmcnt(6)
  ds_read_b64_tr_b16 a[16:17], v17 offset:12288
  ds_read_b64_tr_b16 a[18:19], v17 offset:13824
  ds_read_b64_tr_b16 a[20:21], v17 offset:15360
  ds_read_b64_tr_b16 a[22:23], v17 offset:16896
  ds_read_b64_tr_b16 a[24:25], v17 offset:18432
  ds_read_b64_tr_b16 a[26:27], v17 offset:19968
  ds_read_b64_tr_b16 a[28:29], v17 offset:21504
  ds_read_b64_tr_b16 a[30:31], v17 offset:23040
  s_waitcnt lgkmcnt(6)
  ds_read_b64_tr_b16 a[32:33], v17 offset:24576
  ds_read_b64_tr_b16 a[34:35], v17 offset:26112
  ds_read_b64_tr_b16 a[36:37], v17 offset:27648
  ds_read_b64_tr_b16 a[38:39], v17 offset:29184
  ds_read_b64_tr_b16 a[40:41], v17 offset:30720
  ds_read_b64_tr_b16 a[42:43], v17 offset:32256
  ds_read_b64_tr_b16 a[44:45], v17 offset:33792
  ds_read_b64_tr_b16 a[46:47], v17 offset:35328
  s_waitcnt lgkmcnt(6)
  ds_read_b64_tr_b16 a[48:49], v17 offset:36864
  ds_read_b64_tr_b16 a[50:51], v17 offset:38400
  ds_read_b64_tr_b16 a[52:53], v17 offset:39936
  ds_read_b64_tr_b16 a[54:55], v17 offset:41472
  ds_read_b64_tr_b16 a[56:57], v17 offset:43008
  ds_read_b64_tr_b16 a[58:59], v17 offset:44544
  ds_read_b64_tr_b16 a[60:61], v17 offset:46080
  ds_read_b64_tr_b16 a[62:63], v17 offset:47616
  s_waitcnt lgkmcnt(6)
  ds_read_b64_tr_b16 a[64:65], v17 offset:49152
  ds_read_b64_tr_b16 a[66:67], v17 offset:50688
  ds_read_b64_tr_b16 a[68:69], v17 offset:52224
  ds_read_b64_tr_b16 a[70:71], v17 offset:53760
  ds_read_b64_tr_b16 a[72:73], v17 offset:55296
  ds_read_b64_tr_b16 a[74:75], v17 offset:56832
  ds_read_b64_tr_b16 a[76:77], v17 offset:58368
  ds_read_b64_tr_b16 a[78:79], v17 offset:59904
  s_waitcnt lgkmcnt(6)
  ds_read_b64_tr_b16 a[80:81], v17 offset:32
  ds_read_b64_tr_b16 a[82:83], v17 offset:1568
  ds_read_b64_tr_b16 a[84:85], v17 offset:3104
  ds_read_b64_tr_b16 a[86:87], v17 offset:4640
  ds_read_b64_tr_b16 a[88:89], v17 offset:6176
  ds_read_b64_tr_b16 a[90:91], v17 offset:7712
  ds_read_b64_tr_b16 a[92:93], v17 offset:9248
  ds_read_b64_tr_b16 a[94:95], v17 offset:10784
  s_waitcnt lgkmcnt(6)
  ds_read_b64_tr_b16 a[96:97], v17 offset:12320
  ds_read_b64_tr_b16 a[98:99], v17 offset:13856
  ds_read_b64_tr_b16 a[100:101], v17 offset:15392
  ds_read_b64_tr_b16 a[102:103], v17 offset:16928
  ds_read_b64_tr_b16 a[104:105], v17 offset:18464
  ds_read_b64_tr_b16 a[106:107], v17 offset:20000
  ds_read_b64_tr_b16 a[108:109], v17 offset:21536
  ds_read_b64_tr_b16 a[110:111], v17 offset:23072
  s_waitcnt lgkmcnt(6)
  ds_read_b64_tr_b16 a[112:113], v17 offset:24608
  ds_read_b64_tr_b16 a[114:115], v17 offset:26144
  ds_read_b64_tr_b16 a[116:117], v17 offset:27680
  ds_read_b64_tr_b16 a[118:119], v17 offset:29216
  ds_read_b64_tr_b16 a[120:121], v17 offset:30752
  ds_read_b64_tr_b16 a[122:123], v17 offset:32288
  ds_read_b64_tr_b16 a[124:125], v17 offset:33824
  ds_read_b64_tr_b16 a[126:127], v17 offset:35360
  s_waitcnt lgkmcnt(6)
  ds_read_b64_tr_b16 a[128:129], v17 offset:36896
  ds_read_b64_tr_b16 a[130:131], v17 offset:38432
  ds_read_b64_tr_b16 a[132:133], v17 offset:39968
  ds_read_b64_tr_b16 a[134:135], v17 offset:41504
  ds_read_b64_tr_b16 a[136:137], v17 offset:43040
  ds_read_b64_tr_b16 a[138:139], v17 offset:44576
  ds_read_b64_tr_b16 a[140:141], v17 offset:46112
  ds_read_b64_tr_b16 a[142:143], v17 offset:47648
  s_waitcnt lgkmcnt(6)
  ds_read_b64_tr_b16 a[144:145], v17 offset:49184
  ds_read_b64_tr_b16 a[146:147], v17 offset:50720
  ds_read_b64_tr_b16 a[148:149], v17 offset:52256
  ds_read_b64_tr_b16 a[150:151], v17 offset:53792
  ds_read_b64_tr_b16 a[152:153], v17 offset:55328
  ds_read_b64_tr_b16 a[154:155], v17 offset:56864
  ds_read_b64_tr_b16 a[156:157], v17 offset:58400
  ds_read_b64_tr_b16 a[158:159], v17 offset:59936
  s_waitcnt lgkmcnt(6)
  ds_read_b64_tr_b16 a[160:161], v17 offset:64
  ds_read_b64_tr_b16 a[162:163], v17 offset:1600
  ds_read_b64_tr_b16 a[164:165], v17 offset:3136
  ds_read_b64_tr_b16 a[166:167], v17 offset:4672
  ds_read_b64_tr_b16 a[168:169], v17 offset:6208
  ds_read_b64_tr_b16 a[170:171], v17 offset:7744
  ds_read_b64_tr_b16 a[172:173], v17 offset:9280
  ds_read_b64_tr_b16 a[174:175], v17 offset:10816
  s_waitcnt lgkmcnt(6)
  ds_read_b64_tr_b16 a[176:177], v17 offset:12352
  ds_read_b64_tr_b16 a[178:179], v17 offset:13888
  ds_read_b64_tr_b16 a[180:181], v17 offset:15424
  ds_read_b64_tr_b16 a[182:183], v17 offset:16960
  ds_read_b64_tr_b16 a[184:185], v17 offset:18496
  ds_read_b64_tr_b16 a[186:187], v17 offset:20032
  ds_read_b64_tr_b16 a[188:189], v17 offset:21568
  ds_read_b64_tr_b16 a[190:191], v17 offset:23104
  s_waitcnt lgkmcnt(6)
  ds_read_b64_tr_b16 a[192:193], v17 offset:24640
  ds_read_b64_tr_b16 a[194:195], v17 offset:26176
  ds_read_b64_tr_b16 a[196:197], v17 offset:27712
  ds_read_b64_tr_b16 a[198:199], v17 offset:29248
  ds_read_b64_tr_b16 a[200:201], v17 offset:30784
  ds_read_b64_tr_b16 a[202:203], v17 offset:32320
  ds_read_b64_tr_b16 a[204:205], v17 offset:33856
  ds_read_b64_tr_b16 a[206:207], v17 offset:35392
  s_waitcnt lgkmcnt(6)
  ds_read_b64_tr_b16 a[208:209], v17 offset:36928
  ds_read_b64_tr_b16 a[210:211], v17 offset:38464
  ds_read_b64_tr_b16 a[212:213], v17 offset:40000
  ds_read_b64_tr_b16 a[214:215], v17 offset:41536
  ds_read_b64_tr_b16 a[216:217], v17 offset:43072
  ds_read_b64_tr_b16 a[218:219], v17 offset:44608
  ds_read_b64_tr_b16 a[220:221], v17 offset:46144
  ds_read_b64_tr_b16 a[222:223], v17 offset:47680
  s_waitcnt lgkmcnt(6)
  ds_read_b64_tr_b16 a[224:225], v17 offset:49216
  ds_read_b64_tr_b16 a[226:227], v17 offset:50752
  ds_read_b64_tr_b16 a[228:229], v17 offset:52288
  ds_read_b64_tr_b16 a[230:231], v17 offset:53824
  ds_read_b64_tr_b16 a[232:233], v17 offset:55360
  ds_read_b64_tr_b16 a[234:235], v17 offset:56896
  ds_read_b64_tr_b16 a[236:237], v17 offset:58432
  ds_read_b64_tr_b16 a[238:239], v17 offset:59968
  s_waitcnt lgkmcnt(6)
  s_waitcnt lgkmcnt(0)
w3c_7131:
  s_waitcnt vmcnt(0)
  s_barrier
  s_cmp_eq_u32 s52, 3
  s_cbranch_scc1 w3d_7132
  ds_read_b64_tr_b16 v[184:185], v18 offset:0
  ds_read_b64_tr_b16 v[186:187], v18 offset:5120
  ds_read_b64_tr_b16 v[188:189], v18 offset:10240
  ds_read_b64_tr_b16 v[190:191], v18 offset:15360
  ds_read_b64_tr_b16 v[192:193], v18 offset:20480
  ds_read_b64_tr_b16 v[194:195], v18 offset:25600
  ds_read_b64_tr_b16 v[196:197], v18 offset:30720
  ds_read_b64_tr_b16 v[198:199], v18 offset:35840
  s_waitcnt lgkmcnt(6)
  ds_read_b64_tr_b16 v[200:201], v18 offset:40960
  ds_read_b64_tr_b16 v[202:203], v18 offset:46080
  ds_read_b64_tr_b16 v[204:205], v18 offset:51200
  ds_read_b64_tr_b16 v[206:207], v18 offset:56320
  ds_read_b64_tr_b16 v[208:209], v18 offset:32
  ds_read_b64_tr_b16 v[210:211], v18 offset:5152
  ds_read_b64_tr_b16 v[212:213], v18 offset:10272
  ds_read_b64_tr_b16 v[214:215], v18 offset:15392
  s_waitcnt lgkmcnt(6)
  ds_read_b64_tr_b16 v[216:217], v18 offset:20512
  ds_read_b64_tr_b16 v[218:219], v18 offset:25632
  ds_read_b64_tr_b16 v[220:221], v18 offset:30752
  ds_read_b64_tr_b16 v[222:223], v18 offset:35872
  ds_read_b64_tr_b16 v[224:225], v18 offset:40992
  ds_read_b64_tr_b16 v[226:227], v18 offset:46112
  ds_read_b64_tr_b16 v[228:229], v18 offset:51232
  ds_read_b64_tr_b16 v[230:231], v18 offset:56352
  s_waitcnt lgkmcnt(6)
  ds_read_b64_tr_b16 v[232:233], v18 offset:64
  ds_read_b64_tr_b16 v[234:235], v18 offset:5184
  ds_read_b64_tr_b16 v[236:237], v18 offset:10304
  ds_read_b64_tr_b16 v[238:239], v18 offset:15424
  ds_read_b64_tr_b16 v[240:241], v18 offset:20544
  ds_read_b64_tr_b16 v[242:243], v18 offset:25664
  ds_read_b64_tr_b16 v[244:245], v18 offset:30784
  ds_read_b64_tr_b16 v[246:247], v18 offset:35904
  s_waitcnt lgkmcnt(6)
  ds_read_b64_tr_b16 v[248:249], v18 offset:41024
  ds_read_b64_tr_b16 v[250:251], v18 offset:46144
  ds_read_b64_tr_b16 v[252:253], v18 offset:51264
  ds_read_b64_tr_b16 v[254:255], v18 offset:56384
  s_waitcnt lgkmcnt(0)
  s_branch w3e_7133
w3d_7132:
  ds_read_b64_tr_b16 v[184:185], v18 offset:0
  ds_read_b64_tr_b16 v[186:187], v18 offset:5120
  ds_read_b64_tr_b16 v[188:189], v18 offset:10240
  ds_read_b64_tr_b16 v[190:191], v18 offset:15360
  ds_read_b64_tr_b16 v[192:193], v18 offset:20480
  ds_read_b64_tr_b16 v[194:195], v18 offset:25600
  ds_read_b64_tr_b16 v[196:197], v18 offset:30720
  ds_read_b64_tr_b16 v[198:199], v18 offset:35840
  s_waitcnt lgkmcnt(6)
  ds_read_b64_tr_b16 v[200:201], v18 offset:40960
  ds_read_b64_tr_b16 v[202:203], v18 offset:46080
  ds_read_b64_tr_b16 v[204:205], v18 offset:51200
  ds_read_b64_tr_b16 v[206:207], v18 offset:56320
  s_waitcnt lgkmcnt(0)
w3e_7133:
  v_lshlrev_b32 v34, 4, v0
  v_add_u32 v34, 122880, v34
  v_lshl_or_b32 v72, v49, 16, v48
  v_lshl_or_b32 v73, v51, 16, v50
  v_lshl_or_b32 v74, v53, 16, v52
  v_lshl_or_b32 v75, v55, 16, v54
  ds_write_b128 v34, v[72:75] offset:0
  s_waitcnt lgkmcnt(0)
m1_7134:
  v_lshl_or_b32 v72, v57, 16, v56
  v_lshl_or_b32 v73, v59, 16, v58
  v_lshl_or_b32 v74, v61, 16, v60
  v_lshl_or_b32 v75, v63, 16, v62
  ds_write_b128 v34, v[72:75] offset:4096
  s_waitcnt lgkmcnt(0)
m1_7135:
  s_cmp_ge_u32 s52, 2
  s_cbranch_scc1 m1_7136
  v_lshl_or_b32 v72, v65, 16, v64
  v_lshl_or_b32 v73, v67, 16, v66
  v_lshl_or_b32 v74, v69, 16, v68
  v_lshl_or_b32 v75, v71, 16, v70
  ds_write_b128 v34, v[72:75] offset:8192
  s_waitcnt lgkmcnt(0)
m1_7136:
  v_and_b32 v1, 63, v0
  v_lshlrev_b32 v2, 4, v1
  v_lshlrev_b32 v8, 3, v1
  v_and_b32 v30, 31, v1
  v_lshlrev_b32 v11, 4, v30
  v_add_u32 v3, 2048, v11
  s_mul_i32 s58, s52, 2560
  s_add_u32 s58, s58, 122880
  v_add_u32 v4, s58, v2
  v_add_u32 v5, s58, v3
  v_lshrrev_b32 v30, 2, v1
  v_lshlrev_b32 v31, 4, v30
  v_and_b32 v32, 1, v1
  v_lshlrev_b32 v32, 3, v32
  v_add_u32 v31, v31, v32
  v_add_u32 v6, 122880, v31
  s_mul_i32 s58, s52, 3072
  s_add_u32 s58, s58, 3072
  v_add_u32 v7, s58, v2
  v_lshrrev_b32 v30, 4, v1
  v_and_b32 v30, 1, v30
  v_lshlrev_b32 v30, 3, v30
  v_and_b32 v31, 7, v1
  v_add_u32 v30, v30, v31
  v_lshlrev_b32 v30, 4, v30
  v_add_u32 v9, 1024, v30
  s_mul_i32 s58, s52, 3
  s_add_u32 s58, s58, 0
  s_lshr_b32 s59, s58, 1
  s_lshl_b32 s59, s59, 10
  s_and_b32 s58, s58, 1
  s_lshl_b32 s58, s58, 3
  s_add_u32 s58, s58, s59
  s_add_u32 s58, s58, 148480
  v_add_u32 v12, s58, v2
  s_mul_i32 s58, s52, 3
  s_add_u32 s58, s58, 1
  s_lshr_b32 s59, s58, 1
  s_lshl_b32 s59, s59, 10
  s_and_b32 s58, s58, 1
  s_lshl_b32 s58, s58, 3
  s_add_u32 s58, s58, s59
  s_add_u32 s58, s58, 148480
  v_add_u32 v13, s58, v2
  s_mul_i32 s58, s52, 3
  s_add_u32 s58, s58, 2
  s_lshr_b32 s59, s58, 1
  s_lshl_b32 s59, s59, 10
  s_and_b32 s58, s58, 1
  s_lshl_b32 s58, s58, 3
  s_add_u32 s58, s58, s59
  s_add_u32 s58, s58, 148480
  v_add_u32 v14, s58, v2
  v_add_u32 v23, 148480, v2
  v_add_u32 v20, 143616, v8
  v_add_u32 v21, 146688, v2
  v_add_u32 v22, 147712, v8
  s_mul_i32 s58, s3, 160
  s_mul_i32 s59, s52, 48
  s_add_u32 s58, s58, s59
  v_and_b32 v30, 31, v1
  v_add_u32 v30, s58, v30
  v_lshrrev_b32 v31, 3, v30
  v_lshlrev_b32 v31, 12, v31
  v_and_b32 v30, 7, v30
  v_lshlrev_b32 v30, 4, v30
  v_add_u32 v30, v30, v31
  s_lshl_b32 s58, s99, 7
  v_add_u32 v15, s58, v30
  s_mul_i32 s58, s3, 160
  s_mul_i32 s59, s52, 48
  s_add_u32 s58, s58, s59
  v_and_b32 v30, 15, v1
  v_add_u32 v30, 32, v30
  v_add_u32 v30, s58, v30
  v_lshrrev_b32 v31, 3, v30
  v_lshlrev_b32 v31, 12, v31
  v_and_b32 v30, 7, v30
  v_lshlrev_b32 v30, 4, v30
  v_add_u32 v30, v30, v31
  s_lshl_b32 s58, s99, 7
  v_add_u32 v16, s58, v30
  s_lshl_b32 s58, s52, 5
  s_add_u32 s58, s58, s54
  s_lshl_b32 s58, s58, 7
  v_add_u32 v17, s58, v2
  v_and_b32 v30, 15, v1
  v_mov_b32 v31, 0x3f80
  v_mov_b32 v32, 0
  v_cmp_eq_u32 vcc, 0, v30
  s_nop 1
  v_cndmask_b32 v178, v32, v31, vcc
  v_mov_b32 v31, 0x3f800000
  v_cmp_eq_u32 vcc, 1, v30
  s_nop 1
  v_cndmask_b32 v178, v178, v31, vcc
  v_mov_b32 v31, 0x3f80
  v_mov_b32 v32, 0
  v_cmp_eq_u32 vcc, 2, v30
  s_nop 1
  v_cndmask_b32 v179, v32, v31, vcc
  v_mov_b32 v31, 0x3f800000
  v_cmp_eq_u32 vcc, 3, v30
  s_nop 1
  v_cndmask_b32 v179, v179, v31, vcc
  v_mov_b32 v31, 0x3f80
  v_mov_b32 v32, 0
  v_cmp_eq_u32 vcc, 4, v30
  s_nop 1
  v_cndmask_b32 v180, v32, v31, vcc
  v_mov_b32 v31, 0x3f800000
  v_cmp_eq_u32 vcc, 5, v30
  s_nop 1
  v_cndmask_b32 v180, v180, v31, vcc
  v_mov_b32 v31, 0x3f80
  v_mov_b32 v32, 0
  v_cmp_eq_u32 vcc, 6, v30
  s_nop 1
  v_cndmask_b32 v181, v32, v31, vcc
  v_mov_b32 v31, 0x3f800000
  v_cmp_eq_u32 vcc, 7, v30
  s_nop 1
  v_cndmask_b32 v181, v181, v31, vcc
  s_mul_i32 s58, s3, 160
  v_add_u32 v30, s58, v1
  v_lshrrev_b32 v31, 3, v30
  v_lshlrev_b32 v31, 12, v31
  v_and_b32 v30, 7, v30
  v_lshlrev_b32 v30, 4, v30
  v_add_u32 v30, v30, v31
  s_lshl_b32 s58, s99, 7
  v_add_u32 v182, s58, v30
  v_add_u32 v183, 133120, v2
  s_lshl_b32 s58, s99, 2
  s_add_u32 s58, s58, s3
  s_lshl_b32 s58, s58, 7
  s_add_u32 s58, s58, 8192
  v_mov_b32 v18, s58
  s_lshl_b32 s58, s99, 8
  v_and_b32 v30, 1, v1
  v_lshlrev_b32 v30, 7, v30
  v_add_u32 v19, s58, v30
  v_mov_b32 v24, 0x3f803f80
  v_mov_b32 v25, 0x3f803f80
  v_mov_b32 v26, 0x3f803f80
  v_mov_b32 v27, 0x3f803f80
  v_cmp_gt_u32 vcc, 32, v1
  v_mov_b32 v30, -1
  v_mov_b32 v31, 0
  v_cndmask_b32 v28, v31, v30, vcc
  v_mov_b32 v10, v9
  s_mov_b32 s66, 0x1a000
  s_mul_i32 s58, s53, 10240
  s_add_u32 s66, s66, s58
  s_mul_i32 s58, s52, 2560
  s_add_u32 s66, s66, s58
  s_mov_b32 s73, 0x10000
  s_mul_i32 s58, s53, 10240
  s_add_u32 s73, s73, s58
  s_mov_b32 s67, 0x30000
  s_mul_i32 s58, s99, 5120
  s_add_u32 s67, s67, s58
  s_mul_i32 s58, s3, 1280
  s_add_u32 s67, s67, s58
  s_mov_b32 s68, 0x30000
  s_mul_i32 s58, s99, 5120
  s_add_u32 s68, s68, s58
  s_xor_b32 s59, s3, 1
  s_mov_b32 s69, 0x80000
  s_mul_i32 s58, s99, 6144
  s_add_u32 s69, s69, s58
  s_mul_i32 s58, s59, 1536
  s_add_u32 s69, s69, s58
  s_mov_b32 s70, 0x80000
  s_mul_i32 s58, s99, 6144
  s_add_u32 s70, s70, s58
  s_mul_i32 s58, s52, 1536
  s_add_u32 s70, s70, s58
  s_mov_b32 s71, 0xe0000
  s_mov_b32 s72, 0xe0000
  s_mul_i32 s58, s54, 4096
  s_add_u32 s72, s72, s58
  s_mul_i32 s58, s52, 131072
  s_add_u32 s72, s72, s58
  s_mov_b32 s74, 40960
  s_mov_b32 s75, 163840
  s_mov_b32 s76, 196608
  s_mov_b32 s77, 327680
  s_mov_b32 s78, 0x1a00000
  s_mul_i32 s58, s99, 12288
  s_add_u32 s78, s78, s58
  s_mul_i32 s58, s3, 3072
  s_add_u32 s78, s78, s58
  s_mov_b32 s79, 0x3200000
  s_mul_i32 s58, s99, 12288
  s_add_u32 s79, s79, s58
  s_mov_b32 s62, 0
  s_mov_b32 s63, 1
  s_mov_b32 s64, 0
  s_mov_b32 s65, 0
  s_mov_b32 s101, 0
  s_mov_b32 s56, 0
  v_mov_b32 v32, 140
iw_7137:
  buffer_load_dword v30, v32, s[44:47], 0 offen sc1
  s_waitcnt vmcnt(0)
  v_readfirstlane_b32 s58, v30
  s_cmp_ge_u32 s58, 256
  s_cbranch_scc1 iwd_7138
  s_cmp_lg_u32 s55, 0
  s_cbranch_scc1 iwd_7138
  s_add_u32 s56, s56, 1
  s_cmp_lt_u32 s56, 0x20000
  s_cbranch_scc1 iw_7137
  s_mov_b32 s55, 1
iwd_7138:
  s_cmp_eq_u32 s52, 0
  s_cbranch_scc1 L_chw0_i
  s_cmp_eq_u32 s52, 3
  s_cbranch_scc1 L_chw3_i
  s_mul_i32 s100, s99, 6144
  s_mul_i32 s58, s3, 1536
  s_add_u32 s100, s100, s58
  s_add_u32 s100, s100, 0x200000
  s_lshl_b32 s58, s52, 9
  s_add_u32 s100, s100, s58
  s_barrier
  s_waitcnt vmcnt(0)
  s_mov_b32 s3, 0x3dd53b95
  s_branch L_ch1a_i
L_ch1_i:
  s_mov_b32 s56, 0
ga_9139:
  buffer_load_dwordx4 v[36:39], v2, s[48:51], s66 offen sc1
  buffer_load_dwordx4 v[40:43], v2, s[48:51], s66 offen offset:1024 sc1
  buffer_load_dwordx4 v[44:47], v3, s[48:51], s66 offen sc1
ga_9139w:
  s_waitcnt vmcnt(0)
  v_xor_b32 v30, s65, v36
  v_xor_b32 v31, s65, v40
  v_and_b32 v30, v30, v31
  v_xor_b32 v31, s65, v44
  v_and_b32 v30, v30, v31
  v_and_b32 v30, 1, v30
  v_cmp_eq_u32 vcc, 0, v30
  s_cbranch_vccnz gar_9140
  s_branch gad_9141
gar_9140:
  s_cmp_lg_u32 s55, 0
  s_cbranch_scc1 gad_9141
  s_add_u32 s56, s56, 1
  s_cmp_lt_u32 s56, 0x20000
  s_cbranch_scc1 ga_9139
  s_mov_b32 s55, 1
gad_9141:
  ds_write_b128 v4, v[36:39]
  ds_write_b128 v4, v[40:43] offset:1024
  ds_write_b128 v5, v[44:47]
L_ch1a_i:
  s_waitcnt lgkmcnt(0)
  s_barrier
  ds_read_b64_tr_b16 v[48:49], v6 offset:0
  ds_read_b64_tr_b16 v[50:51], v6 offset:256
  ds_read_b64_tr_b16 v[52:53], v6 offset:512
  ds_read_b64_tr_b16 v[54:55], v6 offset:768
  ds_read_b64_tr_b16 v[56:57], v6 offset:1024
  ds_read_b64_tr_b16 v[58:59], v6 offset:1280
  ds_read_b64_tr_b16 v[60:61], v6 offset:1536
  ds_read_b64_tr_b16 v[62:63], v6 offset:1792
  ds_read_b64_tr_b16 v[64:65], v6 offset:2048
  ds_read_b64_tr_b16 v[66:67], v6 offset:2304
  ds_read_b64_tr_b16 v[68:69], v6 offset:2560
  ds_read_b64_tr_b16 v[70:71], v6 offset:2816
  ds_read_b64_tr_b16 v[72:73], v6 offset:3072
  ds_read_b64_tr_b16 v[74:75], v6 offset:3328
  s_waitcnt lgkmcnt(12)
  v_mfma_f32_16x16x32_bf16 v[128:131], a[0:3], v[48:51], 0
  v_mfma_f32_16x16x32_bf16 v[132:135], a[80:83], v[48:51], 0
  ds_read_b64_tr_b16 v[76:77], v6 offset:3584
  ds_read_b64_tr_b16 v[78:79], v6 offset:3840
  s_waitcnt lgkmcnt(12)
  v_mfma_f32_16x16x32_bf16 v[128:131], a[4:7], v[52:55], v[128:131]
  v_mfma_f32_16x16x32_bf16 v[132:135], a[84:87], v[52:55], v[132:135]
  ds_read_b64_tr_b16 v[80:81], v6 offset:4096
  ds_read_b64_tr_b16 v[82:83], v6 offset:4352
  s_waitcnt lgkmcnt(12)
  v_mfma_f32_16x16x32_bf16 v[128:131], a[8:11], v[56:59], v[128:131]
  v_mfma_f32_16x16x32_bf16 v[132:135], a[88:91], v[56:59], v[132:135]
  ds_read_b64_tr_b16 v[84:85], v6 offset:4608
  ds_read_b64_tr_b16 v[86:87], v6 offset:4864
  s_waitcnt lgkmcnt(12)
  v_mfma_f32_16x16x32_bf16 v[128:131], a[12:15], v[60:63], v[128:131]
  v_mfma_f32_16x16x32_bf16 v[132:135], a[92:95], v[60:63], v[132:135]
  ds_read_b64_tr_b16 v[88:89], v6 offset:5120
  ds_read_b64_tr_b16 v[90:91], v6 offset:5376
  s_waitcnt lgkmcnt(12)
  v_mfma_f32_16x16x32_bf16 v[128:131], a[16:19], v[64:67], v[128:131]
  v_mfma_f32_16x16x32_bf16 v[132:135], a[96:99], v[64:67], v[132:135]
  ds_read_b64_tr_b16 v[92:93], v6 offset:5632
  ds_read_b64_tr_b16 v[94:95], v6 offset:5888
  s_waitcnt lgkmcnt(12)
  v_mfma_f32_16x16x32_bf16 v[128:131], a[20:23], v[68:71], v[128:131]
  v_mfma_f32_16x16x32_bf16 v[132:135], a[100:103], v[68:71], v[132:135]
  ds_read_b64_tr_b16 v[96:97], v6 offset:6144
  ds_read_b64_tr_b16 v[98:99], v6 offset:6400
  s_waitcnt lgkmcnt(12)
  v_mfma_f32_16x16x32_bf16 v[128:131], a[24:27], v[72:75], v[128:131]
  v_mfma_f32_16x16x32_bf16 v[132:135], a[104:107], v[72:75], v[132:135]
  ds_read_b64_tr_b16 v[100:101], v6 offset:6656
  ds_read_b64_tr_b16 v[102:103], v6 offset:6912
  s_waitcnt lgkmcnt(12)
  v_mfma_f32_16x16x32_bf16 v[128:131], a[28:31], v[76:79], v[128:131]
  v_mfma_f32_16x16x32_bf16 v[132:135], a[108:111], v[76:79], v[132:135]
  ds_read_b64_tr_b16 v[104:105], v6 offset:7168
  ds_read_b64_tr_b16 v[106:107], v6 offset:7424
  s_waitcnt lgkmcnt(12)
  v_mfma_f32_16x16x32_bf16 v[128:131], a[32:35], v[80:83], v[128:131]
  v_mfma_f32_16x16x32_bf16 v[132:135], a[112:115], v[80:83], v[132:135]
  ds_read_b64_tr_b16 v[108:109], v6 offset:7680
  ds_read_b64_tr_b16 v[110:111], v6 offset:7936
  s_waitcnt lgkmcnt(12)
  v_mfma_f32_16x16x32_bf16 v[128:131], a[36:39], v[84:87], v[128:131]
  v_mfma_f32_16x16x32_bf16 v[132:135], a[116:119], v[84:87], v[132:135]
  ds_read_b64_tr_b16 v[112:113], v6 offset:8192
  ds_read_b64_tr_b16 v[114:115], v6 offset:8448
  s_waitcnt lgkmcnt(12)
  v_mfma_f32_16x16x32_bf16 v[128:131], a[40:43], v[88:91], v[128:131]
  v_mfma_f32_16x16x32_bf16 v[132:135], a[120:123], v[88:91], v[132:135]
  ds_read_b64_tr_b16 v[116:117], v6 offset:8704
  ds_read_b64_tr_b16 v[118:119], v6 offset:8960
  s_waitcnt lgkmcnt(12)
  v_mfma_f32_16x16x32_bf16 v[128:131], a[44:47], v[92:95], v[128:131]
  v_mfma_f32_16x16x32_bf16 v[132:135], a[124:127], v[92:95], v[132:135]
  ds_read_b64_tr_b16 v[120:121], v6 offset:9216
  ds_read_b64_tr_b16 v[122:123], v6 offset:9472
  s_waitcnt lgkmcnt(12)
  v_mfma_f32_16x16x32_bf16 v[128:131], a[48:51], v[96:99], v[128:131]
  v_mfma_f32_16x16x32_bf16 v[132:135], a[128:131], v[96:99], v[132:135]
  ds_read_b64_tr_b16 v[124:125], v6 offset:9728
  ds_read_b64_tr_b16 v[126:127], v6 offset:9984
  s_waitcnt lgkmcnt(12)
  v_mfma_f32_16x16x32_bf16 v[128:131], a[52:55], v[100:103], v[128:131]
  v_mfma_f32_16x16x32_bf16 v[132:135], a[132:135], v[100:103], v[132:135]
  s_waitcnt lgkmcnt(10)
  v_mfma_f32_16x16x32_bf16 v[128:131], a[56:59], v[104:107], v[128:131]
  v_mfma_f32_16x16x32_bf16 v[132:135], a[136:139], v[104:107], v[132:135]
  s_waitcnt lgkmcnt(8)
  v_mfma_f32_16x16x32_bf16 v[128:131], a[60:63], v[108:111], v[128:131]
  v_mfma_f32_16x16x32_bf16 v[132:135], a[140:143], v[108:111], v[132:135]
  s_waitcnt lgkmcnt(6)
  v_mfma_f32_16x16x32_bf16 v[128:131], a[64:67], v[112:115], v[128:131]
  v_mfma_f32_16x16x32_bf16 v[132:135], a[144:147], v[112:115], v[132:135]
  s_waitcnt lgkmcnt(4)
  v_mfma_f32_16x16x32_bf16 v[128:131], a[68:71], v[116:119], v[128:131]
  v_mfma_f32_16x16x32_bf16 v[132:135], a[148:151], v[116:119], v[132:135]
  s_waitcnt lgkmcnt(2)
  v_mfma_f32_16x16x32_bf16 v[128:131], a[72:75], v[120:123], v[128:131]
  v_mfma_f32_16x16x32_bf16 v[132:135], a[152:155], v[120:123], v[132:135]
  s_waitcnt lgkmcnt(0)
  v_mfma_f32_16x16x32_bf16 v[128:131], a[76:79], v[124:127], v[128:131]
  v_mfma_f32_16x16x32_bf16 v[132:135], a[156:159], v[124:127], v[132:135]
  s_nop 5
  v_cvt_pk_bf16_f32 v140, v128, v129
  v_cvt_pk_bf16_f32 v141, v130, v131
  s_nop 0
  v_cvt_pk_bf16_f32 v142, v132, v133
  v_cvt_pk_bf16_f32 v143, v134, v135
  s_mul_i32 s58, s52, 512
  v_add_u32 v30, s58, v20
  ds_write_b64 v30, v[140:141]
  ds_write_b64 v30, v[142:143] offset:1536
  s_waitcnt lgkmcnt(0)
  s_barrier
  s_cmp_eq_u32 s62, 63
  s_cbranch_scc1 L_ch1x_i
  ds_read_b128 v[158:161], v7 offset:0
  ds_read_b128 v[162:165], v7 offset:1024
  ds_read_b128 v[166:169], v7 offset:2048
  s_mov_b32 s56, 0
gv_9142:
  buffer_load_dwordx4 v[80:83], v11, s[48:51], s70 offen offset:0 sc1
  buffer_load_dwordx4 v[84:87], v11, s[48:51], s70 offen offset:512 sc1
  buffer_load_dwordx4 v[88:91], v11, s[48:51], s70 offen offset:1024 sc1
gv_9142w:
  s_waitcnt vmcnt(0)
  v_xor_b32 v30, s64, v80
  v_xor_b32 v31, s64, v84
  v_and_b32 v30, v30, v31
  v_xor_b32 v31, s64, v88
  v_and_b32 v30, v30, v31
  v_and_b32 v30, 1, v30
  v_cmp_eq_u32 vcc, 0, v30
  s_cbranch_vccnz gvr_9143
  s_branch gvd_9144
gvr_9143:
  s_cmp_lg_u32 s55, 0
  s_cbranch_scc1 gvd_9144
  s_add_u32 s56, s56, 1
  s_cmp_lt_u32 s56, 0x20000
  s_cbranch_scc1 gv_9142
  s_mov_b32 s55, 1
gvd_9144:
  v_cvt_pk_bf16_f32 v92, v80, v81
  v_cvt_pk_bf16_f32 v93, v82, v83
  v_cvt_pk_bf16_f32 v94, v84, v85
  v_cvt_pk_bf16_f32 v95, v86, v87
  v_cvt_pk_bf16_f32 v96, v88, v89
  v_cvt_pk_bf16_f32 v97, v90, v91
  s_waitcnt lgkmcnt(0)
  s_barrier
  ds_read_b128 v[100:103], v21
  ds_read_b64 v[104:105], v22
  s_waitcnt lgkmcnt(0)
  v_mfma_f32_16x16x32_bf16 v[120:123], v[24:27], v[100:103], 0
  v_mfma_f32_16x16x32_bf16 v[108:111], v[158:161], v[100:103], 0
  v_mfma_f32_16x16x32_bf16 v[112:115], v[162:165], v[100:103], 0
  v_mfma_f32_16x16x32_bf16 v[116:119], v[166:169], v[100:103], 0
  v_mfma_f32_16x16x16_bf16 v[120:123], v[24:25], v[104:105], v[120:123]
  v_mfma_f32_16x16x16_bf16 v[108:111], v[92:93], v[104:105], v[108:111]
  v_mfma_f32_16x16x16_bf16 v[112:115], v[94:95], v[104:105], v[112:115]
  v_mfma_f32_16x16x16_bf16 v[116:119], v[96:97], v[104:105], v[116:119]
  s_nop 4
  v_rcp_f32 v30, v120
  s_nop 2
  v_pk_mul_f32 v[108:109], v[108:109], v[30:31] op_sel_hi:[1,0]
  v_pk_mul_f32 v[110:111], v[110:111], v[30:31] op_sel_hi:[1,0]
  v_cvt_pk_bf16_f32 v108, v108, v109
  v_cvt_pk_bf16_f32 v109, v110, v111
  ds_write_b64 v12, v[108:109]
  v_pk_mul_f32 v[112:113], v[112:113], v[30:31] op_sel_hi:[1,0]
  v_pk_mul_f32 v[114:115], v[114:115], v[30:31] op_sel_hi:[1,0]
  v_cvt_pk_bf16_f32 v112, v112, v113
  v_cvt_pk_bf16_f32 v113, v114, v115
  ds_write_b64 v13, v[112:113]
  v_pk_mul_f32 v[116:117], v[116:117], v[30:31] op_sel_hi:[1,0]
  v_pk_mul_f32 v[118:119], v[118:119], v[30:31] op_sel_hi:[1,0]
  v_cvt_pk_bf16_f32 v116, v116, v117
  v_cvt_pk_bf16_f32 v117, v118, v119
  ds_write_b64 v14, v[116:117]
  s_waitcnt lgkmcnt(0)
  s_barrier
  ds_read_b128 v[48:51], v23 offset:0
  ds_read_b128 v[52:55], v23 offset:1024
  ds_read_b128 v[56:59], v23 offset:2048
  ds_read_b128 v[60:63], v23 offset:3072
  ds_read_b128 v[64:67], v23 offset:4096
  ds_read_b128 v[68:71], v23 offset:5120
  s_waitcnt lgkmcnt(5)
  v_mfma_f32_16x16x32_bf16 v[72:75], v[48:51], v[184:187], 0
  v_mfma_f32_16x16x32_bf16 v[76:79], v[48:51], v[208:211], 0
  v_mfma_f32_16x16x32_bf16 v[80:83], v[48:51], v[232:235], 0
  s_waitcnt lgkmcnt(4)
  v_mfma_f32_16x16x32_bf16 v[72:75], v[52:55], v[188:191], v[72:75]
  v_mfma_f32_16x16x32_bf16 v[76:79], v[52:55], v[212:215], v[76:79]
  v_mfma_f32_16x16x32_bf16 v[80:83], v[52:55], v[236:239], v[80:83]
  s_waitcnt lgkmcnt(3)
  v_mfma_f32_16x16x32_bf16 v[72:75], v[56:59], v[192:195], v[72:75]
  v_mfma_f32_16x16x32_bf16 v[76:79], v[56:59], v[216:219], v[76:79]
  v_mfma_f32_16x16x32_bf16 v[80:83], v[56:59], v[240:243], v[80:83]
  s_waitcnt lgkmcnt(2)
  v_mfma_f32_16x16x32_bf16 v[72:75], v[60:63], v[196:199], v[72:75]
  v_mfma_f32_16x16x32_bf16 v[76:79], v[60:63], v[220:223], v[76:79]
  v_mfma_f32_16x16x32_bf16 v[80:83], v[60:63], v[244:247], v[80:83]
  s_waitcnt lgkmcnt(1)
  v_mfma_f32_16x16x32_bf16 v[72:75], v[64:67], v[200:203], v[72:75]
  v_mfma_f32_16x16x32_bf16 v[76:79], v[64:67], v[224:227], v[76:79]
  v_mfma_f32_16x16x32_bf16 v[80:83], v[64:67], v[248:251], v[80:83]
  s_waitcnt lgkmcnt(0)
  v_mfma_f32_16x16x32_bf16 v[72:75], v[68:71], v[204:207], v[72:75]
  v_mfma_f32_16x16x32_bf16 v[76:79], v[68:71], v[228:231], v[76:79]
  v_mfma_f32_16x16x32_bf16 v[80:83], v[68:71], v[252:255], v[80:83]
  s_nop 3
  v_cvt_pk_bf16_f32 v84, v72, v73
  v_cvt_pk_bf16_f32 v85, v74, v75
  v_cvt_pk_bf16_f32 v86, v76, v77
  v_cvt_pk_bf16_f32 v87, v78, v79
  v_cvt_pk_bf16_f32 v88, v80, v81
  v_cvt_pk_bf16_f32 v89, v82, v83
  v_cvt_pk_bf16_f32 v90, v80, v81
  v_cvt_pk_bf16_f32 v91, v82, v83
  v_permlane16_swap_b32 v84, v86
  v_permlane16_swap_b32 v85, v87
  v_permlane16_swap_b32 v88, v90
  v_permlane16_swap_b32 v89, v91
  s_nop 0
  v_bfi_b32 v84, 1, s63, v84
  v_bfi_b32 v88, 1, s63, v88
  s_mov_b64 exec, 0xffffffff
  buffer_store_dwordx4 v[84:87], v15, s[48:51], s71 offen sc1
  s_mov_b64 exec, 0xffff
  buffer_store_dwordx4 v[88:91], v16, s[48:51], s71 offen sc1
  s_mov_b64 exec, -1
  s_waitcnt vmcnt(0)
  s_lshl_b32 s58, s52, 4
  s_add_u32 s58, s58, s54
  s_cmp_ge_u32 s58, 48
  s_cbranch_scc1 noc_9145
  s_mov_b32 s56, 0
  buffer_load_dwordx4 v[48:51], v2, s[48:51], s72 offen offset:0 sc1
  buffer_load_dwordx4 v[52:55], v2, s[48:51], s72 offen offset:1024 sc1
  buffer_load_dwordx4 v[56:59], v2, s[48:51], s72 offen offset:2048 sc1
  buffer_load_dwordx4 v[60:63], v2, s[48:51], s72 offen offset:3072 sc1
  s_waitcnt vmcnt(0)
gc_9146:
  v_xor_b32 v30, s64, v48
  v_xor_b32 v31, s64, v52
  v_and_b32 v30, v30, v31
  v_xor_b32 v31, s64, v56
  v_and_b32 v30, v30, v31
  v_xor_b32 v31, s64, v60
  v_and_b32 v30, v30, v31
  v_and_b32 v30, 1, v30
  v_cmp_eq_u32 vcc, 0, v30
  s_cbranch_vccnz gcr_9147
  s_branch gcd_9148
gcr_9147:
  s_cmp_lg_u32 s55, 0
  s_cbranch_scc1 gcd_9148
  s_add_u32 s56, s56, 1
  s_cmp_lt_u32 s56, 0x20000
  s_cbranch_scc1 gc_9146x
  s_mov_b32 s55, 1
gc_9146x:
  buffer_load_dwordx4 v[48:51], v2, s[48:51], s72 offen offset:0 sc1
  buffer_load_dwordx4 v[52:55], v2, s[48:51], s72 offen offset:1024 sc1
  buffer_load_dwordx4 v[56:59], v2, s[48:51], s72 offen offset:2048 sc1
  buffer_load_dwordx4 v[60:63], v2, s[48:51], s72 offen offset:3072 sc1
  s_waitcnt vmcnt(0)
  s_branch gc_9146
gcd_9148:
  v_mfma_f32_16x16x32_bf16 v[72:75], v[178:181], v[48:51], 0
  v_mfma_f32_16x16x32_bf16 v[72:75], v[178:181], v[52:55], v[72:75]
  v_mfma_f32_16x16x32_bf16 v[72:75], v[178:181], v[56:59], v[72:75]
  v_mfma_f32_16x16x32_bf16 v[72:75], v[178:181], v[60:63], v[72:75]
  s_nop 7
  v_add_f32_dpp v72, v72, v72 row_ror:8 row_mask:0xf bank_mask:0xf
  v_add_f32_dpp v73, v73, v73 row_ror:8 row_mask:0xf bank_mask:0xf
  v_add_f32_dpp v74, v74, v74 row_ror:8 row_mask:0xf bank_mask:0xf
  v_add_f32_dpp v75, v75, v75 row_ror:8 row_mask:0xf bank_mask:0xf
  s_nop 0
  v_cvt_pk_bf16_f32 v84, v72, v73
  v_cvt_pk_bf16_f32 v85, v74, v75
  v_cvt_pk_bf16_f32 v86, v72, v73
  v_cvt_pk_bf16_f32 v87, v74, v75
  s_nop 1
  v_permlane16_swap_b32 v84, v86
  v_permlane16_swap_b32 v85, v87
  s_nop 0
  v_bfi_b32 v84, 1, s63, v84
  s_mov_b64 exec, 0xff
  buffer_store_dwordx4 v[84:87], v17, s[48:51], s73 offen sc1
  s_mov_b64 exec, -1
  s_branch cdn_9149
noc_9145:
cdn_9149:
  s_sub_u32 s66, s66, s74
  s_add_u32 s73, s73, s74
  s_sub_u32 s74, 0, s74
  s_add_u32 s67, s67, s75
  s_add_u32 s68, s68, s75
  s_sub_u32 s75, 0, s75
  s_add_u32 s69, s69, s76
  s_add_u32 s70, s70, s76
  s_sub_u32 s76, 0, s76
  s_add_u32 s71, s71, s77
  s_add_u32 s72, s72, s77
  s_sub_u32 s77, 0, s77
  s_mov_b32 s65, s64
  s_add_u32 s62, s62, 1
  s_lshr_b32 s63, s62, 1
  s_add_u32 s63, s63, 1
  s_and_b32 s63, s63, 1
  s_sub_u32 s64, s63, 1
  s_add_u32 s100, s100, 196608
  s_barrier
  s_branch L_ch1_i
L_ch1x_i:
  s_waitcnt vmcnt(0)
  s_endpgm
L_chw0_i:
  s_mul_i32 s100, s99, 6144
  s_mul_i32 s58, s3, 1536
  s_add_u32 s100, s100, s58
  s_add_u32 s100, s100, 0x200000
  s_lshl_b32 s58, s52, 9
  s_add_u32 s100, s100, s58
  s_barrier
  s_waitcnt vmcnt(0)
  s_mov_b32 s3, 0x3dd53b95
  s_branch L_ch0a_i
L_ch0_i:
  s_mov_b32 s56, 0
ga_10150:
  buffer_load_dwordx4 v[36:39], v2, s[48:51], s66 offen sc1
  buffer_load_dwordx4 v[40:43], v2, s[48:51], s66 offen offset:1024 sc1
  buffer_load_dwordx4 v[44:47], v3, s[48:51], s66 offen sc1
ga_10150w:
  s_waitcnt vmcnt(0)
  v_xor_b32 v30, s65, v36
  v_xor_b32 v31, s65, v40
  v_and_b32 v30, v30, v31
  v_xor_b32 v31, s65, v44
  v_and_b32 v30, v30, v31
  v_and_b32 v30, 1, v30
  v_cmp_eq_u32 vcc, 0, v30
  s_cbranch_vccnz gar_10151
  s_branch gad_10152
gar_10151:
  s_cmp_lg_u32 s55, 0
  s_cbranch_scc1 gad_10152
  s_add_u32 s56, s56, 1
  s_cmp_lt_u32 s56, 0x20000
  s_cbranch_scc1 ga_10150
  s_mov_b32 s55, 1
gad_10152:
  ds_write_b128 v4, v[36:39]
  ds_write_b128 v4, v[40:43] offset:1024
  ds_write_b128 v5, v[44:47]
L_ch0a_i:
  s_waitcnt lgkmcnt(0)
  s_barrier
  ds_read_b64_tr_b16 v[48:49], v6 offset:0
  ds_read_b64_tr_b16 v[50:51], v6 offset:256
  ds_read_b64_tr_b16 v[52:53], v6 offset:512
  ds_read_b64_tr_b16 v[54:55], v6 offset:768
  ds_read_b64_tr_b16 v[56:57], v6 offset:1024
  ds_read_b64_tr_b16 v[58:59], v6 offset:1280
  ds_read_b64_tr_b16 v[60:61], v6 offset:1536
  ds_read_b64_tr_b16 v[62:63], v6 offset:1792
  ds_read_b64_tr_b16 v[64:65], v6 offset:2048
  ds_read_b64_tr_b16 v[66:67], v6 offset:2304
  ds_read_b64_tr_b16 v[68:69], v6 offset:2560
  ds_read_b64_tr_b16 v[70:71], v6 offset:2816
  ds_read_b64_tr_b16 v[72:73], v6 offset:3072
  ds_read_b64_tr_b16 v[74:75], v6 offset:3328
  s_waitcnt lgkmcnt(12)
  v_mfma_f32_16x16x32_bf16 v[128:131], a[0:3], v[48:51], 0
  v_mfma_f32_16x16x32_bf16 v[132:135], a[80:83], v[48:51], 0
  ds_read_b64_tr_b16 v[76:77], v6 offset:3584
  ds_read_b64_tr_b16 v[78:79], v6 offset:3840
  s_waitcnt lgkmcnt(12)
  v_mfma_f32_16x16x32_bf16 v[128:131], a[4:7], v[52:55], v[128:131]
  v_mfma_f32_16x16x32_bf16 v[132:135], a[84:87], v[52:55], v[132:135]
  ds_read_b64_tr_b16 v[80:81], v6 offset:4096
  ds_read_b64_tr_b16 v[82:83], v6 offset:4352
  s_waitcnt lgkmcnt(12)
  v_mfma_f32_16x16x32_bf16 v[128:131], a[8:11], v[56:59], v[128:131]
  v_mfma_f32_16x16x32_bf16 v[132:135], a[88:91], v[56:59], v[132:135]
  ds_read_b64_tr_b16 v[84:85], v6 offset:4608
  ds_read_b64_tr_b16 v[86:87], v6 offset:4864
  s_waitcnt lgkmcnt(12)
  v_mfma_f32_16x16x32_bf16 v[128:131], a[12:15], v[60:63], v[128:131]
  v_mfma_f32_16x16x32_bf16 v[132:135], a[92:95], v[60:63], v[132:135]
  ds_read_b64_tr_b16 v[88:89], v6 offset:5120
  ds_read_b64_tr_b16 v[90:91], v6 offset:5376
  s_waitcnt lgkmcnt(12)
  v_mfma_f32_16x16x32_bf16 v[128:131], a[16:19], v[64:67], v[128:131]
  v_mfma_f32_16x16x32_bf16 v[132:135], a[96:99], v[64:67], v[132:135]
  ds_read_b64_tr_b16 v[92:93], v6 offset:5632
  ds_read_b64_tr_b16 v[94:95], v6 offset:5888
  s_waitcnt lgkmcnt(12)
  v_mfma_f32_16x16x32_bf16 v[128:131], a[20:23], v[68:71], v[128:131]
  v_mfma_f32_16x16x32_bf16 v[132:135], a[100:103], v[68:71], v[132:135]
  ds_read_b64_tr_b16 v[96:97], v6 offset:6144
  ds_read_b64_tr_b16 v[98:99], v6 offset:6400
  s_waitcnt lgkmcnt(12)
  v_mfma_f32_16x16x32_bf16 v[128:131], a[24:27], v[72:75], v[128:131]
  v_mfma_f32_16x16x32_bf16 v[132:135], a[104:107], v[72:75], v[132:135]
  ds_read_b64_tr_b16 v[100:101], v6 offset:6656
  ds_read_b64_tr_b16 v[102:103], v6 offset:6912
  s_waitcnt lgkmcnt(12)
  v_mfma_f32_16x16x32_bf16 v[128:131], a[28:31], v[76:79], v[128:131]
  v_mfma_f32_16x16x32_bf16 v[132:135], a[108:111], v[76:79], v[132:135]
  ds_read_b64_tr_b16 v[104:105], v6 offset:7168
  ds_read_b64_tr_b16 v[106:107], v6 offset:7424
  s_waitcnt lgkmcnt(12)
  v_mfma_f32_16x16x32_bf16 v[128:131], a[32:35], v[80:83], v[128:131]
  v_mfma_f32_16x16x32_bf16 v[132:135], a[112:115], v[80:83], v[132:135]
  ds_read_b64_tr_b16 v[108:109], v6 offset:7680
  ds_read_b64_tr_b16 v[110:111], v6 offset:7936
  s_waitcnt lgkmcnt(12)
  v_mfma_f32_16x16x32_bf16 v[128:131], a[36:39], v[84:87], v[128:131]
  v_mfma_f32_16x16x32_bf16 v[132:135], a[116:119], v[84:87], v[132:135]
  ds_read_b64_tr_b16 v[112:113], v6 offset:8192
  ds_read_b64_tr_b16 v[114:115], v6 offset:8448
  s_waitcnt lgkmcnt(12)
  v_mfma_f32_16x16x32_bf16 v[128:131], a[40:43], v[88:91], v[128:131]
  v_mfma_f32_16x16x32_bf16 v[132:135], a[120:123], v[88:91], v[132:135]
  ds_read_b64_tr_b16 v[116:117], v6 offset:8704
  ds_read_b64_tr_b16 v[118:119], v6 offset:8960
  s_waitcnt lgkmcnt(12)
  v_mfma_f32_16x16x32_bf16 v[128:131], a[44:47], v[92:95], v[128:131]
  v_mfma_f32_16x16x32_bf16 v[132:135], a[124:127], v[92:95], v[132:135]
  ds_read_b64_tr_b16 v[120:121], v6 offset:9216
  ds_read_b64_tr_b16 v[122:123], v6 offset:9472
  s_waitcnt lgkmcnt(12)
  v_mfma_f32_16x16x32_bf16 v[128:131], a[48:51], v[96:99], v[128:131]
  v_mfma_f32_16x16x32_bf16 v[132:135], a[128:131], v[96:99], v[132:135]
  ds_read_b64_tr_b16 v[124:125], v6 offset:9728
  ds_read_b64_tr_b16 v[126:127], v6 offset:9984
  s_waitcnt lgkmcnt(12)
  v_mfma_f32_16x16x32_bf16 v[128:131], a[52:55], v[100:103], v[128:131]
  v_mfma_f32_16x16x32_bf16 v[132:135], a[132:135], v[100:103], v[132:135]
  ds_read_b128 v[146:149], v2 offset:0
  ds_read_b128 v[150:153], v2 offset:1024
  ds_read_b128 v[154:157], v2 offset:2048
  s_waitcnt lgkmcnt(13)
  v_mfma_f32_16x16x32_bf16 v[128:131], a[56:59], v[104:107], v[128:131]
  v_mfma_f32_16x16x32_bf16 v[132:135], a[136:139], v[104:107], v[132:135]
  s_waitcnt lgkmcnt(11)
  v_mfma_f32_16x16x32_bf16 v[128:131], a[60:63], v[108:111], v[128:131]
  v_mfma_f32_16x16x32_bf16 v[132:135], a[140:143], v[108:111], v[132:135]
  s_waitcnt lgkmcnt(9)
  v_mfma_f32_16x16x32_bf16 v[128:131], a[64:67], v[112:115], v[128:131]
  v_mfma_f32_16x16x32_bf16 v[132:135], a[144:147], v[112:115], v[132:135]
  s_waitcnt lgkmcnt(7)
  v_mfma_f32_16x16x32_bf16 v[128:131], a[68:71], v[116:119], v[128:131]
  v_mfma_f32_16x16x32_bf16 v[132:135], a[148:151], v[116:119], v[132:135]
  s_waitcnt lgkmcnt(5)
  v_mfma_f32_16x16x32_bf16 v[128:131], a[72:75], v[120:123], v[128:131]
  v_mfma_f32_16x16x32_bf16 v[132:135], a[152:155], v[120:123], v[132:135]
  s_waitcnt lgkmcnt(3)
  v_mfma_f32_16x16x32_bf16 v[128:131], a[76:79], v[124:127], v[128:131]
  v_mfma_f32_16x16x32_bf16 v[132:135], a[156:159], v[124:127], v[132:135]
  s_waitcnt lgkmcnt(0)
  s_nop 5
  v_cvt_pk_bf16_f32 v140, v128, v129
  v_cvt_pk_bf16_f32 v141, v130, v131
  s_nop 0
  v_cvt_pk_bf16_f32 v142, v132, v133
  v_cvt_pk_bf16_f32 v143, v134, v135
  ds_write_b64 v20, v[142:143] offset:1536
  s_nop 0
  v_mfma_f32_16x16x16_bf16 v[112:115], v[142:143], v[140:141], 0
  v_mfma_f32_16x16x16_bf16 v[116:119], v[146:147], v[140:141], 0
  v_mfma_f32_16x16x16_bf16 v[120:123], v[148:149], v[140:141], 0
  s_waitcnt lgkmcnt(0)
  s_barrier
  s_cmp_eq_u32 s62, 63
  s_cbranch_scc1 L_ch0x_i
  ds_read_b64 v[170:171], v20 offset:512
  ds_read_b64 v[172:173], v20 offset:2048
  ds_read_b64 v[174:175], v20 offset:1024
  ds_read_b64 v[176:177], v20 offset:2560
  s_waitcnt lgkmcnt(2)
  v_mfma_f32_16x16x16_bf16 v[112:115], v[172:173], v[170:171], v[112:115]
  v_mfma_f32_16x16x16_bf16 v[116:119], v[150:151], v[170:171], v[116:119]
  v_mfma_f32_16x16x16_bf16 v[120:123], v[152:153], v[170:171], v[120:123]
  s_waitcnt lgkmcnt(0)
  v_mfma_f32_16x16x16_bf16 v[112:115], v[176:177], v[174:175], v[112:115]
  v_mfma_f32_16x16x16_bf16 v[116:119], v[154:155], v[174:175], v[116:119]
  v_mfma_f32_16x16x16_bf16 v[120:123], v[156:157], v[174:175], v[120:123]
  v_and_b32 v30, 8, v1
  v_cmp_eq_u32 vcc, 0, v30
  s_nop 5
  v_bfi_b32 v112, 1, s63, v112
  v_cndmask_b32 v116, v120, v116, vcc
  v_cndmask_b32 v117, v121, v117, vcc
  v_cndmask_b32 v118, v122, v118, vcc
  v_cndmask_b32 v119, v123, v119, vcc
  v_bfi_b32 v116, 1, s63, v116
  buffer_store_dwordx4 v[116:119], v2, s[48:51], s67 offen sc1
  s_mov_b64 exec, 0x00ff00ff
  buffer_store_dwordx4 v[112:115], v10, s[48:51], s67 offen sc1
  s_mov_b64 exec, -1
  ds_read_b128 v[158:161], v7 offset:0
  ds_read_b128 v[162:165], v7 offset:1024
  ds_read_b128 v[166:169], v7 offset:2048
  s_mov_b32 s56, 0
gs_10153:
  buffer_load_dwordx4 v[48:51], v2, s[48:51], s68 offen offset:0 sc1
  buffer_load_dwordx4 v[52:55], v2, s[48:51], s68 offen offset:1280 sc1
  buffer_load_dwordx4 v[56:59], v2, s[48:51], s68 offen offset:2560 sc1
  buffer_load_dwordx4 v[60:63], v2, s[48:51], s68 offen offset:3840 sc1
  buffer_load_dwordx4 v[64:67], v9, s[48:51], s68 offen offset:0 sc1
  buffer_load_dwordx4 v[68:71], v9, s[48:51], s68 offen offset:1280 sc1
  buffer_load_dwordx4 v[72:75], v9, s[48:51], s68 offen offset:2560 sc1
  buffer_load_dwordx4 v[76:79], v9, s[48:51], s68 offen offset:3840 sc1
  buffer_load_dwordx4 v[80:83], v11, s[48:51], s70 offen offset:0 sc1
  buffer_load_dwordx4 v[84:87], v11, s[48:51], s70 offen offset:512 sc1
  buffer_load_dwordx4 v[88:91], v11, s[48:51], s70 offen offset:1024 sc1
gs_10153w:
  s_waitcnt vmcnt(0)
  v_xor_b32 v30, s64, v48
  v_xor_b32 v31, s64, v52
  v_and_b32 v30, v30, v31
  v_xor_b32 v31, s64, v56
  v_and_b32 v30, v30, v31
  v_xor_b32 v31, s64, v60
  v_and_b32 v30, v30, v31
  v_xor_b32 v31, s64, v64
  v_and_b32 v30, v30, v31
  v_xor_b32 v31, s64, v68
  v_and_b32 v30, v30, v31
  v_xor_b32 v31, s64, v72
  v_and_b32 v30, v30, v31
  v_xor_b32 v31, s64, v76
  v_and_b32 v30, v30, v31
  v_xor_b32 v31, s64, v80
  v_and_b32 v30, v30, v31
  v_xor_b32 v31, s64, v84
  v_and_b32 v30, v30, v31
  v_xor_b32 v31, s64, v88
  v_and_b32 v30, v30, v31
  v_and_b32 v30, 1, v30
  v_cmp_eq_u32 vcc, 0, v30
  s_cbranch_vccnz gsr_10154
  s_branch gsd_10155
gsr_10154:
  s_cmp_lg_u32 s55, 0
  s_cbranch_scc1 gsd_10155
  s_add_u32 s56, s56, 1
  s_cmp_lt_u32 s56, 0x20000
  s_cbranch_scc1 gs_10153
  s_mov_b32 s55, 1
gsd_10155:
  v_pk_add_f32 v[48:49], v[48:49], v[52:53]
  v_pk_add_f32 v[50:51], v[50:51], v[54:55]
  v_pk_add_f32 v[56:57], v[56:57], v[60:61]
  v_pk_add_f32 v[58:59], v[58:59], v[62:63]
  v_pk_add_f32 v[64:65], v[64:65], v[68:69]
  v_pk_add_f32 v[66:67], v[66:67], v[70:71]
  v_pk_add_f32 v[72:73], v[72:73], v[76:77]
  v_pk_add_f32 v[74:75], v[74:75], v[78:79]
  v_pk_add_f32 v[48:49], v[48:49], v[56:57]
  v_pk_add_f32 v[50:51], v[50:51], v[58:59]
  v_pk_add_f32 v[64:65], v[64:65], v[72:73]
  v_pk_add_f32 v[66:67], v[66:67], v[74:75]
  v_max3_f32 v30, v48, v49, v50
  v_max3_f32 v31, v51, v64, v65
  v_max3_f32 v30, v30, v66, v67
  v_max_f32 v30, v30, v31
  s_nop 1
  v_max_f32_dpp v30, v30, v30 row_ror:8 row_mask:0xf bank_mask:0xf
  v_mov_b32 v31, v30
  s_nop 1
  v_permlane16_swap_b32 v30, v31
  s_nop 0
  v_max_f32 v30, v30, v31
  v_mov_b32 v31, v30
  s_nop 1
  v_permlane32_swap_b32 v30, v31
  s_nop 0
  v_max_f32 v30, v30, v31
  v_mul_f32 v30, s3, v30
  v_fma_f32 v48, v48, s3, -v30
  v_fma_f32 v49, v49, s3, -v30
  v_fma_f32 v50, v50, s3, -v30
  v_fma_f32 v51, v51, s3, -v30
  v_fma_f32 v64, v64, s3, -v30
  v_fma_f32 v65, v65, s3, -v30
  v_fma_f32 v66, v66, s3, -v30
  v_fma_f32 v67, v67, s3, -v30
  v_exp_f32 v48, v48
  v_exp_f32 v49, v49
  v_exp_f32 v50, v50
  v_exp_f32 v51, v51
  v_exp_f32 v64, v64
  v_exp_f32 v65, v65
  v_exp_f32 v66, v66
  v_exp_f32 v67, v67
  v_cvt_pk_bf16_f32 v100, v48, v49
  v_cvt_pk_bf16_f32 v101, v50, v51
  v_cvt_pk_bf16_f32 v104, v64, v65
  v_cvt_pk_bf16_f32 v105, v66, v67
  v_mov_b32_dpp v102, v100 row_ror:8 row_mask:0xf bank_mask:0xf
  v_mov_b32_dpp v103, v101 row_ror:8 row_mask:0xf bank_mask:0xf
  v_and_b32 v104, v104, v28
  v_and_b32 v105, v105, v28
  ds_write_b128 v21, v[100:103]
  ds_write_b64 v22, v[104:105]
  v_cvt_pk_bf16_f32 v92, v80, v81
  v_cvt_pk_bf16_f32 v93, v82, v83
  v_cvt_pk_bf16_f32 v94, v84, v85
  v_cvt_pk_bf16_f32 v95, v86, v87
  v_cvt_pk_bf16_f32 v96, v88, v89
  v_cvt_pk_bf16_f32 v97, v90, v91
  s_waitcnt lgkmcnt(0)
  s_barrier
  v_mfma_f32_16x16x32_bf16 v[120:123], v[24:27], v[100:103], 0
  v_mfma_f32_16x16x32_bf16 v[108:111], v[158:161], v[100:103], 0
  v_mfma_f32_16x16x32_bf16 v[112:115], v[162:165], v[100:103], 0
  v_mfma_f32_16x16x32_bf16 v[116:119], v[166:169], v[100:103], 0
  v_mfma_f32_16x16x16_bf16 v[120:123], v[24:25], v[104:105], v[120:123]
  v_mfma_f32_16x16x16_bf16 v[108:111], v[92:93], v[104:105], v[108:111]
  v_mfma_f32_16x16x16_bf16 v[112:115], v[94:95], v[104:105], v[112:115]
  v_mfma_f32_16x16x16_bf16 v[116:119], v[96:97], v[104:105], v[116:119]
  s_nop 4
  v_rcp_f32 v30, v120
  s_nop 2
  v_pk_mul_f32 v[108:109], v[108:109], v[30:31] op_sel_hi:[1,0]
  v_pk_mul_f32 v[110:111], v[110:111], v[30:31] op_sel_hi:[1,0]
  v_cvt_pk_bf16_f32 v108, v108, v109
  v_cvt_pk_bf16_f32 v109, v110, v111
  ds_write_b64 v12, v[108:109]
  v_pk_mul_f32 v[112:113], v[112:113], v[30:31] op_sel_hi:[1,0]
  v_pk_mul_f32 v[114:115], v[114:115], v[30:31] op_sel_hi:[1,0]
  v_cvt_pk_bf16_f32 v112, v112, v113
  v_cvt_pk_bf16_f32 v113, v114, v115
  ds_write_b64 v13, v[112:113]
  v_pk_mul_f32 v[116:117], v[116:117], v[30:31] op_sel_hi:[1,0]
  v_pk_mul_f32 v[118:119], v[118:119], v[30:31] op_sel_hi:[1,0]
  v_cvt_pk_bf16_f32 v116, v116, v117
  v_cvt_pk_bf16_f32 v117, v118, v119
  ds_write_b64 v14, v[116:117]
  s_waitcnt lgkmcnt(0)
  s_barrier
  ds_read_b128 v[48:51], v23 offset:0
  ds_read_b128 v[52:55], v23 offset:1024
  ds_read_b128 v[56:59], v23 offset:2048
  ds_read_b128 v[60:63], v23 offset:3072
  ds_read_b128 v[64:67], v23 offset:4096
  ds_read_b128 v[68:71], v23 offset:5120
  s_waitcnt lgkmcnt(5)
  v_mfma_f32_16x16x32_bf16 v[72:75], v[48:51], v[184:187], 0
  v_mfma_f32_16x16x32_bf16 v[76:79], v[48:51], v[208:211], 0
  v_mfma_f32_16x16x32_bf16 v[80:83], v[48:51], v[232:235], 0
  s_waitcnt lgkmcnt(4)
  v_mfma_f32_16x16x32_bf16 v[72:75], v[52:55], v[188:191], v[72:75]
  v_mfma_f32_16x16x32_bf16 v[76:79], v[52:55], v[212:215], v[76:79]
  v_mfma_f32_16x16x32_bf16 v[80:83], v[52:55], v[236:239], v[80:83]
  s_waitcnt lgkmcnt(3)
  v_mfma_f32_16x16x32_bf16 v[72:75], v[56:59], v[192:195], v[72:75]
  v_mfma_f32_16x16x32_bf16 v[76:79], v[56:59], v[216:219], v[76:79]
  v_mfma_f32_16x16x32_bf16 v[80:83], v[56:59], v[240:243], v[80:83]
  s_waitcnt lgkmcnt(2)
  v_mfma_f32_16x16x32_bf16 v[72:75], v[60:63], v[196:199], v[72:75]
  v_mfma_f32_16x16x32_bf16 v[76:79], v[60:63], v[220:223], v[76:79]
  v_mfma_f32_16x16x32_bf16 v[80:83], v[60:63], v[244:247], v[80:83]
  s_waitcnt lgkmcnt(1)
  v_mfma_f32_16x16x32_bf16 v[72:75], v[64:67], v[200:203], v[72:75]
  v_mfma_f32_16x16x32_bf16 v[76:79], v[64:67], v[224:227], v[76:79]
  v_mfma_f32_16x16x32_bf16 v[80:83], v[64:67], v[248:251], v[80:83]
  s_waitcnt lgkmcnt(0)
  v_mfma_f32_16x16x32_bf16 v[72:75], v[68:71], v[204:207], v[72:75]
  v_mfma_f32_16x16x32_bf16 v[76:79], v[68:71], v[228:231], v[76:79]
  v_mfma_f32_16x16x32_bf16 v[80:83], v[68:71], v[252:255], v[80:83]
  s_nop 3
  v_cvt_pk_bf16_f32 v84, v72, v73
  v_cvt_pk_bf16_f32 v85, v74, v75
  v_cvt_pk_bf16_f32 v86, v76, v77
  v_cvt_pk_bf16_f32 v87, v78, v79
  v_cvt_pk_bf16_f32 v88, v80, v81
  v_cvt_pk_bf16_f32 v89, v82, v83
  v_cvt_pk_bf16_f32 v90, v80, v81
  v_cvt_pk_bf16_f32 v91, v82, v83
  v_permlane16_swap_b32 v84, v86
  v_permlane16_swap_b32 v85, v87
  v_permlane16_swap_b32 v88, v90
  v_permlane16_swap_b32 v89, v91
  s_nop 0
  v_bfi_b32 v84, 1, s63, v84
  v_bfi_b32 v88, 1, s63, v88
  s_mov_b64 exec, 0xffffffff
  buffer_store_dwordx4 v[84:87], v15, s[48:51], s71 offen sc1
  s_mov_b64 exec, 0xffff
  buffer_store_dwordx4 v[88:91], v16, s[48:51], s71 offen sc1
  s_mov_b64 exec, -1
  s_waitcnt vmcnt(0)
  s_mov_b32 s56, 0
  buffer_load_dwordx4 v[48:51], v2, s[48:51], s72 offen offset:0 sc1
  buffer_load_dwordx4 v[52:55], v2, s[48:51], s72 offen offset:1024 sc1
  buffer_load_dwordx4 v[56:59], v2, s[48:51], s72 offen offset:2048 sc1
  buffer_load_dwordx4 v[60:63], v2, s[48:51], s72 offen offset:3072 sc1
  s_waitcnt vmcnt(0)
gc_10157:
  v_xor_b32 v30, s64, v48
  v_xor_b32 v31, s64, v52
  v_and_b32 v30, v30, v31
  v_xor_b32 v31, s64, v56
  v_and_b32 v30, v30, v31
  v_xor_b32 v31, s64, v60
  v_and_b32 v30, v30, v31
  v_and_b32 v30, 1, v30
  v_cmp_eq_u32 vcc, 0, v30
  s_cbranch_vccnz gcr_10158
  s_branch gcd_10159
gcr_10158:
  s_cmp_lg_u32 s55, 0
  s_cbranch_scc1 gcd_10159
  s_add_u32 s56, s56, 1
  s_cmp_lt_u32 s56, 0x20000
  s_cbranch_scc1 gc_10157x
  s_mov_b32 s55, 1
gc_10157x:
  buffer_load_dwordx4 v[48:51], v2, s[48:51], s72 offen offset:0 sc1
  buffer_load_dwordx4 v[52:55], v2, s[48:51], s72 offen offset:1024 sc1
  buffer_load_dwordx4 v[56:59], v2, s[48:51], s72 offen offset:2048 sc1
  buffer_load_dwordx4 v[60:63], v2, s[48:51], s72 offen offset:3072 sc1
  s_waitcnt vmcnt(0)
  s_branch gc_10157
gcd_10159:
  v_mfma_f32_16x16x32_bf16 v[72:75], v[178:181], v[48:51], 0
  v_mfma_f32_16x16x32_bf16 v[72:75], v[178:181], v[52:55], v[72:75]
  v_mfma_f32_16x16x32_bf16 v[72:75], v[178:181], v[56:59], v[72:75]
  v_mfma_f32_16x16x32_bf16 v[72:75], v[178:181], v[60:63], v[72:75]
  s_nop 7
  v_add_f32_dpp v72, v72, v72 row_ror:8 row_mask:0xf bank_mask:0xf
  v_add_f32_dpp v73, v73, v73 row_ror:8 row_mask:0xf bank_mask:0xf
  v_add_f32_dpp v74, v74, v74 row_ror:8 row_mask:0xf bank_mask:0xf
  v_add_f32_dpp v75, v75, v75 row_ror:8 row_mask:0xf bank_mask:0xf
  s_nop 0
  v_cvt_pk_bf16_f32 v84, v72, v73
  v_cvt_pk_bf16_f32 v85, v74, v75
  v_cvt_pk_bf16_f32 v86, v72, v73
  v_cvt_pk_bf16_f32 v87, v74, v75
  s_nop 1
  v_permlane16_swap_b32 v84, v86
  v_permlane16_swap_b32 v85, v87
  s_nop 0
  v_bfi_b32 v84, 1, s63, v84
  s_mov_b64 exec, 0xff
  buffer_store_dwordx4 v[84:87], v17, s[48:51], s73 offen sc1
  s_mov_b64 exec, -1
  s_branch cdn_10160
noc_10156:
cdn_10160:
  s_sub_u32 s66, s66, s74
  s_add_u32 s73, s73, s74
  s_sub_u32 s74, 0, s74
  s_add_u32 s67, s67, s75
  s_add_u32 s68, s68, s75
  s_sub_u32 s75, 0, s75
  s_add_u32 s69, s69, s76
  s_add_u32 s70, s70, s76
  s_sub_u32 s76, 0, s76
  s_add_u32 s71, s71, s77
  s_add_u32 s72, s72, s77
  s_sub_u32 s77, 0, s77
  s_mov_b32 s65, s64
  s_add_u32 s62, s62, 1
  s_lshr_b32 s63, s62, 1
  s_add_u32 s63, s63, 1
  s_and_b32 s63, s63, 1
  s_sub_u32 s64, s63, 1
  s_add_u32 s100, s100, 196608
  s_barrier
  s_branch L_ch0_i
L_ch0x_i:
  s_waitcnt vmcnt(0)
  s_endpgm
L_chw3_i:
  s_mul_i32 s100, s99, 6144
  s_mul_i32 s58, s3, 1536
  s_add_u32 s100, s100, s58
  s_add_u32 s100, s100, 0xe00000
  s_xor_b32 s59, s3, 1
  s_mul_i32 s59, s59, 1536
  s_sub_u32 s59, s59, s58
  s_add_u32 s100, s100, s59
  s_add_u32 s60, s59, 0xc00000
  s_barrier
  s_mov_b32 s59, 1
  s_cmp_ge_u32 s101, s59
  s_cbranch_scc1 t1ok_14161
  s_mov_b32 s56, 0
t1p_14162:
  buffer_load_dword v30, v19, s[48:51], 0 offen sc1
  s_waitcnt vmcnt(0)
  v_readlane_b32 s58, v30, 0
  v_readlane_b32 s101, v30, 1
  s_min_u32 s101, s101, s58
  s_cmp_ge_u32 s101, s59
  s_cbranch_scc1 t1ok_14161
  s_cmp_lg_u32 s55, 0
  s_cbranch_scc1 t1ok_14161
  s_add_u32 s56, s56, 1
  s_cmp_lt_u32 s56, 0x20000
  s_cbranch_scc1 t1p_14162
  s_mov_b32 s55, 1
t1ok_14161:
  s_mov_b32 m0, 0
  s_nop 0
  buffer_load_dwordx4 v2, s[48:51], s78 offen offset:0 sc1 lds
  buffer_load_dwordx4 v2, s[48:51], s78 offen offset:1024 sc1 lds
  buffer_load_dwordx4 v2, s[48:51], s78 offen offset:2048 sc1 lds
  s_add_u32 s58, s79, 0
  s_mov_b32 m0, 3072
  s_nop 0
  buffer_load_dwordx4 v2, s[48:51], s58 offen offset:0 sc1 lds
  buffer_load_dwordx4 v2, s[48:51], s58 offen offset:1024 sc1 lds
  buffer_load_dwordx4 v2, s[48:51], s58 offen offset:2048 sc1 lds
  buffer_load_dwordx4 v2, s[48:51], s58 offen offset:3072 sc1 lds
  s_add_u32 s58, s79, 4096
  s_mov_b32 m0, 7168
  s_nop 0
  buffer_load_dwordx4 v2, s[48:51], s58 offen offset:0 sc1 lds
  buffer_load_dwordx4 v2, s[48:51], s58 offen offset:1024 sc1 lds
  buffer_load_dwordx4 v2, s[48:51], s58 offen offset:2048 sc1 lds
  buffer_load_dwordx4 v2, s[48:51], s58 offen offset:3072 sc1 lds
  s_add_u32 s58, s79, 8192
  s_mov_b32 m0, 11264
  s_nop 0
  buffer_load_dwordx4 v2, s[48:51], s58 offen offset:0 sc1 lds
  buffer_load_dwordx4 v2, s[48:51], s58 offen offset:1024 sc1 lds
  buffer_load_dwordx4 v2, s[48:51], s58 offen offset:2048 sc1 lds
  buffer_load_dwordx4 v2, s[48:51], s58 offen offset:3072 sc1 lds
  s_add_u32 s78, s78, 393216
  s_add_u32 s79, s79, 393216
  s_waitcnt vmcnt(0)
  s_mov_b32 s3, 0x3dd53b95
  s_branch L_ch3a_i
L_ch3_i:
  s_mov_b32 s56, 0
ga_14163:
  buffer_load_dwordx4 v[36:39], v2, s[48:51], s66 offen sc1
  buffer_load_dwordx4 v[40:43], v2, s[48:51], s66 offen offset:1024 sc1
  buffer_load_dwordx4 v[44:47], v3, s[48:51], s66 offen sc1
ga_14163w:
  s_waitcnt vmcnt(0)
  v_xor_b32 v30, s65, v36
  v_xor_b32 v31, s65, v40
  v_and_b32 v30, v30, v31
  v_xor_b32 v31, s65, v44
  v_and_b32 v30, v30, v31
  v_and_b32 v30, 1, v30
  v_cmp_eq_u32 vcc, 0, v30
  s_cbranch_vccnz gar_14164
  s_branch gad_14165
gar_14164:
  s_cmp_lg_u32 s55, 0
  s_cbranch_scc1 gad_14165
  s_add_u32 s56, s56, 1
  s_cmp_lt_u32 s56, 0x20000
  s_cbranch_scc1 ga_14163
  s_mov_b32 s55, 1
gad_14165:
  ds_write_b128 v4, v[36:39]
  ds_write_b128 v4, v[40:43] offset:1024
  ds_write_b128 v5, v[44:47]
L_ch3a_i:
  s_waitcnt lgkmcnt(0)
  s_barrier
  ds_read_b64_tr_b16 v[48:49], v6 offset:0
  ds_read_b64_tr_b16 v[50:51], v6 offset:256
  ds_read_b64_tr_b16 v[52:53], v6 offset:512
  ds_read_b64_tr_b16 v[54:55], v6 offset:768
  ds_read_b64_tr_b16 v[56:57], v6 offset:1024
  ds_read_b64_tr_b16 v[58:59], v6 offset:1280
  ds_read_b64_tr_b16 v[60:61], v6 offset:1536
  ds_read_b64_tr_b16 v[62:63], v6 offset:1792
  ds_read_b64_tr_b16 v[64:65], v6 offset:2048
  ds_read_b64_tr_b16 v[66:67], v6 offset:2304
  ds_read_b64_tr_b16 v[68:69], v6 offset:2560
  ds_read_b64_tr_b16 v[70:71], v6 offset:2816
  ds_read_b64_tr_b16 v[72:73], v6 offset:3072
  ds_read_b64_tr_b16 v[74:75], v6 offset:3328
  s_waitcnt lgkmcnt(12)
  v_mfma_f32_16x16x32_bf16 v[128:131], v[48:51], a[0:3], 0
  v_mfma_f32_16x16x32_bf16 v[132:135], v[48:51], a[80:83], 0
  v_mfma_f32_16x16x32_bf16 v[136:139], v[48:51], a[160:163], 0
  ds_read_b64_tr_b16 v[76:77], v6 offset:3584
  ds_read_b64_tr_b16 v[78:79], v6 offset:3840
  s_waitcnt lgkmcnt(12)
  v_mfma_f32_16x16x32_bf16 v[128:131], v[52:55], a[4:7], v[128:131]
  v_mfma_f32_16x16x32_bf16 v[132:135], v[52:55], a[84:87], v[132:135]
  v_mfma_f32_16x16x32_bf16 v[136:139], v[52:55], a[164:167], v[136:139]
  ds_read_b64_tr_b16 v[80:81], v6 offset:4096
  ds_read_b64_tr_b16 v[82:83], v6 offset:4352
  s_waitcnt lgkmcnt(12)
  v_mfma_f32_16x16x32_bf16 v[128:131], v[56:59], a[8:11], v[128:131]
  v_mfma_f32_16x16x32_bf16 v[132:135], v[56:59], a[88:91], v[132:135]
  v_mfma_f32_16x16x32_bf16 v[136:139], v[56:59], a[168:171], v[136:139]
  ds_read_b64_tr_b16 v[84:85], v6 offset:4608
  ds_read_b64_tr_b16 v[86:87], v6 offset:4864
  s_waitcnt lgkmcnt(12)
  v_mfma_f32_16x16x32_bf16 v[128:131], v[60:63], a[12:15], v[128:131]
  v_mfma_f32_16x16x32_bf16 v[132:135], v[60:63], a[92:95], v[132:135]
  v_mfma_f32_16x16x32_bf16 v[136:139], v[60:63], a[172:175], v[136:139]
  ds_read_b64_tr_b16 v[88:89], v6 offset:5120
  ds_read_b64_tr_b16 v[90:91], v6 offset:5376
  s_waitcnt lgkmcnt(12)
  v_mfma_f32_16x16x32_bf16 v[128:131], v[64:67], a[16:19], v[128:131]
  v_mfma_f32_16x16x32_bf16 v[132:135], v[64:67], a[96:99], v[132:135]
  v_mfma_f32_16x16x32_bf16 v[136:139], v[64:67], a[176:179], v[136:139]
  ds_read_b64_tr_b16 v[92:93], v6 offset:5632
  ds_read_b64_tr_b16 v[94:95], v6 offset:5888
  s_waitcnt lgkmcnt(12)
  v_mfma_f32_16x16x32_bf16 v[128:131], v[68:71], a[20:23], v[128:131]
  v_mfma_f32_16x16x32_bf16 v[132:135], v[68:71], a[100:103], v[132:135]
  v_mfma_f32_16x16x32_bf16 v[136:139], v[68:71], a[180:183], v[136:139]
  ds_read_b64_tr_b16 v[96:97], v6 offset:6144
  ds_read_b64_tr_b16 v[98:99], v6 offset:6400
  s_waitcnt lgkmcnt(12)
  v_mfma_f32_16x16x32_bf16 v[128:131], v[72:75], a[24:27], v[128:131]
  v_mfma_f32_16x16x32_bf16 v[132:135], v[72:75], a[104:107], v[132:135]
  v_mfma_f32_16x16x32_bf16 v[136:139], v[72:75], a[184:187], v[136:139]
  ds_read_b64_tr_b16 v[100:101], v6 offset:6656
  ds_read_b64_tr_b16 v[102:103], v6 offset:6912
  s_waitcnt lgkmcnt(12)
  v_mfma_f32_16x16x32_bf16 v[128:131], v[76:79], a[28:31], v[128:131]
  v_mfma_f32_16x16x32_bf16 v[132:135], v[76:79], a[108:111], v[132:135]
  v_mfma_f32_16x16x32_bf16 v[136:139], v[76:79], a[188:191], v[136:139]
  ds_read_b64_tr_b16 v[104:105], v6 offset:7168
  ds_read_b64_tr_b16 v[106:107], v6 offset:7424
  s_waitcnt lgkmcnt(12)
  v_mfma_f32_16x16x32_bf16 v[128:131], v[80:83], a[32:35], v[128:131]
  v_mfma_f32_16x16x32_bf16 v[132:135], v[80:83], a[112:115], v[132:135]
  v_mfma_f32_16x16x32_bf16 v[136:139], v[80:83], a[192:195], v[136:139]
  ds_read_b64_tr_b16 v[108:109], v6 offset:7680
  ds_read_b64_tr_b16 v[110:111], v6 offset:7936
  s_waitcnt lgkmcnt(12)
  v_mfma_f32_16x16x32_bf16 v[128:131], v[84:87], a[36:39], v[128:131]
  v_mfma_f32_16x16x32_bf16 v[132:135], v[84:87], a[116:119], v[132:135]
  v_mfma_f32_16x16x32_bf16 v[136:139], v[84:87], a[196:199], v[136:139]
  ds_read_b64_tr_b16 v[112:113], v6 offset:8192
  ds_read_b64_tr_b16 v[114:115], v6 offset:8448
  s_waitcnt lgkmcnt(12)
  v_mfma_f32_16x16x32_bf16 v[128:131], v[88:91], a[40:43], v[128:131]
  v_mfma_f32_16x16x32_bf16 v[132:135], v[88:91], a[120:123], v[132:135]
  v_mfma_f32_16x16x32_bf16 v[136:139], v[88:91], a[200:203], v[136:139]
  ds_read_b64_tr_b16 v[116:117], v6 offset:8704
  ds_read_b64_tr_b16 v[118:119], v6 offset:8960
  s_waitcnt lgkmcnt(12)
  v_mfma_f32_16x16x32_bf16 v[128:131], v[92:95], a[44:47], v[128:131]
  v_mfma_f32_16x16x32_bf16 v[132:135], v[92:95], a[124:127], v[132:135]
  v_mfma_f32_16x16x32_bf16 v[136:139], v[92:95], a[204:207], v[136:139]
  ds_read_b64_tr_b16 v[120:121], v6 offset:9216
  ds_read_b64_tr_b16 v[122:123], v6 offset:9472
  s_waitcnt lgkmcnt(12)
  v_mfma_f32_16x16x32_bf16 v[128:131], v[96:99], a[48:51], v[128:131]
  v_mfma_f32_16x16x32_bf16 v[132:135], v[96:99], a[128:131], v[132:135]
  v_mfma_f32_16x16x32_bf16 v[136:139], v[96:99], a[208:211], v[136:139]
  ds_read_b64_tr_b16 v[124:125], v6 offset:9728
  ds_read_b64_tr_b16 v[126:127], v6 offset:9984
  s_waitcnt lgkmcnt(12)
  v_mfma_f32_16x16x32_bf16 v[128:131], v[100:103], a[52:55], v[128:131]
  v_mfma_f32_16x16x32_bf16 v[132:135], v[100:103], a[132:135], v[132:135]
  v_mfma_f32_16x16x32_bf16 v[136:139], v[100:103], a[212:215], v[136:139]
  s_waitcnt lgkmcnt(10)
  v_mfma_f32_16x16x32_bf16 v[128:131], v[104:107], a[56:59], v[128:131]
  v_mfma_f32_16x16x32_bf16 v[132:135], v[104:107], a[136:139], v[132:135]
  v_mfma_f32_16x16x32_bf16 v[136:139], v[104:107], a[216:219], v[136:139]
  s_waitcnt lgkmcnt(8)
  v_mfma_f32_16x16x32_bf16 v[128:131], v[108:111], a[60:63], v[128:131]
  v_mfma_f32_16x16x32_bf16 v[132:135], v[108:111], a[140:143], v[132:135]
  v_mfma_f32_16x16x32_bf16 v[136:139], v[108:111], a[220:223], v[136:139]
  s_waitcnt lgkmcnt(6)
  v_mfma_f32_16x16x32_bf16 v[128:131], v[112:115], a[64:67], v[128:131]
  v_mfma_f32_16x16x32_bf16 v[132:135], v[112:115], a[144:147], v[132:135]
  v_mfma_f32_16x16x32_bf16 v[136:139], v[112:115], a[224:227], v[136:139]
  s_barrier
  s_waitcnt lgkmcnt(4)
  v_mfma_f32_16x16x32_bf16 v[128:131], v[116:119], a[68:71], v[128:131]
  v_mfma_f32_16x16x32_bf16 v[132:135], v[116:119], a[148:151], v[132:135]
  v_mfma_f32_16x16x32_bf16 v[136:139], v[116:119], a[228:231], v[136:139]
  s_waitcnt lgkmcnt(2)
  v_mfma_f32_16x16x32_bf16 v[128:131], v[120:123], a[72:75], v[128:131]
  v_mfma_f32_16x16x32_bf16 v[132:135], v[120:123], a[152:155], v[132:135]
  v_mfma_f32_16x16x32_bf16 v[136:139], v[120:123], a[232:235], v[136:139]
  s_waitcnt lgkmcnt(0)
  v_mfma_f32_16x16x32_bf16 v[128:131], v[124:127], a[76:79], v[128:131]
  v_mfma_f32_16x16x32_bf16 v[132:135], v[124:127], a[156:159], v[132:135]
  v_mfma_f32_16x16x32_bf16 v[136:139], v[124:127], a[236:239], v[136:139]
  s_nop 7
  v_cvt_pk_bf16_f32 v140, v128, v129
  v_cvt_pk_bf16_f32 v141, v130, v131
  v_cvt_pk_bf16_f32 v142, v132, v133
  v_cvt_pk_bf16_f32 v143, v134, v135
  v_cvt_pk_bf16_f32 v144, v136, v137
  v_cvt_pk_bf16_f32 v145, v138, v139
  s_cmp_eq_u32 s62, 63
  s_cbranch_scc1 L_ch3x_i
  v_bfi_b32 v128, 1, s63, v128
  v_bfi_b32 v132, 1, s63, v132
  v_bfi_b32 v136, 1, s63, v136
  s_mov_b64 exec, 0xffffffff
  buffer_store_dwordx4 v[128:131], v2, s[48:51], s69 offen offset:0 sc1
  buffer_store_dwordx4 v[132:135], v2, s[48:51], s69 offen offset:512 sc1
  buffer_store_dwordx4 v[136:139], v2, s[48:51], s69 offen offset:1024 sc1
  s_mov_b64 exec, -1
  ds_read_b64 v[170:171], v20 offset:1536
  ds_read_b64 v[172:173], v20 offset:2048
  ds_read_b64 v[174:175], v20 offset:2560
  ds_read_b128 v[158:161], v7 offset:0
  ds_read_b128 v[162:165], v7 offset:1024
  ds_read_b128 v[166:169], v7 offset:2048
  s_mov_b32 s56, 0
gv_14166:
  buffer_load_dwordx4 v[80:83], v11, s[48:51], s70 offen offset:0 sc1
  buffer_load_dwordx4 v[84:87], v11, s[48:51], s70 offen offset:512 sc1
  buffer_load_dwordx4 v[88:91], v11, s[48:51], s70 offen offset:1024 sc1
gv_14166w:
  s_waitcnt vmcnt(0)
  v_xor_b32 v30, s64, v80
  v_xor_b32 v31, s64, v84
  v_and_b32 v30, v30, v31
  v_xor_b32 v31, s64, v88
  v_and_b32 v30, v30, v31
  v_and_b32 v30, 1, v30
  v_cmp_eq_u32 vcc, 0, v30
  s_cbranch_vccnz gvr_14167
  s_branch gvd_14168
gvr_14167:
  s_cmp_lg_u32 s55, 0
  s_cbranch_scc1 gvd_14168
  s_add_u32 s56, s56, 1
  s_cmp_lt_u32 s56, 0x20000
  s_cbranch_scc1 gv_14166
  s_mov_b32 s55, 1
gvd_14168:
  v_cvt_pk_bf16_f32 v92, v80, v81
  v_cvt_pk_bf16_f32 v93, v82, v83
  v_cvt_pk_bf16_f32 v94, v84, v85
  v_cvt_pk_bf16_f32 v95, v86, v87
  v_cvt_pk_bf16_f32 v96, v88, v89
  v_cvt_pk_bf16_f32 v97, v90, v91
  s_waitcnt lgkmcnt(0)
  s_barrier
  ds_read_b128 v[100:103], v21
  ds_read_b64 v[104:105], v22
  s_waitcnt lgkmcnt(0)
  v_mfma_f32_16x16x32_bf16 v[120:123], v[24:27], v[100:103], 0
  v_mfma_f32_16x16x32_bf16 v[108:111], v[158:161], v[100:103], 0
  v_mfma_f32_16x16x32_bf16 v[112:115], v[162:165], v[100:103], 0
  v_mfma_f32_16x16x32_bf16 v[116:119], v[166:169], v[100:103], 0
  v_mfma_f32_16x16x16_bf16 v[120:123], v[24:25], v[104:105], v[120:123]
  v_mfma_f32_16x16x16_bf16 v[108:111], v[92:93], v[104:105], v[108:111]
  v_mfma_f32_16x16x16_bf16 v[112:115], v[94:95], v[104:105], v[112:115]
  v_mfma_f32_16x16x16_bf16 v[116:119], v[96:97], v[104:105], v[116:119]
  s_nop 4
  v_rcp_f32 v30, v120
  s_nop 2
  v_pk_mul_f32 v[108:109], v[108:109], v[30:31] op_sel_hi:[1,0]
  v_pk_mul_f32 v[110:111], v[110:111], v[30:31] op_sel_hi:[1,0]
  v_cvt_pk_bf16_f32 v108, v108, v109
  v_cvt_pk_bf16_f32 v109, v110, v111
  ds_write_b64 v12, v[108:109]
  v_pk_mul_f32 v[112:113], v[112:113], v[30:31] op_sel_hi:[1,0]
  v_pk_mul_f32 v[114:115], v[114:115], v[30:31] op_sel_hi:[1,0]
  v_cvt_pk_bf16_f32 v112, v112, v113
  v_cvt_pk_bf16_f32 v113, v114, v115
  ds_write_b64 v13, v[112:113]
  v_pk_mul_f32 v[116:117], v[116:117], v[30:31] op_sel_hi:[1,0]
  v_pk_mul_f32 v[118:119], v[118:119], v[30:31] op_sel_hi:[1,0]
  v_cvt_pk_bf16_f32 v116, v116, v117
  v_cvt_pk_bf16_f32 v117, v118, v119
  ds_write_b64 v14, v[116:117]
  s_waitcnt lgkmcnt(0)
  s_barrier
  ds_read_b128 v[48:51], v23 offset:0
  ds_read_b128 v[52:55], v23 offset:1024
  ds_read_b128 v[56:59], v23 offset:2048
  ds_read_b128 v[60:63], v23 offset:3072
  ds_read_b128 v[64:67], v23 offset:4096
  ds_read_b128 v[68:71], v23 offset:5120
  buffer_store_dwordx2 v[140:141], v8, s[48:51], s100 offen offset:0 sc1
  buffer_store_dwordx2 v[142:143], v8, s[48:51], s100 offen offset:512 sc1
  buffer_store_dwordx2 v[144:145], v8, s[48:51], s100 offen offset:1024 sc1
  s_sub_u32 s58, s100, s60
  buffer_store_dwordx2 v[170:171], v8, s[48:51], s58 offen offset:0 sc1
  buffer_store_dwordx2 v[172:173], v8, s[48:51], s58 offen offset:512 sc1
  buffer_store_dwordx2 v[174:175], v8, s[48:51], s58 offen offset:1024 sc1
  s_add_u32 s59, s62, 2
  s_min_u32 s59, s59, 64
  s_cmp_ge_u32 s101, s59
  s_cbranch_scc1 t1ok_14169
  s_mov_b32 s56, 0
t1p_14170:
  buffer_load_dword v30, v19, s[48:51], 0 offen sc1
  s_waitcnt vmcnt(0)
  v_readlane_b32 s58, v30, 0
  v_readlane_b32 s101, v30, 1
  s_min_u32 s101, s101, s58
  s_cmp_ge_u32 s101, s59
  s_cbranch_scc1 t1ok_14169
  s_cmp_lg_u32 s55, 0
  s_cbranch_scc1 t1ok_14169
  s_add_u32 s56, s56, 1
  s_cmp_lt_u32 s56, 0x20000
  s_cbranch_scc1 t1p_14170
  s_mov_b32 s55, 1
t1ok_14169:
  s_mov_b32 m0, 0
  s_nop 0
  buffer_load_dwordx4 v2, s[48:51], s78 offen offset:0 sc1 lds
  buffer_load_dwordx4 v2, s[48:51], s78 offen offset:1024 sc1 lds
  buffer_load_dwordx4 v2, s[48:51], s78 offen offset:2048 sc1 lds
  s_add_u32 s58, s79, 0
  s_mov_b32 m0, 3072
  s_nop 0
  buffer_load_dwordx4 v2, s[48:51], s58 offen offset:0 sc1 lds
  buffer_load_dwordx4 v2, s[48:51], s58 offen offset:1024 sc1 lds
  buffer_load_dwordx4 v2, s[48:51], s58 offen offset:2048 sc1 lds
  buffer_load_dwordx4 v2, s[48:51], s58 offen offset:3072 sc1 lds
  s_add_u32 s58, s79, 4096
  s_mov_b32 m0, 7168
  s_nop 0
  buffer_load_dwordx4 v2, s[48:51], s58 offen offset:0 sc1 lds
  buffer_load_dwordx4 v2, s[48:51], s58 offen offset:1024 sc1 lds
  buffer_load_dwordx4 v2, s[48:51], s58 offen offset:2048 sc1 lds
  buffer_load_dwordx4 v2, s[48:51], s58 offen offset:3072 sc1 lds
  s_add_u32 s58, s79, 8192
  s_mov_b32 m0, 11264
  s_nop 0
  buffer_load_dwordx4 v2, s[48:51], s58 offen offset:0 sc1 lds
  buffer_load_dwordx4 v2, s[48:51], s58 offen offset:1024 sc1 lds
  buffer_load_dwordx4 v2, s[48:51], s58 offen offset:2048 sc1 lds
  buffer_load_dwordx4 v2, s[48:51], s58 offen offset:3072 sc1 lds
  s_add_u32 s78, s78, 393216
  s_add_u32 s79, s79, 393216
  s_waitcnt lgkmcnt(5)
  v_mfma_f32_16x16x32_bf16 v[72:75], v[48:51], v[184:187], 0
  s_waitcnt lgkmcnt(4)
  v_mfma_f32_16x16x32_bf16 v[72:75], v[52:55], v[188:191], v[72:75]
  s_waitcnt lgkmcnt(3)
  v_mfma_f32_16x16x32_bf16 v[72:75], v[56:59], v[192:195], v[72:75]
  s_waitcnt lgkmcnt(2)
  v_mfma_f32_16x16x32_bf16 v[72:75], v[60:63], v[196:199], v[72:75]
  s_waitcnt lgkmcnt(1)
  v_mfma_f32_16x16x32_bf16 v[72:75], v[64:67], v[200:203], v[72:75]
  s_waitcnt lgkmcnt(0)
  v_mfma_f32_16x16x32_bf16 v[72:75], v[68:71], v[204:207], v[72:75]
  s_nop 7
  s_nop 0
  v_cvt_pk_bf16_f32 v84, v72, v73
  v_cvt_pk_bf16_f32 v85, v74, v75
  v_cvt_pk_bf16_f32 v86, v72, v73
  v_cvt_pk_bf16_f32 v87, v74, v75
  s_nop 1
  v_permlane16_swap_b32 v84, v86
  v_permlane16_swap_b32 v85, v87
  s_nop 0
  v_bfi_b32 v84, 1, s63, v84
  s_mov_b64 exec, 0xffff
  buffer_store_dwordx4 v[84:87], v15, s[48:51], s71 offen sc1
  s_mov_b64 exec, -1
  s_waitcnt vmcnt(16)
  s_add_u32 s58, s62, 1
  v_mov_b32 v30, s58
  s_mov_b64 exec, 1
  buffer_store_dword v30, v18, s[48:51], 0 offen sc1
  s_mov_b64 exec, -1
noc_14171:
  s_sub_u32 s66, s66, s74
  s_add_u32 s73, s73, s74
  s_sub_u32 s74, 0, s74
  s_add_u32 s67, s67, s75
  s_add_u32 s68, s68, s75
  s_sub_u32 s75, 0, s75
  s_add_u32 s69, s69, s76
  s_add_u32 s70, s70, s76
  s_sub_u32 s76, 0, s76
  s_add_u32 s71, s71, s77
  s_add_u32 s72, s72, s77
  s_sub_u32 s77, 0, s77
  s_mov_b32 s65, s64
  s_add_u32 s62, s62, 1
  s_lshr_b32 s63, s62, 1
  s_add_u32 s63, s63, 1
  s_and_b32 s63, s63, 1
  s_sub_u32 s64, s63, 1
  s_add_u32 s100, s100, 196608
  s_barrier
  s_branch L_ch3_i
L_ch3x_i:
  ds_read_b64 v[170:171], v20 offset:1536
  ds_read_b64 v[172:173], v20 offset:2048
  ds_read_b64 v[174:175], v20 offset:2560
  buffer_store_dwordx2 v[140:141], v8, s[48:51], s100 offen offset:0 sc1
  buffer_store_dwordx2 v[142:143], v8, s[48:51], s100 offen offset:512 sc1
  buffer_store_dwordx2 v[144:145], v8, s[48:51], s100 offen offset:1024 sc1
  s_sub_u32 s58, s100, s60
  s_waitcnt lgkmcnt(0)
  buffer_store_dwordx2 v[170:171], v8, s[48:51], s58 offen offset:0 sc1
  buffer_store_dwordx2 v[172:173], v8, s[48:51], s58 offen offset:512 sc1
  buffer_store_dwordx2 v[174:175], v8, s[48:51], s58 offen offset:1024 sc1
  s_waitcnt vmcnt(0)
  s_add_u32 s58, s62, 1
  v_mov_b32 v30, s58
  s_mov_b64 exec, 1
  buffer_store_dword v30, v18, s[48:51], 0 offen sc1
  s_mov_b64 exec, -1
  s_waitcnt vmcnt(0)
  s_endpgm
L_bulk_i:
  s_sub_u32 s53, s53, 4
  s_cmp_lt_u32 s54, 16
  s_cbranch_scc0 L_t23_i
  s_lshl_b32 s69, s53, 3
  s_lshr_b32 s58, s54, 1
  s_add_u32 s69, s69, s58
  s_bitcmp1_b32 s54, 0
  s_cbranch_scc1 L_t1v_i
  v_and_b32 v1, 63, v0
  s_mul_i32 s58, s52, 640
  s_add_u32 s59, s58, 0
  v_add_u32 v18, s59, v1
  v_mul_u32_u24 v19, 3277, v18
  v_lshrrev_b32 v19, 18, v19
  v_mul_u32_u24 v20, 80, v19
  v_sub_u32 v18, v18, v20
  v_and_b32 v20, 15, v19
  v_xor_b32 v18, v18, v20
  v_lshlrev_b32 v18, 4, v18
  v_mul_u32_u24 v19, 1280, v19
  v_add_u32 v92, v18, v19
  s_add_u32 s59, s58, 64
  v_add_u32 v18, s59, v1
  v_mul_u32_u24 v19, 3277, v18
  v_lshrrev_b32 v19, 18, v19
  v_mul_u32_u24 v20, 80, v19
  v_sub_u32 v18, v18, v20
  v_and_b32 v20, 15, v19
  v_xor_b32 v18, v18, v20
  v_lshlrev_b32 v18, 4, v18
  v_mul_u32_u24 v19, 1280, v19
  v_add_u32 v93, v18, v19
  s_add_u32 s59, s58, 128
  v_add_u32 v18, s59, v1
  v_mul_u32_u24 v19, 3277, v18
  v_lshrrev_b32 v19, 18, v19
  v_mul_u32_u24 v20, 80, v19
  v_sub_u32 v18, v18, v20
  v_and_b32 v20, 15, v19
  v_xor_b32 v18, v18, v20
  v_lshlrev_b32 v18, 4, v18
  v_mul_u32_u24 v19, 1280, v19
  v_add_u32 v94, v18, v19
  s_add_u32 s59, s58, 192
  v_add_u32 v18, s59, v1
  v_mul_u32_u24 v19, 3277, v18
  v_lshrrev_b32 v19, 18, v19
  v_mul_u32_u24 v20, 80, v19
  v_sub_u32 v18, v18, v20
  v_and_b32 v20, 15, v19
  v_xor_b32 v18, v18, v20
  v_lshlrev_b32 v18, 4, v18
  v_mul_u32_u24 v19, 1280, v19
  v_add_u32 v95, v18, v19
  s_add_u32 s59, s58, 256
  v_add_u32 v18, s59, v1
  v_mul_u32_u24 v19, 3277, v18
  v_lshrrev_b32 v19, 18, v19
  v_mul_u32_u24 v20, 80, v19
  v_sub_u32 v18, v18, v20
  v_and_b32 v20, 15, v19
  v_xor_b32 v18, v18, v20
  v_lshlrev_b32 v18, 4, v18
  v_mul_u32_u24 v19, 1280, v19
  v_add_u32 v96, v18, v19
  s_add_u32 s59, s58, 320
  v_add_u32 v18, s59, v1
  v_mul_u32_u24 v19, 3277, v18
  v_lshrrev_b32 v19, 18, v19
  v_mul_u32_u24 v20, 80, v19
  v_sub_u32 v18, v18, v20
  v_and_b32 v20, 15, v19
  v_xor_b32 v18, v18, v20
  v_lshlrev_b32 v18, 4, v18
  v_mul_u32_u24 v19, 1280, v19
  v_add_u32 v97, v18, v19
  s_add_u32 s59, s58, 384
  v_add_u32 v18, s59, v1
  v_mul_u32_u24 v19, 3277, v18
  v_lshrrev_b32 v19, 18, v19
  v_mul_u32_u24 v20, 80, v19
  v_sub_u32 v18, v18, v20
  v_and_b32 v20, 15, v19
  v_xor_b32 v18, v18, v20
  v_lshlrev_b32 v18, 4, v18
  v_mul_u32_u24 v19, 1280, v19
  v_add_u32 v98, v18, v19
  s_add_u32 s59, s58, 448
  v_add_u32 v18, s59, v1
  v_mul_u32_u24 v19, 3277, v18
  v_lshrrev_b32 v19, 18, v19
  v_mul_u32_u24 v20, 80, v19
  v_sub_u32 v18, v18, v20
  v_and_b32 v20, 15, v19
  v_xor_b32 v18, v18, v20
  v_lshlrev_b32 v18, 4, v18
  v_mul_u32_u24 v19, 1280, v19
  v_add_u32 v99, v18, v19
  s_add_u32 s59, s58, 512
  v_add_u32 v18, s59, v1
  v_mul_u32_u24 v19, 3277, v18
  v_lshrrev_b32 v19, 18, v19
  v_mul_u32_u24 v20, 80, v19
  v_sub_u32 v18, v18, v20
  v_and_b32 v20, 15, v19
  v_xor_b32 v18, v18, v20
  v_lshlrev_b32 v18, 4, v18
  v_mul_u32_u24 v19, 1280, v19
  v_add_u32 v100, v18, v19
  s_add_u32 s59, s58, 576
  v_add_u32 v18, s59, v1
  v_mul_u32_u24 v19, 3277, v18
  v_lshrrev_b32 v19, 18, v19
  v_mul_u32_u24 v20, 80, v19
  v_sub_u32 v18, v18, v20
  v_and_b32 v20, 15, v19
  v_xor_b32 v18, v18, v20
  v_lshlrev_b32 v18, 4, v18
  v_mul_u32_u24 v19, 1280, v19
  v_add_u32 v101, v18, v19
  v_and_b32 v18, 15, v1
  v_lshrrev_b32 v19, 4, v1
  v_xor_b32 v19, v19, v18
  v_mul_u32_u24 v18, 1280, v18
  v_add_u32 v18, 0x1e000, v18
  v_xor_b32 v20, 0, v19
  v_lshlrev_b32 v20, 4, v20
  v_add_u32 v102, v18, v20
  v_xor_b32 v20, 4, v19
  v_lshlrev_b32 v20, 4, v20
  v_add_u32 v103, v18, v20
  v_xor_b32 v20, 8, v19
  v_lshlrev_b32 v20, 4, v20
  v_add_u32 v104, v18, v20
  v_xor_b32 v20, 12, v19
  v_lshlrev_b32 v20, 4, v20
  v_add_u32 v105, v18, v20
  v_lshrrev_b32 v18, 4, v1
  v_lshrrev_b32 v19, 2, v1
  v_and_b32 v19, 3, v19
  v_lshlrev_b32 v20, 3, v18
  v_add_u32 v20, v20, v19
  v_mul_u32_u24 v20, 384, v20
  v_and_b32 v21, 3, v1
  v_lshlrev_b32 v21, 3, v21
  v_add_u32 v20, v20, v21
  v_lshrrev_b32 v19, 1, v19
  v_and_b32 v18, 1, v18
  v_lshlrev_b32 v18, 1, v18
  v_or_b32 v18, v18, v19
  s_mul_i32 s58, s52, 3
  s_add_u32 s59, s58, 0
  v_xor_b32 v19, s59, v18
  v_lshlrev_b32 v19, 5, v19
  v_add_u32 v26, v19, v20
  s_add_u32 s59, s58, 1
  v_xor_b32 v19, s59, v18
  v_lshlrev_b32 v19, 5, v19
  v_add_u32 v27, v19, v20
  s_add_u32 s59, s58, 2
  v_xor_b32 v19, s59, v18
  v_lshlrev_b32 v19, 5, v19
  v_add_u32 v28, v19, v20
  s_mul_i32 s67, s69, 384
  s_mov_b32 s64, 0
  s_mul_i32 s65, s52, 10240
  s_add_u32 s65, s65, 122880
  v_mov_b32 v18, v0
  v_mul_u32_u24 v19, 2731, v18
  v_lshrrev_b32 v19, 16, v19
  v_mul_u32_u24 v20, 24, v19
  v_sub_u32 v18, v18, v20
  v_and_b32 v20, 2, v19
  v_lshrrev_b32 v21, 1, v19
  v_and_b32 v21, 4, v21
  v_or_b32 v20, v20, v21
  v_xor_b32 v18, v18, v20
  v_mul_u32_u24 v19, 12288, v19
  v_lshlrev_b32 v18, 4, v18
  v_add_u32 v2, v18, v19
  v_add_u32 v18, 256, v0
  v_mul_u32_u24 v19, 2731, v18
  v_lshrrev_b32 v19, 16, v19
  v_mul_u32_u24 v20, 24, v19
  v_sub_u32 v18, v18, v20
  v_and_b32 v20, 2, v19
  v_lshrrev_b32 v21, 1, v19
  v_and_b32 v21, 4, v21
  v_or_b32 v20, v20, v21
  v_xor_b32 v18, v18, v20
  v_mul_u32_u24 v19, 12288, v19
  v_lshlrev_b32 v18, 4, v18
  v_add_u32 v3, v18, v19
  v_add_u32 v18, 512, v0
  v_mul_u32_u24 v19, 2731, v18
  v_lshrrev_b32 v19, 16, v19
  v_mul_u32_u24 v20, 24, v19
  v_sub_u32 v18, v18, v20
  v_and_b32 v20, 2, v19
  v_lshrrev_b32 v21, 1, v19
  v_and_b32 v21, 4, v21
  v_or_b32 v20, v20, v21
  v_xor_b32 v18, v18, v20
  v_mul_u32_u24 v19, 12288, v19
  v_lshlrev_b32 v18, 4, v18
  v_add_u32 v4, v18, v19
  v_add_u32 v18, 768, v0
  v_mul_u32_u24 v19, 2731, v18
  v_lshrrev_b32 v19, 16, v19
  v_mul_u32_u24 v20, 24, v19
  v_sub_u32 v18, v18, v20
  v_and_b32 v20, 2, v19
  v_lshrrev_b32 v21, 1, v19
  v_and_b32 v21, 4, v21
  v_or_b32 v20, v20, v21
  v_xor_b32 v18, v18, v20
  v_mul_u32_u24 v19, 12288, v19
  v_lshlrev_b32 v18, 4, v18
  v_add_u32 v5, v18, v19
  v_add_u32 v18, 1024, v0
  v_mul_u32_u24 v19, 2731, v18
  v_lshrrev_b32 v19, 16, v19
  v_mul_u32_u24 v20, 24, v19
  v_sub_u32 v18, v18, v20
  v_and_b32 v20, 2, v19
  v_lshrrev_b32 v21, 1, v19
  v_and_b32 v21, 4, v21
  v_or_b32 v20, v20, v21
  v_xor_b32 v18, v18, v20
  v_mul_u32_u24 v19, 12288, v19
  v_lshlrev_b32 v18, 4, v18
  v_add_u32 v6, v18, v19
  v_add_u32 v18, 1280, v0
  v_mul_u32_u24 v19, 2731, v18
  v_lshrrev_b32 v19, 16, v19
  v_mul_u32_u24 v20, 24, v19
  v_sub_u32 v18, v18, v20
  v_and_b32 v20, 2, v19
  v_lshrrev_b32 v21, 1, v19
  v_and_b32 v21, 4, v21
  v_or_b32 v20, v20, v21
  v_xor_b32 v18, v18, v20
  v_mul_u32_u24 v19, 12288, v19
  v_lshlrev_b32 v18, 4, v18
  v_add_u32 v7, v18, v19
  v_add_u32 v18, 1536, v0
  v_mul_u32_u24 v19, 2731, v18
  v_lshrrev_b32 v19, 16, v19
  v_mul_u32_u24 v20, 24, v19
  v_sub_u32 v18, v18, v20
  v_and_b32 v20, 2, v19
  v_lshrrev_b32 v21, 1, v19
  v_and_b32 v21, 4, v21
  v_or_b32 v20, v20, v21
  v_xor_b32 v18, v18, v20
  v_mul_u32_u24 v19, 12288, v19
  v_lshlrev_b32 v18, 4, v18
  v_add_u32 v8, v18, v19
  v_add_u32 v18, 1792, v0
  v_mul_u32_u24 v19, 2731, v18
  v_lshrrev_b32 v19, 16, v19
  v_mul_u32_u24 v20, 24, v19
  v_sub_u32 v18, v18, v20
  v_and_b32 v20, 2, v19
  v_lshrrev_b32 v21, 1, v19
  v_and_b32 v21, 4, v21
  v_or_b32 v20, v20, v21
  v_xor_b32 v18, v18, v20
  v_mul_u32_u24 v19, 12288, v19
  v_lshlrev_b32 v18, 4, v18
  v_add_u32 v9, v18, v19
  v_add_u32 v18, 2048, v0
  v_mul_u32_u24 v19, 2731, v18
  v_lshrrev_b32 v19, 16, v19
  v_mul_u32_u24 v20, 24, v19
  v_sub_u32 v18, v18, v20
  v_and_b32 v20, 2, v19
  v_lshrrev_b32 v21, 1, v19
  v_and_b32 v21, 4, v21
  v_or_b32 v20, v20, v21
  v_xor_b32 v18, v18, v20
  v_mul_u32_u24 v19, 12288, v19
  v_lshlrev_b32 v18, 4, v18
  v_add_u32 v10, v18, v19
  v_add_u32 v18, 2304, v0
  v_mul_u32_u24 v19, 2731, v18
  v_lshrrev_b32 v19, 16, v19
  v_mul_u32_u24 v20, 24, v19
  v_sub_u32 v18, v18, v20
  v_and_b32 v20, 2, v19
  v_lshrrev_b32 v21, 1, v19
  v_and_b32 v21, 4, v21
  v_or_b32 v20, v20, v21
  v_xor_b32 v18, v18, v20
  v_mul_u32_u24 v19, 12288, v19
  v_lshlrev_b32 v18, 4, v18
  v_add_u32 v11, v18, v19
  v_add_u32 v18, 2560, v0
  v_mul_u32_u24 v19, 2731, v18
  v_lshrrev_b32 v19, 16, v19
  v_mul_u32_u24 v20, 24, v19
  v_sub_u32 v18, v18, v20
  v_and_b32 v20, 2, v19
  v_lshrrev_b32 v21, 1, v19
  v_and_b32 v21, 4, v21
  v_or_b32 v20, v20, v21
  v_xor_b32 v18, v18, v20
  v_mul_u32_u24 v19, 12288, v19
  v_lshlrev_b32 v18, 4, v18
  v_add_u32 v12, v18, v19
  v_add_u32 v18, 2816, v0
  v_mul_u32_u24 v19, 2731, v18
  v_lshrrev_b32 v19, 16, v19
  v_mul_u32_u24 v20, 24, v19
  v_sub_u32 v18, v18, v20
  v_and_b32 v20, 2, v19
  v_lshrrev_b32 v21, 1, v19
  v_and_b32 v21, 4, v21
  v_or_b32 v20, v20, v21
  v_xor_b32 v18, v18, v20
  v_mul_u32_u24 v19, 12288, v19
  v_lshlrev_b32 v18, 4, v18
  v_add_u32 v13, v18, v19
  v_add_u32 v18, 3072, v0
  v_mul_u32_u24 v19, 2731, v18
  v_lshrrev_b32 v19, 16, v19
  v_mul_u32_u24 v20, 24, v19
  v_sub_u32 v18, v18, v20
  v_and_b32 v20, 2, v19
  v_lshrrev_b32 v21, 1, v19
  v_and_b32 v21, 4, v21
  v_or_b32 v20, v20, v21
  v_xor_b32 v18, v18, v20
  v_mul_u32_u24 v19, 12288, v19
  v_lshlrev_b32 v18, 4, v18
  v_add_u32 v14, v18, v19
  v_add_u32 v18, 3328, v0
  v_mul_u32_u24 v19, 2731, v18
  v_lshrrev_b32 v19, 16, v19
  v_mul_u32_u24 v20, 24, v19
  v_sub_u32 v18, v18, v20
  v_and_b32 v20, 2, v19
  v_lshrrev_b32 v21, 1, v19
  v_and_b32 v21, 4, v21
  v_or_b32 v20, v20, v21
  v_xor_b32 v18, v18, v20
  v_mul_u32_u24 v19, 12288, v19
  v_lshlrev_b32 v18, 4, v18
  v_add_u32 v15, v18, v19
  v_add_u32 v18, 3584, v0
  v_mul_u32_u24 v19, 2731, v18
  v_lshrrev_b32 v19, 16, v19
  v_mul_u32_u24 v20, 24, v19
  v_sub_u32 v18, v18, v20
  v_and_b32 v20, 2, v19
  v_lshrrev_b32 v21, 1, v19
  v_and_b32 v21, 4, v21
  v_or_b32 v20, v20, v21
  v_xor_b32 v18, v18, v20
  v_mul_u32_u24 v19, 12288, v19
  v_lshlrev_b32 v18, 4, v18
  v_add_u32 v16, v18, v19
  s_add_u32 m0, s65, 0
  s_nop 0
  buffer_load_dwordx4 v92, s[4:7], s64 offen lds
  s_add_u32 m0, s65, 1024
  s_nop 0
  buffer_load_dwordx4 v93, s[4:7], s64 offen lds
  s_add_u32 m0, s65, 2048
  s_nop 0
  buffer_load_dwordx4 v94, s[4:7], s64 offen lds
  s_add_u32 m0, s65, 3072
  s_nop 0
  buffer_load_dwordx4 v95, s[4:7], s64 offen lds
  s_add_u32 m0, s65, 4096
  s_nop 0
  buffer_load_dwordx4 v96, s[4:7], s64 offen lds
  s_add_u32 m0, s65, 5120
  s_nop 0
  buffer_load_dwordx4 v97, s[4:7], s64 offen lds
  s_add_u32 m0, s65, 6144
  s_nop 0
  buffer_load_dwordx4 v98, s[4:7], s64 offen lds
  s_add_u32 m0, s65, 7168
  s_nop 0
  buffer_load_dwordx4 v99, s[4:7], s64 offen lds
  s_add_u32 m0, s65, 8192
  s_nop 0
  buffer_load_dwordx4 v100, s[4:7], s64 offen lds
  s_add_u32 m0, s65, 9216
  s_nop 0
  buffer_load_dwordx4 v101, s[4:7], s64 offen lds
  s_mov_b32 s70, s67
  s_lshl_b32 s60, s52, 10
  s_add_u32 s60, s60, 0x0
  s_add_u32 m0, s60, 0
  s_nop 0
  buffer_load_dwordx4 v2, s[16:19], s70 offen lds
  s_add_u32 m0, s60, 4096
  s_nop 0
  buffer_load_dwordx4 v3, s[16:19], s70 offen lds
  s_add_u32 m0, s60, 8192
  s_nop 0
  buffer_load_dwordx4 v4, s[16:19], s70 offen lds
  s_add_u32 m0, s60, 12288
  s_nop 0
  buffer_load_dwordx4 v5, s[16:19], s70 offen lds
  s_add_u32 m0, s60, 16384
  s_nop 0
  buffer_load_dwordx4 v6, s[16:19], s70 offen lds
  s_add_u32 m0, s60, 20480
  s_nop 0
  buffer_load_dwordx4 v7, s[16:19], s70 offen lds
  s_add_u32 m0, s60, 24576
  s_nop 0
  buffer_load_dwordx4 v8, s[16:19], s70 offen lds
  s_add_u32 m0, s60, 28672
  s_nop 0
  buffer_load_dwordx4 v9, s[16:19], s70 offen lds
  s_add_u32 m0, s60, 32768
  s_nop 0
  buffer_load_dwordx4 v10, s[16:19], s70 offen lds
  s_add_u32 m0, s60, 36864
  s_nop 0
  buffer_load_dwordx4 v11, s[16:19], s70 offen lds
  s_add_u32 m0, s60, 40960
  s_nop 0
  buffer_load_dwordx4 v12, s[16:19], s70 offen lds
  s_add_u32 m0, s60, 45056
  s_nop 0
  buffer_load_dwordx4 v13, s[16:19], s70 offen lds
  s_add_u32 m0, s60, 49152
  s_nop 0
  buffer_load_dwordx4 v14, s[16:19], s70 offen lds
  s_add_u32 m0, s60, 53248
  s_nop 0
  buffer_load_dwordx4 v15, s[16:19], s70 offen lds
  s_add_u32 m0, s60, 57344
  s_nop 0
  buffer_load_dwordx4 v16, s[16:19], s70 offen lds
  s_add_u32 s70, s70, 1966080
  s_lshl_b32 s60, s52, 10
  s_add_u32 s60, s60, 0xf000
  s_add_u32 m0, s60, 0
  s_nop 0
  buffer_load_dwordx4 v2, s[16:19], s70 offen lds
  s_add_u32 m0, s60, 4096
  s_nop 0
  buffer_load_dwordx4 v3, s[16:19], s70 offen lds
  s_add_u32 m0, s60, 8192
  s_nop 0
  buffer_load_dwordx4 v4, s[16:19], s70 offen lds
  s_add_u32 m0, s60, 12288
  s_nop 0
  buffer_load_dwordx4 v5, s[16:19], s70 offen lds
  s_add_u32 m0, s60, 16384
  s_nop 0
  buffer_load_dwordx4 v6, s[16:19], s70 offen lds
  s_add_u32 m0, s60, 20480
  s_nop 0
  buffer_load_dwordx4 v7, s[16:19], s70 offen lds
  s_add_u32 m0, s60, 24576
  s_nop 0
  buffer_load_dwordx4 v8, s[16:19], s70 offen lds
  s_add_u32 m0, s60, 28672
  s_nop 0
  buffer_load_dwordx4 v9, s[16:19], s70 offen lds
  s_add_u32 m0, s60, 32768
  s_nop 0
  buffer_load_dwordx4 v10, s[16:19], s70 offen lds
  s_add_u32 m0, s60, 36864
  s_nop 0
  buffer_load_dwordx4 v11, s[16:19], s70 offen lds
  s_add_u32 m0, s60, 40960
  s_nop 0
  buffer_load_dwordx4 v12, s[16:19], s70 offen lds
  s_add_u32 m0, s60, 45056
  s_nop 0
  buffer_load_dwordx4 v13, s[16:19], s70 offen lds
  s_add_u32 m0, s60, 49152
  s_nop 0
  buffer_load_dwordx4 v14, s[16:19], s70 offen lds
  s_add_u32 m0, s60, 53248
  s_nop 0
  buffer_load_dwordx4 v15, s[16:19], s70 offen lds
  s_add_u32 m0, s60, 57344
  s_nop 0
  buffer_load_dwordx4 v16, s[16:19], s70 offen lds
  s_waitcnt vmcnt(15)
  s_barrier
  ds_read_b64_tr_b16 a[0:1], v26 offset:0
  ds_read_b64_tr_b16 a[2:3], v26 offset:1536
  ds_read_b64_tr_b16 a[4:5], v26 offset:12288
  ds_read_b64_tr_b16 a[6:7], v26 offset:13824
  ds_read_b64_tr_b16 a[8:9], v26 offset:24576
  ds_read_b64_tr_b16 a[10:11], v26 offset:26112
  s_waitcnt lgkmcnt(4)
  ds_read_b64_tr_b16 a[12:13], v26 offset:36864
  ds_read_b64_tr_b16 a[14:15], v26 offset:38400
  ds_read_b64_tr_b16 a[16:17], v26 offset:49152
  ds_read_b64_tr_b16 a[18:19], v26 offset:50688
  s_waitcnt lgkmcnt(4)
  ds_read_b64_tr_b16 a[80:81], v27 offset:0
  ds_read_b64_tr_b16 a[82:83], v27 offset:1536
  ds_read_b64_tr_b16 a[84:85], v27 offset:12288
  ds_read_b64_tr_b16 a[86:87], v27 offset:13824
  ds_read_b64_tr_b16 a[88:89], v27 offset:24576
  ds_read_b64_tr_b16 a[90:91], v27 offset:26112
  s_waitcnt lgkmcnt(4)
  ds_read_b64_tr_b16 a[92:93], v27 offset:36864
  ds_read_b64_tr_b16 a[94:95], v27 offset:38400
  ds_read_b64_tr_b16 a[96:97], v27 offset:49152
  ds_read_b64_tr_b16 a[98:99], v27 offset:50688
  s_waitcnt lgkmcnt(4)
  ds_read_b64_tr_b16 a[160:161], v28 offset:0
  ds_read_b64_tr_b16 a[162:163], v28 offset:1536
  ds_read_b64_tr_b16 a[164:165], v28 offset:12288
  ds_read_b64_tr_b16 a[166:167], v28 offset:13824
  ds_read_b64_tr_b16 a[168:169], v28 offset:24576
  ds_read_b64_tr_b16 a[170:171], v28 offset:26112
  s_waitcnt lgkmcnt(4)
  ds_read_b64_tr_b16 a[172:173], v28 offset:36864
  ds_read_b64_tr_b16 a[174:175], v28 offset:38400
  ds_read_b64_tr_b16 a[176:177], v28 offset:49152
  ds_read_b64_tr_b16 a[178:179], v28 offset:50688
  s_waitcnt lgkmcnt(4)
  s_waitcnt lgkmcnt(0)
  v_add_u32 v26, 61440, v26
  v_add_u32 v27, 61440, v27
  v_add_u32 v28, 61440, v28
  s_barrier
  s_add_u32 s70, s70, 1966080
  s_lshl_b32 s60, s52, 10
  s_add_u32 s60, s60, 0x0
  s_add_u32 m0, s60, 0
  s_nop 0
  buffer_load_dwordx4 v2, s[16:19], s70 offen lds
  s_add_u32 m0, s60, 4096
  s_nop 0
  buffer_load_dwordx4 v3, s[16:19], s70 offen lds
  s_add_u32 m0, s60, 8192
  s_nop 0
  buffer_load_dwordx4 v4, s[16:19], s70 offen lds
  s_add_u32 m0, s60, 12288
  s_nop 0
  buffer_load_dwordx4 v5, s[16:19], s70 offen lds
  s_add_u32 m0, s60, 16384
  s_nop 0
  buffer_load_dwordx4 v6, s[16:19], s70 offen lds
  s_add_u32 m0, s60, 20480
  s_nop 0
  buffer_load_dwordx4 v7, s[16:19], s70 offen lds
  s_add_u32 m0, s60, 24576
  s_nop 0
  buffer_load_dwordx4 v8, s[16:19], s70 offen lds
  s_add_u32 m0, s60, 28672
  s_nop 0
  buffer_load_dwordx4 v9, s[16:19], s70 offen lds
  s_add_u32 m0, s60, 32768
  s_nop 0
  buffer_load_dwordx4 v10, s[16:19], s70 offen lds
  s_add_u32 m0, s60, 36864
  s_nop 0
  buffer_load_dwordx4 v11, s[16:19], s70 offen lds
  s_add_u32 m0, s60, 40960
  s_nop 0
  buffer_load_dwordx4 v12, s[16:19], s70 offen lds
  s_add_u32 m0, s60, 45056
  s_nop 0
  buffer_load_dwordx4 v13, s[16:19], s70 offen lds
  s_add_u32 m0, s60, 49152
  s_nop 0
  buffer_load_dwordx4 v14, s[16:19], s70 offen lds
  s_add_u32 m0, s60, 53248
  s_nop 0
  buffer_load_dwordx4 v15, s[16:19], s70 offen lds
  s_add_u32 m0, s60, 57344
  s_nop 0
  buffer_load_dwordx4 v16, s[16:19], s70 offen lds
  s_waitcnt vmcnt(15)
  s_barrier
  ds_read_b64_tr_b16 a[20:21], v26 offset:0
  ds_read_b64_tr_b16 a[22:23], v26 offset:1536
  ds_read_b64_tr_b16 a[24:25], v26 offset:12288
  ds_read_b64_tr_b16 a[26:27], v26 offset:13824
  ds_read_b64_tr_b16 a[28:29], v26 offset:24576
  ds_read_b64_tr_b16 a[30:31], v26 offset:26112
  s_waitcnt lgkmcnt(4)
  ds_read_b64_tr_b16 a[32:33], v26 offset:36864
  ds_read_b64_tr_b16 a[34:35], v26 offset:38400
  ds_read_b64_tr_b16 a[36:37], v26 offset:49152
  ds_read_b64_tr_b16 a[38:39], v26 offset:50688
  s_waitcnt lgkmcnt(4)
  ds_read_b64_tr_b16 a[100:101], v27 offset:0
  ds_read_b64_tr_b16 a[102:103], v27 offset:1536
  ds_read_b64_tr_b16 a[104:105], v27 offset:12288
  ds_read_b64_tr_b16 a[106:107], v27 offset:13824
  ds_read_b64_tr_b16 a[108:109], v27 offset:24576
  ds_read_b64_tr_b16 a[110:111], v27 offset:26112
  s_waitcnt lgkmcnt(4)
  ds_read_b64_tr_b16 a[112:113], v27 offset:36864
  ds_read_b64_tr_b16 a[114:115], v27 offset:38400
  ds_read_b64_tr_b16 a[116:117], v27 offset:49152
  ds_read_b64_tr_b16 a[118:119], v27 offset:50688
  s_waitcnt lgkmcnt(4)
  ds_read_b64_tr_b16 a[180:181], v28 offset:0
  ds_read_b64_tr_b16 a[182:183], v28 offset:1536
  ds_read_b64_tr_b16 a[184:185], v28 offset:12288
  ds_read_b64_tr_b16 a[186:187], v28 offset:13824
  ds_read_b64_tr_b16 a[188:189], v28 offset:24576
  ds_read_b64_tr_b16 a[190:191], v28 offset:26112
  s_waitcnt lgkmcnt(4)
  ds_read_b64_tr_b16 a[192:193], v28 offset:36864
  ds_read_b64_tr_b16 a[194:195], v28 offset:38400
  ds_read_b64_tr_b16 a[196:197], v28 offset:49152
  ds_read_b64_tr_b16 a[198:199], v28 offset:50688
  s_waitcnt lgkmcnt(4)
  s_waitcnt lgkmcnt(0)
  v_subrev_u32 v26, 61440, v26
  v_subrev_u32 v27, 61440, v27
  v_subrev_u32 v28, 61440, v28
  s_barrier
  s_add_u32 s70, s70, 1966080
  s_lshl_b32 s60, s52, 10
  s_add_u32 s60, s60, 0xf000
  s_add_u32 m0, s60, 0
  s_nop 0
  buffer_load_dwordx4 v2, s[16:19], s70 offen lds
  s_add_u32 m0, s60, 4096
  s_nop 0
  buffer_load_dwordx4 v3, s[16:19], s70 offen lds
  s_add_u32 m0, s60, 8192
  s_nop 0
  buffer_load_dwordx4 v4, s[16:19], s70 offen lds
  s_add_u32 m0, s60, 12288
  s_nop 0
  buffer_load_dwordx4 v5, s[16:19], s70 offen lds
  s_add_u32 m0, s60, 16384
  s_nop 0
  buffer_load_dwordx4 v6, s[16:19], s70 offen lds
  s_add_u32 m0, s60, 20480
  s_nop 0
  buffer_load_dwordx4 v7, s[16:19], s70 offen lds
  s_add_u32 m0, s60, 24576
  s_nop 0
  buffer_load_dwordx4 v8, s[16:19], s70 offen lds
  s_add_u32 m0, s60, 28672
  s_nop 0
  buffer_load_dwordx4 v9, s[16:19], s70 offen lds
  s_add_u32 m0, s60, 32768
  s_nop 0
  buffer_load_dwordx4 v10, s[16:19], s70 offen lds
  s_add_u32 m0, s60, 36864
  s_nop 0
  buffer_load_dwordx4 v11, s[16:19], s70 offen lds
  s_add_u32 m0, s60, 40960
  s_nop 0
  buffer_load_dwordx4 v12, s[16:19], s70 offen lds
  s_add_u32 m0, s60, 45056
  s_nop 0
  buffer_load_dwordx4 v13, s[16:19], s70 offen lds
  s_add_u32 m0, s60, 49152
  s_nop 0
  buffer_load_dwordx4 v14, s[16:19], s70 offen lds
  s_add_u32 m0, s60, 53248
  s_nop 0
  buffer_load_dwordx4 v15, s[16:19], s70 offen lds
  s_add_u32 m0, s60, 57344
  s_nop 0
  buffer_load_dwordx4 v16, s[16:19], s70 offen lds
  s_waitcnt vmcnt(15)
  s_barrier
  ds_read_b64_tr_b16 a[40:41], v26 offset:0
  ds_read_b64_tr_b16 a[42:43], v26 offset:1536
  ds_read_b64_tr_b16 a[44:45], v26 offset:12288
  ds_read_b64_tr_b16 a[46:47], v26 offset:13824
  ds_read_b64_tr_b16 a[48:49], v26 offset:24576
  ds_read_b64_tr_b16 a[50:51], v26 offset:26112
  s_waitcnt lgkmcnt(4)
  ds_read_b64_tr_b16 a[52:53], v26 offset:36864
  ds_read_b64_tr_b16 a[54:55], v26 offset:38400
  ds_read_b64_tr_b16 a[56:57], v26 offset:49152
  ds_read_b64_tr_b16 a[58:59], v26 offset:50688
  s_waitcnt lgkmcnt(4)
  ds_read_b64_tr_b16 a[120:121], v27 offset:0
  ds_read_b64_tr_b16 a[122:123], v27 offset:1536
  ds_read_b64_tr_b16 a[124:125], v27 offset:12288
  ds_read_b64_tr_b16 a[126:127], v27 offset:13824
  ds_read_b64_tr_b16 a[128:129], v27 offset:24576
  ds_read_b64_tr_b16 a[130:131], v27 offset:26112
  s_waitcnt lgkmcnt(4)
  ds_read_b64_tr_b16 a[132:133], v27 offset:36864
  ds_read_b64_tr_b16 a[134:135], v27 offset:38400
  ds_read_b64_tr_b16 a[136:137], v27 offset:49152
  ds_read_b64_tr_b16 a[138:139], v27 offset:50688
  s_waitcnt lgkmcnt(4)
  ds_read_b64_tr_b16 a[200:201], v28 offset:0
  ds_read_b64_tr_b16 a[202:203], v28 offset:1536
  ds_read_b64_tr_b16 a[204:205], v28 offset:12288
  ds_read_b64_tr_b16 a[206:207], v28 offset:13824
  ds_read_b64_tr_b16 a[208:209], v28 offset:24576
  ds_read_b64_tr_b16 a[210:211], v28 offset:26112
  s_waitcnt lgkmcnt(4)
  ds_read_b64_tr_b16 a[212:213], v28 offset:36864
  ds_read_b64_tr_b16 a[214:215], v28 offset:38400
  ds_read_b64_tr_b16 a[216:217], v28 offset:49152
  ds_read_b64_tr_b16 a[218:219], v28 offset:50688
  s_waitcnt lgkmcnt(4)
  s_waitcnt lgkmcnt(0)
  v_add_u32 v26, 61440, v26
  v_add_u32 v27, 61440, v27
  v_add_u32 v28, 61440, v28
  s_barrier
  s_waitcnt vmcnt(0)
  s_barrier
  ds_read_b64_tr_b16 a[60:61], v26 offset:0
  ds_read_b64_tr_b16 a[62:63], v26 offset:1536
  ds_read_b64_tr_b16 a[64:65], v26 offset:12288
  ds_read_b64_tr_b16 a[66:67], v26 offset:13824
  ds_read_b64_tr_b16 a[68:69], v26 offset:24576
  ds_read_b64_tr_b16 a[70:71], v26 offset:26112
  s_waitcnt lgkmcnt(4)
  ds_read_b64_tr_b16 a[72:73], v26 offset:36864
  ds_read_b64_tr_b16 a[74:75], v26 offset:38400
  ds_read_b64_tr_b16 a[76:77], v26 offset:49152
  ds_read_b64_tr_b16 a[78:79], v26 offset:50688
  s_waitcnt lgkmcnt(4)
  ds_read_b64_tr_b16 a[140:141], v27 offset:0
  ds_read_b64_tr_b16 a[142:143], v27 offset:1536
  ds_read_b64_tr_b16 a[144:145], v27 offset:12288
  ds_read_b64_tr_b16 a[146:147], v27 offset:13824
  ds_read_b64_tr_b16 a[148:149], v27 offset:24576
  ds_read_b64_tr_b16 a[150:151], v27 offset:26112
  s_waitcnt lgkmcnt(4)
  ds_read_b64_tr_b16 a[152:153], v27 offset:36864
  ds_read_b64_tr_b16 a[154:155], v27 offset:38400
  ds_read_b64_tr_b16 a[156:157], v27 offset:49152
  ds_read_b64_tr_b16 a[158:159], v27 offset:50688
  s_waitcnt lgkmcnt(4)
  ds_read_b64_tr_b16 a[220:221], v28 offset:0
  ds_read_b64_tr_b16 a[222:223], v28 offset:1536
  ds_read_b64_tr_b16 a[224:225], v28 offset:12288
  ds_read_b64_tr_b16 a[226:227], v28 offset:13824
  ds_read_b64_tr_b16 a[228:229], v28 offset:24576
  ds_read_b64_tr_b16 a[230:231], v28 offset:26112
  s_waitcnt lgkmcnt(4)
  ds_read_b64_tr_b16 a[232:233], v28 offset:36864
  ds_read_b64_tr_b16 a[234:235], v28 offset:38400
  ds_read_b64_tr_b16 a[236:237], v28 offset:49152
  ds_read_b64_tr_b16 a[238:239], v28 offset:50688
  s_waitcnt lgkmcnt(4)
  s_waitcnt lgkmcnt(0)
  v_subrev_u32 v26, 61440, v26
  v_subrev_u32 v27, 61440, v27
  v_subrev_u32 v28, 61440, v28
  s_barrier
  s_mov_b32 s56, 0
  v_mov_b32 v20, 140
iw_14172:
  buffer_load_dword v18, v20, s[44:47], 0 offen sc1
  s_waitcnt vmcnt(0)
  v_readfirstlane_b32 s58, v18
  s_cmp_ge_u32 s58, 256
  s_cbranch_scc1 iwd_14173
  s_cmp_lg_u32 s55, 0
  s_cbranch_scc1 iwd_14173
  s_add_u32 s56, s56, 1
  s_cmp_lt_u32 s56, 0x20000
  s_cbranch_scc1 iw_14172
  s_mov_b32 s55, 1
iwd_14173:
  s_mov_b32 s71, 0xfffe2000
  s_mul_i32 s58, s52, 3072
  v_lshlrev_b32 v25, 4, v1
  v_add_u32 v25, s58, v25
  s_mul_i32 s66, s69, 12288
  s_add_u32 s66, s66, 0x1a00000
  s_lshl_b32 s58, s69, 8
  s_add_u32 s58, s58, 0
  v_mov_b32 v29, s58
  s_mov_b32 s62, 0
L_t1_ki:
  s_waitcnt vmcnt(3)
  s_cmp_lg_u32 s62, 1
  s_cbranch_scc1 t1w_14174
  s_waitcnt vmcnt(0)
t1w_14174:
  s_barrier
  s_cmp_lg_u32 s52, 0
  s_cbranch_scc1 t1f_14175
  s_cmp_lt_u32 s62, 1
  s_cbranch_scc1 t1f_14175
  s_sub_u32 s58, s62, 1
  s_max_u32 s58, s58, 1
  v_mov_b32 v18, s58
  s_mov_b64 exec, 1
  buffer_store_dword v18, v29, s[48:51], 0 offen sc1
  s_mov_b64 exec, -1
t1f_14175:
  s_cmp_lt_u32 s62, 63
  s_cselect_b32 s58, 40960, 0
  s_add_u32 s64, s64, s58
  s_add_u32 s65, s65, s71
  ds_read_b128 v[32:35], v102 offset:0
  ds_read_b128 v[36:39], v102 offset:20480
  ds_read_b128 v[40:43], v103 offset:0
  ds_read_b128 v[44:47], v103 offset:20480
  ds_read_b128 v[48:51], v104 offset:0
  ds_read_b128 v[52:55], v104 offset:20480
  s_waitcnt lgkmcnt(4)
  v_mfma_f32_16x16x32_bf16 v[56:59], a[0:3], v[32:35], 0
  v_mfma_f32_16x16x32_bf16 v[64:67], a[80:83], v[32:35], 0
  v_mfma_f32_16x16x32_bf16 v[72:75], a[160:163], v[32:35], 0
  v_mfma_f32_16x16x32_bf16 v[60:63], a[0:3], v[36:39], 0
  v_mfma_f32_16x16x32_bf16 v[68:71], a[80:83], v[36:39], 0
  v_mfma_f32_16x16x32_bf16 v[76:79], a[160:163], v[36:39], 0
  ds_read_b128 v[32:35], v105 offset:0
  ds_read_b128 v[36:39], v105 offset:20480
  s_waitcnt lgkmcnt(4)
  v_mfma_f32_16x16x32_bf16 v[56:59], a[4:7], v[40:43], v[56:59]
  s_add_u32 m0, s65, 0
  s_nop 0
  buffer_load_dwordx4 v92, s[4:7], s64 offen lds
  v_mfma_f32_16x16x32_bf16 v[64:67], a[84:87], v[40:43], v[64:67]
  v_mfma_f32_16x16x32_bf16 v[72:75], a[164:167], v[40:43], v[72:75]
  v_mfma_f32_16x16x32_bf16 v[60:63], a[4:7], v[44:47], v[60:63]
  v_mfma_f32_16x16x32_bf16 v[68:71], a[84:87], v[44:47], v[68:71]
  v_mfma_f32_16x16x32_bf16 v[76:79], a[164:167], v[44:47], v[76:79]
  ds_read_b128 v[40:43], v102 offset:256
  ds_read_b128 v[44:47], v102 offset:20736
  s_waitcnt lgkmcnt(4)
  v_mfma_f32_16x16x32_bf16 v[56:59], a[8:11], v[48:51], v[56:59]
  v_mfma_f32_16x16x32_bf16 v[64:67], a[88:91], v[48:51], v[64:67]
  v_mfma_f32_16x16x32_bf16 v[72:75], a[168:171], v[48:51], v[72:75]
  v_mfma_f32_16x16x32_bf16 v[60:63], a[8:11], v[52:55], v[60:63]
  v_mfma_f32_16x16x32_bf16 v[68:71], a[88:91], v[52:55], v[68:71]
  s_add_u32 m0, s65, 1024
  s_nop 0
  buffer_load_dwordx4 v93, s[4:7], s64 offen lds
  v_mfma_f32_16x16x32_bf16 v[76:79], a[168:171], v[52:55], v[76:79]
  ds_read_b128 v[48:51], v103 offset:256
  ds_read_b128 v[52:55], v103 offset:20736
  s_waitcnt lgkmcnt(4)
  v_mfma_f32_16x16x32_bf16 v[56:59], a[12:15], v[32:35], v[56:59]
  v_mfma_f32_16x16x32_bf16 v[64:67], a[92:95], v[32:35], v[64:67]
  v_mfma_f32_16x16x32_bf16 v[72:75], a[172:175], v[32:35], v[72:75]
  v_mfma_f32_16x16x32_bf16 v[60:63], a[12:15], v[36:39], v[60:63]
  v_mfma_f32_16x16x32_bf16 v[68:71], a[92:95], v[36:39], v[68:71]
  v_mfma_f32_16x16x32_bf16 v[76:79], a[172:175], v[36:39], v[76:79]
  ds_read_b128 v[32:35], v104 offset:256
  ds_read_b128 v[36:39], v104 offset:20736
  s_waitcnt lgkmcnt(4)
  v_mfma_f32_16x16x32_bf16 v[56:59], a[16:19], v[40:43], v[56:59]
  v_mfma_f32_16x16x32_bf16 v[64:67], a[96:99], v[40:43], v[64:67]
  v_mfma_f32_16x16x32_bf16 v[72:75], a[176:179], v[40:43], v[72:75]
  s_add_u32 m0, s65, 2048
  s_nop 0
  buffer_load_dwordx4 v94, s[4:7], s64 offen lds
  v_mfma_f32_16x16x32_bf16 v[60:63], a[16:19], v[44:47], v[60:63]
  v_mfma_f32_16x16x32_bf16 v[68:71], a[96:99], v[44:47], v[68:71]
  v_mfma_f32_16x16x32_bf16 v[76:79], a[176:179], v[44:47], v[76:79]
  ds_read_b128 v[40:43], v105 offset:256
  ds_read_b128 v[44:47], v105 offset:20736
  s_waitcnt lgkmcnt(4)
  v_mfma_f32_16x16x32_bf16 v[56:59], a[20:23], v[48:51], v[56:59]
  v_mfma_f32_16x16x32_bf16 v[64:67], a[100:103], v[48:51], v[64:67]
  v_mfma_f32_16x16x32_bf16 v[72:75], a[180:183], v[48:51], v[72:75]
  v_mfma_f32_16x16x32_bf16 v[60:63], a[20:23], v[52:55], v[60:63]
  v_mfma_f32_16x16x32_bf16 v[68:71], a[100:103], v[52:55], v[68:71]
  v_mfma_f32_16x16x32_bf16 v[76:79], a[180:183], v[52:55], v[76:79]
  ds_read_b128 v[48:51], v102 offset:512
  ds_read_b128 v[52:55], v102 offset:20992
  s_waitcnt lgkmcnt(4)
  v_mfma_f32_16x16x32_bf16 v[56:59], a[24:27], v[32:35], v[56:59]
  s_add_u32 m0, s65, 3072
  s_nop 0
  buffer_load_dwordx4 v95, s[4:7], s64 offen lds
  v_mfma_f32_16x16x32_bf16 v[64:67], a[104:107], v[32:35], v[64:67]
  v_mfma_f32_16x16x32_bf16 v[72:75], a[184:187], v[32:35], v[72:75]
  v_mfma_f32_16x16x32_bf16 v[60:63], a[24:27], v[36:39], v[60:63]
  v_mfma_f32_16x16x32_bf16 v[68:71], a[104:107], v[36:39], v[68:71]
  v_mfma_f32_16x16x32_bf16 v[76:79], a[184:187], v[36:39], v[76:79]
  ds_read_b128 v[32:35], v103 offset:512
  ds_read_b128 v[36:39], v103 offset:20992
  s_waitcnt lgkmcnt(4)
  v_mfma_f32_16x16x32_bf16 v[56:59], a[28:31], v[40:43], v[56:59]
  v_mfma_f32_16x16x32_bf16 v[64:67], a[108:111], v[40:43], v[64:67]
  v_mfma_f32_16x16x32_bf16 v[72:75], a[188:191], v[40:43], v[72:75]
  v_mfma_f32_16x16x32_bf16 v[60:63], a[28:31], v[44:47], v[60:63]
  v_mfma_f32_16x16x32_bf16 v[68:71], a[108:111], v[44:47], v[68:71]
  s_add_u32 m0, s65, 4096
  s_nop 0
  buffer_load_dwordx4 v96, s[4:7], s64 offen lds
  v_mfma_f32_16x16x32_bf16 v[76:79], a[188:191], v[44:47], v[76:79]
  ds_read_b128 v[40:43], v104 offset:512
  ds_read_b128 v[44:47], v104 offset:20992
  s_waitcnt lgkmcnt(4)
  v_mfma_f32_16x16x32_bf16 v[56:59], a[32:35], v[48:51], v[56:59]
  v_mfma_f32_16x16x32_bf16 v[64:67], a[112:115], v[48:51], v[64:67]
  v_mfma_f32_16x16x32_bf16 v[72:75], a[192:195], v[48:51], v[72:75]
  v_mfma_f32_16x16x32_bf16 v[60:63], a[32:35], v[52:55], v[60:63]
  v_mfma_f32_16x16x32_bf16 v[68:71], a[112:115], v[52:55], v[68:71]
  v_mfma_f32_16x16x32_bf16 v[76:79], a[192:195], v[52:55], v[76:79]
  ds_read_b128 v[48:51], v105 offset:512
  ds_read_b128 v[52:55], v105 offset:20992
  s_waitcnt lgkmcnt(4)
  v_mfma_f32_16x16x32_bf16 v[56:59], a[36:39], v[32:35], v[56:59]
  v_mfma_f32_16x16x32_bf16 v[64:67], a[116:119], v[32:35], v[64:67]
  v_mfma_f32_16x16x32_bf16 v[72:75], a[196:199], v[32:35], v[72:75]
  s_add_u32 m0, s65, 5120
  s_nop 0
  buffer_load_dwordx4 v97, s[4:7], s64 offen lds
  v_mfma_f32_16x16x32_bf16 v[60:63], a[36:39], v[36:39], v[60:63]
  v_mfma_f32_16x16x32_bf16 v[68:71], a[116:119], v[36:39], v[68:71]
  v_mfma_f32_16x16x32_bf16 v[76:79], a[196:199], v[36:39], v[76:79]
  ds_read_b128 v[32:35], v102 offset:768
  ds_read_b128 v[36:39], v102 offset:21248
  s_waitcnt lgkmcnt(4)
  v_mfma_f32_16x16x32_bf16 v[56:59], a[40:43], v[40:43], v[56:59]
  v_mfma_f32_16x16x32_bf16 v[64:67], a[120:123], v[40:43], v[64:67]
  v_mfma_f32_16x16x32_bf16 v[72:75], a[200:203], v[40:43], v[72:75]
  v_mfma_f32_16x16x32_bf16 v[60:63], a[40:43], v[44:47], v[60:63]
  v_mfma_f32_16x16x32_bf16 v[68:71], a[120:123], v[44:47], v[68:71]
  v_mfma_f32_16x16x32_bf16 v[76:79], a[200:203], v[44:47], v[76:79]
  ds_read_b128 v[40:43], v103 offset:768
  ds_read_b128 v[44:47], v103 offset:21248
  s_waitcnt lgkmcnt(4)
  v_mfma_f32_16x16x32_bf16 v[56:59], a[44:47], v[48:51], v[56:59]
  s_add_u32 m0, s65, 6144
  s_nop 0
  buffer_load_dwordx4 v98, s[4:7], s64 offen lds
  v_mfma_f32_16x16x32_bf16 v[64:67], a[124:127], v[48:51], v[64:67]
  v_mfma_f32_16x16x32_bf16 v[72:75], a[204:207], v[48:51], v[72:75]
  v_mfma_f32_16x16x32_bf16 v[60:63], a[44:47], v[52:55], v[60:63]
  v_mfma_f32_16x16x32_bf16 v[68:71], a[124:127], v[52:55], v[68:71]
  v_mfma_f32_16x16x32_bf16 v[76:79], a[204:207], v[52:55], v[76:79]
  ds_read_b128 v[48:51], v104 offset:768
  ds_read_b128 v[52:55], v104 offset:21248
  s_waitcnt lgkmcnt(4)
  v_mfma_f32_16x16x32_bf16 v[56:59], a[48:51], v[32:35], v[56:59]
  v_mfma_f32_16x16x32_bf16 v[64:67], a[128:131], v[32:35], v[64:67]
  v_mfma_f32_16x16x32_bf16 v[72:75], a[208:211], v[32:35], v[72:75]
  v_mfma_f32_16x16x32_bf16 v[60:63], a[48:51], v[36:39], v[60:63]
  v_mfma_f32_16x16x32_bf16 v[68:71], a[128:131], v[36:39], v[68:71]
  s_add_u32 m0, s65, 7168
  s_nop 0
  buffer_load_dwordx4 v99, s[4:7], s64 offen lds
  v_mfma_f32_16x16x32_bf16 v[76:79], a[208:211], v[36:39], v[76:79]
  ds_read_b128 v[32:35], v105 offset:768
  ds_read_b128 v[36:39], v105 offset:21248
  s_waitcnt lgkmcnt(4)
  v_mfma_f32_16x16x32_bf16 v[56:59], a[52:55], v[40:43], v[56:59]
  v_mfma_f32_16x16x32_bf16 v[64:67], a[132:135], v[40:43], v[64:67]
  v_mfma_f32_16x16x32_bf16 v[72:75], a[212:215], v[40:43], v[72:75]
  v_mfma_f32_16x16x32_bf16 v[60:63], a[52:55], v[44:47], v[60:63]
  v_mfma_f32_16x16x32_bf16 v[68:71], a[132:135], v[44:47], v[68:71]
  v_mfma_f32_16x16x32_bf16 v[76:79], a[212:215], v[44:47], v[76:79]
  ds_read_b128 v[40:43], v102 offset:1024
  ds_read_b128 v[44:47], v102 offset:21504
  s_waitcnt lgkmcnt(4)
  v_mfma_f32_16x16x32_bf16 v[56:59], a[56:59], v[48:51], v[56:59]
  v_mfma_f32_16x16x32_bf16 v[64:67], a[136:139], v[48:51], v[64:67]
  v_mfma_f32_16x16x32_bf16 v[72:75], a[216:219], v[48:51], v[72:75]
  s_add_u32 m0, s65, 8192
  s_nop 0
  buffer_load_dwordx4 v100, s[4:7], s64 offen lds
  v_mfma_f32_16x16x32_bf16 v[60:63], a[56:59], v[52:55], v[60:63]
  v_mfma_f32_16x16x32_bf16 v[68:71], a[136:139], v[52:55], v[68:71]
  v_mfma_f32_16x16x32_bf16 v[76:79], a[216:219], v[52:55], v[76:79]
  ds_read_b128 v[48:51], v103 offset:1024
  ds_read_b128 v[52:55], v103 offset:21504
  s_waitcnt lgkmcnt(4)
  v_mfma_f32_16x16x32_bf16 v[56:59], a[60:63], v[32:35], v[56:59]
  v_mfma_f32_16x16x32_bf16 v[64:67], a[140:143], v[32:35], v[64:67]
  v_mfma_f32_16x16x32_bf16 v[72:75], a[220:223], v[32:35], v[72:75]
  v_mfma_f32_16x16x32_bf16 v[60:63], a[60:63], v[36:39], v[60:63]
  v_mfma_f32_16x16x32_bf16 v[68:71], a[140:143], v[36:39], v[68:71]
  v_mfma_f32_16x16x32_bf16 v[76:79], a[220:223], v[36:39], v[76:79]
  ds_read_b128 v[32:35], v104 offset:1024
  ds_read_b128 v[36:39], v104 offset:21504
  s_waitcnt lgkmcnt(4)
  v_mfma_f32_16x16x32_bf16 v[56:59], a[64:67], v[40:43], v[56:59]
  s_add_u32 m0, s65, 9216
  s_nop 0
  buffer_load_dwordx4 v101, s[4:7], s64 offen lds
  v_mfma_f32_16x16x32_bf16 v[64:67], a[144:147], v[40:43], v[64:67]
  v_mfma_f32_16x16x32_bf16 v[72:75], a[224:227], v[40:43], v[72:75]
  v_mfma_f32_16x16x32_bf16 v[60:63], a[64:67], v[44:47], v[60:63]
  v_mfma_f32_16x16x32_bf16 v[68:71], a[144:147], v[44:47], v[68:71]
  v_mfma_f32_16x16x32_bf16 v[76:79], a[224:227], v[44:47], v[76:79]
  ds_read_b128 v[40:43], v105 offset:1024
  ds_read_b128 v[44:47], v105 offset:21504
  s_waitcnt lgkmcnt(4)
  v_mfma_f32_16x16x32_bf16 v[56:59], a[68:71], v[48:51], v[56:59]
  v_mfma_f32_16x16x32_bf16 v[64:67], a[148:151], v[48:51], v[64:67]
  v_mfma_f32_16x16x32_bf16 v[72:75], a[228:231], v[48:51], v[72:75]
  v_mfma_f32_16x16x32_bf16 v[60:63], a[68:71], v[52:55], v[60:63]
  v_mfma_f32_16x16x32_bf16 v[68:71], a[148:151], v[52:55], v[68:71]
  v_mfma_f32_16x16x32_bf16 v[76:79], a[228:231], v[52:55], v[76:79]
  s_waitcnt lgkmcnt(2)
  v_mfma_f32_16x16x32_bf16 v[56:59], a[72:75], v[32:35], v[56:59]
  v_mfma_f32_16x16x32_bf16 v[64:67], a[152:155], v[32:35], v[64:67]
  v_mfma_f32_16x16x32_bf16 v[72:75], a[232:235], v[32:35], v[72:75]
  v_mfma_f32_16x16x32_bf16 v[60:63], a[72:75], v[36:39], v[60:63]
  v_mfma_f32_16x16x32_bf16 v[68:71], a[152:155], v[36:39], v[68:71]
  v_mfma_f32_16x16x32_bf16 v[76:79], a[232:235], v[36:39], v[76:79]
  s_waitcnt lgkmcnt(0)
  v_mfma_f32_16x16x32_bf16 v[56:59], a[76:79], v[40:43], v[56:59]
  v_mfma_f32_16x16x32_bf16 v[64:67], a[156:159], v[40:43], v[64:67]
  v_mfma_f32_16x16x32_bf16 v[72:75], a[236:239], v[40:43], v[72:75]
  v_mfma_f32_16x16x32_bf16 v[60:63], a[76:79], v[44:47], v[60:63]
  v_mfma_f32_16x16x32_bf16 v[68:71], a[156:159], v[44:47], v[68:71]
  v_mfma_f32_16x16x32_bf16 v[76:79], a[236:239], v[44:47], v[76:79]
  v_add_u32 v102, s71, v102
  v_add_u32 v103, s71, v103
  v_add_u32 v104, s71, v104
  v_add_u32 v105, s71, v105
  s_sub_u32 s71, 0, s71
  s_nop 2
  v_cvt_pk_bf16_f32 v80, v56, v57
  v_cvt_pk_bf16_f32 v81, v58, v59
  v_cvt_pk_bf16_f32 v82, v60, v61
  v_cvt_pk_bf16_f32 v83, v62, v63
  buffer_store_dwordx4 v[80:83], v25, s[48:51], s66 offen offset:0 sc1
  v_cvt_pk_bf16_f32 v84, v64, v65
  v_cvt_pk_bf16_f32 v85, v66, v67
  v_cvt_pk_bf16_f32 v86, v68, v69
  v_cvt_pk_bf16_f32 v87, v70, v71
  buffer_store_dwordx4 v[84:87], v25, s[48:51], s66 offen offset:1024 sc1
  v_cvt_pk_bf16_f32 v88, v72, v73
  v_cvt_pk_bf16_f32 v89, v74, v75
  v_cvt_pk_bf16_f32 v90, v76, v77
  v_cvt_pk_bf16_f32 v91, v78, v79
  buffer_store_dwordx4 v[88:91], v25, s[48:51], s66 offen offset:2048 sc1
  s_add_u32 s66, s66, 393216
  s_add_u32 s62, s62, 1
  s_cmp_lt_u32 s62, 64
  s_cbranch_scc1 L_t1_ki
  s_waitcnt vmcnt(0)
  s_barrier
  s_cmp_lg_u32 s52, 0
  s_cbranch_scc1 t1e_14176
  v_mov_b32 v18, 64
  s_mov_b64 exec, 1
  buffer_store_dword v18, v29, s[48:51], 0 offen sc1
  s_mov_b64 exec, -1
t1e_14176:
  s_branch L_t1done_i
L_t1v_i:
  v_and_b32 v1, 63, v0
  s_mul_i32 s58, s52, 640
  s_add_u32 s59, s58, 0
  v_add_u32 v18, s59, v1
  v_mul_u32_u24 v19, 3277, v18
  v_lshrrev_b32 v19, 18, v19
  v_mul_u32_u24 v20, 80, v19
  v_sub_u32 v18, v18, v20
  v_and_b32 v20, 15, v19
  v_xor_b32 v18, v18, v20
  v_lshlrev_b32 v18, 4, v18
  v_mul_u32_u24 v19, 1280, v19
  v_add_u32 v92, v18, v19
  s_add_u32 s59, s58, 64
  v_add_u32 v18, s59, v1
  v_mul_u32_u24 v19, 3277, v18
  v_lshrrev_b32 v19, 18, v19
  v_mul_u32_u24 v20, 80, v19
  v_sub_u32 v18, v18, v20
  v_and_b32 v20, 15, v19
  v_xor_b32 v18, v18, v20
  v_lshlrev_b32 v18, 4, v18
  v_mul_u32_u24 v19, 1280, v19
  v_add_u32 v93, v18, v19
  s_add_u32 s59, s58, 128
  v_add_u32 v18, s59, v1
  v_mul_u32_u24 v19, 3277, v18
  v_lshrrev_b32 v19, 18, v19
  v_mul_u32_u24 v20, 80, v19
  v_sub_u32 v18, v18, v20
  v_and_b32 v20, 15, v19
  v_xor_b32 v18, v18, v20
  v_lshlrev_b32 v18, 4, v18
  v_mul_u32_u24 v19, 1280, v19
  v_add_u32 v94, v18, v19
  s_add_u32 s59, s58, 192
  v_add_u32 v18, s59, v1
  v_mul_u32_u24 v19, 3277, v18
  v_lshrrev_b32 v19, 18, v19
  v_mul_u32_u24 v20, 80, v19
  v_sub_u32 v18, v18, v20
  v_and_b32 v20, 15, v19
  v_xor_b32 v18, v18, v20
  v_lshlrev_b32 v18, 4, v18
  v_mul_u32_u24 v19, 1280, v19
  v_add_u32 v95, v18, v19
  s_add_u32 s59, s58, 256
  v_add_u32 v18, s59, v1
  v_mul_u32_u24 v19, 3277, v18
  v_lshrrev_b32 v19, 18, v19
  v_mul_u32_u24 v20, 80, v19
  v_sub_u32 v18, v18, v20
  v_and_b32 v20, 15, v19
  v_xor_b32 v18, v18, v20
  v_lshlrev_b32 v18, 4, v18
  v_mul_u32_u24 v19, 1280, v19
  v_add_u32 v96, v18, v19
  s_add_u32 s59, s58, 320
  v_add_u32 v18, s59, v1
  v_mul_u32_u24 v19, 3277, v18
  v_lshrrev_b32 v19, 18, v19
  v_mul_u32_u24 v20, 80, v19
  v_sub_u32 v18, v18, v20
  v_and_b32 v20, 15, v19
  v_xor_b32 v18, v18, v20
  v_lshlrev_b32 v18, 4, v18
  v_mul_u32_u24 v19, 1280, v19
  v_add_u32 v97, v18, v19
  s_add_u32 s59, s58, 384
  v_add_u32 v18, s59, v1
  v_mul_u32_u24 v19, 3277, v18
  v_lshrrev_b32 v19, 18, v19
  v_mul_u32_u24 v20, 80, v19
  v_sub_u32 v18, v18, v20
  v_and_b32 v20, 15, v19
  v_xor_b32 v18, v18, v20
  v_lshlrev_b32 v18, 4, v18
  v_mul_u32_u24 v19, 1280, v19
  v_add_u32 v98, v18, v19
  s_add_u32 s59, s58, 448
  v_add_u32 v18, s59, v1
  v_mul_u32_u24 v19, 3277, v18
  v_lshrrev_b32 v19, 18, v19
  v_mul_u32_u24 v20, 80, v19
  v_sub_u32 v18, v18, v20
  v_and_b32 v20, 15, v19
  v_xor_b32 v18, v18, v20
  v_lshlrev_b32 v18, 4, v18
  v_mul_u32_u24 v19, 1280, v19
  v_add_u32 v99, v18, v19
  s_add_u32 s59, s58, 512
  v_add_u32 v18, s59, v1
  v_mul_u32_u24 v19, 3277, v18
  v_lshrrev_b32 v19, 18, v19
  v_mul_u32_u24 v20, 80, v19
  v_sub_u32 v18, v18, v20
  v_and_b32 v20, 15, v19
  v_xor_b32 v18, v18, v20
  v_lshlrev_b32 v18, 4, v18
  v_mul_u32_u24 v19, 1280, v19
  v_add_u32 v100, v18, v19
  s_add_u32 s59, s58, 576
  v_add_u32 v18, s59, v1
  v_mul_u32_u24 v19, 3277, v18
  v_lshrrev_b32 v19, 18, v19
  v_mul_u32_u24 v20, 80, v19
  v_sub_u32 v18, v18, v20
  v_and_b32 v20, 15, v19
  v_xor_b32 v18, v18, v20
  v_lshlrev_b32 v18, 4, v18
  v_mul_u32_u24 v19, 1280, v19
  v_add_u32 v101, v18, v19
  v_and_b32 v18, 15, v1
  v_lshrrev_b32 v19, 4, v1
  v_xor_b32 v19, v19, v18
  v_mul_u32_u24 v18, 1280, v18
  v_add_u32 v18, 0x1e000, v18
  v_xor_b32 v20, 0, v19
  v_lshlrev_b32 v20, 4, v20
  v_add_u32 v102, v18, v20
  v_xor_b32 v20, 4, v19
  v_lshlrev_b32 v20, 4, v20
  v_add_u32 v103, v18, v20
  v_xor_b32 v20, 8, v19
  v_lshlrev_b32 v20, 4, v20
  v_add_u32 v104, v18, v20
  v_xor_b32 v20, 12, v19
  v_lshlrev_b32 v20, 4, v20
  v_add_u32 v105, v18, v20
  v_lshrrev_b32 v18, 4, v1
  v_lshrrev_b32 v19, 2, v1
  v_and_b32 v19, 3, v19
  v_lshlrev_b32 v20, 3, v18
  v_add_u32 v20, v20, v19
  v_mul_u32_u24 v20, 384, v20
  v_and_b32 v21, 3, v1
  v_lshlrev_b32 v21, 3, v21
  v_add_u32 v20, v20, v21
  v_lshrrev_b32 v19, 1, v19
  v_and_b32 v18, 1, v18
  v_lshlrev_b32 v18, 1, v18
  v_or_b32 v18, v18, v19
  s_mul_i32 s58, s52, 3
  s_add_u32 s59, s58, 0
  v_xor_b32 v19, s59, v18
  v_lshlrev_b32 v19, 5, v19
  v_add_u32 v26, v19, v20
  s_add_u32 s59, s58, 1
  v_xor_b32 v19, s59, v18
  v_lshlrev_b32 v19, 5, v19
  v_add_u32 v27, v19, v20
  s_add_u32 s59, s58, 2
  v_xor_b32 v19, s59, v18
  v_lshlrev_b32 v19, 5, v19
  v_add_u32 v28, v19, v20
  s_mul_i32 s67, s69, 384
  s_mov_b32 s64, 0
  s_mul_i32 s65, s52, 10240
  s_add_u32 s65, s65, 122880
  v_mov_b32 v18, v0
  v_mul_u32_u24 v19, 2731, v18
  v_lshrrev_b32 v19, 16, v19
  v_mul_u32_u24 v20, 24, v19
  v_sub_u32 v18, v18, v20
  v_and_b32 v20, 2, v19
  v_lshrrev_b32 v21, 1, v19
  v_and_b32 v21, 4, v21
  v_or_b32 v20, v20, v21
  v_xor_b32 v18, v18, v20
  v_mul_u32_u24 v19, 12288, v19
  v_lshlrev_b32 v18, 4, v18
  v_add_u32 v2, v18, v19
  v_add_u32 v18, 256, v0
  v_mul_u32_u24 v19, 2731, v18
  v_lshrrev_b32 v19, 16, v19
  v_mul_u32_u24 v20, 24, v19
  v_sub_u32 v18, v18, v20
  v_and_b32 v20, 2, v19
  v_lshrrev_b32 v21, 1, v19
  v_and_b32 v21, 4, v21
  v_or_b32 v20, v20, v21
  v_xor_b32 v18, v18, v20
  v_mul_u32_u24 v19, 12288, v19
  v_lshlrev_b32 v18, 4, v18
  v_add_u32 v3, v18, v19
  v_add_u32 v18, 512, v0
  v_mul_u32_u24 v19, 2731, v18
  v_lshrrev_b32 v19, 16, v19
  v_mul_u32_u24 v20, 24, v19
  v_sub_u32 v18, v18, v20
  v_and_b32 v20, 2, v19
  v_lshrrev_b32 v21, 1, v19
  v_and_b32 v21, 4, v21
  v_or_b32 v20, v20, v21
  v_xor_b32 v18, v18, v20
  v_mul_u32_u24 v19, 12288, v19
  v_lshlrev_b32 v18, 4, v18
  v_add_u32 v4, v18, v19
  v_add_u32 v18, 768, v0
  v_mul_u32_u24 v19, 2731, v18
  v_lshrrev_b32 v19, 16, v19
  v_mul_u32_u24 v20, 24, v19
  v_sub_u32 v18, v18, v20
  v_and_b32 v20, 2, v19
  v_lshrrev_b32 v21, 1, v19
  v_and_b32 v21, 4, v21
  v_or_b32 v20, v20, v21
  v_xor_b32 v18, v18, v20
  v_mul_u32_u24 v19, 12288, v19
  v_lshlrev_b32 v18, 4, v18
  v_add_u32 v5, v18, v19
  v_add_u32 v18, 1024, v0
  v_mul_u32_u24 v19, 2731, v18
  v_lshrrev_b32 v19, 16, v19
  v_mul_u32_u24 v20, 24, v19
  v_sub_u32 v18, v18, v20
  v_and_b32 v20, 2, v19
  v_lshrrev_b32 v21, 1, v19
  v_and_b32 v21, 4, v21
  v_or_b32 v20, v20, v21
  v_xor_b32 v18, v18, v20
  v_mul_u32_u24 v19, 12288, v19
  v_lshlrev_b32 v18, 4, v18
  v_add_u32 v6, v18, v19
  v_add_u32 v18, 1280, v0
  v_mul_u32_u24 v19, 2731, v18
  v_lshrrev_b32 v19, 16, v19
  v_mul_u32_u24 v20, 24, v19
  v_sub_u32 v18, v18, v20
  v_and_b32 v20, 2, v19
  v_lshrrev_b32 v21, 1, v19
  v_and_b32 v21, 4, v21
  v_or_b32 v20, v20, v21
  v_xor_b32 v18, v18, v20
  v_mul_u32_u24 v19, 12288, v19
  v_lshlrev_b32 v18, 4, v18
  v_add_u32 v7, v18, v19
  v_add_u32 v18, 1536, v0
  v_mul_u32_u24 v19, 2731, v18
  v_lshrrev_b32 v19, 16, v19
  v_mul_u32_u24 v20, 24, v19
  v_sub_u32 v18, v18, v20
  v_and_b32 v20, 2, v19
  v_lshrrev_b32 v21, 1, v19
  v_and_b32 v21, 4, v21
  v_or_b32 v20, v20, v21
  v_xor_b32 v18, v18, v20
  v_mul_u32_u24 v19, 12288, v19
  v_lshlrev_b32 v18, 4, v18
  v_add_u32 v8, v18, v19
  v_add_u32 v18, 1792, v0
  v_mul_u32_u24 v19, 2731, v18
  v_lshrrev_b32 v19, 16, v19
  v_mul_u32_u24 v20, 24, v19
  v_sub_u32 v18, v18, v20
  v_and_b32 v20, 2, v19
  v_lshrrev_b32 v21, 1, v19
  v_and_b32 v21, 4, v21
  v_or_b32 v20, v20, v21
  v_xor_b32 v18, v18, v20
  v_mul_u32_u24 v19, 12288, v19
  v_lshlrev_b32 v18, 4, v18
  v_add_u32 v9, v18, v19
  v_add_u32 v18, 2048, v0
  v_mul_u32_u24 v19, 2731, v18
  v_lshrrev_b32 v19, 16, v19
  v_mul_u32_u24 v20, 24, v19
  v_sub_u32 v18, v18, v20
  v_and_b32 v20, 2, v19
  v_lshrrev_b32 v21, 1, v19
  v_and_b32 v21, 4, v21
  v_or_b32 v20, v20, v21
  v_xor_b32 v18, v18, v20
  v_mul_u32_u24 v19, 12288, v19
  v_lshlrev_b32 v18, 4, v18
  v_add_u32 v10, v18, v19
  v_add_u32 v18, 2304, v0
  v_mul_u32_u24 v19, 2731, v18
  v_lshrrev_b32 v19, 16, v19
  v_mul_u32_u24 v20, 24, v19
  v_sub_u32 v18, v18, v20
  v_and_b32 v20, 2, v19
  v_lshrrev_b32 v21, 1, v19
  v_and_b32 v21, 4, v21
  v_or_b32 v20, v20, v21
  v_xor_b32 v18, v18, v20
  v_mul_u32_u24 v19, 12288, v19
  v_lshlrev_b32 v18, 4, v18
  v_add_u32 v11, v18, v19
  v_add_u32 v18, 2560, v0
  v_mul_u32_u24 v19, 2731, v18
  v_lshrrev_b32 v19, 16, v19
  v_mul_u32_u24 v20, 24, v19
  v_sub_u32 v18, v18, v20
  v_and_b32 v20, 2, v19
  v_lshrrev_b32 v21, 1, v19
  v_and_b32 v21, 4, v21
  v_or_b32 v20, v20, v21
  v_xor_b32 v18, v18, v20
  v_mul_u32_u24 v19, 12288, v19
  v_lshlrev_b32 v18, 4, v18
  v_add_u32 v12, v18, v19
  v_add_u32 v18, 2816, v0
  v_mul_u32_u24 v19, 2731, v18
  v_lshrrev_b32 v19, 16, v19
  v_mul_u32_u24 v20, 24, v19
  v_sub_u32 v18, v18, v20
  v_and_b32 v20, 2, v19
  v_lshrrev_b32 v21, 1, v19
  v_and_b32 v21, 4, v21
  v_or_b32 v20, v20, v21
  v_xor_b32 v18, v18, v20
  v_mul_u32_u24 v19, 12288, v19
  v_lshlrev_b32 v18, 4, v18
  v_add_u32 v13, v18, v19
  v_add_u32 v18, 3072, v0
  v_mul_u32_u24 v19, 2731, v18
  v_lshrrev_b32 v19, 16, v19
  v_mul_u32_u24 v20, 24, v19
  v_sub_u32 v18, v18, v20
  v_and_b32 v20, 2, v19
  v_lshrrev_b32 v21, 1, v19
  v_and_b32 v21, 4, v21
  v_or_b32 v20, v20, v21
  v_xor_b32 v18, v18, v20
  v_mul_u32_u24 v19, 12288, v19
  v_lshlrev_b32 v18, 4, v18
  v_add_u32 v14, v18, v19
  v_add_u32 v18, 3328, v0
  v_mul_u32_u24 v19, 2731, v18
  v_lshrrev_b32 v19, 16, v19
  v_mul_u32_u24 v20, 24, v19
  v_sub_u32 v18, v18, v20
  v_and_b32 v20, 2, v19
  v_lshrrev_b32 v21, 1, v19
  v_and_b32 v21, 4, v21
  v_or_b32 v20, v20, v21
  v_xor_b32 v18, v18, v20
  v_mul_u32_u24 v19, 12288, v19
  v_lshlrev_b32 v18, 4, v18
  v_add_u32 v15, v18, v19
  v_add_u32 v18, 3584, v0
  v_mul_u32_u24 v19, 2731, v18
  v_lshrrev_b32 v19, 16, v19
  v_mul_u32_u24 v20, 24, v19
  v_sub_u32 v18, v18, v20
  v_and_b32 v20, 2, v19
  v_lshrrev_b32 v21, 1, v19
  v_and_b32 v21, 4, v21
  v_or_b32 v20, v20, v21
  v_xor_b32 v18, v18, v20
  v_mul_u32_u24 v19, 12288, v19
  v_lshlrev_b32 v18, 4, v18
  v_add_u32 v16, v18, v19
  s_add_u32 m0, s65, 0
  s_nop 0
  buffer_load_dwordx4 v92, s[4:7], s64 offen lds
  s_add_u32 m0, s65, 1024
  s_nop 0
  buffer_load_dwordx4 v93, s[4:7], s64 offen lds
  s_add_u32 m0, s65, 2048
  s_nop 0
  buffer_load_dwordx4 v94, s[4:7], s64 offen lds
  s_add_u32 m0, s65, 3072
  s_nop 0
  buffer_load_dwordx4 v95, s[4:7], s64 offen lds
  s_add_u32 m0, s65, 4096
  s_nop 0
  buffer_load_dwordx4 v96, s[4:7], s64 offen lds
  s_add_u32 m0, s65, 5120
  s_nop 0
  buffer_load_dwordx4 v97, s[4:7], s64 offen lds
  s_add_u32 m0, s65, 6144
  s_nop 0
  buffer_load_dwordx4 v98, s[4:7], s64 offen lds
  s_add_u32 m0, s65, 7168
  s_nop 0
  buffer_load_dwordx4 v99, s[4:7], s64 offen lds
  s_add_u32 m0, s65, 8192
  s_nop 0
  buffer_load_dwordx4 v100, s[4:7], s64 offen lds
  s_add_u32 m0, s65, 9216
  s_nop 0
  buffer_load_dwordx4 v101, s[4:7], s64 offen lds
  s_mov_b32 s70, s67
  s_lshl_b32 s60, s52, 10
  s_add_u32 s60, s60, 0x0
  s_add_u32 m0, s60, 0
  s_nop 0
  buffer_load_dwordx4 v2, s[20:23], s70 offen lds
  s_add_u32 m0, s60, 4096
  s_nop 0
  buffer_load_dwordx4 v3, s[20:23], s70 offen lds
  s_add_u32 m0, s60, 8192
  s_nop 0
  buffer_load_dwordx4 v4, s[20:23], s70 offen lds
  s_add_u32 m0, s60, 12288
  s_nop 0
  buffer_load_dwordx4 v5, s[20:23], s70 offen lds
  s_add_u32 m0, s60, 16384
  s_nop 0
  buffer_load_dwordx4 v6, s[20:23], s70 offen lds
  s_add_u32 m0, s60, 20480
  s_nop 0
  buffer_load_dwordx4 v7, s[20:23], s70 offen lds
  s_add_u32 m0, s60, 24576
  s_nop 0
  buffer_load_dwordx4 v8, s[20:23], s70 offen lds
  s_add_u32 m0, s60, 28672
  s_nop 0
  buffer_load_dwordx4 v9, s[20:23], s70 offen lds
  s_add_u32 m0, s60, 32768
  s_nop 0
  buffer_load_dwordx4 v10, s[20:23], s70 offen lds
  s_add_u32 m0, s60, 36864
  s_nop 0
  buffer_load_dwordx4 v11, s[20:23], s70 offen lds
  s_add_u32 m0, s60, 40960
  s_nop 0
  buffer_load_dwordx4 v12, s[20:23], s70 offen lds
  s_add_u32 m0, s60, 45056
  s_nop 0
  buffer_load_dwordx4 v13, s[20:23], s70 offen lds
  s_add_u32 m0, s60, 49152
  s_nop 0
  buffer_load_dwordx4 v14, s[20:23], s70 offen lds
  s_add_u32 m0, s60, 53248
  s_nop 0
  buffer_load_dwordx4 v15, s[20:23], s70 offen lds
  s_add_u32 m0, s60, 57344
  s_nop 0
  buffer_load_dwordx4 v16, s[20:23], s70 offen lds
  s_add_u32 s70, s70, 1966080
  s_lshl_b32 s60, s52, 10
  s_add_u32 s60, s60, 0xf000
  s_add_u32 m0, s60, 0
  s_nop 0
  buffer_load_dwordx4 v2, s[20:23], s70 offen lds
  s_add_u32 m0, s60, 4096
  s_nop 0
  buffer_load_dwordx4 v3, s[20:23], s70 offen lds
  s_add_u32 m0, s60, 8192
  s_nop 0
  buffer_load_dwordx4 v4, s[20:23], s70 offen lds
  s_add_u32 m0, s60, 12288
  s_nop 0
  buffer_load_dwordx4 v5, s[20:23], s70 offen lds
  s_add_u32 m0, s60, 16384
  s_nop 0
  buffer_load_dwordx4 v6, s[20:23], s70 offen lds
  s_add_u32 m0, s60, 20480
  s_nop 0
  buffer_load_dwordx4 v7, s[20:23], s70 offen lds
  s_add_u32 m0, s60, 24576
  s_nop 0
  buffer_load_dwordx4 v8, s[20:23], s70 offen lds
  s_add_u32 m0, s60, 28672
  s_nop 0
  buffer_load_dwordx4 v9, s[20:23], s70 offen lds
  s_add_u32 m0, s60, 32768
  s_nop 0
  buffer_load_dwordx4 v10, s[20:23], s70 offen lds
  s_add_u32 m0, s60, 36864
  s_nop 0
  buffer_load_dwordx4 v11, s[20:23], s70 offen lds
  s_add_u32 m0, s60, 40960
  s_nop 0
  buffer_load_dwordx4 v12, s[20:23], s70 offen lds
  s_add_u32 m0, s60, 45056
  s_nop 0
  buffer_load_dwordx4 v13, s[20:23], s70 offen lds
  s_add_u32 m0, s60, 49152
  s_nop 0
  buffer_load_dwordx4 v14, s[20:23], s70 offen lds
  s_add_u32 m0, s60, 53248
  s_nop 0
  buffer_load_dwordx4 v15, s[20:23], s70 offen lds
  s_add_u32 m0, s60, 57344
  s_nop 0
  buffer_load_dwordx4 v16, s[20:23], s70 offen lds
  s_waitcnt vmcnt(15)
  s_barrier
  ds_read_b64_tr_b16 a[0:1], v26 offset:0
  ds_read_b64_tr_b16 a[2:3], v26 offset:1536
  ds_read_b64_tr_b16 a[4:5], v26 offset:12288
  ds_read_b64_tr_b16 a[6:7], v26 offset:13824
  ds_read_b64_tr_b16 a[8:9], v26 offset:24576
  ds_read_b64_tr_b16 a[10:11], v26 offset:26112
  s_waitcnt lgkmcnt(4)
  ds_read_b64_tr_b16 a[12:13], v26 offset:36864
  ds_read_b64_tr_b16 a[14:15], v26 offset:38400
  ds_read_b64_tr_b16 a[16:17], v26 offset:49152
  ds_read_b64_tr_b16 a[18:19], v26 offset:50688
  s_waitcnt lgkmcnt(4)
  ds_read_b64_tr_b16 a[80:81], v27 offset:0
  ds_read_b64_tr_b16 a[82:83], v27 offset:1536
  ds_read_b64_tr_b16 a[84:85], v27 offset:12288
  ds_read_b64_tr_b16 a[86:87], v27 offset:13824
  ds_read_b64_tr_b16 a[88:89], v27 offset:24576
  ds_read_b64_tr_b16 a[90:91], v27 offset:26112
  s_waitcnt lgkmcnt(4)
  ds_read_b64_tr_b16 a[92:93], v27 offset:36864
  ds_read_b64_tr_b16 a[94:95], v27 offset:38400
  ds_read_b64_tr_b16 a[96:97], v27 offset:49152
  ds_read_b64_tr_b16 a[98:99], v27 offset:50688
  s_waitcnt lgkmcnt(4)
  ds_read_b64_tr_b16 a[160:161], v28 offset:0
  ds_read_b64_tr_b16 a[162:163], v28 offset:1536
  ds_read_b64_tr_b16 a[164:165], v28 offset:12288
  ds_read_b64_tr_b16 a[166:167], v28 offset:13824
  ds_read_b64_tr_b16 a[168:169], v28 offset:24576
  ds_read_b64_tr_b16 a[170:171], v28 offset:26112
  s_waitcnt lgkmcnt(4)
  ds_read_b64_tr_b16 a[172:173], v28 offset:36864
  ds_read_b64_tr_b16 a[174:175], v28 offset:38400
  ds_read_b64_tr_b16 a[176:177], v28 offset:49152
  ds_read_b64_tr_b16 a[178:179], v28 offset:50688
  s_waitcnt lgkmcnt(4)
  s_waitcnt lgkmcnt(0)
  v_add_u32 v26, 61440, v26
  v_add_u32 v27, 61440, v27
  v_add_u32 v28, 61440, v28
  s_barrier
  s_add_u32 s70, s70, 1966080
  s_lshl_b32 s60, s52, 10
  s_add_u32 s60, s60, 0x0
  s_add_u32 m0, s60, 0
  s_nop 0
  buffer_load_dwordx4 v2, s[20:23], s70 offen lds
  s_add_u32 m0, s60, 4096
  s_nop 0
  buffer_load_dwordx4 v3, s[20:23], s70 offen lds
  s_add_u32 m0, s60, 8192
  s_nop 0
  buffer_load_dwordx4 v4, s[20:23], s70 offen lds
  s_add_u32 m0, s60, 12288
  s_nop 0
  buffer_load_dwordx4 v5, s[20:23], s70 offen lds
  s_add_u32 m0, s60, 16384
  s_nop 0
  buffer_load_dwordx4 v6, s[20:23], s70 offen lds
  s_add_u32 m0, s60, 20480
  s_nop 0
  buffer_load_dwordx4 v7, s[20:23], s70 offen lds
  s_add_u32 m0, s60, 24576
  s_nop 0
  buffer_load_dwordx4 v8, s[20:23], s70 offen lds
  s_add_u32 m0, s60, 28672
  s_nop 0
  buffer_load_dwordx4 v9, s[20:23], s70 offen lds
  s_add_u32 m0, s60, 32768
  s_nop 0
  buffer_load_dwordx4 v10, s[20:23], s70 offen lds
  s_add_u32 m0, s60, 36864
  s_nop 0
  buffer_load_dwordx4 v11, s[20:23], s70 offen lds
  s_add_u32 m0, s60, 40960
  s_nop 0
  buffer_load_dwordx4 v12, s[20:23], s70 offen lds
  s_add_u32 m0, s60, 45056
  s_nop 0
  buffer_load_dwordx4 v13, s[20:23], s70 offen lds
  s_add_u32 m0, s60, 49152
  s_nop 0
  buffer_load_dwordx4 v14, s[20:23], s70 offen lds
  s_add_u32 m0, s60, 53248
  s_nop 0
  buffer_load_dwordx4 v15, s[20:23], s70 offen lds
  s_add_u32 m0, s60, 57344
  s_nop 0
  buffer_load_dwordx4 v16, s[20:23], s70 offen lds
  s_waitcnt vmcnt(15)
  s_barrier
  ds_read_b64_tr_b16 a[20:21], v26 offset:0
  ds_read_b64_tr_b16 a[22:23], v26 offset:1536
  ds_read_b64_tr_b16 a[24:25], v26 offset:12288
  ds_read_b64_tr_b16 a[26:27], v26 offset:13824
  ds_read_b64_tr_b16 a[28:29], v26 offset:24576
  ds_read_b64_tr_b16 a[30:31], v26 offset:26112
  s_waitcnt lgkmcnt(4)
  ds_read_b64_tr_b16 a[32:33], v26 offset:36864
  ds_read_b64_tr_b16 a[34:35], v26 offset:38400
  ds_read_b64_tr_b16 a[36:37], v26 offset:49152
  ds_read_b64_tr_b16 a[38:39], v26 offset:50688
  s_waitcnt lgkmcnt(4)
  ds_read_b64_tr_b16 a[100:101], v27 offset:0
  ds_read_b64_tr_b16 a[102:103], v27 offset:1536
  ds_read_b64_tr_b16 a[104:105], v27 offset:12288
  ds_read_b64_tr_b16 a[106:107], v27 offset:13824
  ds_read_b64_tr_b16 a[108:109], v27 offset:24576
  ds_read_b64_tr_b16 a[110:111], v27 offset:26112
  s_waitcnt lgkmcnt(4)
  ds_read_b64_tr_b16 a[112:113], v27 offset:36864
  ds_read_b64_tr_b16 a[114:115], v27 offset:38400
  ds_read_b64_tr_b16 a[116:117], v27 offset:49152
  ds_read_b64_tr_b16 a[118:119], v27 offset:50688
  s_waitcnt lgkmcnt(4)
  ds_read_b64_tr_b16 a[180:181], v28 offset:0
  ds_read_b64_tr_b16 a[182:183], v28 offset:1536
  ds_read_b64_tr_b16 a[184:185], v28 offset:12288
  ds_read_b64_tr_b16 a[186:187], v28 offset:13824
  ds_read_b64_tr_b16 a[188:189], v28 offset:24576
  ds_read_b64_tr_b16 a[190:191], v28 offset:26112
  s_waitcnt lgkmcnt(4)
  ds_read_b64_tr_b16 a[192:193], v28 offset:36864
  ds_read_b64_tr_b16 a[194:195], v28 offset:38400
  ds_read_b64_tr_b16 a[196:197], v28 offset:49152
  ds_read_b64_tr_b16 a[198:199], v28 offset:50688
  s_waitcnt lgkmcnt(4)
  s_waitcnt lgkmcnt(0)
  v_subrev_u32 v26, 61440, v26
  v_subrev_u32 v27, 61440, v27
  v_subrev_u32 v28, 61440, v28
  s_barrier
  s_add_u32 s70, s70, 1966080
  s_lshl_b32 s60, s52, 10
  s_add_u32 s60, s60, 0xf000
  s_add_u32 m0, s60, 0
  s_nop 0
  buffer_load_dwordx4 v2, s[20:23], s70 offen lds
  s_add_u32 m0, s60, 4096
  s_nop 0
  buffer_load_dwordx4 v3, s[20:23], s70 offen lds
  s_add_u32 m0, s60, 8192
  s_nop 0
  buffer_load_dwordx4 v4, s[20:23], s70 offen lds
  s_add_u32 m0, s60, 12288
  s_nop 0
  buffer_load_dwordx4 v5, s[20:23], s70 offen lds
  s_add_u32 m0, s60, 16384
  s_nop 0
  buffer_load_dwordx4 v6, s[20:23], s70 offen lds
  s_add_u32 m0, s60, 20480
  s_nop 0
  buffer_load_dwordx4 v7, s[20:23], s70 offen lds
  s_add_u32 m0, s60, 24576
  s_nop 0
  buffer_load_dwordx4 v8, s[20:23], s70 offen lds
  s_add_u32 m0, s60, 28672
  s_nop 0
  buffer_load_dwordx4 v9, s[20:23], s70 offen lds
  s_add_u32 m0, s60, 32768
  s_nop 0
  buffer_load_dwordx4 v10, s[20:23], s70 offen lds
  s_add_u32 m0, s60, 36864
  s_nop 0
  buffer_load_dwordx4 v11, s[20:23], s70 offen lds
  s_add_u32 m0, s60, 40960
  s_nop 0
  buffer_load_dwordx4 v12, s[20:23], s70 offen lds
  s_add_u32 m0, s60, 45056
  s_nop 0
  buffer_load_dwordx4 v13, s[20:23], s70 offen lds
  s_add_u32 m0, s60, 49152
  s_nop 0
  buffer_load_dwordx4 v14, s[20:23], s70 offen lds
  s_add_u32 m0, s60, 53248
  s_nop 0
  buffer_load_dwordx4 v15, s[20:23], s70 offen lds
  s_add_u32 m0, s60, 57344
  s_nop 0
  buffer_load_dwordx4 v16, s[20:23], s70 offen lds
  s_waitcnt vmcnt(15)
  s_barrier
  ds_read_b64_tr_b16 a[40:41], v26 offset:0
  ds_read_b64_tr_b16 a[42:43], v26 offset:1536
  ds_read_b64_tr_b16 a[44:45], v26 offset:12288
  ds_read_b64_tr_b16 a[46:47], v26 offset:13824
  ds_read_b64_tr_b16 a[48:49], v26 offset:24576
  ds_read_b64_tr_b16 a[50:51], v26 offset:26112
  s_waitcnt lgkmcnt(4)
  ds_read_b64_tr_b16 a[52:53], v26 offset:36864
  ds_read_b64_tr_b16 a[54:55], v26 offset:38400
  ds_read_b64_tr_b16 a[56:57], v26 offset:49152
  ds_read_b64_tr_b16 a[58:59], v26 offset:50688
  s_waitcnt lgkmcnt(4)
  ds_read_b64_tr_b16 a[120:121], v27 offset:0
  ds_read_b64_tr_b16 a[122:123], v27 offset:1536
  ds_read_b64_tr_b16 a[124:125], v27 offset:12288
  ds_read_b64_tr_b16 a[126:127], v27 offset:13824
  ds_read_b64_tr_b16 a[128:129], v27 offset:24576
  ds_read_b64_tr_b16 a[130:131], v27 offset:26112
  s_waitcnt lgkmcnt(4)
  ds_read_b64_tr_b16 a[132:133], v27 offset:36864
  ds_read_b64_tr_b16 a[134:135], v27 offset:38400
  ds_read_b64_tr_b16 a[136:137], v27 offset:49152
  ds_read_b64_tr_b16 a[138:139], v27 offset:50688
  s_waitcnt lgkmcnt(4)
  ds_read_b64_tr_b16 a[200:201], v28 offset:0
  ds_read_b64_tr_b16 a[202:203], v28 offset:1536
  ds_read_b64_tr_b16 a[204:205], v28 offset:12288
  ds_read_b64_tr_b16 a[206:207], v28 offset:13824
  ds_read_b64_tr_b16 a[208:209], v28 offset:24576
  ds_read_b64_tr_b16 a[210:211], v28 offset:26112
  s_waitcnt lgkmcnt(4)
  ds_read_b64_tr_b16 a[212:213], v28 offset:36864
  ds_read_b64_tr_b16 a[214:215], v28 offset:38400
  ds_read_b64_tr_b16 a[216:217], v28 offset:49152
  ds_read_b64_tr_b16 a[218:219], v28 offset:50688
  s_waitcnt lgkmcnt(4)
  s_waitcnt lgkmcnt(0)
  v_add_u32 v26, 61440, v26
  v_add_u32 v27, 61440, v27
  v_add_u32 v28, 61440, v28
  s_barrier
  s_waitcnt vmcnt(0)
  s_barrier
  ds_read_b64_tr_b16 a[60:61], v26 offset:0
  ds_read_b64_tr_b16 a[62:63], v26 offset:1536
  ds_read_b64_tr_b16 a[64:65], v26 offset:12288
  ds_read_b64_tr_b16 a[66:67], v26 offset:13824
  ds_read_b64_tr_b16 a[68:69], v26 offset:24576
  ds_read_b64_tr_b16 a[70:71], v26 offset:26112
  s_waitcnt lgkmcnt(4)
  ds_read_b64_tr_b16 a[72:73], v26 offset:36864
  ds_read_b64_tr_b16 a[74:75], v26 offset:38400
  ds_read_b64_tr_b16 a[76:77], v26 offset:49152
  ds_read_b64_tr_b16 a[78:79], v26 offset:50688
  s_waitcnt lgkmcnt(4)
  ds_read_b64_tr_b16 a[140:141], v27 offset:0
  ds_read_b64_tr_b16 a[142:143], v27 offset:1536
  ds_read_b64_tr_b16 a[144:145], v27 offset:12288
  ds_read_b64_tr_b16 a[146:147], v27 offset:13824
  ds_read_b64_tr_b16 a[148:149], v27 offset:24576
  ds_read_b64_tr_b16 a[150:151], v27 offset:26112
  s_waitcnt lgkmcnt(4)
  ds_read_b64_tr_b16 a[152:153], v27 offset:36864
  ds_read_b64_tr_b16 a[154:155], v27 offset:38400
  ds_read_b64_tr_b16 a[156:157], v27 offset:49152
  ds_read_b64_tr_b16 a[158:159], v27 offset:50688
  s_waitcnt lgkmcnt(4)
  ds_read_b64_tr_b16 a[220:221], v28 offset:0
  ds_read_b64_tr_b16 a[222:223], v28 offset:1536
  ds_read_b64_tr_b16 a[224:225], v28 offset:12288
  ds_read_b64_tr_b16 a[226:227], v28 offset:13824
  ds_read_b64_tr_b16 a[228:229], v28 offset:24576
  ds_read_b64_tr_b16 a[230:231], v28 offset:26112
  s_waitcnt lgkmcnt(4)
  ds_read_b64_tr_b16 a[232:233], v28 offset:36864
  ds_read_b64_tr_b16 a[234:235], v28 offset:38400
  ds_read_b64_tr_b16 a[236:237], v28 offset:49152
  ds_read_b64_tr_b16 a[238:239], v28 offset:50688
  s_waitcnt lgkmcnt(4)
  s_waitcnt lgkmcnt(0)
  v_subrev_u32 v26, 61440, v26
  v_subrev_u32 v27, 61440, v27
  v_subrev_u32 v28, 61440, v28
  s_barrier
  s_mov_b32 s56, 0
  v_mov_b32 v20, 140
iw_14177:
  buffer_load_dword v18, v20, s[44:47], 0 offen sc1
  s_waitcnt vmcnt(0)
  v_readfirstlane_b32 s58, v18
  s_cmp_ge_u32 s58, 256
  s_cbranch_scc1 iwd_14178
  s_cmp_lg_u32 s55, 0
  s_cbranch_scc1 iwd_14178
  s_add_u32 s56, s56, 1
  s_cmp_lt_u32 s56, 0x20000
  s_cbranch_scc1 iw_14177
  s_mov_b32 s55, 1
iwd_14178:
  s_mov_b32 s71, 0xfffe2000
  s_mul_i32 s58, s52, 3072
  v_lshlrev_b32 v25, 4, v1
  v_add_u32 v25, s58, v25
  s_mul_i32 s66, s69, 12288
  s_add_u32 s66, s66, 0x3200000
  s_lshl_b32 s58, s69, 8
  s_add_u32 s58, s58, 128
  v_mov_b32 v29, s58
  s_mov_b32 s62, 0
L_t1_vi:
  s_waitcnt vmcnt(3)
  s_cmp_lg_u32 s62, 1
  s_cbranch_scc1 t1w_14179
  s_waitcnt vmcnt(0)
t1w_14179:
  s_barrier
  s_cmp_lg_u32 s52, 0
  s_cbranch_scc1 t1f_14180
  s_cmp_lt_u32 s62, 1
  s_cbranch_scc1 t1f_14180
  s_sub_u32 s58, s62, 1
  s_max_u32 s58, s58, 1
  v_mov_b32 v18, s58
  s_mov_b64 exec, 1
  buffer_store_dword v18, v29, s[48:51], 0 offen sc1
  s_mov_b64 exec, -1
t1f_14180:
  s_cmp_lt_u32 s62, 63
  s_cselect_b32 s58, 40960, 0
  s_add_u32 s64, s64, s58
  s_add_u32 s65, s65, s71
  ds_read_b128 v[32:35], v102 offset:0
  ds_read_b128 v[36:39], v102 offset:20480
  ds_read_b128 v[40:43], v103 offset:0
  ds_read_b128 v[44:47], v103 offset:20480
  ds_read_b128 v[48:51], v104 offset:0
  ds_read_b128 v[52:55], v104 offset:20480
  s_waitcnt lgkmcnt(4)
  v_mfma_f32_16x16x32_bf16 v[56:59], v[32:35], a[0:3], 0
  v_mfma_f32_16x16x32_bf16 v[64:67], v[32:35], a[80:83], 0
  v_mfma_f32_16x16x32_bf16 v[72:75], v[32:35], a[160:163], 0
  v_mfma_f32_16x16x32_bf16 v[60:63], v[36:39], a[0:3], 0
  v_mfma_f32_16x16x32_bf16 v[68:71], v[36:39], a[80:83], 0
  v_mfma_f32_16x16x32_bf16 v[76:79], v[36:39], a[160:163], 0
  ds_read_b128 v[32:35], v105 offset:0
  ds_read_b128 v[36:39], v105 offset:20480
  s_waitcnt lgkmcnt(4)
  v_mfma_f32_16x16x32_bf16 v[56:59], v[40:43], a[4:7], v[56:59]
  s_add_u32 m0, s65, 0
  s_nop 0
  buffer_load_dwordx4 v92, s[4:7], s64 offen lds
  v_mfma_f32_16x16x32_bf16 v[64:67], v[40:43], a[84:87], v[64:67]
  v_mfma_f32_16x16x32_bf16 v[72:75], v[40:43], a[164:167], v[72:75]
  v_mfma_f32_16x16x32_bf16 v[60:63], v[44:47], a[4:7], v[60:63]
  v_mfma_f32_16x16x32_bf16 v[68:71], v[44:47], a[84:87], v[68:71]
  v_mfma_f32_16x16x32_bf16 v[76:79], v[44:47], a[164:167], v[76:79]
  ds_read_b128 v[40:43], v102 offset:256
  ds_read_b128 v[44:47], v102 offset:20736
  s_waitcnt lgkmcnt(4)
  v_mfma_f32_16x16x32_bf16 v[56:59], v[48:51], a[8:11], v[56:59]
  v_mfma_f32_16x16x32_bf16 v[64:67], v[48:51], a[88:91], v[64:67]
  v_mfma_f32_16x16x32_bf16 v[72:75], v[48:51], a[168:171], v[72:75]
  v_mfma_f32_16x16x32_bf16 v[60:63], v[52:55], a[8:11], v[60:63]
  v_mfma_f32_16x16x32_bf16 v[68:71], v[52:55], a[88:91], v[68:71]
  s_add_u32 m0, s65, 1024
  s_nop 0
  buffer_load_dwordx4 v93, s[4:7], s64 offen lds
  v_mfma_f32_16x16x32_bf16 v[76:79], v[52:55], a[168:171], v[76:79]
  ds_read_b128 v[48:51], v103 offset:256
  ds_read_b128 v[52:55], v103 offset:20736
  s_waitcnt lgkmcnt(4)
  v_mfma_f32_16x16x32_bf16 v[56:59], v[32:35], a[12:15], v[56:59]
  v_mfma_f32_16x16x32_bf16 v[64:67], v[32:35], a[92:95], v[64:67]
  v_mfma_f32_16x16x32_bf16 v[72:75], v[32:35], a[172:175], v[72:75]
  v_mfma_f32_16x16x32_bf16 v[60:63], v[36:39], a[12:15], v[60:63]
  v_mfma_f32_16x16x32_bf16 v[68:71], v[36:39], a[92:95], v[68:71]
  v_mfma_f32_16x16x32_bf16 v[76:79], v[36:39], a[172:175], v[76:79]
  ds_read_b128 v[32:35], v104 offset:256
  ds_read_b128 v[36:39], v104 offset:20736
  s_waitcnt lgkmcnt(4)
  v_mfma_f32_16x16x32_bf16 v[56:59], v[40:43], a[16:19], v[56:59]
  v_mfma_f32_16x16x32_bf16 v[64:67], v[40:43], a[96:99], v[64:67]
  v_mfma_f32_16x16x32_bf16 v[72:75], v[40:43], a[176:179], v[72:75]
  s_add_u32 m0, s65, 2048
  s_nop 0
  buffer_load_dwordx4 v94, s[4:7], s64 offen lds
  v_mfma_f32_16x16x32_bf16 v[60:63], v[44:47], a[16:19], v[60:63]
  v_mfma_f32_16x16x32_bf16 v[68:71], v[44:47], a[96:99], v[68:71]
  v_mfma_f32_16x16x32_bf16 v[76:79], v[44:47], a[176:179], v[76:79]
  ds_read_b128 v[40:43], v105 offset:256
  ds_read_b128 v[44:47], v105 offset:20736
  s_waitcnt lgkmcnt(4)
  v_mfma_f32_16x16x32_bf16 v[56:59], v[48:51], a[20:23], v[56:59]
  v_mfma_f32_16x16x32_bf16 v[64:67], v[48:51], a[100:103], v[64:67]
  v_mfma_f32_16x16x32_bf16 v[72:75], v[48:51], a[180:183], v[72:75]
  v_mfma_f32_16x16x32_bf16 v[60:63], v[52:55], a[20:23], v[60:63]
  v_mfma_f32_16x16x32_bf16 v[68:71], v[52:55], a[100:103], v[68:71]
  v_mfma_f32_16x16x32_bf16 v[76:79], v[52:55], a[180:183], v[76:79]
  ds_read_b128 v[48:51], v102 offset:512
  ds_read_b128 v[52:55], v102 offset:20992
  s_waitcnt lgkmcnt(4)
  v_mfma_f32_16x16x32_bf16 v[56:59], v[32:35], a[24:27], v[56:59]
  s_add_u32 m0, s65, 3072
  s_nop 0
  buffer_load_dwordx4 v95, s[4:7], s64 offen lds
  v_mfma_f32_16x16x32_bf16 v[64:67], v[32:35], a[104:107], v[64:67]
  v_mfma_f32_16x16x32_bf16 v[72:75], v[32:35], a[184:187], v[72:75]
  v_mfma_f32_16x16x32_bf16 v[60:63], v[36:39], a[24:27], v[60:63]
  v_mfma_f32_16x16x32_bf16 v[68:71], v[36:39], a[104:107], v[68:71]
  v_mfma_f32_16x16x32_bf16 v[76:79], v[36:39], a[184:187], v[76:79]
  ds_read_b128 v[32:35], v103 offset:512
  ds_read_b128 v[36:39], v103 offset:20992
  s_waitcnt lgkmcnt(4)
  v_mfma_f32_16x16x32_bf16 v[56:59], v[40:43], a[28:31], v[56:59]
  v_mfma_f32_16x16x32_bf16 v[64:67], v[40:43], a[108:111], v[64:67]
  v_mfma_f32_16x16x32_bf16 v[72:75], v[40:43], a[188:191], v[72:75]
  v_mfma_f32_16x16x32_bf16 v[60:63], v[44:47], a[28:31], v[60:63]
  v_mfma_f32_16x16x32_bf16 v[68:71], v[44:47], a[108:111], v[68:71]
  s_add_u32 m0, s65, 4096
  s_nop 0
  buffer_load_dwordx4 v96, s[4:7], s64 offen lds
  v_mfma_f32_16x16x32_bf16 v[76:79], v[44:47], a[188:191], v[76:79]
  ds_read_b128 v[40:43], v104 offset:512
  ds_read_b128 v[44:47], v104 offset:20992
  s_waitcnt lgkmcnt(4)
  v_mfma_f32_16x16x32_bf16 v[56:59], v[48:51], a[32:35], v[56:59]
  v_mfma_f32_16x16x32_bf16 v[64:67], v[48:51], a[112:115], v[64:67]
  v_mfma_f32_16x16x32_bf16 v[72:75], v[48:51], a[192:195], v[72:75]
  v_mfma_f32_16x16x32_bf16 v[60:63], v[52:55], a[32:35], v[60:63]
  v_mfma_f32_16x16x32_bf16 v[68:71], v[52:55], a[112:115], v[68:71]
  v_mfma_f32_16x16x32_bf16 v[76:79], v[52:55], a[192:195], v[76:79]
  ds_read_b128 v[48:51], v105 offset:512
  ds_read_b128 v[52:55], v105 offset:20992
  s_waitcnt lgkmcnt(4)
  v_mfma_f32_16x16x32_bf16 v[56:59], v[32:35], a[36:39], v[56:59]
  v_mfma_f32_16x16x32_bf16 v[64:67], v[32:35], a[116:119], v[64:67]
  v_mfma_f32_16x16x32_bf16 v[72:75], v[32:35], a[196:199], v[72:75]
  s_add_u32 m0, s65, 5120
  s_nop 0
  buffer_load_dwordx4 v97, s[4:7], s64 offen lds
  v_mfma_f32_16x16x32_bf16 v[60:63], v[36:39], a[36:39], v[60:63]
  v_mfma_f32_16x16x32_bf16 v[68:71], v[36:39], a[116:119], v[68:71]
  v_mfma_f32_16x16x32_bf16 v[76:79], v[36:39], a[196:199], v[76:79]
  ds_read_b128 v[32:35], v102 offset:768
  ds_read_b128 v[36:39], v102 offset:21248
  s_waitcnt lgkmcnt(4)
  v_mfma_f32_16x16x32_bf16 v[56:59], v[40:43], a[40:43], v[56:59]
  v_mfma_f32_16x16x32_bf16 v[64:67], v[40:43], a[120:123], v[64:67]
  v_mfma_f32_16x16x32_bf16 v[72:75], v[40:43], a[200:203], v[72:75]
  v_mfma_f32_16x16x32_bf16 v[60:63], v[44:47], a[40:43], v[60:63]
  v_mfma_f32_16x16x32_bf16 v[68:71], v[44:47], a[120:123], v[68:71]
  v_mfma_f32_16x16x32_bf16 v[76:79], v[44:47], a[200:203], v[76:79]
  ds_read_b128 v[40:43], v103 offset:768
  ds_read_b128 v[44:47], v103 offset:21248
  s_waitcnt lgkmcnt(4)
  v_mfma_f32_16x16x32_bf16 v[56:59], v[48:51], a[44:47], v[56:59]
  s_add_u32 m0, s65, 6144
  s_nop 0
  buffer_load_dwordx4 v98, s[4:7], s64 offen lds
  v_mfma_f32_16x16x32_bf16 v[64:67], v[48:51], a[124:127], v[64:67]
  v_mfma_f32_16x16x32_bf16 v[72:75], v[48:51], a[204:207], v[72:75]
  v_mfma_f32_16x16x32_bf16 v[60:63], v[52:55], a[44:47], v[60:63]
  v_mfma_f32_16x16x32_bf16 v[68:71], v[52:55], a[124:127], v[68:71]
  v_mfma_f32_16x16x32_bf16 v[76:79], v[52:55], a[204:207], v[76:79]
  ds_read_b128 v[48:51], v104 offset:768
  ds_read_b128 v[52:55], v104 offset:21248
  s_waitcnt lgkmcnt(4)
  v_mfma_f32_16x16x32_bf16 v[56:59], v[32:35], a[48:51], v[56:59]
  v_mfma_f32_16x16x32_bf16 v[64:67], v[32:35], a[128:131], v[64:67]
  v_mfma_f32_16x16x32_bf16 v[72:75], v[32:35], a[208:211], v[72:75]
  v_mfma_f32_16x16x32_bf16 v[60:63], v[36:39], a[48:51], v[60:63]
  v_mfma_f32_16x16x32_bf16 v[68:71], v[36:39], a[128:131], v[68:71]
  s_add_u32 m0, s65, 7168
  s_nop 0
  buffer_load_dwordx4 v99, s[4:7], s64 offen lds
  v_mfma_f32_16x16x32_bf16 v[76:79], v[36:39], a[208:211], v[76:79]
  ds_read_b128 v[32:35], v105 offset:768
  ds_read_b128 v[36:39], v105 offset:21248
  s_waitcnt lgkmcnt(4)
  v_mfma_f32_16x16x32_bf16 v[56:59], v[40:43], a[52:55], v[56:59]
  v_mfma_f32_16x16x32_bf16 v[64:67], v[40:43], a[132:135], v[64:67]
  v_mfma_f32_16x16x32_bf16 v[72:75], v[40:43], a[212:215], v[72:75]
  v_mfma_f32_16x16x32_bf16 v[60:63], v[44:47], a[52:55], v[60:63]
  v_mfma_f32_16x16x32_bf16 v[68:71], v[44:47], a[132:135], v[68:71]
  v_mfma_f32_16x16x32_bf16 v[76:79], v[44:47], a[212:215], v[76:79]
  ds_read_b128 v[40:43], v102 offset:1024
  ds_read_b128 v[44:47], v102 offset:21504
  s_waitcnt lgkmcnt(4)
  v_mfma_f32_16x16x32_bf16 v[56:59], v[48:51], a[56:59], v[56:59]
  v_mfma_f32_16x16x32_bf16 v[64:67], v[48:51], a[136:139], v[64:67]
  v_mfma_f32_16x16x32_bf16 v[72:75], v[48:51], a[216:219], v[72:75]
  s_add_u32 m0, s65, 8192
  s_nop 0
  buffer_load_dwordx4 v100, s[4:7], s64 offen lds
  v_mfma_f32_16x16x32_bf16 v[60:63], v[52:55], a[56:59], v[60:63]
  v_mfma_f32_16x16x32_bf16 v[68:71], v[52:55], a[136:139], v[68:71]
  v_mfma_f32_16x16x32_bf16 v[76:79], v[52:55], a[216:219], v[76:79]
  ds_read_b128 v[48:51], v103 offset:1024
  ds_read_b128 v[52:55], v103 offset:21504
  s_waitcnt lgkmcnt(4)
  v_mfma_f32_16x16x32_bf16 v[56:59], v[32:35], a[60:63], v[56:59]
  v_mfma_f32_16x16x32_bf16 v[64:67], v[32:35], a[140:143], v[64:67]
  v_mfma_f32_16x16x32_bf16 v[72:75], v[32:35], a[220:223], v[72:75]
  v_mfma_f32_16x16x32_bf16 v[60:63], v[36:39], a[60:63], v[60:63]
  v_mfma_f32_16x16x32_bf16 v[68:71], v[36:39], a[140:143], v[68:71]
  v_mfma_f32_16x16x32_bf16 v[76:79], v[36:39], a[220:223], v[76:79]
  ds_read_b128 v[32:35], v104 offset:1024
  ds_read_b128 v[36:39], v104 offset:21504
  s_waitcnt lgkmcnt(4)
  v_mfma_f32_16x16x32_bf16 v[56:59], v[40:43], a[64:67], v[56:59]
  s_add_u32 m0, s65, 9216
  s_nop 0
  buffer_load_dwordx4 v101, s[4:7], s64 offen lds
  v_mfma_f32_16x16x32_bf16 v[64:67], v[40:43], a[144:147], v[64:67]
  v_mfma_f32_16x16x32_bf16 v[72:75], v[40:43], a[224:227], v[72:75]
  v_mfma_f32_16x16x32_bf16 v[60:63], v[44:47], a[64:67], v[60:63]
  v_mfma_f32_16x16x32_bf16 v[68:71], v[44:47], a[144:147], v[68:71]
  v_mfma_f32_16x16x32_bf16 v[76:79], v[44:47], a[224:227], v[76:79]
  ds_read_b128 v[40:43], v105 offset:1024
  ds_read_b128 v[44:47], v105 offset:21504
  s_waitcnt lgkmcnt(4)
  v_mfma_f32_16x16x32_bf16 v[56:59], v[48:51], a[68:71], v[56:59]
  v_mfma_f32_16x16x32_bf16 v[64:67], v[48:51], a[148:151], v[64:67]
  v_mfma_f32_16x16x32_bf16 v[72:75], v[48:51], a[228:231], v[72:75]
  v_mfma_f32_16x16x32_bf16 v[60:63], v[52:55], a[68:71], v[60:63]
  v_mfma_f32_16x16x32_bf16 v[68:71], v[52:55], a[148:151], v[68:71]
  v_mfma_f32_16x16x32_bf16 v[76:79], v[52:55], a[228:231], v[76:79]
  s_waitcnt lgkmcnt(2)
  v_mfma_f32_16x16x32_bf16 v[56:59], v[32:35], a[72:75], v[56:59]
  v_mfma_f32_16x16x32_bf16 v[64:67], v[32:35], a[152:155], v[64:67]
  v_mfma_f32_16x16x32_bf16 v[72:75], v[32:35], a[232:235], v[72:75]
  v_mfma_f32_16x16x32_bf16 v[60:63], v[36:39], a[72:75], v[60:63]
  v_mfma_f32_16x16x32_bf16 v[68:71], v[36:39], a[152:155], v[68:71]
  v_mfma_f32_16x16x32_bf16 v[76:79], v[36:39], a[232:235], v[76:79]
  s_waitcnt lgkmcnt(0)
  v_mfma_f32_16x16x32_bf16 v[56:59], v[40:43], a[76:79], v[56:59]
  v_mfma_f32_16x16x32_bf16 v[64:67], v[40:43], a[156:159], v[64:67]
  v_mfma_f32_16x16x32_bf16 v[72:75], v[40:43], a[236:239], v[72:75]
  v_mfma_f32_16x16x32_bf16 v[60:63], v[44:47], a[76:79], v[60:63]
  v_mfma_f32_16x16x32_bf16 v[68:71], v[44:47], a[156:159], v[68:71]
  v_mfma_f32_16x16x32_bf16 v[76:79], v[44:47], a[236:239], v[76:79]
  v_add_u32 v102, s71, v102
  v_add_u32 v103, s71, v103
  v_add_u32 v104, s71, v104
  v_add_u32 v105, s71, v105
  s_sub_u32 s71, 0, s71
  s_nop 2
  v_cvt_pk_bf16_f32 v80, v56, v57
  v_cvt_pk_bf16_f32 v81, v58, v59
  v_cvt_pk_bf16_f32 v82, v60, v61
  v_cvt_pk_bf16_f32 v83, v62, v63
  buffer_store_dwordx4 v[80:83], v25, s[48:51], s66 offen offset:0 sc1
  v_cvt_pk_bf16_f32 v84, v64, v65
  v_cvt_pk_bf16_f32 v85, v66, v67
  v_cvt_pk_bf16_f32 v86, v68, v69
  v_cvt_pk_bf16_f32 v87, v70, v71
  buffer_store_dwordx4 v[84:87], v25, s[48:51], s66 offen offset:1024 sc1
  v_cvt_pk_bf16_f32 v88, v72, v73
  v_cvt_pk_bf16_f32 v89, v74, v75
  v_cvt_pk_bf16_f32 v90, v76, v77
  v_cvt_pk_bf16_f32 v91, v78, v79
  buffer_store_dwordx4 v[88:91], v25, s[48:51], s66 offen offset:2048 sc1
  s_add_u32 s66, s66, 393216
  s_add_u32 s62, s62, 1
  s_cmp_lt_u32 s62, 64
  s_cbranch_scc1 L_t1_vi
  s_waitcnt vmcnt(0)
  s_barrier
  s_cmp_lg_u32 s52, 0
  s_cbranch_scc1 t1e_14181
  v_mov_b32 v18, 64
  s_mov_b64 exec, 1
  buffer_store_dword v18, v29, s[48:51], 0 offen sc1
  s_mov_b64 exec, -1
t1e_14181:
L_t1done_i:
  s_lshl_b32 s61, s53, 4
  s_add_u32 s61, s61, s54
  s_lshr_b32 s62, s61, 1
  s_and_b32 s63, s61, 1
  s_mul_i32 s63, s63, 4
  s_mov_b32 s64, 4
  s_waitcnt vmcnt(0)
  v_mov_b32 v19, 32768
  s_mov_b32 s56, 0
poll_14182:
  buffer_load_dword v18, v19, s[48:51], 0 offen sc1
  s_waitcnt vmcnt(0)
  v_readfirstlane_b32 s58, v18
  s_cmp_ge_u32 s58, 30
  s_cbranch_scc1 polldone_14183
  s_cmp_lg_u32 s55, 0
  s_cbranch_scc1 polldone_14183
  s_add_u32 s56, s56, 1
  s_cmp_lt_u32 s56, 0x20000
  s_cbranch_scc1 poll_14182
  s_mov_b32 s55, 1
polldone_14183:
  v_and_b32 v1, 63, v0
  v_lshlrev_b32 v2, 4, v1
  s_mul_i32 s72, s52, 3072
  s_mul_i32 s59, s62, 98304
  s_add_u32 s59, s59, 0x7900000
  v_mul_u32_u24 v18, 48, v0
  v_mov_b32 v19, 0
  s_add_u32 s58, s59, 0
  buffer_load_dwordx4 v[64:67], v18, s[48:51], s58 offen sc1
  buffer_load_dwordx4 v[68:71], v18, s[48:51], s58 offen offset:16 sc1
  buffer_load_dwordx2 v[72:73], v18, s[48:51], s58 offen offset:32 sc1
  s_add_u32 s58, s59, 12288
  buffer_load_dwordx4 v[76:79], v18, s[48:51], s58 offen sc1
  buffer_load_dwordx4 v[80:83], v18, s[48:51], s58 offen offset:16 sc1
  buffer_load_dwordx2 v[84:85], v18, s[48:51], s58 offen offset:32 sc1
  s_add_u32 s58, s59, 24576
  buffer_load_dwordx4 v[88:91], v18, s[48:51], s58 offen sc1
  buffer_load_dwordx4 v[92:95], v18, s[48:51], s58 offen offset:16 sc1
  buffer_load_dwordx2 v[96:97], v18, s[48:51], s58 offen offset:32 sc1
  s_add_u32 s58, s59, 36864
  buffer_load_dwordx4 v[100:103], v18, s[48:51], s58 offen sc1
  buffer_load_dwordx4 v[104:107], v18, s[48:51], s58 offen offset:16 sc1
  buffer_load_dwordx2 v[108:109], v18, s[48:51], s58 offen offset:32 sc1
  s_waitcnt vmcnt(0)
  v_mov_b32 v192, 0
  v_mov_b32 v193, 0
  v_mov_b32 v194, 0
  v_mov_b32 v195, 0
  v_dot2c_f32_bf16 v192, v64, v64
  v_dot2c_f32_bf16 v193, v76, v76
  v_dot2c_f32_bf16 v194, v88, v88
  v_dot2c_f32_bf16 v195, v100, v100
  v_dot2c_f32_bf16 v192, v65, v65
  v_dot2c_f32_bf16 v193, v77, v77
  v_dot2c_f32_bf16 v194, v89, v89
  v_dot2c_f32_bf16 v195, v101, v101
  v_dot2c_f32_bf16 v192, v66, v66
  v_dot2c_f32_bf16 v193, v78, v78
  v_dot2c_f32_bf16 v194, v90, v90
  v_dot2c_f32_bf16 v195, v102, v102
  v_dot2c_f32_bf16 v192, v67, v67
  v_dot2c_f32_bf16 v193, v79, v79
  v_dot2c_f32_bf16 v194, v91, v91
  v_dot2c_f32_bf16 v195, v103, v103
  v_dot2c_f32_bf16 v192, v68, v68
  v_dot2c_f32_bf16 v193, v80, v80
  v_dot2c_f32_bf16 v194, v92, v92
  v_dot2c_f32_bf16 v195, v104, v104
  v_dot2c_f32_bf16 v192, v69, v69
  v_dot2c_f32_bf16 v193, v81, v81
  v_dot2c_f32_bf16 v194, v93, v93
  v_dot2c_f32_bf16 v195, v105, v105
  v_dot2c_f32_bf16 v192, v70, v70
  v_dot2c_f32_bf16 v193, v82, v82
  v_dot2c_f32_bf16 v194, v94, v94
  v_dot2c_f32_bf16 v195, v106, v106
  v_dot2c_f32_bf16 v192, v71, v71
  v_dot2c_f32_bf16 v193, v83, v83
  v_dot2c_f32_bf16 v194, v95, v95
  v_dot2c_f32_bf16 v195, v107, v107
  v_dot2c_f32_bf16 v192, v72, v72
  v_dot2c_f32_bf16 v193, v84, v84
  v_dot2c_f32_bf16 v194, v96, v96
  v_dot2c_f32_bf16 v195, v108, v108
  v_dot2c_f32_bf16 v192, v73, v73
  v_dot2c_f32_bf16 v193, v85, v85
  v_dot2c_f32_bf16 v194, v97, v97
  v_dot2c_f32_bf16 v195, v109, v109
  s_nop 2
  v_max3_f32 v19, v19, v192, v193
  v_max3_f32 v19, v19, v194, v195
  s_add_u32 s58, s59, 49152
  buffer_load_dwordx4 v[64:67], v18, s[48:51], s58 offen sc1
  buffer_load_dwordx4 v[68:71], v18, s[48:51], s58 offen offset:16 sc1
  buffer_load_dwordx2 v[72:73], v18, s[48:51], s58 offen offset:32 sc1
  s_add_u32 s58, s59, 61440
  buffer_load_dwordx4 v[76:79], v18, s[48:51], s58 offen sc1
  buffer_load_dwordx4 v[80:83], v18, s[48:51], s58 offen offset:16 sc1
  buffer_load_dwordx2 v[84:85], v18, s[48:51], s58 offen offset:32 sc1
  s_add_u32 s58, s59, 73728
  buffer_load_dwordx4 v[88:91], v18, s[48:51], s58 offen sc1
  buffer_load_dwordx4 v[92:95], v18, s[48:51], s58 offen offset:16 sc1
  buffer_load_dwordx2 v[96:97], v18, s[48:51], s58 offen offset:32 sc1
  s_add_u32 s58, s59, 86016
  buffer_load_dwordx4 v[100:103], v18, s[48:51], s58 offen sc1
  buffer_load_dwordx4 v[104:107], v18, s[48:51], s58 offen offset:16 sc1
  buffer_load_dwordx2 v[108:109], v18, s[48:51], s58 offen offset:32 sc1
  s_waitcnt vmcnt(0)
  v_mov_b32 v192, 0
  v_mov_b32 v193, 0
  v_mov_b32 v194, 0
  v_mov_b32 v195, 0
  v_dot2c_f32_bf16 v192, v64, v64
  v_dot2c_f32_bf16 v193, v76, v76
  v_dot2c_f32_bf16 v194, v88, v88
  v_dot2c_f32_bf16 v195, v100, v100
  v_dot2c_f32_bf16 v192, v65, v65
  v_dot2c_f32_bf16 v193, v77, v77
  v_dot2c_f32_bf16 v194, v89, v89
  v_dot2c_f32_bf16 v195, v101, v101
  v_dot2c_f32_bf16 v192, v66, v66
  v_dot2c_f32_bf16 v193, v78, v78
  v_dot2c_f32_bf16 v194, v90, v90
  v_dot2c_f32_bf16 v195, v102, v102
  v_dot2c_f32_bf16 v192, v67, v67
  v_dot2c_f32_bf16 v193, v79, v79
  v_dot2c_f32_bf16 v194, v91, v91
  v_dot2c_f32_bf16 v195, v103, v103
  v_dot2c_f32_bf16 v192, v68, v68
  v_dot2c_f32_bf16 v193, v80, v80
  v_dot2c_f32_bf16 v194, v92, v92
  v_dot2c_f32_bf16 v195, v104, v104
  v_dot2c_f32_bf16 v192, v69, v69
  v_dot2c_f32_bf16 v193, v81, v81
  v_dot2c_f32_bf16 v194, v93, v93
  v_dot2c_f32_bf16 v195, v105, v105
  v_dot2c_f32_bf16 v192, v70, v70
  v_dot2c_f32_bf16 v193, v82, v82
  v_dot2c_f32_bf16 v194, v94, v94
  v_dot2c_f32_bf16 v195, v106, v106
  v_dot2c_f32_bf16 v192, v71, v71
  v_dot2c_f32_bf16 v193, v83, v83
  v_dot2c_f32_bf16 v194, v95, v95
  v_dot2c_f32_bf16 v195, v107, v107
  v_dot2c_f32_bf16 v192, v72, v72
  v_dot2c_f32_bf16 v193, v84, v84
  v_dot2c_f32_bf16 v194, v96, v96
  v_dot2c_f32_bf16 v195, v108, v108
  v_dot2c_f32_bf16 v192, v73, v73
  v_dot2c_f32_bf16 v193, v85, v85
  v_dot2c_f32_bf16 v194, v97, v97
  v_dot2c_f32_bf16 v195, v109, v109
  s_nop 2
  v_max3_f32 v19, v19, v192, v193
  v_max3_f32 v19, v19, v194, v195
  v_mov_b32 v20, 73728
  v_mov_b32 v21, 0
  ds_write_b32 v20, v21
  ds_write_b32 v20, v21 offset:4
  s_waitcnt lgkmcnt(0)
  s_barrier
  ds_max_u32 v20, v19
  s_waitcnt lgkmcnt(0)
  s_barrier
  ds_read_b32 v19, v20
  s_waitcnt lgkmcnt(0)
  v_readfirstlane_b32 s69, v19
  v_and_b32 v18, 31, v1
  v_mul_u32_u24 v18, 48, v18
  v_lshrrev_b32 v19, 5, v1
  v_lshlrev_b32 v20, 4, v19
  v_add_u32 v3, v18, v20
  v_add_u32 v4, 32, v18
  v_mov_b32 v6, v3
  v_lshlrev_b32 v20, 2, v19
  v_lshrrev_b32 v21, 2, v1
  v_and_b32 v21, 3, v21
  v_add_u32 v20, v20, v21
  v_mul_u32_u24 v20, 48, v20
  v_lshrrev_b32 v21, 4, v1
  v_and_b32 v21, 1, v21
  v_lshlrev_b32 v21, 5, v21
  v_add_u32 v20, v20, v21
  v_and_b32 v21, 3, v1
  v_lshlrev_b32 v21, 3, v21
  v_add_u32 v20, v20, v21
  v_add_u32 v5, 12288, v20
  v_and_b32 v18, 31, v1
  v_mul_u32_u24 v18, 1280, v18
  v_lshlrev_b32 v19, 3, v19
  v_add_u32 v7, v18, v19
  s_mov_b32 s68, 0
L_b2_bi:
  s_lshl_b32 s58, s63, 8
  s_lshl_b32 s59, s52, 6
  s_add_u32 s58, s58, s59
  s_mul_i32 s71, s58, 1280
  s_mul_i32 s59, s62, 40
  s_add_u32 s71, s71, s59
  s_add_u32 s71, s71, 0x7f00000
  s_mul_i32 s58, s58, 48
  s_mul_i32 s59, s62, 98304
  s_add_u32 s70, s58, s59
  s_add_u32 s70, s70, 0x7600000
  v_and_b32 v18, 31, v1
  v_mul_u32_u24 v18, 48, v18
  buffer_load_dwordx4 v[208:211], v6, s[48:51], s70 offen offset:0 sc1
  buffer_load_dwordx2 v[212:213], v18, s[48:51], s70 offen offset:32 sc1
  buffer_load_dwordx4 v[216:219], v6, s[48:51], s70 offen offset:1536 sc1
  buffer_load_dwordx2 v[220:221], v18, s[48:51], s70 offen offset:1568 sc1
  v_cmp_gt_u32 vcc, 32, v1
  v_mov_b32 v19, 0
  s_waitcnt vmcnt(0)
  v_cndmask_b32 v212, v19, v212, vcc
  v_cndmask_b32 v213, v19, v213, vcc
  v_mov_b32 v214, 0
  v_mov_b32 v215, 0
  v_mov_b32 v192, 0
  v_cndmask_b32 v220, v19, v220, vcc
  v_cndmask_b32 v221, v19, v221, vcc
  v_mov_b32 v222, 0
  v_mov_b32 v223, 0
  v_mov_b32 v193, 0
  v_dot2c_f32_bf16 v192, v208, v208
  v_dot2c_f32_bf16 v193, v216, v216
  v_dot2c_f32_bf16 v192, v209, v209
  v_dot2c_f32_bf16 v193, v217, v217
  v_dot2c_f32_bf16 v192, v210, v210
  v_dot2c_f32_bf16 v193, v218, v218
  v_dot2c_f32_bf16 v192, v211, v211
  v_dot2c_f32_bf16 v193, v219, v219
  v_dot2c_f32_bf16 v192, v212, v212
  v_dot2c_f32_bf16 v193, v220, v220
  v_dot2c_f32_bf16 v192, v213, v213
  v_dot2c_f32_bf16 v193, v221, v221
  s_nop 2
  v_mov_b32 v194, v192
  s_nop 1
  v_permlane32_swap_b32 v192, v194
  s_nop 0
  v_add_f32 v192, v192, v194
  v_mov_b32 v194, v193
  s_nop 1
  v_permlane32_swap_b32 v193, v194
  s_nop 0
  v_add_f32 v193, v193, v194
  v_mul_f32 v192, s69, v192
  v_sqrt_f32 v192, v192
  s_nop 0
  v_mul_f32 v192, 0x3f828f5c, v192
  v_add_u32 v192, 0x10000, v192
  v_lshrrev_b32 v192, 16, v192
  v_or_b32 v192, 0x8000, v192
  v_cndmask_b32 v214, v19, v192, vcc
  v_mul_f32 v193, s69, v193
  v_sqrt_f32 v193, v193
  s_nop 0
  v_mul_f32 v193, 0x3f828f5c, v193
  v_add_u32 v193, 0x10000, v193
  v_lshrrev_b32 v193, 16, v193
  v_or_b32 v193, 0x8000, v193
  v_cndmask_b32 v222, v19, v193, vcc
  s_mul_i32 s65, s62, 98304
  s_add_u32 s65, s65, 0x7900000
  s_barrier
  s_mov_b32 s67, 0
  s_add_u32 m0, s67, s72
  s_add_u32 s58, s65, s72
  buffer_load_dwordx4 v2, s[48:51], s58 offen offset:0 sc1 lds
  buffer_load_dwordx4 v2, s[48:51], s58 offen offset:1024 sc1 lds
  buffer_load_dwordx4 v2, s[48:51], s58 offen offset:2048 sc1 lds
  s_add_u32 m0, m0, 12288
  s_add_u32 s58, s58, 3145728
  buffer_load_dwordx4 v2, s[48:51], s58 offen offset:0 sc1 lds
  buffer_load_dwordx4 v2, s[48:51], s58 offen offset:1024 sc1 lds
  buffer_load_dwordx4 v2, s[48:51], s58 offen offset:2048 sc1 lds
  s_add_u32 s65, s65, 12288
  s_mov_b32 s67, 24576
  s_add_u32 m0, s67, s72
  s_add_u32 s58, s65, s72
  buffer_load_dwordx4 v2, s[48:51], s58 offen offset:0 sc1 lds
  buffer_load_dwordx4 v2, s[48:51], s58 offen offset:1024 sc1 lds
  buffer_load_dwordx4 v2, s[48:51], s58 offen offset:2048 sc1 lds
  s_add_u32 m0, m0, 12288
  s_add_u32 s58, s58, 3145728
  buffer_load_dwordx4 v2, s[48:51], s58 offen offset:0 sc1 lds
  buffer_load_dwordx4 v2, s[48:51], s58 offen offset:1024 sc1 lds
  buffer_load_dwordx4 v2, s[48:51], s58 offen offset:2048 sc1 lds
  s_add_u32 s65, s65, 12288
  v_mov_b32 v160, 0
  v_mov_b32 v161, 0
  v_mov_b32 v162, 0
  v_mov_b32 v163, 0
  v_mov_b32 v164, 0
  v_mov_b32 v165, 0
  v_mov_b32 v166, 0
  v_mov_b32 v167, 0
  v_mov_b32 v168, 0
  v_mov_b32 v169, 0
  v_mov_b32 v170, 0
  v_mov_b32 v171, 0
  v_mov_b32 v172, 0
  v_mov_b32 v173, 0
  v_mov_b32 v174, 0
  v_mov_b32 v175, 0
  v_mov_b32 v176, 0
  v_mov_b32 v177, 0
  v_mov_b32 v178, 0
  v_mov_b32 v179, 0
  v_mov_b32 v180, 0
  v_mov_b32 v181, 0
  v_mov_b32 v182, 0
  v_mov_b32 v183, 0
  v_mov_b32 v184, 0
  v_mov_b32 v185, 0
  v_mov_b32 v186, 0
  v_mov_b32 v187, 0
  v_mov_b32 v188, 0
  v_mov_b32 v189, 0
  v_mov_b32 v190, 0
  v_mov_b32 v191, 0
  v_mov_b32 v128, 0
  v_mov_b32 v129, 0
  v_mov_b32 v130, 0
  v_mov_b32 v131, 0
  v_mov_b32 v132, 0
  v_mov_b32 v133, 0
  v_mov_b32 v134, 0
  v_mov_b32 v135, 0
  v_mov_b32 v136, 0
  v_mov_b32 v137, 0
  v_mov_b32 v138, 0
  v_mov_b32 v139, 0
  v_mov_b32 v140, 0
  v_mov_b32 v141, 0
  v_mov_b32 v142, 0
  v_mov_b32 v143, 0
  v_mov_b32 v144, 0
  v_mov_b32 v145, 0
  v_mov_b32 v146, 0
  v_mov_b32 v147, 0
  v_mov_b32 v148, 0
  v_mov_b32 v149, 0
  v_mov_b32 v150, 0
  v_mov_b32 v151, 0
  v_mov_b32 v152, 0
  v_mov_b32 v153, 0
  v_mov_b32 v154, 0
  v_mov_b32 v155, 0
  v_mov_b32 v156, 0
  v_mov_b32 v157, 0
  v_mov_b32 v158, 0
  v_mov_b32 v159, 0
  s_waitcnt vmcnt(6)
  s_barrier
  ds_read_b128 v[32:35], v3 offset:0
  ds_read_b128 v[36:39], v4 offset:0
  ds_read_b64_tr_b16 v[56:57], v5 offset:0
  ds_read_b64_tr_b16 v[58:59], v5 offset:384
  ds_read_b64_tr_b16 v[60:61], v5 offset:768
  ds_read_b64_tr_b16 v[62:63], v5 offset:1152
  s_waitcnt lgkmcnt(4)
  v_mfma_f32_32x32x16_bf16 v[64:79], v[32:35], v[208:211], 0
  v_mfma_f32_32x32x16_bf16 v[64:79], v[36:39], v[212:215], v[64:79]
  v_mfma_f32_32x32x16_bf16 v[80:95], v[32:35], v[216:219], 0
  v_mfma_f32_32x32x16_bf16 v[80:95], v[36:39], v[220:223], v[80:95]
  ds_read_b128 v[40:43], v3 offset:1536
  ds_read_b128 v[44:47], v4 offset:1536
  s_mov_b32 s66, 0
  s_mov_b32 s67, 49152
L_b2_bi_m:
  s_waitcnt lgkmcnt(0)
  v_mfma_f32_32x32x16_bf16 v[96:111], v[40:43], v[208:211], 0
  v_exp_f32 v64, v64
  v_exp_f32 v65, v65
  v_exp_f32 v66, v66
  v_exp_f32 v67, v67
  v_cvt_pk_bf16_f32 v128, v64, v65
  v_exp_f32 v68, v68
  v_mfma_f32_32x32x16_bf16 v[160:175], v[56:59], v[144:147], v[160:175]
  ds_read_b64_tr_b16 v[48:49], v5 offset:0
  ds_read_b64_tr_b16 v[50:51], v5 offset:384
  ds_read_b64_tr_b16 v[52:53], v5 offset:768
  ds_read_b64_tr_b16 v[54:55], v5 offset:1152
  v_exp_f32 v69, v69
  v_cvt_pk_bf16_f32 v129, v66, v67
  v_exp_f32 v70, v70
  v_exp_f32 v71, v71
  v_cvt_pk_bf16_f32 v130, v68, v69
  v_exp_f32 v72, v72
  v_mfma_f32_32x32x16_bf16 v[112:127], v[40:43], v[216:219], 0
  v_exp_f32 v73, v73
  v_cvt_pk_bf16_f32 v131, v70, v71
  v_exp_f32 v74, v74
  v_exp_f32 v75, v75
  v_cvt_pk_bf16_f32 v132, v72, v73
  v_exp_f32 v76, v76
  v_mfma_f32_32x32x16_bf16 v[176:191], v[56:59], v[152:155], v[176:191]
  v_exp_f32 v77, v77
  v_cvt_pk_bf16_f32 v133, v74, v75
  v_exp_f32 v78, v78
  v_exp_f32 v79, v79
  v_cvt_pk_bf16_f32 v134, v76, v77
  v_exp_f32 v80, v80
  v_mfma_f32_32x32x16_bf16 v[96:111], v[44:47], v[212:215], v[96:111]
  v_exp_f32 v81, v81
  v_cvt_pk_bf16_f32 v135, v78, v79
  v_exp_f32 v82, v82
  v_exp_f32 v83, v83
  v_cvt_pk_bf16_f32 v136, v80, v81
  v_exp_f32 v84, v84
  v_mfma_f32_32x32x16_bf16 v[160:175], v[60:63], v[148:151], v[160:175]
  v_exp_f32 v85, v85
  v_cvt_pk_bf16_f32 v137, v82, v83
  v_exp_f32 v86, v86
  v_exp_f32 v87, v87
  v_cvt_pk_bf16_f32 v138, v84, v85
  v_exp_f32 v88, v88
  v_mfma_f32_32x32x16_bf16 v[112:127], v[44:47], v[220:223], v[112:127]
  ds_read_b128 v[32:35], v3 offset:3072
  ds_read_b128 v[36:39], v4 offset:3072
  v_exp_f32 v89, v89
  v_cvt_pk_bf16_f32 v139, v86, v87
  v_exp_f32 v90, v90
  v_exp_f32 v91, v91
  v_cvt_pk_bf16_f32 v140, v88, v89
  v_exp_f32 v92, v92
  v_mfma_f32_32x32x16_bf16 v[176:191], v[60:63], v[156:159], v[176:191]
  v_exp_f32 v93, v93
  v_cvt_pk_bf16_f32 v141, v90, v91
  v_exp_f32 v94, v94
  v_exp_f32 v95, v95
  v_cvt_pk_bf16_f32 v142, v92, v93
  v_cvt_pk_bf16_f32 v143, v94, v95
  s_waitcnt lgkmcnt(0)
  v_mfma_f32_32x32x16_bf16 v[64:79], v[32:35], v[208:211], 0
  v_exp_f32 v96, v96
  v_exp_f32 v97, v97
  v_exp_f32 v98, v98
  v_exp_f32 v99, v99
  v_cvt_pk_bf16_f32 v144, v96, v97
  v_exp_f32 v100, v100
  v_mfma_f32_32x32x16_bf16 v[160:175], v[48:51], v[128:131], v[160:175]
  ds_read_b64_tr_b16 v[56:57], v5 offset:1536
  ds_read_b64_tr_b16 v[58:59], v5 offset:1920
  ds_read_b64_tr_b16 v[60:61], v5 offset:2304
  ds_read_b64_tr_b16 v[62:63], v5 offset:2688
  v_exp_f32 v101, v101
  v_cvt_pk_bf16_f32 v145, v98, v99
  v_exp_f32 v102, v102
  v_exp_f32 v103, v103
  v_cvt_pk_bf16_f32 v146, v100, v101
  v_exp_f32 v104, v104
  v_mfma_f32_32x32x16_bf16 v[80:95], v[32:35], v[216:219], 0
  v_exp_f32 v105, v105
  v_cvt_pk_bf16_f32 v147, v102, v103
  v_exp_f32 v106, v106
  v_exp_f32 v107, v107
  v_cvt_pk_bf16_f32 v148, v104, v105
  v_exp_f32 v108, v108
  v_mfma_f32_32x32x16_bf16 v[176:191], v[48:51], v[136:139], v[176:191]
  v_exp_f32 v109, v109
  v_cvt_pk_bf16_f32 v149, v106, v107
  v_exp_f32 v110, v110
  v_exp_f32 v111, v111
  v_cvt_pk_bf16_f32 v150, v108, v109
  v_exp_f32 v112, v112
  v_mfma_f32_32x32x16_bf16 v[64:79], v[36:39], v[212:215], v[64:79]
  v_exp_f32 v113, v113
  v_cvt_pk_bf16_f32 v151, v110, v111
  v_exp_f32 v114, v114
  v_exp_f32 v115, v115
  v_cvt_pk_bf16_f32 v152, v112, v113
  v_exp_f32 v116, v116
  v_mfma_f32_32x32x16_bf16 v[160:175], v[52:55], v[132:135], v[160:175]
  v_exp_f32 v117, v117
  v_cvt_pk_bf16_f32 v153, v114, v115
  v_exp_f32 v118, v118
  v_exp_f32 v119, v119
  v_cvt_pk_bf16_f32 v154, v116, v117
  v_exp_f32 v120, v120
  v_mfma_f32_32x32x16_bf16 v[80:95], v[36:39], v[220:223], v[80:95]
  ds_read_b128 v[40:43], v3 offset:4608
  ds_read_b128 v[44:47], v4 offset:4608
  v_exp_f32 v121, v121
  v_cvt_pk_bf16_f32 v155, v118, v119
  v_exp_f32 v122, v122
  v_exp_f32 v123, v123
  v_cvt_pk_bf16_f32 v156, v120, v121
  v_exp_f32 v124, v124
  v_mfma_f32_32x32x16_bf16 v[176:191], v[52:55], v[140:143], v[176:191]
  v_exp_f32 v125, v125
  v_cvt_pk_bf16_f32 v157, v122, v123
  v_exp_f32 v126, v126
  v_exp_f32 v127, v127
  v_cvt_pk_bf16_f32 v158, v124, v125
  v_cvt_pk_bf16_f32 v159, v126, v127
  s_waitcnt lgkmcnt(0)
  v_mfma_f32_32x32x16_bf16 v[96:111], v[40:43], v[208:211], 0
  v_exp_f32 v64, v64
  v_exp_f32 v65, v65
  v_exp_f32 v66, v66
  v_exp_f32 v67, v67
  v_cvt_pk_bf16_f32 v128, v64, v65
  v_exp_f32 v68, v68
  v_mfma_f32_32x32x16_bf16 v[160:175], v[56:59], v[144:147], v[160:175]
  ds_read_b64_tr_b16 v[48:49], v5 offset:3072
  ds_read_b64_tr_b16 v[50:51], v5 offset:3456
  ds_read_b64_tr_b16 v[52:53], v5 offset:3840
  ds_read_b64_tr_b16 v[54:55], v5 offset:4224
  v_exp_f32 v69, v69
  v_cvt_pk_bf16_f32 v129, v66, v67
  v_exp_f32 v70, v70
  v_exp_f32 v71, v71
  v_cvt_pk_bf16_f32 v130, v68, v69
  v_exp_f32 v72, v72
  v_mfma_f32_32x32x16_bf16 v[112:127], v[40:43], v[216:219], 0
  v_exp_f32 v73, v73
  v_cvt_pk_bf16_f32 v131, v70, v71
  v_exp_f32 v74, v74
  v_exp_f32 v75, v75
  v_cvt_pk_bf16_f32 v132, v72, v73
  v_exp_f32 v76, v76
  v_mfma_f32_32x32x16_bf16 v[176:191], v[56:59], v[152:155], v[176:191]
  v_exp_f32 v77, v77
  v_cvt_pk_bf16_f32 v133, v74, v75
  v_exp_f32 v78, v78
  v_exp_f32 v79, v79
  v_cvt_pk_bf16_f32 v134, v76, v77
  v_exp_f32 v80, v80
  v_mfma_f32_32x32x16_bf16 v[96:111], v[44:47], v[212:215], v[96:111]
  v_exp_f32 v81, v81
  v_cvt_pk_bf16_f32 v135, v78, v79
  v_exp_f32 v82, v82
  v_exp_f32 v83, v83
  v_cvt_pk_bf16_f32 v136, v80, v81
  v_exp_f32 v84, v84
  v_mfma_f32_32x32x16_bf16 v[160:175], v[60:63], v[148:151], v[160:175]
  v_exp_f32 v85, v85
  v_cvt_pk_bf16_f32 v137, v82, v83
  v_exp_f32 v86, v86
  v_exp_f32 v87, v87
  v_cvt_pk_bf16_f32 v138, v84, v85
  v_exp_f32 v88, v88
  v_mfma_f32_32x32x16_bf16 v[112:127], v[44:47], v[220:223], v[112:127]
  ds_read_b128 v[32:35], v3 offset:6144
  ds_read_b128 v[36:39], v4 offset:6144
  v_exp_f32 v89, v89
  v_cvt_pk_bf16_f32 v139, v86, v87
  v_exp_f32 v90, v90
  v_exp_f32 v91, v91
  v_cvt_pk_bf16_f32 v140, v88, v89
  v_exp_f32 v92, v92
  v_mfma_f32_32x32x16_bf16 v[176:191], v[60:63], v[156:159], v[176:191]
  v_exp_f32 v93, v93
  v_cvt_pk_bf16_f32 v141, v90, v91
  v_exp_f32 v94, v94
  v_exp_f32 v95, v95
  v_cvt_pk_bf16_f32 v142, v92, v93
  v_cvt_pk_bf16_f32 v143, v94, v95
  s_waitcnt lgkmcnt(0)
  v_mfma_f32_32x32x16_bf16 v[64:79], v[32:35], v[208:211], 0
  v_exp_f32 v96, v96
  v_exp_f32 v97, v97
  v_exp_f32 v98, v98
  v_exp_f32 v99, v99
  v_cvt_pk_bf16_f32 v144, v96, v97
  v_exp_f32 v100, v100
  v_mfma_f32_32x32x16_bf16 v[160:175], v[48:51], v[128:131], v[160:175]
  ds_read_b64_tr_b16 v[56:57], v5 offset:4608
  ds_read_b64_tr_b16 v[58:59], v5 offset:4992
  ds_read_b64_tr_b16 v[60:61], v5 offset:5376
  ds_read_b64_tr_b16 v[62:63], v5 offset:5760
  v_exp_f32 v101, v101
  v_cvt_pk_bf16_f32 v145, v98, v99
  v_exp_f32 v102, v102
  v_exp_f32 v103, v103
  v_cvt_pk_bf16_f32 v146, v100, v101
  v_exp_f32 v104, v104
  v_mfma_f32_32x32x16_bf16 v[80:95], v[32:35], v[216:219], 0
  v_exp_f32 v105, v105
  v_cvt_pk_bf16_f32 v147, v102, v103
  v_exp_f32 v106, v106
  v_exp_f32 v107, v107
  v_cvt_pk_bf16_f32 v148, v104, v105
  v_exp_f32 v108, v108
  v_mfma_f32_32x32x16_bf16 v[176:191], v[48:51], v[136:139], v[176:191]
  v_exp_f32 v109, v109
  v_cvt_pk_bf16_f32 v149, v106, v107
  v_exp_f32 v110, v110
  v_exp_f32 v111, v111
  v_cvt_pk_bf16_f32 v150, v108, v109
  v_exp_f32 v112, v112
  v_mfma_f32_32x32x16_bf16 v[64:79], v[36:39], v[212:215], v[64:79]
  v_exp_f32 v113, v113
  v_cvt_pk_bf16_f32 v151, v110, v111
  v_exp_f32 v114, v114
  v_exp_f32 v115, v115
  v_cvt_pk_bf16_f32 v152, v112, v113
  v_exp_f32 v116, v116
  v_mfma_f32_32x32x16_bf16 v[160:175], v[52:55], v[132:135], v[160:175]
  v_exp_f32 v117, v117
  v_cvt_pk_bf16_f32 v153, v114, v115
  v_exp_f32 v118, v118
  v_exp_f32 v119, v119
  v_cvt_pk_bf16_f32 v154, v116, v117
  v_exp_f32 v120, v120
  v_mfma_f32_32x32x16_bf16 v[80:95], v[36:39], v[220:223], v[80:95]
  ds_read_b128 v[40:43], v3 offset:7680
  ds_read_b128 v[44:47], v4 offset:7680
  v_exp_f32 v121, v121
  v_cvt_pk_bf16_f32 v155, v118, v119
  v_exp_f32 v122, v122
  v_exp_f32 v123, v123
  v_cvt_pk_bf16_f32 v156, v120, v121
  v_exp_f32 v124, v124
  v_mfma_f32_32x32x16_bf16 v[176:191], v[52:55], v[140:143], v[176:191]
  v_exp_f32 v125, v125
  v_cvt_pk_bf16_f32 v157, v122, v123
  v_exp_f32 v126, v126
  v_exp_f32 v127, v127
  v_cvt_pk_bf16_f32 v158, v124, v125
  v_cvt_pk_bf16_f32 v159, v126, v127
  s_waitcnt lgkmcnt(0)
  v_mfma_f32_32x32x16_bf16 v[96:111], v[40:43], v[208:211], 0
  v_exp_f32 v64, v64
  v_exp_f32 v65, v65
  v_exp_f32 v66, v66
  v_exp_f32 v67, v67
  v_cvt_pk_bf16_f32 v128, v64, v65
  v_exp_f32 v68, v68
  v_mfma_f32_32x32x16_bf16 v[160:175], v[56:59], v[144:147], v[160:175]
  ds_read_b64_tr_b16 v[48:49], v5 offset:6144
  ds_read_b64_tr_b16 v[50:51], v5 offset:6528
  ds_read_b64_tr_b16 v[52:53], v5 offset:6912
  ds_read_b64_tr_b16 v[54:55], v5 offset:7296
  v_exp_f32 v69, v69
  v_cvt_pk_bf16_f32 v129, v66, v67
  v_exp_f32 v70, v70
  v_exp_f32 v71, v71
  v_cvt_pk_bf16_f32 v130, v68, v69
  v_exp_f32 v72, v72
  v_mfma_f32_32x32x16_bf16 v[112:127], v[40:43], v[216:219], 0
  v_exp_f32 v73, v73
  v_cvt_pk_bf16_f32 v131, v70, v71
  v_exp_f32 v74, v74
  v_exp_f32 v75, v75
  v_cvt_pk_bf16_f32 v132, v72, v73
  v_exp_f32 v76, v76
  v_mfma_f32_32x32x16_bf16 v[176:191], v[56:59], v[152:155], v[176:191]
  v_exp_f32 v77, v77
  v_cvt_pk_bf16_f32 v133, v74, v75
  v_exp_f32 v78, v78
  v_exp_f32 v79, v79
  v_cvt_pk_bf16_f32 v134, v76, v77
  v_exp_f32 v80, v80
  v_mfma_f32_32x32x16_bf16 v[96:111], v[44:47], v[212:215], v[96:111]
  v_exp_f32 v81, v81
  v_cvt_pk_bf16_f32 v135, v78, v79
  v_exp_f32 v82, v82
  v_exp_f32 v83, v83
  v_cvt_pk_bf16_f32 v136, v80, v81
  v_exp_f32 v84, v84
  v_mfma_f32_32x32x16_bf16 v[160:175], v[60:63], v[148:151], v[160:175]
  v_exp_f32 v85, v85
  v_cvt_pk_bf16_f32 v137, v82, v83
  v_exp_f32 v86, v86
  v_exp_f32 v87, v87
  v_cvt_pk_bf16_f32 v138, v84, v85
  v_exp_f32 v88, v88
  v_mfma_f32_32x32x16_bf16 v[112:127], v[44:47], v[220:223], v[112:127]
  ds_read_b128 v[32:35], v3 offset:9216
  ds_read_b128 v[36:39], v4 offset:9216
  v_exp_f32 v89, v89
  v_cvt_pk_bf16_f32 v139, v86, v87
  v_exp_f32 v90, v90
  v_exp_f32 v91, v91
  v_cvt_pk_bf16_f32 v140, v88, v89
  v_exp_f32 v92, v92
  v_mfma_f32_32x32x16_bf16 v[176:191], v[60:63], v[156:159], v[176:191]
  v_exp_f32 v93, v93
  v_cvt_pk_bf16_f32 v141, v90, v91
  v_exp_f32 v94, v94
  v_exp_f32 v95, v95
  v_cvt_pk_bf16_f32 v142, v92, v93
  v_cvt_pk_bf16_f32 v143, v94, v95
  s_waitcnt lgkmcnt(0)
  v_mfma_f32_32x32x16_bf16 v[64:79], v[32:35], v[208:211], 0
  v_exp_f32 v96, v96
  v_exp_f32 v97, v97
  v_exp_f32 v98, v98
  v_exp_f32 v99, v99
  v_cvt_pk_bf16_f32 v144, v96, v97
  v_exp_f32 v100, v100
  v_mfma_f32_32x32x16_bf16 v[160:175], v[48:51], v[128:131], v[160:175]
  ds_read_b64_tr_b16 v[56:57], v5 offset:7680
  ds_read_b64_tr_b16 v[58:59], v5 offset:8064
  ds_read_b64_tr_b16 v[60:61], v5 offset:8448
  ds_read_b64_tr_b16 v[62:63], v5 offset:8832
  v_exp_f32 v101, v101
  v_cvt_pk_bf16_f32 v145, v98, v99
  v_exp_f32 v102, v102
  v_exp_f32 v103, v103
  v_cvt_pk_bf16_f32 v146, v100, v101
  v_exp_f32 v104, v104
  v_mfma_f32_32x32x16_bf16 v[80:95], v[32:35], v[216:219], 0
  v_exp_f32 v105, v105
  v_cvt_pk_bf16_f32 v147, v102, v103
  v_exp_f32 v106, v106
  v_exp_f32 v107, v107
  v_cvt_pk_bf16_f32 v148, v104, v105
  v_exp_f32 v108, v108
  v_mfma_f32_32x32x16_bf16 v[176:191], v[48:51], v[136:139], v[176:191]
  v_exp_f32 v109, v109
  v_cvt_pk_bf16_f32 v149, v106, v107
  v_exp_f32 v110, v110
  v_exp_f32 v111, v111
  v_cvt_pk_bf16_f32 v150, v108, v109
  v_exp_f32 v112, v112
  v_mfma_f32_32x32x16_bf16 v[64:79], v[36:39], v[212:215], v[64:79]
  v_exp_f32 v113, v113
  v_cvt_pk_bf16_f32 v151, v110, v111
  v_exp_f32 v114, v114
  v_exp_f32 v115, v115
  v_cvt_pk_bf16_f32 v152, v112, v113
  v_exp_f32 v116, v116
  v_mfma_f32_32x32x16_bf16 v[160:175], v[52:55], v[132:135], v[160:175]
  v_exp_f32 v117, v117
  v_cvt_pk_bf16_f32 v153, v114, v115
  v_exp_f32 v118, v118
  v_exp_f32 v119, v119
  v_cvt_pk_bf16_f32 v154, v116, v117
  v_exp_f32 v120, v120
  v_mfma_f32_32x32x16_bf16 v[80:95], v[36:39], v[220:223], v[80:95]
  ds_read_b128 v[40:43], v3 offset:10752
  ds_read_b128 v[44:47], v4 offset:10752
  v_exp_f32 v121, v121
  v_cvt_pk_bf16_f32 v155, v118, v119
  v_exp_f32 v122, v122
  v_exp_f32 v123, v123
  v_cvt_pk_bf16_f32 v156, v120, v121
  v_exp_f32 v124, v124
  v_mfma_f32_32x32x16_bf16 v[176:191], v[52:55], v[140:143], v[176:191]
  v_exp_f32 v125, v125
  v_cvt_pk_bf16_f32 v157, v122, v123
  v_exp_f32 v126, v126
  v_exp_f32 v127, v127
  v_cvt_pk_bf16_f32 v158, v124, v125
  v_cvt_pk_bf16_f32 v159, v126, v127
  s_waitcnt lgkmcnt(0)
  v_mfma_f32_32x32x16_bf16 v[96:111], v[40:43], v[208:211], 0
  v_exp_f32 v64, v64
  v_exp_f32 v65, v65
  v_exp_f32 v66, v66
  v_exp_f32 v67, v67
  v_cvt_pk_bf16_f32 v128, v64, v65
  v_exp_f32 v68, v68
  v_mfma_f32_32x32x16_bf16 v[160:175], v[56:59], v[144:147], v[160:175]
  ds_read_b64_tr_b16 v[48:49], v5 offset:9216
  ds_read_b64_tr_b16 v[50:51], v5 offset:9600
  ds_read_b64_tr_b16 v[52:53], v5 offset:9984
  ds_read_b64_tr_b16 v[54:55], v5 offset:10368
  v_exp_f32 v69, v69
  v_cvt_pk_bf16_f32 v129, v66, v67
  v_exp_f32 v70, v70
  v_exp_f32 v71, v71
  v_cvt_pk_bf16_f32 v130, v68, v69
  v_exp_f32 v72, v72
  v_mfma_f32_32x32x16_bf16 v[112:127], v[40:43], v[216:219], 0
  v_exp_f32 v73, v73
  v_cvt_pk_bf16_f32 v131, v70, v71
  v_exp_f32 v74, v74
  v_exp_f32 v75, v75
  v_cvt_pk_bf16_f32 v132, v72, v73
  v_exp_f32 v76, v76
  v_mfma_f32_32x32x16_bf16 v[176:191], v[56:59], v[152:155], v[176:191]
  v_exp_f32 v77, v77
  v_cvt_pk_bf16_f32 v133, v74, v75
  v_exp_f32 v78, v78
  v_exp_f32 v79, v79
  v_cvt_pk_bf16_f32 v134, v76, v77
  v_exp_f32 v80, v80
  v_mfma_f32_32x32x16_bf16 v[96:111], v[44:47], v[212:215], v[96:111]
  v_exp_f32 v81, v81
  v_cvt_pk_bf16_f32 v135, v78, v79
  v_exp_f32 v82, v82
  v_exp_f32 v83, v83
  v_cvt_pk_bf16_f32 v136, v80, v81
  v_exp_f32 v84, v84
  v_mfma_f32_32x32x16_bf16 v[160:175], v[60:63], v[148:151], v[160:175]
  v_exp_f32 v85, v85
  v_cvt_pk_bf16_f32 v137, v82, v83
  v_exp_f32 v86, v86
  v_exp_f32 v87, v87
  v_cvt_pk_bf16_f32 v138, v84, v85
  v_exp_f32 v88, v88
  v_mfma_f32_32x32x16_bf16 v[112:127], v[44:47], v[220:223], v[112:127]
  s_waitcnt vmcnt(0)
  s_barrier
  s_cmp_ge_u32 s66, 6
  s_cbranch_scc1 b2nd_14184
  s_add_u32 m0, s67, s72
  s_add_u32 s58, s65, s72
  buffer_load_dwordx4 v2, s[48:51], s58 offen offset:0 sc1 lds
  buffer_load_dwordx4 v2, s[48:51], s58 offen offset:1024 sc1 lds
  buffer_load_dwordx4 v2, s[48:51], s58 offen offset:2048 sc1 lds
  s_add_u32 m0, m0, 12288
  s_add_u32 s58, s58, 3145728
  buffer_load_dwordx4 v2, s[48:51], s58 offen offset:0 sc1 lds
  buffer_load_dwordx4 v2, s[48:51], s58 offen offset:1024 sc1 lds
  buffer_load_dwordx4 v2, s[48:51], s58 offen offset:2048 sc1 lds
  s_add_u32 s65, s65, 12288
b2nd_14184:
  s_add_u32 s67, s67, 24576
  s_cmp_eq_u32 s67, 73728
  s_cselect_b32 s67, 0, s67
  s_add_u32 s68, s68, 24576
  s_cmp_eq_u32 s68, 73728
  s_mov_b32 s59, 24576
  s_cselect_b32 s58, 0xffff4000, s59
  s_cselect_b32 s68, 0, s68
  v_add_u32 v3, s58, v3
  v_add_u32 v4, s58, v4
  s_mov_b32 s59, s58
  ds_read_b128 v[32:35], v3 offset:0
  ds_read_b128 v[36:39], v4 offset:0
  v_exp_f32 v89, v89
  v_cvt_pk_bf16_f32 v139, v86, v87
  v_exp_f32 v90, v90
  v_exp_f32 v91, v91
  v_cvt_pk_bf16_f32 v140, v88, v89
  v_exp_f32 v92, v92
  v_mfma_f32_32x32x16_bf16 v[176:191], v[60:63], v[156:159], v[176:191]
  v_exp_f32 v93, v93
  v_cvt_pk_bf16_f32 v141, v90, v91
  v_exp_f32 v94, v94
  v_exp_f32 v95, v95
  v_cvt_pk_bf16_f32 v142, v92, v93
  v_cvt_pk_bf16_f32 v143, v94, v95
  s_waitcnt lgkmcnt(0)
  v_mfma_f32_32x32x16_bf16 v[64:79], v[32:35], v[208:211], 0
  v_exp_f32 v96, v96
  v_exp_f32 v97, v97
  v_exp_f32 v98, v98
  v_exp_f32 v99, v99
  v_cvt_pk_bf16_f32 v144, v96, v97
  v_exp_f32 v100, v100
  v_mfma_f32_32x32x16_bf16 v[160:175], v[48:51], v[128:131], v[160:175]
  ds_read_b64_tr_b16 v[56:57], v5 offset:10752
  ds_read_b64_tr_b16 v[58:59], v5 offset:11136
  ds_read_b64_tr_b16 v[60:61], v5 offset:11520
  ds_read_b64_tr_b16 v[62:63], v5 offset:11904
  v_exp_f32 v101, v101
  v_cvt_pk_bf16_f32 v145, v98, v99
  v_exp_f32 v102, v102
  v_exp_f32 v103, v103
  v_cvt_pk_bf16_f32 v146, v100, v101
  v_exp_f32 v104, v104
  v_mfma_f32_32x32x16_bf16 v[80:95], v[32:35], v[216:219], 0
  v_exp_f32 v105, v105
  v_cvt_pk_bf16_f32 v147, v102, v103
  v_exp_f32 v106, v106
  v_exp_f32 v107, v107
  v_cvt_pk_bf16_f32 v148, v104, v105
  v_exp_f32 v108, v108
  v_mfma_f32_32x32x16_bf16 v[176:191], v[48:51], v[136:139], v[176:191]
  v_exp_f32 v109, v109
  v_cvt_pk_bf16_f32 v149, v106, v107
  v_exp_f32 v110, v110
  v_exp_f32 v111, v111
  v_cvt_pk_bf16_f32 v150, v108, v109
  v_exp_f32 v112, v112
  v_mfma_f32_32x32x16_bf16 v[64:79], v[36:39], v[212:215], v[64:79]
  v_exp_f32 v113, v113
  v_cvt_pk_bf16_f32 v151, v110, v111
  v_exp_f32 v114, v114
  v_exp_f32 v115, v115
  v_cvt_pk_bf16_f32 v152, v112, v113
  v_exp_f32 v116, v116
  v_mfma_f32_32x32x16_bf16 v[160:175], v[52:55], v[132:135], v[160:175]
  v_exp_f32 v117, v117
  v_cvt_pk_bf16_f32 v153, v114, v115
  v_exp_f32 v118, v118
  v_exp_f32 v119, v119
  v_cvt_pk_bf16_f32 v154, v116, v117
  v_exp_f32 v120, v120
  v_mfma_f32_32x32x16_bf16 v[80:95], v[36:39], v[220:223], v[80:95]
  ds_read_b128 v[40:43], v3 offset:1536
  ds_read_b128 v[44:47], v4 offset:1536
  v_exp_f32 v121, v121
  v_cvt_pk_bf16_f32 v155, v118, v119
  v_exp_f32 v122, v122
  v_exp_f32 v123, v123
  v_cvt_pk_bf16_f32 v156, v120, v121
  v_exp_f32 v124, v124
  v_mfma_f32_32x32x16_bf16 v[176:191], v[52:55], v[140:143], v[176:191]
  v_exp_f32 v125, v125
  v_cvt_pk_bf16_f32 v157, v122, v123
  v_exp_f32 v126, v126
  v_exp_f32 v127, v127
  v_cvt_pk_bf16_f32 v158, v124, v125
  v_cvt_pk_bf16_f32 v159, v126, v127
  v_add_u32 v5, s59, v5
  s_add_u32 s66, s66, 1
  s_cmp_lt_u32 s66, 8
  s_cbranch_scc1 L_b2_bi_m
  s_waitcnt lgkmcnt(0)
  s_nop 1
  v_mfma_f32_32x32x16_bf16 v[160:175], v[56:59], v[144:147], v[160:175]
  v_mfma_f32_32x32x16_bf16 v[160:175], v[60:63], v[148:151], v[160:175]
  v_mfma_f32_32x32x16_bf16 v[176:191], v[56:59], v[152:155], v[176:191]
  v_mfma_f32_32x32x16_bf16 v[176:191], v[60:63], v[156:159], v[176:191]
  v_subrev_u32 v3, s68, v3
  v_subrev_u32 v4, s68, v4
  v_subrev_u32 v5, s68, v5
  s_mov_b32 s68, 0
  s_nop 7
  s_nop 1
  v_mov_b32 v18, 0x1f800000
  v_mov_b32 v19, 0x71800000
  v_cmp_nle_f32 vcc, v18, v168
  s_mov_b64 s[58:59], vcc
  v_cmp_nle_f32 vcc, v18, v184
  s_or_b64 s[58:59], s[58:59], vcc
  v_cmp_nge_f32 vcc, v19, v168
  s_or_b64 s[58:59], s[58:59], vcc
  v_cmp_nge_f32 vcc, v19, v184
  s_or_b64 s[58:59], s[58:59], vcc
  s_cmp_lg_u32 s59, 0
  s_cselect_b32 s58, 1, 0
  v_mov_b32 v18, 73732
  v_mov_b32 v19, s58
  ds_max_u32 v18, v19
  s_waitcnt lgkmcnt(0)
  s_barrier
  ds_read_b32 v19, v18
  s_waitcnt lgkmcnt(0)
  v_readfirstlane_b32 s58, v19
  s_barrier
  v_mov_b32 v19, 0
  ds_write_b32 v18, v19
  s_cmp_lg_u32 s58, 0
  s_cbranch_scc1 L_b2fb_bi
L_b2st_bi:
  v_mov_b32 v18, v168
  v_mov_b32 v19, v168
  s_nop 1
  v_permlane32_swap_b32 v18, v19
  s_nop 0
  v_rcp_f32 v18, v19
  s_nop 0
  v_mul_f32 v160, v160, v18
  v_mul_f32 v161, v161, v18
  v_mul_f32 v162, v162, v18
  v_mul_f32 v163, v163, v18
  v_mul_f32 v164, v164, v18
  v_mul_f32 v165, v165, v18
  v_mul_f32 v166, v166, v18
  v_mul_f32 v167, v167, v18
  v_mul_f32 v168, v168, v18
  v_mul_f32 v169, v169, v18
  v_mul_f32 v170, v170, v18
  v_mul_f32 v171, v171, v18
  v_cvt_pk_bf16_f32 v160, v160, v161
  v_cvt_pk_bf16_f32 v161, v162, v163
  v_cvt_pk_bf16_f32 v164, v164, v165
  v_cvt_pk_bf16_f32 v165, v166, v167
  v_cvt_pk_bf16_f32 v168, v168, v169
  v_cvt_pk_bf16_f32 v169, v170, v171
  s_add_u32 s58, s71, 0
  buffer_store_dwordx2 v[160:161], v7, s[48:51], s58 offen offset:0 sc1
  buffer_store_dwordx2 v[164:165], v7, s[48:51], s58 offen offset:16 sc1
  s_mov_b32 exec_hi, 0
  buffer_store_dwordx2 v[168:169], v7, s[48:51], s58 offen offset:32 sc1
  s_mov_b64 exec, -1
  v_mov_b32 v18, v184
  v_mov_b32 v19, v184
  s_nop 1
  v_permlane32_swap_b32 v18, v19
  s_nop 0
  v_rcp_f32 v18, v19
  s_nop 0
  v_mul_f32 v176, v176, v18
  v_mul_f32 v177, v177, v18
  v_mul_f32 v178, v178, v18
  v_mul_f32 v179, v179, v18
  v_mul_f32 v180, v180, v18
  v_mul_f32 v181, v181, v18
  v_mul_f32 v182, v182, v18
  v_mul_f32 v183, v183, v18
  v_mul_f32 v184, v184, v18
  v_mul_f32 v185, v185, v18
  v_mul_f32 v186, v186, v18
  v_mul_f32 v187, v187, v18
  v_cvt_pk_bf16_f32 v176, v176, v177
  v_cvt_pk_bf16_f32 v177, v178, v179
  v_cvt_pk_bf16_f32 v180, v180, v181
  v_cvt_pk_bf16_f32 v181, v182, v183
  v_cvt_pk_bf16_f32 v184, v184, v185
  v_cvt_pk_bf16_f32 v185, v186, v187
  s_add_u32 s58, s71, 40960
  buffer_store_dwordx2 v[176:177], v7, s[48:51], s58 offen offset:0 sc1
  buffer_store_dwordx2 v[180:181], v7, s[48:51], s58 offen offset:16 sc1
  s_mov_b32 exec_hi, 0
  buffer_store_dwordx2 v[184:185], v7, s[48:51], s58 offen offset:32 sc1
  s_mov_b64 exec, -1
  s_add_u32 s63, s63, 1
  s_sub_u32 s64, s64, 1
  s_cmp_lg_u32 s64, 0
  s_cbranch_scc1 L_b2_bi
  s_branch L_b2_bi_end
L_b2fb_bi:
  v_mov_b32 v214, 0
  v_mov_b32 v8, 0xff7fffff
  v_mov_b32 v222, 0
  v_mov_b32 v9, 0xff7fffff
  v_mov_b32 v160, 0
  v_mov_b32 v161, 0
  v_mov_b32 v162, 0
  v_mov_b32 v163, 0
  v_mov_b32 v164, 0
  v_mov_b32 v165, 0
  v_mov_b32 v166, 0
  v_mov_b32 v167, 0
  v_mov_b32 v168, 0
  v_mov_b32 v169, 0
  v_mov_b32 v170, 0
  v_mov_b32 v171, 0
  v_mov_b32 v172, 0
  v_mov_b32 v173, 0
  v_mov_b32 v174, 0
  v_mov_b32 v175, 0
  v_mov_b32 v176, 0
  v_mov_b32 v177, 0
  v_mov_b32 v178, 0
  v_mov_b32 v179, 0
  v_mov_b32 v180, 0
  v_mov_b32 v181, 0
  v_mov_b32 v182, 0
  v_mov_b32 v183, 0
  v_mov_b32 v184, 0
  v_mov_b32 v185, 0
  v_mov_b32 v186, 0
  v_mov_b32 v187, 0
  v_mov_b32 v188, 0
  v_mov_b32 v189, 0
  v_mov_b32 v190, 0
  v_mov_b32 v191, 0
  s_mul_i32 s65, s62, 98304
  s_add_u32 s65, s65, 0x7900000
  s_mov_b32 s66, 0
  s_mov_b32 s67, 0
L_b2fb_bi_c0:
  s_waitcnt lgkmcnt(0)
  s_barrier
  s_add_u32 m0, s67, s72
  s_add_u32 s58, s65, s72
  buffer_load_dwordx4 v2, s[48:51], s58 offen offset:0 sc1 lds
  buffer_load_dwordx4 v2, s[48:51], s58 offen offset:1024 sc1 lds
  buffer_load_dwordx4 v2, s[48:51], s58 offen offset:2048 sc1 lds
  s_add_u32 m0, m0, 12288
  s_add_u32 s58, s58, 3145728
  buffer_load_dwordx4 v2, s[48:51], s58 offen offset:0 sc1 lds
  buffer_load_dwordx4 v2, s[48:51], s58 offen offset:1024 sc1 lds
  buffer_load_dwordx4 v2, s[48:51], s58 offen offset:2048 sc1 lds
  s_add_u32 s65, s65, 12288
  s_waitcnt vmcnt(0)
  s_barrier
  v_mov_b32 v192, v3
  v_mov_b32 v193, v4
  v_mov_b32 v194, v5
  s_mov_b32 s60, 0
L_b2fb_bi_t0:
  ds_read_b128 v[32:35], v192
  ds_read_b128 v[36:39], v193
  s_waitcnt lgkmcnt(0)
  v_mfma_f32_32x32x16_bf16 v[64:79], v[32:35], v[208:211], 0
  v_mfma_f32_32x32x16_bf16 v[64:79], v[36:39], v[212:215], v[64:79]
  v_mfma_f32_32x32x16_bf16 v[80:95], v[32:35], v[216:219], 0
  v_mfma_f32_32x32x16_bf16 v[80:95], v[36:39], v[220:223], v[80:95]
  s_nop 7
  s_nop 7
  v_max3_f32 v8, v8, v64, v65
  v_max3_f32 v8, v8, v66, v67
  v_max3_f32 v8, v8, v68, v69
  v_max3_f32 v8, v8, v70, v71
  v_max3_f32 v8, v8, v72, v73
  v_max3_f32 v8, v8, v74, v75
  v_max3_f32 v8, v8, v76, v77
  v_max3_f32 v8, v8, v78, v79
  v_max3_f32 v9, v9, v80, v81
  v_max3_f32 v9, v9, v82, v83
  v_max3_f32 v9, v9, v84, v85
  v_max3_f32 v9, v9, v86, v87
  v_max3_f32 v9, v9, v88, v89
  v_max3_f32 v9, v9, v90, v91
  v_max3_f32 v9, v9, v92, v93
  v_max3_f32 v9, v9, v94, v95
  v_add_u32 v192, 1536, v192
  v_add_u32 v193, 1536, v193
  v_add_u32 v194, 1536, v194
  s_add_u32 s60, s60, 1
  s_cmp_lt_u32 s60, 8
  s_cbranch_scc1 L_b2fb_bi_t0
  s_add_u32 s66, s66, 1
  s_cmp_lt_u32 s66, 8
  s_cbranch_scc1 L_b2fb_bi_c0
  v_mov_b32 v18, v8
  s_nop 1
  v_permlane32_swap_b32 v8, v18
  s_nop 0
  v_max_f32 v8, v8, v18
  v_mov_b32 v18, v9
  s_nop 1
  v_permlane32_swap_b32 v9, v18
  s_nop 0
  v_max_f32 v9, v9, v18
  s_mul_i32 s65, s62, 98304
  s_add_u32 s65, s65, 0x7900000
  s_mov_b32 s66, 0
  s_mov_b32 s67, 0
L_b2fb_bi_c1:
  s_waitcnt lgkmcnt(0)
  s_barrier
  s_add_u32 m0, s67, s72
  s_add_u32 s58, s65, s72
  buffer_load_dwordx4 v2, s[48:51], s58 offen offset:0 sc1 lds
  buffer_load_dwordx4 v2, s[48:51], s58 offen offset:1024 sc1 lds
  buffer_load_dwordx4 v2, s[48:51], s58 offen offset:2048 sc1 lds
  s_add_u32 m0, m0, 12288
  s_add_u32 s58, s58, 3145728
  buffer_load_dwordx4 v2, s[48:51], s58 offen offset:0 sc1 lds
  buffer_load_dwordx4 v2, s[48:51], s58 offen offset:1024 sc1 lds
  buffer_load_dwordx4 v2, s[48:51], s58 offen offset:2048 sc1 lds
  s_add_u32 s65, s65, 12288
  s_waitcnt vmcnt(0)
  s_barrier
  v_mov_b32 v192, v3
  v_mov_b32 v193, v4
  v_mov_b32 v194, v5
  s_mov_b32 s60, 0
L_b2fb_bi_t1:
  ds_read_b128 v[32:35], v192
  ds_read_b128 v[36:39], v193
  ds_read_b64_tr_b16 v[48:49], v194 offset:0
  ds_read_b64_tr_b16 v[50:51], v194 offset:384
  ds_read_b64_tr_b16 v[52:53], v194 offset:768
  ds_read_b64_tr_b16 v[54:55], v194 offset:1152
  s_waitcnt lgkmcnt(0)
  v_mfma_f32_32x32x16_bf16 v[64:79], v[32:35], v[208:211], 0
  v_mfma_f32_32x32x16_bf16 v[64:79], v[36:39], v[212:215], v[64:79]
  v_mfma_f32_32x32x16_bf16 v[80:95], v[32:35], v[216:219], 0
  v_mfma_f32_32x32x16_bf16 v[80:95], v[36:39], v[220:223], v[80:95]
  s_nop 7
  s_nop 7
  v_sub_f32 v64, v64, v8
  v_sub_f32 v65, v65, v8
  v_sub_f32 v66, v66, v8
  v_sub_f32 v67, v67, v8
  v_sub_f32 v68, v68, v8
  v_sub_f32 v69, v69, v8
  v_sub_f32 v70, v70, v8
  v_sub_f32 v71, v71, v8
  v_sub_f32 v72, v72, v8
  v_sub_f32 v73, v73, v8
  v_sub_f32 v74, v74, v8
  v_sub_f32 v75, v75, v8
  v_sub_f32 v76, v76, v8
  v_sub_f32 v77, v77, v8
  v_sub_f32 v78, v78, v8
  v_sub_f32 v79, v79, v8
  v_exp_f32 v64, v64
  v_exp_f32 v65, v65
  v_exp_f32 v66, v66
  v_exp_f32 v67, v67
  v_exp_f32 v68, v68
  v_exp_f32 v69, v69
  v_exp_f32 v70, v70
  v_exp_f32 v71, v71
  v_exp_f32 v72, v72
  v_exp_f32 v73, v73
  v_exp_f32 v74, v74
  v_exp_f32 v75, v75
  v_exp_f32 v76, v76
  v_exp_f32 v77, v77
  v_exp_f32 v78, v78
  v_exp_f32 v79, v79
  s_nop 0
  v_cvt_pk_bf16_f32 v128, v64, v65
  v_cvt_pk_bf16_f32 v129, v66, v67
  v_cvt_pk_bf16_f32 v130, v68, v69
  v_cvt_pk_bf16_f32 v131, v70, v71
  v_cvt_pk_bf16_f32 v132, v72, v73
  v_cvt_pk_bf16_f32 v133, v74, v75
  v_cvt_pk_bf16_f32 v134, v76, v77
  v_cvt_pk_bf16_f32 v135, v78, v79
  v_sub_f32 v80, v80, v9
  v_sub_f32 v81, v81, v9
  v_sub_f32 v82, v82, v9
  v_sub_f32 v83, v83, v9
  v_sub_f32 v84, v84, v9
  v_sub_f32 v85, v85, v9
  v_sub_f32 v86, v86, v9
  v_sub_f32 v87, v87, v9
  v_sub_f32 v88, v88, v9
  v_sub_f32 v89, v89, v9
  v_sub_f32 v90, v90, v9
  v_sub_f32 v91, v91, v9
  v_sub_f32 v92, v92, v9
  v_sub_f32 v93, v93, v9
  v_sub_f32 v94, v94, v9
  v_sub_f32 v95, v95, v9
  v_exp_f32 v80, v80
  v_exp_f32 v81, v81
  v_exp_f32 v82, v82
  v_exp_f32 v83, v83
  v_exp_f32 v84, v84
  v_exp_f32 v85, v85
  v_exp_f32 v86, v86
  v_exp_f32 v87, v87
  v_exp_f32 v88, v88
  v_exp_f32 v89, v89
  v_exp_f32 v90, v90
  v_exp_f32 v91, v91
  v_exp_f32 v92, v92
  v_exp_f32 v93, v93
  v_exp_f32 v94, v94
  v_exp_f32 v95, v95
  s_nop 0
  v_cvt_pk_bf16_f32 v136, v80, v81
  v_cvt_pk_bf16_f32 v137, v82, v83
  v_cvt_pk_bf16_f32 v138, v84, v85
  v_cvt_pk_bf16_f32 v139, v86, v87
  v_cvt_pk_bf16_f32 v140, v88, v89
  v_cvt_pk_bf16_f32 v141, v90, v91
  v_cvt_pk_bf16_f32 v142, v92, v93
  v_cvt_pk_bf16_f32 v143, v94, v95
  s_nop 1
  v_mfma_f32_32x32x16_bf16 v[160:175], v[48:51], v[128:131], v[160:175]
  v_mfma_f32_32x32x16_bf16 v[160:175], v[52:55], v[132:135], v[160:175]
  v_mfma_f32_32x32x16_bf16 v[176:191], v[48:51], v[136:139], v[176:191]
  v_mfma_f32_32x32x16_bf16 v[176:191], v[52:55], v[140:143], v[176:191]
  v_add_u32 v192, 1536, v192
  v_add_u32 v193, 1536, v193
  v_add_u32 v194, 1536, v194
  s_add_u32 s60, s60, 1
  s_cmp_lt_u32 s60, 8
  s_cbranch_scc1 L_b2fb_bi_t1
  s_add_u32 s66, s66, 1
  s_cmp_lt_u32 s66, 8
  s_cbranch_scc1 L_b2fb_bi_c1
  s_nop 7
  s_nop 7
  s_branch L_b2st_bi
L_b2_bi_end:
  s_waitcnt vmcnt(0) lgkmcnt(0)
  s_barrier
  s_cmp_lg_u32 s52, 0
  s_cbranch_scc1 cnt_14185
  v_mov_b32 v19, 32896
  v_mov_b32 v18, 1
  s_mov_b64 exec, 1
  buffer_atomic_add v18, v19, s[48:51], 0 offen sc1
  s_mov_b64 exec, -1
cnt_14185:
  s_waitcnt vmcnt(0)
  s_lshl_b32 s61, s53, 4
  s_add_u32 s61, s61, s54
  s_and_b32 s58, s61, 3
  s_mul_i32 s78, s58, 192
  s_min_u32 s78, s78, 448
  s_lshr_b32 s62, s61, 2
  s_lshl_b32 s62, s62, 2
  s_add_u32 s63, s62, 4
  v_and_b32 v1, 63, v0
  s_mul_i32 s58, s52, 640
  s_add_u32 s59, s58, 0
  v_add_u32 v18, s59, v1
  v_mul_u32_u24 v19, 3277, v18
  v_lshrrev_b32 v19, 18, v19
  v_mul_u32_u24 v20, 80, v19
  v_sub_u32 v18, v18, v20
  v_and_b32 v20, 15, v19
  v_xor_b32 v18, v18, v20
  v_lshlrev_b32 v18, 4, v18
  v_mul_u32_u24 v19, 1280, v19
  v_add_u32 v92, v18, v19
  s_add_u32 s59, s58, 64
  v_add_u32 v18, s59, v1
  v_mul_u32_u24 v19, 3277, v18
  v_lshrrev_b32 v19, 18, v19
  v_mul_u32_u24 v20, 80, v19
  v_sub_u32 v18, v18, v20
  v_and_b32 v20, 15, v19
  v_xor_b32 v18, v18, v20
  v_lshlrev_b32 v18, 4, v18
  v_mul_u32_u24 v19, 1280, v19
  v_add_u32 v93, v18, v19
  s_add_u32 s59, s58, 128
  v_add_u32 v18, s59, v1
  v_mul_u32_u24 v19, 3277, v18
  v_lshrrev_b32 v19, 18, v19
  v_mul_u32_u24 v20, 80, v19
  v_sub_u32 v18, v18, v20
  v_and_b32 v20, 15, v19
  v_xor_b32 v18, v18, v20
  v_lshlrev_b32 v18, 4, v18
  v_mul_u32_u24 v19, 1280, v19
  v_add_u32 v94, v18, v19
  s_add_u32 s59, s58, 192
  v_add_u32 v18, s59, v1
  v_mul_u32_u24 v19, 3277, v18
  v_lshrrev_b32 v19, 18, v19
  v_mul_u32_u24 v20, 80, v19
  v_sub_u32 v18, v18, v20
  v_and_b32 v20, 15, v19
  v_xor_b32 v18, v18, v20
  v_lshlrev_b32 v18, 4, v18
  v_mul_u32_u24 v19, 1280, v19
  v_add_u32 v95, v18, v19
  s_add_u32 s59, s58, 256
  v_add_u32 v18, s59, v1
  v_mul_u32_u24 v19, 3277, v18
  v_lshrrev_b32 v19, 18, v19
  v_mul_u32_u24 v20, 80, v19
  v_sub_u32 v18, v18, v20
  v_and_b32 v20, 15, v19
  v_xor_b32 v18, v18, v20
  v_lshlrev_b32 v18, 4, v18
  v_mul_u32_u24 v19, 1280, v19
  v_add_u32 v96, v18, v19
  s_add_u32 s59, s58, 320
  v_add_u32 v18, s59, v1
  v_mul_u32_u24 v19, 3277, v18
  v_lshrrev_b32 v19, 18, v19
  v_mul_u32_u24 v20, 80, v19
  v_sub_u32 v18, v18, v20
  v_and_b32 v20, 15, v19
  v_xor_b32 v18, v18, v20
  v_lshlrev_b32 v18, 4, v18
  v_mul_u32_u24 v19, 1280, v19
  v_add_u32 v97, v18, v19
  s_add_u32 s59, s58, 384
  v_add_u32 v18, s59, v1
  v_mul_u32_u24 v19, 3277, v18
  v_lshrrev_b32 v19, 18, v19
  v_mul_u32_u24 v20, 80, v19
  v_sub_u32 v18, v18, v20
  v_and_b32 v20, 15, v19
  v_xor_b32 v18, v18, v20
  v_lshlrev_b32 v18, 4, v18
  v_mul_u32_u24 v19, 1280, v19
  v_add_u32 v98, v18, v19
  s_add_u32 s59, s58, 448
  v_add_u32 v18, s59, v1
  v_mul_u32_u24 v19, 3277, v18
  v_lshrrev_b32 v19, 18, v19
  v_mul_u32_u24 v20, 80, v19
  v_sub_u32 v18, v18, v20
  v_and_b32 v20, 15, v19
  v_xor_b32 v18, v18, v20
  v_lshlrev_b32 v18, 4, v18
  v_mul_u32_u24 v19, 1280, v19
  v_add_u32 v99, v18, v19
  s_add_u32 s59, s58, 512
  v_add_u32 v18, s59, v1
  v_mul_u32_u24 v19, 3277, v18
  v_lshrrev_b32 v19, 18, v19
  v_mul_u32_u24 v20, 80, v19
  v_sub_u32 v18, v18, v20
  v_and_b32 v20, 15, v19
  v_xor_b32 v18, v18, v20
  v_lshlrev_b32 v18, 4, v18
  v_mul_u32_u24 v19, 1280, v19
  v_add_u32 v100, v18, v19
  s_add_u32 s59, s58, 576
  v_add_u32 v18, s59, v1
  v_mul_u32_u24 v19, 3277, v18
  v_lshrrev_b32 v19, 18, v19
  v_mul_u32_u24 v20, 80, v19
  v_sub_u32 v18, v18, v20
  v_and_b32 v20, 15, v19
  v_xor_b32 v18, v18, v20
  v_lshlrev_b32 v18, 4, v18
  v_mul_u32_u24 v19, 1280, v19
  v_add_u32 v101, v18, v19
  v_and_b32 v18, 15, v1
  v_lshrrev_b32 v19, 4, v1
  v_xor_b32 v19, v19, v18
  v_mul_u32_u24 v18, 1280, v18
  v_add_u32 v18, 0x1e000, v18
  v_xor_b32 v20, 0, v19
  v_lshlrev_b32 v20, 4, v20
  v_add_u32 v102, v18, v20
  v_xor_b32 v20, 4, v19
  v_lshlrev_b32 v20, 4, v20
  v_add_u32 v103, v18, v20
  v_xor_b32 v20, 8, v19
  v_lshlrev_b32 v20, 4, v20
  v_add_u32 v104, v18, v20
  v_xor_b32 v20, 12, v19
  v_lshlrev_b32 v20, 4, v20
  v_add_u32 v105, v18, v20
  v_lshrrev_b32 v18, 4, v1
  v_lshrrev_b32 v19, 2, v1
  v_and_b32 v19, 3, v19
  v_lshlrev_b32 v20, 3, v18
  v_add_u32 v20, v20, v19
  v_mul_u32_u24 v20, 384, v20
  v_and_b32 v21, 3, v1
  v_lshlrev_b32 v21, 3, v21
  v_add_u32 v20, v20, v21
  v_lshrrev_b32 v19, 1, v19
  v_and_b32 v18, 1, v18
  v_lshlrev_b32 v18, 1, v18
  v_or_b32 v18, v18, v19
  s_mul_i32 s58, s52, 3
  s_add_u32 s59, s58, 0
  v_xor_b32 v19, s59, v18
  v_lshlrev_b32 v19, 5, v19
  v_add_u32 v26, v19, v20
  s_add_u32 s59, s58, 1
  v_xor_b32 v19, s59, v18
  v_lshlrev_b32 v19, 5, v19
  v_add_u32 v27, v19, v20
  s_add_u32 s59, s58, 2
  v_xor_b32 v19, s59, v18
  v_lshlrev_b32 v19, 5, v19
  v_add_u32 v28, v19, v20
  s_lshl_b32 s67, s78, 1
  s_mul_i32 s64, s62, 40960
  s_add_u32 s64, s64, 0x7f00000
  s_mul_i32 s65, s52, 10240
  s_add_u32 s65, s65, 122880
  v_mov_b32 v18, v0
  v_mul_u32_u24 v19, 2731, v18
  v_lshrrev_b32 v19, 16, v19
  v_mul_u32_u24 v20, 24, v19
  v_sub_u32 v18, v18, v20
  v_and_b32 v20, 2, v19
  v_lshrrev_b32 v21, 1, v19
  v_and_b32 v21, 4, v21
  v_or_b32 v20, v20, v21
  v_xor_b32 v18, v18, v20
  v_mul_u32_u24 v19, 1280, v19
  v_lshlrev_b32 v18, 4, v18
  v_add_u32 v2, v18, v19
  v_add_u32 v18, 256, v0
  v_mul_u32_u24 v19, 2731, v18
  v_lshrrev_b32 v19, 16, v19
  v_mul_u32_u24 v20, 24, v19
  v_sub_u32 v18, v18, v20
  v_and_b32 v20, 2, v19
  v_lshrrev_b32 v21, 1, v19
  v_and_b32 v21, 4, v21
  v_or_b32 v20, v20, v21
  v_xor_b32 v18, v18, v20
  v_mul_u32_u24 v19, 1280, v19
  v_lshlrev_b32 v18, 4, v18
  v_add_u32 v3, v18, v19
  v_add_u32 v18, 512, v0
  v_mul_u32_u24 v19, 2731, v18
  v_lshrrev_b32 v19, 16, v19
  v_mul_u32_u24 v20, 24, v19
  v_sub_u32 v18, v18, v20
  v_and_b32 v20, 2, v19
  v_lshrrev_b32 v21, 1, v19
  v_and_b32 v21, 4, v21
  v_or_b32 v20, v20, v21
  v_xor_b32 v18, v18, v20
  v_mul_u32_u24 v19, 1280, v19
  v_lshlrev_b32 v18, 4, v18
  v_add_u32 v4, v18, v19
  v_add_u32 v18, 768, v0
  v_mul_u32_u24 v19, 2731, v18
  v_lshrrev_b32 v19, 16, v19
  v_mul_u32_u24 v20, 24, v19
  v_sub_u32 v18, v18, v20
  v_and_b32 v20, 2, v19
  v_lshrrev_b32 v21, 1, v19
  v_and_b32 v21, 4, v21
  v_or_b32 v20, v20, v21
  v_xor_b32 v18, v18, v20
  v_mul_u32_u24 v19, 1280, v19
  v_lshlrev_b32 v18, 4, v18
  v_add_u32 v5, v18, v19
  v_add_u32 v18, 1024, v0
  v_mul_u32_u24 v19, 2731, v18
  v_lshrrev_b32 v19, 16, v19
  v_mul_u32_u24 v20, 24, v19
  v_sub_u32 v18, v18, v20
  v_and_b32 v20, 2, v19
  v_lshrrev_b32 v21, 1, v19
  v_and_b32 v21, 4, v21
  v_or_b32 v20, v20, v21
  v_xor_b32 v18, v18, v20
  v_mul_u32_u24 v19, 1280, v19
  v_lshlrev_b32 v18, 4, v18
  v_add_u32 v6, v18, v19
  v_add_u32 v18, 1280, v0
  v_mul_u32_u24 v19, 2731, v18
  v_lshrrev_b32 v19, 16, v19
  v_mul_u32_u24 v20, 24, v19
  v_sub_u32 v18, v18, v20
  v_and_b32 v20, 2, v19
  v_lshrrev_b32 v21, 1, v19
  v_and_b32 v21, 4, v21
  v_or_b32 v20, v20, v21
  v_xor_b32 v18, v18, v20
  v_mul_u32_u24 v19, 1280, v19
  v_lshlrev_b32 v18, 4, v18
  v_add_u32 v7, v18, v19
  v_add_u32 v18, 1536, v0
  v_mul_u32_u24 v19, 2731, v18
  v_lshrrev_b32 v19, 16, v19
  v_mul_u32_u24 v20, 24, v19
  v_sub_u32 v18, v18, v20
  v_and_b32 v20, 2, v19
  v_lshrrev_b32 v21, 1, v19
  v_and_b32 v21, 4, v21
  v_or_b32 v20, v20, v21
  v_xor_b32 v18, v18, v20
  v_mul_u32_u24 v19, 1280, v19
  v_lshlrev_b32 v18, 4, v18
  v_add_u32 v8, v18, v19
  v_add_u32 v18, 1792, v0
  v_mul_u32_u24 v19, 2731, v18
  v_lshrrev_b32 v19, 16, v19
  v_mul_u32_u24 v20, 24, v19
  v_sub_u32 v18, v18, v20
  v_and_b32 v20, 2, v19
  v_lshrrev_b32 v21, 1, v19
  v_and_b32 v21, 4, v21
  v_or_b32 v20, v20, v21
  v_xor_b32 v18, v18, v20
  v_mul_u32_u24 v19, 1280, v19
  v_lshlrev_b32 v18, 4, v18
  v_add_u32 v9, v18, v19
  v_add_u32 v18, 2048, v0
  v_mul_u32_u24 v19, 2731, v18
  v_lshrrev_b32 v19, 16, v19
  v_mul_u32_u24 v20, 24, v19
  v_sub_u32 v18, v18, v20
  v_and_b32 v20, 2, v19
  v_lshrrev_b32 v21, 1, v19
  v_and_b32 v21, 4, v21
  v_or_b32 v20, v20, v21
  v_xor_b32 v18, v18, v20
  v_mul_u32_u24 v19, 1280, v19
  v_lshlrev_b32 v18, 4, v18
  v_add_u32 v10, v18, v19
  v_add_u32 v18, 2304, v0
  v_mul_u32_u24 v19, 2731, v18
  v_lshrrev_b32 v19, 16, v19
  v_mul_u32_u24 v20, 24, v19
  v_sub_u32 v18, v18, v20
  v_and_b32 v20, 2, v19
  v_lshrrev_b32 v21, 1, v19
  v_and_b32 v21, 4, v21
  v_or_b32 v20, v20, v21
  v_xor_b32 v18, v18, v20
  v_mul_u32_u24 v19, 1280, v19
  v_lshlrev_b32 v18, 4, v18
  v_add_u32 v11, v18, v19
  v_add_u32 v18, 2560, v0
  v_mul_u32_u24 v19, 2731, v18
  v_lshrrev_b32 v19, 16, v19
  v_mul_u32_u24 v20, 24, v19
  v_sub_u32 v18, v18, v20
  v_and_b32 v20, 2, v19
  v_lshrrev_b32 v21, 1, v19
  v_and_b32 v21, 4, v21
  v_or_b32 v20, v20, v21
  v_xor_b32 v18, v18, v20
  v_mul_u32_u24 v19, 1280, v19
  v_lshlrev_b32 v18, 4, v18
  v_add_u32 v12, v18, v19
  v_add_u32 v18, 2816, v0
  v_mul_u32_u24 v19, 2731, v18
  v_lshrrev_b32 v19, 16, v19
  v_mul_u32_u24 v20, 24, v19
  v_sub_u32 v18, v18, v20
  v_and_b32 v20, 2, v19
  v_lshrrev_b32 v21, 1, v19
  v_and_b32 v21, 4, v21
  v_or_b32 v20, v20, v21
  v_xor_b32 v18, v18, v20
  v_mul_u32_u24 v19, 1280, v19
  v_lshlrev_b32 v18, 4, v18
  v_add_u32 v13, v18, v19
  v_add_u32 v18, 3072, v0
  v_mul_u32_u24 v19, 2731, v18
  v_lshrrev_b32 v19, 16, v19
  v_mul_u32_u24 v20, 24, v19
  v_sub_u32 v18, v18, v20
  v_and_b32 v20, 2, v19
  v_lshrrev_b32 v21, 1, v19
  v_and_b32 v21, 4, v21
  v_or_b32 v20, v20, v21
  v_xor_b32 v18, v18, v20
  v_mul_u32_u24 v19, 1280, v19
  v_lshlrev_b32 v18, 4, v18
  v_add_u32 v14, v18, v19
  v_add_u32 v18, 3328, v0
  v_mul_u32_u24 v19, 2731, v18
  v_lshrrev_b32 v19, 16, v19
  v_mul_u32_u24 v20, 24, v19
  v_sub_u32 v18, v18, v20
  v_and_b32 v20, 2, v19
  v_lshrrev_b32 v21, 1, v19
  v_and_b32 v21, 4, v21
  v_or_b32 v20, v20, v21
  v_xor_b32 v18, v18, v20
  v_mul_u32_u24 v19, 1280, v19
  v_lshlrev_b32 v18, 4, v18
  v_add_u32 v15, v18, v19
  v_add_u32 v18, 3584, v0
  v_mul_u32_u24 v19, 2731, v18
  v_lshrrev_b32 v19, 16, v19
  v_mul_u32_u24 v20, 24, v19
  v_sub_u32 v18, v18, v20
  v_and_b32 v20, 2, v19
  v_lshrrev_b32 v21, 1, v19
  v_and_b32 v21, 4, v21
  v_or_b32 v20, v20, v21
  v_xor_b32 v18, v18, v20
  v_mul_u32_u24 v19, 1280, v19
  v_lshlrev_b32 v18, 4, v18
  v_add_u32 v16, v18, v19
  s_mov_b32 s70, s67
  s_lshl_b32 s60, s52, 10
  s_add_u32 s60, s60, 0x0
  s_add_u32 m0, s60, 0
  s_nop 0
  buffer_load_dwordx4 v2, s[36:39], s70 offen lds
  s_add_u32 m0, s60, 4096
  s_nop 0
  buffer_load_dwordx4 v3, s[36:39], s70 offen lds
  s_add_u32 m0, s60, 8192
  s_nop 0
  buffer_load_dwordx4 v4, s[36:39], s70 offen lds
  s_add_u32 m0, s60, 12288
  s_nop 0
  buffer_load_dwordx4 v5, s[36:39], s70 offen lds
  s_add_u32 m0, s60, 16384
  s_nop 0
  buffer_load_dwordx4 v6, s[36:39], s70 offen lds
  s_add_u32 m0, s60, 20480
  s_nop 0
  buffer_load_dwordx4 v7, s[36:39], s70 offen lds
  s_add_u32 m0, s60, 24576
  s_nop 0
  buffer_load_dwordx4 v8, s[36:39], s70 offen lds
  s_add_u32 m0, s60, 28672
  s_nop 0
  buffer_load_dwordx4 v9, s[36:39], s70 offen lds
  s_add_u32 m0, s60, 32768
  s_nop 0
  buffer_load_dwordx4 v10, s[36:39], s70 offen lds
  s_add_u32 m0, s60, 36864
  s_nop 0
  buffer_load_dwordx4 v11, s[36:39], s70 offen lds
  s_add_u32 m0, s60, 40960
  s_nop 0
  buffer_load_dwordx4 v12, s[36:39], s70 offen lds
  s_add_u32 m0, s60, 45056
  s_nop 0
  buffer_load_dwordx4 v13, s[36:39], s70 offen lds
  s_add_u32 m0, s60, 49152
  s_nop 0
  buffer_load_dwordx4 v14, s[36:39], s70 offen lds
  s_add_u32 m0, s60, 53248
  s_nop 0
  buffer_load_dwordx4 v15, s[36:39], s70 offen lds
  s_add_u32 m0, s60, 57344
  s_nop 0
  buffer_load_dwordx4 v16, s[36:39], s70 offen lds
  s_add_u32 s70, s70, 204800
  s_lshl_b32 s60, s52, 10
  s_add_u32 s60, s60, 0xf000
  s_add_u32 m0, s60, 0
  s_nop 0
  buffer_load_dwordx4 v2, s[36:39], s70 offen lds
  s_add_u32 m0, s60, 4096
  s_nop 0
  buffer_load_dwordx4 v3, s[36:39], s70 offen lds
  s_add_u32 m0, s60, 8192
  s_nop 0
  buffer_load_dwordx4 v4, s[36:39], s70 offen lds
  s_add_u32 m0, s60, 12288
  s_nop 0
  buffer_load_dwordx4 v5, s[36:39], s70 offen lds
  s_add_u32 m0, s60, 16384
  s_nop 0
  buffer_load_dwordx4 v6, s[36:39], s70 offen lds
  s_add_u32 m0, s60, 20480
  s_nop 0
  buffer_load_dwordx4 v7, s[36:39], s70 offen lds
  s_add_u32 m0, s60, 24576
  s_nop 0
  buffer_load_dwordx4 v8, s[36:39], s70 offen lds
  s_add_u32 m0, s60, 28672
  s_nop 0
  buffer_load_dwordx4 v9, s[36:39], s70 offen lds
  s_add_u32 m0, s60, 32768
  s_nop 0
  buffer_load_dwordx4 v10, s[36:39], s70 offen lds
  s_add_u32 m0, s60, 36864
  s_nop 0
  buffer_load_dwordx4 v11, s[36:39], s70 offen lds
  s_add_u32 m0, s60, 40960
  s_nop 0
  buffer_load_dwordx4 v12, s[36:39], s70 offen lds
  s_add_u32 m0, s60, 45056
  s_nop 0
  buffer_load_dwordx4 v13, s[36:39], s70 offen lds
  s_add_u32 m0, s60, 49152
  s_nop 0
  buffer_load_dwordx4 v14, s[36:39], s70 offen lds
  s_add_u32 m0, s60, 53248
  s_nop 0
  buffer_load_dwordx4 v15, s[36:39], s70 offen lds
  s_add_u32 m0, s60, 57344
  s_nop 0
  buffer_load_dwordx4 v16, s[36:39], s70 offen lds
  s_waitcnt vmcnt(15)
  s_barrier
  ds_read_b64_tr_b16 a[0:1], v26 offset:0
  ds_read_b64_tr_b16 a[2:3], v26 offset:1536
  ds_read_b64_tr_b16 a[4:5], v26 offset:12288
  ds_read_b64_tr_b16 a[6:7], v26 offset:13824
  ds_read_b64_tr_b16 a[8:9], v26 offset:24576
  ds_read_b64_tr_b16 a[10:11], v26 offset:26112
  s_waitcnt lgkmcnt(4)
  ds_read_b64_tr_b16 a[12:13], v26 offset:36864
  ds_read_b64_tr_b16 a[14:15], v26 offset:38400
  ds_read_b64_tr_b16 a[16:17], v26 offset:49152
  ds_read_b64_tr_b16 a[18:19], v26 offset:50688
  s_waitcnt lgkmcnt(4)
  ds_read_b64_tr_b16 a[80:81], v27 offset:0
  ds_read_b64_tr_b16 a[82:83], v27 offset:1536
  ds_read_b64_tr_b16 a[84:85], v27 offset:12288
  ds_read_b64_tr_b16 a[86:87], v27 offset:13824
  ds_read_b64_tr_b16 a[88:89], v27 offset:24576
  ds_read_b64_tr_b16 a[90:91], v27 offset:26112
  s_waitcnt lgkmcnt(4)
  ds_read_b64_tr_b16 a[92:93], v27 offset:36864
  ds_read_b64_tr_b16 a[94:95], v27 offset:38400
  ds_read_b64_tr_b16 a[96:97], v27 offset:49152
  ds_read_b64_tr_b16 a[98:99], v27 offset:50688
  s_waitcnt lgkmcnt(4)
  ds_read_b64_tr_b16 a[160:161], v28 offset:0
  ds_read_b64_tr_b16 a[162:163], v28 offset:1536
  ds_read_b64_tr_b16 a[164:165], v28 offset:12288
  ds_read_b64_tr_b16 a[166:167], v28 offset:13824
  ds_read_b64_tr_b16 a[168:169], v28 offset:24576
  ds_read_b64_tr_b16 a[170:171], v28 offset:26112
  s_waitcnt lgkmcnt(4)
  ds_read_b64_tr_b16 a[172:173], v28 offset:36864
  ds_read_b64_tr_b16 a[174:175], v28 offset:38400
  ds_read_b64_tr_b16 a[176:177], v28 offset:49152
  ds_read_b64_tr_b16 a[178:179], v28 offset:50688
  s_waitcnt lgkmcnt(4)
  s_waitcnt lgkmcnt(0)
  v_add_u32 v26, 61440, v26
  v_add_u32 v27, 61440, v27
  v_add_u32 v28, 61440, v28
  s_barrier
  s_add_u32 s70, s70, 204800
  s_lshl_b32 s60, s52, 10
  s_add_u32 s60, s60, 0x0
  s_add_u32 m0, s60, 0
  s_nop 0
  buffer_load_dwordx4 v2, s[36:39], s70 offen lds
  s_add_u32 m0, s60, 4096
  s_nop 0
  buffer_load_dwordx4 v3, s[36:39], s70 offen lds
  s_add_u32 m0, s60, 8192
  s_nop 0
  buffer_load_dwordx4 v4, s[36:39], s70 offen lds
  s_add_u32 m0, s60, 12288
  s_nop 0
  buffer_load_dwordx4 v5, s[36:39], s70 offen lds
  s_add_u32 m0, s60, 16384
  s_nop 0
  buffer_load_dwordx4 v6, s[36:39], s70 offen lds
  s_add_u32 m0, s60, 20480
  s_nop 0
  buffer_load_dwordx4 v7, s[36:39], s70 offen lds
  s_add_u32 m0, s60, 24576
  s_nop 0
  buffer_load_dwordx4 v8, s[36:39], s70 offen lds
  s_add_u32 m0, s60, 28672
  s_nop 0
  buffer_load_dwordx4 v9, s[36:39], s70 offen lds
  s_add_u32 m0, s60, 32768
  s_nop 0
  buffer_load_dwordx4 v10, s[36:39], s70 offen lds
  s_add_u32 m0, s60, 36864
  s_nop 0
  buffer_load_dwordx4 v11, s[36:39], s70 offen lds
  s_add_u32 m0, s60, 40960
  s_nop 0
  buffer_load_dwordx4 v12, s[36:39], s70 offen lds
  s_add_u32 m0, s60, 45056
  s_nop 0
  buffer_load_dwordx4 v13, s[36:39], s70 offen lds
  s_add_u32 m0, s60, 49152
  s_nop 0
  buffer_load_dwordx4 v14, s[36:39], s70 offen lds
  s_add_u32 m0, s60, 53248
  s_nop 0
  buffer_load_dwordx4 v15, s[36:39], s70 offen lds
  s_add_u32 m0, s60, 57344
  s_nop 0
  buffer_load_dwordx4 v16, s[36:39], s70 offen lds
  s_waitcnt vmcnt(15)
  s_barrier
  ds_read_b64_tr_b16 a[20:21], v26 offset:0
  ds_read_b64_tr_b16 a[22:23], v26 offset:1536
  ds_read_b64_tr_b16 a[24:25], v26 offset:12288
  ds_read_b64_tr_b16 a[26:27], v26 offset:13824
  ds_read_b64_tr_b16 a[28:29], v26 offset:24576
  ds_read_b64_tr_b16 a[30:31], v26 offset:26112
  s_waitcnt lgkmcnt(4)
  ds_read_b64_tr_b16 a[32:33], v26 offset:36864
  ds_read_b64_tr_b16 a[34:35], v26 offset:38400
  ds_read_b64_tr_b16 a[36:37], v26 offset:49152
  ds_read_b64_tr_b16 a[38:39], v26 offset:50688
  s_waitcnt lgkmcnt(4)
  ds_read_b64_tr_b16 a[100:101], v27 offset:0
  ds_read_b64_tr_b16 a[102:103], v27 offset:1536
  ds_read_b64_tr_b16 a[104:105], v27 offset:12288
  ds_read_b64_tr_b16 a[106:107], v27 offset:13824
  ds_read_b64_tr_b16 a[108:109], v27 offset:24576
  ds_read_b64_tr_b16 a[110:111], v27 offset:26112
  s_waitcnt lgkmcnt(4)
  ds_read_b64_tr_b16 a[112:113], v27 offset:36864
  ds_read_b64_tr_b16 a[114:115], v27 offset:38400
  ds_read_b64_tr_b16 a[116:117], v27 offset:49152
  ds_read_b64_tr_b16 a[118:119], v27 offset:50688
  s_waitcnt lgkmcnt(4)
  ds_read_b64_tr_b16 a[180:181], v28 offset:0
  ds_read_b64_tr_b16 a[182:183], v28 offset:1536
  ds_read_b64_tr_b16 a[184:185], v28 offset:12288
  ds_read_b64_tr_b16 a[186:187], v28 offset:13824
  ds_read_b64_tr_b16 a[188:189], v28 offset:24576
  ds_read_b64_tr_b16 a[190:191], v28 offset:26112
  s_waitcnt lgkmcnt(4)
  ds_read_b64_tr_b16 a[192:193], v28 offset:36864
  ds_read_b64_tr_b16 a[194:195], v28 offset:38400
  ds_read_b64_tr_b16 a[196:197], v28 offset:49152
  ds_read_b64_tr_b16 a[198:199], v28 offset:50688
  s_waitcnt lgkmcnt(4)
  s_waitcnt lgkmcnt(0)
  v_subrev_u32 v26, 61440, v26
  v_subrev_u32 v27, 61440, v27
  v_subrev_u32 v28, 61440, v28
  s_barrier
  s_add_u32 s70, s70, 204800
  s_lshl_b32 s60, s52, 10
  s_add_u32 s60, s60, 0xf000
  s_add_u32 m0, s60, 0
  s_nop 0
  buffer_load_dwordx4 v2, s[36:39], s70 offen lds
  s_add_u32 m0, s60, 4096
  s_nop 0
  buffer_load_dwordx4 v3, s[36:39], s70 offen lds
  s_add_u32 m0, s60, 8192
  s_nop 0
  buffer_load_dwordx4 v4, s[36:39], s70 offen lds
  s_add_u32 m0, s60, 12288
  s_nop 0
  buffer_load_dwordx4 v5, s[36:39], s70 offen lds
  s_add_u32 m0, s60, 16384
  s_nop 0
  buffer_load_dwordx4 v6, s[36:39], s70 offen lds
  s_add_u32 m0, s60, 20480
  s_nop 0
  buffer_load_dwordx4 v7, s[36:39], s70 offen lds
  s_add_u32 m0, s60, 24576
  s_nop 0
  buffer_load_dwordx4 v8, s[36:39], s70 offen lds
  s_add_u32 m0, s60, 28672
  s_nop 0
  buffer_load_dwordx4 v9, s[36:39], s70 offen lds
  s_add_u32 m0, s60, 32768
  s_nop 0
  buffer_load_dwordx4 v10, s[36:39], s70 offen lds
  s_add_u32 m0, s60, 36864
  s_nop 0
  buffer_load_dwordx4 v11, s[36:39], s70 offen lds
  s_add_u32 m0, s60, 40960
  s_nop 0
  buffer_load_dwordx4 v12, s[36:39], s70 offen lds
  s_add_u32 m0, s60, 45056
  s_nop 0
  buffer_load_dwordx4 v13, s[36:39], s70 offen lds
  s_add_u32 m0, s60, 49152
  s_nop 0
  buffer_load_dwordx4 v14, s[36:39], s70 offen lds
  s_add_u32 m0, s60, 53248
  s_nop 0
  buffer_load_dwordx4 v15, s[36:39], s70 offen lds
  s_add_u32 m0, s60, 57344
  s_nop 0
  buffer_load_dwordx4 v16, s[36:39], s70 offen lds
  s_waitcnt vmcnt(15)
  s_barrier
  ds_read_b64_tr_b16 a[40:41], v26 offset:0
  ds_read_b64_tr_b16 a[42:43], v26 offset:1536
  ds_read_b64_tr_b16 a[44:45], v26 offset:12288
  ds_read_b64_tr_b16 a[46:47], v26 offset:13824
  ds_read_b64_tr_b16 a[48:49], v26 offset:24576
  ds_read_b64_tr_b16 a[50:51], v26 offset:26112
  s_waitcnt lgkmcnt(4)
  ds_read_b64_tr_b16 a[52:53], v26 offset:36864
  ds_read_b64_tr_b16 a[54:55], v26 offset:38400
  ds_read_b64_tr_b16 a[56:57], v26 offset:49152
  ds_read_b64_tr_b16 a[58:59], v26 offset:50688
  s_waitcnt lgkmcnt(4)
  ds_read_b64_tr_b16 a[120:121], v27 offset:0
  ds_read_b64_tr_b16 a[122:123], v27 offset:1536
  ds_read_b64_tr_b16 a[124:125], v27 offset:12288
  ds_read_b64_tr_b16 a[126:127], v27 offset:13824
  ds_read_b64_tr_b16 a[128:129], v27 offset:24576
  ds_read_b64_tr_b16 a[130:131], v27 offset:26112
  s_waitcnt lgkmcnt(4)
  ds_read_b64_tr_b16 a[132:133], v27 offset:36864
  ds_read_b64_tr_b16 a[134:135], v27 offset:38400
  ds_read_b64_tr_b16 a[136:137], v27 offset:49152
  ds_read_b64_tr_b16 a[138:139], v27 offset:50688
  s_waitcnt lgkmcnt(4)
  ds_read_b64_tr_b16 a[200:201], v28 offset:0
  ds_read_b64_tr_b16 a[202:203], v28 offset:1536
  ds_read_b64_tr_b16 a[204:205], v28 offset:12288
  ds_read_b64_tr_b16 a[206:207], v28 offset:13824
  ds_read_b64_tr_b16 a[208:209], v28 offset:24576
  ds_read_b64_tr_b16 a[210:211], v28 offset:26112
  s_waitcnt lgkmcnt(4)
  ds_read_b64_tr_b16 a[212:213], v28 offset:36864
  ds_read_b64_tr_b16 a[214:215], v28 offset:38400
  ds_read_b64_tr_b16 a[216:217], v28 offset:49152
  ds_read_b64_tr_b16 a[218:219], v28 offset:50688
  s_waitcnt lgkmcnt(4)
  s_waitcnt lgkmcnt(0)
  v_add_u32 v26, 61440, v26
  v_add_u32 v27, 61440, v27
  v_add_u32 v28, 61440, v28
  s_barrier
  s_waitcnt vmcnt(0)
  s_barrier
  ds_read_b64_tr_b16 a[60:61], v26 offset:0
  ds_read_b64_tr_b16 a[62:63], v26 offset:1536
  ds_read_b64_tr_b16 a[64:65], v26 offset:12288
  ds_read_b64_tr_b16 a[66:67], v26 offset:13824
  ds_read_b64_tr_b16 a[68:69], v26 offset:24576
  ds_read_b64_tr_b16 a[70:71], v26 offset:26112
  s_waitcnt lgkmcnt(4)
  ds_read_b64_tr_b16 a[72:73], v26 offset:36864
  ds_read_b64_tr_b16 a[74:75], v26 offset:38400
  ds_read_b64_tr_b16 a[76:77], v26 offset:49152
  ds_read_b64_tr_b16 a[78:79], v26 offset:50688
  s_waitcnt lgkmcnt(4)
  ds_read_b64_tr_b16 a[140:141], v27 offset:0
  ds_read_b64_tr_b16 a[142:143], v27 offset:1536
  ds_read_b64_tr_b16 a[144:145], v27 offset:12288
  ds_read_b64_tr_b16 a[146:147], v27 offset:13824
  ds_read_b64_tr_b16 a[148:149], v27 offset:24576
  ds_read_b64_tr_b16 a[150:151], v27 offset:26112
  s_waitcnt lgkmcnt(4)
  ds_read_b64_tr_b16 a[152:153], v27 offset:36864
  ds_read_b64_tr_b16 a[154:155], v27 offset:38400
  ds_read_b64_tr_b16 a[156:157], v27 offset:49152
  ds_read_b64_tr_b16 a[158:159], v27 offset:50688
  s_waitcnt lgkmcnt(4)
  ds_read_b64_tr_b16 a[220:221], v28 offset:0
  ds_read_b64_tr_b16 a[222:223], v28 offset:1536
  ds_read_b64_tr_b16 a[224:225], v28 offset:12288
  ds_read_b64_tr_b16 a[226:227], v28 offset:13824
  ds_read_b64_tr_b16 a[228:229], v28 offset:24576
  ds_read_b64_tr_b16 a[230:231], v28 offset:26112
  s_waitcnt lgkmcnt(4)
  ds_read_b64_tr_b16 a[232:233], v28 offset:36864
  ds_read_b64_tr_b16 a[234:235], v28 offset:38400
  ds_read_b64_tr_b16 a[236:237], v28 offset:49152
  ds_read_b64_tr_b16 a[238:239], v28 offset:50688
  s_waitcnt lgkmcnt(4)
  s_waitcnt lgkmcnt(0)
  v_subrev_u32 v26, 61440, v26
  v_subrev_u32 v27, 61440, v27
  v_subrev_u32 v28, 61440, v28
  s_barrier
  v_mov_b32 v19, 32896
  s_mov_b32 s56, 0
poll_14186:
  buffer_load_dword v18, v19, s[48:51], 0 offen sc1
  s_waitcnt vmcnt(0)
  v_readfirstlane_b32 s58, v18
  s_cmp_ge_u32 s58, 64
  s_cbranch_scc1 polldone_14187
  s_cmp_lg_u32 s55, 0
  s_cbranch_scc1 polldone_14187
  s_add_u32 s56, s56, 1
  s_cmp_lt_u32 s56, 0x20000
  s_cbranch_scc1 poll_14186
  s_mov_b32 s55, 1
polldone_14187:
  s_add_u32 m0, s65, 0
  s_nop 0
  buffer_load_dwordx4 v92, s[48:51], s64 offen sc1 lds
  s_add_u32 m0, s65, 1024
  s_nop 0
  buffer_load_dwordx4 v93, s[48:51], s64 offen sc1 lds
  s_add_u32 m0, s65, 2048
  s_nop 0
  buffer_load_dwordx4 v94, s[48:51], s64 offen sc1 lds
  s_add_u32 m0, s65, 3072
  s_nop 0
  buffer_load_dwordx4 v95, s[48:51], s64 offen sc1 lds
  s_add_u32 m0, s65, 4096
  s_nop 0
  buffer_load_dwordx4 v96, s[48:51], s64 offen sc1 lds
  s_add_u32 m0, s65, 5120
  s_nop 0
  buffer_load_dwordx4 v97, s[48:51], s64 offen sc1 lds
  s_add_u32 m0, s65, 6144
  s_nop 0
  buffer_load_dwordx4 v98, s[48:51], s64 offen sc1 lds
  s_add_u32 m0, s65, 7168
  s_nop 0
  buffer_load_dwordx4 v99, s[48:51], s64 offen sc1 lds
  s_add_u32 m0, s65, 8192
  s_nop 0
  buffer_load_dwordx4 v100, s[48:51], s64 offen sc1 lds
  s_add_u32 m0, s65, 9216
  s_nop 0
  buffer_load_dwordx4 v101, s[48:51], s64 offen sc1 lds
  s_waitcnt vmcnt(0)
  s_mul_i32 s58, s52, 48
  s_add_u32 s58, s58, s78
  s_lshl_b32 s58, s58, 1
  s_add_u32 s58, s58, 1280
  v_and_b32 v18, 15, v1
  v_mul_u32_u24 v18, 2560, v18
  v_lshrrev_b32 v19, 4, v1
  v_lshlrev_b32 v19, 3, v19
  v_add_u32 v18, v18, v19
  v_add_u32 v2, s58, v18
  v_add_u32 v3, 40960, v2
  s_mul_i32 s66, s62, 81920
  s_mov_b32 s71, 0xfffe2000
L_b3_i:
  s_waitcnt vmcnt(6)
  s_barrier
  s_add_u32 s58, s62, 1
  s_cmp_lt_u32 s58, s63
  s_cselect_b32 s58, 40960, 0
  s_add_u32 s64, s64, s58
  s_add_u32 s65, s65, s71
  ds_read_b128 v[32:35], v102 offset:0
  ds_read_b128 v[36:39], v102 offset:20480
  ds_read_b128 v[40:43], v103 offset:0
  ds_read_b128 v[44:47], v103 offset:20480
  ds_read_b128 v[48:51], v104 offset:0
  ds_read_b128 v[52:55], v104 offset:20480
  s_waitcnt lgkmcnt(4)
  v_mfma_f32_16x16x32_bf16 v[56:59], a[0:3], v[32:35], 0
  v_mfma_f32_16x16x32_bf16 v[64:67], a[80:83], v[32:35], 0
  v_mfma_f32_16x16x32_bf16 v[72:75], a[160:163], v[32:35], 0
  v_mfma_f32_16x16x32_bf16 v[60:63], a[0:3], v[36:39], 0
  v_mfma_f32_16x16x32_bf16 v[68:71], a[80:83], v[36:39], 0
  v_mfma_f32_16x16x32_bf16 v[76:79], a[160:163], v[36:39], 0
  ds_read_b128 v[32:35], v105 offset:0
  ds_read_b128 v[36:39], v105 offset:20480
  s_waitcnt lgkmcnt(4)
  v_mfma_f32_16x16x32_bf16 v[56:59], a[4:7], v[40:43], v[56:59]
  s_add_u32 m0, s65, 0
  s_nop 0
  buffer_load_dwordx4 v92, s[48:51], s64 offen sc1 lds
  v_mfma_f32_16x16x32_bf16 v[64:67], a[84:87], v[40:43], v[64:67]
  v_mfma_f32_16x16x32_bf16 v[72:75], a[164:167], v[40:43], v[72:75]
  v_mfma_f32_16x16x32_bf16 v[60:63], a[4:7], v[44:47], v[60:63]
  v_mfma_f32_16x16x32_bf16 v[68:71], a[84:87], v[44:47], v[68:71]
  v_mfma_f32_16x16x32_bf16 v[76:79], a[164:167], v[44:47], v[76:79]
  ds_read_b128 v[40:43], v102 offset:256
  ds_read_b128 v[44:47], v102 offset:20736
  s_waitcnt lgkmcnt(4)
  v_mfma_f32_16x16x32_bf16 v[56:59], a[8:11], v[48:51], v[56:59]
  v_mfma_f32_16x16x32_bf16 v[64:67], a[88:91], v[48:51], v[64:67]
  v_mfma_f32_16x16x32_bf16 v[72:75], a[168:171], v[48:51], v[72:75]
  v_mfma_f32_16x16x32_bf16 v[60:63], a[8:11], v[52:55], v[60:63]
  v_mfma_f32_16x16x32_bf16 v[68:71], a[88:91], v[52:55], v[68:71]
  s_add_u32 m0, s65, 1024
  s_nop 0
  buffer_load_dwordx4 v93, s[48:51], s64 offen sc1 lds
  v_mfma_f32_16x16x32_bf16 v[76:79], a[168:171], v[52:55], v[76:79]
  ds_read_b128 v[48:51], v103 offset:256
  ds_read_b128 v[52:55], v103 offset:20736
  s_waitcnt lgkmcnt(4)
  v_mfma_f32_16x16x32_bf16 v[56:59], a[12:15], v[32:35], v[56:59]
  v_mfma_f32_16x16x32_bf16 v[64:67], a[92:95], v[32:35], v[64:67]
  v_mfma_f32_16x16x32_bf16 v[72:75], a[172:175], v[32:35], v[72:75]
  v_mfma_f32_16x16x32_bf16 v[60:63], a[12:15], v[36:39], v[60:63]
  v_mfma_f32_16x16x32_bf16 v[68:71], a[92:95], v[36:39], v[68:71]
  v_mfma_f32_16x16x32_bf16 v[76:79], a[172:175], v[36:39], v[76:79]
  ds_read_b128 v[32:35], v104 offset:256
  ds_read_b128 v[36:39], v104 offset:20736
  s_waitcnt lgkmcnt(4)
  v_mfma_f32_16x16x32_bf16 v[56:59], a[16:19], v[40:43], v[56:59]
  v_mfma_f32_16x16x32_bf16 v[64:67], a[96:99], v[40:43], v[64:67]
  v_mfma_f32_16x16x32_bf16 v[72:75], a[176:179], v[40:43], v[72:75]
  s_add_u32 m0, s65, 2048
  s_nop 0
  buffer_load_dwordx4 v94, s[48:51], s64 offen sc1 lds
  v_mfma_f32_16x16x32_bf16 v[60:63], a[16:19], v[44:47], v[60:63]
  v_mfma_f32_16x16x32_bf16 v[68:71], a[96:99], v[44:47], v[68:71]
  v_mfma_f32_16x16x32_bf16 v[76:79], a[176:179], v[44:47], v[76:79]
  ds_read_b128 v[40:43], v105 offset:256
  ds_read_b128 v[44:47], v105 offset:20736
  s_waitcnt lgkmcnt(4)
  v_mfma_f32_16x16x32_bf16 v[56:59], a[20:23], v[48:51], v[56:59]
  v_mfma_f32_16x16x32_bf16 v[64:67], a[100:103], v[48:51], v[64:67]
  v_mfma_f32_16x16x32_bf16 v[72:75], a[180:183], v[48:51], v[72:75]
  v_mfma_f32_16x16x32_bf16 v[60:63], a[20:23], v[52:55], v[60:63]
  v_mfma_f32_16x16x32_bf16 v[68:71], a[100:103], v[52:55], v[68:71]
  v_mfma_f32_16x16x32_bf16 v[76:79], a[180:183], v[52:55], v[76:79]
  ds_read_b128 v[48:51], v102 offset:512
  ds_read_b128 v[52:55], v102 offset:20992
  s_waitcnt lgkmcnt(4)
  v_mfma_f32_16x16x32_bf16 v[56:59], a[24:27], v[32:35], v[56:59]
  s_add_u32 m0, s65, 3072
  s_nop 0
  buffer_load_dwordx4 v95, s[48:51], s64 offen sc1 lds
  v_mfma_f32_16x16x32_bf16 v[64:67], a[104:107], v[32:35], v[64:67]
  v_mfma_f32_16x16x32_bf16 v[72:75], a[184:187], v[32:35], v[72:75]
  v_mfma_f32_16x16x32_bf16 v[60:63], a[24:27], v[36:39], v[60:63]
  v_mfma_f32_16x16x32_bf16 v[68:71], a[104:107], v[36:39], v[68:71]
  v_mfma_f32_16x16x32_bf16 v[76:79], a[184:187], v[36:39], v[76:79]
  ds_read_b128 v[32:35], v103 offset:512
  ds_read_b128 v[36:39], v103 offset:20992
  s_waitcnt lgkmcnt(4)
  v_mfma_f32_16x16x32_bf16 v[56:59], a[28:31], v[40:43], v[56:59]
  v_mfma_f32_16x16x32_bf16 v[64:67], a[108:111], v[40:43], v[64:67]
  v_mfma_f32_16x16x32_bf16 v[72:75], a[188:191], v[40:43], v[72:75]
  v_mfma_f32_16x16x32_bf16 v[60:63], a[28:31], v[44:47], v[60:63]
  v_mfma_f32_16x16x32_bf16 v[68:71], a[108:111], v[44:47], v[68:71]
  s_add_u32 m0, s65, 4096
  s_nop 0
  buffer_load_dwordx4 v96, s[48:51], s64 offen sc1 lds
  v_mfma_f32_16x16x32_bf16 v[76:79], a[188:191], v[44:47], v[76:79]
  ds_read_b128 v[40:43], v104 offset:512
  ds_read_b128 v[44:47], v104 offset:20992
  s_waitcnt lgkmcnt(4)
  v_mfma_f32_16x16x32_bf16 v[56:59], a[32:35], v[48:51], v[56:59]
  v_mfma_f32_16x16x32_bf16 v[64:67], a[112:115], v[48:51], v[64:67]
  v_mfma_f32_16x16x32_bf16 v[72:75], a[192:195], v[48:51], v[72:75]
  v_mfma_f32_16x16x32_bf16 v[60:63], a[32:35], v[52:55], v[60:63]
  v_mfma_f32_16x16x32_bf16 v[68:71], a[112:115], v[52:55], v[68:71]
  v_mfma_f32_16x16x32_bf16 v[76:79], a[192:195], v[52:55], v[76:79]
  ds_read_b128 v[48:51], v105 offset:512
  ds_read_b128 v[52:55], v105 offset:20992
  s_waitcnt lgkmcnt(4)
  v_mfma_f32_16x16x32_bf16 v[56:59], a[36:39], v[32:35], v[56:59]
  v_mfma_f32_16x16x32_bf16 v[64:67], a[116:119], v[32:35], v[64:67]
  v_mfma_f32_16x16x32_bf16 v[72:75], a[196:199], v[32:35], v[72:75]
  s_add_u32 m0, s65, 5120
  s_nop 0
  buffer_load_dwordx4 v97, s[48:51], s64 offen sc1 lds
  v_mfma_f32_16x16x32_bf16 v[60:63], a[36:39], v[36:39], v[60:63]
  v_mfma_f32_16x16x32_bf16 v[68:71], a[116:119], v[36:39], v[68:71]
  v_mfma_f32_16x16x32_bf16 v[76:79], a[196:199], v[36:39], v[76:79]
  ds_read_b128 v[32:35], v102 offset:768
  ds_read_b128 v[36:39], v102 offset:21248
  s_waitcnt lgkmcnt(4)
  v_mfma_f32_16x16x32_bf16 v[56:59], a[40:43], v[40:43], v[56:59]
  v_mfma_f32_16x16x32_bf16 v[64:67], a[120:123], v[40:43], v[64:67]
  v_mfma_f32_16x16x32_bf16 v[72:75], a[200:203], v[40:43], v[72:75]
  v_mfma_f32_16x16x32_bf16 v[60:63], a[40:43], v[44:47], v[60:63]
  v_mfma_f32_16x16x32_bf16 v[68:71], a[120:123], v[44:47], v[68:71]
  v_mfma_f32_16x16x32_bf16 v[76:79], a[200:203], v[44:47], v[76:79]
  ds_read_b128 v[40:43], v103 offset:768
  ds_read_b128 v[44:47], v103 offset:21248
  s_waitcnt lgkmcnt(4)
  v_mfma_f32_16x16x32_bf16 v[56:59], a[44:47], v[48:51], v[56:59]
  s_add_u32 m0, s65, 6144
  s_nop 0
  buffer_load_dwordx4 v98, s[48:51], s64 offen sc1 lds
  v_mfma_f32_16x16x32_bf16 v[64:67], a[124:127], v[48:51], v[64:67]
  v_mfma_f32_16x16x32_bf16 v[72:75], a[204:207], v[48:51], v[72:75]
  v_mfma_f32_16x16x32_bf16 v[60:63], a[44:47], v[52:55], v[60:63]
  v_mfma_f32_16x16x32_bf16 v[68:71], a[124:127], v[52:55], v[68:71]
  v_mfma_f32_16x16x32_bf16 v[76:79], a[204:207], v[52:55], v[76:79]
  ds_read_b128 v[48:51], v104 offset:768
  ds_read_b128 v[52:55], v104 offset:21248
  s_waitcnt lgkmcnt(4)
  v_mfma_f32_16x16x32_bf16 v[56:59], a[48:51], v[32:35], v[56:59]
  v_mfma_f32_16x16x32_bf16 v[64:67], a[128:131], v[32:35], v[64:67]
  v_mfma_f32_16x16x32_bf16 v[72:75], a[208:211], v[32:35], v[72:75]
  v_mfma_f32_16x16x32_bf16 v[60:63], a[48:51], v[36:39], v[60:63]
  v_mfma_f32_16x16x32_bf16 v[68:71], a[128:131], v[36:39], v[68:71]
  s_add_u32 m0, s65, 7168
  s_nop 0
  buffer_load_dwordx4 v99, s[48:51], s64 offen sc1 lds
  v_mfma_f32_16x16x32_bf16 v[76:79], a[208:211], v[36:39], v[76:79]
  ds_read_b128 v[32:35], v105 offset:768
  ds_read_b128 v[36:39], v105 offset:21248
  s_waitcnt lgkmcnt(4)
  v_mfma_f32_16x16x32_bf16 v[56:59], a[52:55], v[40:43], v[56:59]
  v_mfma_f32_16x16x32_bf16 v[64:67], a[132:135], v[40:43], v[64:67]
  v_mfma_f32_16x16x32_bf16 v[72:75], a[212:215], v[40:43], v[72:75]
  v_mfma_f32_16x16x32_bf16 v[60:63], a[52:55], v[44:47], v[60:63]
  v_mfma_f32_16x16x32_bf16 v[68:71], a[132:135], v[44:47], v[68:71]
  v_mfma_f32_16x16x32_bf16 v[76:79], a[212:215], v[44:47], v[76:79]
  ds_read_b128 v[40:43], v102 offset:1024
  ds_read_b128 v[44:47], v102 offset:21504
  s_waitcnt lgkmcnt(4)
  v_mfma_f32_16x16x32_bf16 v[56:59], a[56:59], v[48:51], v[56:59]
  v_mfma_f32_16x16x32_bf16 v[64:67], a[136:139], v[48:51], v[64:67]
  v_mfma_f32_16x16x32_bf16 v[72:75], a[216:219], v[48:51], v[72:75]
  s_add_u32 m0, s65, 8192
  s_nop 0
  buffer_load_dwordx4 v100, s[48:51], s64 offen sc1 lds
  v_mfma_f32_16x16x32_bf16 v[60:63], a[56:59], v[52:55], v[60:63]
  v_mfma_f32_16x16x32_bf16 v[68:71], a[136:139], v[52:55], v[68:71]
  v_mfma_f32_16x16x32_bf16 v[76:79], a[216:219], v[52:55], v[76:79]
  ds_read_b128 v[48:51], v103 offset:1024
  ds_read_b128 v[52:55], v103 offset:21504
  s_waitcnt lgkmcnt(4)
  v_mfma_f32_16x16x32_bf16 v[56:59], a[60:63], v[32:35], v[56:59]
  v_mfma_f32_16x16x32_bf16 v[64:67], a[140:143], v[32:35], v[64:67]
  v_mfma_f32_16x16x32_bf16 v[72:75], a[220:223], v[32:35], v[72:75]
  v_mfma_f32_16x16x32_bf16 v[60:63], a[60:63], v[36:39], v[60:63]
  v_mfma_f32_16x16x32_bf16 v[68:71], a[140:143], v[36:39], v[68:71]
  v_mfma_f32_16x16x32_bf16 v[76:79], a[220:223], v[36:39], v[76:79]
  ds_read_b128 v[32:35], v104 offset:1024
  ds_read_b128 v[36:39], v104 offset:21504
  s_waitcnt lgkmcnt(4)
  v_mfma_f32_16x16x32_bf16 v[56:59], a[64:67], v[40:43], v[56:59]
  s_add_u32 m0, s65, 9216
  s_nop 0
  buffer_load_dwordx4 v101, s[48:51], s64 offen sc1 lds
  v_mfma_f32_16x16x32_bf16 v[64:67], a[144:147], v[40:43], v[64:67]
  v_mfma_f32_16x16x32_bf16 v[72:75], a[224:227], v[40:43], v[72:75]
  v_mfma_f32_16x16x32_bf16 v[60:63], a[64:67], v[44:47], v[60:63]
  v_mfma_f32_16x16x32_bf16 v[68:71], a[144:147], v[44:47], v[68:71]
  v_mfma_f32_16x16x32_bf16 v[76:79], a[224:227], v[44:47], v[76:79]
  ds_read_b128 v[40:43], v105 offset:1024
  ds_read_b128 v[44:47], v105 offset:21504
  s_waitcnt lgkmcnt(4)
  v_mfma_f32_16x16x32_bf16 v[56:59], a[68:71], v[48:51], v[56:59]
  v_mfma_f32_16x16x32_bf16 v[64:67], a[148:151], v[48:51], v[64:67]
  v_mfma_f32_16x16x32_bf16 v[72:75], a[228:231], v[48:51], v[72:75]
  v_mfma_f32_16x16x32_bf16 v[60:63], a[68:71], v[52:55], v[60:63]
  v_mfma_f32_16x16x32_bf16 v[68:71], a[148:151], v[52:55], v[68:71]
  v_mfma_f32_16x16x32_bf16 v[76:79], a[228:231], v[52:55], v[76:79]
  s_waitcnt lgkmcnt(2)
  v_mfma_f32_16x16x32_bf16 v[56:59], a[72:75], v[32:35], v[56:59]
  v_mfma_f32_16x16x32_bf16 v[64:67], a[152:155], v[32:35], v[64:67]
  v_mfma_f32_16x16x32_bf16 v[72:75], a[232:235], v[32:35], v[72:75]
  v_mfma_f32_16x16x32_bf16 v[60:63], a[72:75], v[36:39], v[60:63]
  v_mfma_f32_16x16x32_bf16 v[68:71], a[152:155], v[36:39], v[68:71]
  v_mfma_f32_16x16x32_bf16 v[76:79], a[232:235], v[36:39], v[76:79]
  s_waitcnt lgkmcnt(0)
  v_mfma_f32_16x16x32_bf16 v[56:59], a[76:79], v[40:43], v[56:59]
  v_mfma_f32_16x16x32_bf16 v[64:67], a[156:159], v[40:43], v[64:67]
  v_mfma_f32_16x16x32_bf16 v[72:75], a[236:239], v[40:43], v[72:75]
  v_mfma_f32_16x16x32_bf16 v[60:63], a[76:79], v[44:47], v[60:63]
  v_mfma_f32_16x16x32_bf16 v[68:71], a[156:159], v[44:47], v[68:71]
  v_mfma_f32_16x16x32_bf16 v[76:79], a[236:239], v[44:47], v[76:79]
  v_add_u32 v102, s71, v102
  v_add_u32 v103, s71, v103
  v_add_u32 v104, s71, v104
  v_add_u32 v105, s71, v105
  s_sub_u32 s71, 0, s71
  s_nop 2
  v_cvt_pk_bf16_f32 v80, v56, v57
  v_cvt_pk_bf16_f32 v81, v58, v59
  buffer_store_dwordx2 v[80:81], v2, s[40:43], s66 offen offset:0
  v_cvt_pk_bf16_f32 v82, v60, v61
  v_cvt_pk_bf16_f32 v83, v62, v63
  buffer_store_dwordx2 v[82:83], v3, s[40:43], s66 offen offset:0
  v_cvt_pk_bf16_f32 v84, v64, v65
  v_cvt_pk_bf16_f32 v85, v66, v67
  buffer_store_dwordx2 v[84:85], v2, s[40:43], s66 offen offset:32
  v_cvt_pk_bf16_f32 v86, v68, v69
  v_cvt_pk_bf16_f32 v87, v70, v71
  buffer_store_dwordx2 v[86:87], v3, s[40:43], s66 offen offset:32
  v_cvt_pk_bf16_f32 v88, v72, v73
  v_cvt_pk_bf16_f32 v89, v74, v75
  buffer_store_dwordx2 v[88:89], v2, s[40:43], s66 offen offset:64
  v_cvt_pk_bf16_f32 v90, v76, v77
  v_cvt_pk_bf16_f32 v91, v78, v79
  buffer_store_dwordx2 v[90:91], v3, s[40:43], s66 offen offset:64
  s_add_u32 s66, s66, 81920
  s_add_u32 s62, s62, 1
  s_cmp_lt_u32 s62, s63
  s_cbranch_scc1 L_b3_i
  s_waitcnt vmcnt(0)
  s_barrier
  s_endpgm
L_t23_i:
  s_waitcnt vmcnt(0)
  s_barrier
  s_waitcnt vmcnt(0)
  s_mov_b32 s56, 0
  v_mov_b32 v20, 140
iw_14190:
  buffer_load_dword v18, v20, s[44:47], 0 offen sc1
  s_waitcnt vmcnt(0)
  v_readfirstlane_b32 s58, v18
  s_cmp_ge_u32 s58, 256
  s_cbranch_scc1 iwd_14191
  s_cmp_lg_u32 s55, 0
  s_cbranch_scc1 iwd_14191
  s_add_u32 s56, s56, 1
  s_cmp_lt_u32 s56, 0x20000
  s_cbranch_scc1 iw_14190
  s_mov_b32 s55, 1
iwd_14191:
  s_cmp_lg_u32 s52, 0
  s_cbranch_scc1 gate_14192
  s_lshl_b32 s59, s53, 3
  s_and_b32 s60, s54, 7
  s_add_u32 s59, s59, s60
  s_lshl_b32 s59, s59, 8
  s_add_u32 s59, s59, 0
  v_mov_b32 v19, s59
  s_mov_b32 s56, 0
poll_14193:
  buffer_load_dword v18, v19, s[48:51], 0 offen sc1
  s_waitcnt vmcnt(0)
  v_readfirstlane_b32 s58, v18
  s_cmp_ge_u32 s58, 1
  s_cbranch_scc1 polldone_14194
  s_cmp_lg_u32 s55, 0
  s_cbranch_scc1 polldone_14194
  s_add_u32 s56, s56, 1
  s_cmp_lt_u32 s56, 0x20000
  s_cbranch_scc1 poll_14193
  s_mov_b32 s55, 1
polldone_14194:
gate_14192:
  s_barrier
  s_cmp_lt_u32 s54, 24
  s_cbranch_scc1 nob1_14188
  s_lshl_b32 s61, s53, 3
  s_add_u32 s61, s61, s54
  s_sub_u32 s61, s61, 24
  s_cmp_ge_u32 s61, 30
  s_cbranch_scc1 nob1_14188
  s_mul_i32 s58, s61, 6554
  s_lshr_b32 s58, s58, 16
  s_mul_i32 s59, s58, 10
  s_sub_u32 s78, s61, s59
  s_mul_i32 s62, s58, 22
  s_cmp_eq_u32 s58, 2
  s_cselect_b32 s59, 1, 0
  s_sub_u32 s62, s62, s59
  s_cmp_lt_u32 s58, 1
  s_cselect_b32 s59, 22, 21
  s_add_u32 s63, s62, s59
  v_and_b32 v1, 63, v0
  s_mul_i32 s58, s52, 640
  s_add_u32 s59, s58, 0
  v_add_u32 v18, s59, v1
  v_mul_u32_u24 v19, 3277, v18
  v_lshrrev_b32 v19, 18, v19
  v_mul_u32_u24 v20, 80, v19
  v_sub_u32 v18, v18, v20
  v_and_b32 v20, 15, v19
  v_xor_b32 v18, v18, v20
  v_lshlrev_b32 v18, 4, v18
  v_mul_u32_u24 v19, 1280, v19
  v_add_u32 v92, v18, v19
  s_add_u32 s59, s58, 64
  v_add_u32 v18, s59, v1
  v_mul_u32_u24 v19, 3277, v18
  v_lshrrev_b32 v19, 18, v19
  v_mul_u32_u24 v20, 80, v19
  v_sub_u32 v18, v18, v20
  v_and_b32 v20, 15, v19
  v_xor_b32 v18, v18, v20
  v_lshlrev_b32 v18, 4, v18
  v_mul_u32_u24 v19, 1280, v19
  v_add_u32 v93, v18, v19
  s_add_u32 s59, s58, 128
  v_add_u32 v18, s59, v1
  v_mul_u32_u24 v19, 3277, v18
  v_lshrrev_b32 v19, 18, v19
  v_mul_u32_u24 v20, 80, v19
  v_sub_u32 v18, v18, v20
  v_and_b32 v20, 15, v19
  v_xor_b32 v18, v18, v20
  v_lshlrev_b32 v18, 4, v18
  v_mul_u32_u24 v19, 1280, v19
  v_add_u32 v94, v18, v19
  s_add_u32 s59, s58, 192
  v_add_u32 v18, s59, v1
  v_mul_u32_u24 v19, 3277, v18
  v_lshrrev_b32 v19, 18, v19
  v_mul_u32_u24 v20, 80, v19
  v_sub_u32 v18, v18, v20
  v_and_b32 v20, 15, v19
  v_xor_b32 v18, v18, v20
  v_lshlrev_b32 v18, 4, v18
  v_mul_u32_u24 v19, 1280, v19
  v_add_u32 v95, v18, v19
  s_add_u32 s59, s58, 256
  v_add_u32 v18, s59, v1
  v_mul_u32_u24 v19, 3277, v18
  v_lshrrev_b32 v19, 18, v19
  v_mul_u32_u24 v20, 80, v19
  v_sub_u32 v18, v18, v20
  v_and_b32 v20, 15, v19
  v_xor_b32 v18, v18, v20
  v_lshlrev_b32 v18, 4, v18
  v_mul_u32_u24 v19, 1280, v19
  v_add_u32 v96, v18, v19
  s_add_u32 s59, s58, 320
  v_add_u32 v18, s59, v1
  v_mul_u32_u24 v19, 3277, v18
  v_lshrrev_b32 v19, 18, v19
  v_mul_u32_u24 v20, 80, v19
  v_sub_u32 v18, v18, v20
  v_and_b32 v20, 15, v19
  v_xor_b32 v18, v18, v20
  v_lshlrev_b32 v18, 4, v18
  v_mul_u32_u24 v19, 1280, v19
  v_add_u32 v97, v18, v19
  s_add_u32 s59, s58, 384
  v_add_u32 v18, s59, v1
  v_mul_u32_u24 v19, 3277, v18
  v_lshrrev_b32 v19, 18, v19
  v_mul_u32_u24 v20, 80, v19
  v_sub_u32 v18, v18, v20
  v_and_b32 v20, 15, v19
  v_xor_b32 v18, v18, v20
  v_lshlrev_b32 v18, 4, v18
  v_mul_u32_u24 v19, 1280, v19
  v_add_u32 v98, v18, v19
  s_add_u32 s59, s58, 448
  v_add_u32 v18, s59, v1
  v_mul_u32_u24 v19, 3277, v18
  v_lshrrev_b32 v19, 18, v19
  v_mul_u32_u24 v20, 80, v19
  v_sub_u32 v18, v18, v20
  v_and_b32 v20, 15, v19
  v_xor_b32 v18, v18, v20
  v_lshlrev_b32 v18, 4, v18
  v_mul_u32_u24 v19, 1280, v19
  v_add_u32 v99, v18, v19
  s_add_u32 s59, s58, 512
  v_add_u32 v18, s59, v1
  v_mul_u32_u24 v19, 3277, v18
  v_lshrrev_b32 v19, 18, v19
  v_mul_u32_u24 v20, 80, v19
  v_sub_u32 v18, v18, v20
  v_and_b32 v20, 15, v19
  v_xor_b32 v18, v18, v20
  v_lshlrev_b32 v18, 4, v18
  v_mul_u32_u24 v19, 1280, v19
  v_add_u32 v100, v18, v19
  s_add_u32 s59, s58, 576
  v_add_u32 v18, s59, v1
  v_mul_u32_u24 v19, 3277, v18
  v_lshrrev_b32 v19, 18, v19
  v_mul_u32_u24 v20, 80, v19
  v_sub_u32 v18, v18, v20
  v_and_b32 v20, 15, v19
  v_xor_b32 v18, v18, v20
  v_lshlrev_b32 v18, 4, v18
  v_mul_u32_u24 v19, 1280, v19
  v_add_u32 v101, v18, v19
  v_and_b32 v18, 15, v1
  v_lshrrev_b32 v19, 4, v1
  v_xor_b32 v19, v19, v18
  v_mul_u32_u24 v18, 1280, v18
  v_add_u32 v18, 0x1e000, v18
  v_xor_b32 v20, 0, v19
  v_lshlrev_b32 v20, 4, v20
  v_add_u32 v102, v18, v20
  v_xor_b32 v20, 4, v19
  v_lshlrev_b32 v20, 4, v20
  v_add_u32 v103, v18, v20
  v_xor_b32 v20, 8, v19
  v_lshlrev_b32 v20, 4, v20
  v_add_u32 v104, v18, v20
  v_xor_b32 v20, 12, v19
  v_lshlrev_b32 v20, 4, v20
  v_add_u32 v105, v18, v20
  v_lshrrev_b32 v18, 4, v1
  v_lshrrev_b32 v19, 2, v1
  v_and_b32 v19, 3, v19
  v_lshlrev_b32 v20, 3, v18
  v_add_u32 v20, v20, v19
  v_mul_u32_u24 v20, 384, v20
  v_and_b32 v21, 3, v1
  v_lshlrev_b32 v21, 3, v21
  v_add_u32 v20, v20, v21
  v_lshrrev_b32 v19, 1, v19
  v_and_b32 v18, 1, v18
  v_lshlrev_b32 v18, 1, v18
  v_or_b32 v18, v18, v19
  s_mul_i32 s58, s52, 3
  s_add_u32 s59, s58, 0
  v_xor_b32 v19, s59, v18
  v_lshlrev_b32 v19, 5, v19
  v_add_u32 v26, v19, v20
  s_add_u32 s59, s58, 1
  v_xor_b32 v19, s59, v18
  v_lshlrev_b32 v19, 5, v19
  v_add_u32 v27, v19, v20
  s_add_u32 s59, s58, 2
  v_xor_b32 v19, s59, v18
  v_lshlrev_b32 v19, 5, v19
  v_add_u32 v28, v19, v20
  s_mul_i32 s67, s78, 384
  s_mul_i32 s64, s62, 40960
  s_mul_i32 s65, s52, 10240
  s_add_u32 s65, s65, 122880
  v_mov_b32 v18, v0
  v_mul_u32_u24 v19, 2731, v18
  v_lshrrev_b32 v19, 16, v19
  v_mul_u32_u24 v20, 24, v19
  v_sub_u32 v18, v18, v20
  v_and_b32 v20, 2, v19
  v_lshrrev_b32 v21, 1, v19
  v_and_b32 v21, 4, v21
  v_or_b32 v20, v20, v21
  v_xor_b32 v18, v18, v20
  v_mul_u32_u24 v19, 3840, v19
  v_lshlrev_b32 v18, 4, v18
  v_add_u32 v2, v18, v19
  v_add_u32 v18, 256, v0
  v_mul_u32_u24 v19, 2731, v18
  v_lshrrev_b32 v19, 16, v19
  v_mul_u32_u24 v20, 24, v19
  v_sub_u32 v18, v18, v20
  v_and_b32 v20, 2, v19
  v_lshrrev_b32 v21, 1, v19
  v_and_b32 v21, 4, v21
  v_or_b32 v20, v20, v21
  v_xor_b32 v18, v18, v20
  v_mul_u32_u24 v19, 3840, v19
  v_lshlrev_b32 v18, 4, v18
  v_add_u32 v3, v18, v19
  v_add_u32 v18, 512, v0
  v_mul_u32_u24 v19, 2731, v18
  v_lshrrev_b32 v19, 16, v19
  v_mul_u32_u24 v20, 24, v19
  v_sub_u32 v18, v18, v20
  v_and_b32 v20, 2, v19
  v_lshrrev_b32 v21, 1, v19
  v_and_b32 v21, 4, v21
  v_or_b32 v20, v20, v21
  v_xor_b32 v18, v18, v20
  v_mul_u32_u24 v19, 3840, v19
  v_lshlrev_b32 v18, 4, v18
  v_add_u32 v4, v18, v19
  v_add_u32 v18, 768, v0
  v_mul_u32_u24 v19, 2731, v18
  v_lshrrev_b32 v19, 16, v19
  v_mul_u32_u24 v20, 24, v19
  v_sub_u32 v18, v18, v20
  v_and_b32 v20, 2, v19
  v_lshrrev_b32 v21, 1, v19
  v_and_b32 v21, 4, v21
  v_or_b32 v20, v20, v21
  v_xor_b32 v18, v18, v20
  v_mul_u32_u24 v19, 3840, v19
  v_lshlrev_b32 v18, 4, v18
  v_add_u32 v5, v18, v19
  v_add_u32 v18, 1024, v0
  v_mul_u32_u24 v19, 2731, v18
  v_lshrrev_b32 v19, 16, v19
  v_mul_u32_u24 v20, 24, v19
  v_sub_u32 v18, v18, v20
  v_and_b32 v20, 2, v19
  v_lshrrev_b32 v21, 1, v19
  v_and_b32 v21, 4, v21
  v_or_b32 v20, v20, v21
  v_xor_b32 v18, v18, v20
  v_mul_u32_u24 v19, 3840, v19
  v_lshlrev_b32 v18, 4, v18
  v_add_u32 v6, v18, v19
  v_add_u32 v18, 1280, v0
  v_mul_u32_u24 v19, 2731, v18
  v_lshrrev_b32 v19, 16, v19
  v_mul_u32_u24 v20, 24, v19
  v_sub_u32 v18, v18, v20
  v_and_b32 v20, 2, v19
  v_lshrrev_b32 v21, 1, v19
  v_and_b32 v21, 4, v21
  v_or_b32 v20, v20, v21
  v_xor_b32 v18, v18, v20
  v_mul_u32_u24 v19, 3840, v19
  v_lshlrev_b32 v18, 4, v18
  v_add_u32 v7, v18, v19
  v_add_u32 v18, 1536, v0
  v_mul_u32_u24 v19, 2731, v18
  v_lshrrev_b32 v19, 16, v19
  v_mul_u32_u24 v20, 24, v19
  v_sub_u32 v18, v18, v20
  v_and_b32 v20, 2, v19
  v_lshrrev_b32 v21, 1, v19
  v_and_b32 v21, 4, v21
  v_or_b32 v20, v20, v21
  v_xor_b32 v18, v18, v20
  v_mul_u32_u24 v19, 3840, v19
  v_lshlrev_b32 v18, 4, v18
  v_add_u32 v8, v18, v19
  v_add_u32 v18, 1792, v0
  v_mul_u32_u24 v19, 2731, v18
  v_lshrrev_b32 v19, 16, v19
  v_mul_u32_u24 v20, 24, v19
  v_sub_u32 v18, v18, v20
  v_and_b32 v20, 2, v19
  v_lshrrev_b32 v21, 1, v19
  v_and_b32 v21, 4, v21
  v_or_b32 v20, v20, v21
  v_xor_b32 v18, v18, v20
  v_mul_u32_u24 v19, 3840, v19
  v_lshlrev_b32 v18, 4, v18
  v_add_u32 v9, v18, v19
  v_add_u32 v18, 2048, v0
  v_mul_u32_u24 v19, 2731, v18
  v_lshrrev_b32 v19, 16, v19
  v_mul_u32_u24 v20, 24, v19
  v_sub_u32 v18, v18, v20
  v_and_b32 v20, 2, v19
  v_lshrrev_b32 v21, 1, v19
  v_and_b32 v21, 4, v21
  v_or_b32 v20, v20, v21
  v_xor_b32 v18, v18, v20
  v_mul_u32_u24 v19, 3840, v19
  v_lshlrev_b32 v18, 4, v18
  v_add_u32 v10, v18, v19
  v_add_u32 v18, 2304, v0
  v_mul_u32_u24 v19, 2731, v18
  v_lshrrev_b32 v19, 16, v19
  v_mul_u32_u24 v20, 24, v19
  v_sub_u32 v18, v18, v20
  v_and_b32 v20, 2, v19
  v_lshrrev_b32 v21, 1, v19
  v_and_b32 v21, 4, v21
  v_or_b32 v20, v20, v21
  v_xor_b32 v18, v18, v20
  v_mul_u32_u24 v19, 3840, v19
  v_lshlrev_b32 v18, 4, v18
  v_add_u32 v11, v18, v19
  v_add_u32 v18, 2560, v0
  v_mul_u32_u24 v19, 2731, v18
  v_lshrrev_b32 v19, 16, v19
  v_mul_u32_u24 v20, 24, v19
  v_sub_u32 v18, v18, v20
  v_and_b32 v20, 2, v19
  v_lshrrev_b32 v21, 1, v19
  v_and_b32 v21, 4, v21
  v_or_b32 v20, v20, v21
  v_xor_b32 v18, v18, v20
  v_mul_u32_u24 v19, 3840, v19
  v_lshlrev_b32 v18, 4, v18
  v_add_u32 v12, v18, v19
  v_add_u32 v18, 2816, v0
  v_mul_u32_u24 v19, 2731, v18
  v_lshrrev_b32 v19, 16, v19
  v_mul_u32_u24 v20, 24, v19
  v_sub_u32 v18, v18, v20
  v_and_b32 v20, 2, v19
  v_lshrrev_b32 v21, 1, v19
  v_and_b32 v21, 4, v21
  v_or_b32 v20, v20, v21
  v_xor_b32 v18, v18, v20
  v_mul_u32_u24 v19, 3840, v19
  v_lshlrev_b32 v18, 4, v18
  v_add_u32 v13, v18, v19
  v_add_u32 v18, 3072, v0
  v_mul_u32_u24 v19, 2731, v18
  v_lshrrev_b32 v19, 16, v19
  v_mul_u32_u24 v20, 24, v19
  v_sub_u32 v18, v18, v20
  v_and_b32 v20, 2, v19
  v_lshrrev_b32 v21, 1, v19
  v_and_b32 v21, 4, v21
  v_or_b32 v20, v20, v21
  v_xor_b32 v18, v18, v20
  v_mul_u32_u24 v19, 3840, v19
  v_lshlrev_b32 v18, 4, v18
  v_add_u32 v14, v18, v19
  v_add_u32 v18, 3328, v0
  v_mul_u32_u24 v19, 2731, v18
  v_lshrrev_b32 v19, 16, v19
  v_mul_u32_u24 v20, 24, v19
  v_sub_u32 v18, v18, v20
  v_and_b32 v20, 2, v19
  v_lshrrev_b32 v21, 1, v19
  v_and_b32 v21, 4, v21
  v_or_b32 v20, v20, v21
  v_xor_b32 v18, v18, v20
  v_mul_u32_u24 v19, 3840, v19
  v_lshlrev_b32 v18, 4, v18
  v_add_u32 v15, v18, v19
  v_add_u32 v18, 3584, v0
  v_mul_u32_u24 v19, 2731, v18
  v_lshrrev_b32 v19, 16, v19
  v_mul_u32_u24 v20, 24, v19
  v_sub_u32 v18, v18, v20
  v_and_b32 v20, 2, v19
  v_lshrrev_b32 v21, 1, v19
  v_and_b32 v21, 4, v21
  v_or_b32 v20, v20, v21
  v_xor_b32 v18, v18, v20
  v_mul_u32_u24 v19, 3840, v19
  v_lshlrev_b32 v18, 4, v18
  v_add_u32 v16, v18, v19
  s_add_u32 m0, s65, 0
  s_nop 0
  buffer_load_dwordx4 v92, s[28:31], s64 offen lds
  s_add_u32 m0, s65, 1024
  s_nop 0
  buffer_load_dwordx4 v93, s[28:31], s64 offen lds
  s_add_u32 m0, s65, 2048
  s_nop 0
  buffer_load_dwordx4 v94, s[28:31], s64 offen lds
  s_add_u32 m0, s65, 3072
  s_nop 0
  buffer_load_dwordx4 v95, s[28:31], s64 offen lds
  s_add_u32 m0, s65, 4096
  s_nop 0
  buffer_load_dwordx4 v96, s[28:31], s64 offen lds
  s_add_u32 m0, s65, 5120
  s_nop 0
  buffer_load_dwordx4 v97, s[28:31], s64 offen lds
  s_add_u32 m0, s65, 6144
  s_nop 0
  buffer_load_dwordx4 v98, s[28:31], s64 offen lds
  s_add_u32 m0, s65, 7168
  s_nop 0
  buffer_load_dwordx4 v99, s[28:31], s64 offen lds
  s_add_u32 m0, s65, 8192
  s_nop 0
  buffer_load_dwordx4 v100, s[28:31], s64 offen lds
  s_add_u32 m0, s65, 9216
  s_nop 0
  buffer_load_dwordx4 v101, s[28:31], s64 offen lds
  s_mov_b32 s70, s67
  s_lshl_b32 s60, s52, 10
  s_add_u32 s60, s60, 0x0
  s_add_u32 m0, s60, 0
  s_nop 0
  buffer_load_dwordx4 v2, s[32:35], s70 offen lds
  s_add_u32 m0, s60, 4096
  s_nop 0
  buffer_load_dwordx4 v3, s[32:35], s70 offen lds
  s_add_u32 m0, s60, 8192
  s_nop 0
  buffer_load_dwordx4 v4, s[32:35], s70 offen lds
  s_add_u32 m0, s60, 12288
  s_nop 0
  buffer_load_dwordx4 v5, s[32:35], s70 offen lds
  s_add_u32 m0, s60, 16384
  s_nop 0
  buffer_load_dwordx4 v6, s[32:35], s70 offen lds
  s_add_u32 m0, s60, 20480
  s_nop 0
  buffer_load_dwordx4 v7, s[32:35], s70 offen lds
  s_add_u32 m0, s60, 24576
  s_nop 0
  buffer_load_dwordx4 v8, s[32:35], s70 offen lds
  s_add_u32 m0, s60, 28672
  s_nop 0
  buffer_load_dwordx4 v9, s[32:35], s70 offen lds
  s_add_u32 m0, s60, 32768
  s_nop 0
  buffer_load_dwordx4 v10, s[32:35], s70 offen lds
  s_add_u32 m0, s60, 36864
  s_nop 0
  buffer_load_dwordx4 v11, s[32:35], s70 offen lds
  s_add_u32 m0, s60, 40960
  s_nop 0
  buffer_load_dwordx4 v12, s[32:35], s70 offen lds
  s_add_u32 m0, s60, 45056
  s_nop 0
  buffer_load_dwordx4 v13, s[32:35], s70 offen lds
  s_add_u32 m0, s60, 49152
  s_nop 0
  buffer_load_dwordx4 v14, s[32:35], s70 offen lds
  s_add_u32 m0, s60, 53248
  s_nop 0
  buffer_load_dwordx4 v15, s[32:35], s70 offen lds
  s_add_u32 m0, s60, 57344
  s_nop 0
  buffer_load_dwordx4 v16, s[32:35], s70 offen lds
  s_add_u32 s70, s70, 614400
  s_lshl_b32 s60, s52, 10
  s_add_u32 s60, s60, 0xf000
  s_add_u32 m0, s60, 0
  s_nop 0
  buffer_load_dwordx4 v2, s[32:35], s70 offen lds
  s_add_u32 m0, s60, 4096
  s_nop 0
  buffer_load_dwordx4 v3, s[32:35], s70 offen lds
  s_add_u32 m0, s60, 8192
  s_nop 0
  buffer_load_dwordx4 v4, s[32:35], s70 offen lds
  s_add_u32 m0, s60, 12288
  s_nop 0
  buffer_load_dwordx4 v5, s[32:35], s70 offen lds
  s_add_u32 m0, s60, 16384
  s_nop 0
  buffer_load_dwordx4 v6, s[32:35], s70 offen lds
  s_add_u32 m0, s60, 20480
  s_nop 0
  buffer_load_dwordx4 v7, s[32:35], s70 offen lds
  s_add_u32 m0, s60, 24576
  s_nop 0
  buffer_load_dwordx4 v8, s[32:35], s70 offen lds
  s_add_u32 m0, s60, 28672
  s_nop 0
  buffer_load_dwordx4 v9, s[32:35], s70 offen lds
  s_add_u32 m0, s60, 32768
  s_nop 0
  buffer_load_dwordx4 v10, s[32:35], s70 offen lds
  s_add_u32 m0, s60, 36864
  s_nop 0
  buffer_load_dwordx4 v11, s[32:35], s70 offen lds
  s_add_u32 m0, s60, 40960
  s_nop 0
  buffer_load_dwordx4 v12, s[32:35], s70 offen lds
  s_add_u32 m0, s60, 45056
  s_nop 0
  buffer_load_dwordx4 v13, s[32:35], s70 offen lds
  s_add_u32 m0, s60, 49152
  s_nop 0
  buffer_load_dwordx4 v14, s[32:35], s70 offen lds
  s_add_u32 m0, s60, 53248
  s_nop 0
  buffer_load_dwordx4 v15, s[32:35], s70 offen lds
  s_add_u32 m0, s60, 57344
  s_nop 0
  buffer_load_dwordx4 v16, s[32:35], s70 offen lds
  s_waitcnt vmcnt(15)
  s_barrier
  ds_read_b64_tr_b16 a[0:1], v26 offset:0
  ds_read_b64_tr_b16 a[2:3], v26 offset:1536
  ds_read_b64_tr_b16 a[4:5], v26 offset:12288
  ds_read_b64_tr_b16 a[6:7], v26 offset:13824
  ds_read_b64_tr_b16 a[8:9], v26 offset:24576
  ds_read_b64_tr_b16 a[10:11], v26 offset:26112
  s_waitcnt lgkmcnt(4)
  ds_read_b64_tr_b16 a[12:13], v26 offset:36864
  ds_read_b64_tr_b16 a[14:15], v26 offset:38400
  ds_read_b64_tr_b16 a[16:17], v26 offset:49152
  ds_read_b64_tr_b16 a[18:19], v26 offset:50688
  s_waitcnt lgkmcnt(4)
  ds_read_b64_tr_b16 a[80:81], v27 offset:0
  ds_read_b64_tr_b16 a[82:83], v27 offset:1536
  ds_read_b64_tr_b16 a[84:85], v27 offset:12288
  ds_read_b64_tr_b16 a[86:87], v27 offset:13824
  ds_read_b64_tr_b16 a[88:89], v27 offset:24576
  ds_read_b64_tr_b16 a[90:91], v27 offset:26112
  s_waitcnt lgkmcnt(4)
  ds_read_b64_tr_b16 a[92:93], v27 offset:36864
  ds_read_b64_tr_b16 a[94:95], v27 offset:38400
  ds_read_b64_tr_b16 a[96:97], v27 offset:49152
  ds_read_b64_tr_b16 a[98:99], v27 offset:50688
  s_waitcnt lgkmcnt(4)
  ds_read_b64_tr_b16 a[160:161], v28 offset:0
  ds_read_b64_tr_b16 a[162:163], v28 offset:1536
  ds_read_b64_tr_b16 a[164:165], v28 offset:12288
  ds_read_b64_tr_b16 a[166:167], v28 offset:13824
  ds_read_b64_tr_b16 a[168:169], v28 offset:24576
  ds_read_b64_tr_b16 a[170:171], v28 offset:26112
  s_waitcnt lgkmcnt(4)
  ds_read_b64_tr_b16 a[172:173], v28 offset:36864
  ds_read_b64_tr_b16 a[174:175], v28 offset:38400
  ds_read_b64_tr_b16 a[176:177], v28 offset:49152
  ds_read_b64_tr_b16 a[178:179], v28 offset:50688
  s_waitcnt lgkmcnt(4)
  s_waitcnt lgkmcnt(0)
  v_add_u32 v26, 61440, v26
  v_add_u32 v27, 61440, v27
  v_add_u32 v28, 61440, v28
  s_barrier
  s_add_u32 s70, s70, 614400
  s_lshl_b32 s60, s52, 10
  s_add_u32 s60, s60, 0x0
  s_add_u32 m0, s60, 0
  s_nop 0
  buffer_load_dwordx4 v2, s[32:35], s70 offen lds
  s_add_u32 m0, s60, 4096
  s_nop 0
  buffer_load_dwordx4 v3, s[32:35], s70 offen lds
  s_add_u32 m0, s60, 8192
  s_nop 0
  buffer_load_dwordx4 v4, s[32:35], s70 offen lds
  s_add_u32 m0, s60, 12288
  s_nop 0
  buffer_load_dwordx4 v5, s[32:35], s70 offen lds
  s_add_u32 m0, s60, 16384
  s_nop 0
  buffer_load_dwordx4 v6, s[32:35], s70 offen lds
  s_add_u32 m0, s60, 20480
  s_nop 0
  buffer_load_dwordx4 v7, s[32:35], s70 offen lds
  s_add_u32 m0, s60, 24576
  s_nop 0
  buffer_load_dwordx4 v8, s[32:35], s70 offen lds
  s_add_u32 m0, s60, 28672
  s_nop 0
  buffer_load_dwordx4 v9, s[32:35], s70 offen lds
  s_add_u32 m0, s60, 32768
  s_nop 0
  buffer_load_dwordx4 v10, s[32:35], s70 offen lds
  s_add_u32 m0, s60, 36864
  s_nop 0
  buffer_load_dwordx4 v11, s[32:35], s70 offen lds
  s_add_u32 m0, s60, 40960
  s_nop 0
  buffer_load_dwordx4 v12, s[32:35], s70 offen lds
  s_add_u32 m0, s60, 45056
  s_nop 0
  buffer_load_dwordx4 v13, s[32:35], s70 offen lds
  s_add_u32 m0, s60, 49152
  s_nop 0
  buffer_load_dwordx4 v14, s[32:35], s70 offen lds
  s_add_u32 m0, s60, 53248
  s_nop 0
  buffer_load_dwordx4 v15, s[32:35], s70 offen lds
  s_add_u32 m0, s60, 57344
  s_nop 0
  buffer_load_dwordx4 v16, s[32:35], s70 offen lds
  s_waitcnt vmcnt(15)
  s_barrier
  ds_read_b64_tr_b16 a[20:21], v26 offset:0
  ds_read_b64_tr_b16 a[22:23], v26 offset:1536
  ds_read_b64_tr_b16 a[24:25], v26 offset:12288
  ds_read_b64_tr_b16 a[26:27], v26 offset:13824
  ds_read_b64_tr_b16 a[28:29], v26 offset:24576
  ds_read_b64_tr_b16 a[30:31], v26 offset:26112
  s_waitcnt lgkmcnt(4)
  ds_read_b64_tr_b16 a[32:33], v26 offset:36864
  ds_read_b64_tr_b16 a[34:35], v26 offset:38400
  ds_read_b64_tr_b16 a[36:37], v26 offset:49152
  ds_read_b64_tr_b16 a[38:39], v26 offset:50688
  s_waitcnt lgkmcnt(4)
  ds_read_b64_tr_b16 a[100:101], v27 offset:0
  ds_read_b64_tr_b16 a[102:103], v27 offset:1536
  ds_read_b64_tr_b16 a[104:105], v27 offset:12288
  ds_read_b64_tr_b16 a[106:107], v27 offset:13824
  ds_read_b64_tr_b16 a[108:109], v27 offset:24576
  ds_read_b64_tr_b16 a[110:111], v27 offset:26112
  s_waitcnt lgkmcnt(4)
  ds_read_b64_tr_b16 a[112:113], v27 offset:36864
  ds_read_b64_tr_b16 a[114:115], v27 offset:38400
  ds_read_b64_tr_b16 a[116:117], v27 offset:49152
  ds_read_b64_tr_b16 a[118:119], v27 offset:50688
  s_waitcnt lgkmcnt(4)
  ds_read_b64_tr_b16 a[180:181], v28 offset:0
  ds_read_b64_tr_b16 a[182:183], v28 offset:1536
  ds_read_b64_tr_b16 a[184:185], v28 offset:12288
  ds_read_b64_tr_b16 a[186:187], v28 offset:13824
  ds_read_b64_tr_b16 a[188:189], v28 offset:24576
  ds_read_b64_tr_b16 a[190:191], v28 offset:26112
  s_waitcnt lgkmcnt(4)
  ds_read_b64_tr_b16 a[192:193], v28 offset:36864
  ds_read_b64_tr_b16 a[194:195], v28 offset:38400
  ds_read_b64_tr_b16 a[196:197], v28 offset:49152
  ds_read_b64_tr_b16 a[198:199], v28 offset:50688
  s_waitcnt lgkmcnt(4)
  s_waitcnt lgkmcnt(0)
  v_subrev_u32 v26, 61440, v26
  v_subrev_u32 v27, 61440, v27
  v_subrev_u32 v28, 61440, v28
  s_barrier
  s_add_u32 s70, s70, 614400
  s_lshl_b32 s60, s52, 10
  s_add_u32 s60, s60, 0xf000
  s_add_u32 m0, s60, 0
  s_nop 0
  buffer_load_dwordx4 v2, s[32:35], s70 offen lds
  s_add_u32 m0, s60, 4096
  s_nop 0
  buffer_load_dwordx4 v3, s[32:35], s70 offen lds
  s_add_u32 m0, s60, 8192
  s_nop 0
  buffer_load_dwordx4 v4, s[32:35], s70 offen lds
  s_add_u32 m0, s60, 12288
  s_nop 0
  buffer_load_dwordx4 v5, s[32:35], s70 offen lds
  s_add_u32 m0, s60, 16384
  s_nop 0
  buffer_load_dwordx4 v6, s[32:35], s70 offen lds
  s_add_u32 m0, s60, 20480
  s_nop 0
  buffer_load_dwordx4 v7, s[32:35], s70 offen lds
  s_add_u32 m0, s60, 24576
  s_nop 0
  buffer_load_dwordx4 v8, s[32:35], s70 offen lds
  s_add_u32 m0, s60, 28672
  s_nop 0
  buffer_load_dwordx4 v9, s[32:35], s70 offen lds
  s_add_u32 m0, s60, 32768
  s_nop 0
  buffer_load_dwordx4 v10, s[32:35], s70 offen lds
  s_add_u32 m0, s60, 36864
  s_nop 0
  buffer_load_dwordx4 v11, s[32:35], s70 offen lds
  s_add_u32 m0, s60, 40960
  s_nop 0
  buffer_load_dwordx4 v12, s[32:35], s70 offen lds
  s_add_u32 m0, s60, 45056
  s_nop 0
  buffer_load_dwordx4 v13, s[32:35], s70 offen lds
  s_add_u32 m0, s60, 49152
  s_nop 0
  buffer_load_dwordx4 v14, s[32:35], s70 offen lds
  s_add_u32 m0, s60, 53248
  s_nop 0
  buffer_load_dwordx4 v15, s[32:35], s70 offen lds
  s_add_u32 m0, s60, 57344
  s_nop 0
  buffer_load_dwordx4 v16, s[32:35], s70 offen lds
  s_waitcnt vmcnt(15)
  s_barrier
  ds_read_b64_tr_b16 a[40:41], v26 offset:0
  ds_read_b64_tr_b16 a[42:43], v26 offset:1536
  ds_read_b64_tr_b16 a[44:45], v26 offset:12288
  ds_read_b64_tr_b16 a[46:47], v26 offset:13824
  ds_read_b64_tr_b16 a[48:49], v26 offset:24576
  ds_read_b64_tr_b16 a[50:51], v26 offset:26112
  s_waitcnt lgkmcnt(4)
  ds_read_b64_tr_b16 a[52:53], v26 offset:36864
  ds_read_b64_tr_b16 a[54:55], v26 offset:38400
  ds_read_b64_tr_b16 a[56:57], v26 offset:49152
  ds_read_b64_tr_b16 a[58:59], v26 offset:50688
  s_waitcnt lgkmcnt(4)
  ds_read_b64_tr_b16 a[120:121], v27 offset:0
  ds_read_b64_tr_b16 a[122:123], v27 offset:1536
  ds_read_b64_tr_b16 a[124:125], v27 offset:12288
  ds_read_b64_tr_b16 a[126:127], v27 offset:13824
  ds_read_b64_tr_b16 a[128:129], v27 offset:24576
  ds_read_b64_tr_b16 a[130:131], v27 offset:26112
  s_waitcnt lgkmcnt(4)
  ds_read_b64_tr_b16 a[132:133], v27 offset:36864
  ds_read_b64_tr_b16 a[134:135], v27 offset:38400
  ds_read_b64_tr_b16 a[136:137], v27 offset:49152
  ds_read_b64_tr_b16 a[138:139], v27 offset:50688
  s_waitcnt lgkmcnt(4)
  ds_read_b64_tr_b16 a[200:201], v28 offset:0
  ds_read_b64_tr_b16 a[202:203], v28 offset:1536
  ds_read_b64_tr_b16 a[204:205], v28 offset:12288
  ds_read_b64_tr_b16 a[206:207], v28 offset:13824
  ds_read_b64_tr_b16 a[208:209], v28 offset:24576
  ds_read_b64_tr_b16 a[210:211], v28 offset:26112
  s_waitcnt lgkmcnt(4)
  ds_read_b64_tr_b16 a[212:213], v28 offset:36864
  ds_read_b64_tr_b16 a[214:215], v28 offset:38400
  ds_read_b64_tr_b16 a[216:217], v28 offset:49152
  ds_read_b64_tr_b16 a[218:219], v28 offset:50688
  s_waitcnt lgkmcnt(4)
  s_waitcnt lgkmcnt(0)
  v_add_u32 v26, 61440, v26
  v_add_u32 v27, 61440, v27
  v_add_u32 v28, 61440, v28
  s_barrier
  s_waitcnt vmcnt(0)
  s_barrier
  ds_read_b64_tr_b16 a[60:61], v26 offset:0
  ds_read_b64_tr_b16 a[62:63], v26 offset:1536
  ds_read_b64_tr_b16 a[64:65], v26 offset:12288
  ds_read_b64_tr_b16 a[66:67], v26 offset:13824
  ds_read_b64_tr_b16 a[68:69], v26 offset:24576
  ds_read_b64_tr_b16 a[70:71], v26 offset:26112
  s_waitcnt lgkmcnt(4)
  ds_read_b64_tr_b16 a[72:73], v26 offset:36864
  ds_read_b64_tr_b16 a[74:75], v26 offset:38400
  ds_read_b64_tr_b16 a[76:77], v26 offset:49152
  ds_read_b64_tr_b16 a[78:79], v26 offset:50688
  s_waitcnt lgkmcnt(4)
  ds_read_b64_tr_b16 a[140:141], v27 offset:0
  ds_read_b64_tr_b16 a[142:143], v27 offset:1536
  ds_read_b64_tr_b16 a[144:145], v27 offset:12288
  ds_read_b64_tr_b16 a[146:147], v27 offset:13824
  ds_read_b64_tr_b16 a[148:149], v27 offset:24576
  ds_read_b64_tr_b16 a[150:151], v27 offset:26112
  s_waitcnt lgkmcnt(4)
  ds_read_b64_tr_b16 a[152:153], v27 offset:36864
  ds_read_b64_tr_b16 a[154:155], v27 offset:38400
  ds_read_b64_tr_b16 a[156:157], v27 offset:49152
  ds_read_b64_tr_b16 a[158:159], v27 offset:50688
  s_waitcnt lgkmcnt(4)
  ds_read_b64_tr_b16 a[220:221], v28 offset:0
  ds_read_b64_tr_b16 a[222:223], v28 offset:1536
  ds_read_b64_tr_b16 a[224:225], v28 offset:12288
  ds_read_b64_tr_b16 a[226:227], v28 offset:13824
  ds_read_b64_tr_b16 a[228:229], v28 offset:24576
  ds_read_b64_tr_b16 a[230:231], v28 offset:26112
  s_waitcnt lgkmcnt(4)
  ds_read_b64_tr_b16 a[232:233], v28 offset:36864
  ds_read_b64_tr_b16 a[234:235], v28 offset:38400
  ds_read_b64_tr_b16 a[236:237], v28 offset:49152
  ds_read_b64_tr_b16 a[238:239], v28 offset:50688
  s_waitcnt lgkmcnt(4)
  s_waitcnt lgkmcnt(0)
  v_subrev_u32 v26, 61440, v26
  v_subrev_u32 v27, 61440, v27
  v_subrev_u32 v28, 61440, v28
  s_barrier
  s_mul_i32 s58, s78, 192
  s_mul_i32 s59, s52, 48
  s_add_u32 s58, s58, s59
  s_add_u32 s58, s58, 0
  v_lshrrev_b32 v18, 4, v1
  v_lshlrev_b32 v18, 2, v18
  v_add_u32 v18, s58, v18
  v_mov_b32 v19, 0
  v_mov_b32 v20, 1
  v_cmp_le_u32 vcc, 640, v18
  s_nop 1
  v_cndmask_b32 v19, v19, v20, vcc
  v_mov_b32 v20, 2
  v_cmp_le_u32 vcc, 1280, v18
  s_nop 1
  v_cndmask_b32 v19, v19, v20, vcc
  v_mul_u32_u24 v20, 640, v19
  v_sub_u32 v18, v18, v20
  v_mul_u32_u24 v2, 3145728, v19
  v_cmp_eq_u32 vcc, 0, v19
  v_mov_b32 v20, 0x3ea52b5c
  v_mov_b32 v21, 1.0
  v_cndmask_b32 v5, v21, v20, vcc
  v_mul_u32_u24 v19, 3277, v18
  v_lshrrev_b32 v19, 16, v19
  v_mul_u32_u24 v20, 20, v19
  v_sub_u32 v18, v18, v20
  v_mul_u32_u24 v19, 98304, v19
  v_add_u32 v2, v2, v19
  v_cmp_eq_u32 vcc, 16, v18
  v_lshlrev_b32 v18, 1, v18
  v_add_u32 v2, v2, v18
  s_mov_b64 s[72:73], vcc
  v_and_b32 v18, 15, v1
  v_mul_u32_u24 v18, 48, v18
  v_add_u32 v2, v2, v18
  s_mul_i32 s58, s78, 192
  s_mul_i32 s59, s52, 48
  s_add_u32 s58, s58, s59
  s_add_u32 s58, s58, 16
  v_lshrrev_b32 v18, 4, v1
  v_lshlrev_b32 v18, 2, v18
  v_add_u32 v18, s58, v18
  v_mov_b32 v19, 0
  v_mov_b32 v20, 1
  v_cmp_le_u32 vcc, 640, v18
  s_nop 1
  v_cndmask_b32 v19, v19, v20, vcc
  v_mov_b32 v20, 2
  v_cmp_le_u32 vcc, 1280, v18
  s_nop 1
  v_cndmask_b32 v19, v19, v20, vcc
  v_mul_u32_u24 v20, 640, v19
  v_sub_u32 v18, v18, v20
  v_mul_u32_u24 v3, 3145728, v19
  v_cmp_eq_u32 vcc, 0, v19
  v_mov_b32 v20, 0x3ea52b5c
  v_mov_b32 v21, 1.0
  v_cndmask_b32 v6, v21, v20, vcc
  v_mul_u32_u24 v19, 3277, v18
  v_lshrrev_b32 v19, 16, v19
  v_mul_u32_u24 v20, 20, v19
  v_sub_u32 v18, v18, v20
  v_mul_u32_u24 v19, 98304, v19
  v_add_u32 v3, v3, v19
  v_cmp_eq_u32 vcc, 16, v18
  v_lshlrev_b32 v18, 1, v18
  v_add_u32 v3, v3, v18
  s_mov_b64 s[74:75], vcc
  v_and_b32 v18, 15, v1
  v_mul_u32_u24 v18, 48, v18
  v_add_u32 v3, v3, v18
  s_mul_i32 s58, s78, 192
  s_mul_i32 s59, s52, 48
  s_add_u32 s58, s58, s59
  s_add_u32 s58, s58, 32
  v_lshrrev_b32 v18, 4, v1
  v_lshlrev_b32 v18, 2, v18
  v_add_u32 v18, s58, v18
  v_mov_b32 v19, 0
  v_mov_b32 v20, 1
  v_cmp_le_u32 vcc, 640, v18
  s_nop 1
  v_cndmask_b32 v19, v19, v20, vcc
  v_mov_b32 v20, 2
  v_cmp_le_u32 vcc, 1280, v18
  s_nop 1
  v_cndmask_b32 v19, v19, v20, vcc
  v_mul_u32_u24 v20, 640, v19
  v_sub_u32 v18, v18, v20
  v_mul_u32_u24 v4, 3145728, v19
  v_cmp_eq_u32 vcc, 0, v19
  v_mov_b32 v20, 0x3ea52b5c
  v_mov_b32 v21, 1.0
  v_cndmask_b32 v7, v21, v20, vcc
  v_mul_u32_u24 v19, 3277, v18
  v_lshrrev_b32 v19, 16, v19
  v_mul_u32_u24 v20, 20, v19
  v_sub_u32 v18, v18, v20
  v_mul_u32_u24 v19, 98304, v19
  v_add_u32 v4, v4, v19
  v_cmp_eq_u32 vcc, 16, v18
  v_lshlrev_b32 v18, 1, v18
  v_add_u32 v4, v4, v18
  s_mov_b64 s[76:77], vcc
  v_and_b32 v18, 15, v1
  v_mul_u32_u24 v18, 48, v18
  v_add_u32 v4, v4, v18
  v_mov_b32 v8, 0x3f80
  v_mov_b32 v9, 0
  s_mul_i32 s66, s62, 1536
  s_add_u32 s66, s66, 0x7600000
  s_mov_b32 s71, 0xfffe2000
L_b1_i:
  s_waitcnt vmcnt(12)
  s_barrier
  s_add_u32 s58, s62, 1
  s_cmp_lt_u32 s58, s63
  s_cselect_b32 s58, 40960, 0
  s_add_u32 s64, s64, s58
  s_add_u32 s65, s65, s71
  ds_read_b128 v[32:35], v102 offset:0
  ds_read_b128 v[36:39], v102 offset:20480
  ds_read_b128 v[40:43], v103 offset:0
  ds_read_b128 v[44:47], v103 offset:20480
  ds_read_b128 v[48:51], v104 offset:0
  ds_read_b128 v[52:55], v104 offset:20480
  s_waitcnt lgkmcnt(4)
  v_mfma_f32_16x16x32_bf16 v[56:59], a[0:3], v[32:35], 0
  v_mfma_f32_16x16x32_bf16 v[64:67], a[80:83], v[32:35], 0
  v_mfma_f32_16x16x32_bf16 v[72:75], a[160:163], v[32:35], 0
  v_mfma_f32_16x16x32_bf16 v[60:63], a[0:3], v[36:39], 0
  v_mfma_f32_16x16x32_bf16 v[68:71], a[80:83], v[36:39], 0
  v_mfma_f32_16x16x32_bf16 v[76:79], a[160:163], v[36:39], 0
  ds_read_b128 v[32:35], v105 offset:0
  ds_read_b128 v[36:39], v105 offset:20480
  s_waitcnt lgkmcnt(4)
  v_mfma_f32_16x16x32_bf16 v[56:59], a[4:7], v[40:43], v[56:59]
  s_add_u32 m0, s65, 0
  s_nop 0
  buffer_load_dwordx4 v92, s[28:31], s64 offen lds
  v_mfma_f32_16x16x32_bf16 v[64:67], a[84:87], v[40:43], v[64:67]
  v_mfma_f32_16x16x32_bf16 v[72:75], a[164:167], v[40:43], v[72:75]
  v_mfma_f32_16x16x32_bf16 v[60:63], a[4:7], v[44:47], v[60:63]
  v_mfma_f32_16x16x32_bf16 v[68:71], a[84:87], v[44:47], v[68:71]
  v_mfma_f32_16x16x32_bf16 v[76:79], a[164:167], v[44:47], v[76:79]
  ds_read_b128 v[40:43], v102 offset:256
  ds_read_b128 v[44:47], v102 offset:20736
  s_waitcnt lgkmcnt(4)
  v_mfma_f32_16x16x32_bf16 v[56:59], a[8:11], v[48:51], v[56:59]
  v_mfma_f32_16x16x32_bf16 v[64:67], a[88:91], v[48:51], v[64:67]
  v_mfma_f32_16x16x32_bf16 v[72:75], a[168:171], v[48:51], v[72:75]
  v_mfma_f32_16x16x32_bf16 v[60:63], a[8:11], v[52:55], v[60:63]
  v_mfma_f32_16x16x32_bf16 v[68:71], a[88:91], v[52:55], v[68:71]
  s_add_u32 m0, s65, 1024
  s_nop 0
  buffer_load_dwordx4 v93, s[28:31], s64 offen lds
  v_mfma_f32_16x16x32_bf16 v[76:79], a[168:171], v[52:55], v[76:79]
  ds_read_b128 v[48:51], v103 offset:256
  ds_read_b128 v[52:55], v103 offset:20736
  s_waitcnt lgkmcnt(4)
  v_mfma_f32_16x16x32_bf16 v[56:59], a[12:15], v[32:35], v[56:59]
  v_mfma_f32_16x16x32_bf16 v[64:67], a[92:95], v[32:35], v[64:67]
  v_mfma_f32_16x16x32_bf16 v[72:75], a[172:175], v[32:35], v[72:75]
  v_mfma_f32_16x16x32_bf16 v[60:63], a[12:15], v[36:39], v[60:63]
  v_mfma_f32_16x16x32_bf16 v[68:71], a[92:95], v[36:39], v[68:71]
  v_mfma_f32_16x16x32_bf16 v[76:79], a[172:175], v[36:39], v[76:79]
  ds_read_b128 v[32:35], v104 offset:256
  ds_read_b128 v[36:39], v104 offset:20736
  s_waitcnt lgkmcnt(4)
  v_mfma_f32_16x16x32_bf16 v[56:59], a[16:19], v[40:43], v[56:59]
  v_mfma_f32_16x16x32_bf16 v[64:67], a[96:99], v[40:43], v[64:67]
  v_mfma_f32_16x16x32_bf16 v[72:75], a[176:179], v[40:43], v[72:75]
  s_add_u32 m0, s65, 2048
  s_nop 0
  buffer_load_dwordx4 v94, s[28:31], s64 offen lds
  v_mfma_f32_16x16x32_bf16 v[60:63], a[16:19], v[44:47], v[60:63]
  v_mfma_f32_16x16x32_bf16 v[68:71], a[96:99], v[44:47], v[68:71]
  v_mfma_f32_16x16x32_bf16 v[76:79], a[176:179], v[44:47], v[76:79]
  ds_read_b128 v[40:43], v105 offset:256
  ds_read_b128 v[44:47], v105 offset:20736
  s_waitcnt lgkmcnt(4)
  v_mfma_f32_16x16x32_bf16 v[56:59], a[20:23], v[48:51], v[56:59]
  v_mfma_f32_16x16x32_bf16 v[64:67], a[100:103], v[48:51], v[64:67]
  v_mfma_f32_16x16x32_bf16 v[72:75], a[180:183], v[48:51], v[72:75]
  v_mfma_f32_16x16x32_bf16 v[60:63], a[20:23], v[52:55], v[60:63]
  v_mfma_f32_16x16x32_bf16 v[68:71], a[100:103], v[52:55], v[68:71]
  v_mfma_f32_16x16x32_bf16 v[76:79], a[180:183], v[52:55], v[76:79]
  ds_read_b128 v[48:51], v102 offset:512
  ds_read_b128 v[52:55], v102 offset:20992
  s_waitcnt lgkmcnt(4)
  v_mfma_f32_16x16x32_bf16 v[56:59], a[24:27], v[32:35], v[56:59]
  s_add_u32 m0, s65, 3072
  s_nop 0
  buffer_load_dwordx4 v95, s[28:31], s64 offen lds
  v_mfma_f32_16x16x32_bf16 v[64:67], a[104:107], v[32:35], v[64:67]
  v_mfma_f32_16x16x32_bf16 v[72:75], a[184:187], v[32:35], v[72:75]
  v_mfma_f32_16x16x32_bf16 v[60:63], a[24:27], v[36:39], v[60:63]
  v_mfma_f32_16x16x32_bf16 v[68:71], a[104:107], v[36:39], v[68:71]
  v_mfma_f32_16x16x32_bf16 v[76:79], a[184:187], v[36:39], v[76:79]
  ds_read_b128 v[32:35], v103 offset:512
  ds_read_b128 v[36:39], v103 offset:20992
  s_waitcnt lgkmcnt(4)
  v_mfma_f32_16x16x32_bf16 v[56:59], a[28:31], v[40:43], v[56:59]
  v_mfma_f32_16x16x32_bf16 v[64:67], a[108:111], v[40:43], v[64:67]
  v_mfma_f32_16x16x32_bf16 v[72:75], a[188:191], v[40:43], v[72:75]
  v_mfma_f32_16x16x32_bf16 v[60:63], a[28:31], v[44:47], v[60:63]
  v_mfma_f32_16x16x32_bf16 v[68:71], a[108:111], v[44:47], v[68:71]
  s_add_u32 m0, s65, 4096
  s_nop 0
  buffer_load_dwordx4 v96, s[28:31], s64 offen lds
  v_mfma_f32_16x16x32_bf16 v[76:79], a[188:191], v[44:47], v[76:79]
  ds_read_b128 v[40:43], v104 offset:512
  ds_read_b128 v[44:47], v104 offset:20992
  s_waitcnt lgkmcnt(4)
  v_mfma_f32_16x16x32_bf16 v[56:59], a[32:35], v[48:51], v[56:59]
  v_mfma_f32_16x16x32_bf16 v[64:67], a[112:115], v[48:51], v[64:67]
  v_mfma_f32_16x16x32_bf16 v[72:75], a[192:195], v[48:51], v[72:75]
  v_mfma_f32_16x16x32_bf16 v[60:63], a[32:35], v[52:55], v[60:63]
  v_mfma_f32_16x16x32_bf16 v[68:71], a[112:115], v[52:55], v[68:71]
  v_mfma_f32_16x16x32_bf16 v[76:79], a[192:195], v[52:55], v[76:79]
  ds_read_b128 v[48:51], v105 offset:512
  ds_read_b128 v[52:55], v105 offset:20992
  s_waitcnt lgkmcnt(4)
  v_mfma_f32_16x16x32_bf16 v[56:59], a[36:39], v[32:35], v[56:59]
  v_mfma_f32_16x16x32_bf16 v[64:67], a[116:119], v[32:35], v[64:67]
  v_mfma_f32_16x16x32_bf16 v[72:75], a[196:199], v[32:35], v[72:75]
  s_add_u32 m0, s65, 5120
  s_nop 0
  buffer_load_dwordx4 v97, s[28:31], s64 offen lds
  v_mfma_f32_16x16x32_bf16 v[60:63], a[36:39], v[36:39], v[60:63]
  v_mfma_f32_16x16x32_bf16 v[68:71], a[116:119], v[36:39], v[68:71]
  v_mfma_f32_16x16x32_bf16 v[76:79], a[196:199], v[36:39], v[76:79]
  ds_read_b128 v[32:35], v102 offset:768
  ds_read_b128 v[36:39], v102 offset:21248
  s_waitcnt lgkmcnt(4)
  v_mfma_f32_16x16x32_bf16 v[56:59], a[40:43], v[40:43], v[56:59]
  v_mfma_f32_16x16x32_bf16 v[64:67], a[120:123], v[40:43], v[64:67]
  v_mfma_f32_16x16x32_bf16 v[72:75], a[200:203], v[40:43], v[72:75]
  v_mfma_f32_16x16x32_bf16 v[60:63], a[40:43], v[44:47], v[60:63]
  v_mfma_f32_16x16x32_bf16 v[68:71], a[120:123], v[44:47], v[68:71]
  v_mfma_f32_16x16x32_bf16 v[76:79], a[200:203], v[44:47], v[76:79]
  ds_read_b128 v[40:43], v103 offset:768
  ds_read_b128 v[44:47], v103 offset:21248
  s_waitcnt lgkmcnt(4)
  v_mfma_f32_16x16x32_bf16 v[56:59], a[44:47], v[48:51], v[56:59]
  s_add_u32 m0, s65, 6144
  s_nop 0
  buffer_load_dwordx4 v98, s[28:31], s64 offen lds
  v_mfma_f32_16x16x32_bf16 v[64:67], a[124:127], v[48:51], v[64:67]
  v_mfma_f32_16x16x32_bf16 v[72:75], a[204:207], v[48:51], v[72:75]
  v_mfma_f32_16x16x32_bf16 v[60:63], a[44:47], v[52:55], v[60:63]
  v_mfma_f32_16x16x32_bf16 v[68:71], a[124:127], v[52:55], v[68:71]
  v_mfma_f32_16x16x32_bf16 v[76:79], a[204:207], v[52:55], v[76:79]
  ds_read_b128 v[48:51], v104 offset:768
  ds_read_b128 v[52:55], v104 offset:21248
  s_waitcnt lgkmcnt(4)
  v_mfma_f32_16x16x32_bf16 v[56:59], a[48:51], v[32:35], v[56:59]
  v_mfma_f32_16x16x32_bf16 v[64:67], a[128:131], v[32:35], v[64:67]
  v_mfma_f32_16x16x32_bf16 v[72:75], a[208:211], v[32:35], v[72:75]
  v_mfma_f32_16x16x32_bf16 v[60:63], a[48:51], v[36:39], v[60:63]
  v_mfma_f32_16x16x32_bf16 v[68:71], a[128:131], v[36:39], v[68:71]
  s_add_u32 m0, s65, 7168
  s_nop 0
  buffer_load_dwordx4 v99, s[28:31], s64 offen lds
  v_mfma_f32_16x16x32_bf16 v[76:79], a[208:211], v[36:39], v[76:79]
  ds_read_b128 v[32:35], v105 offset:768
  ds_read_b128 v[36:39], v105 offset:21248
  s_waitcnt lgkmcnt(4)
  v_mfma_f32_16x16x32_bf16 v[56:59], a[52:55], v[40:43], v[56:59]
  v_mfma_f32_16x16x32_bf16 v[64:67], a[132:135], v[40:43], v[64:67]
  v_mfma_f32_16x16x32_bf16 v[72:75], a[212:215], v[40:43], v[72:75]
  v_mfma_f32_16x16x32_bf16 v[60:63], a[52:55], v[44:47], v[60:63]
  v_mfma_f32_16x16x32_bf16 v[68:71], a[132:135], v[44:47], v[68:71]
  v_mfma_f32_16x16x32_bf16 v[76:79], a[212:215], v[44:47], v[76:79]
  ds_read_b128 v[40:43], v102 offset:1024
  ds_read_b128 v[44:47], v102 offset:21504
  s_waitcnt lgkmcnt(4)
  v_mfma_f32_16x16x32_bf16 v[56:59], a[56:59], v[48:51], v[56:59]
  v_mfma_f32_16x16x32_bf16 v[64:67], a[136:139], v[48:51], v[64:67]
  v_mfma_f32_16x16x32_bf16 v[72:75], a[216:219], v[48:51], v[72:75]
  s_add_u32 m0, s65, 8192
  s_nop 0
  buffer_load_dwordx4 v100, s[28:31], s64 offen lds
  v_mfma_f32_16x16x32_bf16 v[60:63], a[56:59], v[52:55], v[60:63]
  v_mfma_f32_16x16x32_bf16 v[68:71], a[136:139], v[52:55], v[68:71]
  v_mfma_f32_16x16x32_bf16 v[76:79], a[216:219], v[52:55], v[76:79]
  ds_read_b128 v[48:51], v103 offset:1024
  ds_read_b128 v[52:55], v103 offset:21504
  s_waitcnt lgkmcnt(4)
  v_mfma_f32_16x16x32_bf16 v[56:59], a[60:63], v[32:35], v[56:59]
  v_mfma_f32_16x16x32_bf16 v[64:67], a[140:143], v[32:35], v[64:67]
  v_mfma_f32_16x16x32_bf16 v[72:75], a[220:223], v[32:35], v[72:75]
  v_mfma_f32_16x16x32_bf16 v[60:63], a[60:63], v[36:39], v[60:63]
  v_mfma_f32_16x16x32_bf16 v[68:71], a[140:143], v[36:39], v[68:71]
  v_mfma_f32_16x16x32_bf16 v[76:79], a[220:223], v[36:39], v[76:79]
  ds_read_b128 v[32:35], v104 offset:1024
  ds_read_b128 v[36:39], v104 offset:21504
  s_waitcnt lgkmcnt(4)
  v_mfma_f32_16x16x32_bf16 v[56:59], a[64:67], v[40:43], v[56:59]
  s_add_u32 m0, s65, 9216
  s_nop 0
  buffer_load_dwordx4 v101, s[28:31], s64 offen lds
  v_mfma_f32_16x16x32_bf16 v[64:67], a[144:147], v[40:43], v[64:67]
  v_mfma_f32_16x16x32_bf16 v[72:75], a[224:227], v[40:43], v[72:75]
  v_mfma_f32_16x16x32_bf16 v[60:63], a[64:67], v[44:47], v[60:63]
  v_mfma_f32_16x16x32_bf16 v[68:71], a[144:147], v[44:47], v[68:71]
  v_mfma_f32_16x16x32_bf16 v[76:79], a[224:227], v[44:47], v[76:79]
  ds_read_b128 v[40:43], v105 offset:1024
  ds_read_b128 v[44:47], v105 offset:21504
  s_waitcnt lgkmcnt(4)
  v_mfma_f32_16x16x32_bf16 v[56:59], a[68:71], v[48:51], v[56:59]
  v_mfma_f32_16x16x32_bf16 v[64:67], a[148:151], v[48:51], v[64:67]
  v_mfma_f32_16x16x32_bf16 v[72:75], a[228:231], v[48:51], v[72:75]
  v_mfma_f32_16x16x32_bf16 v[60:63], a[68:71], v[52:55], v[60:63]
  v_mfma_f32_16x16x32_bf16 v[68:71], a[148:151], v[52:55], v[68:71]
  v_mfma_f32_16x16x32_bf16 v[76:79], a[228:231], v[52:55], v[76:79]
  s_waitcnt lgkmcnt(2)
  v_mfma_f32_16x16x32_bf16 v[56:59], a[72:75], v[32:35], v[56:59]
  v_mfma_f32_16x16x32_bf16 v[64:67], a[152:155], v[32:35], v[64:67]
  v_mfma_f32_16x16x32_bf16 v[72:75], a[232:235], v[32:35], v[72:75]
  v_mfma_f32_16x16x32_bf16 v[60:63], a[72:75], v[36:39], v[60:63]
  v_mfma_f32_16x16x32_bf16 v[68:71], a[152:155], v[36:39], v[68:71]
  v_mfma_f32_16x16x32_bf16 v[76:79], a[232:235], v[36:39], v[76:79]
  s_waitcnt lgkmcnt(0)
  v_mfma_f32_16x16x32_bf16 v[56:59], a[76:79], v[40:43], v[56:59]
  v_mfma_f32_16x16x32_bf16 v[64:67], a[156:159], v[40:43], v[64:67]
  v_mfma_f32_16x16x32_bf16 v[72:75], a[236:239], v[40:43], v[72:75]
  v_mfma_f32_16x16x32_bf16 v[60:63], a[76:79], v[44:47], v[60:63]
  v_mfma_f32_16x16x32_bf16 v[68:71], a[156:159], v[44:47], v[68:71]
  v_mfma_f32_16x16x32_bf16 v[76:79], a[236:239], v[44:47], v[76:79]
  v_add_u32 v102, s71, v102
  v_add_u32 v103, s71, v103
  v_add_u32 v104, s71, v104
  v_add_u32 v105, s71, v105
  s_sub_u32 s71, 0, s71
  s_nop 2
  v_mul_f32 v56, v56, v5
  v_mul_f32 v57, v57, v5
  v_mul_f32 v58, v58, v5
  v_mul_f32 v59, v59, v5
  v_cvt_pk_bf16_f32 v80, v56, v57
  v_cvt_pk_bf16_f32 v81, v58, v59
  buffer_store_dwordx2 v[80:81], v2, s[48:51], s66 offen offset:0 sc1
  v_mul_f32 v60, v60, v5
  v_mul_f32 v61, v61, v5
  v_mul_f32 v62, v62, v5
  v_mul_f32 v63, v63, v5
  v_cvt_pk_bf16_f32 v82, v60, v61
  v_cvt_pk_bf16_f32 v83, v62, v63
  buffer_store_dwordx2 v[82:83], v2, s[48:51], s66 offen offset:768 sc1
  v_mul_f32 v64, v64, v6
  v_mul_f32 v65, v65, v6
  v_mul_f32 v66, v66, v6
  v_mul_f32 v67, v67, v6
  v_cvt_pk_bf16_f32 v84, v64, v65
  v_cvt_pk_bf16_f32 v85, v66, v67
  buffer_store_dwordx2 v[84:85], v3, s[48:51], s66 offen offset:0 sc1
  v_mul_f32 v68, v68, v6
  v_mul_f32 v69, v69, v6
  v_mul_f32 v70, v70, v6
  v_mul_f32 v71, v71, v6
  v_cvt_pk_bf16_f32 v86, v68, v69
  v_cvt_pk_bf16_f32 v87, v70, v71
  buffer_store_dwordx2 v[86:87], v3, s[48:51], s66 offen offset:768 sc1
  v_mul_f32 v72, v72, v7
  v_mul_f32 v73, v73, v7
  v_mul_f32 v74, v74, v7
  v_mul_f32 v75, v75, v7
  v_cvt_pk_bf16_f32 v88, v72, v73
  v_cvt_pk_bf16_f32 v89, v74, v75
  buffer_store_dwordx2 v[88:89], v4, s[48:51], s66 offen offset:0 sc1
  v_mul_f32 v76, v76, v7
  v_mul_f32 v77, v77, v7
  v_mul_f32 v78, v78, v7
  v_mul_f32 v79, v79, v7
  v_cvt_pk_bf16_f32 v90, v76, v77
  v_cvt_pk_bf16_f32 v91, v78, v79
  buffer_store_dwordx2 v[90:91], v4, s[48:51], s66 offen offset:768 sc1
  s_mov_b64 exec, s[72:73]
  buffer_store_dwordx2 v[8:9], v2, s[48:51], s66 offen offset:8 sc1
  buffer_store_dwordx2 v[8:9], v2, s[48:51], s66 offen offset:776 sc1
  s_mov_b64 exec, s[74:75]
  buffer_store_dwordx2 v[8:9], v3, s[48:51], s66 offen offset:8 sc1
  buffer_store_dwordx2 v[8:9], v3, s[48:51], s66 offen offset:776 sc1
  s_mov_b64 exec, s[76:77]
  buffer_store_dwordx2 v[8:9], v4, s[48:51], s66 offen offset:8 sc1
  buffer_store_dwordx2 v[8:9], v4, s[48:51], s66 offen offset:776 sc1
  s_mov_b64 exec, -1
  s_add_u32 s66, s66, 1536
  s_add_u32 s62, s62, 1
  s_cmp_lt_u32 s62, s63
  s_cbranch_scc1 L_b1_i
  s_waitcnt vmcnt(0)
  s_barrier
  s_cmp_lg_u32 s52, 0
  s_cbranch_scc1 cnt_14195
  v_mov_b32 v19, 32768
  v_mov_b32 v18, 1
  s_mov_b64 exec, 1
  buffer_atomic_add v18, v19, s[48:51], 0 offen sc1
  s_mov_b64 exec, -1
cnt_14195:
  s_branch b1dn_14189
nob1_14188:
b1dn_14189:
  s_cmp_lt_u32 s54, 24
  s_cbranch_scc0 L_t3role_i
  s_lshl_b32 s69, s53, 3
  s_add_u32 s69, s69, s54
  s_sub_u32 s69, s69, 16
  v_and_b32 v1, 63, v0
  s_mul_i32 s58, s52, 640
  s_add_u32 s59, s58, 0
  v_add_u32 v18, s59, v1
  v_mul_u32_u24 v19, 3277, v18
  v_lshrrev_b32 v19, 18, v19
  v_mul_u32_u24 v20, 80, v19
  v_sub_u32 v18, v18, v20
  v_and_b32 v20, 15, v19
  v_xor_b32 v18, v18, v20
  v_lshlrev_b32 v18, 4, v18
  v_mul_u32_u24 v19, 1280, v19
  v_add_u32 v92, v18, v19
  s_add_u32 s59, s58, 64
  v_add_u32 v18, s59, v1
  v_mul_u32_u24 v19, 3277, v18
  v_lshrrev_b32 v19, 18, v19
  v_mul_u32_u24 v20, 80, v19
  v_sub_u32 v18, v18, v20
  v_and_b32 v20, 15, v19
  v_xor_b32 v18, v18, v20
  v_lshlrev_b32 v18, 4, v18
  v_mul_u32_u24 v19, 1280, v19
  v_add_u32 v93, v18, v19
  s_add_u32 s59, s58, 128
  v_add_u32 v18, s59, v1
  v_mul_u32_u24 v19, 3277, v18
  v_lshrrev_b32 v19, 18, v19
  v_mul_u32_u24 v20, 80, v19
  v_sub_u32 v18, v18, v20
  v_and_b32 v20, 15, v19
  v_xor_b32 v18, v18, v20
  v_lshlrev_b32 v18, 4, v18
  v_mul_u32_u24 v19, 1280, v19
  v_add_u32 v94, v18, v19
  s_add_u32 s59, s58, 192
  v_add_u32 v18, s59, v1
  v_mul_u32_u24 v19, 3277, v18
  v_lshrrev_b32 v19, 18, v19
  v_mul_u32_u24 v20, 80, v19
  v_sub_u32 v18, v18, v20
  v_and_b32 v20, 15, v19
  v_xor_b32 v18, v18, v20
  v_lshlrev_b32 v18, 4, v18
  v_mul_u32_u24 v19, 1280, v19
  v_add_u32 v95, v18, v19
  s_add_u32 s59, s58, 256
  v_add_u32 v18, s59, v1
  v_mul_u32_u24 v19, 3277, v18
  v_lshrrev_b32 v19, 18, v19
  v_mul_u32_u24 v20, 80, v19
  v_sub_u32 v18, v18, v20
  v_and_b32 v20, 15, v19
  v_xor_b32 v18, v18, v20
  v_lshlrev_b32 v18, 4, v18
  v_mul_u32_u24 v19, 1280, v19
  v_add_u32 v96, v18, v19
  s_add_u32 s59, s58, 320
  v_add_u32 v18, s59, v1
  v_mul_u32_u24 v19, 3277, v18
  v_lshrrev_b32 v19, 18, v19
  v_mul_u32_u24 v20, 80, v19
  v_sub_u32 v18, v18, v20
  v_and_b32 v20, 15, v19
  v_xor_b32 v18, v18, v20
  v_lshlrev_b32 v18, 4, v18
  v_mul_u32_u24 v19, 1280, v19
  v_add_u32 v97, v18, v19
  s_add_u32 s59, s58, 384
  v_add_u32 v18, s59, v1
  v_mul_u32_u24 v19, 3277, v18
  v_lshrrev_b32 v19, 18, v19
  v_mul_u32_u24 v20, 80, v19
  v_sub_u32 v18, v18, v20
  v_and_b32 v20, 15, v19
  v_xor_b32 v18, v18, v20
  v_lshlrev_b32 v18, 4, v18
  v_mul_u32_u24 v19, 1280, v19
  v_add_u32 v98, v18, v19
  s_add_u32 s59, s58, 448
  v_add_u32 v18, s59, v1
  v_mul_u32_u24 v19, 3277, v18
  v_lshrrev_b32 v19, 18, v19
  v_mul_u32_u24 v20, 80, v19
  v_sub_u32 v18, v18, v20
  v_and_b32 v20, 15, v19
  v_xor_b32 v18, v18, v20
  v_lshlrev_b32 v18, 4, v18
  v_mul_u32_u24 v19, 1280, v19
  v_add_u32 v99, v18, v19
  s_add_u32 s59, s58, 512
  v_add_u32 v18, s59, v1
  v_mul_u32_u24 v19, 3277, v18
  v_lshrrev_b32 v19, 18, v19
  v_mul_u32_u24 v20, 80, v19
  v_sub_u32 v18, v18, v20
  v_and_b32 v20, 15, v19
  v_xor_b32 v18, v18, v20
  v_lshlrev_b32 v18, 4, v18
  v_mul_u32_u24 v19, 1280, v19
  v_add_u32 v100, v18, v19
  s_add_u32 s59, s58, 576
  v_add_u32 v18, s59, v1
  v_mul_u32_u24 v19, 3277, v18
  v_lshrrev_b32 v19, 18, v19
  v_mul_u32_u24 v20, 80, v19
  v_sub_u32 v18, v18, v20
  v_and_b32 v20, 15, v19
  v_xor_b32 v18, v18, v20
  v_lshlrev_b32 v18, 4, v18
  v_mul_u32_u24 v19, 1280, v19
  v_add_u32 v101, v18, v19
  v_and_b32 v18, 15, v1
  v_lshrrev_b32 v19, 4, v1
  v_xor_b32 v19, v19, v18
  v_mul_u32_u24 v18, 1280, v18
  v_add_u32 v18, 0x1e000, v18
  v_xor_b32 v20, 0, v19
  v_lshlrev_b32 v20, 4, v20
  v_add_u32 v102, v18, v20
  v_xor_b32 v20, 4, v19
  v_lshlrev_b32 v20, 4, v20
  v_add_u32 v103, v18, v20
  v_xor_b32 v20, 8, v19
  v_lshlrev_b32 v20, 4, v20
  v_add_u32 v104, v18, v20
  v_xor_b32 v20, 12, v19
  v_lshlrev_b32 v20, 4, v20
  v_add_u32 v105, v18, v20
  v_lshrrev_b32 v18, 4, v1
  v_lshrrev_b32 v19, 2, v1
  v_and_b32 v19, 3, v19
  v_lshlrev_b32 v20, 3, v18
  v_add_u32 v20, v20, v19
  v_mul_u32_u24 v20, 384, v20
  v_and_b32 v21, 3, v1
  v_lshlrev_b32 v21, 3, v21
  v_add_u32 v20, v20, v21
  v_lshrrev_b32 v19, 1, v19
  v_and_b32 v18, 1, v18
  v_lshlrev_b32 v18, 1, v18
  v_or_b32 v18, v18, v19
  s_mul_i32 s58, s52, 3
  s_add_u32 s59, s58, 0
  v_xor_b32 v19, s59, v18
  v_lshlrev_b32 v19, 5, v19
  v_add_u32 v26, v19, v20
  s_add_u32 s59, s58, 1
  v_xor_b32 v19, s59, v18
  v_lshlrev_b32 v19, 5, v19
  v_add_u32 v27, v19, v20
  s_add_u32 s59, s58, 2
  v_xor_b32 v19, s59, v18
  v_lshlrev_b32 v19, 5, v19
  v_add_u32 v28, v19, v20
  s_mul_i32 s67, s69, 384
  s_mov_b32 s64, 0
  s_mul_i32 s65, s52, 10240
  s_add_u32 s65, s65, 122880
  v_mov_b32 v18, v0
  v_mul_u32_u24 v19, 2731, v18
  v_lshrrev_b32 v19, 16, v19
  v_mul_u32_u24 v20, 24, v19
  v_sub_u32 v18, v18, v20
  v_and_b32 v20, 2, v19
  v_lshrrev_b32 v21, 1, v19
  v_and_b32 v21, 4, v21
  v_or_b32 v20, v20, v21
  v_xor_b32 v18, v18, v20
  v_mul_u32_u24 v19, 12288, v19
  v_lshlrev_b32 v18, 4, v18
  v_add_u32 v2, v18, v19
  v_add_u32 v18, 256, v0
  v_mul_u32_u24 v19, 2731, v18
  v_lshrrev_b32 v19, 16, v19
  v_mul_u32_u24 v20, 24, v19
  v_sub_u32 v18, v18, v20
  v_and_b32 v20, 2, v19
  v_lshrrev_b32 v21, 1, v19
  v_and_b32 v21, 4, v21
  v_or_b32 v20, v20, v21
  v_xor_b32 v18, v18, v20
  v_mul_u32_u24 v19, 12288, v19
  v_lshlrev_b32 v18, 4, v18
  v_add_u32 v3, v18, v19
  v_add_u32 v18, 512, v0
  v_mul_u32_u24 v19, 2731, v18
  v_lshrrev_b32 v19, 16, v19
  v_mul_u32_u24 v20, 24, v19
  v_sub_u32 v18, v18, v20
  v_and_b32 v20, 2, v19
  v_lshrrev_b32 v21, 1, v19
  v_and_b32 v21, 4, v21
  v_or_b32 v20, v20, v21
  v_xor_b32 v18, v18, v20
  v_mul_u32_u24 v19, 12288, v19
  v_lshlrev_b32 v18, 4, v18
  v_add_u32 v4, v18, v19
  v_add_u32 v18, 768, v0
  v_mul_u32_u24 v19, 2731, v18
  v_lshrrev_b32 v19, 16, v19
  v_mul_u32_u24 v20, 24, v19
  v_sub_u32 v18, v18, v20
  v_and_b32 v20, 2, v19
  v_lshrrev_b32 v21, 1, v19
  v_and_b32 v21, 4, v21
  v_or_b32 v20, v20, v21
  v_xor_b32 v18, v18, v20
  v_mul_u32_u24 v19, 12288, v19
  v_lshlrev_b32 v18, 4, v18
  v_add_u32 v5, v18, v19
  v_add_u32 v18, 1024, v0
  v_mul_u32_u24 v19, 2731, v18
  v_lshrrev_b32 v19, 16, v19
  v_mul_u32_u24 v20, 24, v19
  v_sub_u32 v18, v18, v20
  v_and_b32 v20, 2, v19
  v_lshrrev_b32 v21, 1, v19
  v_and_b32 v21, 4, v21
  v_or_b32 v20, v20, v21
  v_xor_b32 v18, v18, v20
  v_mul_u32_u24 v19, 12288, v19
  v_lshlrev_b32 v18, 4, v18
  v_add_u32 v6, v18, v19
  v_add_u32 v18, 1280, v0
  v_mul_u32_u24 v19, 2731, v18
  v_lshrrev_b32 v19, 16, v19
  v_mul_u32_u24 v20, 24, v19
  v_sub_u32 v18, v18, v20
  v_and_b32 v20, 2, v19
  v_lshrrev_b32 v21, 1, v19
  v_and_b32 v21, 4, v21
  v_or_b32 v20, v20, v21
  v_xor_b32 v18, v18, v20
  v_mul_u32_u24 v19, 12288, v19
  v_lshlrev_b32 v18, 4, v18
  v_add_u32 v7, v18, v19
  v_add_u32 v18, 1536, v0
  v_mul_u32_u24 v19, 2731, v18
  v_lshrrev_b32 v19, 16, v19
  v_mul_u32_u24 v20, 24, v19
  v_sub_u32 v18, v18, v20
  v_and_b32 v20, 2, v19
  v_lshrrev_b32 v21, 1, v19
  v_and_b32 v21, 4, v21
  v_or_b32 v20, v20, v21
  v_xor_b32 v18, v18, v20
  v_mul_u32_u24 v19, 12288, v19
  v_lshlrev_b32 v18, 4, v18
  v_add_u32 v8, v18, v19
  v_add_u32 v18, 1792, v0
  v_mul_u32_u24 v19, 2731, v18
  v_lshrrev_b32 v19, 16, v19
  v_mul_u32_u24 v20, 24, v19
  v_sub_u32 v18, v18, v20
  v_and_b32 v20, 2, v19
  v_lshrrev_b32 v21, 1, v19
  v_and_b32 v21, 4, v21
  v_or_b32 v20, v20, v21
  v_xor_b32 v18, v18, v20
  v_mul_u32_u24 v19, 12288, v19
  v_lshlrev_b32 v18, 4, v18
  v_add_u32 v9, v18, v19
  v_add_u32 v18, 2048, v0
  v_mul_u32_u24 v19, 2731, v18
  v_lshrrev_b32 v19, 16, v19
  v_mul_u32_u24 v20, 24, v19
  v_sub_u32 v18, v18, v20
  v_and_b32 v20, 2, v19
  v_lshrrev_b32 v21, 1, v19
  v_and_b32 v21, 4, v21
  v_or_b32 v20, v20, v21
  v_xor_b32 v18, v18, v20
  v_mul_u32_u24 v19, 12288, v19
  v_lshlrev_b32 v18, 4, v18
  v_add_u32 v10, v18, v19
  v_add_u32 v18, 2304, v0
  v_mul_u32_u24 v19, 2731, v18
  v_lshrrev_b32 v19, 16, v19
  v_mul_u32_u24 v20, 24, v19
  v_sub_u32 v18, v18, v20
  v_and_b32 v20, 2, v19
  v_lshrrev_b32 v21, 1, v19
  v_and_b32 v21, 4, v21
  v_or_b32 v20, v20, v21
  v_xor_b32 v18, v18, v20
  v_mul_u32_u24 v19, 12288, v19
  v_lshlrev_b32 v18, 4, v18
  v_add_u32 v11, v18, v19
  v_add_u32 v18, 2560, v0
  v_mul_u32_u24 v19, 2731, v18
  v_lshrrev_b32 v19, 16, v19
  v_mul_u32_u24 v20, 24, v19
  v_sub_u32 v18, v18, v20
  v_and_b32 v20, 2, v19
  v_lshrrev_b32 v21, 1, v19
  v_and_b32 v21, 4, v21
  v_or_b32 v20, v20, v21
  v_xor_b32 v18, v18, v20
  v_mul_u32_u24 v19, 12288, v19
  v_lshlrev_b32 v18, 4, v18
  v_add_u32 v12, v18, v19
  v_add_u32 v18, 2816, v0
  v_mul_u32_u24 v19, 2731, v18
  v_lshrrev_b32 v19, 16, v19
  v_mul_u32_u24 v20, 24, v19
  v_sub_u32 v18, v18, v20
  v_and_b32 v20, 2, v19
  v_lshrrev_b32 v21, 1, v19
  v_and_b32 v21, 4, v21
  v_or_b32 v20, v20, v21
  v_xor_b32 v18, v18, v20
  v_mul_u32_u24 v19, 12288, v19
  v_lshlrev_b32 v18, 4, v18
  v_add_u32 v13, v18, v19
  v_add_u32 v18, 3072, v0
  v_mul_u32_u24 v19, 2731, v18
  v_lshrrev_b32 v19, 16, v19
  v_mul_u32_u24 v20, 24, v19
  v_sub_u32 v18, v18, v20
  v_and_b32 v20, 2, v19
  v_lshrrev_b32 v21, 1, v19
  v_and_b32 v21, 4, v21
  v_or_b32 v20, v20, v21
  v_xor_b32 v18, v18, v20
  v_mul_u32_u24 v19, 12288, v19
  v_lshlrev_b32 v18, 4, v18
  v_add_u32 v14, v18, v19
  v_add_u32 v18, 3328, v0
  v_mul_u32_u24 v19, 2731, v18
  v_lshrrev_b32 v19, 16, v19
  v_mul_u32_u24 v20, 24, v19
  v_sub_u32 v18, v18, v20
  v_and_b32 v20, 2, v19
  v_lshrrev_b32 v21, 1, v19
  v_and_b32 v21, 4, v21
  v_or_b32 v20, v20, v21
  v_xor_b32 v18, v18, v20
  v_mul_u32_u24 v19, 12288, v19
  v_lshlrev_b32 v18, 4, v18
  v_add_u32 v15, v18, v19
  v_add_u32 v18, 3584, v0
  v_mul_u32_u24 v19, 2731, v18
  v_lshrrev_b32 v19, 16, v19
  v_mul_u32_u24 v20, 24, v19
  v_sub_u32 v18, v18, v20
  v_and_b32 v20, 2, v19
  v_lshrrev_b32 v21, 1, v19
  v_and_b32 v21, 4, v21
  v_or_b32 v20, v20, v21
  v_xor_b32 v18, v18, v20
  v_mul_u32_u24 v19, 12288, v19
  v_lshlrev_b32 v18, 4, v18
  v_add_u32 v16, v18, v19
  s_add_u32 m0, s65, 0
  s_nop 0
  buffer_load_dwordx4 v92, s[4:7], s64 offen lds
  s_add_u32 m0, s65, 1024
  s_nop 0
  buffer_load_dwordx4 v93, s[4:7], s64 offen lds
  s_add_u32 m0, s65, 2048
  s_nop 0
  buffer_load_dwordx4 v94, s[4:7], s64 offen lds
  s_add_u32 m0, s65, 3072
  s_nop 0
  buffer_load_dwordx4 v95, s[4:7], s64 offen lds
  s_add_u32 m0, s65, 4096
  s_nop 0
  buffer_load_dwordx4 v96, s[4:7], s64 offen lds
  s_add_u32 m0, s65, 5120
  s_nop 0
  buffer_load_dwordx4 v97, s[4:7], s64 offen lds
  s_add_u32 m0, s65, 6144
  s_nop 0
  buffer_load_dwordx4 v98, s[4:7], s64 offen lds
  s_add_u32 m0, s65, 7168
  s_nop 0
  buffer_load_dwordx4 v99, s[4:7], s64 offen lds
  s_add_u32 m0, s65, 8192
  s_nop 0
  buffer_load_dwordx4 v100, s[4:7], s64 offen lds
  s_add_u32 m0, s65, 9216
  s_nop 0
  buffer_load_dwordx4 v101, s[4:7], s64 offen lds
  s_mov_b32 s70, s67
  s_lshl_b32 s60, s52, 10
  s_add_u32 s60, s60, 0x0
  s_add_u32 m0, s60, 0
  s_nop 0
  buffer_load_dwordx4 v2, s[12:15], s70 offen lds
  s_add_u32 m0, s60, 4096
  s_nop 0
  buffer_load_dwordx4 v3, s[12:15], s70 offen lds
  s_add_u32 m0, s60, 8192
  s_nop 0
  buffer_load_dwordx4 v4, s[12:15], s70 offen lds
  s_add_u32 m0, s60, 12288
  s_nop 0
  buffer_load_dwordx4 v5, s[12:15], s70 offen lds
  s_add_u32 m0, s60, 16384
  s_nop 0
  buffer_load_dwordx4 v6, s[12:15], s70 offen lds
  s_add_u32 m0, s60, 20480
  s_nop 0
  buffer_load_dwordx4 v7, s[12:15], s70 offen lds
  s_add_u32 m0, s60, 24576
  s_nop 0
  buffer_load_dwordx4 v8, s[12:15], s70 offen lds
  s_add_u32 m0, s60, 28672
  s_nop 0
  buffer_load_dwordx4 v9, s[12:15], s70 offen lds
  s_add_u32 m0, s60, 32768
  s_nop 0
  buffer_load_dwordx4 v10, s[12:15], s70 offen lds
  s_add_u32 m0, s60, 36864
  s_nop 0
  buffer_load_dwordx4 v11, s[12:15], s70 offen lds
  s_add_u32 m0, s60, 40960
  s_nop 0
  buffer_load_dwordx4 v12, s[12:15], s70 offen lds
  s_add_u32 m0, s60, 45056
  s_nop 0
  buffer_load_dwordx4 v13, s[12:15], s70 offen lds
  s_add_u32 m0, s60, 49152
  s_nop 0
  buffer_load_dwordx4 v14, s[12:15], s70 offen lds
  s_add_u32 m0, s60, 53248
  s_nop 0
  buffer_load_dwordx4 v15, s[12:15], s70 offen lds
  s_add_u32 m0, s60, 57344
  s_nop 0
  buffer_load_dwordx4 v16, s[12:15], s70 offen lds
  s_add_u32 s70, s70, 1966080
  s_lshl_b32 s60, s52, 10
  s_add_u32 s60, s60, 0xf000
  s_add_u32 m0, s60, 0
  s_nop 0
  buffer_load_dwordx4 v2, s[12:15], s70 offen lds
  s_add_u32 m0, s60, 4096
  s_nop 0
  buffer_load_dwordx4 v3, s[12:15], s70 offen lds
  s_add_u32 m0, s60, 8192
  s_nop 0
  buffer_load_dwordx4 v4, s[12:15], s70 offen lds
  s_add_u32 m0, s60, 12288
  s_nop 0
  buffer_load_dwordx4 v5, s[12:15], s70 offen lds
  s_add_u32 m0, s60, 16384
  s_nop 0
  buffer_load_dwordx4 v6, s[12:15], s70 offen lds
  s_add_u32 m0, s60, 20480
  s_nop 0
  buffer_load_dwordx4 v7, s[12:15], s70 offen lds
  s_add_u32 m0, s60, 24576
  s_nop 0
  buffer_load_dwordx4 v8, s[12:15], s70 offen lds
  s_add_u32 m0, s60, 28672
  s_nop 0
  buffer_load_dwordx4 v9, s[12:15], s70 offen lds
  s_add_u32 m0, s60, 32768
  s_nop 0
  buffer_load_dwordx4 v10, s[12:15], s70 offen lds
  s_add_u32 m0, s60, 36864
  s_nop 0
  buffer_load_dwordx4 v11, s[12:15], s70 offen lds
  s_add_u32 m0, s60, 40960
  s_nop 0
  buffer_load_dwordx4 v12, s[12:15], s70 offen lds
  s_add_u32 m0, s60, 45056
  s_nop 0
  buffer_load_dwordx4 v13, s[12:15], s70 offen lds
  s_add_u32 m0, s60, 49152
  s_nop 0
  buffer_load_dwordx4 v14, s[12:15], s70 offen lds
  s_add_u32 m0, s60, 53248
  s_nop 0
  buffer_load_dwordx4 v15, s[12:15], s70 offen lds
  s_add_u32 m0, s60, 57344
  s_nop 0
  buffer_load_dwordx4 v16, s[12:15], s70 offen lds
  s_waitcnt vmcnt(15)
  s_barrier
  ds_read_b64_tr_b16 a[0:1], v26 offset:0
  ds_read_b64_tr_b16 a[2:3], v26 offset:1536
  ds_read_b64_tr_b16 a[4:5], v26 offset:12288
  ds_read_b64_tr_b16 a[6:7], v26 offset:13824
  ds_read_b64_tr_b16 a[8:9], v26 offset:24576
  ds_read_b64_tr_b16 a[10:11], v26 offset:26112
  s_waitcnt lgkmcnt(4)
  ds_read_b64_tr_b16 a[12:13], v26 offset:36864
  ds_read_b64_tr_b16 a[14:15], v26 offset:38400
  ds_read_b64_tr_b16 a[16:17], v26 offset:49152
  ds_read_b64_tr_b16 a[18:19], v26 offset:50688
  s_waitcnt lgkmcnt(4)
  ds_read_b64_tr_b16 a[80:81], v27 offset:0
  ds_read_b64_tr_b16 a[82:83], v27 offset:1536
  ds_read_b64_tr_b16 a[84:85], v27 offset:12288
  ds_read_b64_tr_b16 a[86:87], v27 offset:13824
  ds_read_b64_tr_b16 a[88:89], v27 offset:24576
  ds_read_b64_tr_b16 a[90:91], v27 offset:26112
  s_waitcnt lgkmcnt(4)
  ds_read_b64_tr_b16 a[92:93], v27 offset:36864
  ds_read_b64_tr_b16 a[94:95], v27 offset:38400
  ds_read_b64_tr_b16 a[96:97], v27 offset:49152
  ds_read_b64_tr_b16 a[98:99], v27 offset:50688
  s_waitcnt lgkmcnt(4)
  ds_read_b64_tr_b16 a[160:161], v28 offset:0
  ds_read_b64_tr_b16 a[162:163], v28 offset:1536
  ds_read_b64_tr_b16 a[164:165], v28 offset:12288
  ds_read_b64_tr_b16 a[166:167], v28 offset:13824
  ds_read_b64_tr_b16 a[168:169], v28 offset:24576
  ds_read_b64_tr_b16 a[170:171], v28 offset:26112
  s_waitcnt lgkmcnt(4)
  ds_read_b64_tr_b16 a[172:173], v28 offset:36864
  ds_read_b64_tr_b16 a[174:175], v28 offset:38400
  ds_read_b64_tr_b16 a[176:177], v28 offset:49152
  ds_read_b64_tr_b16 a[178:179], v28 offset:50688
  s_waitcnt lgkmcnt(4)
  s_waitcnt lgkmcnt(0)
  v_add_u32 v26, 61440, v26
  v_add_u32 v27, 61440, v27
  v_add_u32 v28, 61440, v28
  s_barrier
  s_add_u32 s70, s70, 1966080
  s_lshl_b32 s60, s52, 10
  s_add_u32 s60, s60, 0x0
  s_add_u32 m0, s60, 0
  s_nop 0
  buffer_load_dwordx4 v2, s[12:15], s70 offen lds
  s_add_u32 m0, s60, 4096
  s_nop 0
  buffer_load_dwordx4 v3, s[12:15], s70 offen lds
  s_add_u32 m0, s60, 8192
  s_nop 0
  buffer_load_dwordx4 v4, s[12:15], s70 offen lds
  s_add_u32 m0, s60, 12288
  s_nop 0
  buffer_load_dwordx4 v5, s[12:15], s70 offen lds
  s_add_u32 m0, s60, 16384
  s_nop 0
  buffer_load_dwordx4 v6, s[12:15], s70 offen lds
  s_add_u32 m0, s60, 20480
  s_nop 0
  buffer_load_dwordx4 v7, s[12:15], s70 offen lds
  s_add_u32 m0, s60, 24576
  s_nop 0
  buffer_load_dwordx4 v8, s[12:15], s70 offen lds
  s_add_u32 m0, s60, 28672
  s_nop 0
  buffer_load_dwordx4 v9, s[12:15], s70 offen lds
  s_add_u32 m0, s60, 32768
  s_nop 0
  buffer_load_dwordx4 v10, s[12:15], s70 offen lds
  s_add_u32 m0, s60, 36864
  s_nop 0
  buffer_load_dwordx4 v11, s[12:15], s70 offen lds
  s_add_u32 m0, s60, 40960
  s_nop 0
  buffer_load_dwordx4 v12, s[12:15], s70 offen lds
  s_add_u32 m0, s60, 45056
  s_nop 0
  buffer_load_dwordx4 v13, s[12:15], s70 offen lds
  s_add_u32 m0, s60, 49152
  s_nop 0
  buffer_load_dwordx4 v14, s[12:15], s70 offen lds
  s_add_u32 m0, s60, 53248
  s_nop 0
  buffer_load_dwordx4 v15, s[12:15], s70 offen lds
  s_add_u32 m0, s60, 57344
  s_nop 0
  buffer_load_dwordx4 v16, s[12:15], s70 offen lds
  s_waitcnt vmcnt(15)
  s_barrier
  ds_read_b64_tr_b16 a[20:21], v26 offset:0
  ds_read_b64_tr_b16 a[22:23], v26 offset:1536
  ds_read_b64_tr_b16 a[24:25], v26 offset:12288
  ds_read_b64_tr_b16 a[26:27], v26 offset:13824
  ds_read_b64_tr_b16 a[28:29], v26 offset:24576
  ds_read_b64_tr_b16 a[30:31], v26 offset:26112
  s_waitcnt lgkmcnt(4)
  ds_read_b64_tr_b16 a[32:33], v26 offset:36864
  ds_read_b64_tr_b16 a[34:35], v26 offset:38400
  ds_read_b64_tr_b16 a[36:37], v26 offset:49152
  ds_read_b64_tr_b16 a[38:39], v26 offset:50688
  s_waitcnt lgkmcnt(4)
  ds_read_b64_tr_b16 a[100:101], v27 offset:0
  ds_read_b64_tr_b16 a[102:103], v27 offset:1536
  ds_read_b64_tr_b16 a[104:105], v27 offset:12288
  ds_read_b64_tr_b16 a[106:107], v27 offset:13824
  ds_read_b64_tr_b16 a[108:109], v27 offset:24576
  ds_read_b64_tr_b16 a[110:111], v27 offset:26112
  s_waitcnt lgkmcnt(4)
  ds_read_b64_tr_b16 a[112:113], v27 offset:36864
  ds_read_b64_tr_b16 a[114:115], v27 offset:38400
  ds_read_b64_tr_b16 a[116:117], v27 offset:49152
  ds_read_b64_tr_b16 a[118:119], v27 offset:50688
  s_waitcnt lgkmcnt(4)
  ds_read_b64_tr_b16 a[180:181], v28 offset:0
  ds_read_b64_tr_b16 a[182:183], v28 offset:1536
  ds_read_b64_tr_b16 a[184:185], v28 offset:12288
  ds_read_b64_tr_b16 a[186:187], v28 offset:13824
  ds_read_b64_tr_b16 a[188:189], v28 offset:24576
  ds_read_b64_tr_b16 a[190:191], v28 offset:26112
  s_waitcnt lgkmcnt(4)
  ds_read_b64_tr_b16 a[192:193], v28 offset:36864
  ds_read_b64_tr_b16 a[194:195], v28 offset:38400
  ds_read_b64_tr_b16 a[196:197], v28 offset:49152
  ds_read_b64_tr_b16 a[198:199], v28 offset:50688
  s_waitcnt lgkmcnt(4)
  s_waitcnt lgkmcnt(0)
  v_subrev_u32 v26, 61440, v26
  v_subrev_u32 v27, 61440, v27
  v_subrev_u32 v28, 61440, v28
  s_barrier
  s_add_u32 s70, s70, 1966080
  s_lshl_b32 s60, s52, 10
  s_add_u32 s60, s60, 0xf000
  s_add_u32 m0, s60, 0
  s_nop 0
  buffer_load_dwordx4 v2, s[12:15], s70 offen lds
  s_add_u32 m0, s60, 4096
  s_nop 0
  buffer_load_dwordx4 v3, s[12:15], s70 offen lds
  s_add_u32 m0, s60, 8192
  s_nop 0
  buffer_load_dwordx4 v4, s[12:15], s70 offen lds
  s_add_u32 m0, s60, 12288
  s_nop 0
  buffer_load_dwordx4 v5, s[12:15], s70 offen lds
  s_add_u32 m0, s60, 16384
  s_nop 0
  buffer_load_dwordx4 v6, s[12:15], s70 offen lds
  s_add_u32 m0, s60, 20480
  s_nop 0
  buffer_load_dwordx4 v7, s[12:15], s70 offen lds
  s_add_u32 m0, s60, 24576
  s_nop 0
  buffer_load_dwordx4 v8, s[12:15], s70 offen lds
  s_add_u32 m0, s60, 28672
  s_nop 0
  buffer_load_dwordx4 v9, s[12:15], s70 offen lds
  s_add_u32 m0, s60, 32768
  s_nop 0
  buffer_load_dwordx4 v10, s[12:15], s70 offen lds
  s_add_u32 m0, s60, 36864
  s_nop 0
  buffer_load_dwordx4 v11, s[12:15], s70 offen lds
  s_add_u32 m0, s60, 40960
  s_nop 0
  buffer_load_dwordx4 v12, s[12:15], s70 offen lds
  s_add_u32 m0, s60, 45056
  s_nop 0
  buffer_load_dwordx4 v13, s[12:15], s70 offen lds
  s_add_u32 m0, s60, 49152
  s_nop 0
  buffer_load_dwordx4 v14, s[12:15], s70 offen lds
  s_add_u32 m0, s60, 53248
  s_nop 0
  buffer_load_dwordx4 v15, s[12:15], s70 offen lds
  s_add_u32 m0, s60, 57344
  s_nop 0
  buffer_load_dwordx4 v16, s[12:15], s70 offen lds
  s_waitcnt vmcnt(15)
  s_barrier
  ds_read_b64_tr_b16 a[40:41], v26 offset:0
  ds_read_b64_tr_b16 a[42:43], v26 offset:1536
  ds_read_b64_tr_b16 a[44:45], v26 offset:12288
  ds_read_b64_tr_b16 a[46:47], v26 offset:13824
  ds_read_b64_tr_b16 a[48:49], v26 offset:24576
  ds_read_b64_tr_b16 a[50:51], v26 offset:26112
  s_waitcnt lgkmcnt(4)
  ds_read_b64_tr_b16 a[52:53], v26 offset:36864
  ds_read_b64_tr_b16 a[54:55], v26 offset:38400
  ds_read_b64_tr_b16 a[56:57], v26 offset:49152
  ds_read_b64_tr_b16 a[58:59], v26 offset:50688
  s_waitcnt lgkmcnt(4)
  ds_read_b64_tr_b16 a[120:121], v27 offset:0
  ds_read_b64_tr_b16 a[122:123], v27 offset:1536
  ds_read_b64_tr_b16 a[124:125], v27 offset:12288
  ds_read_b64_tr_b16 a[126:127], v27 offset:13824
  ds_read_b64_tr_b16 a[128:129], v27 offset:24576
  ds_read_b64_tr_b16 a[130:131], v27 offset:26112
  s_waitcnt lgkmcnt(4)
  ds_read_b64_tr_b16 a[132:133], v27 offset:36864
  ds_read_b64_tr_b16 a[134:135], v27 offset:38400
  ds_read_b64_tr_b16 a[136:137], v27 offset:49152
  ds_read_b64_tr_b16 a[138:139], v27 offset:50688
  s_waitcnt lgkmcnt(4)
  ds_read_b64_tr_b16 a[200:201], v28 offset:0
  ds_read_b64_tr_b16 a[202:203], v28 offset:1536
  ds_read_b64_tr_b16 a[204:205], v28 offset:12288
  ds_read_b64_tr_b16 a[206:207], v28 offset:13824
  ds_read_b64_tr_b16 a[208:209], v28 offset:24576
  ds_read_b64_tr_b16 a[210:211], v28 offset:26112
  s_waitcnt lgkmcnt(4)
  ds_read_b64_tr_b16 a[212:213], v28 offset:36864
  ds_read_b64_tr_b16 a[214:215], v28 offset:38400
  ds_read_b64_tr_b16 a[216:217], v28 offset:49152
  ds_read_b64_tr_b16 a[218:219], v28 offset:50688
  s_waitcnt lgkmcnt(4)
  s_waitcnt lgkmcnt(0)
  v_add_u32 v26, 61440, v26
  v_add_u32 v27, 61440, v27
  v_add_u32 v28, 61440, v28
  s_barrier
  s_waitcnt vmcnt(0)
  s_barrier
  ds_read_b64_tr_b16 a[60:61], v26 offset:0
  ds_read_b64_tr_b16 a[62:63], v26 offset:1536
  ds_read_b64_tr_b16 a[64:65], v26 offset:12288
  ds_read_b64_tr_b16 a[66:67], v26 offset:13824
  ds_read_b64_tr_b16 a[68:69], v26 offset:24576
  ds_read_b64_tr_b16 a[70:71], v26 offset:26112
  s_waitcnt lgkmcnt(4)
  ds_read_b64_tr_b16 a[72:73], v26 offset:36864
  ds_read_b64_tr_b16 a[74:75], v26 offset:38400
  ds_read_b64_tr_b16 a[76:77], v26 offset:49152
  ds_read_b64_tr_b16 a[78:79], v26 offset:50688
  s_waitcnt lgkmcnt(4)
  ds_read_b64_tr_b16 a[140:141], v27 offset:0
  ds_read_b64_tr_b16 a[142:143], v27 offset:1536
  ds_read_b64_tr_b16 a[144:145], v27 offset:12288
  ds_read_b64_tr_b16 a[146:147], v27 offset:13824
  ds_read_b64_tr_b16 a[148:149], v27 offset:24576
  ds_read_b64_tr_b16 a[150:151], v27 offset:26112
  s_waitcnt lgkmcnt(4)
  ds_read_b64_tr_b16 a[152:153], v27 offset:36864
  ds_read_b64_tr_b16 a[154:155], v27 offset:38400
  ds_read_b64_tr_b16 a[156:157], v27 offset:49152
  ds_read_b64_tr_b16 a[158:159], v27 offset:50688
  s_waitcnt lgkmcnt(4)
  ds_read_b64_tr_b16 a[220:221], v28 offset:0
  ds_read_b64_tr_b16 a[222:223], v28 offset:1536
  ds_read_b64_tr_b16 a[224:225], v28 offset:12288
  ds_read_b64_tr_b16 a[226:227], v28 offset:13824
  ds_read_b64_tr_b16 a[228:229], v28 offset:24576
  ds_read_b64_tr_b16 a[230:231], v28 offset:26112
  s_waitcnt lgkmcnt(4)
  ds_read_b64_tr_b16 a[232:233], v28 offset:36864
  ds_read_b64_tr_b16 a[234:235], v28 offset:38400
  ds_read_b64_tr_b16 a[236:237], v28 offset:49152
  ds_read_b64_tr_b16 a[238:239], v28 offset:50688
  s_waitcnt lgkmcnt(4)
  s_waitcnt lgkmcnt(0)
  v_subrev_u32 v26, 61440, v26
  v_subrev_u32 v27, 61440, v27
  v_subrev_u32 v28, 61440, v28
  s_barrier
  s_mov_b32 s71, 0xfffe2000
  v_mov_b32 v2, 0x3f803f80
  v_mov_b32 v3, 0x3f803f80
  v_mov_b32 v4, 0x3f803f80
  v_mov_b32 v5, 0x3f803f80
  v_lshlrev_b32 v15, 4, v1
  v_lshlrev_b32 v16, 3, v1
  v_lshrrev_b32 v18, 4, v1
  v_lshlrev_b32 v18, 2, v18
  v_and_b32 v19, 15, v1
  v_mov_b32 v20, 0
  v_mov_b32 v21, 0xf149f2ca
  v_add_u32 v6, 0, v18
  v_cmp_le_u32 vcc, v6, v19
  s_nop 1
  v_cndmask_b32 v6, v21, v20, vcc
  v_add_u32 v7, 1, v18
  v_cmp_le_u32 vcc, v7, v19
  s_nop 1
  v_cndmask_b32 v7, v21, v20, vcc
  v_add_u32 v8, 2, v18
  v_cmp_le_u32 vcc, v8, v19
  s_nop 1
  v_cndmask_b32 v8, v21, v20, vcc
  v_add_u32 v9, 3, v18
  v_cmp_le_u32 vcc, v9, v19
  s_nop 1
  v_cndmask_b32 v9, v21, v20, vcc
  v_cmp_gt_u32 vcc, 32, v1
  s_nop 1
  v_cndmask_b32 v10, v21, v20, vcc
  s_lshl_b32 s58, s69, 8
  v_and_b32 v18, 1, v1
  v_lshlrev_b32 v18, 7, v18
  v_add_u32 v18, s58, v18
  s_lshl_b32 s58, s69, 9
  s_add_u32 s58, s58, 8192
  v_and_b32 v19, 3, v1
  v_lshlrev_b32 v19, 7, v19
  v_add_u32 v19, s58, v19
  v_cmp_gt_u32 vcc, 16, v1
  s_nop 1
  v_cndmask_b32 v11, v18, v19, vcc
  s_mul_i32 s58, s52, 3
  s_add_u32 s58, s58, 0
  s_lshr_b32 s59, s58, 1
  s_lshl_b32 s59, s59, 11
  s_and_b32 s58, s58, 1
  s_lshl_b32 s58, s58, 3
  s_add_u32 s58, s58, s59
  v_add_u32 v12, s58, v15
  s_mul_i32 s58, s52, 3
  s_add_u32 s58, s58, 1
  s_lshr_b32 s59, s58, 1
  s_lshl_b32 s59, s59, 11
  s_and_b32 s58, s58, 1
  s_lshl_b32 s58, s58, 3
  s_add_u32 s58, s58, s59
  v_add_u32 v13, s58, v15
  s_mul_i32 s58, s52, 3
  s_add_u32 s58, s58, 2
  s_lshr_b32 s59, s58, 1
  s_lshl_b32 s59, s59, 11
  s_and_b32 s58, s58, 1
  s_lshl_b32 s58, s58, 3
  s_add_u32 s58, s58, s59
  v_add_u32 v14, s58, v15
  s_lshl_b32 s58, s52, 10
  s_add_u32 s58, s58, 40960
  v_add_u32 v22, s58, v15
  v_add_u32 v23, 40960, v15
  s_mul_i32 s73, s69, 12288
  s_mul_i32 s58, s52, 3072
  s_add_u32 s73, s73, s58
  s_add_u32 s73, s73, 0x1a00000
  s_mul_i32 s74, s69, 6144
  s_mul_i32 s58, s52, 1536
  s_add_u32 s74, s74, s58
  s_add_u32 s74, s74, 0x200000
  s_mul_i32 s75, s69, 12288
  s_add_u32 s75, s75, 0x4a00000
  s_lshl_b32 s58, s69, 7
  s_add_u32 s58, s58, 24576
  v_mov_b32 v17, s58
  s_mov_b32 s77, 0x3dd53b95
  s_mov_b32 s62, 0
  s_mov_b32 s72, 0
  s_waitcnt vmcnt(0)
  s_barrier
  s_cmp_lt_u32 s62, 63
  s_cselect_b32 s58, 40960, 0
  s_add_u32 s64, s64, s58
  s_add_u32 s65, s65, s71
  ds_read_b128 v[32:35], v102 offset:0
  ds_read_b128 v[36:39], v102 offset:20480
  ds_read_b128 v[40:43], v103 offset:0
  ds_read_b128 v[44:47], v103 offset:20480
  ds_read_b128 v[48:51], v104 offset:0
  ds_read_b128 v[52:55], v104 offset:20480
  s_waitcnt lgkmcnt(4)
  v_mfma_f32_16x16x32_bf16 v[56:59], a[0:3], v[32:35], 0
  v_mfma_f32_16x16x32_bf16 v[64:67], a[80:83], v[32:35], 0
  v_mfma_f32_16x16x32_bf16 v[72:75], a[160:163], v[32:35], 0
  v_mfma_f32_16x16x32_bf16 v[60:63], a[0:3], v[36:39], 0
  v_mfma_f32_16x16x32_bf16 v[68:71], a[80:83], v[36:39], 0
  v_mfma_f32_16x16x32_bf16 v[76:79], a[160:163], v[36:39], 0
  ds_read_b128 v[32:35], v105 offset:0
  ds_read_b128 v[36:39], v105 offset:20480
  s_waitcnt lgkmcnt(4)
  v_mfma_f32_16x16x32_bf16 v[56:59], a[4:7], v[40:43], v[56:59]
  s_add_u32 m0, s65, 0
  s_nop 0
  buffer_load_dwordx4 v92, s[4:7], s64 offen lds
  v_mfma_f32_16x16x32_bf16 v[64:67], a[84:87], v[40:43], v[64:67]
  v_mfma_f32_16x16x32_bf16 v[72:75], a[164:167], v[40:43], v[72:75]
  v_mfma_f32_16x16x32_bf16 v[60:63], a[4:7], v[44:47], v[60:63]
  v_mfma_f32_16x16x32_bf16 v[68:71], a[84:87], v[44:47], v[68:71]
  v_mfma_f32_16x16x32_bf16 v[76:79], a[164:167], v[44:47], v[76:79]
  ds_read_b128 v[40:43], v102 offset:256
  ds_read_b128 v[44:47], v102 offset:20736
  s_waitcnt lgkmcnt(4)
  v_mfma_f32_16x16x32_bf16 v[56:59], a[8:11], v[48:51], v[56:59]
  v_mfma_f32_16x16x32_bf16 v[64:67], a[88:91], v[48:51], v[64:67]
  v_mfma_f32_16x16x32_bf16 v[72:75], a[168:171], v[48:51], v[72:75]
  v_mfma_f32_16x16x32_bf16 v[60:63], a[8:11], v[52:55], v[60:63]
  v_mfma_f32_16x16x32_bf16 v[68:71], a[88:91], v[52:55], v[68:71]
  s_add_u32 m0, s65, 1024
  s_nop 0
  buffer_load_dwordx4 v93, s[4:7], s64 offen lds
  v_mfma_f32_16x16x32_bf16 v[76:79], a[168:171], v[52:55], v[76:79]
  ds_read_b128 v[48:51], v103 offset:256
  ds_read_b128 v[52:55], v103 offset:20736
  s_waitcnt lgkmcnt(4)
  v_mfma_f32_16x16x32_bf16 v[56:59], a[12:15], v[32:35], v[56:59]
  v_mfma_f32_16x16x32_bf16 v[64:67], a[92:95], v[32:35], v[64:67]
  v_mfma_f32_16x16x32_bf16 v[72:75], a[172:175], v[32:35], v[72:75]
  v_mfma_f32_16x16x32_bf16 v[60:63], a[12:15], v[36:39], v[60:63]
  v_mfma_f32_16x16x32_bf16 v[68:71], a[92:95], v[36:39], v[68:71]
  v_mfma_f32_16x16x32_bf16 v[76:79], a[172:175], v[36:39], v[76:79]
  ds_read_b128 v[32:35], v104 offset:256
  ds_read_b128 v[36:39], v104 offset:20736
  s_waitcnt lgkmcnt(4)
  v_mfma_f32_16x16x32_bf16 v[56:59], a[16:19], v[40:43], v[56:59]
  v_mfma_f32_16x16x32_bf16 v[64:67], a[96:99], v[40:43], v[64:67]
  v_mfma_f32_16x16x32_bf16 v[72:75], a[176:179], v[40:43], v[72:75]
  s_add_u32 m0, s65, 2048
  s_nop 0
  buffer_load_dwordx4 v94, s[4:7], s64 offen lds
  v_mfma_f32_16x16x32_bf16 v[60:63], a[16:19], v[44:47], v[60:63]
  v_mfma_f32_16x16x32_bf16 v[68:71], a[96:99], v[44:47], v[68:71]
  v_mfma_f32_16x16x32_bf16 v[76:79], a[176:179], v[44:47], v[76:79]
  ds_read_b128 v[40:43], v105 offset:256
  ds_read_b128 v[44:47], v105 offset:20736
  s_waitcnt lgkmcnt(4)
  v_mfma_f32_16x16x32_bf16 v[56:59], a[20:23], v[48:51], v[56:59]
  v_mfma_f32_16x16x32_bf16 v[64:67], a[100:103], v[48:51], v[64:67]
  v_mfma_f32_16x16x32_bf16 v[72:75], a[180:183], v[48:51], v[72:75]
  v_mfma_f32_16x16x32_bf16 v[60:63], a[20:23], v[52:55], v[60:63]
  v_mfma_f32_16x16x32_bf16 v[68:71], a[100:103], v[52:55], v[68:71]
  v_mfma_f32_16x16x32_bf16 v[76:79], a[180:183], v[52:55], v[76:79]
  ds_read_b128 v[48:51], v102 offset:512
  ds_read_b128 v[52:55], v102 offset:20992
  s_waitcnt lgkmcnt(4)
  v_mfma_f32_16x16x32_bf16 v[56:59], a[24:27], v[32:35], v[56:59]
  s_add_u32 m0, s65, 3072
  s_nop 0
  buffer_load_dwordx4 v95, s[4:7], s64 offen lds
  v_mfma_f32_16x16x32_bf16 v[64:67], a[104:107], v[32:35], v[64:67]
  v_mfma_f32_16x16x32_bf16 v[72:75], a[184:187], v[32:35], v[72:75]
  v_mfma_f32_16x16x32_bf16 v[60:63], a[24:27], v[36:39], v[60:63]
  v_mfma_f32_16x16x32_bf16 v[68:71], a[104:107], v[36:39], v[68:71]
  v_mfma_f32_16x16x32_bf16 v[76:79], a[184:187], v[36:39], v[76:79]
  ds_read_b128 v[32:35], v103 offset:512
  ds_read_b128 v[36:39], v103 offset:20992
  s_waitcnt lgkmcnt(4)
  v_mfma_f32_16x16x32_bf16 v[56:59], a[28:31], v[40:43], v[56:59]
  v_mfma_f32_16x16x32_bf16 v[64:67], a[108:111], v[40:43], v[64:67]
  v_mfma_f32_16x16x32_bf16 v[72:75], a[188:191], v[40:43], v[72:75]
  v_mfma_f32_16x16x32_bf16 v[60:63], a[28:31], v[44:47], v[60:63]
  v_mfma_f32_16x16x32_bf16 v[68:71], a[108:111], v[44:47], v[68:71]
  s_add_u32 m0, s65, 4096
  s_nop 0
  buffer_load_dwordx4 v96, s[4:7], s64 offen lds
  v_mfma_f32_16x16x32_bf16 v[76:79], a[188:191], v[44:47], v[76:79]
  ds_read_b128 v[40:43], v104 offset:512
  ds_read_b128 v[44:47], v104 offset:20992
  s_waitcnt lgkmcnt(4)
  v_mfma_f32_16x16x32_bf16 v[56:59], a[32:35], v[48:51], v[56:59]
  v_mfma_f32_16x16x32_bf16 v[64:67], a[112:115], v[48:51], v[64:67]
  v_mfma_f32_16x16x32_bf16 v[72:75], a[192:195], v[48:51], v[72:75]
  v_mfma_f32_16x16x32_bf16 v[60:63], a[32:35], v[52:55], v[60:63]
  v_mfma_f32_16x16x32_bf16 v[68:71], a[112:115], v[52:55], v[68:71]
  v_mfma_f32_16x16x32_bf16 v[76:79], a[192:195], v[52:55], v[76:79]
  ds_read_b128 v[48:51], v105 offset:512
  ds_read_b128 v[52:55], v105 offset:20992
  s_waitcnt lgkmcnt(4)
  v_mfma_f32_16x16x32_bf16 v[56:59], a[36:39], v[32:35], v[56:59]
  v_mfma_f32_16x16x32_bf16 v[64:67], a[116:119], v[32:35], v[64:67]
  v_mfma_f32_16x16x32_bf16 v[72:75], a[196:199], v[32:35], v[72:75]
  s_add_u32 m0, s65, 5120
  s_nop 0
  buffer_load_dwordx4 v97, s[4:7], s64 offen lds
  v_mfma_f32_16x16x32_bf16 v[60:63], a[36:39], v[36:39], v[60:63]
  v_mfma_f32_16x16x32_bf16 v[68:71], a[116:119], v[36:39], v[68:71]
  v_mfma_f32_16x16x32_bf16 v[76:79], a[196:199], v[36:39], v[76:79]
  ds_read_b128 v[32:35], v102 offset:768
  ds_read_b128 v[36:39], v102 offset:21248
  s_waitcnt lgkmcnt(4)
  v_mfma_f32_16x16x32_bf16 v[56:59], a[40:43], v[40:43], v[56:59]
  v_mfma_f32_16x16x32_bf16 v[64:67], a[120:123], v[40:43], v[64:67]
  v_mfma_f32_16x16x32_bf16 v[72:75], a[200:203], v[40:43], v[72:75]
  v_mfma_f32_16x16x32_bf16 v[60:63], a[40:43], v[44:47], v[60:63]
  v_mfma_f32_16x16x32_bf16 v[68:71], a[120:123], v[44:47], v[68:71]
  v_mfma_f32_16x16x32_bf16 v[76:79], a[200:203], v[44:47], v[76:79]
  ds_read_b128 v[40:43], v103 offset:768
  ds_read_b128 v[44:47], v103 offset:21248
  s_waitcnt lgkmcnt(4)
  v_mfma_f32_16x16x32_bf16 v[56:59], a[44:47], v[48:51], v[56:59]
  s_add_u32 m0, s65, 6144
  s_nop 0
  buffer_load_dwordx4 v98, s[4:7], s64 offen lds
  v_mfma_f32_16x16x32_bf16 v[64:67], a[124:127], v[48:51], v[64:67]
  v_mfma_f32_16x16x32_bf16 v[72:75], a[204:207], v[48:51], v[72:75]
  v_mfma_f32_16x16x32_bf16 v[60:63], a[44:47], v[52:55], v[60:63]
  v_mfma_f32_16x16x32_bf16 v[68:71], a[124:127], v[52:55], v[68:71]
  v_mfma_f32_16x16x32_bf16 v[76:79], a[204:207], v[52:55], v[76:79]
  ds_read_b128 v[48:51], v104 offset:768
  ds_read_b128 v[52:55], v104 offset:21248
  s_waitcnt lgkmcnt(4)
  v_mfma_f32_16x16x32_bf16 v[56:59], a[48:51], v[32:35], v[56:59]
  v_mfma_f32_16x16x32_bf16 v[64:67], a[128:131], v[32:35], v[64:67]
  v_mfma_f32_16x16x32_bf16 v[72:75], a[208:211], v[32:35], v[72:75]
  v_mfma_f32_16x16x32_bf16 v[60:63], a[48:51], v[36:39], v[60:63]
  v_mfma_f32_16x16x32_bf16 v[68:71], a[128:131], v[36:39], v[68:71]
  s_add_u32 m0, s65, 7168
  s_nop 0
  buffer_load_dwordx4 v99, s[4:7], s64 offen lds
  v_mfma_f32_16x16x32_bf16 v[76:79], a[208:211], v[36:39], v[76:79]
  ds_read_b128 v[32:35], v105 offset:768
  ds_read_b128 v[36:39], v105 offset:21248
  s_waitcnt lgkmcnt(4)
  v_mfma_f32_16x16x32_bf16 v[56:59], a[52:55], v[40:43], v[56:59]
  v_mfma_f32_16x16x32_bf16 v[64:67], a[132:135], v[40:43], v[64:67]
  v_mfma_f32_16x16x32_bf16 v[72:75], a[212:215], v[40:43], v[72:75]
  v_mfma_f32_16x16x32_bf16 v[60:63], a[52:55], v[44:47], v[60:63]
  v_mfma_f32_16x16x32_bf16 v[68:71], a[132:135], v[44:47], v[68:71]
  v_mfma_f32_16x16x32_bf16 v[76:79], a[212:215], v[44:47], v[76:79]
  ds_read_b128 v[40:43], v102 offset:1024
  ds_read_b128 v[44:47], v102 offset:21504
  s_waitcnt lgkmcnt(4)
  v_mfma_f32_16x16x32_bf16 v[56:59], a[56:59], v[48:51], v[56:59]
  v_mfma_f32_16x16x32_bf16 v[64:67], a[136:139], v[48:51], v[64:67]
  v_mfma_f32_16x16x32_bf16 v[72:75], a[216:219], v[48:51], v[72:75]
  s_add_u32 m0, s65, 8192
  s_nop 0
  buffer_load_dwordx4 v100, s[4:7], s64 offen lds
  v_mfma_f32_16x16x32_bf16 v[60:63], a[56:59], v[52:55], v[60:63]
  v_mfma_f32_16x16x32_bf16 v[68:71], a[136:139], v[52:55], v[68:71]
  v_mfma_f32_16x16x32_bf16 v[76:79], a[216:219], v[52:55], v[76:79]
  ds_read_b128 v[48:51], v103 offset:1024
  ds_read_b128 v[52:55], v103 offset:21504
  s_waitcnt lgkmcnt(4)
  v_mfma_f32_16x16x32_bf16 v[56:59], a[60:63], v[32:35], v[56:59]
  v_mfma_f32_16x16x32_bf16 v[64:67], a[140:143], v[32:35], v[64:67]
  v_mfma_f32_16x16x32_bf16 v[72:75], a[220:223], v[32:35], v[72:75]
  v_mfma_f32_16x16x32_bf16 v[60:63], a[60:63], v[36:39], v[60:63]
  v_mfma_f32_16x16x32_bf16 v[68:71], a[140:143], v[36:39], v[68:71]
  v_mfma_f32_16x16x32_bf16 v[76:79], a[220:223], v[36:39], v[76:79]
  ds_read_b128 v[32:35], v104 offset:1024
  ds_read_b128 v[36:39], v104 offset:21504
  s_waitcnt lgkmcnt(4)
  v_mfma_f32_16x16x32_bf16 v[56:59], a[64:67], v[40:43], v[56:59]
  s_add_u32 m0, s65, 9216
  s_nop 0
  buffer_load_dwordx4 v101, s[4:7], s64 offen lds
  v_mfma_f32_16x16x32_bf16 v[64:67], a[144:147], v[40:43], v[64:67]
  v_mfma_f32_16x16x32_bf16 v[72:75], a[224:227], v[40:43], v[72:75]
  v_mfma_f32_16x16x32_bf16 v[60:63], a[64:67], v[44:47], v[60:63]
  v_mfma_f32_16x16x32_bf16 v[68:71], a[144:147], v[44:47], v[68:71]
  v_mfma_f32_16x16x32_bf16 v[76:79], a[224:227], v[44:47], v[76:79]
  ds_read_b128 v[40:43], v105 offset:1024
  ds_read_b128 v[44:47], v105 offset:21504
  s_waitcnt lgkmcnt(4)
  v_mfma_f32_16x16x32_bf16 v[56:59], a[68:71], v[48:51], v[56:59]
  v_mfma_f32_16x16x32_bf16 v[64:67], a[148:151], v[48:51], v[64:67]
  v_mfma_f32_16x16x32_bf16 v[72:75], a[228:231], v[48:51], v[72:75]
  v_mfma_f32_16x16x32_bf16 v[60:63], a[68:71], v[52:55], v[60:63]
  v_mfma_f32_16x16x32_bf16 v[68:71], a[148:151], v[52:55], v[68:71]
  v_mfma_f32_16x16x32_bf16 v[76:79], a[228:231], v[52:55], v[76:79]
  s_waitcnt lgkmcnt(2)
  v_mfma_f32_16x16x32_bf16 v[56:59], a[72:75], v[32:35], v[56:59]
  v_mfma_f32_16x16x32_bf16 v[64:67], a[152:155], v[32:35], v[64:67]
  v_mfma_f32_16x16x32_bf16 v[72:75], a[232:235], v[32:35], v[72:75]
  v_mfma_f32_16x16x32_bf16 v[60:63], a[72:75], v[36:39], v[60:63]
  v_mfma_f32_16x16x32_bf16 v[68:71], a[152:155], v[36:39], v[68:71]
  v_mfma_f32_16x16x32_bf16 v[76:79], a[232:235], v[36:39], v[76:79]
  s_waitcnt lgkmcnt(0)
  v_mfma_f32_16x16x32_bf16 v[56:59], a[76:79], v[40:43], v[56:59]
  v_mfma_f32_16x16x32_bf16 v[64:67], a[156:159], v[40:43], v[64:67]
  v_mfma_f32_16x16x32_bf16 v[72:75], a[236:239], v[40:43], v[72:75]
  v_mfma_f32_16x16x32_bf16 v[60:63], a[76:79], v[44:47], v[60:63]
  v_mfma_f32_16x16x32_bf16 v[68:71], a[156:159], v[44:47], v[68:71]
  v_mfma_f32_16x16x32_bf16 v[76:79], a[236:239], v[44:47], v[76:79]
  v_add_u32 v102, s71, v102
  v_add_u32 v103, s71, v103
  v_add_u32 v104, s71, v104
  v_add_u32 v105, s71, v105
  s_sub_u32 s71, 0, s71
  s_nop 3
  v_cvt_pk_bf16_f32 v80, v56, v57
  v_cvt_pk_bf16_f32 v81, v58, v59
  v_cvt_pk_bf16_f32 v82, v60, v61
  v_cvt_pk_bf16_f32 v83, v62, v63
  v_cvt_pk_bf16_f32 v84, v64, v65
  v_cvt_pk_bf16_f32 v85, v66, v67
  v_cvt_pk_bf16_f32 v86, v68, v69
  v_cvt_pk_bf16_f32 v87, v70, v71
  v_cvt_pk_bf16_f32 v88, v72, v73
  v_cvt_pk_bf16_f32 v89, v74, v75
  v_cvt_pk_bf16_f32 v90, v76, v77
  v_cvt_pk_bf16_f32 v91, v78, v79
  s_waitcnt vmcnt(0)
  s_barrier
L_t2_i:
  s_cmp_eq_u32 s62, 62
  s_cbranch_scc1 t2late_14196
  s_add_u32 s60, s62, 1
  s_cmp_ge_u32 s72, s60
  s_cbranch_scc1 t2wd_14199
  s_mov_b32 s56, 0
t2w_14198:
  buffer_load_dword v18, v11, s[48:51], 0 offen sc1
  s_waitcnt vmcnt(0)
  s_nop 1
  v_min_u32_dpp v18, v18, v18 row_ror:8 row_mask:0xf bank_mask:0xf
  s_nop 1
  v_min_u32_dpp v18, v18, v18 row_ror:4 row_mask:0xf bank_mask:0xf
  s_nop 1
  v_min_u32_dpp v18, v18, v18 row_ror:2 row_mask:0xf bank_mask:0xf
  s_nop 1
  v_min_u32_dpp v18, v18, v18 row_ror:1 row_mask:0xf bank_mask:0xf
  s_nop 0
  v_readlane_b32 s72, v18, 0
  v_readlane_b32 s58, v18, 16
  s_min_u32 s72, s72, s58
  s_cmp_ge_u32 s72, s60
  s_cbranch_scc1 t2wd_14199
  s_cmp_lg_u32 s55, 0
  s_cbranch_scc1 t2wd_14199
  s_add_u32 s56, s56, 1
  s_cmp_lt_u32 s56, 0x20000
  s_cbranch_scc1 t2w_14198
  s_mov_b32 s55, 1
t2wd_14199:
  s_add_u32 s58, s73, 0x1800000
  s_add_u32 s59, s74, 0xc00000
  buffer_load_dwordx4 v[106:109], v15, s[48:51], s73 offen offset:0 sc1
  buffer_load_dwordx2 v[118:119], v16, s[48:51], s74 offen offset:0 sc1
  buffer_load_dwordx4 v[110:113], v15, s[48:51], s73 offen offset:1024 sc1
  buffer_load_dwordx2 v[120:121], v16, s[48:51], s74 offen offset:512 sc1
  buffer_load_dwordx4 v[114:117], v15, s[48:51], s73 offen offset:2048 sc1
  buffer_load_dwordx2 v[122:123], v16, s[48:51], s74 offen offset:1024 sc1
  buffer_load_dwordx4 v[124:127], v15, s[48:51], s58 offen offset:0 sc1
  buffer_load_dwordx2 v[136:137], v16, s[48:51], s59 offen offset:0 sc1
  buffer_load_dwordx4 v[128:131], v15, s[48:51], s58 offen offset:1024 sc1
  buffer_load_dwordx2 v[138:139], v16, s[48:51], s59 offen offset:512 sc1
  buffer_load_dwordx4 v[132:135], v15, s[48:51], s58 offen offset:2048 sc1
  buffer_load_dwordx2 v[140:141], v16, s[48:51], s59 offen offset:1024 sc1
t2late_14196:
  s_cmp_eq_u32 s62, 63
  s_cbranch_scc1 t2go_14197
  s_cmp_lt_u32 s62, 62
  s_cselect_b32 s58, 40960, 0
  s_add_u32 s64, s64, s58
  s_add_u32 s65, s65, s71
  ds_read_b128 v[32:35], v102 offset:0
  ds_read_b128 v[36:39], v102 offset:20480
  ds_read_b128 v[40:43], v103 offset:0
  ds_read_b128 v[44:47], v103 offset:20480
  ds_read_b128 v[48:51], v104 offset:0
  ds_read_b128 v[52:55], v104 offset:20480
  s_waitcnt lgkmcnt(4)
  v_mfma_f32_16x16x32_bf16 v[56:59], a[0:3], v[32:35], 0
  v_mfma_f32_16x16x32_bf16 v[64:67], a[80:83], v[32:35], 0
  v_mfma_f32_16x16x32_bf16 v[72:75], a[160:163], v[32:35], 0
  v_mfma_f32_16x16x32_bf16 v[60:63], a[0:3], v[36:39], 0
  v_mfma_f32_16x16x32_bf16 v[68:71], a[80:83], v[36:39], 0
  v_mfma_f32_16x16x32_bf16 v[76:79], a[160:163], v[36:39], 0
  ds_read_b128 v[32:35], v105 offset:0
  ds_read_b128 v[36:39], v105 offset:20480
  s_waitcnt lgkmcnt(4)
  v_mfma_f32_16x16x32_bf16 v[56:59], a[4:7], v[40:43], v[56:59]
  s_add_u32 m0, s65, 0
  s_nop 0
  buffer_load_dwordx4 v92, s[4:7], s64 offen lds
  v_mfma_f32_16x16x32_bf16 v[64:67], a[84:87], v[40:43], v[64:67]
  v_mfma_f32_16x16x32_bf16 v[72:75], a[164:167], v[40:43], v[72:75]
  v_mfma_f32_16x16x32_bf16 v[60:63], a[4:7], v[44:47], v[60:63]
  v_mfma_f32_16x16x32_bf16 v[68:71], a[84:87], v[44:47], v[68:71]
  v_mfma_f32_16x16x32_bf16 v[76:79], a[164:167], v[44:47], v[76:79]
  ds_read_b128 v[40:43], v102 offset:256
  ds_read_b128 v[44:47], v102 offset:20736
  s_waitcnt lgkmcnt(4)
  v_mfma_f32_16x16x32_bf16 v[56:59], a[8:11], v[48:51], v[56:59]
  v_mfma_f32_16x16x32_bf16 v[64:67], a[88:91], v[48:51], v[64:67]
  v_mfma_f32_16x16x32_bf16 v[72:75], a[168:171], v[48:51], v[72:75]
  v_mfma_f32_16x16x32_bf16 v[60:63], a[8:11], v[52:55], v[60:63]
  v_mfma_f32_16x16x32_bf16 v[68:71], a[88:91], v[52:55], v[68:71]
  s_add_u32 m0, s65, 1024
  s_nop 0
  buffer_load_dwordx4 v93, s[4:7], s64 offen lds
  v_mfma_f32_16x16x32_bf16 v[76:79], a[168:171], v[52:55], v[76:79]
  ds_read_b128 v[48:51], v103 offset:256
  ds_read_b128 v[52:55], v103 offset:20736
  s_waitcnt lgkmcnt(4)
  v_mfma_f32_16x16x32_bf16 v[56:59], a[12:15], v[32:35], v[56:59]
  v_mfma_f32_16x16x32_bf16 v[64:67], a[92:95], v[32:35], v[64:67]
  v_mfma_f32_16x16x32_bf16 v[72:75], a[172:175], v[32:35], v[72:75]
  v_mfma_f32_16x16x32_bf16 v[60:63], a[12:15], v[36:39], v[60:63]
  v_mfma_f32_16x16x32_bf16 v[68:71], a[92:95], v[36:39], v[68:71]
  v_mfma_f32_16x16x32_bf16 v[76:79], a[172:175], v[36:39], v[76:79]
  ds_read_b128 v[32:35], v104 offset:256
  ds_read_b128 v[36:39], v104 offset:20736
  s_waitcnt lgkmcnt(4)
  v_mfma_f32_16x16x32_bf16 v[56:59], a[16:19], v[40:43], v[56:59]
  v_mfma_f32_16x16x32_bf16 v[64:67], a[96:99], v[40:43], v[64:67]
  v_mfma_f32_16x16x32_bf16 v[72:75], a[176:179], v[40:43], v[72:75]
  s_add_u32 m0, s65, 2048
  s_nop 0
  buffer_load_dwordx4 v94, s[4:7], s64 offen lds
  v_mfma_f32_16x16x32_bf16 v[60:63], a[16:19], v[44:47], v[60:63]
  v_mfma_f32_16x16x32_bf16 v[68:71], a[96:99], v[44:47], v[68:71]
  v_mfma_f32_16x16x32_bf16 v[76:79], a[176:179], v[44:47], v[76:79]
  ds_read_b128 v[40:43], v105 offset:256
  ds_read_b128 v[44:47], v105 offset:20736
  s_waitcnt lgkmcnt(4)
  v_mfma_f32_16x16x32_bf16 v[56:59], a[20:23], v[48:51], v[56:59]
  v_mfma_f32_16x16x32_bf16 v[64:67], a[100:103], v[48:51], v[64:67]
  v_mfma_f32_16x16x32_bf16 v[72:75], a[180:183], v[48:51], v[72:75]
  v_mfma_f32_16x16x32_bf16 v[60:63], a[20:23], v[52:55], v[60:63]
  v_mfma_f32_16x16x32_bf16 v[68:71], a[100:103], v[52:55], v[68:71]
  v_mfma_f32_16x16x32_bf16 v[76:79], a[180:183], v[52:55], v[76:79]
  ds_read_b128 v[48:51], v102 offset:512
  ds_read_b128 v[52:55], v102 offset:20992
  s_waitcnt lgkmcnt(4)
  v_mfma_f32_16x16x32_bf16 v[56:59], a[24:27], v[32:35], v[56:59]
  s_add_u32 m0, s65, 3072
  s_nop 0
  buffer_load_dwordx4 v95, s[4:7], s64 offen lds
  v_mfma_f32_16x16x32_bf16 v[64:67], a[104:107], v[32:35], v[64:67]
  v_mfma_f32_16x16x32_bf16 v[72:75], a[184:187], v[32:35], v[72:75]
  v_mfma_f32_16x16x32_bf16 v[60:63], a[24:27], v[36:39], v[60:63]
  v_mfma_f32_16x16x32_bf16 v[68:71], a[104:107], v[36:39], v[68:71]
  v_mfma_f32_16x16x32_bf16 v[76:79], a[184:187], v[36:39], v[76:79]
  ds_read_b128 v[32:35], v103 offset:512
  ds_read_b128 v[36:39], v103 offset:20992
  s_waitcnt lgkmcnt(4)
  v_mfma_f32_16x16x32_bf16 v[56:59], a[28:31], v[40:43], v[56:59]
  v_mfma_f32_16x16x32_bf16 v[64:67], a[108:111], v[40:43], v[64:67]
  v_mfma_f32_16x16x32_bf16 v[72:75], a[188:191], v[40:43], v[72:75]
  v_mfma_f32_16x16x32_bf16 v[60:63], a[28:31], v[44:47], v[60:63]
  v_mfma_f32_16x16x32_bf16 v[68:71], a[108:111], v[44:47], v[68:71]
  s_add_u32 m0, s65, 4096
  s_nop 0
  buffer_load_dwordx4 v96, s[4:7], s64 offen lds
  v_mfma_f32_16x16x32_bf16 v[76:79], a[188:191], v[44:47], v[76:79]
  ds_read_b128 v[40:43], v104 offset:512
  ds_read_b128 v[44:47], v104 offset:20992
  s_waitcnt lgkmcnt(4)
  v_mfma_f32_16x16x32_bf16 v[56:59], a[32:35], v[48:51], v[56:59]
  v_mfma_f32_16x16x32_bf16 v[64:67], a[112:115], v[48:51], v[64:67]
  v_mfma_f32_16x16x32_bf16 v[72:75], a[192:195], v[48:51], v[72:75]
  v_mfma_f32_16x16x32_bf16 v[60:63], a[32:35], v[52:55], v[60:63]
  v_mfma_f32_16x16x32_bf16 v[68:71], a[112:115], v[52:55], v[68:71]
  v_mfma_f32_16x16x32_bf16 v[76:79], a[192:195], v[52:55], v[76:79]
  ds_read_b128 v[48:51], v105 offset:512
  ds_read_b128 v[52:55], v105 offset:20992
  s_waitcnt lgkmcnt(4)
  v_mfma_f32_16x16x32_bf16 v[56:59], a[36:39], v[32:35], v[56:59]
  v_mfma_f32_16x16x32_bf16 v[64:67], a[116:119], v[32:35], v[64:67]
  v_mfma_f32_16x16x32_bf16 v[72:75], a[196:199], v[32:35], v[72:75]
  s_add_u32 m0, s65, 5120
  s_nop 0
  buffer_load_dwordx4 v97, s[4:7], s64 offen lds
  v_mfma_f32_16x16x32_bf16 v[60:63], a[36:39], v[36:39], v[60:63]
  v_mfma_f32_16x16x32_bf16 v[68:71], a[116:119], v[36:39], v[68:71]
  v_mfma_f32_16x16x32_bf16 v[76:79], a[196:199], v[36:39], v[76:79]
  ds_read_b128 v[32:35], v102 offset:768
  ds_read_b128 v[36:39], v102 offset:21248
  s_waitcnt lgkmcnt(4)
  v_mfma_f32_16x16x32_bf16 v[56:59], a[40:43], v[40:43], v[56:59]
  v_mfma_f32_16x16x32_bf16 v[64:67], a[120:123], v[40:43], v[64:67]
  v_mfma_f32_16x16x32_bf16 v[72:75], a[200:203], v[40:43], v[72:75]
  v_mfma_f32_16x16x32_bf16 v[60:63], a[40:43], v[44:47], v[60:63]
  v_mfma_f32_16x16x32_bf16 v[68:71], a[120:123], v[44:47], v[68:71]
  v_mfma_f32_16x16x32_bf16 v[76:79], a[200:203], v[44:47], v[76:79]
  ds_read_b128 v[40:43], v103 offset:768
  ds_read_b128 v[44:47], v103 offset:21248
  s_waitcnt lgkmcnt(4)
  v_mfma_f32_16x16x32_bf16 v[56:59], a[44:47], v[48:51], v[56:59]
  s_add_u32 m0, s65, 6144
  s_nop 0
  buffer_load_dwordx4 v98, s[4:7], s64 offen lds
  v_mfma_f32_16x16x32_bf16 v[64:67], a[124:127], v[48:51], v[64:67]
  v_mfma_f32_16x16x32_bf16 v[72:75], a[204:207], v[48:51], v[72:75]
  v_mfma_f32_16x16x32_bf16 v[60:63], a[44:47], v[52:55], v[60:63]
  v_mfma_f32_16x16x32_bf16 v[68:71], a[124:127], v[52:55], v[68:71]
  v_mfma_f32_16x16x32_bf16 v[76:79], a[204:207], v[52:55], v[76:79]
  ds_read_b128 v[48:51], v104 offset:768
  ds_read_b128 v[52:55], v104 offset:21248
  s_waitcnt lgkmcnt(4)
  v_mfma_f32_16x16x32_bf16 v[56:59], a[48:51], v[32:35], v[56:59]
  v_mfma_f32_16x16x32_bf16 v[64:67], a[128:131], v[32:35], v[64:67]
  v_mfma_f32_16x16x32_bf16 v[72:75], a[208:211], v[32:35], v[72:75]
  v_mfma_f32_16x16x32_bf16 v[60:63], a[48:51], v[36:39], v[60:63]
  v_mfma_f32_16x16x32_bf16 v[68:71], a[128:131], v[36:39], v[68:71]
  s_add_u32 m0, s65, 7168
  s_nop 0
  buffer_load_dwordx4 v99, s[4:7], s64 offen lds
  v_mfma_f32_16x16x32_bf16 v[76:79], a[208:211], v[36:39], v[76:79]
  ds_read_b128 v[32:35], v105 offset:768
  ds_read_b128 v[36:39], v105 offset:21248
  s_waitcnt lgkmcnt(4)
  v_mfma_f32_16x16x32_bf16 v[56:59], a[52:55], v[40:43], v[56:59]
  v_mfma_f32_16x16x32_bf16 v[64:67], a[132:135], v[40:43], v[64:67]
  v_mfma_f32_16x16x32_bf16 v[72:75], a[212:215], v[40:43], v[72:75]
  v_mfma_f32_16x16x32_bf16 v[60:63], a[52:55], v[44:47], v[60:63]
  v_mfma_f32_16x16x32_bf16 v[68:71], a[132:135], v[44:47], v[68:71]
  v_mfma_f32_16x16x32_bf16 v[76:79], a[212:215], v[44:47], v[76:79]
  ds_read_b128 v[40:43], v102 offset:1024
  ds_read_b128 v[44:47], v102 offset:21504
  s_waitcnt lgkmcnt(4)
  v_mfma_f32_16x16x32_bf16 v[56:59], a[56:59], v[48:51], v[56:59]
  v_mfma_f32_16x16x32_bf16 v[64:67], a[136:139], v[48:51], v[64:67]
  v_mfma_f32_16x16x32_bf16 v[72:75], a[216:219], v[48:51], v[72:75]
  s_add_u32 m0, s65, 8192
  s_nop 0
  buffer_load_dwordx4 v100, s[4:7], s64 offen lds
  v_mfma_f32_16x16x32_bf16 v[60:63], a[56:59], v[52:55], v[60:63]
  v_mfma_f32_16x16x32_bf16 v[68:71], a[136:139], v[52:55], v[68:71]
  v_mfma_f32_16x16x32_bf16 v[76:79], a[216:219], v[52:55], v[76:79]
  ds_read_b128 v[48:51], v103 offset:1024
  ds_read_b128 v[52:55], v103 offset:21504
  s_waitcnt lgkmcnt(4)
  v_mfma_f32_16x16x32_bf16 v[56:59], a[60:63], v[32:35], v[56:59]
  v_mfma_f32_16x16x32_bf16 v[64:67], a[140:143], v[32:35], v[64:67]
  v_mfma_f32_16x16x32_bf16 v[72:75], a[220:223], v[32:35], v[72:75]
  v_mfma_f32_16x16x32_bf16 v[60:63], a[60:63], v[36:39], v[60:63]
  v_mfma_f32_16x16x32_bf16 v[68:71], a[140:143], v[36:39], v[68:71]
  v_mfma_f32_16x16x32_bf16 v[76:79], a[220:223], v[36:39], v[76:79]
  ds_read_b128 v[32:35], v104 offset:1024
  ds_read_b128 v[36:39], v104 offset:21504
  s_waitcnt lgkmcnt(4)
  v_mfma_f32_16x16x32_bf16 v[56:59], a[64:67], v[40:43], v[56:59]
  s_add_u32 m0, s65, 9216
  s_nop 0
  buffer_load_dwordx4 v101, s[4:7], s64 offen lds
  v_mfma_f32_16x16x32_bf16 v[64:67], a[144:147], v[40:43], v[64:67]
  v_mfma_f32_16x16x32_bf16 v[72:75], a[224:227], v[40:43], v[72:75]
  v_mfma_f32_16x16x32_bf16 v[60:63], a[64:67], v[44:47], v[60:63]
  v_mfma_f32_16x16x32_bf16 v[68:71], a[144:147], v[44:47], v[68:71]
  v_mfma_f32_16x16x32_bf16 v[76:79], a[224:227], v[44:47], v[76:79]
  ds_read_b128 v[40:43], v105 offset:1024
  ds_read_b128 v[44:47], v105 offset:21504
  s_waitcnt lgkmcnt(4)
  v_mfma_f32_16x16x32_bf16 v[56:59], a[68:71], v[48:51], v[56:59]
  v_mfma_f32_16x16x32_bf16 v[64:67], a[148:151], v[48:51], v[64:67]
  v_mfma_f32_16x16x32_bf16 v[72:75], a[228:231], v[48:51], v[72:75]
  v_mfma_f32_16x16x32_bf16 v[60:63], a[68:71], v[52:55], v[60:63]
  v_mfma_f32_16x16x32_bf16 v[68:71], a[148:151], v[52:55], v[68:71]
  v_mfma_f32_16x16x32_bf16 v[76:79], a[228:231], v[52:55], v[76:79]
  s_waitcnt lgkmcnt(2)
  v_mfma_f32_16x16x32_bf16 v[56:59], a[72:75], v[32:35], v[56:59]
  v_mfma_f32_16x16x32_bf16 v[64:67], a[152:155], v[32:35], v[64:67]
  v_mfma_f32_16x16x32_bf16 v[72:75], a[232:235], v[32:35], v[72:75]
  v_mfma_f32_16x16x32_bf16 v[60:63], a[72:75], v[36:39], v[60:63]
  v_mfma_f32_16x16x32_bf16 v[68:71], a[152:155], v[36:39], v[68:71]
  v_mfma_f32_16x16x32_bf16 v[76:79], a[232:235], v[36:39], v[76:79]
  s_waitcnt lgkmcnt(0)
  v_mfma_f32_16x16x32_bf16 v[56:59], a[76:79], v[40:43], v[56:59]
  v_mfma_f32_16x16x32_bf16 v[64:67], a[156:159], v[40:43], v[64:67]
  v_mfma_f32_16x16x32_bf16 v[72:75], a[236:239], v[40:43], v[72:75]
  v_mfma_f32_16x16x32_bf16 v[60:63], a[76:79], v[44:47], v[60:63]
  v_mfma_f32_16x16x32_bf16 v[68:71], a[156:159], v[44:47], v[68:71]
  v_mfma_f32_16x16x32_bf16 v[76:79], a[236:239], v[44:47], v[76:79]
  v_add_u32 v102, s71, v102
  v_add_u32 v103, s71, v103
  v_add_u32 v104, s71, v104
  v_add_u32 v105, s71, v105
  s_sub_u32 s71, 0, s71
  s_cmp_lg_u32 s62, 62
  s_cbranch_scc1 t2go_14197
  s_add_u32 s60, s62, 1
  s_cmp_ge_u32 s72, s60
  s_cbranch_scc1 t2wd_14201
  s_mov_b32 s56, 0
t2w_14200:
  buffer_load_dword v18, v11, s[48:51], 0 offen sc1
  s_waitcnt vmcnt(0)
  s_nop 1
  v_min_u32_dpp v18, v18, v18 row_ror:8 row_mask:0xf bank_mask:0xf
  s_nop 1
  v_min_u32_dpp v18, v18, v18 row_ror:4 row_mask:0xf bank_mask:0xf
  s_nop 1
  v_min_u32_dpp v18, v18, v18 row_ror:2 row_mask:0xf bank_mask:0xf
  s_nop 1
  v_min_u32_dpp v18, v18, v18 row_ror:1 row_mask:0xf bank_mask:0xf
  s_nop 0
  v_readlane_b32 s72, v18, 0
  v_readlane_b32 s58, v18, 16
  s_min_u32 s72, s72, s58
  s_cmp_ge_u32 s72, s60
  s_cbranch_scc1 t2wd_14201
  s_cmp_lg_u32 s55, 0
  s_cbranch_scc1 t2wd_14201
  s_add_u32 s56, s56, 1
  s_cmp_lt_u32 s56, 0x20000
  s_cbranch_scc1 t2w_14200
  s_mov_b32 s55, 1
t2wd_14201:
  s_add_u32 s58, s73, 0x1800000
  s_add_u32 s59, s74, 0xc00000
  buffer_load_dwordx4 v[106:109], v15, s[48:51], s73 offen offset:0 sc1
  buffer_load_dwordx2 v[118:119], v16, s[48:51], s74 offen offset:0 sc1
  buffer_load_dwordx4 v[110:113], v15, s[48:51], s73 offen offset:1024 sc1
  buffer_load_dwordx2 v[120:121], v16, s[48:51], s74 offen offset:512 sc1
  buffer_load_dwordx4 v[114:117], v15, s[48:51], s73 offen offset:2048 sc1
  buffer_load_dwordx2 v[122:123], v16, s[48:51], s74 offen offset:1024 sc1
  buffer_load_dwordx4 v[124:127], v15, s[48:51], s58 offen offset:0 sc1
  buffer_load_dwordx2 v[136:137], v16, s[48:51], s59 offen offset:0 sc1
  buffer_load_dwordx4 v[128:131], v15, s[48:51], s58 offen offset:1024 sc1
  buffer_load_dwordx2 v[138:139], v16, s[48:51], s59 offen offset:512 sc1
  buffer_load_dwordx4 v[132:135], v15, s[48:51], s58 offen offset:2048 sc1
  buffer_load_dwordx2 v[140:141], v16, s[48:51], s59 offen offset:1024 sc1
t2go_14197:
  s_waitcnt vmcnt(0)
  v_mfma_f32_16x16x16_bf16 v[144:147], v[118:119], v[80:81], 0
  v_mfma_f32_16x16x16_bf16 v[148:151], v[106:107], v[80:81], 0
  v_mfma_f32_16x16x16_bf16 v[152:155], v[118:119], v[82:83], 0
  v_mfma_f32_16x16x16_bf16 v[156:159], v[106:107], v[82:83], 0
  v_mfma_f32_16x16x16_bf16 v[160:163], v[108:109], v[82:83], 0
  v_mfma_f32_16x16x16_bf16 v[144:147], v[120:121], v[84:85], v[144:147]
  v_mfma_f32_16x16x16_bf16 v[148:151], v[110:111], v[84:85], v[148:151]
  v_mfma_f32_16x16x16_bf16 v[152:155], v[120:121], v[86:87], v[152:155]
  v_mfma_f32_16x16x16_bf16 v[156:159], v[110:111], v[86:87], v[156:159]
  v_mfma_f32_16x16x16_bf16 v[160:163], v[112:113], v[86:87], v[160:163]
  v_mfma_f32_16x16x16_bf16 v[144:147], v[122:123], v[88:89], v[144:147]
  v_mfma_f32_16x16x16_bf16 v[148:151], v[114:115], v[88:89], v[148:151]
  v_mfma_f32_16x16x16_bf16 v[152:155], v[122:123], v[90:91], v[152:155]
  v_mfma_f32_16x16x16_bf16 v[156:159], v[114:115], v[90:91], v[156:159]
  v_mfma_f32_16x16x16_bf16 v[160:163], v[116:117], v[90:91], v[160:163]
  s_nop 3
  ds_write_b128 v22, v[144:147] offset:0
  ds_write_b128 v22, v[148:151] offset:4096
  ds_write_b128 v22, v[152:155] offset:8192
  ds_write_b128 v22, v[156:159] offset:12288
  ds_write_b128 v22, v[160:163] offset:16384
  s_waitcnt lgkmcnt(0)
  s_barrier
  v_cvt_pk_bf16_f32 v80, v56, v57
  v_cvt_pk_bf16_f32 v81, v58, v59
  v_cvt_pk_bf16_f32 v82, v60, v61
  v_cvt_pk_bf16_f32 v83, v62, v63
  v_cvt_pk_bf16_f32 v84, v64, v65
  v_cvt_pk_bf16_f32 v85, v66, v67
  v_cvt_pk_bf16_f32 v86, v68, v69
  v_cvt_pk_bf16_f32 v87, v70, v71
  v_cvt_pk_bf16_f32 v88, v72, v73
  v_cvt_pk_bf16_f32 v89, v74, v75
  v_cvt_pk_bf16_f32 v90, v76, v77
  v_cvt_pk_bf16_f32 v91, v78, v79
  ds_read_b128 v[144:147], v23 offset:0
  ds_read_b128 v[148:151], v23 offset:1024
  ds_read_b128 v[152:155], v23 offset:2048
  ds_read_b128 v[156:159], v23 offset:3072
  ds_read_b128 v[160:163], v23 offset:4096
  ds_read_b128 v[164:167], v23 offset:5120
  ds_read_b128 v[168:171], v23 offset:6144
  ds_read_b128 v[172:175], v23 offset:7168
  ds_read_b128 v[176:179], v23 offset:8192
  ds_read_b128 v[180:183], v23 offset:9216
  ds_read_b128 v[184:187], v23 offset:10240
  ds_read_b128 v[188:191], v23 offset:11264
  s_waitcnt lgkmcnt(8)
  ds_read_b128 v[192:195], v23 offset:12288
  ds_read_b128 v[196:199], v23 offset:13312
  ds_read_b128 v[200:203], v23 offset:14336
  ds_read_b128 v[204:207], v23 offset:15360
  v_add_f32 v144, v144, v148
  v_add_f32 v152, v152, v156
  v_add_f32 v145, v145, v149
  v_add_f32 v153, v153, v157
  v_add_f32 v146, v146, v150
  v_add_f32 v154, v154, v158
  v_add_f32 v147, v147, v151
  v_add_f32 v155, v155, v159
  v_add_f32 v144, v144, v152
  v_add_f32 v145, v145, v153
  v_add_f32 v146, v146, v154
  v_add_f32 v147, v147, v155
  v_add_f32 v144, v144, v10
  v_add_f32 v145, v145, v10
  v_add_f32 v146, v146, v10
  v_add_f32 v147, v147, v10
  s_waitcnt lgkmcnt(8)
  ds_read_b128 v[208:211], v23 offset:16384
  ds_read_b128 v[212:215], v23 offset:17408
  ds_read_b128 v[216:219], v23 offset:18432
  ds_read_b128 v[220:223], v23 offset:19456
  v_add_f32 v160, v160, v164
  v_add_f32 v168, v168, v172
  v_add_f32 v161, v161, v165
  v_add_f32 v169, v169, v173
  v_add_f32 v162, v162, v166
  v_add_f32 v170, v170, v174
  v_add_f32 v163, v163, v167
  v_add_f32 v171, v171, v175
  v_add_f32 v160, v160, v168
  v_add_f32 v161, v161, v169
  v_add_f32 v162, v162, v170
  v_add_f32 v163, v163, v171
  v_add_f32 v160, v160, v6
  v_add_f32 v161, v161, v7
  v_add_f32 v162, v162, v8
  v_add_f32 v163, v163, v9
  s_waitcnt lgkmcnt(8)
  v_add_f32 v176, v176, v180
  v_add_f32 v184, v184, v188
  v_add_f32 v177, v177, v181
  v_add_f32 v185, v185, v189
  v_add_f32 v178, v178, v182
  v_add_f32 v186, v186, v190
  v_add_f32 v179, v179, v183
  v_add_f32 v187, v187, v191
  v_add_f32 v176, v176, v184
  v_add_f32 v177, v177, v185
  v_add_f32 v178, v178, v186
  v_add_f32 v179, v179, v187
  v_add_f32 v176, v176, v10
  v_add_f32 v177, v177, v10
  v_add_f32 v178, v178, v10
  v_add_f32 v179, v179, v10
  s_waitcnt lgkmcnt(4)
  v_add_f32 v192, v192, v196
  v_add_f32 v200, v200, v204
  v_add_f32 v193, v193, v197
  v_add_f32 v201, v201, v205
  v_add_f32 v194, v194, v198
  v_add_f32 v202, v202, v206
  v_add_f32 v195, v195, v199
  v_add_f32 v203, v203, v207
  v_add_f32 v192, v192, v200
  v_add_f32 v193, v193, v201
  v_add_f32 v194, v194, v202
  v_add_f32 v195, v195, v203
  s_waitcnt lgkmcnt(0)
  v_add_f32 v208, v208, v212
  v_add_f32 v216, v216, v220
  v_add_f32 v209, v209, v213
  v_add_f32 v217, v217, v221
  v_add_f32 v210, v210, v214
  v_add_f32 v218, v218, v222
  v_add_f32 v211, v211, v215
  v_add_f32 v219, v219, v223
  v_add_f32 v208, v208, v216
  v_add_f32 v209, v209, v217
  v_add_f32 v210, v210, v218
  v_add_f32 v211, v211, v219
  v_add_f32 v208, v208, v6
  v_add_f32 v209, v209, v7
  v_add_f32 v210, v210, v8
  v_add_f32 v211, v211, v9
  v_max3_f32 v18, v144, v145, v146
  v_max3_f32 v19, v176, v177, v178
  v_max3_f32 v18, v18, v147, v160
  v_max3_f32 v19, v19, v179, v192
  v_max3_f32 v18, v18, v161, v162
  v_max3_f32 v19, v19, v193, v194
  v_max_f32 v18, v18, v163
  v_max3_f32 v19, v19, v195, v208
  v_max3_f32 v19, v19, v209, v210
  v_max_f32 v19, v19, v211
  v_mov_b32 v20, v18
  s_nop 1
  v_permlane16_swap_b32 v18, v20
  s_nop 0
  v_max_f32 v18, v18, v20
  v_mov_b32 v20, v18
  s_nop 1
  v_permlane32_swap_b32 v18, v20
  s_nop 0
  v_max_f32 v18, v18, v20
  v_mov_b32 v20, v19
  s_nop 1
  v_permlane16_swap_b32 v19, v20
  s_nop 0
  v_max_f32 v19, v19, v20
  v_mov_b32 v20, v19
  s_nop 1
  v_permlane32_swap_b32 v19, v20
  s_nop 0
  v_max_f32 v19, v19, v20
  v_mul_f32 v18, s77, v18
  v_mul_f32 v19, s77, v19
  v_fma_f32 v144, v144, s77, -v18
  v_fma_f32 v145, v145, s77, -v18
  v_fma_f32 v146, v146, s77, -v18
  v_fma_f32 v147, v147, s77, -v18
  v_fma_f32 v160, v160, s77, -v18
  v_fma_f32 v161, v161, s77, -v18
  v_fma_f32 v162, v162, s77, -v18
  v_fma_f32 v163, v163, s77, -v18
  v_fma_f32 v176, v176, s77, -v19
  v_fma_f32 v177, v177, s77, -v19
  v_fma_f32 v178, v178, s77, -v19
  v_fma_f32 v179, v179, s77, -v19
  v_fma_f32 v192, v192, s77, -v19
  v_fma_f32 v193, v193, s77, -v19
  v_fma_f32 v194, v194, s77, -v19
  v_fma_f32 v195, v195, s77, -v19
  v_fma_f32 v208, v208, s77, -v19
  v_fma_f32 v209, v209, s77, -v19
  v_fma_f32 v210, v210, s77, -v19
  v_fma_f32 v211, v211, s77, -v19
  v_exp_f32 v144, v144
  v_exp_f32 v145, v145
  v_exp_f32 v146, v146
  v_exp_f32 v147, v147
  v_exp_f32 v160, v160
  v_exp_f32 v161, v161
  v_exp_f32 v162, v162
  v_exp_f32 v163, v163
  v_exp_f32 v176, v176
  v_exp_f32 v177, v177
  v_exp_f32 v178, v178
  v_exp_f32 v179, v179
  v_exp_f32 v192, v192
  v_exp_f32 v193, v193
  v_exp_f32 v194, v194
  v_exp_f32 v195, v195
  v_exp_f32 v208, v208
  v_exp_f32 v209, v209
  v_exp_f32 v210, v210
  v_exp_f32 v211, v211
  s_nop 0
  v_cvt_pk_bf16_f32 v150, v144, v145
  v_cvt_pk_bf16_f32 v151, v146, v147
  v_cvt_pk_bf16_f32 v148, v160, v161
  v_cvt_pk_bf16_f32 v149, v162, v163
  v_cvt_pk_bf16_f32 v156, v176, v177
  v_cvt_pk_bf16_f32 v157, v178, v179
  v_cvt_pk_bf16_f32 v152, v192, v193
  v_cvt_pk_bf16_f32 v153, v194, v195
  v_cvt_pk_bf16_f32 v154, v208, v209
  v_cvt_pk_bf16_f32 v155, v210, v211
  s_nop 1
  v_mfma_f32_16x16x16_bf16 v[248:251], v[2:3], v[148:149], 0
  v_mfma_f32_16x16x32_bf16 v[252:255], v[2:5], v[152:155], 0
  v_mfma_f32_16x16x16_bf16 v[224:227], v[124:125], v[148:149], 0
  v_mfma_f32_16x16x32_bf16 v[228:231], v[124:127], v[152:155], 0
  v_mfma_f32_16x16x16_bf16 v[232:235], v[128:129], v[148:149], 0
  v_mfma_f32_16x16x32_bf16 v[236:239], v[128:131], v[152:155], 0
  v_mfma_f32_16x16x16_bf16 v[240:243], v[132:133], v[148:149], 0
  v_mfma_f32_16x16x32_bf16 v[244:247], v[132:135], v[152:155], 0
  v_mfma_f32_16x16x16_bf16 v[248:251], v[2:3], v[150:151], v[248:251]
  v_mfma_f32_16x16x16_bf16 v[252:255], v[2:3], v[156:157], v[252:255]
  v_mfma_f32_16x16x16_bf16 v[224:227], v[136:137], v[150:151], v[224:227]
  v_mfma_f32_16x16x16_bf16 v[228:231], v[136:137], v[156:157], v[228:231]
  v_mfma_f32_16x16x16_bf16 v[232:235], v[138:139], v[150:151], v[232:235]
  v_mfma_f32_16x16x16_bf16 v[236:239], v[138:139], v[156:157], v[236:239]
  v_mfma_f32_16x16x16_bf16 v[240:243], v[140:141], v[150:151], v[240:243]
  v_mfma_f32_16x16x16_bf16 v[244:247], v[140:141], v[156:157], v[244:247]
  s_nop 1
  v_rcp_f32 v18, v248
  v_rcp_f32 v19, v252
  s_nop 1
  v_mul_f32 v224, v224, v18
  v_mul_f32 v225, v225, v18
  v_mul_f32 v226, v226, v18
  v_mul_f32 v227, v227, v18
  v_cvt_pk_bf16_f32 v224, v224, v225
  v_cvt_pk_bf16_f32 v225, v226, v227
  buffer_store_dwordx2 v[224:225], v12, s[48:51], s75 offen offset:0 sc1
  v_mul_f32 v228, v228, v19
  v_mul_f32 v229, v229, v19
  v_mul_f32 v230, v230, v19
  v_mul_f32 v231, v231, v19
  v_cvt_pk_bf16_f32 v228, v228, v229
  v_cvt_pk_bf16_f32 v229, v230, v231
  buffer_store_dwordx2 v[228:229], v12, s[48:51], s75 offen offset:1024 sc1
  v_mul_f32 v232, v232, v18
  v_mul_f32 v233, v233, v18
  v_mul_f32 v234, v234, v18
  v_mul_f32 v235, v235, v18
  v_cvt_pk_bf16_f32 v232, v232, v233
  v_cvt_pk_bf16_f32 v233, v234, v235
  buffer_store_dwordx2 v[232:233], v13, s[48:51], s75 offen offset:0 sc1
  v_mul_f32 v236, v236, v19
  v_mul_f32 v237, v237, v19
  v_mul_f32 v238, v238, v19
  v_mul_f32 v239, v239, v19
  v_cvt_pk_bf16_f32 v236, v236, v237
  v_cvt_pk_bf16_f32 v237, v238, v239
  buffer_store_dwordx2 v[236:237], v13, s[48:51], s75 offen offset:1024 sc1
  v_mul_f32 v240, v240, v18
  v_mul_f32 v241, v241, v18
  v_mul_f32 v242, v242, v18
  v_mul_f32 v243, v243, v18
  v_cvt_pk_bf16_f32 v240, v240, v241
  v_cvt_pk_bf16_f32 v241, v242, v243
  buffer_store_dwordx2 v[240:241], v14, s[48:51], s75 offen offset:0 sc1
  v_mul_f32 v244, v244, v19
  v_mul_f32 v245, v245, v19
  v_mul_f32 v246, v246, v19
  v_mul_f32 v247, v247, v19
  v_cvt_pk_bf16_f32 v244, v244, v245
  v_cvt_pk_bf16_f32 v245, v246, v247
  buffer_store_dwordx2 v[244:245], v14, s[48:51], s75 offen offset:1024 sc1
  s_waitcnt vmcnt(0)
  s_barrier
  s_cmp_lg_u32 s52, 0
  s_cbranch_scc1 t2f_14202
  s_add_u32 s58, s62, 1
  v_mov_b32 v18, s58
  s_mov_b64 exec, 1
  buffer_store_dword v18, v17, s[48:51], 0 offen sc1
  s_mov_b64 exec, -1
t2f_14202:
  s_add_u32 s73, s73, 393216
  s_add_u32 s74, s74, 196608
  s_add_u32 s75, s75, 393216
  s_add_u32 s62, s62, 1
  s_cmp_lt_u32 s62, 64
  s_cbranch_scc1 L_t2_i
  s_waitcnt vmcnt(0)
  s_endpgm
L_t3role_i:
  s_sub_u32 s62, s54, 24
  v_mov_b32 v18, v0
  v_mul_u32_u24 v19, 6554, v18
  v_lshrrev_b32 v19, 16, v19
  v_mul_u32_u24 v20, 10, v19
  v_sub_u32 v18, v18, v20
  v_mul_u32_u24 v19, 1280, v19
  v_lshlrev_b32 v18, 4, v18
  v_add_u32 v2, v18, v19
  v_add_u32 v18, 256, v0
  v_mul_u32_u24 v19, 6554, v18
  v_lshrrev_b32 v19, 16, v19
  v_mul_u32_u24 v20, 10, v19
  v_sub_u32 v18, v18, v20
  v_mul_u32_u24 v19, 1280, v19
  v_lshlrev_b32 v18, 4, v18
  v_add_u32 v3, v18, v19
  v_add_u32 v18, 512, v0
  v_mul_u32_u24 v19, 6554, v18
  v_lshrrev_b32 v19, 16, v19
  v_mul_u32_u24 v20, 10, v19
  v_sub_u32 v18, v18, v20
  v_mul_u32_u24 v19, 1280, v19
  v_lshlrev_b32 v18, 4, v18
  v_add_u32 v4, v18, v19
  v_add_u32 v18, 768, v0
  v_mul_u32_u24 v19, 6554, v18
  v_lshrrev_b32 v19, 16, v19
  v_mul_u32_u24 v20, 10, v19
  v_sub_u32 v18, v18, v20
  v_mul_u32_u24 v19, 1280, v19
  v_lshlrev_b32 v18, 4, v18
  v_add_u32 v5, v18, v19
  v_add_u32 v18, 1024, v0
  v_mul_u32_u24 v19, 6554, v18
  v_lshrrev_b32 v19, 16, v19
  v_mul_u32_u24 v20, 10, v19
  v_sub_u32 v18, v18, v20
  v_mul_u32_u24 v19, 1280, v19
  v_lshlrev_b32 v18, 4, v18
  v_add_u32 v6, v18, v19
  v_add_u32 v18, 1280, v0
  v_mul_u32_u24 v19, 6554, v18
  v_lshrrev_b32 v19, 16, v19
  v_mul_u32_u24 v20, 10, v19
  v_sub_u32 v18, v18, v20
  v_mul_u32_u24 v19, 1280, v19
  v_lshlrev_b32 v18, 4, v18
  v_add_u32 v7, v18, v19
  v_add_u32 v18, 1536, v0
  v_mul_u32_u24 v19, 6554, v18
  v_lshrrev_b32 v19, 16, v19
  v_mul_u32_u24 v20, 10, v19
  v_sub_u32 v18, v18, v20
  v_mul_u32_u24 v19, 1280, v19
  v_lshlrev_b32 v18, 4, v18
  v_add_u32 v8, v18, v19
  v_add_u32 v18, 1792, v0
  v_mul_u32_u24 v19, 6554, v18
  v_lshrrev_b32 v19, 16, v19
  v_mul_u32_u24 v20, 10, v19
  v_sub_u32 v18, v18, v20
  v_mul_u32_u24 v19, 1280, v19
  v_lshlrev_b32 v18, 4, v18
  v_add_u32 v9, v18, v19
  v_add_u32 v18, 2048, v0
  v_mul_u32_u24 v19, 6554, v18
  v_lshrrev_b32 v19, 16, v19
  v_mul_u32_u24 v20, 10, v19
  v_sub_u32 v18, v18, v20
  v_mul_u32_u24 v19, 1280, v19
  v_lshlrev_b32 v18, 4, v18
  v_add_u32 v10, v18, v19
  v_add_u32 v18, 2304, v0
  v_mul_u32_u24 v19, 6554, v18
  v_lshrrev_b32 v19, 16, v19
  v_mul_u32_u24 v20, 10, v19
  v_sub_u32 v18, v18, v20
  v_mul_u32_u24 v19, 1280, v19
  v_lshlrev_b32 v18, 4, v18
  v_add_u32 v11, v18, v19
  v_add_u32 v18, 2560, v0
  v_mul_u32_u24 v19, 6554, v18
  v_lshrrev_b32 v19, 16, v19
  v_mul_u32_u24 v20, 10, v19
  v_sub_u32 v18, v18, v20
  v_mul_u32_u24 v19, 1280, v19
  v_lshlrev_b32 v18, 4, v18
  v_add_u32 v12, v18, v19
  v_add_u32 v18, 2816, v0
  v_mul_u32_u24 v19, 6554, v18
  v_lshrrev_b32 v19, 16, v19
  v_mul_u32_u24 v20, 10, v19
  v_sub_u32 v18, v18, v20
  v_mul_u32_u24 v19, 1280, v19
  v_lshlrev_b32 v18, 4, v18
  v_add_u32 v13, v18, v19
  v_add_u32 v18, 3072, v0
  v_mul_u32_u24 v19, 6554, v18
  v_lshrrev_b32 v19, 16, v19
  v_mul_u32_u24 v20, 10, v19
  v_sub_u32 v18, v18, v20
  v_mul_u32_u24 v19, 1280, v19
  v_lshlrev_b32 v18, 4, v18
  v_add_u32 v14, v18, v19
  v_add_u32 v18, 3328, v0
  v_mul_u32_u24 v19, 6554, v18
  v_lshrrev_b32 v19, 16, v19
  v_mul_u32_u24 v20, 10, v19
  v_sub_u32 v18, v18, v20
  v_mul_u32_u24 v19, 1280, v19
  v_lshlrev_b32 v18, 4, v18
  v_add_u32 v15, v18, v19
  v_add_u32 v18, 3584, v0
  v_mul_u32_u24 v19, 6554, v18
  v_lshrrev_b32 v19, 16, v19
  v_mul_u32_u24 v20, 10, v19
  v_sub_u32 v18, v18, v20
  v_mul_u32_u24 v19, 1280, v19
  v_lshlrev_b32 v18, 4, v18
  v_add_u32 v16, v18, v19
  s_mul_i32 s63, s53, 1966080
  s_mul_i32 s58, s62, 160
  s_add_u32 s63, s63, s58
  s_lshl_b32 s60, s52, 10
  s_add_u32 s60, s60, 0x0
  s_add_u32 m0, s60, 0
  s_nop 0
  buffer_load_dwordx4 v2, s[24:27], s63 offen lds
  s_add_u32 m0, s60, 4096
  s_nop 0
  buffer_load_dwordx4 v3, s[24:27], s63 offen lds
  s_add_u32 m0, s60, 8192
  s_nop 0
  buffer_load_dwordx4 v4, s[24:27], s63 offen lds
  s_add_u32 m0, s60, 12288
  s_nop 0
  buffer_load_dwordx4 v5, s[24:27], s63 offen lds
  s_add_u32 m0, s60, 16384
  s_nop 0
  buffer_load_dwordx4 v6, s[24:27], s63 offen lds
  s_add_u32 m0, s60, 20480
  s_nop 0
  buffer_load_dwordx4 v7, s[24:27], s63 offen lds
  s_add_u32 m0, s60, 24576
  s_nop 0
  buffer_load_dwordx4 v8, s[24:27], s63 offen lds
  s_add_u32 m0, s60, 28672
  s_nop 0
  buffer_load_dwordx4 v9, s[24:27], s63 offen lds
  s_add_u32 m0, s60, 32768
  s_nop 0
  buffer_load_dwordx4 v10, s[24:27], s63 offen lds
  s_add_u32 m0, s60, 36864
  s_nop 0
  buffer_load_dwordx4 v11, s[24:27], s63 offen lds
  s_add_u32 m0, s60, 40960
  s_nop 0
  buffer_load_dwordx4 v12, s[24:27], s63 offen lds
  s_add_u32 m0, s60, 45056
  s_nop 0
  buffer_load_dwordx4 v13, s[24:27], s63 offen lds
  s_add_u32 m0, s60, 49152
  s_nop 0
  buffer_load_dwordx4 v14, s[24:27], s63 offen lds
  s_add_u32 m0, s60, 53248
  s_nop 0
  buffer_load_dwordx4 v15, s[24:27], s63 offen lds
  s_add_u32 m0, s60, 57344
  s_nop 0
  buffer_load_dwordx4 v16, s[24:27], s63 offen lds
  s_add_u32 s63, s63, 491520
  s_lshl_b32 s60, s52, 10
  s_add_u32 s60, s60, 0xf000
  s_add_u32 m0, s60, 0
  s_nop 0
  buffer_load_dwordx4 v2, s[24:27], s63 offen lds
  s_add_u32 m0, s60, 4096
  s_nop 0
  buffer_load_dwordx4 v3, s[24:27], s63 offen lds
  s_add_u32 m0, s60, 8192
  s_nop 0
  buffer_load_dwordx4 v4, s[24:27], s63 offen lds
  s_add_u32 m0, s60, 12288
  s_nop 0
  buffer_load_dwordx4 v5, s[24:27], s63 offen lds
  s_add_u32 m0, s60, 16384
  s_nop 0
  buffer_load_dwordx4 v6, s[24:27], s63 offen lds
  s_add_u32 m0, s60, 20480
  s_nop 0
  buffer_load_dwordx4 v7, s[24:27], s63 offen lds
  s_add_u32 m0, s60, 24576
  s_nop 0
  buffer_load_dwordx4 v8, s[24:27], s63 offen lds
  s_add_u32 m0, s60, 28672
  s_nop 0
  buffer_load_dwordx4 v9, s[24:27], s63 offen lds
  s_add_u32 m0, s60, 32768
  s_nop 0
  buffer_load_dwordx4 v10, s[24:27], s63 offen lds
  s_add_u32 m0, s60, 36864
  s_nop 0
  buffer_load_dwordx4 v11, s[24:27], s63 offen lds
  s_add_u32 m0, s60, 40960
  s_nop 0
  buffer_load_dwordx4 v12, s[24:27], s63 offen lds
  s_add_u32 m0, s60, 45056
  s_nop 0
  buffer_load_dwordx4 v13, s[24:27], s63 offen lds
  s_add_u32 m0, s60, 49152
  s_nop 0
  buffer_load_dwordx4 v14, s[24:27], s63 offen lds
  s_add_u32 m0, s60, 53248
  s_nop 0
  buffer_load_dwordx4 v15, s[24:27], s63 offen lds
  s_add_u32 m0, s60, 57344
  s_nop 0
  buffer_load_dwordx4 v16, s[24:27], s63 offen lds
  v_and_b32 v1, 63, v0
  v_lshrrev_b32 v18, 2, v1
  v_mul_u32_u24 v18, 160, v18
  v_and_b32 v19, 3, v1
  v_lshlrev_b32 v19, 3, v19
  v_add_u32 v22, v18, v19
  s_waitcnt vmcnt(15)
  s_barrier
  s_cmp_lg_u32 s52, 0
  s_cbranch_scc1 t3w_14203
  ds_read_b64_tr_b16 a[0:1], v22 offset:0
  ds_read_b64_tr_b16 a[2:3], v22 offset:2560
  ds_read_b64_tr_b16 a[4:5], v22 offset:32
  ds_read_b64_tr_b16 a[6:7], v22 offset:2592
  ds_read_b64_tr_b16 a[8:9], v22 offset:64
  ds_read_b64_tr_b16 a[10:11], v22 offset:2624
  ds_read_b64_tr_b16 a[12:13], v22 offset:96
  ds_read_b64_tr_b16 a[14:15], v22 offset:2656
  s_waitcnt lgkmcnt(6)
  ds_read_b64_tr_b16 a[16:17], v22 offset:128
  ds_read_b64_tr_b16 a[18:19], v22 offset:2688
  ds_read_b64_tr_b16 a[20:21], v22 offset:5120
  ds_read_b64_tr_b16 a[22:23], v22 offset:7680
  ds_read_b64_tr_b16 a[24:25], v22 offset:5152
  ds_read_b64_tr_b16 a[26:27], v22 offset:7712
  ds_read_b64_tr_b16 a[28:29], v22 offset:5184
  ds_read_b64_tr_b16 a[30:31], v22 offset:7744
  s_waitcnt lgkmcnt(6)
  ds_read_b64_tr_b16 a[32:33], v22 offset:5216
  ds_read_b64_tr_b16 a[34:35], v22 offset:7776
  ds_read_b64_tr_b16 a[36:37], v22 offset:5248
  ds_read_b64_tr_b16 a[38:39], v22 offset:7808
  ds_read_b64_tr_b16 a[40:41], v22 offset:10240
  ds_read_b64_tr_b16 a[42:43], v22 offset:12800
  ds_read_b64_tr_b16 a[44:45], v22 offset:10272
  ds_read_b64_tr_b16 a[46:47], v22 offset:12832
  s_waitcnt lgkmcnt(6)
  ds_read_b64_tr_b16 a[48:49], v22 offset:10304
  ds_read_b64_tr_b16 a[50:51], v22 offset:12864
  ds_read_b64_tr_b16 a[52:53], v22 offset:10336
  ds_read_b64_tr_b16 a[54:55], v22 offset:12896
  ds_read_b64_tr_b16 a[56:57], v22 offset:10368
  ds_read_b64_tr_b16 a[58:59], v22 offset:12928
  ds_read_b64_tr_b16 a[60:61], v22 offset:15360
  ds_read_b64_tr_b16 a[62:63], v22 offset:17920
  s_waitcnt lgkmcnt(6)
  ds_read_b64_tr_b16 a[64:65], v22 offset:15392
  ds_read_b64_tr_b16 a[66:67], v22 offset:17952
  ds_read_b64_tr_b16 a[68:69], v22 offset:15424
  ds_read_b64_tr_b16 a[70:71], v22 offset:17984
  ds_read_b64_tr_b16 a[72:73], v22 offset:15456
  ds_read_b64_tr_b16 a[74:75], v22 offset:18016
  ds_read_b64_tr_b16 a[76:77], v22 offset:15488
  ds_read_b64_tr_b16 a[78:79], v22 offset:18048
  s_waitcnt lgkmcnt(6)
  ds_read_b64_tr_b16 a[80:81], v22 offset:20480
  ds_read_b64_tr_b16 a[82:83], v22 offset:23040
  ds_read_b64_tr_b16 a[84:85], v22 offset:20512
  ds_read_b64_tr_b16 a[86:87], v22 offset:23072
  ds_read_b64_tr_b16 a[88:89], v22 offset:20544
  ds_read_b64_tr_b16 a[90:91], v22 offset:23104
  ds_read_b64_tr_b16 a[92:93], v22 offset:20576
  ds_read_b64_tr_b16 a[94:95], v22 offset:23136
  s_waitcnt lgkmcnt(6)
  ds_read_b64_tr_b16 a[96:97], v22 offset:20608
  ds_read_b64_tr_b16 a[98:99], v22 offset:23168
  ds_read_b64_tr_b16 a[100:101], v22 offset:25600
  ds_read_b64_tr_b16 a[102:103], v22 offset:28160
  ds_read_b64_tr_b16 a[104:105], v22 offset:25632
  ds_read_b64_tr_b16 a[106:107], v22 offset:28192
  ds_read_b64_tr_b16 a[108:109], v22 offset:25664
  ds_read_b64_tr_b16 a[110:111], v22 offset:28224
  s_waitcnt lgkmcnt(6)
  ds_read_b64_tr_b16 a[112:113], v22 offset:25696
  ds_read_b64_tr_b16 a[114:115], v22 offset:28256
  ds_read_b64_tr_b16 a[116:117], v22 offset:25728
  ds_read_b64_tr_b16 a[118:119], v22 offset:28288
  ds_read_b64_tr_b16 a[120:121], v22 offset:30720
  ds_read_b64_tr_b16 a[122:123], v22 offset:33280
  ds_read_b64_tr_b16 a[124:125], v22 offset:30752
  ds_read_b64_tr_b16 a[126:127], v22 offset:33312
  s_waitcnt lgkmcnt(6)
  ds_read_b64_tr_b16 a[128:129], v22 offset:30784
  ds_read_b64_tr_b16 a[130:131], v22 offset:33344
  ds_read_b64_tr_b16 a[132:133], v22 offset:30816
  ds_read_b64_tr_b16 a[134:135], v22 offset:33376
  ds_read_b64_tr_b16 a[136:137], v22 offset:30848
  ds_read_b64_tr_b16 a[138:139], v22 offset:33408
  ds_read_b64_tr_b16 a[140:141], v22 offset:35840
  ds_read_b64_tr_b16 a[142:143], v22 offset:38400
  s_waitcnt lgkmcnt(6)
  ds_read_b64_tr_b16 a[144:145], v22 offset:35872
  ds_read_b64_tr_b16 a[146:147], v22 offset:38432
  ds_read_b64_tr_b16 a[148:149], v22 offset:35904
  ds_read_b64_tr_b16 a[150:151], v22 offset:38464
  ds_read_b64_tr_b16 a[152:153], v22 offset:35936
  ds_read_b64_tr_b16 a[154:155], v22 offset:38496
  ds_read_b64_tr_b16 a[156:157], v22 offset:35968
  ds_read_b64_tr_b16 a[158:159], v22 offset:38528
  s_waitcnt lgkmcnt(6)
  ds_read_b64_tr_b16 a[160:161], v22 offset:40960
  ds_read_b64_tr_b16 a[162:163], v22 offset:43520
  ds_read_b64_tr_b16 a[164:165], v22 offset:40992
  ds_read_b64_tr_b16 a[166:167], v22 offset:43552
  ds_read_b64_tr_b16 a[168:169], v22 offset:41024
  ds_read_b64_tr_b16 a[170:171], v22 offset:43584
  ds_read_b64_tr_b16 a[172:173], v22 offset:41056
  ds_read_b64_tr_b16 a[174:175], v22 offset:43616
  s_waitcnt lgkmcnt(6)
  ds_read_b64_tr_b16 a[176:177], v22 offset:41088
  ds_read_b64_tr_b16 a[178:179], v22 offset:43648
  ds_read_b64_tr_b16 a[180:181], v22 offset:46080
  ds_read_b64_tr_b16 a[182:183], v22 offset:48640
  ds_read_b64_tr_b16 a[184:185], v22 offset:46112
  ds_read_b64_tr_b16 a[186:187], v22 offset:48672
  ds_read_b64_tr_b16 a[188:189], v22 offset:46144
  ds_read_b64_tr_b16 a[190:191], v22 offset:48704
  s_waitcnt lgkmcnt(6)
  ds_read_b64_tr_b16 a[192:193], v22 offset:46176
  ds_read_b64_tr_b16 a[194:195], v22 offset:48736
  ds_read_b64_tr_b16 a[196:197], v22 offset:46208
  ds_read_b64_tr_b16 a[198:199], v22 offset:48768
  ds_read_b64_tr_b16 a[200:201], v22 offset:51200
  ds_read_b64_tr_b16 a[202:203], v22 offset:53760
  ds_read_b64_tr_b16 a[204:205], v22 offset:51232
  ds_read_b64_tr_b16 a[206:207], v22 offset:53792
  s_waitcnt lgkmcnt(6)
  ds_read_b64_tr_b16 a[208:209], v22 offset:51264
  ds_read_b64_tr_b16 a[210:211], v22 offset:53824
  ds_read_b64_tr_b16 a[212:213], v22 offset:51296
  ds_read_b64_tr_b16 a[214:215], v22 offset:53856
  ds_read_b64_tr_b16 a[216:217], v22 offset:51328
  ds_read_b64_tr_b16 a[218:219], v22 offset:53888
  ds_read_b64_tr_b16 a[220:221], v22 offset:56320
  ds_read_b64_tr_b16 a[222:223], v22 offset:58880
  s_waitcnt lgkmcnt(6)
  ds_read_b64_tr_b16 a[224:225], v22 offset:56352
  ds_read_b64_tr_b16 a[226:227], v22 offset:58912
  ds_read_b64_tr_b16 a[228:229], v22 offset:56384
  ds_read_b64_tr_b16 a[230:231], v22 offset:58944
  ds_read_b64_tr_b16 a[232:233], v22 offset:56416
  ds_read_b64_tr_b16 a[234:235], v22 offset:58976
  ds_read_b64_tr_b16 a[236:237], v22 offset:56448
  ds_read_b64_tr_b16 a[238:239], v22 offset:59008
  s_waitcnt lgkmcnt(6)
  s_waitcnt lgkmcnt(0)
t3w_14203:
  s_barrier
  s_add_u32 s63, s63, 491520
  s_lshl_b32 s60, s52, 10
  s_add_u32 s60, s60, 0x0
  s_add_u32 m0, s60, 0
  s_nop 0
  buffer_load_dwordx4 v2, s[24:27], s63 offen lds
  s_add_u32 m0, s60, 4096
  s_nop 0
  buffer_load_dwordx4 v3, s[24:27], s63 offen lds
  s_add_u32 m0, s60, 8192
  s_nop 0
  buffer_load_dwordx4 v4, s[24:27], s63 offen lds
  s_add_u32 m0, s60, 12288
  s_nop 0
  buffer_load_dwordx4 v5, s[24:27], s63 offen lds
  s_add_u32 m0, s60, 16384
  s_nop 0
  buffer_load_dwordx4 v6, s[24:27], s63 offen lds
  s_add_u32 m0, s60, 20480
  s_nop 0
  buffer_load_dwordx4 v7, s[24:27], s63 offen lds
  s_add_u32 m0, s60, 24576
  s_nop 0
  buffer_load_dwordx4 v8, s[24:27], s63 offen lds
  s_add_u32 m0, s60, 28672
  s_nop 0
  buffer_load_dwordx4 v9, s[24:27], s63 offen lds
  s_add_u32 m0, s60, 32768
  s_nop 0
  buffer_load_dwordx4 v10, s[24:27], s63 offen lds
  s_add_u32 m0, s60, 36864
  s_nop 0
  buffer_load_dwordx4 v11, s[24:27], s63 offen lds
  s_add_u32 m0, s60, 40960
  s_nop 0
  buffer_load_dwordx4 v12, s[24:27], s63 offen lds
  s_add_u32 m0, s60, 45056
  s_nop 0
  buffer_load_dwordx4 v13, s[24:27], s63 offen lds
  s_add_u32 m0, s60, 49152
  s_nop 0
  buffer_load_dwordx4 v14, s[24:27], s63 offen lds
  s_add_u32 m0, s60, 53248
  s_nop 0
  buffer_load_dwordx4 v15, s[24:27], s63 offen lds
  s_add_u32 m0, s60, 57344
  s_nop 0
  buffer_load_dwordx4 v16, s[24:27], s63 offen lds
  s_waitcnt vmcnt(15)
  s_barrier
  s_cmp_lg_u32 s52, 1
  s_cbranch_scc1 t3w_14204
  v_add_u32 v22, 61440, v22
  ds_read_b64_tr_b16 a[0:1], v22 offset:0
  ds_read_b64_tr_b16 a[2:3], v22 offset:2560
  ds_read_b64_tr_b16 a[4:5], v22 offset:32
  ds_read_b64_tr_b16 a[6:7], v22 offset:2592
  ds_read_b64_tr_b16 a[8:9], v22 offset:64
  ds_read_b64_tr_b16 a[10:11], v22 offset:2624
  ds_read_b64_tr_b16 a[12:13], v22 offset:96
  ds_read_b64_tr_b16 a[14:15], v22 offset:2656
  s_waitcnt lgkmcnt(6)
  ds_read_b64_tr_b16 a[16:17], v22 offset:128
  ds_read_b64_tr_b16 a[18:19], v22 offset:2688
  ds_read_b64_tr_b16 a[20:21], v22 offset:5120
  ds_read_b64_tr_b16 a[22:23], v22 offset:7680
  ds_read_b64_tr_b16 a[24:25], v22 offset:5152
  ds_read_b64_tr_b16 a[26:27], v22 offset:7712
  ds_read_b64_tr_b16 a[28:29], v22 offset:5184
  ds_read_b64_tr_b16 a[30:31], v22 offset:7744
  s_waitcnt lgkmcnt(6)
  ds_read_b64_tr_b16 a[32:33], v22 offset:5216
  ds_read_b64_tr_b16 a[34:35], v22 offset:7776
  ds_read_b64_tr_b16 a[36:37], v22 offset:5248
  ds_read_b64_tr_b16 a[38:39], v22 offset:7808
  ds_read_b64_tr_b16 a[40:41], v22 offset:10240
  ds_read_b64_tr_b16 a[42:43], v22 offset:12800
  ds_read_b64_tr_b16 a[44:45], v22 offset:10272
  ds_read_b64_tr_b16 a[46:47], v22 offset:12832
  s_waitcnt lgkmcnt(6)
  ds_read_b64_tr_b16 a[48:49], v22 offset:10304
  ds_read_b64_tr_b16 a[50:51], v22 offset:12864
  ds_read_b64_tr_b16 a[52:53], v22 offset:10336
  ds_read_b64_tr_b16 a[54:55], v22 offset:12896
  ds_read_b64_tr_b16 a[56:57], v22 offset:10368
  ds_read_b64_tr_b16 a[58:59], v22 offset:12928
  ds_read_b64_tr_b16 a[60:61], v22 offset:15360
  ds_read_b64_tr_b16 a[62:63], v22 offset:17920
  s_waitcnt lgkmcnt(6)
  ds_read_b64_tr_b16 a[64:65], v22 offset:15392
  ds_read_b64_tr_b16 a[66:67], v22 offset:17952
  ds_read_b64_tr_b16 a[68:69], v22 offset:15424
  ds_read_b64_tr_b16 a[70:71], v22 offset:17984
  ds_read_b64_tr_b16 a[72:73], v22 offset:15456
  ds_read_b64_tr_b16 a[74:75], v22 offset:18016
  ds_read_b64_tr_b16 a[76:77], v22 offset:15488
  ds_read_b64_tr_b16 a[78:79], v22 offset:18048
  s_waitcnt lgkmcnt(6)
  ds_read_b64_tr_b16 a[80:81], v22 offset:20480
  ds_read_b64_tr_b16 a[82:83], v22 offset:23040
  ds_read_b64_tr_b16 a[84:85], v22 offset:20512
  ds_read_b64_tr_b16 a[86:87], v22 offset:23072
  ds_read_b64_tr_b16 a[88:89], v22 offset:20544
  ds_read_b64_tr_b16 a[90:91], v22 offset:23104
  ds_read_b64_tr_b16 a[92:93], v22 offset:20576
  ds_read_b64_tr_b16 a[94:95], v22 offset:23136
  s_waitcnt lgkmcnt(6)
  ds_read_b64_tr_b16 a[96:97], v22 offset:20608
  ds_read_b64_tr_b16 a[98:99], v22 offset:23168
  ds_read_b64_tr_b16 a[100:101], v22 offset:25600
  ds_read_b64_tr_b16 a[102:103], v22 offset:28160
  ds_read_b64_tr_b16 a[104:105], v22 offset:25632
  ds_read_b64_tr_b16 a[106:107], v22 offset:28192
  ds_read_b64_tr_b16 a[108:109], v22 offset:25664
  ds_read_b64_tr_b16 a[110:111], v22 offset:28224
  s_waitcnt lgkmcnt(6)
  ds_read_b64_tr_b16 a[112:113], v22 offset:25696
  ds_read_b64_tr_b16 a[114:115], v22 offset:28256
  ds_read_b64_tr_b16 a[116:117], v22 offset:25728
  ds_read_b64_tr_b16 a[118:119], v22 offset:28288
  ds_read_b64_tr_b16 a[120:121], v22 offset:30720
  ds_read_b64_tr_b16 a[122:123], v22 offset:33280
  ds_read_b64_tr_b16 a[124:125], v22 offset:30752
  ds_read_b64_tr_b16 a[126:127], v22 offset:33312
  s_waitcnt lgkmcnt(6)
  ds_read_b64_tr_b16 a[128:129], v22 offset:30784
  ds_read_b64_tr_b16 a[130:131], v22 offset:33344
  ds_read_b64_tr_b16 a[132:133], v22 offset:30816
  ds_read_b64_tr_b16 a[134:135], v22 offset:33376
  ds_read_b64_tr_b16 a[136:137], v22 offset:30848
  ds_read_b64_tr_b16 a[138:139], v22 offset:33408
  ds_read_b64_tr_b16 a[140:141], v22 offset:35840
  ds_read_b64_tr_b16 a[142:143], v22 offset:38400
  s_waitcnt lgkmcnt(6)
  ds_read_b64_tr_b16 a[144:145], v22 offset:35872
  ds_read_b64_tr_b16 a[146:147], v22 offset:38432
  ds_read_b64_tr_b16 a[148:149], v22 offset:35904
  ds_read_b64_tr_b16 a[150:151], v22 offset:38464
  ds_read_b64_tr_b16 a[152:153], v22 offset:35936
  ds_read_b64_tr_b16 a[154:155], v22 offset:38496
  ds_read_b64_tr_b16 a[156:157], v22 offset:35968
  ds_read_b64_tr_b16 a[158:159], v22 offset:38528
  s_waitcnt lgkmcnt(6)
  ds_read_b64_tr_b16 a[160:161], v22 offset:40960
  ds_read_b64_tr_b16 a[162:163], v22 offset:43520
  ds_read_b64_tr_b16 a[164:165], v22 offset:40992
  ds_read_b64_tr_b16 a[166:167], v22 offset:43552
  ds_read_b64_tr_b16 a[168:169], v22 offset:41024
  ds_read_b64_tr_b16 a[170:171], v22 offset:43584
  ds_read_b64_tr_b16 a[172:173], v22 offset:41056
  ds_read_b64_tr_b16 a[174:175], v22 offset:43616
  s_waitcnt lgkmcnt(6)
  ds_read_b64_tr_b16 a[176:177], v22 offset:41088
  ds_read_b64_tr_b16 a[178:179], v22 offset:43648
  ds_read_b64_tr_b16 a[180:181], v22 offset:46080
  ds_read_b64_tr_b16 a[182:183], v22 offset:48640
  ds_read_b64_tr_b16 a[184:185], v22 offset:46112
  ds_read_b64_tr_b16 a[186:187], v22 offset:48672
  ds_read_b64_tr_b16 a[188:189], v22 offset:46144
  ds_read_b64_tr_b16 a[190:191], v22 offset:48704
  s_waitcnt lgkmcnt(6)
  ds_read_b64_tr_b16 a[192:193], v22 offset:46176
  ds_read_b64_tr_b16 a[194:195], v22 offset:48736
  ds_read_b64_tr_b16 a[196:197], v22 offset:46208
  ds_read_b64_tr_b16 a[198:199], v22 offset:48768
  ds_read_b64_tr_b16 a[200:201], v22 offset:51200
  ds_read_b64_tr_b16 a[202:203], v22 offset:53760
  ds_read_b64_tr_b16 a[204:205], v22 offset:51232
  ds_read_b64_tr_b16 a[206:207], v22 offset:53792
  s_waitcnt lgkmcnt(6)
  ds_read_b64_tr_b16 a[208:209], v22 offset:51264
  ds_read_b64_tr_b16 a[210:211], v22 offset:53824
  ds_read_b64_tr_b16 a[212:213], v22 offset:51296
  ds_read_b64_tr_b16 a[214:215], v22 offset:53856
  ds_read_b64_tr_b16 a[216:217], v22 offset:51328
  ds_read_b64_tr_b16 a[218:219], v22 offset:53888
  ds_read_b64_tr_b16 a[220:221], v22 offset:56320
  ds_read_b64_tr_b16 a[222:223], v22 offset:58880
  s_waitcnt lgkmcnt(6)
  ds_read_b64_tr_b16 a[224:225], v22 offset:56352
  ds_read_b64_tr_b16 a[226:227], v22 offset:58912
  ds_read_b64_tr_b16 a[228:229], v22 offset:56384
  ds_read_b64_tr_b16 a[230:231], v22 offset:58944
  ds_read_b64_tr_b16 a[232:233], v22 offset:56416
  ds_read_b64_tr_b16 a[234:235], v22 offset:58976
  ds_read_b64_tr_b16 a[236:237], v22 offset:56448
  ds_read_b64_tr_b16 a[238:239], v22 offset:59008
  s_waitcnt lgkmcnt(6)
  s_waitcnt lgkmcnt(0)
t3w_14204:
  s_barrier
  s_add_u32 s63, s63, 491520
  s_lshl_b32 s60, s52, 10
  s_add_u32 s60, s60, 0xf000
  s_add_u32 m0, s60, 0
  s_nop 0
  buffer_load_dwordx4 v2, s[24:27], s63 offen lds
  s_add_u32 m0, s60, 4096
  s_nop 0
  buffer_load_dwordx4 v3, s[24:27], s63 offen lds
  s_add_u32 m0, s60, 8192
  s_nop 0
  buffer_load_dwordx4 v4, s[24:27], s63 offen lds
  s_add_u32 m0, s60, 12288
  s_nop 0
  buffer_load_dwordx4 v5, s[24:27], s63 offen lds
  s_add_u32 m0, s60, 16384
  s_nop 0
  buffer_load_dwordx4 v6, s[24:27], s63 offen lds
  s_add_u32 m0, s60, 20480
  s_nop 0
  buffer_load_dwordx4 v7, s[24:27], s63 offen lds
  s_add_u32 m0, s60, 24576
  s_nop 0
  buffer_load_dwordx4 v8, s[24:27], s63 offen lds
  s_add_u32 m0, s60, 28672
  s_nop 0
  buffer_load_dwordx4 v9, s[24:27], s63 offen lds
  s_add_u32 m0, s60, 32768
  s_nop 0
  buffer_load_dwordx4 v10, s[24:27], s63 offen lds
  s_add_u32 m0, s60, 36864
  s_nop 0
  buffer_load_dwordx4 v11, s[24:27], s63 offen lds
  s_add_u32 m0, s60, 40960
  s_nop 0
  buffer_load_dwordx4 v12, s[24:27], s63 offen lds
  s_add_u32 m0, s60, 45056
  s_nop 0
  buffer_load_dwordx4 v13, s[24:27], s63 offen lds
  s_add_u32 m0, s60, 49152
  s_nop 0
  buffer_load_dwordx4 v14, s[24:27], s63 offen lds
  s_add_u32 m0, s60, 53248
  s_nop 0
  buffer_load_dwordx4 v15, s[24:27], s63 offen lds
  s_add_u32 m0, s60, 57344
  s_nop 0
  buffer_load_dwordx4 v16, s[24:27], s63 offen lds
  s_waitcnt vmcnt(15)
  s_barrier
  s_cmp_lg_u32 s52, 2
  s_cbranch_scc1 t3w_14205
  ds_read_b64_tr_b16 a[0:1], v22 offset:0
  ds_read_b64_tr_b16 a[2:3], v22 offset:2560
  ds_read_b64_tr_b16 a[4:5], v22 offset:32
  ds_read_b64_tr_b16 a[6:7], v22 offset:2592
  ds_read_b64_tr_b16 a[8:9], v22 offset:64
  ds_read_b64_tr_b16 a[10:11], v22 offset:2624
  ds_read_b64_tr_b16 a[12:13], v22 offset:96
  ds_read_b64_tr_b16 a[14:15], v22 offset:2656
  s_waitcnt lgkmcnt(6)
  ds_read_b64_tr_b16 a[16:17], v22 offset:128
  ds_read_b64_tr_b16 a[18:19], v22 offset:2688
  ds_read_b64_tr_b16 a[20:21], v22 offset:5120
  ds_read_b64_tr_b16 a[22:23], v22 offset:7680
  ds_read_b64_tr_b16 a[24:25], v22 offset:5152
  ds_read_b64_tr_b16 a[26:27], v22 offset:7712
  ds_read_b64_tr_b16 a[28:29], v22 offset:5184
  ds_read_b64_tr_b16 a[30:31], v22 offset:7744
  s_waitcnt lgkmcnt(6)
  ds_read_b64_tr_b16 a[32:33], v22 offset:5216
  ds_read_b64_tr_b16 a[34:35], v22 offset:7776
  ds_read_b64_tr_b16 a[36:37], v22 offset:5248
  ds_read_b64_tr_b16 a[38:39], v22 offset:7808
  ds_read_b64_tr_b16 a[40:41], v22 offset:10240
  ds_read_b64_tr_b16 a[42:43], v22 offset:12800
  ds_read_b64_tr_b16 a[44:45], v22 offset:10272
  ds_read_b64_tr_b16 a[46:47], v22 offset:12832
  s_waitcnt lgkmcnt(6)
  ds_read_b64_tr_b16 a[48:49], v22 offset:10304
  ds_read_b64_tr_b16 a[50:51], v22 offset:12864
  ds_read_b64_tr_b16 a[52:53], v22 offset:10336
  ds_read_b64_tr_b16 a[54:55], v22 offset:12896
  ds_read_b64_tr_b16 a[56:57], v22 offset:10368
  ds_read_b64_tr_b16 a[58:59], v22 offset:12928
  ds_read_b64_tr_b16 a[60:61], v22 offset:15360
  ds_read_b64_tr_b16 a[62:63], v22 offset:17920
  s_waitcnt lgkmcnt(6)
  ds_read_b64_tr_b16 a[64:65], v22 offset:15392
  ds_read_b64_tr_b16 a[66:67], v22 offset:17952
  ds_read_b64_tr_b16 a[68:69], v22 offset:15424
  ds_read_b64_tr_b16 a[70:71], v22 offset:17984
  ds_read_b64_tr_b16 a[72:73], v22 offset:15456
  ds_read_b64_tr_b16 a[74:75], v22 offset:18016
  ds_read_b64_tr_b16 a[76:77], v22 offset:15488
  ds_read_b64_tr_b16 a[78:79], v22 offset:18048
  s_waitcnt lgkmcnt(6)
  ds_read_b64_tr_b16 a[80:81], v22 offset:20480
  ds_read_b64_tr_b16 a[82:83], v22 offset:23040
  ds_read_b64_tr_b16 a[84:85], v22 offset:20512
  ds_read_b64_tr_b16 a[86:87], v22 offset:23072
  ds_read_b64_tr_b16 a[88:89], v22 offset:20544
  ds_read_b64_tr_b16 a[90:91], v22 offset:23104
  ds_read_b64_tr_b16 a[92:93], v22 offset:20576
  ds_read_b64_tr_b16 a[94:95], v22 offset:23136
  s_waitcnt lgkmcnt(6)
  ds_read_b64_tr_b16 a[96:97], v22 offset:20608
  ds_read_b64_tr_b16 a[98:99], v22 offset:23168
  ds_read_b64_tr_b16 a[100:101], v22 offset:25600
  ds_read_b64_tr_b16 a[102:103], v22 offset:28160
  ds_read_b64_tr_b16 a[104:105], v22 offset:25632
  ds_read_b64_tr_b16 a[106:107], v22 offset:28192
  ds_read_b64_tr_b16 a[108:109], v22 offset:25664
  ds_read_b64_tr_b16 a[110:111], v22 offset:28224
  s_waitcnt lgkmcnt(6)
  ds_read_b64_tr_b16 a[112:113], v22 offset:25696
  ds_read_b64_tr_b16 a[114:115], v22 offset:28256
  ds_read_b64_tr_b16 a[116:117], v22 offset:25728
  ds_read_b64_tr_b16 a[118:119], v22 offset:28288
  ds_read_b64_tr_b16 a[120:121], v22 offset:30720
  ds_read_b64_tr_b16 a[122:123], v22 offset:33280
  ds_read_b64_tr_b16 a[124:125], v22 offset:30752
  ds_read_b64_tr_b16 a[126:127], v22 offset:33312
  s_waitcnt lgkmcnt(6)
  ds_read_b64_tr_b16 a[128:129], v22 offset:30784
  ds_read_b64_tr_b16 a[130:131], v22 offset:33344
  ds_read_b64_tr_b16 a[132:133], v22 offset:30816
  ds_read_b64_tr_b16 a[134:135], v22 offset:33376
  ds_read_b64_tr_b16 a[136:137], v22 offset:30848
  ds_read_b64_tr_b16 a[138:139], v22 offset:33408
  ds_read_b64_tr_b16 a[140:141], v22 offset:35840
  ds_read_b64_tr_b16 a[142:143], v22 offset:38400
  s_waitcnt lgkmcnt(6)
  ds_read_b64_tr_b16 a[144:145], v22 offset:35872
  ds_read_b64_tr_b16 a[146:147], v22 offset:38432
  ds_read_b64_tr_b16 a[148:149], v22 offset:35904
  ds_read_b64_tr_b16 a[150:151], v22 offset:38464
  ds_read_b64_tr_b16 a[152:153], v22 offset:35936
  ds_read_b64_tr_b16 a[154:155], v22 offset:38496
  ds_read_b64_tr_b16 a[156:157], v22 offset:35968
  ds_read_b64_tr_b16 a[158:159], v22 offset:38528
  s_waitcnt lgkmcnt(6)
  ds_read_b64_tr_b16 a[160:161], v22 offset:40960
  ds_read_b64_tr_b16 a[162:163], v22 offset:43520
  ds_read_b64_tr_b16 a[164:165], v22 offset:40992
  ds_read_b64_tr_b16 a[166:167], v22 offset:43552
  ds_read_b64_tr_b16 a[168:169], v22 offset:41024
  ds_read_b64_tr_b16 a[170:171], v22 offset:43584
  ds_read_b64_tr_b16 a[172:173], v22 offset:41056
  ds_read_b64_tr_b16 a[174:175], v22 offset:43616
  s_waitcnt lgkmcnt(6)
  ds_read_b64_tr_b16 a[176:177], v22 offset:41088
  ds_read_b64_tr_b16 a[178:179], v22 offset:43648
  ds_read_b64_tr_b16 a[180:181], v22 offset:46080
  ds_read_b64_tr_b16 a[182:183], v22 offset:48640
  ds_read_b64_tr_b16 a[184:185], v22 offset:46112
  ds_read_b64_tr_b16 a[186:187], v22 offset:48672
  ds_read_b64_tr_b16 a[188:189], v22 offset:46144
  ds_read_b64_tr_b16 a[190:191], v22 offset:48704
  s_waitcnt lgkmcnt(6)
  ds_read_b64_tr_b16 a[192:193], v22 offset:46176
  ds_read_b64_tr_b16 a[194:195], v22 offset:48736
  ds_read_b64_tr_b16 a[196:197], v22 offset:46208
  ds_read_b64_tr_b16 a[198:199], v22 offset:48768
  ds_read_b64_tr_b16 a[200:201], v22 offset:51200
  ds_read_b64_tr_b16 a[202:203], v22 offset:53760
  ds_read_b64_tr_b16 a[204:205], v22 offset:51232
  ds_read_b64_tr_b16 a[206:207], v22 offset:53792
  s_waitcnt lgkmcnt(6)
  ds_read_b64_tr_b16 a[208:209], v22 offset:51264
  ds_read_b64_tr_b16 a[210:211], v22 offset:53824
  ds_read_b64_tr_b16 a[212:213], v22 offset:51296
  ds_read_b64_tr_b16 a[214:215], v22 offset:53856
  ds_read_b64_tr_b16 a[216:217], v22 offset:51328
  ds_read_b64_tr_b16 a[218:219], v22 offset:53888
  ds_read_b64_tr_b16 a[220:221], v22 offset:56320
  ds_read_b64_tr_b16 a[222:223], v22 offset:58880
  s_waitcnt lgkmcnt(6)
  ds_read_b64_tr_b16 a[224:225], v22 offset:56352
  ds_read_b64_tr_b16 a[226:227], v22 offset:58912
  ds_read_b64_tr_b16 a[228:229], v22 offset:56384
  ds_read_b64_tr_b16 a[230:231], v22 offset:58944
  ds_read_b64_tr_b16 a[232:233], v22 offset:56416
  ds_read_b64_tr_b16 a[234:235], v22 offset:58976
  ds_read_b64_tr_b16 a[236:237], v22 offset:56448
  ds_read_b64_tr_b16 a[238:239], v22 offset:59008
  s_waitcnt lgkmcnt(6)
  s_waitcnt lgkmcnt(0)
t3w_14205:
  s_barrier
  s_waitcnt vmcnt(0)
  s_barrier
  s_cmp_lg_u32 s52, 3
  s_cbranch_scc1 t3w_14206
  v_add_u32 v22, 61440, v22
  ds_read_b64_tr_b16 a[0:1], v22 offset:0
  ds_read_b64_tr_b16 a[2:3], v22 offset:2560
  ds_read_b64_tr_b16 a[4:5], v22 offset:32
  ds_read_b64_tr_b16 a[6:7], v22 offset:2592
  ds_read_b64_tr_b16 a[8:9], v22 offset:64
  ds_read_b64_tr_b16 a[10:11], v22 offset:2624
  ds_read_b64_tr_b16 a[12:13], v22 offset:96
  ds_read_b64_tr_b16 a[14:15], v22 offset:2656
  s_waitcnt lgkmcnt(6)
  ds_read_b64_tr_b16 a[16:17], v22 offset:128
  ds_read_b64_tr_b16 a[18:19], v22 offset:2688
  ds_read_b64_tr_b16 a[20:21], v22 offset:5120
  ds_read_b64_tr_b16 a[22:23], v22 offset:7680
  ds_read_b64_tr_b16 a[24:25], v22 offset:5152
  ds_read_b64_tr_b16 a[26:27], v22 offset:7712
  ds_read_b64_tr_b16 a[28:29], v22 offset:5184
  ds_read_b64_tr_b16 a[30:31], v22 offset:7744
  s_waitcnt lgkmcnt(6)
  ds_read_b64_tr_b16 a[32:33], v22 offset:5216
  ds_read_b64_tr_b16 a[34:35], v22 offset:7776
  ds_read_b64_tr_b16 a[36:37], v22 offset:5248
  ds_read_b64_tr_b16 a[38:39], v22 offset:7808
  ds_read_b64_tr_b16 a[40:41], v22 offset:10240
  ds_read_b64_tr_b16 a[42:43], v22 offset:12800
  ds_read_b64_tr_b16 a[44:45], v22 offset:10272
  ds_read_b64_tr_b16 a[46:47], v22 offset:12832
  s_waitcnt lgkmcnt(6)
  ds_read_b64_tr_b16 a[48:49], v22 offset:10304
  ds_read_b64_tr_b16 a[50:51], v22 offset:12864
  ds_read_b64_tr_b16 a[52:53], v22 offset:10336
  ds_read_b64_tr_b16 a[54:55], v22 offset:12896
  ds_read_b64_tr_b16 a[56:57], v22 offset:10368
  ds_read_b64_tr_b16 a[58:59], v22 offset:12928
  ds_read_b64_tr_b16 a[60:61], v22 offset:15360
  ds_read_b64_tr_b16 a[62:63], v22 offset:17920
  s_waitcnt lgkmcnt(6)
  ds_read_b64_tr_b16 a[64:65], v22 offset:15392
  ds_read_b64_tr_b16 a[66:67], v22 offset:17952
  ds_read_b64_tr_b16 a[68:69], v22 offset:15424
  ds_read_b64_tr_b16 a[70:71], v22 offset:17984
  ds_read_b64_tr_b16 a[72:73], v22 offset:15456
  ds_read_b64_tr_b16 a[74:75], v22 offset:18016
  ds_read_b64_tr_b16 a[76:77], v22 offset:15488
  ds_read_b64_tr_b16 a[78:79], v22 offset:18048
  s_waitcnt lgkmcnt(6)
  ds_read_b64_tr_b16 a[80:81], v22 offset:20480
  ds_read_b64_tr_b16 a[82:83], v22 offset:23040
  ds_read_b64_tr_b16 a[84:85], v22 offset:20512
  ds_read_b64_tr_b16 a[86:87], v22 offset:23072
  ds_read_b64_tr_b16 a[88:89], v22 offset:20544
  ds_read_b64_tr_b16 a[90:91], v22 offset:23104
  ds_read_b64_tr_b16 a[92:93], v22 offset:20576
  ds_read_b64_tr_b16 a[94:95], v22 offset:23136
  s_waitcnt lgkmcnt(6)
  ds_read_b64_tr_b16 a[96:97], v22 offset:20608
  ds_read_b64_tr_b16 a[98:99], v22 offset:23168
  ds_read_b64_tr_b16 a[100:101], v22 offset:25600
  ds_read_b64_tr_b16 a[102:103], v22 offset:28160
  ds_read_b64_tr_b16 a[104:105], v22 offset:25632
  ds_read_b64_tr_b16 a[106:107], v22 offset:28192
  ds_read_b64_tr_b16 a[108:109], v22 offset:25664
  ds_read_b64_tr_b16 a[110:111], v22 offset:28224
  s_waitcnt lgkmcnt(6)
  ds_read_b64_tr_b16 a[112:113], v22 offset:25696
  ds_read_b64_tr_b16 a[114:115], v22 offset:28256
  ds_read_b64_tr_b16 a[116:117], v22 offset:25728
  ds_read_b64_tr_b16 a[118:119], v22 offset:28288
  ds_read_b64_tr_b16 a[120:121], v22 offset:30720
  ds_read_b64_tr_b16 a[122:123], v22 offset:33280
  ds_read_b64_tr_b16 a[124:125], v22 offset:30752
  ds_read_b64_tr_b16 a[126:127], v22 offset:33312
  s_waitcnt lgkmcnt(6)
  ds_read_b64_tr_b16 a[128:129], v22 offset:30784
  ds_read_b64_tr_b16 a[130:131], v22 offset:33344
  ds_read_b64_tr_b16 a[132:133], v22 offset:30816
  ds_read_b64_tr_b16 a[134:135], v22 offset:33376
  ds_read_b64_tr_b16 a[136:137], v22 offset:30848
  ds_read_b64_tr_b16 a[138:139], v22 offset:33408
  ds_read_b64_tr_b16 a[140:141], v22 offset:35840
  ds_read_b64_tr_b16 a[142:143], v22 offset:38400
  s_waitcnt lgkmcnt(6)
  ds_read_b64_tr_b16 a[144:145], v22 offset:35872
  ds_read_b64_tr_b16 a[146:147], v22 offset:38432
  ds_read_b64_tr_b16 a[148:149], v22 offset:35904
  ds_read_b64_tr_b16 a[150:151], v22 offset:38464
  ds_read_b64_tr_b16 a[152:153], v22 offset:35936
  ds_read_b64_tr_b16 a[154:155], v22 offset:38496
  ds_read_b64_tr_b16 a[156:157], v22 offset:35968
  ds_read_b64_tr_b16 a[158:159], v22 offset:38528
  s_waitcnt lgkmcnt(6)
  ds_read_b64_tr_b16 a[160:161], v22 offset:40960
  ds_read_b64_tr_b16 a[162:163], v22 offset:43520
  ds_read_b64_tr_b16 a[164:165], v22 offset:40992
  ds_read_b64_tr_b16 a[166:167], v22 offset:43552
  ds_read_b64_tr_b16 a[168:169], v22 offset:41024
  ds_read_b64_tr_b16 a[170:171], v22 offset:43584
  ds_read_b64_tr_b16 a[172:173], v22 offset:41056
  ds_read_b64_tr_b16 a[174:175], v22 offset:43616
  s_waitcnt lgkmcnt(6)
  ds_read_b64_tr_b16 a[176:177], v22 offset:41088
  ds_read_b64_tr_b16 a[178:179], v22 offset:43648
  ds_read_b64_tr_b16 a[180:181], v22 offset:46080
  ds_read_b64_tr_b16 a[182:183], v22 offset:48640
  ds_read_b64_tr_b16 a[184:185], v22 offset:46112
  ds_read_b64_tr_b16 a[186:187], v22 offset:48672
  ds_read_b64_tr_b16 a[188:189], v22 offset:46144
  ds_read_b64_tr_b16 a[190:191], v22 offset:48704
  s_waitcnt lgkmcnt(6)
  ds_read_b64_tr_b16 a[192:193], v22 offset:46176
  ds_read_b64_tr_b16 a[194:195], v22 offset:48736
  ds_read_b64_tr_b16 a[196:197], v22 offset:46208
  ds_read_b64_tr_b16 a[198:199], v22 offset:48768
  ds_read_b64_tr_b16 a[200:201], v22 offset:51200
  ds_read_b64_tr_b16 a[202:203], v22 offset:53760
  ds_read_b64_tr_b16 a[204:205], v22 offset:51232
  ds_read_b64_tr_b16 a[206:207], v22 offset:53792
  s_waitcnt lgkmcnt(6)
  ds_read_b64_tr_b16 a[208:209], v22 offset:51264
  ds_read_b64_tr_b16 a[210:211], v22 offset:53824
  ds_read_b64_tr_b16 a[212:213], v22 offset:51296
  ds_read_b64_tr_b16 a[214:215], v22 offset:53856
  ds_read_b64_tr_b16 a[216:217], v22 offset:51328
  ds_read_b64_tr_b16 a[218:219], v22 offset:53888
  ds_read_b64_tr_b16 a[220:221], v22 offset:56320
  ds_read_b64_tr_b16 a[222:223], v22 offset:58880
  s_waitcnt lgkmcnt(6)
  ds_read_b64_tr_b16 a[224:225], v22 offset:56352
  ds_read_b64_tr_b16 a[226:227], v22 offset:58912
  ds_read_b64_tr_b16 a[228:229], v22 offset:56384
  ds_read_b64_tr_b16 a[230:231], v22 offset:58944
  ds_read_b64_tr_b16 a[232:233], v22 offset:56416
  ds_read_b64_tr_b16 a[234:235], v22 offset:58976
  ds_read_b64_tr_b16 a[236:237], v22 offset:56448
  ds_read_b64_tr_b16 a[238:239], v22 offset:59008
  s_waitcnt lgkmcnt(6)
  s_waitcnt lgkmcnt(0)
t3w_14206:
  s_barrier
  v_lshlrev_b32 v23, 4, v1
  s_lshl_b32 s58, s53, 10
  s_add_u32 s58, s58, 24576
  v_and_b32 v18, 7, v1
  v_lshlrev_b32 v18, 7, v18
  v_add_u32 v24, s58, v18
  s_lshl_b32 s58, s62, 7
  s_add_u32 s58, s58, 28672
  v_and_b32 v18, 3, v1
  v_lshlrev_b32 v18, 10, v18
  v_bfe_u32 v19, v1, 2, 2
  v_lshlrev_b32 v19, 5, v19
  v_add_u32 v18, v18, v19
  v_add_u32 v25, s58, v18
  s_lshl_b32 s59, s53, 10
  s_add_u32 s58, s58, s59
  s_lshl_b32 s59, s52, 5
  s_add_u32 s58, s58, s59
  v_mov_b32 v26, s58
  s_mul_i32 s58, s52, 10240
  v_add_u32 v27, s58, v23
  s_lshl_b32 s58, s52, 10
  v_add_u32 v28, s58, v23
  s_and_b32 s58, s52, 1
  s_mul_i32 s58, s58, 40960
  s_lshr_b32 s59, s52, 1
  s_lshl_b32 s59, s59, 6
  s_add_u32 s58, s58, s59
  s_mul_i32 s59, s62, 320
  s_add_u32 s58, s58, s59
  v_and_b32 v18, 15, v1
  v_mul_u32_u24 v18, 2560, v18
  v_lshrrev_b32 v19, 4, v1
  v_lshlrev_b32 v19, 4, v19
  v_add_u32 v18, v18, v19
  v_add_u32 v29, s58, v18
  v_mov_b32 v18, v0
  v_mul_u32_u24 v19, 3277, v18
  v_lshrrev_b32 v19, 16, v19
  v_mul_u32_u24 v20, 20, v19
  v_sub_u32 v18, v18, v20
  s_mul_i32 s58, s62, 320
  v_mul_u32_u24 v20, 2560, v19
  v_lshlrev_b32 v21, 4, v18
  v_add_u32 v20, v20, v21
  v_add_u32 v184, s58, v20
  v_mul_u32_u24 v20, 2560, v19
  v_lshlrev_b32 v21, 3, v18
  s_mul_i32 s58, s62, 160
  v_add_u32 v20, v20, v21
  v_add_u32 v187, s58, v20
  v_add_u32 v18, 256, v0
  v_mul_u32_u24 v19, 3277, v18
  v_lshrrev_b32 v19, 16, v19
  v_mul_u32_u24 v20, 20, v19
  v_sub_u32 v18, v18, v20
  s_mul_i32 s58, s62, 320
  v_mul_u32_u24 v20, 2560, v19
  v_lshlrev_b32 v21, 4, v18
  v_add_u32 v20, v20, v21
  v_add_u32 v185, s58, v20
  v_mul_u32_u24 v20, 2560, v19
  v_lshlrev_b32 v21, 3, v18
  s_mul_i32 s58, s62, 160
  v_add_u32 v20, v20, v21
  v_add_u32 v188, s58, v20
  v_add_u32 v18, 512, v0
  v_mul_u32_u24 v19, 3277, v18
  v_lshrrev_b32 v19, 16, v19
  v_mul_u32_u24 v20, 20, v19
  v_sub_u32 v18, v18, v20
  s_mul_i32 s58, s62, 320
  v_mul_u32_u24 v20, 2560, v19
  v_lshlrev_b32 v21, 4, v18
  v_add_u32 v20, v20, v21
  v_add_u32 v186, s58, v20
  v_mul_u32_u24 v20, 2560, v19
  v_lshlrev_b32 v21, 3, v18
  s_mul_i32 s58, s62, 160
  v_add_u32 v20, v20, v21
  v_add_u32 v189, s58, v20
  s_mul_i32 s64, s53, 98304
  s_mul_i32 s58, s52, 24576
  s_add_u32 s64, s64, s58
  s_add_u32 s64, s64, 0x4a00000
  s_mul_i32 s65, s53, 81920
  s_add_u32 s65, s65, 0x6200000
  s_mov_b32 s68, 0
  s_mov_b32 s72, 0
  s_mov_b32 s66, 0
  s_mov_b32 s69, 0
  s_mov_b32 s71, 0
L_t3_i:
  s_cmp_eq_u32 s69, 1
  s_cbranch_scc1 t3h_14207
  s_add_u32 s60, s68, 1
  s_cmp_ge_u32 s72, s60
  s_cbranch_scc1 t3wd_14209
  s_mov_b32 s56, 0
t3w_14208:
  buffer_load_dword v18, v24, s[48:51], 0 offen sc1
  s_waitcnt vmcnt(0)
  s_nop 1
  v_min_u32_dpp v18, v18, v18 row_ror:4 row_mask:0xf bank_mask:0xf
  s_nop 1
  v_min_u32_dpp v18, v18, v18 row_ror:2 row_mask:0xf bank_mask:0xf
  s_nop 1
  v_min_u32_dpp v18, v18, v18 row_ror:1 row_mask:0xf bank_mask:0xf
  s_nop 0
  v_readlane_b32 s72, v18, 0
  s_cmp_ge_u32 s72, s60
  s_cbranch_scc1 t3wd_14209
  s_cmp_lg_u32 s55, 0
  s_cbranch_scc1 t3wd_14209
  s_add_u32 s56, s56, 1
  s_cmp_lt_u32 s56, 0x20000
  s_cbranch_scc1 t3w_14208
  s_mov_b32 s55, 1
t3wd_14209:
  s_add_u32 s58, s64, 0
  buffer_load_dwordx4 v[32:35], v23, s[48:51], s58 offen offset:0 sc1
  buffer_load_dwordx4 v[36:39], v23, s[48:51], s58 offen offset:1024 sc1
  buffer_load_dwordx4 v[40:43], v23, s[48:51], s58 offen offset:2048 sc1
  buffer_load_dwordx4 v[44:47], v23, s[48:51], s58 offen offset:3072 sc1
  s_add_u32 s58, s64, 4096
  buffer_load_dwordx4 v[48:51], v23, s[48:51], s58 offen offset:0 sc1
  buffer_load_dwordx4 v[52:55], v23, s[48:51], s58 offen offset:1024 sc1
  buffer_load_dwordx4 v[56:59], v23, s[48:51], s58 offen offset:2048 sc1
  buffer_load_dwordx4 v[60:63], v23, s[48:51], s58 offen offset:3072 sc1
  s_add_u32 s58, s64, 8192
  buffer_load_dwordx4 v[64:67], v23, s[48:51], s58 offen offset:0 sc1
  buffer_load_dwordx4 v[68:71], v23, s[48:51], s58 offen offset:1024 sc1
  buffer_load_dwordx4 v[72:75], v23, s[48:51], s58 offen offset:2048 sc1
  buffer_load_dwordx4 v[76:79], v23, s[48:51], s58 offen offset:3072 sc1
  s_add_u32 s58, s64, 12288
  buffer_load_dwordx4 v[80:83], v23, s[48:51], s58 offen offset:0 sc1
  buffer_load_dwordx4 v[84:87], v23, s[48:51], s58 offen offset:1024 sc1
  buffer_load_dwordx4 v[88:91], v23, s[48:51], s58 offen offset:2048 sc1
  buffer_load_dwordx4 v[92:95], v23, s[48:51], s58 offen offset:3072 sc1
  s_add_u32 s58, s64, 16384
  buffer_load_dwordx4 v[96:99], v23, s[48:51], s58 offen offset:0 sc1
  buffer_load_dwordx4 v[100:103], v23, s[48:51], s58 offen offset:1024 sc1
  buffer_load_dwordx4 v[104:107], v23, s[48:51], s58 offen offset:2048 sc1
  buffer_load_dwordx4 v[108:111], v23, s[48:51], s58 offen offset:3072 sc1
  s_add_u32 s58, s64, 20480
  buffer_load_dwordx4 v[112:115], v23, s[48:51], s58 offen offset:0 sc1
  buffer_load_dwordx4 v[116:119], v23, s[48:51], s58 offen offset:1024 sc1
  buffer_load_dwordx4 v[120:123], v23, s[48:51], s58 offen offset:2048 sc1
  buffer_load_dwordx4 v[124:127], v23, s[48:51], s58 offen offset:3072 sc1
t3h_14207:
  s_mov_b32 s74, 0
  s_sub_u32 s67, s68, 2
  s_and_b32 s58, s67, 3
  s_cmp_lt_u32 s68, 2
  s_cbranch_scc1 t3fe_14210
  s_cmp_lg_u32 s58, s53
  s_cbranch_scc1 t3fe_14210
  s_cmp_ge_u32 s68, 62
  s_cbranch_scc1 t3fe_14210
  s_cmp_gt_u32 s66, s67
  s_cbranch_scc0 t3fe_14210
  s_mul_i32 s60, s67, 327680
  s_add_u32 s60, s60, 0x6200000
  s_add_u32 s58, s60, 0
  buffer_load_dwordx4 v[192:195], v184, s[48:51], s58 offen sc1
  s_add_u32 s58, s60, 81920
  buffer_load_dwordx4 v[196:199], v184, s[48:51], s58 offen sc1
  s_add_u32 s58, s60, 163840
  buffer_load_dwordx4 v[200:203], v184, s[48:51], s58 offen sc1
  s_add_u32 s58, s60, 245760
  buffer_load_dwordx4 v[204:207], v184, s[48:51], s58 offen sc1
t3k_14211:
  s_add_u32 s58, s60, 0
  buffer_load_dwordx4 v[208:211], v185, s[48:51], s58 offen sc1
  s_add_u32 s58, s60, 81920
  buffer_load_dwordx4 v[212:215], v185, s[48:51], s58 offen sc1
  s_add_u32 s58, s60, 163840
  buffer_load_dwordx4 v[216:219], v185, s[48:51], s58 offen sc1
  s_add_u32 s58, s60, 245760
  buffer_load_dwordx4 v[220:223], v185, s[48:51], s58 offen sc1
t3k_14212:
  s_cmp_ge_u32 s52, 2
  s_cbranch_scc1 t3k_14213
  s_add_u32 s58, s60, 0
  buffer_load_dwordx4 v[224:227], v186, s[48:51], s58 offen sc1
  s_add_u32 s58, s60, 81920
  buffer_load_dwordx4 v[228:231], v186, s[48:51], s58 offen sc1
  s_add_u32 s58, s60, 163840
  buffer_load_dwordx4 v[232:235], v186, s[48:51], s58 offen sc1
  s_add_u32 s58, s60, 245760
  buffer_load_dwordx4 v[236:239], v186, s[48:51], s58 offen sc1
t3k_14213:
  s_mov_b32 s74, 1
t3fe_14210:
  s_add_u32 s73, s64, 393216
  s_add_u32 s60, s68, 2
  s_mov_b32 s70, 0
  s_cmp_ge_u32 s72, s60
  s_cbranch_scc0 t3b_14214
  s_mov_b32 s70, 1
  s_waitcnt vmcnt(22)
  v_mfma_f32_16x16x32_bf16 v[128:131], a[0:3], v[32:35], 0
  v_mfma_f32_16x16x32_bf16 v[132:135], a[0:3], v[36:39], 0
  v_mfma_f32_16x16x32_bf16 v[136:139], a[4:7], v[32:35], 0
  v_mfma_f32_16x16x32_bf16 v[140:143], a[4:7], v[36:39], 0
  v_mfma_f32_16x16x32_bf16 v[144:147], a[8:11], v[32:35], 0
  v_mfma_f32_16x16x32_bf16 v[148:151], a[8:11], v[36:39], 0
  v_mfma_f32_16x16x32_bf16 v[152:155], a[12:15], v[32:35], 0
  v_mfma_f32_16x16x32_bf16 v[156:159], a[12:15], v[36:39], 0
  v_mfma_f32_16x16x32_bf16 v[160:163], a[16:19], v[32:35], 0
  v_mfma_f32_16x16x32_bf16 v[164:167], a[16:19], v[36:39], 0
  s_add_u32 s58, s73, 0
  buffer_load_dwordx4 v[32:35], v23, s[48:51], s58 offen offset:0 sc1
  buffer_load_dwordx4 v[36:39], v23, s[48:51], s58 offen offset:1024 sc1
  s_waitcnt vmcnt(22)
  v_mfma_f32_16x16x32_bf16 v[128:131], a[20:23], v[40:43], v[128:131]
  v_mfma_f32_16x16x32_bf16 v[132:135], a[20:23], v[44:47], v[132:135]
  v_mfma_f32_16x16x32_bf16 v[136:139], a[24:27], v[40:43], v[136:139]
  v_mfma_f32_16x16x32_bf16 v[140:143], a[24:27], v[44:47], v[140:143]
  v_mfma_f32_16x16x32_bf16 v[144:147], a[28:31], v[40:43], v[144:147]
  v_mfma_f32_16x16x32_bf16 v[148:151], a[28:31], v[44:47], v[148:151]
  v_mfma_f32_16x16x32_bf16 v[152:155], a[32:35], v[40:43], v[152:155]
  v_mfma_f32_16x16x32_bf16 v[156:159], a[32:35], v[44:47], v[156:159]
  v_mfma_f32_16x16x32_bf16 v[160:163], a[36:39], v[40:43], v[160:163]
  v_mfma_f32_16x16x32_bf16 v[164:167], a[36:39], v[44:47], v[164:167]
  buffer_load_dwordx4 v[40:43], v23, s[48:51], s58 offen offset:2048 sc1
  buffer_load_dwordx4 v[44:47], v23, s[48:51], s58 offen offset:3072 sc1
  s_waitcnt vmcnt(22)
  v_mfma_f32_16x16x32_bf16 v[128:131], a[40:43], v[48:51], v[128:131]
  v_mfma_f32_16x16x32_bf16 v[132:135], a[40:43], v[52:55], v[132:135]
  v_mfma_f32_16x16x32_bf16 v[136:139], a[44:47], v[48:51], v[136:139]
  v_mfma_f32_16x16x32_bf16 v[140:143], a[44:47], v[52:55], v[140:143]
  v_mfma_f32_16x16x32_bf16 v[144:147], a[48:51], v[48:51], v[144:147]
  v_mfma_f32_16x16x32_bf16 v[148:151], a[48:51], v[52:55], v[148:151]
  v_mfma_f32_16x16x32_bf16 v[152:155], a[52:55], v[48:51], v[152:155]
  v_mfma_f32_16x16x32_bf16 v[156:159], a[52:55], v[52:55], v[156:159]
  v_mfma_f32_16x16x32_bf16 v[160:163], a[56:59], v[48:51], v[160:163]
  v_mfma_f32_16x16x32_bf16 v[164:167], a[56:59], v[52:55], v[164:167]
  s_add_u32 s58, s73, 4096
  buffer_load_dwordx4 v[48:51], v23, s[48:51], s58 offen offset:0 sc1
  buffer_load_dwordx4 v[52:55], v23, s[48:51], s58 offen offset:1024 sc1
  s_waitcnt vmcnt(22)
  v_mfma_f32_16x16x32_bf16 v[128:131], a[60:63], v[56:59], v[128:131]
  v_mfma_f32_16x16x32_bf16 v[132:135], a[60:63], v[60:63], v[132:135]
  v_mfma_f32_16x16x32_bf16 v[136:139], a[64:67], v[56:59], v[136:139]
  v_mfma_f32_16x16x32_bf16 v[140:143], a[64:67], v[60:63], v[140:143]
  v_mfma_f32_16x16x32_bf16 v[144:147], a[68:71], v[56:59], v[144:147]
  v_mfma_f32_16x16x32_bf16 v[148:151], a[68:71], v[60:63], v[148:151]
  v_mfma_f32_16x16x32_bf16 v[152:155], a[72:75], v[56:59], v[152:155]
  v_mfma_f32_16x16x32_bf16 v[156:159], a[72:75], v[60:63], v[156:159]
  v_mfma_f32_16x16x32_bf16 v[160:163], a[76:79], v[56:59], v[160:163]
  v_mfma_f32_16x16x32_bf16 v[164:167], a[76:79], v[60:63], v[164:167]
  buffer_load_dwordx4 v[56:59], v23, s[48:51], s58 offen offset:2048 sc1
  buffer_load_dwordx4 v[60:63], v23, s[48:51], s58 offen offset:3072 sc1
  s_waitcnt vmcnt(22)
  v_mfma_f32_16x16x32_bf16 v[128:131], a[80:83], v[64:67], v[128:131]
  v_mfma_f32_16x16x32_bf16 v[132:135], a[80:83], v[68:71], v[132:135]
  v_mfma_f32_16x16x32_bf16 v[136:139], a[84:87], v[64:67], v[136:139]
  v_mfma_f32_16x16x32_bf16 v[140:143], a[84:87], v[68:71], v[140:143]
  v_mfma_f32_16x16x32_bf16 v[144:147], a[88:91], v[64:67], v[144:147]
  v_mfma_f32_16x16x32_bf16 v[148:151], a[88:91], v[68:71], v[148:151]
  v_mfma_f32_16x16x32_bf16 v[152:155], a[92:95], v[64:67], v[152:155]
  v_mfma_f32_16x16x32_bf16 v[156:159], a[92:95], v[68:71], v[156:159]
  v_mfma_f32_16x16x32_bf16 v[160:163], a[96:99], v[64:67], v[160:163]
  v_mfma_f32_16x16x32_bf16 v[164:167], a[96:99], v[68:71], v[164:167]
  s_add_u32 s58, s73, 8192
  buffer_load_dwordx4 v[64:67], v23, s[48:51], s58 offen offset:0 sc1
  buffer_load_dwordx4 v[68:71], v23, s[48:51], s58 offen offset:1024 sc1
  s_waitcnt vmcnt(22)
  v_mfma_f32_16x16x32_bf16 v[128:131], a[100:103], v[72:75], v[128:131]
  v_mfma_f32_16x16x32_bf16 v[132:135], a[100:103], v[76:79], v[132:135]
  v_mfma_f32_16x16x32_bf16 v[136:139], a[104:107], v[72:75], v[136:139]
  v_mfma_f32_16x16x32_bf16 v[140:143], a[104:107], v[76:79], v[140:143]
  v_mfma_f32_16x16x32_bf16 v[144:147], a[108:111], v[72:75], v[144:147]
  v_mfma_f32_16x16x32_bf16 v[148:151], a[108:111], v[76:79], v[148:151]
  v_mfma_f32_16x16x32_bf16 v[152:155], a[112:115], v[72:75], v[152:155]
  v_mfma_f32_16x16x32_bf16 v[156:159], a[112:115], v[76:79], v[156:159]
  v_mfma_f32_16x16x32_bf16 v[160:163], a[116:119], v[72:75], v[160:163]
  v_mfma_f32_16x16x32_bf16 v[164:167], a[116:119], v[76:79], v[164:167]
  buffer_load_dwordx4 v[72:75], v23, s[48:51], s58 offen offset:2048 sc1
  buffer_load_dwordx4 v[76:79], v23, s[48:51], s58 offen offset:3072 sc1
  s_waitcnt vmcnt(22)
  v_mfma_f32_16x16x32_bf16 v[128:131], a[120:123], v[80:83], v[128:131]
  v_mfma_f32_16x16x32_bf16 v[132:135], a[120:123], v[84:87], v[132:135]
  v_mfma_f32_16x16x32_bf16 v[136:139], a[124:127], v[80:83], v[136:139]
  v_mfma_f32_16x16x32_bf16 v[140:143], a[124:127], v[84:87], v[140:143]
  v_mfma_f32_16x16x32_bf16 v[144:147], a[128:131], v[80:83], v[144:147]
  v_mfma_f32_16x16x32_bf16 v[148:151], a[128:131], v[84:87], v[148:151]
  v_mfma_f32_16x16x32_bf16 v[152:155], a[132:135], v[80:83], v[152:155]
  v_mfma_f32_16x16x32_bf16 v[156:159], a[132:135], v[84:87], v[156:159]
  v_mfma_f32_16x16x32_bf16 v[160:163], a[136:139], v[80:83], v[160:163]
  v_mfma_f32_16x16x32_bf16 v[164:167], a[136:139], v[84:87], v[164:167]
  s_add_u32 s58, s73, 12288
  buffer_load_dwordx4 v[80:83], v23, s[48:51], s58 offen offset:0 sc1
  buffer_load_dwordx4 v[84:87], v23, s[48:51], s58 offen offset:1024 sc1
  s_waitcnt vmcnt(22)
  v_mfma_f32_16x16x32_bf16 v[128:131], a[140:143], v[88:91], v[128:131]
  v_mfma_f32_16x16x32_bf16 v[132:135], a[140:143], v[92:95], v[132:135]
  v_mfma_f32_16x16x32_bf16 v[136:139], a[144:147], v[88:91], v[136:139]
  v_mfma_f32_16x16x32_bf16 v[140:143], a[144:147], v[92:95], v[140:143]
  v_mfma_f32_16x16x32_bf16 v[144:147], a[148:151], v[88:91], v[144:147]
  v_mfma_f32_16x16x32_bf16 v[148:151], a[148:151], v[92:95], v[148:151]
  v_mfma_f32_16x16x32_bf16 v[152:155], a[152:155], v[88:91], v[152:155]
  v_mfma_f32_16x16x32_bf16 v[156:159], a[152:155], v[92:95], v[156:159]
  v_mfma_f32_16x16x32_bf16 v[160:163], a[156:159], v[88:91], v[160:163]
  v_mfma_f32_16x16x32_bf16 v[164:167], a[156:159], v[92:95], v[164:167]
  buffer_load_dwordx4 v[88:91], v23, s[48:51], s58 offen offset:2048 sc1
  buffer_load_dwordx4 v[92:95], v23, s[48:51], s58 offen offset:3072 sc1
  s_waitcnt vmcnt(22)
  v_mfma_f32_16x16x32_bf16 v[128:131], a[160:163], v[96:99], v[128:131]
  v_mfma_f32_16x16x32_bf16 v[132:135], a[160:163], v[100:103], v[132:135]
  v_mfma_f32_16x16x32_bf16 v[136:139], a[164:167], v[96:99], v[136:139]
  v_mfma_f32_16x16x32_bf16 v[140:143], a[164:167], v[100:103], v[140:143]
  v_mfma_f32_16x16x32_bf16 v[144:147], a[168:171], v[96:99], v[144:147]
  v_mfma_f32_16x16x32_bf16 v[148:151], a[168:171], v[100:103], v[148:151]
  v_mfma_f32_16x16x32_bf16 v[152:155], a[172:175], v[96:99], v[152:155]
  v_mfma_f32_16x16x32_bf16 v[156:159], a[172:175], v[100:103], v[156:159]
  v_mfma_f32_16x16x32_bf16 v[160:163], a[176:179], v[96:99], v[160:163]
  v_mfma_f32_16x16x32_bf16 v[164:167], a[176:179], v[100:103], v[164:167]
  s_add_u32 s58, s73, 16384
  buffer_load_dwordx4 v[96:99], v23, s[48:51], s58 offen offset:0 sc1
  buffer_load_dwordx4 v[100:103], v23, s[48:51], s58 offen offset:1024 sc1
  s_waitcnt vmcnt(22)
  v_mfma_f32_16x16x32_bf16 v[128:131], a[180:183], v[104:107], v[128:131]
  v_mfma_f32_16x16x32_bf16 v[132:135], a[180:183], v[108:111], v[132:135]
  v_mfma_f32_16x16x32_bf16 v[136:139], a[184:187], v[104:107], v[136:139]
  v_mfma_f32_16x16x32_bf16 v[140:143], a[184:187], v[108:111], v[140:143]
  v_mfma_f32_16x16x32_bf16 v[144:147], a[188:191], v[104:107], v[144:147]
  v_mfma_f32_16x16x32_bf16 v[148:151], a[188:191], v[108:111], v[148:151]
  v_mfma_f32_16x16x32_bf16 v[152:155], a[192:195], v[104:107], v[152:155]
  v_mfma_f32_16x16x32_bf16 v[156:159], a[192:195], v[108:111], v[156:159]
  v_mfma_f32_16x16x32_bf16 v[160:163], a[196:199], v[104:107], v[160:163]
  v_mfma_f32_16x16x32_bf16 v[164:167], a[196:199], v[108:111], v[164:167]
  buffer_load_dwordx4 v[104:107], v23, s[48:51], s58 offen offset:2048 sc1
  buffer_load_dwordx4 v[108:111], v23, s[48:51], s58 offen offset:3072 sc1
  s_waitcnt vmcnt(22)
  v_mfma_f32_16x16x32_bf16 v[128:131], a[200:203], v[112:115], v[128:131]
  v_mfma_f32_16x16x32_bf16 v[132:135], a[200:203], v[116:119], v[132:135]
  v_mfma_f32_16x16x32_bf16 v[136:139], a[204:207], v[112:115], v[136:139]
  v_mfma_f32_16x16x32_bf16 v[140:143], a[204:207], v[116:119], v[140:143]
  v_mfma_f32_16x16x32_bf16 v[144:147], a[208:211], v[112:115], v[144:147]
  v_mfma_f32_16x16x32_bf16 v[148:151], a[208:211], v[116:119], v[148:151]
  v_mfma_f32_16x16x32_bf16 v[152:155], a[212:215], v[112:115], v[152:155]
  v_mfma_f32_16x16x32_bf16 v[156:159], a[212:215], v[116:119], v[156:159]
  v_mfma_f32_16x16x32_bf16 v[160:163], a[216:219], v[112:115], v[160:163]
  v_mfma_f32_16x16x32_bf16 v[164:167], a[216:219], v[116:119], v[164:167]
  s_add_u32 s58, s73, 20480
  buffer_load_dwordx4 v[112:115], v23, s[48:51], s58 offen offset:0 sc1
  buffer_load_dwordx4 v[116:119], v23, s[48:51], s58 offen offset:1024 sc1
  s_waitcnt vmcnt(22)
  v_mfma_f32_16x16x32_bf16 v[128:131], a[220:223], v[120:123], v[128:131]
  v_mfma_f32_16x16x32_bf16 v[132:135], a[220:223], v[124:127], v[132:135]
  v_mfma_f32_16x16x32_bf16 v[136:139], a[224:227], v[120:123], v[136:139]
  v_mfma_f32_16x16x32_bf16 v[140:143], a[224:227], v[124:127], v[140:143]
  v_mfma_f32_16x16x32_bf16 v[144:147], a[228:231], v[120:123], v[144:147]
  v_mfma_f32_16x16x32_bf16 v[148:151], a[228:231], v[124:127], v[148:151]
  v_mfma_f32_16x16x32_bf16 v[152:155], a[232:235], v[120:123], v[152:155]
  v_mfma_f32_16x16x32_bf16 v[156:159], a[232:235], v[124:127], v[156:159]
  v_mfma_f32_16x16x32_bf16 v[160:163], a[236:239], v[120:123], v[160:163]
  v_mfma_f32_16x16x32_bf16 v[164:167], a[236:239], v[124:127], v[164:167]
  buffer_load_dwordx4 v[120:123], v23, s[48:51], s58 offen offset:2048 sc1
  buffer_load_dwordx4 v[124:127], v23, s[48:51], s58 offen offset:3072 sc1
  s_branch t3x_14215
t3b_14214:
  s_waitcnt vmcnt(22)
  v_mfma_f32_16x16x32_bf16 v[128:131], a[0:3], v[32:35], 0
  v_mfma_f32_16x16x32_bf16 v[132:135], a[0:3], v[36:39], 0
  v_mfma_f32_16x16x32_bf16 v[136:139], a[4:7], v[32:35], 0
  v_mfma_f32_16x16x32_bf16 v[140:143], a[4:7], v[36:39], 0
  v_mfma_f32_16x16x32_bf16 v[144:147], a[8:11], v[32:35], 0
  v_mfma_f32_16x16x32_bf16 v[148:151], a[8:11], v[36:39], 0
  v_mfma_f32_16x16x32_bf16 v[152:155], a[12:15], v[32:35], 0
  v_mfma_f32_16x16x32_bf16 v[156:159], a[12:15], v[36:39], 0
  v_mfma_f32_16x16x32_bf16 v[160:163], a[16:19], v[32:35], 0
  v_mfma_f32_16x16x32_bf16 v[164:167], a[16:19], v[36:39], 0
  s_waitcnt vmcnt(20)
  v_mfma_f32_16x16x32_bf16 v[128:131], a[20:23], v[40:43], v[128:131]
  v_mfma_f32_16x16x32_bf16 v[132:135], a[20:23], v[44:47], v[132:135]
  v_mfma_f32_16x16x32_bf16 v[136:139], a[24:27], v[40:43], v[136:139]
  v_mfma_f32_16x16x32_bf16 v[140:143], a[24:27], v[44:47], v[140:143]
  v_mfma_f32_16x16x32_bf16 v[144:147], a[28:31], v[40:43], v[144:147]
  v_mfma_f32_16x16x32_bf16 v[148:151], a[28:31], v[44:47], v[148:151]
  v_mfma_f32_16x16x32_bf16 v[152:155], a[32:35], v[40:43], v[152:155]
  v_mfma_f32_16x16x32_bf16 v[156:159], a[32:35], v[44:47], v[156:159]
  v_mfma_f32_16x16x32_bf16 v[160:163], a[36:39], v[40:43], v[160:163]
  v_mfma_f32_16x16x32_bf16 v[164:167], a[36:39], v[44:47], v[164:167]
  s_waitcnt vmcnt(18)
  v_mfma_f32_16x16x32_bf16 v[128:131], a[40:43], v[48:51], v[128:131]
  v_mfma_f32_16x16x32_bf16 v[132:135], a[40:43], v[52:55], v[132:135]
  v_mfma_f32_16x16x32_bf16 v[136:139], a[44:47], v[48:51], v[136:139]
  v_mfma_f32_16x16x32_bf16 v[140:143], a[44:47], v[52:55], v[140:143]
  v_mfma_f32_16x16x32_bf16 v[144:147], a[48:51], v[48:51], v[144:147]
  v_mfma_f32_16x16x32_bf16 v[148:151], a[48:51], v[52:55], v[148:151]
  v_mfma_f32_16x16x32_bf16 v[152:155], a[52:55], v[48:51], v[152:155]
  v_mfma_f32_16x16x32_bf16 v[156:159], a[52:55], v[52:55], v[156:159]
  v_mfma_f32_16x16x32_bf16 v[160:163], a[56:59], v[48:51], v[160:163]
  v_mfma_f32_16x16x32_bf16 v[164:167], a[56:59], v[52:55], v[164:167]
  s_waitcnt vmcnt(16)
  v_mfma_f32_16x16x32_bf16 v[128:131], a[60:63], v[56:59], v[128:131]
  v_mfma_f32_16x16x32_bf16 v[132:135], a[60:63], v[60:63], v[132:135]
  v_mfma_f32_16x16x32_bf16 v[136:139], a[64:67], v[56:59], v[136:139]
  v_mfma_f32_16x16x32_bf16 v[140:143], a[64:67], v[60:63], v[140:143]
  v_mfma_f32_16x16x32_bf16 v[144:147], a[68:71], v[56:59], v[144:147]
  v_mfma_f32_16x16x32_bf16 v[148:151], a[68:71], v[60:63], v[148:151]
  v_mfma_f32_16x16x32_bf16 v[152:155], a[72:75], v[56:59], v[152:155]
  v_mfma_f32_16x16x32_bf16 v[156:159], a[72:75], v[60:63], v[156:159]
  v_mfma_f32_16x16x32_bf16 v[160:163], a[76:79], v[56:59], v[160:163]
  v_mfma_f32_16x16x32_bf16 v[164:167], a[76:79], v[60:63], v[164:167]
  s_waitcnt vmcnt(14)
  v_mfma_f32_16x16x32_bf16 v[128:131], a[80:83], v[64:67], v[128:131]
  v_mfma_f32_16x16x32_bf16 v[132:135], a[80:83], v[68:71], v[132:135]
  v_mfma_f32_16x16x32_bf16 v[136:139], a[84:87], v[64:67], v[136:139]
  v_mfma_f32_16x16x32_bf16 v[140:143], a[84:87], v[68:71], v[140:143]
  v_mfma_f32_16x16x32_bf16 v[144:147], a[88:91], v[64:67], v[144:147]
  v_mfma_f32_16x16x32_bf16 v[148:151], a[88:91], v[68:71], v[148:151]
  v_mfma_f32_16x16x32_bf16 v[152:155], a[92:95], v[64:67], v[152:155]
  v_mfma_f32_16x16x32_bf16 v[156:159], a[92:95], v[68:71], v[156:159]
  v_mfma_f32_16x16x32_bf16 v[160:163], a[96:99], v[64:67], v[160:163]
  v_mfma_f32_16x16x32_bf16 v[164:167], a[96:99], v[68:71], v[164:167]
  s_waitcnt vmcnt(12)
  v_mfma_f32_16x16x32_bf16 v[128:131], a[100:103], v[72:75], v[128:131]
  v_mfma_f32_16x16x32_bf16 v[132:135], a[100:103], v[76:79], v[132:135]
  v_mfma_f32_16x16x32_bf16 v[136:139], a[104:107], v[72:75], v[136:139]
  v_mfma_f32_16x16x32_bf16 v[140:143], a[104:107], v[76:79], v[140:143]
  v_mfma_f32_16x16x32_bf16 v[144:147], a[108:111], v[72:75], v[144:147]
  v_mfma_f32_16x16x32_bf16 v[148:151], a[108:111], v[76:79], v[148:151]
  v_mfma_f32_16x16x32_bf16 v[152:155], a[112:115], v[72:75], v[152:155]
  v_mfma_f32_16x16x32_bf16 v[156:159], a[112:115], v[76:79], v[156:159]
  v_mfma_f32_16x16x32_bf16 v[160:163], a[116:119], v[72:75], v[160:163]
  v_mfma_f32_16x16x32_bf16 v[164:167], a[116:119], v[76:79], v[164:167]
  s_waitcnt vmcnt(10)
  v_mfma_f32_16x16x32_bf16 v[128:131], a[120:123], v[80:83], v[128:131]
  v_mfma_f32_16x16x32_bf16 v[132:135], a[120:123], v[84:87], v[132:135]
  v_mfma_f32_16x16x32_bf16 v[136:139], a[124:127], v[80:83], v[136:139]
  v_mfma_f32_16x16x32_bf16 v[140:143], a[124:127], v[84:87], v[140:143]
  v_mfma_f32_16x16x32_bf16 v[144:147], a[128:131], v[80:83], v[144:147]
  v_mfma_f32_16x16x32_bf16 v[148:151], a[128:131], v[84:87], v[148:151]
  v_mfma_f32_16x16x32_bf16 v[152:155], a[132:135], v[80:83], v[152:155]
  v_mfma_f32_16x16x32_bf16 v[156:159], a[132:135], v[84:87], v[156:159]
  v_mfma_f32_16x16x32_bf16 v[160:163], a[136:139], v[80:83], v[160:163]
  v_mfma_f32_16x16x32_bf16 v[164:167], a[136:139], v[84:87], v[164:167]
  s_waitcnt vmcnt(8)
  v_mfma_f32_16x16x32_bf16 v[128:131], a[140:143], v[88:91], v[128:131]
  v_mfma_f32_16x16x32_bf16 v[132:135], a[140:143], v[92:95], v[132:135]
  v_mfma_f32_16x16x32_bf16 v[136:139], a[144:147], v[88:91], v[136:139]
  v_mfma_f32_16x16x32_bf16 v[140:143], a[144:147], v[92:95], v[140:143]
  v_mfma_f32_16x16x32_bf16 v[144:147], a[148:151], v[88:91], v[144:147]
  v_mfma_f32_16x16x32_bf16 v[148:151], a[148:151], v[92:95], v[148:151]
  v_mfma_f32_16x16x32_bf16 v[152:155], a[152:155], v[88:91], v[152:155]
  v_mfma_f32_16x16x32_bf16 v[156:159], a[152:155], v[92:95], v[156:159]
  v_mfma_f32_16x16x32_bf16 v[160:163], a[156:159], v[88:91], v[160:163]
  v_mfma_f32_16x16x32_bf16 v[164:167], a[156:159], v[92:95], v[164:167]
  s_waitcnt vmcnt(6)
  v_mfma_f32_16x16x32_bf16 v[128:131], a[160:163], v[96:99], v[128:131]
  v_mfma_f32_16x16x32_bf16 v[132:135], a[160:163], v[100:103], v[132:135]
  v_mfma_f32_16x16x32_bf16 v[136:139], a[164:167], v[96:99], v[136:139]
  v_mfma_f32_16x16x32_bf16 v[140:143], a[164:167], v[100:103], v[140:143]
  v_mfma_f32_16x16x32_bf16 v[144:147], a[168:171], v[96:99], v[144:147]
  v_mfma_f32_16x16x32_bf16 v[148:151], a[168:171], v[100:103], v[148:151]
  v_mfma_f32_16x16x32_bf16 v[152:155], a[172:175], v[96:99], v[152:155]
  v_mfma_f32_16x16x32_bf16 v[156:159], a[172:175], v[100:103], v[156:159]
  v_mfma_f32_16x16x32_bf16 v[160:163], a[176:179], v[96:99], v[160:163]
  v_mfma_f32_16x16x32_bf16 v[164:167], a[176:179], v[100:103], v[164:167]
  s_waitcnt vmcnt(4)
  v_mfma_f32_16x16x32_bf16 v[128:131], a[180:183], v[104:107], v[128:131]
  v_mfma_f32_16x16x32_bf16 v[132:135], a[180:183], v[108:111], v[132:135]
  v_mfma_f32_16x16x32_bf16 v[136:139], a[184:187], v[104:107], v[136:139]
  v_mfma_f32_16x16x32_bf16 v[140:143], a[184:187], v[108:111], v[140:143]
  v_mfma_f32_16x16x32_bf16 v[144:147], a[188:191], v[104:107], v[144:147]
  v_mfma_f32_16x16x32_bf16 v[148:151], a[188:191], v[108:111], v[148:151]
  v_mfma_f32_16x16x32_bf16 v[152:155], a[192:195], v[104:107], v[152:155]
  v_mfma_f32_16x16x32_bf16 v[156:159], a[192:195], v[108:111], v[156:159]
  v_mfma_f32_16x16x32_bf16 v[160:163], a[196:199], v[104:107], v[160:163]
  v_mfma_f32_16x16x32_bf16 v[164:167], a[196:199], v[108:111], v[164:167]
  s_waitcnt vmcnt(2)
  v_mfma_f32_16x16x32_bf16 v[128:131], a[200:203], v[112:115], v[128:131]
  v_mfma_f32_16x16x32_bf16 v[132:135], a[200:203], v[116:119], v[132:135]
  v_mfma_f32_16x16x32_bf16 v[136:139], a[204:207], v[112:115], v[136:139]
  v_mfma_f32_16x16x32_bf16 v[140:143], a[204:207], v[116:119], v[140:143]
  v_mfma_f32_16x16x32_bf16 v[144:147], a[208:211], v[112:115], v[144:147]
  v_mfma_f32_16x16x32_bf16 v[148:151], a[208:211], v[116:119], v[148:151]
  v_mfma_f32_16x16x32_bf16 v[152:155], a[212:215], v[112:115], v[152:155]
  v_mfma_f32_16x16x32_bf16 v[156:159], a[212:215], v[116:119], v[156:159]
  v_mfma_f32_16x16x32_bf16 v[160:163], a[216:219], v[112:115], v[160:163]
  v_mfma_f32_16x16x32_bf16 v[164:167], a[216:219], v[116:119], v[164:167]
  s_waitcnt vmcnt(0)
  v_mfma_f32_16x16x32_bf16 v[128:131], a[220:223], v[120:123], v[128:131]
  v_mfma_f32_16x16x32_bf16 v[132:135], a[220:223], v[124:127], v[132:135]
  v_mfma_f32_16x16x32_bf16 v[136:139], a[224:227], v[120:123], v[136:139]
  v_mfma_f32_16x16x32_bf16 v[140:143], a[224:227], v[124:127], v[140:143]
  v_mfma_f32_16x16x32_bf16 v[144:147], a[228:231], v[120:123], v[144:147]
  v_mfma_f32_16x16x32_bf16 v[148:151], a[228:231], v[124:127], v[148:151]
  v_mfma_f32_16x16x32_bf16 v[152:155], a[232:235], v[120:123], v[152:155]
  v_mfma_f32_16x16x32_bf16 v[156:159], a[232:235], v[124:127], v[156:159]
  v_mfma_f32_16x16x32_bf16 v[160:163], a[236:239], v[120:123], v[160:163]
  v_mfma_f32_16x16x32_bf16 v[164:167], a[236:239], v[124:127], v[164:167]
t3x_14215:
  s_cmp_eq_u32 s68, 63
  s_cbranch_scc1 t3q_14216
  buffer_load_dword v31, v25, s[48:51], 0 offen sc1
  buffer_load_dword v30, v24, s[48:51], 0 offen sc1
t3q_14216:
  s_nop 1
  ds_write_b128 v27, v[128:131] offset:0
  ds_write_b128 v27, v[132:135] offset:1024
  ds_write_b128 v27, v[136:139] offset:2048
  ds_write_b128 v27, v[140:143] offset:3072
  ds_write_b128 v27, v[144:147] offset:4096
  ds_write_b128 v27, v[148:151] offset:5120
  ds_write_b128 v27, v[152:155] offset:6144
  ds_write_b128 v27, v[156:159] offset:7168
  ds_write_b128 v27, v[160:163] offset:8192
  ds_write_b128 v27, v[164:167] offset:9216
  s_waitcnt lgkmcnt(0)
  s_barrier
  ds_read_b128 v[168:171], v28 offset:0
  ds_read_b128 v[172:175], v28 offset:10240
  ds_read_b128 v[176:179], v28 offset:20480
  ds_read_b128 v[180:183], v28 offset:30720
  s_waitcnt vmcnt(0)
  s_nop 1
  v_min_u32_dpp v30, v30, v30 row_ror:4 row_mask:0xf bank_mask:0xf
  s_nop 1
  v_min_u32_dpp v30, v30, v30 row_ror:2 row_mask:0xf bank_mask:0xf
  s_nop 1
  v_min_u32_dpp v30, v30, v30 row_ror:1 row_mask:0xf bank_mask:0xf
  s_nop 0
  v_readlane_b32 s72, v30, 0
  s_nop 1
  v_min_u32_dpp v31, v31, v31 row_ror:8 row_mask:0xf bank_mask:0xf
  s_nop 1
  v_min_u32_dpp v31, v31, v31 row_ror:4 row_mask:0xf bank_mask:0xf
  s_nop 1
  v_min_u32_dpp v31, v31, v31 row_ror:2 row_mask:0xf bank_mask:0xf
  s_nop 1
  v_min_u32_dpp v31, v31, v31 row_ror:1 row_mask:0xf bank_mask:0xf
  s_nop 0
  v_readlane_b32 s66, v31, 0
  s_cmp_eq_u32 s71, 0
  s_cbranch_scc1 t3p_14218
  s_add_u32 s58, s68, 0
  v_mov_b32 v18, s58
  s_mov_b64 exec, 1
  buffer_store_dword v18, v26, s[48:51], 0 offen sc1
  s_mov_b64 exec, -1
t3p_14218:
  s_cmp_eq_u32 s70, 1
  s_cbranch_scc1 t3l_14219
  s_add_u32 s60, s68, 2
  s_cmp_ge_u32 s72, s60
  s_cbranch_scc0 t3l_14219
  s_add_u32 s58, s73, 0
  buffer_load_dwordx4 v[32:35], v23, s[48:51], s58 offen offset:0 sc1
  buffer_load_dwordx4 v[36:39], v23, s[48:51], s58 offen offset:1024 sc1
  buffer_load_dwordx4 v[40:43], v23, s[48:51], s58 offen offset:2048 sc1
  buffer_load_dwordx4 v[44:47], v23, s[48:51], s58 offen offset:3072 sc1
  s_add_u32 s58, s73, 4096
  buffer_load_dwordx4 v[48:51], v23, s[48:51], s58 offen offset:0 sc1
  buffer_load_dwordx4 v[52:55], v23, s[48:51], s58 offen offset:1024 sc1
  buffer_load_dwordx4 v[56:59], v23, s[48:51], s58 offen offset:2048 sc1
  buffer_load_dwordx4 v[60:63], v23, s[48:51], s58 offen offset:3072 sc1
  s_add_u32 s58, s73, 8192
  buffer_load_dwordx4 v[64:67], v23, s[48:51], s58 offen offset:0 sc1
  buffer_load_dwordx4 v[68:71], v23, s[48:51], s58 offen offset:1024 sc1
  buffer_load_dwordx4 v[72:75], v23, s[48:51], s58 offen offset:2048 sc1
  buffer_load_dwordx4 v[76:79], v23, s[48:51], s58 offen offset:3072 sc1
  s_add_u32 s58, s73, 12288
  buffer_load_dwordx4 v[80:83], v23, s[48:51], s58 offen offset:0 sc1
  buffer_load_dwordx4 v[84:87], v23, s[48:51], s58 offen offset:1024 sc1
  buffer_load_dwordx4 v[88:91], v23, s[48:51], s58 offen offset:2048 sc1
  buffer_load_dwordx4 v[92:95], v23, s[48:51], s58 offen offset:3072 sc1
  s_add_u32 s58, s73, 16384
  buffer_load_dwordx4 v[96:99], v23, s[48:51], s58 offen offset:0 sc1
  buffer_load_dwordx4 v[100:103], v23, s[48:51], s58 offen offset:1024 sc1
  buffer_load_dwordx4 v[104:107], v23, s[48:51], s58 offen offset:2048 sc1
  buffer_load_dwordx4 v[108:111], v23, s[48:51], s58 offen offset:3072 sc1
  s_add_u32 s58, s73, 20480
  buffer_load_dwordx4 v[112:115], v23, s[48:51], s58 offen offset:0 sc1
  buffer_load_dwordx4 v[116:119], v23, s[48:51], s58 offen offset:1024 sc1
  buffer_load_dwordx4 v[120:123], v23, s[48:51], s58 offen offset:2048 sc1
  buffer_load_dwordx4 v[124:127], v23, s[48:51], s58 offen offset:3072 sc1
  s_mov_b32 s70, 1
t3l_14219:
  s_waitcnt lgkmcnt(2)
  v_add_f32 v168, v168, v172
  v_add_f32 v169, v169, v173
  v_add_f32 v170, v170, v174
  v_add_f32 v171, v171, v175
  s_waitcnt lgkmcnt(0)
  v_add_f32 v176, v176, v180
  v_add_f32 v177, v177, v181
  v_add_f32 v178, v178, v182
  v_add_f32 v179, v179, v183
  v_add_f32 v128, v168, v176
  v_add_f32 v129, v169, v177
  v_add_f32 v130, v170, v178
  v_add_f32 v131, v171, v179
  buffer_store_dwordx4 v[128:131], v29, s[48:51], s65 offen offset:0 sc1
t3r_14217:
  ds_read_b128 v[168:171], v28 offset:4096
  ds_read_b128 v[172:175], v28 offset:14336
  ds_read_b128 v[176:179], v28 offset:24576
  ds_read_b128 v[180:183], v28 offset:34816
  s_waitcnt lgkmcnt(2)
  v_add_f32 v168, v168, v172
  v_add_f32 v169, v169, v173
  v_add_f32 v170, v170, v174
  v_add_f32 v171, v171, v175
  s_waitcnt lgkmcnt(0)
  v_add_f32 v176, v176, v180
  v_add_f32 v177, v177, v181
  v_add_f32 v178, v178, v182
  v_add_f32 v179, v179, v183
  v_add_f32 v132, v168, v176
  v_add_f32 v133, v169, v177
  v_add_f32 v134, v170, v178
  v_add_f32 v135, v171, v179
  buffer_store_dwordx4 v[132:135], v29, s[48:51], s65 offen offset:128 sc1
t3r_14220:
  s_cmp_ge_u32 s52, 2
  s_cbranch_scc1 t3r_14221
  ds_read_b128 v[168:171], v28 offset:8192
  ds_read_b128 v[172:175], v28 offset:18432
  ds_read_b128 v[176:179], v28 offset:28672
  ds_read_b128 v[180:183], v28 offset:38912
  s_waitcnt lgkmcnt(2)
  v_add_f32 v168, v168, v172
  v_add_f32 v169, v169, v173
  v_add_f32 v170, v170, v174
  v_add_f32 v171, v171, v175
  s_waitcnt lgkmcnt(0)
  v_add_f32 v176, v176, v180
  v_add_f32 v177, v177, v181
  v_add_f32 v178, v178, v182
  v_add_f32 v179, v179, v183
  v_add_f32 v136, v168, v176
  v_add_f32 v137, v169, v177
  v_add_f32 v138, v170, v178
  v_add_f32 v139, v171, v179
  buffer_store_dwordx4 v[136:139], v29, s[48:51], s65 offen offset:256 sc1
t3r_14221:
  v_xor_b32 v27, 0x10000, v27
  v_xor_b32 v28, 0x10000, v28
  s_mov_b32 s69, s70
  s_mov_b32 s71, s70
  s_cmp_eq_u32 s70, 1
  s_cbranch_scc1 t3d_14222
  s_waitcnt vmcnt(0)
  s_add_u32 s58, s68, 1
  v_mov_b32 v18, s58
  s_mov_b64 exec, 1
  buffer_store_dword v18, v26, s[48:51], 0 offen sc1
  s_mov_b64 exec, -1
t3d_14222:
  s_sub_u32 s67, s68, 2
  s_and_b32 s58, s67, 3
  s_cmp_lt_u32 s68, 2
  s_cbranch_scc1 t3n_14223
  s_cmp_lg_u32 s58, s53
  s_cbranch_scc1 t3n_14223
  s_cmp_ge_u32 s68, 62
  s_cbranch_scc1 t3n_14223
  s_cmp_eq_u32 s74, 1
  s_cbranch_scc0 t3fl_14224
  s_mul_i32 s61, s67, 81920
  v_add_f32 v192, v192, v196
  v_add_f32 v200, v200, v204
  v_add_f32 v193, v193, v197
  v_add_f32 v201, v201, v205
  v_add_f32 v194, v194, v198
  v_add_f32 v202, v202, v206
  v_add_f32 v195, v195, v199
  v_add_f32 v203, v203, v207
  v_add_f32 v192, v192, v200
  v_add_f32 v193, v193, v201
  v_add_f32 v194, v194, v202
  v_add_f32 v195, v195, v203
  v_cvt_pk_bf16_f32 v192, v192, v193
  v_cvt_pk_bf16_f32 v193, v194, v195
  buffer_store_dwordx2 v[192:193], v187, s[40:43], s61 offen
t3s_14225:
  v_add_f32 v208, v208, v212
  v_add_f32 v216, v216, v220
  v_add_f32 v209, v209, v213
  v_add_f32 v217, v217, v221
  v_add_f32 v210, v210, v214
  v_add_f32 v218, v218, v222
  v_add_f32 v211, v211, v215
  v_add_f32 v219, v219, v223
  v_add_f32 v208, v208, v216
  v_add_f32 v209, v209, v217
  v_add_f32 v210, v210, v218
  v_add_f32 v211, v211, v219
  v_cvt_pk_bf16_f32 v208, v208, v209
  v_cvt_pk_bf16_f32 v209, v210, v211
  buffer_store_dwordx2 v[208:209], v188, s[40:43], s61 offen
t3s_14226:
  s_cmp_ge_u32 s52, 2
  s_cbranch_scc1 t3s_14227
  v_add_f32 v224, v224, v228
  v_add_f32 v232, v232, v236
  v_add_f32 v225, v225, v229
  v_add_f32 v233, v233, v237
  v_add_f32 v226, v226, v230
  v_add_f32 v234, v234, v238
  v_add_f32 v227, v227, v231
  v_add_f32 v235, v235, v239
  v_add_f32 v224, v224, v232
  v_add_f32 v225, v225, v233
  v_add_f32 v226, v226, v234
  v_add_f32 v227, v227, v235
  v_cvt_pk_bf16_f32 v224, v224, v225
  v_cvt_pk_bf16_f32 v225, v226, v227
  buffer_store_dwordx2 v[224:225], v189, s[40:43], s61 offen
t3s_14227:
  s_branch t3n_14223
t3fl_14224:
  s_add_u32 s60, s67, 1
  s_cmp_ge_u32 s66, s60
  s_cbranch_scc1 t3fad_14229
  s_mov_b32 s56, 0
t3fa_14228:
  buffer_load_dword v18, v25, s[48:51], 0 offen sc1
  s_waitcnt vmcnt(0)
  s_nop 1
  v_min_u32_dpp v18, v18, v18 row_ror:8 row_mask:0xf bank_mask:0xf
  s_nop 1
  v_min_u32_dpp v18, v18, v18 row_ror:4 row_mask:0xf bank_mask:0xf
  s_nop 1
  v_min_u32_dpp v18, v18, v18 row_ror:2 row_mask:0xf bank_mask:0xf
  s_nop 1
  v_min_u32_dpp v18, v18, v18 row_ror:1 row_mask:0xf bank_mask:0xf
  s_nop 0
  v_readlane_b32 s66, v18, 0
  s_cmp_ge_u32 s66, s60
  s_cbranch_scc1 t3fad_14229
  s_cmp_lg_u32 s55, 0
  s_cbranch_scc1 t3fad_14229
  s_add_u32 s56, s56, 1
  s_cmp_lt_u32 s56, 0x20000
  s_cbranch_scc1 t3fa_14228
  s_mov_b32 s55, 1
t3fad_14229:
  s_mul_i32 s60, s67, 327680
  s_add_u32 s60, s60, 0x6200000
  s_add_u32 s58, s60, 0
  buffer_load_dwordx4 v[192:195], v184, s[48:51], s58 offen sc1
  s_add_u32 s58, s60, 81920
  buffer_load_dwordx4 v[196:199], v184, s[48:51], s58 offen sc1
  s_add_u32 s58, s60, 163840
  buffer_load_dwordx4 v[200:203], v184, s[48:51], s58 offen sc1
  s_add_u32 s58, s60, 245760
  buffer_load_dwordx4 v[204:207], v184, s[48:51], s58 offen sc1
t3k_14230:
  s_add_u32 s58, s60, 0
  buffer_load_dwordx4 v[208:211], v185, s[48:51], s58 offen sc1
  s_add_u32 s58, s60, 81920
  buffer_load_dwordx4 v[212:215], v185, s[48:51], s58 offen sc1
  s_add_u32 s58, s60, 163840
  buffer_load_dwordx4 v[216:219], v185, s[48:51], s58 offen sc1
  s_add_u32 s58, s60, 245760
  buffer_load_dwordx4 v[220:223], v185, s[48:51], s58 offen sc1
t3k_14231:
  s_cmp_ge_u32 s52, 2
  s_cbranch_scc1 t3k_14232
  s_add_u32 s58, s60, 0
  buffer_load_dwordx4 v[224:227], v186, s[48:51], s58 offen sc1
  s_add_u32 s58, s60, 81920
  buffer_load_dwordx4 v[228:231], v186, s[48:51], s58 offen sc1
  s_add_u32 s58, s60, 163840
  buffer_load_dwordx4 v[232:235], v186, s[48:51], s58 offen sc1
  s_add_u32 s58, s60, 245760
  buffer_load_dwordx4 v[236:239], v186, s[48:51], s58 offen sc1
t3k_14232:
  s_waitcnt vmcnt(0)
  s_mul_i32 s61, s67, 81920
  v_add_f32 v192, v192, v196
  v_add_f32 v200, v200, v204
  v_add_f32 v193, v193, v197
  v_add_f32 v201, v201, v205
  v_add_f32 v194, v194, v198
  v_add_f32 v202, v202, v206
  v_add_f32 v195, v195, v199
  v_add_f32 v203, v203, v207
  v_add_f32 v192, v192, v200
  v_add_f32 v193, v193, v201
  v_add_f32 v194, v194, v202
  v_add_f32 v195, v195, v203
  v_cvt_pk_bf16_f32 v192, v192, v193
  v_cvt_pk_bf16_f32 v193, v194, v195
  buffer_store_dwordx2 v[192:193], v187, s[40:43], s61 offen
t3s_14233:
  v_add_f32 v208, v208, v212
  v_add_f32 v216, v216, v220
  v_add_f32 v209, v209, v213
  v_add_f32 v217, v217, v221
  v_add_f32 v210, v210, v214
  v_add_f32 v218, v218, v222
  v_add_f32 v211, v211, v215
  v_add_f32 v219, v219, v223
  v_add_f32 v208, v208, v216
  v_add_f32 v209, v209, v217
  v_add_f32 v210, v210, v218
  v_add_f32 v211, v211, v219
  v_cvt_pk_bf16_f32 v208, v208, v209
  v_cvt_pk_bf16_f32 v209, v210, v211
  buffer_store_dwordx2 v[208:209], v188, s[40:43], s61 offen
t3s_14234:
  s_cmp_ge_u32 s52, 2
  s_cbranch_scc1 t3s_14235
  v_add_f32 v224, v224, v228
  v_add_f32 v232, v232, v236
  v_add_f32 v225, v225, v229
  v_add_f32 v233, v233, v237
  v_add_f32 v226, v226, v230
  v_add_f32 v234, v234, v238
  v_add_f32 v227, v227, v231
  v_add_f32 v235, v235, v239
  v_add_f32 v224, v224, v232
  v_add_f32 v225, v225, v233
  v_add_f32 v226, v226, v234
  v_add_f32 v227, v227, v235
  v_cvt_pk_bf16_f32 v224, v224, v225
  v_cvt_pk_bf16_f32 v225, v226, v227
  buffer_store_dwordx2 v[224:225], v189, s[40:43], s61 offen
t3s_14235:
t3n_14223:
  s_add_u32 s64, s64, 393216
  s_add_u32 s65, s65, 327680
  s_add_u32 s68, s68, 1
  s_cmp_lt_u32 s68, 64
  s_cbranch_scc1 L_t3_i
  s_add_u32 s67, s53, 60
  s_add_u32 s60, s67, 1
  s_cmp_ge_u32 s66, s60
  s_cbranch_scc1 t3fbd_14238
  s_mov_b32 s56, 0
t3fb_14237:
  buffer_load_dword v18, v25, s[48:51], 0 offen sc1
  s_waitcnt vmcnt(0)
  s_nop 1
  v_min_u32_dpp v18, v18, v18 row_ror:8 row_mask:0xf bank_mask:0xf
  s_nop 1
  v_min_u32_dpp v18, v18, v18 row_ror:4 row_mask:0xf bank_mask:0xf
  s_nop 1
  v_min_u32_dpp v18, v18, v18 row_ror:2 row_mask:0xf bank_mask:0xf
  s_nop 1
  v_min_u32_dpp v18, v18, v18 row_ror:1 row_mask:0xf bank_mask:0xf
  s_nop 0
  v_readlane_b32 s66, v18, 0
  s_cmp_ge_u32 s66, s60
  s_cbranch_scc1 t3fbd_14238
  s_cmp_lg_u32 s55, 0
  s_cbranch_scc1 t3fbd_14238
  s_add_u32 s56, s56, 1
  s_cmp_lt_u32 s56, 0x20000
  s_cbranch_scc1 t3fb_14237
  s_mov_b32 s55, 1
t3fbd_14238:
  s_mul_i32 s60, s67, 327680
  s_add_u32 s60, s60, 0x6200000
  s_add_u32 s58, s60, 0
  buffer_load_dwordx4 v[192:195], v184, s[48:51], s58 offen sc1
  s_add_u32 s58, s60, 81920
  buffer_load_dwordx4 v[196:199], v184, s[48:51], s58 offen sc1
  s_add_u32 s58, s60, 163840
  buffer_load_dwordx4 v[200:203], v184, s[48:51], s58 offen sc1
  s_add_u32 s58, s60, 245760
  buffer_load_dwordx4 v[204:207], v184, s[48:51], s58 offen sc1
t3k_14239:
  s_add_u32 s58, s60, 0
  buffer_load_dwordx4 v[208:211], v185, s[48:51], s58 offen sc1
  s_add_u32 s58, s60, 81920
  buffer_load_dwordx4 v[212:215], v185, s[48:51], s58 offen sc1
  s_add_u32 s58, s60, 163840
  buffer_load_dwordx4 v[216:219], v185, s[48:51], s58 offen sc1
  s_add_u32 s58, s60, 245760
  buffer_load_dwordx4 v[220:223], v185, s[48:51], s58 offen sc1
t3k_14240:
  s_cmp_ge_u32 s52, 2
  s_cbranch_scc1 t3k_14241
  s_add_u32 s58, s60, 0
  buffer_load_dwordx4 v[224:227], v186, s[48:51], s58 offen sc1
  s_add_u32 s58, s60, 81920
  buffer_load_dwordx4 v[228:231], v186, s[48:51], s58 offen sc1
  s_add_u32 s58, s60, 163840
  buffer_load_dwordx4 v[232:235], v186, s[48:51], s58 offen sc1
  s_add_u32 s58, s60, 245760
  buffer_load_dwordx4 v[236:239], v186, s[48:51], s58 offen sc1
t3k_14241:
  s_waitcnt vmcnt(0)
  s_mul_i32 s61, s67, 81920
  v_add_f32 v192, v192, v196
  v_add_f32 v200, v200, v204
  v_add_f32 v193, v193, v197
  v_add_f32 v201, v201, v205
  v_add_f32 v194, v194, v198
  v_add_f32 v202, v202, v206
  v_add_f32 v195, v195, v199
  v_add_f32 v203, v203, v207
  v_add_f32 v192, v192, v200
  v_add_f32 v193, v193, v201
  v_add_f32 v194, v194, v202
  v_add_f32 v195, v195, v203
  v_cvt_pk_bf16_f32 v192, v192, v193
  v_cvt_pk_bf16_f32 v193, v194, v195
  buffer_store_dwordx2 v[192:193], v187, s[40:43], s61 offen
t3s_14242:
  v_add_f32 v208, v208, v212
  v_add_f32 v216, v216, v220
  v_add_f32 v209, v209, v213
  v_add_f32 v217, v217, v221
  v_add_f32 v210, v210, v214
  v_add_f32 v218, v218, v222
  v_add_f32 v211, v211, v215
  v_add_f32 v219, v219, v223
  v_add_f32 v208, v208, v216
  v_add_f32 v209, v209, v217
  v_add_f32 v210, v210, v218
  v_add_f32 v211, v211, v219
  v_cvt_pk_bf16_f32 v208, v208, v209
  v_cvt_pk_bf16_f32 v209, v210, v211
  buffer_store_dwordx2 v[208:209], v188, s[40:43], s61 offen
t3s_14243:
  s_cmp_ge_u32 s52, 2
  s_cbranch_scc1 t3s_14244
  v_add_f32 v224, v224, v228
  v_add_f32 v232, v232, v236
  v_add_f32 v225, v225, v229
  v_add_f32 v233, v233, v237
  v_add_f32 v226, v226, v230
  v_add_f32 v234, v234, v238
  v_add_f32 v227, v227, v231
  v_add_f32 v235, v235, v239
  v_add_f32 v224, v224, v232
  v_add_f32 v225, v225, v233
  v_add_f32 v226, v226, v234
  v_add_f32 v227, v227, v235
  v_cvt_pk_bf16_f32 v224, v224, v225
  v_cvt_pk_bf16_f32 v225, v226, v227
  buffer_store_dwordx2 v[224:225], v189, s[40:43], s61 offen
t3s_14244:
t3e_14236:
  s_waitcnt vmcnt(0)
  s_endpgm
.section .rodata,"a"
.p2align 6
.amdhsa_kernel concat_heads__memory_aug_recurrent_mem_tr__mha_block__prompt_kernel
  .amdhsa_next_free_vgpr 512
  .amdhsa_next_free_sgpr 102
  .amdhsa_accum_offset 256
  .amdhsa_group_segment_fixed_size 0
  .amdhsa_kernarg_size 104
  .amdhsa_user_sgpr_count 2
  .amdhsa_user_sgpr_kernarg_segment_ptr 1
  .amdhsa_system_sgpr_workgroup_id_x 1
.end_amdhsa_kernel
```
